```python
import torch

def _softmax(x, axis=-1):
    return torch.softmax(x, dim=axis)
def _gelu(x):
    return torch.nn.functional.gelu(x, approximate="tanh")
def _silu(x):
    return torch.nn.functional.silu(x)
def _sigmoid(x):
    return torch.sigmoid(x)
def _layernorm(x, axis=-1, eps=1e-5):
    m = x.mean(dim=axis, keepdim=True)
    v = x.var(dim=axis, keepdim=True, unbiased=False)
    return (x - m) / torch.sqrt(v + eps)
def _scatter_add(tgt, idx, src, axis=0):
    return tgt.clone().index_add_(axis, idx, src)
def _segment_sum(src, seg, n):
    out = torch.zeros((n,) + src.shape[1:], dtype=src.dtype)
    return out.index_add_(0, seg, src)
def _pad(x, pw):
    flat = tuple(v for pair in reversed(pw) for v in pair)
    return torch.nn.functional.pad(x, flat)

kernel_name = 'gated_mix__compressed_kv_cla__dense_activation_silu__prompt'

def setup_inputs():

    _w = (lambda a: (lambda t: t.to(torch.bfloat16) if t.is_floating_point() else t)(torch.as_tensor(a)))
    def _A_setup():
        B, H, Sq, Sk, D, M = 1, 32, 2048, 2048, 128, 576
        Dc = 4 * D
        return {
            "x": _w((lambda *s: torch.randn(*s, dtype=torch.bfloat16) * 0.1)(B, Sq, M)),
            "c_kv": _w((lambda *s: torch.randn(*s, dtype=torch.bfloat16) * 0.8)(B, Sk, Dc)),
            "w_q": _w((lambda *s: torch.randn(*s, dtype=torch.bfloat16) * 6.4)(M, H, D) * (M ** -0.5)),
            "w_uk": _w((lambda *s: torch.randn(*s, dtype=torch.bfloat16) * 6.4)(Dc, H, D) * (Dc ** -0.5)),
            "w_uv": _w((lambda *s: torch.randn(*s, dtype=torch.bfloat16) * 0.8)(Dc, H, D) * (Dc ** -0.5)),
            "w_o": _w((lambda *s: torch.randn(*s, dtype=torch.bfloat16) * 0.8)(H, D, M) * ((H * D) ** -0.5)),
        }
    _A_in = _A_setup()

    def _B_setup():
        B, S, D, F = 1, 2048, 576, 4608
        return {
            "x": _w((lambda *s: torch.randn(*s, dtype=torch.bfloat16) * 0.1)(B, S, D)),
            "w1": _w((lambda *s: torch.randn(*s, dtype=torch.bfloat16) * 3.2)(D, F) * (D ** -0.5)),
            "w2": _w((lambda *s: torch.randn(*s, dtype=torch.bfloat16) * 3.2)(F, D) * (F ** -0.5)),
        }
    _B_in = _B_setup()

    return {
        "A_x": _A_in["x"],
        "A_c_kv": _A_in["c_kv"],
        "A_w_q": _A_in["w_q"],
        "A_w_uk": _A_in["w_uk"],
        "A_w_uv": _A_in["w_uv"],
        "A_w_o": _A_in["w_o"],
        "B_x": _B_in["x"],
        "B_w1": _B_in["w1"],
        "B_w2": _B_in["w2"],
        "gate_w": _w((lambda *s: torch.randn(*s, dtype=torch.bfloat16) * 0.1)(576) * 16.0),
    }

def reference(A_x, A_c_kv, A_w_q, A_w_uk, A_w_uv, A_w_o, B_x, B_w1, B_w2, gate_w):
    def _A_ref(x, c_kv, w_q, w_uk, w_uv, w_o):
        B, Sq, M = x.shape[0], x.shape[1], x.shape[2]
        Sk = c_kv.shape[1]
        H, D = w_q.shape[1], w_q.shape[2]
        q = torch.einsum("bqm,mhd->bhqd", x, w_q)
        k = torch.einsum("bkc,chd->bhkd", c_kv, w_uk)
        v = torch.einsum("bkc,chd->bhkd", c_kv, w_uv)
        scores = torch.einsum("bhqd,bhkd->bhqk", q, k) * (D ** -0.5)
        off = Sk - Sq
        qi = torch.arange(Sq)[:, None]
        kj = torch.arange(Sk)[None, :]
        cmask = kj <= (qi + off)
        scores = torch.where(cmask[None, None], scores, -1e9)
        p = _softmax(scores, axis=-1)
        ctx = torch.einsum("bhqk,bhkd->bhqd", p, v)
        return torch.einsum("bhqd,hdm->bqm", ctx, w_o)

    def _B_ref(x, w1, w2):
        h = torch.einsum("bsd,df->bsf", x, w1)
        h = _silu(h)
        out = torch.einsum("bsf,fd->bsd", h, w2)
        return out

    x = A_x
    g = _sigmoid((x * gate_w).sum(-1, keepdims=True))
    a = _A_ref(x, A_c_kv, A_w_q, A_w_uk, A_w_uv, A_w_o)
    b = _B_ref(x, B_w1, B_w2)
    return g * a + (1 - g) * b
```

```asm
; @launch grid=(256,1,1) block=(256,1,1) lds=163840
.amdgcn_target "amdgcn-amd-amdhsa--gfx950"
.text
.macro Maav d, a, b
  v_mfma_f32_16x16x32_bf16 a[\d:\d+3], a[\a:\a+3], v[\b:\b+3], a[\d:\d+3]
.endm
.macro Mvav d, a, b
  v_mfma_f32_16x16x32_bf16 v[\d:\d+3], a[\a:\a+3], v[\b:\b+3], v[\d:\d+3]
.endm
.macro Mvva d, a, b
  v_mfma_f32_16x16x32_bf16 v[\d:\d+3], v[\a:\a+3], a[\b:\b+3], v[\d:\d+3]
.endm
.macro Mvvv d, a, b
  v_mfma_f32_16x16x32_bf16 v[\d:\d+3], v[\a:\a+3], v[\b:\b+3], v[\d:\d+3]
.endm
.macro TR d, a, o
  ds_read_b64_tr_b16 v[\d:\d+1], v[\a] offset:\o
.endm
.macro WL n
  s_waitcnt lgkmcnt(\n)
.endm
.globl gated_mix__compressed_kv_cla__dense_activation_silu__prompt_kernel
.p2align 8
.type gated_mix__compressed_kv_cla__dense_activation_silu__prompt_kernel,@function
gated_mix__compressed_kv_cla__dense_activation_silu__prompt_kernel:
  s_cmp_ge_u32 s2, 256
  s_cbranch_scc1 Lexit1
  v_lshrrev_b32 v1, 6, v0
  v_and_b32 v0, 63, v0
  v_readfirstlane_b32 s3, v1
  s_mov_b32 s6, 0
  s_getpc_b64 s[46:47]
Lpc0:
  s_lshr_b32 s44, s2, 1
  s_and_b32 s44, s44, 60
  s_add_u32 s44, s44, s3
  s_lshl_b32 s44, s44, 13
  v_lshl_add_u32 v1, v0, 7, s44
  v_min_u32 v1, Lend-Lpc0-4, v1
  global_load_dword v47, v1, s[46:47]
  s_lshr_b32 s44, s2, 1
  s_and_b32 s44, s44, 0x7c
  s_add_u32 s44, s44, s3
  s_lshl_b32 s44, s44, 7
  s_add_u32 s100, s46, s44
  s_addc_u32 s101, s47, 0
Lstart:
  s_load_dwordx2 s[12:13], s[0:1], 0
  s_load_dwordx2 s[40:41], s[0:1], 72
  s_load_dwordx2 s[8:9], s[0:1], 8
  s_load_dwordx2 s[16:17], s[0:1], 24
  s_load_dwordx2 s[24:25], s[0:1], 32
  s_load_dwordx2 s[20:21], s[0:1], 96
  s_load_dwordx2 s[28:29], s[0:1], 56
  s_load_dwordx2 s[32:33], s[0:1], 16
  s_load_dwordx2 s[36:37], s[0:1], 88
  s_and_b32 s4, s2, 31
  s_lshr_b32 s5, s2, 5
  v_lshrrev_b32 v28, 3, v0
  s_lshl_b32 s44, s3, 3
  v_add_u32 v28, s44, v28
  v_and_b32 v30, 3, v28
  v_bfe_u32 v29, v28, 2, 2
  v_lshl_add_u32 v30, v29, 3, v30
  v_lshrrev_b32 v29, 4, v28
  v_lshl_add_u32 v30, v29, 2, v30
  v_bfe_u32 v28, v28, 1, 2
  v_bfe_u32 v29, v0, 1, 2
  v_xor_b32 v28, v28, v29
  v_and_b32 v29, 1, v0
  v_lshlrev_b32 v29, 4, v29
  v_lshl_add_u32 v31, v28, 5, v29
  v_lshl_add_u32 v7, v30, 13, v31
  v_mul_u32_u24 v30, 9216, v30
  v_add_u32 v8, v30, v31
  v_lshrrev_b32 v28, 4, v0
  v_and_b32 v29, 7, v0
  v_xor_b32 v28, v28, v29
  v_lshlrev_b32 v28, 4, v28
  v_lshrrev_b32 v29, 3, v0
  v_lshl_add_u32 v10, v29, 10, v28
  v_xor_b32 v11, 64, v10
  s_lshl_b32 s50, s3, 12
  s_mul_i32 s51, s3, 24576
  s_add_u32 s51, s51, 0x10000
  s_lshl_b32 s44, s5, 2
  s_add_u32 s44, s44, s3
  s_lshl_b32 s52, s44, 16
  s_lshl_b32 s54, s4, 8
  s_mov_b32 s10, 0x200000
  s_mov_b32 s11, 0x00020000
  s_mov_b32 s18, 0x400000
  s_mov_b32 s19, 0x00020000
  s_mov_b32 s14, 0x240000
  s_mov_b32 s15, 0x00020000
  s_mov_b32 s42, 0x480
  s_mov_b32 s43, 0x00020000
  s_add_u32 m0, s50, 0
  s_add_u32 s48, s54, 0
 WL 0
  buffer_load_dwordx4 v7, s[16:19], s48 offen lds
  s_add_u32 s48, s54, 261120
  buffer_load_dwordx4 v7, s[16:19], s48 offen offset:1024 lds
  s_add_u32 m0, s51, 0
  s_add_u32 s48, s52, 0
  buffer_load_dwordx4 v10, s[8:11], s48 offen lds
  s_add_u32 s48, s52, 7168
  buffer_load_dwordx4 v11, s[8:11], s48 offen offset:1024 lds
  s_add_u32 s48, s52, 14336
  buffer_load_dwordx4 v10, s[8:11], s48 offen offset:2048 lds
  s_add_u32 s48, s52, 21504
  buffer_load_dwordx4 v11, s[8:11], s48 offen offset:3072 lds
  s_add_u32 m0, s51, 4096
  s_add_u32 s48, s52, 32768
  buffer_load_dwordx4 v10, s[8:11], s48 offen lds
  s_add_u32 s48, s52, 39936
  buffer_load_dwordx4 v11, s[8:11], s48 offen offset:1024 lds
  s_add_u32 s48, s52, 47104
  buffer_load_dwordx4 v10, s[8:11], s48 offen offset:2048 lds
  s_add_u32 s48, s52, 54272
  buffer_load_dwordx4 v11, s[8:11], s48 offen offset:3072 lds
  s_lshl_b32 s44, s5, 2
  s_add_u32 s44, s44, s3
  s_lshl_b32 s45, s44, 17
  s_add_u32 s45, s45, s54
  v_lshrrev_b32 v44, 2, v0
  v_and_b32 v45, 3, v0
  v_lshlrev_b32 v45, 6, v45
  v_lshl_add_u32 v44, v44, 13, v45
  buffer_load_dword v47, v44, s[16:19], s45 offen
  s_lshl_b32 s45, s2, 2
  s_add_u32 s45, s45, s3
  s_lshl_b32 s45, s45, 11
  v_lshlrev_b32 v44, 5, v0
  buffer_load_dword v47, v44, s[8:11], s45 offen
  s_add_u32 m0, s50, 2048
  s_add_u32 s48, s54, 128
  buffer_load_dwordx4 v7, s[16:19], s48 offen lds
  s_add_u32 m0, s50, 0
  s_add_u32 s48, s54, 259200
  buffer_load_dwordx4 v7, s[16:19], s48 offen offset:3072 lds
  s_add_u32 m0, s51, 8192
  s_add_u32 s48, s52, 128
  buffer_load_dwordx4 v10, s[8:11], s48 offen lds
  s_add_u32 s48, s52, 7296
  buffer_load_dwordx4 v11, s[8:11], s48 offen offset:1024 lds
  s_add_u32 s48, s52, 14464
  buffer_load_dwordx4 v10, s[8:11], s48 offen offset:2048 lds
  s_add_u32 s48, s52, 21632
  buffer_load_dwordx4 v11, s[8:11], s48 offen offset:3072 lds
  s_add_u32 m0, s51, 12288
  s_add_u32 s48, s52, 32896
  buffer_load_dwordx4 v10, s[8:11], s48 offen lds
  s_add_u32 s48, s52, 40064
  buffer_load_dwordx4 v11, s[8:11], s48 offen offset:1024 lds
  s_add_u32 s48, s52, 47232
  buffer_load_dwordx4 v10, s[8:11], s48 offen offset:2048 lds
  v_lshrrev_b32 v228, 5, v0
  s_sub_u32 s44, 15, s5
  s_cmp_lt_u32 s4, 16
  s_cselect_b32 s44, s44, s5
  s_lshl_b32 s44, s44, 4
  s_and_b32 s45, s4, 15
  s_add_u32 s44, s44, s45
  s_lshl_b32 s44, s44, 2
  s_add_u32 s44, s44, s3
  s_lshl_b32 s44, s44, 1
  v_add_u32 v226, s44, v228
  v_mul_u32_u24 v224, 1152, v226
  v_and_b32 v228, 31, v0
  v_lshlrev_b32 v225, 4, v228
  v_add_u32 v224, v224, v225
  buffer_load_dwordx4 v[192:195], v224, s[12:15], 0 offen
  buffer_load_dwordx4 v[196:199], v224, s[12:15], 0 offen offset:512
  buffer_load_dwordx4 v[200:203], v224, s[12:15], 0 offen offset:1024
  buffer_load_dwordx4 v[208:211], v225, s[40:43], 0 offen
  buffer_load_dwordx4 v[212:215], v225, s[40:43], 0 offen offset:512
  buffer_load_dwordx4 v[216:219], v225, s[40:43], 0 offen offset:1024
  s_sub_u32 s44, 15, s5
  s_cmp_lt_u32 s4, 16
  s_cselect_b32 s44, s44, s5
  s_bfe_u32 s45, s4, 0x30001
  s_and_b32 s46, s4, 1
  s_mul_i32 s46, s46, 9
  s_mul_i32 s7, s44, 18
  s_add_u32 s7, s7, s46
  s_lshl_b32 s7, s7, 3
  s_add_u32 s7, s7, s45
  s_lshl_b32 s7, s7, 10
  s_add_u32 s7, s7, 0x5800000
  s_lshl_b32 s44, s44, 3
  s_add_u32 s44, s44, s45
  s_mul_i32 s44, s44, 18432
  s_lshl_b32 s46, s46, 6
  s_add_u32 s44, s44, s46
  s_lshl_b32 s45, s3, 6
  s_add_u32 s45, s45, s44
  v_and_b32 v252, 15, v0
  v_mul_u32_u24 v252, 1152, v252
  v_and_b32 v253, 48, v0
  v_add_u32 v252, v252, v253
  buffer_load_dwordx4 v[240:243], v252, s[12:15], s45 offen
  buffer_load_dwordx4 v[244:247], v252, s[12:15], s45 offen offset:256
  buffer_load_dwordx4 v[248:251], v252, s[12:15], s44 offen offset:512
  s_add_u32 s48, s52, 54400
  buffer_load_dwordx4 v11, s[8:11], s48 offen offset:3072 lds
  s_add_u32 m0, s50, 16384
  s_add_u32 s48, s54, 524288
  buffer_load_dwordx4 v7, s[16:19], s48 offen lds
  s_add_u32 s48, s54, 785408
  buffer_load_dwordx4 v7, s[16:19], s48 offen offset:1024 lds
  s_add_u32 s48, s54, 522368
  buffer_load_dwordx4 v7, s[16:19], s48 offen offset:2048 lds
  s_add_u32 s48, s54, 783488
  buffer_load_dwordx4 v7, s[16:19], s48 offen offset:3072 lds
  s_add_u32 m0, s51, 16384
  s_add_u32 s48, s52, 256
  buffer_load_dwordx4 v10, s[8:11], s48 offen lds
  s_add_u32 s48, s52, 7424
  buffer_load_dwordx4 v11, s[8:11], s48 offen offset:1024 lds
  s_add_u32 s48, s52, 14592
  buffer_load_dwordx4 v10, s[8:11], s48 offen offset:2048 lds
  s_add_u32 s48, s52, 21760
  buffer_load_dwordx4 v11, s[8:11], s48 offen offset:3072 lds
  s_add_u32 m0, s51, 20480
  s_add_u32 s48, s52, 33024
  buffer_load_dwordx4 v10, s[8:11], s48 offen lds
  s_add_u32 s48, s52, 40192
  buffer_load_dwordx4 v11, s[8:11], s48 offen offset:1024 lds
  s_add_u32 s48, s52, 47360
  buffer_load_dwordx4 v10, s[8:11], s48 offen offset:2048 lds
  s_add_u32 s48, s52, 54528
  buffer_load_dwordx4 v11, s[8:11], s48 offen offset:3072 lds
  s_add_u32 m0, s50, 32768
  s_add_u32 s48, s54, 1048576
  buffer_load_dwordx4 v7, s[16:19], s48 offen lds
  s_add_u32 s48, s54, 1309696
  buffer_load_dwordx4 v7, s[16:19], s48 offen offset:1024 lds
  s_add_u32 s48, s54, 1046656
  buffer_load_dwordx4 v7, s[16:19], s48 offen offset:2048 lds
  s_add_u32 s48, s54, 1307776
  buffer_load_dwordx4 v7, s[16:19], s48 offen offset:3072 lds
  s_add_u32 m0, s50, 49152
  s_add_u32 s48, s54, 1572864
  buffer_load_dwordx4 v7, s[16:19], s48 offen lds
  s_add_u32 s48, s54, 1833984
  buffer_load_dwordx4 v7, s[16:19], s48 offen offset:1024 lds
  s_add_u32 s48, s54, 1570944
  buffer_load_dwordx4 v7, s[16:19], s48 offen offset:2048 lds
  s_add_u32 s48, s54, 1832064
  buffer_load_dwordx4 v7, s[16:19], s48 offen offset:3072 lds
  s_load_dwordx2 s[12:13], s[0:1], 64
  s_load_dwordx2 s[40:41], s[0:1], 40
  s_mov_b32 s14, 5308416
  s_mov_b32 s42, 4718592
  s_mov_b32 s26, 0x400000
  s_mov_b32 s27, 0x00020000
  s_mov_b32 s22, 0x8000000
  s_mov_b32 s23, 0x00020000
  s_mov_b32 s30, 0x510000
  s_mov_b32 s31, 0x00020000
  s_mov_b32 s34, 0x480000
  s_mov_b32 s35, 0x00020000
  s_mov_b32 s38, 0x100
  s_mov_b32 s39, 0x00020000
  v_bfe_u32 v28, v0, 2, 3
  v_lshlrev_b32 v28, 7, v28
  v_and_b32 v29, 3, v0
  v_lshl_add_u32 v28, v29, 3, v28
  v_lshrrev_b32 v29, 5, v0
  v_lshl_add_u32 v28, v29, 12, v28
  v_bfe_u32 v29, v0, 3, 2
  v_xor_b32 v30, 0, v29
  v_lshl_add_u32 v1, v30, 5, v28
  v_xor_b32 v30, 1, v29
  v_lshl_add_u32 v2, v30, 5, v28
  v_xor_b32 v30, 2, v29
  v_lshl_add_u32 v3, v30, 5, v28
  v_xor_b32 v30, 3, v29
  v_lshl_add_u32 v4, v30, 5, v28
  v_lshlrev_b32 v28, 3, v0
  v_add_u32 v5, 0x20000, v28
  v_lshrrev_b32 v28, 1, v0
  v_and_b32 v30, 3, v28
  v_bfe_u32 v29, v28, 2, 2
  v_lshl_add_u32 v30, v29, 3, v30
  v_lshrrev_b32 v29, 4, v28
  v_lshl_add_u32 v30, v29, 2, v30
  s_lshl_b32 s44, s3, 5
  v_add_u32 v30, s44, v30
  v_mul_u32_u24 v30, 9216, v30
  v_and_b32 v29, 1, v0
  v_lshl_add_u32 v9, v29, 4, v30
  v_and_b32 v28, 15, v0
  v_lshrrev_b32 v29, 1, v28
  v_lshrrev_b32 v30, 4, v0
  v_xor_b32 v29, v29, v30
  v_lshlrev_b32 v29, 4, v29
  v_lshl_add_u32 v29, v28, 7, v29
  v_add_u32 v14, s51, v29
  v_xor_b32 v15, 64, v14
  v_lshlrev_b32 v16, 4, v0
  v_add_u32 v17, 0x1000, v16
  s_lshl_b32 s44, s5, 2
  s_add_u32 s44, s44, s3
  s_lshl_b32 s44, s44, 15
  s_mul_i32 s45, s4, 0x104000
  s_add_u32 s44, s44, s45
  s_add_u32 s57, s44, 0x10000
  s_mov_b32 s61, 0x3e0293ee
  s_mov_b32 s62, 0xbfb8aa3b
  s_sub_u32 s44, 15, s5
  s_cmp_lt_u32 s3, 2
  s_cselect_b32 s63, s44, s5
  s_and_b32 s45, s3, 1
  s_mul_i32 s44, s63, 144
  s_add_u32 s44, s44, s45
  s_lshl_b32 s53, s44, 10
  s_add_u32 s53, s53, 0x5800000
  s_and_b32 s44, s4, 7
  s_mul_i32 s58, s44, 147456
  s_mul_i32 s46, s63, 0x220000
  s_add_u32 s58, s58, s46
  s_lshl_b32 s45, s45, 10
  s_add_u32 s58, s58, s45
  s_add_u32 s58, s58, 0x2100000
  s_lshr_b32 s45, s4, 4
  s_bfe_u32 s46, s4, 0x10003
  s_lshl_b32 s44, s44, 1
  s_add_u32 s44, s44, s45
  s_mul_i32 s44, s44, 576
  s_lshl_b32 s47, s46, 8
  s_add_u32 s55, s44, s47
  s_lshl_b32 s47, s46, 5
  s_add_u32 s56, s44, s47
  s_add_u32 s56, s56, 512
  s_mul_i32 s44, s45, 73728
  s_add_u32 s44, s44, s58
  s_lshl_b32 s47, s46, 15
  s_add_u32 s59, s44, s47
  s_lshl_b32 s47, s46, 3
  s_add_u32 s60, s44, s47
  s_add_u32 s60, s60, 65536
  s_lshr_b32 s45, s4, 3
  s_lshl_b32 s45, s45, 15
  s_add_u32 s58, s58, s45
  s_and_b32 s45, s4, 7
  s_lshl_b32 s45, s45, 14
  s_sub_u32 s58, s58, s45
  s_add_u32 s58, s58, 1179648
  s_cmp_lg_u32 s3, 0
  s_cselect_b32 s64, 256, 0
  s_add_u32 s64, s64, s6
  s_waitcnt vmcnt(41)
  ds_read_b128 a[0:3], v14 offset:0
  ds_read_b128 a[16:19], v15 offset:0
  ds_read_b128 a[4:7], v14 offset:2048
  ds_read_b128 a[20:23], v15 offset:2048
  ds_read_b128 a[8:11], v14 offset:4096
  ds_read_b128 a[24:27], v15 offset:4096
  ds_read_b128 a[12:15], v14 offset:6144
  ds_read_b128 a[28:31], v15 offset:6144
  s_barrier
 TR 48,1,0
 TR 50,1,8192
 TR 52,1,1024
 TR 54,1,9216
 TR 56,2,0
 TR 58,2,8192
 TR 60,2,1024
 TR 62,2,9216
 TR 40,3,0
 TR 42,3,8192
 WL 0
  v_mfma_f32_16x16x32_bf16 v[64:67], v[48:51], a[0:3], 0
  s_lshl_b32 s44, s5, 2
  s_add_u32 s44, s44, s3
  s_lshl_b32 s45, s44, 15
 Mvva 64,52,16
  s_add_u32 s45, s45, s54
  v_min_u32 v44, 7, v0
  v_and_b32 v45, 1, v44
  v_mfma_f32_16x16x32_bf16 v[68:71], v[48:51], a[4:7], 0
  s_lshl_b32 s66, s64, 20
  v_lshrrev_b32 v44, 1, v44
  v_lshlrev_b32 v45, 7, v45
 Mvva 68,52,20
  s_lshr_b32 s46, s4, 3
  s_lshl_b32 s46, s46, 5
  v_lshl_add_u32 v44, v44, 13, v45
  v_mfma_f32_16x16x32_bf16 v[72:75], v[48:51], a[8:11], 0
  s_add_u32 s46, s46, s44
  s_mul_i32 s46, s46, 9216
  s_and_b32 s47, s4, 7
 Mvva 72,52,24
  s_mul_i32 s47, s47, 1152
  s_add_u32 s46, s46, s47
  s_mov_b32 s44, s45
  v_mfma_f32_16x16x32_bf16 v[76:79], v[48:51], a[12:15], 0
 TR 48,3,1024
  v_min_u32 v45, 8, v0
 Mvva 76,52,28
  v_lshlrev_b32 v45, 7, v45
  v_lshl_add_u32 v36, v0, 2, s66
  v_mfma_f32_16x16x32_bf16 v[80:83], v[56:59], a[0:3], 0
 TR 50,3,9216
  v_mov_b32 v37, 0
 Mvva 80,60,16
  s_lshl_b32 s66, s2, 8
  s_add_u32 s66, s66, 0x4480000
  v_mfma_f32_16x16x32_bf16 v[84:87], v[56:59], a[4:7], 0
 TR 52,4,0
 Mvva 84,60,20
  buffer_store_dword v37, v36, s[20:23], s66 offen sc1
  v_mfma_f32_16x16x32_bf16 v[88:91], v[56:59], a[8:11], 0
 TR 54,4,8192
  s_getreg_b32 s65, hwreg(HW_REG_XCC_ID, 0, 3)
 Mvva 88,60,24
  s_and_b32 s66, s4, 7
  s_lshl_b32 s66, s66, 3
  s_add_u32 s66, s66, s65
  v_mfma_f32_16x16x32_bf16 v[92:95], v[56:59], a[12:15], 0
 TR 56,4,1024
  s_and_b32 s66, s66, 60
 Mvva 92,60,28
  s_add_u32 s66, s66, 160
  s_and_b32 s65, s65, 3
  s_lshl_b32 s65, s65, 3
  v_mfma_f32_16x16x32_bf16 v[96:99], v[40:43], a[0:3], 0
 TR 58,4,9216
  s_waitcnt vmcnt(38)
 WL 4
 Mvva 96,48,16
  s_barrier
  s_add_u32 m0, s51, 0
  v_mfma_f32_16x16x32_bf16 v[100:103], v[40:43], a[4:7], 0
 TR 60,1,2048
  s_add_u32 s48, s52, 384
 Mvva 100,48,20
  buffer_load_dwordx4 v10, s[8:11], s48 offen lds
  v_mfma_f32_16x16x32_bf16 v[104:107], v[40:43], a[8:11], 0
 TR 62,1,10240
  s_add_u32 s48, s52, 7552
 Mvva 104,48,24
  buffer_load_dwordx4 v11, s[8:11], s48 offen offset:1024 lds
  v_mfma_f32_16x16x32_bf16 v[108:111], v[40:43], a[12:15], 0
 TR 40,1,3072
  s_add_u32 s48, s52, 14720
 Mvva 108,48,28
  buffer_load_dwordx4 v10, s[8:11], s48 offen offset:2048 lds
 WL 5
  v_mfma_f32_16x16x32_bf16 v[112:115], v[52:55], a[0:3], 0
 TR 42,1,11264
  s_lshl_b32 s65, 1, s65
 WL 4
 Mvva 112,56,16
  s_add_u32 s48, s52, 21888
  v_lshl_add_u32 v36, v0, 8, s64
  v_mov_b32 v37, s65
  v_mfma_f32_16x16x32_bf16 v[116:119], v[52:55], a[4:7], 0
 TR 48,2,2048
 Mvva 116,56,20
  buffer_load_dwordx4 v11, s[8:11], s48 offen offset:3072 lds
  v_mfma_f32_16x16x32_bf16 v[120:123], v[52:55], a[8:11], 0
 TR 50,2,10240
  s_add_u32 m0, s51, 4096
 Mvva 120,56,24
  buffer_atomic_add v37, v36, s[36:39], s66 offen sc1
  v_mfma_f32_16x16x32_bf16 v[124:127], v[52:55], a[12:15], 0
 TR 52,2,3072
  s_add_u32 s48, s52, 33152
 Mvva 124,56,28
  buffer_load_dwordx4 v10, s[8:11], s48 offen lds
 WL 5
  v_mfma_f32_16x16x32_bf16 v[128:131], v[60:63], a[0:3], 0
 TR 54,2,11264
  s_waitcnt vmcnt(27)
 WL 4
 Mvva 128,40,16
  ds_read_b128 a[32:35], v14 offset:8192
  s_add_u32 s48, s52, 40320
  v_mfma_f32_16x16x32_bf16 v[132:135], v[60:63], a[4:7], 0
 TR 56,3,2048
  s_lshl_b32 s66, s3, 13
 Mvva 132,40,20
  ds_read_b128 a[48:51], v15 offset:8192
  s_add_u32 s66, s66, s7
  v_mfma_f32_16x16x32_bf16 v[136:139], v[60:63], a[8:11], 0
 TR 58,3,10240
 Mvva 136,40,24
  ds_read_b128 a[36:39], v14 offset:10240
  v_mfma_f32_16x16x32_bf16 v[140:143], v[60:63], a[12:15], 0
 TR 60,3,3072
 Mvva 140,40,28
  ds_read_b128 a[52:55], v15 offset:10240
 WL 9
  v_mfma_f32_16x16x32_bf16 v[144:147], v[48:51], a[0:3], 0
 TR 62,3,11264
 WL 8
 Mvva 144,52,16
  ds_read_b128 a[40:43], v14 offset:12288
  v_mfma_f32_16x16x32_bf16 v[148:151], v[48:51], a[4:7], 0
 TR 40,4,2048
 Mvva 148,52,20
  ds_read_b128 a[56:59], v15 offset:12288
  v_mfma_f32_16x16x32_bf16 v[152:155], v[48:51], a[8:11], 0
 TR 42,4,10240
 Mvva 152,52,24
  ds_read_b128 a[44:47], v14 offset:14336
  v_mfma_f32_16x16x32_bf16 v[156:159], v[48:51], a[12:15], 0
 TR 48,4,3072
 WL 6
 Mvva 156,52,28
  ds_read_b128 a[60:63], v15 offset:14336
 WL 11
  v_mfma_f32_16x16x32_bf16 v[160:163], v[56:59], a[0:3], 0
 TR 50,4,11264
  s_waitcnt vmcnt(25)
 Mvva 160,60,16
  s_barrier
  buffer_load_dwordx4 v11, s[8:11], s48 offen offset:1024 lds
  v_mfma_f32_16x16x32_bf16 v[164:167], v[56:59], a[4:7], 0
 TR 52,1,16384
  s_add_u32 s48, s52, 47488
 Mvva 164,60,20
  buffer_load_dwordx4 v10, s[8:11], s48 offen offset:2048 lds
  v_mfma_f32_16x16x32_bf16 v[168:171], v[56:59], a[8:11], 0
 TR 54,1,24576
  s_add_u32 s48, s52, 54656
 Mvva 168,60,24
  buffer_load_dwordx4 v11, s[8:11], s48 offen offset:3072 lds
  v_mfma_f32_16x16x32_bf16 v[172:175], v[56:59], a[12:15], 0
 TR 56,1,17408
 WL 7
 Mvva 172,60,28
  buffer_store_dwordx4 v[240:243], v16, s[20:23], s66 offen sc1
  v_mfma_f32_16x16x32_bf16 v[176:179], v[40:43], a[0:3], 0
 TR 58,1,25600
 WL 5
 WL 4
 Mvva 176,48,16
  s_add_u32 m0, s51, 8192
  s_add_u32 s48, s52, 512
  s_add_u32 s66, s66, 32768
  v_mfma_f32_16x16x32_bf16 v[180:183], v[40:43], a[4:7], 0
 TR 60,2,16384
 Mvva 180,48,20
  buffer_load_dwordx4 v10, s[8:11], s48 offen lds
  v_mfma_f32_16x16x32_bf16 v[184:187], v[40:43], a[8:11], 0
 TR 62,2,24576
  s_add_u32 m0, s50, 0
 Mvva 184,48,24
  buffer_store_dwordx4 v[244:247], v16, s[20:23], s66 offen sc1
  v_mfma_f32_16x16x32_bf16 v[188:191], v[40:43], a[12:15], 0
 TR 40,2,17408
  s_add_u32 s48, s54, 2097152
 Mvva 188,48,28
  buffer_load_dwordx4 v7, s[16:19], s48 offen lds
 WL 5
 Mvva 64,52,32
 TR 42,2,25600
  s_add_u32 s48, s54, 2358272
 WL 4
 Mvva 64,56,48
  buffer_load_dwordx4 v7, s[16:19], s48 offen offset:1024 lds
 Mvva 68,52,36
 TR 48,3,16384
  s_add_u32 m0, s51, 8192
 Mvva 68,56,52
  s_add_u32 s48, s52, 7680
  s_add_u32 s66, s7, 65536
 Mvva 72,52,40
 TR 50,3,24576
 WL 4
 Mvva 72,56,56
  buffer_load_dwordx4 v11, s[8:11], s48 offen offset:1024 lds
 Mvva 76,52,44
 TR 52,3,17408
  s_add_u32 s48, s52, 14848
 Mvva 76,56,60
  buffer_load_dwordx4 v10, s[8:11], s48 offen offset:2048 lds
 Mvva 80,60,32
 TR 54,3,25600
  s_add_u32 s48, s52, 22016
 WL 4
 Mvva 80,40,48
  buffer_load_dwordx4 v11, s[8:11], s48 offen offset:3072 lds
 Mvva 84,60,36
 TR 56,4,16384
  s_add_u32 m0, s51, 12288
 Mvva 84,40,52
  buffer_store_dwordx4 v[248:251], v16, s[20:23], s66 offen sc1
 Mvva 88,60,40
 TR 58,4,24576
  s_add_u32 s48, s52, 33280
 Mvva 88,40,56
  buffer_load_dwordx4 v10, s[8:11], s48 offen lds
 Mvva 92,60,44
 TR 60,4,17408
  s_add_u32 s48, s52, 40448
 Mvva 92,40,60
  buffer_load_dwordx4 v11, s[8:11], s48 offen offset:1024 lds
 WL 5
 Mvva 96,48,32
 TR 62,4,25600
  s_waitcnt vmcnt(37)
 WL 4
 Mvva 96,52,48
  s_barrier
  s_add_u32 s48, s52, 47616
  v_and_b32 v232, 31, v0
 Mvva 100,48,36
 TR 40,1,18432
  v_cmp_gt_u32 vcc, 8, v232
 Mvva 100,52,52
  buffer_load_dwordx4 v10, s[8:11], s48 offen offset:2048 lds
 Mvva 104,48,40
 TR 42,1,26624
  s_add_u32 s48, s52, 54784
 Mvva 104,52,56
  buffer_load_dwordx4 v11, s[8:11], s48 offen offset:3072 lds
 Mvva 108,48,44
 TR 48,1,19456
  s_add_u32 m0, s50, 0
 Mvva 108,52,60
  s_add_u32 s48, s54, 2095232
  v_mov_b32 v236, 0
  v_mov_b32 v237, 0
 WL 5
 Mvva 112,56,32
 TR 50,1,27648
  v_cndmask_b32 v200, 0, v200, vcc
 WL 4
 Mvva 112,60,48
  buffer_load_dwordx4 v7, s[16:19], s48 offen offset:2048 lds
 Mvva 116,56,36
 TR 52,2,18432
  s_add_u32 s48, s54, 2356352
 Mvva 116,60,52
  buffer_load_dwordx4 v7, s[16:19], s48 offen offset:3072 lds
 Mvva 120,56,40
 TR 54,2,26624
  v_cndmask_b32 v201, 0, v201, vcc
 Mvva 120,60,56
 WL 2
  v_cndmask_b32 v202, 0, v202, vcc
  v_cndmask_b32 v203, 0, v203, vcc
 Mvva 124,56,44
 TR 56,2,19456
  v_lshlrev_b32 v232, 16, v192
 Mvva 124,60,60
 WL 5
  v_and_b32 v233, 0xffff0000, v192
  v_lshlrev_b32 v234, 16, v208
 Mvva 128,40,32
 TR 58,2,27648
  s_waitcnt vmcnt(33)
 Mvva 128,48,48
  ds_read_b128 a[64:67], v14 offset:16384
  v_and_b32 v235, 0xffff0000, v208
 Mvva 132,40,36
 TR 60,3,18432
  v_fmac_f32 v236, v232, v234
 Mvva 132,48,52
  ds_read_b128 a[80:83], v15 offset:16384
  v_fmac_f32 v237, v233, v235
 Mvva 136,40,40
 TR 62,3,26624
  v_lshlrev_b32 v232, 16, v193
 Mvva 136,48,56
  ds_read_b128 a[68:71], v14 offset:18432
  v_and_b32 v233, 0xffff0000, v193
 Mvva 140,40,44
 TR 40,3,19456
  v_lshlrev_b32 v234, 16, v209
 Mvva 140,48,60
  ds_read_b128 a[84:87], v15 offset:18432
  v_and_b32 v235, 0xffff0000, v209
 WL 9
 Mvva 144,52,32
 TR 42,3,27648
  v_fmac_f32 v236, v232, v234
 WL 8
 Mvva 144,56,48
  ds_read_b128 a[72:75], v14 offset:20480
  v_fmac_f32 v237, v233, v235
 Mvva 148,52,36
 TR 48,4,18432
  v_lshlrev_b32 v232, 16, v194
 Mvva 148,56,52
  ds_read_b128 a[88:91], v15 offset:20480
  v_and_b32 v233, 0xffff0000, v194
 Mvva 152,52,40
 TR 50,4,26624
  v_lshlrev_b32 v234, 16, v210
 Mvva 152,56,56
  ds_read_b128 a[76:79], v14 offset:22528
  v_and_b32 v235, 0xffff0000, v210
 Mvva 156,52,44
 TR 52,4,19456
  v_fmac_f32 v236, v232, v234
 Mvva 156,56,60
  ds_read_b128 a[92:95], v15 offset:22528
  v_fmac_f32 v237, v233, v235
 WL 11
 Mvva 160,60,32
 TR 54,4,27648
  s_waitcnt vmcnt(31)
 WL 8
 Mvva 160,40,48
  s_barrier
  v_lshlrev_b32 v232, 16, v195
  v_and_b32 v233, 0xffff0000, v195
 Mvva 164,60,36
 TR 56,1,32768
  v_lshlrev_b32 v234, 16, v211
 Mvva 164,40,52
  v_and_b32 v235, 0xffff0000, v211
  v_fmac_f32 v236, v232, v234
 Mvva 168,60,40
 TR 58,1,40960
  v_fmac_f32 v237, v233, v235
 Mvva 168,40,56
 WL 2
  v_lshlrev_b32 v232, 16, v196
  v_and_b32 v233, 0xffff0000, v196
 Mvva 172,60,44
 TR 60,1,33792
  v_lshlrev_b32 v234, 16, v212
 Mvva 172,40,60
 WL 4
  s_add_u32 m0, s51, 16384
  s_add_u32 s48, s52, 640
 Mvva 176,48,32
 TR 62,1,41984
  v_and_b32 v235, 0xffff0000, v212
 Mvva 176,52,48
  buffer_load_dwordx4 v10, s[8:11], s48 offen lds
 Mvva 180,48,36
 TR 40,2,32768
  s_add_u32 m0, s50, 16384
 Mvva 180,52,52
  s_add_u32 s48, s54, 2621440
  v_fmac_f32 v236, v232, v234
  v_fmac_f32 v237, v233, v235
 Mvva 184,48,40
 TR 42,2,40960
  v_lshlrev_b32 v232, 16, v197
 Mvva 184,52,56
  buffer_load_dwordx4 v7, s[16:19], s48 offen lds
 Mvva 188,48,44
 TR 48,2,33792
  s_add_u32 s48, s54, 2882560
 Mvva 188,52,60
  buffer_load_dwordx4 v7, s[16:19], s48 offen offset:1024 lds
 WL 5
 Mvva 64,56,64
 TR 50,2,41984
  s_add_u32 m0, s51, 16384
 WL 4
 Mvva 64,60,80
  s_add_u32 s48, s52, 7808
  v_and_b32 v233, 0xffff0000, v197
  v_lshlrev_b32 v234, 16, v213
 Mvva 68,56,68
 TR 52,3,32768
  v_and_b32 v235, 0xffff0000, v213
 Mvva 68,60,84
  v_fmac_f32 v236, v232, v234
  v_fmac_f32 v237, v233, v235
  v_lshlrev_b32 v232, 16, v198
  v_and_b32 v233, 0xffff0000, v198
  v_lshlrev_b32 v234, 16, v214
  v_and_b32 v235, 0xffff0000, v214
  v_fmac_f32 v236, v232, v234
  v_fmac_f32 v237, v233, v235
  v_lshlrev_b32 v232, 16, v199
  v_and_b32 v233, 0xffff0000, v199
  v_lshlrev_b32 v234, 16, v215
  v_and_b32 v235, 0xffff0000, v215
  v_fmac_f32 v236, v232, v234
  v_fmac_f32 v237, v233, v235
  v_lshlrev_b32 v232, 16, v200
  v_and_b32 v233, 0xffff0000, v200
  v_lshlrev_b32 v234, 16, v216
  v_and_b32 v235, 0xffff0000, v216
  v_fmac_f32 v236, v232, v234
  v_fmac_f32 v237, v233, v235
  v_lshlrev_b32 v232, 16, v201
  v_and_b32 v233, 0xffff0000, v201
  v_lshlrev_b32 v234, 16, v217
  v_and_b32 v235, 0xffff0000, v217
  v_fmac_f32 v236, v232, v234
  v_fmac_f32 v237, v233, v235
  v_lshlrev_b32 v232, 16, v202
  v_and_b32 v233, 0xffff0000, v202
  v_lshlrev_b32 v234, 16, v218
  v_and_b32 v235, 0xffff0000, v218
  v_fmac_f32 v236, v232, v234
  v_fmac_f32 v237, v233, v235
  v_lshlrev_b32 v232, 16, v203
  v_and_b32 v233, 0xffff0000, v203
  v_lshlrev_b32 v234, 16, v219
  v_and_b32 v235, 0xffff0000, v219
  v_fmac_f32 v236, v232, v234
  v_fmac_f32 v237, v233, v235
  v_add_f32 v236, v236, v237
  s_nop 1
  v_add_f32_dpp v236, v236, v236 quad_perm:[1,0,3,2] row_mask:0xf bank_mask:0xf
  s_nop 1
  v_add_f32_dpp v236, v236, v236 quad_perm:[2,3,0,1] row_mask:0xf bank_mask:0xf
  s_nop 1
  v_add_f32_dpp v236, v236, v236 row_half_mirror row_mask:0xf bank_mask:0xf
  s_nop 1
  v_add_f32_dpp v236, v236, v236 row_mirror row_mask:0xf bank_mask:0xf
  v_mov_b32 v232, v236
  s_nop 1
  v_permlane16_swap_b32 v232, v236
  v_add_f32 v236, v236, v232
  v_mul_f32 v232, 0x3fb8aa3b, v236
  v_exp_f32 v235, v232
  v_exp_f32 v234, -v232
  v_add_f32 v235, 1.0, v235
  v_add_f32 v234, 1.0, v234
  v_min_f32 v235, 0x7149f2ca, v235
  v_rcp_f32 v234, v234
  v_lshlrev_b32 v226, 3, v226
  v_and_b32 v232, 31, v0
  v_cmp_eq_u32 vcc, 0, v232
  v_add_u32 v226, 0x4400000, v226
  s_nop 0
  v_cndmask_b32 v226, -1, v226, vcc
  buffer_store_dwordx2 v[234:235], v226, s[20:23], 0 offen sc1
 Mvva 72,56,72
 TR 54,3,40960
 WL 4
 Mvva 72,60,88
  buffer_load_dwordx4 v11, s[8:11], s48 offen offset:1024 lds
 Mvva 76,56,76
 TR 56,3,33792
  s_add_u32 s48, s52, 14976
 Mvva 76,60,92
  buffer_load_dwordx4 v10, s[8:11], s48 offen offset:2048 lds
 Mvva 80,40,64
 TR 58,3,41984
  s_add_u32 s48, s52, 22144
 WL 4
 Mvva 80,48,80
  buffer_load_dwordx4 v11, s[8:11], s48 offen offset:3072 lds
 Mvva 84,40,68
 TR 60,4,32768
  s_add_u32 m0, s51, 20480
 Mvva 84,48,84
  s_add_u32 s48, s52, 33408
 Mvva 88,40,72
 TR 62,4,40960
 WL 4
 Mvva 88,48,88
  buffer_load_dwordx4 v10, s[8:11], s48 offen lds
 Mvva 92,40,76
 TR 40,4,33792
  s_add_u32 s48, s52, 40576
 Mvva 92,48,92
  buffer_load_dwordx4 v11, s[8:11], s48 offen offset:1024 lds
 Mvva 96,52,64
 TR 42,4,41984
  s_waitcnt vmcnt(38)
 WL 4
 Mvva 96,56,80
  s_barrier
  s_add_u32 s48, s52, 47744
 Mvva 100,52,68
 TR 48,1,34816
 Mvva 100,56,84
  buffer_load_dwordx4 v10, s[8:11], s48 offen offset:2048 lds
 Mvva 104,52,72
 TR 50,1,43008
  s_add_u32 s48, s52, 54912
 Mvva 104,56,88
  buffer_load_dwordx4 v11, s[8:11], s48 offen offset:3072 lds
 Mvva 108,52,76
 TR 52,1,35840
  s_add_u32 m0, s50, 16384
 Mvva 108,56,92
  s_add_u32 s48, s54, 2619520
 WL 5
 Mvva 112,60,64
 TR 54,1,44032
 WL 4
 Mvva 112,40,80
  buffer_load_dwordx4 v7, s[16:19], s48 offen offset:2048 lds
 Mvva 116,60,68
 TR 56,2,34816
  s_add_u32 s48, s54, 2880640
 Mvva 116,40,84
  buffer_load_dwordx4 v7, s[16:19], s48 offen offset:3072 lds
 Mvva 120,60,72
 TR 58,2,43008
 Mvva 120,40,88
 Mvva 124,60,76
 TR 60,2,35840
 Mvva 124,40,92
 WL 5
 WL 3
 Mvva 128,48,64
 TR 62,2,44032
  s_waitcnt vmcnt(28)
 Mvva 128,52,80
  ds_read_b128 a[96:99], v14 offset:0
 Mvva 132,48,68
 TR 40,3,34816
 Mvva 132,52,84
  ds_read_b128 a[112:115], v15 offset:0
 Mvva 136,48,72
 TR 42,3,43008
 Mvva 136,52,88
  ds_read_b128 a[100:103], v14 offset:2048
 Mvva 140,48,76
 TR 48,3,35840
 Mvva 140,52,92
  ds_read_b128 a[116:119], v15 offset:2048
 WL 9
 Mvva 144,56,64
 TR 50,3,44032
 WL 8
 Mvva 144,60,80
  ds_read_b128 a[104:107], v14 offset:4096
 Mvva 148,56,68
 TR 52,4,34816
 Mvva 148,60,84
  ds_read_b128 a[120:123], v15 offset:4096
 Mvva 152,56,72
 TR 54,4,43008
 Mvva 152,60,88
  ds_read_b128 a[108:111], v14 offset:6144
 Mvva 156,56,76
 TR 56,4,35840
 Mvva 156,60,92
  ds_read_b128 a[124:127], v15 offset:6144
 WL 11
 Mvva 160,40,64
 TR 58,4,44032
 WL 8
 Mvva 160,48,80
  s_barrier
 Mvva 164,40,68
 TR 60,1,49152
 Mvva 164,48,84
 Mvva 168,40,72
 TR 62,1,57344
 Mvva 168,48,88
 Mvva 172,40,76
 TR 40,1,50176
 Mvva 172,48,92
 WL 4
  s_add_u32 m0, s51, 0
  s_add_u32 s48, s52, 768
 Mvva 176,52,64
 TR 42,1,58368
 WL 4
 Mvva 176,56,80
  buffer_load_dwordx4 v10, s[8:11], s48 offen lds
 Mvva 180,52,68
 TR 48,2,49152
  s_add_u32 m0, s50, 32768
 Mvva 180,56,84
  s_add_u32 s48, s54, 3145728
 Mvva 184,52,72
 TR 50,2,57344
 WL 4
 Mvva 184,56,88
  buffer_load_dwordx4 v7, s[16:19], s48 offen lds
 Mvva 188,52,76
 TR 52,2,50176
  s_add_u32 s48, s54, 3406848
 Mvva 188,56,92
  buffer_load_dwordx4 v7, s[16:19], s48 offen offset:1024 lds
 Mvva 64,60,96
 TR 54,2,58368
  s_add_u32 m0, s51, 0
 WL 4
 Mvva 64,40,112
  s_add_u32 s48, s52, 7936
 Mvva 68,60,100
 TR 56,3,49152
 Mvva 68,40,116
  buffer_load_dwordx4 v11, s[8:11], s48 offen offset:1024 lds
 Mvva 72,60,104
 TR 58,3,57344
  s_add_u32 s48, s52, 15104
 Mvva 72,40,120
  buffer_load_dwordx4 v10, s[8:11], s48 offen offset:2048 lds
 Mvva 76,60,108
 TR 60,3,50176
  s_add_u32 s48, s52, 22272
 Mvva 76,40,124
  buffer_load_dwordx4 v11, s[8:11], s48 offen offset:3072 lds
 WL 5
 Mvva 80,48,96
 TR 62,3,58368
  s_add_u32 m0, s51, 4096
 WL 4
 Mvva 80,52,112
  s_add_u32 s48, s52, 33536
 Mvva 84,48,100
 TR 40,4,49152
 Mvva 84,52,116
  buffer_load_dwordx4 v10, s[8:11], s48 offen lds
 Mvva 88,48,104
 TR 42,4,57344
  s_add_u32 s48, s52, 40704
 Mvva 88,52,120
  buffer_load_dwordx4 v11, s[8:11], s48 offen offset:1024 lds
 Mvva 92,48,108
 TR 48,4,50176
  s_add_u32 s48, s52, 47872
 Mvva 92,52,124
  buffer_load_dwordx4 v10, s[8:11], s48 offen offset:2048 lds
 WL 5
 Mvva 96,56,96
 TR 50,4,58368
 WL 4
 Mvva 96,60,112
  s_barrier
  s_add_u32 s48, s52, 55040
 Mvva 100,56,100
 TR 52,1,51200
 Mvva 100,60,116
  buffer_load_dwordx4 v11, s[8:11], s48 offen offset:3072 lds
 Mvva 104,56,104
 TR 54,1,59392
  s_add_u32 m0, s50, 32768
 Mvva 104,60,120
  s_add_u32 s48, s54, 3143808
 WL 2
 Mvva 108,56,108
 TR 56,1,52224
 WL 5
 Mvva 108,60,124
  buffer_load_dwordx4 v7, s[16:19], s48 offen offset:2048 lds
 Mvva 112,40,96
 TR 58,1,60416
  s_add_u32 s48, s54, 3404928
 Mvva 112,48,112
  buffer_load_dwordx4 v7, s[16:19], s48 offen offset:3072 lds
 Mvva 116,40,100
 TR 60,2,51200
 Mvva 116,48,116
 Mvva 120,40,104
 TR 62,2,59392
 Mvva 120,48,120
 Mvva 124,40,108
 TR 40,2,52224
 Mvva 124,48,124
 WL 5
 WL 3
 Mvva 128,52,96
 TR 42,2,60416
  s_waitcnt vmcnt(27)
 Mvva 128,56,112
  ds_read_b128 a[128:131], v14 offset:8192
 Mvva 132,52,100
 TR 48,3,51200
 Mvva 132,56,116
  ds_read_b128 a[144:147], v15 offset:8192
 Mvva 136,52,104
 TR 50,3,59392
 Mvva 136,56,120
  ds_read_b128 a[132:135], v14 offset:10240
 Mvva 140,52,108
 TR 52,3,52224
 Mvva 140,56,124
  ds_read_b128 a[148:151], v15 offset:10240
 WL 9
 Mvva 144,60,96
 TR 54,3,60416
 WL 8
 Mvva 144,40,112
  ds_read_b128 a[136:139], v14 offset:12288
 Mvva 148,60,100
 TR 56,4,51200
 Mvva 148,40,116
  ds_read_b128 a[152:155], v15 offset:12288
 Mvva 152,60,104
 TR 58,4,59392
 Mvva 152,40,120
  ds_read_b128 a[140:143], v14 offset:14336
 Mvva 156,60,108
 TR 60,4,52224
 Mvva 156,40,124
  ds_read_b128 a[156:159], v15 offset:14336
 WL 11
 Mvva 160,48,96
 TR 62,4,60416
 WL 8
 Mvva 160,52,112
  s_barrier
 Mvva 164,48,100
 TR 40,1,0
 Mvva 164,52,116
  buffer_load_dword v47, v44, s[24:27], s45 offen
 Mvva 168,48,104
 TR 42,1,8192
  s_add_u32 s45, s45, 1048576
 Mvva 168,52,120
 Mvva 172,48,108
 TR 48,1,1024
 Mvva 172,52,124
 WL 4
  s_add_u32 m0, s51, 8192
  s_add_u32 s48, s52, 896
 Mvva 176,56,96
 TR 50,1,9216
 WL 4
 Mvva 176,60,112
  buffer_load_dwordx4 v10, s[8:11], s48 offen lds
 Mvva 180,56,100
 TR 52,2,0
  s_add_u32 m0, s50, 49152
 Mvva 180,60,116
  s_add_u32 s48, s54, 3670016
 Mvva 184,56,104
 TR 54,2,8192
 WL 4
 Mvva 184,60,120
  buffer_load_dwordx4 v7, s[16:19], s48 offen lds
 Mvva 188,56,108
 TR 56,2,1024
  s_add_u32 s48, s54, 3931136
 Mvva 188,60,124
  buffer_load_dwordx4 v7, s[16:19], s48 offen offset:1024 lds
 Mvva 64,40,128
 TR 58,2,9216
  s_add_u32 m0, s51, 8192
 WL 4
 Mvva 64,48,144
  s_add_u32 s48, s52, 8064
 Mvva 68,40,132
 TR 60,3,0
 Mvva 68,48,148
  buffer_load_dwordx4 v11, s[8:11], s48 offen offset:1024 lds
 Mvva 72,40,136
 TR 62,3,8192
  s_add_u32 s48, s52, 15232
 Mvva 72,48,152
  buffer_load_dwordx4 v10, s[8:11], s48 offen offset:2048 lds
 Mvva 76,40,140
 TR 40,3,1024
  s_add_u32 s48, s52, 22400
 Mvva 76,48,156
  buffer_load_dwordx4 v11, s[8:11], s48 offen offset:3072 lds
 WL 5
 Mvva 80,52,128
 TR 42,3,9216
  s_add_u32 m0, s51, 12288
 WL 4
 Mvva 80,56,144
  buffer_load_dword v47, v44, s[24:27], s45 offen
 Mvva 84,52,132
 TR 48,4,0
  s_add_u32 s48, s52, 33664
 Mvva 84,56,148
  buffer_load_dwordx4 v10, s[8:11], s48 offen lds
 Mvva 88,52,136
 TR 50,4,8192
  s_add_u32 s48, s52, 40832
 Mvva 88,56,152
  buffer_load_dwordx4 v11, s[8:11], s48 offen offset:1024 lds
 Mvva 92,52,140
 TR 52,4,1024
  s_add_u32 s48, s52, 48000
 Mvva 92,56,156
  s_waitcnt vmcnt(31)
  s_add_u32 s45, s45, 1048576
  v_lshl_add_u32 v36, v0, 8, s64
 WL 5
 Mvva 96,60,128
 TR 54,4,9216
 WL 4
 Mvva 96,40,144
  s_barrier
  s_lshl_b32 s66, s5, 2
  v_mov_b32 v37, 1
 Mvva 100,60,132
 TR 56,1,2048
  v_lshrrev_b32 v202, 3, v0
 Mvva 100,40,148
  buffer_load_dwordx4 v10, s[8:11], s48 offen offset:2048 lds
 Mvva 104,60,136
 TR 58,1,10240
  s_add_u32 s48, s52, 55168
 Mvva 104,40,152
  buffer_load_dwordx4 v11, s[8:11], s48 offen offset:3072 lds
 Mvva 108,60,140
 TR 60,1,3072
  s_add_u32 m0, s50, 49152
 Mvva 108,40,156
  buffer_atomic_add v37, v36, s[36:39], s66 offen sc1
 WL 5
 Mvva 112,48,128
 TR 62,1,11264
  s_add_u32 s48, s54, 3668096
 WL 4
 Mvva 112,52,144
  buffer_load_dwordx4 v7, s[16:19], s48 offen offset:2048 lds
 Mvva 116,48,132
 TR 40,2,2048
  s_add_u32 s48, s54, 3929216
 Mvva 116,52,148
  buffer_load_dwordx4 v7, s[16:19], s48 offen offset:3072 lds
 Mvva 120,48,136
 TR 42,2,10240
  v_mul_u32_u24 v200, 1024, v202
 Mvva 120,52,152
  buffer_load_dword v47, v44, s[24:27], s45 offen
 Mvva 124,48,140
 TR 48,2,3072
  s_add_u32 s45, s45, 1048576
 Mvva 124,52,156
 WL 5
  v_lshl_add_u32 v200, v0, 4, v200
  v_lshlrev_b32 v201, 5, v202
 Mvva 128,56,128
 TR 50,2,11264
  s_waitcnt vmcnt(30)
  s_mul_i32 s7, s2, 36864
  v_and_b32 v202, 1, v0
  v_lshl_add_u32 v201, v202, 4, v201
  v_bfe_u32 v202, v0, 1, 2
  v_lshl_add_u32 v201, v202, 10, v201
  v_add_u32 v200, s7, v200
  v_add_u32 v201, s7, v201
  s_mul_i32 s7, s3, 9216
  v_add_u32 v200, s7, v200
  s_lshl_b32 s7, s3, 8
  s_add_u32 s7, s7, 0x6000000
  v_add_u32 v201, s7, v201
  s_brev_b32 s7, 1
  buffer_load_dwordx4 v[192:195], v200, s[12:15], 0 offen offset:1024
  v_subrev_u32 v202, 4718592, v200
  buffer_load_dwordx4 v[196:199], v202, s[40:43], 0 offen offset:1024
  v_subrev_u32 v203, 4714496, v201
 WL 4
 Mvva 128,60,144
  ds_read_b128 a[160:163], v14 offset:16384
  v_lshlrev_b32 v46, 14, v0
 Mvva 132,56,132
 TR 52,3,2048
  v_min_u32 v46, Lend1-Lpc0-16388, v46
 Mvva 132,60,148
  ds_read_b128 a[176:179], v15 offset:16384
  v_add_u32 v200, 0x7faf0000, v200
 Mvva 136,56,136
 TR 54,3,10240
  v_and_b32 v200, 0x80000000, v200
 Mvva 136,60,152
  ds_read_b128 a[164:167], v14 offset:18432
  v_or_b32 v201, v200, v201
 Mvva 140,56,140
 TR 56,3,3072
  v_and_or_b32 v203, v202, s7, v203
 Mvva 140,60,156
  ds_read_b128 a[180:183], v15 offset:18432
 WL 9
 Mvva 144,40,128
 TR 58,3,11264
 WL 8
 Mvva 144,48,144
  ds_read_b128 a[168:171], v14 offset:20480
 Mvva 148,40,132
 TR 60,4,2048
 Mvva 148,48,148
  ds_read_b128 a[184:187], v15 offset:20480
 Mvva 152,40,136
 TR 62,4,10240
 Mvva 152,48,152
  ds_read_b128 a[172:175], v14 offset:22528
 Mvva 156,40,140
 TR 40,4,3072
 Mvva 156,48,156
  ds_read_b128 a[188:191], v15 offset:22528
 WL 11
 Mvva 160,52,128
 TR 42,4,11264
 WL 8
 Mvva 160,56,144
  s_barrier
 Mvva 164,52,132
 TR 48,1,16384
  s_add_u32 m0, s50, 0
 Mvva 164,56,148
  buffer_load_dword v47, v44, s[24:27], s45 offen
 Mvva 168,52,136
 TR 50,1,24576
  s_add_u32 s48, s54, 0
 Mvva 168,56,152
  buffer_load_dwordx4 v7, s[24:27], s48 offen lds
 Mvva 172,52,140
 TR 52,1,17408
  s_add_u32 s48, s54, 261120
 Mvva 172,56,156
  buffer_load_dwordx4 v7, s[24:27], s48 offen offset:1024 lds
 WL 7
 Mvva 176,60,128
 TR 54,1,25600
  s_add_u32 s45, s45, 1048576
 WL 4
 Mvva 176,40,144
 Mvva 180,60,132
 TR 56,2,16384
 Mvva 180,40,148
 Mvva 184,60,136
 TR 58,2,24576
 Mvva 184,40,152
 Mvva 188,60,140
 TR 60,2,17408
 Mvva 188,40,156
 WL 5
 Mvva 64,48,160
 TR 62,2,25600
 WL 4
 Mvva 64,52,176
 Mvva 68,48,164
 TR 40,3,16384
 Mvva 68,52,180
 Mvva 72,48,168
 TR 42,3,24576
 Mvva 72,52,184
  buffer_load_dword v47, v45, s[28:31], s46 offen
 Mvva 76,48,172
 TR 48,3,17408
  s_add_u32 s46, s46, 1179648
 Mvva 76,52,188
 WL 5
 Mvva 80,56,160
 TR 50,3,25600
 WL 4
 Mvva 80,60,176
 Mvva 84,56,164
 TR 52,4,16384
 Mvva 84,60,180
 Mvva 88,56,168
 TR 54,4,24576
 Mvva 88,60,184
 Mvva 92,56,172
 TR 56,4,17408
 Mvva 92,60,188
 WL 5
 WL 3
 Mvva 96,40,160
 TR 58,4,25600
  s_waitcnt vmcnt(34)
 Mvva 96,48,176
  s_barrier
 Mvva 100,40,164
 TR 60,1,18432
  s_add_u32 s48, s54, 522240
 Mvva 100,48,180
  buffer_load_dwordx4 v7, s[24:27], s48 offen offset:2048 lds
 Mvva 104,40,168
 TR 62,1,26624
  s_add_u32 s48, s54, 783360
 Mvva 104,48,184
  buffer_load_dwordx4 v7, s[24:27], s48 offen offset:3072 lds
 Mvva 108,40,172
 TR 40,1,19456
 Mvva 108,48,188
 WL 5
 Mvva 112,52,160
 TR 42,1,27648
 WL 4
 Mvva 112,56,176
 Mvva 116,52,164
 TR 48,2,18432
 Mvva 116,56,180
  buffer_load_dword v47, v45, s[28:31], s46 offen
 Mvva 120,52,168
 TR 50,2,26624
  s_add_u32 s46, s46, 1179648
 Mvva 120,56,184
 Mvva 124,52,172
 TR 52,2,19456
 Mvva 124,56,188
 WL 5
 WL 3
 Mvva 128,60,160
 TR 54,2,27648
  s_waitcnt vmcnt(27)
 Mvva 128,40,176
  ds_read_b128 a[192:195], v14 offset:0
 Mvva 132,60,164
 TR 56,3,18432
 Mvva 132,40,180
  ds_read_b128 a[208:211], v15 offset:0
 Mvva 136,60,168
 TR 58,3,26624
 Mvva 136,40,184
  ds_read_b128 a[196:199], v14 offset:2048
 Mvva 140,60,172
 TR 60,3,19456
 Mvva 140,40,188
  ds_read_b128 a[212:215], v15 offset:2048
 WL 9
 Mvva 144,48,160
 TR 62,3,27648
 WL 8
 Mvva 144,52,176
  ds_read_b128 a[200:203], v14 offset:4096
 Mvva 148,48,164
 TR 40,4,18432
 Mvva 148,52,180
  ds_read_b128 a[216:219], v15 offset:4096
 Mvva 152,48,168
 TR 42,4,26624
 Mvva 152,52,184
  ds_read_b128 a[204:207], v14 offset:6144
 Mvva 156,48,172
 TR 48,4,19456
 Mvva 156,52,188
  ds_read_b128 a[220:223], v15 offset:6144
 WL 11
 Mvva 160,56,160
 TR 50,4,27648
 WL 8
 Mvva 160,60,176
  s_barrier
 Mvva 164,56,164
 TR 52,1,32768
  s_add_u32 m0, s50, 16384
 Mvva 164,60,180
  buffer_load_dword v47, v45, s[28:31], s46 offen
 Mvva 168,56,168
 TR 54,1,40960
  s_add_u32 s48, s54, 1048576
 Mvva 168,60,184
  buffer_load_dwordx4 v7, s[24:27], s48 offen lds
 Mvva 172,56,172
 TR 56,1,33792
  s_add_u32 s48, s54, 1309696
 Mvva 172,60,188
  buffer_load_dwordx4 v7, s[24:27], s48 offen offset:1024 lds
 WL 7
 Mvva 176,40,160
 TR 58,1,41984
  s_add_u32 s46, s46, 1179648
 WL 4
 Mvva 176,48,176
 Mvva 180,40,164
 TR 60,2,32768
 Mvva 180,48,180
 Mvva 184,40,168
 TR 62,2,40960
 Mvva 184,48,184
 Mvva 188,40,172
 TR 40,2,33792
 Mvva 188,48,188
 WL 5
 Mvva 64,52,192
 TR 42,2,41984
 WL 4
 Mvva 64,56,208
  global_load_dword v47, v46, s[100:101]
 Mvva 68,52,196
 TR 48,3,32768
 Mvva 68,56,212
  s_waitcnt vmcnt(12)
  buffer_store_dwordx4 v[192:195], v201, s[20:23], 0 offen sc1
 Mvva 72,52,200
 TR 50,3,40960
 Mvva 72,56,216
  s_waitcnt vmcnt(12)
  buffer_store_dwordx4 v[196:199], v203, s[20:23], 0 offen sc1
 Mvva 76,52,204
 TR 52,3,33792
 WL 5
 Mvva 76,56,220
  buffer_load_dword v47, v45, s[28:31], s46 offen
 Mvva 80,60,192
 TR 54,3,41984
  s_add_u32 s46, s46, 1179648
 WL 4
 Mvva 80,40,208
 Mvva 84,60,196
 TR 56,4,32768
 Mvva 84,40,212
 Mvva 88,60,200
 TR 58,4,40960
 Mvva 88,40,216
 Mvva 92,60,204
 TR 60,4,33792
 Mvva 92,40,220
 WL 5
 Mvva 96,48,192
 TR 62,4,41984
 WL 4
 Mvva 96,52,208
  s_barrier
 Mvva 100,48,196
 TR 40,1,34816
  s_add_u32 m0, s50, 18432
 Mvva 100,52,212
  s_add_u32 s48, s54, 128
 Mvva 104,48,200
 TR 42,1,43008
 Mvva 104,52,216
  buffer_load_dwordx4 v7, s[24:27], s48 offen lds
 Mvva 108,48,204
 TR 48,1,35840
  s_add_u32 m0, s50, 16384
 Mvva 108,52,220
  s_add_u32 s48, s54, 259200
 WL 5
 Mvva 112,56,192
 TR 50,1,44032
 WL 4
 Mvva 112,60,208
  buffer_load_dwordx4 v7, s[24:27], s48 offen offset:3072 lds
 Mvva 116,56,196
 TR 52,2,34816
 Mvva 116,60,212
  buffer_load_dword v47, v45, s[28:31], s46 offen
 Mvva 120,56,200
 TR 54,2,43008
  s_add_u32 s46, s46, 1179648
 Mvva 120,60,216
 Mvva 124,56,204
 TR 56,2,35840
 Mvva 124,60,220
 WL 5
 Mvva 128,40,192
 TR 58,2,44032
 WL 4
 Mvva 128,48,208
  ds_read_b128 a[224:227], v14 offset:8192
 Mvva 132,40,196
 TR 60,3,34816
 Mvva 132,48,212
  ds_read_b128 a[240:243], v15 offset:8192
 Mvva 136,40,200
 TR 62,3,43008
 Mvva 136,48,216
  ds_read_b128 a[228:231], v14 offset:10240
 Mvva 140,40,204
 TR 40,3,35840
 Mvva 140,48,220
  ds_read_b128 a[244:247], v15 offset:10240
 WL 9
 Mvva 144,52,192
 TR 42,3,44032
 WL 8
 Mvva 144,56,208
  ds_read_b128 a[232:235], v14 offset:12288
 Mvva 148,52,196
 TR 48,4,34816
 Mvva 148,56,212
  ds_read_b128 a[248:251], v15 offset:12288
 Mvva 152,52,200
 TR 50,4,43008
 Mvva 152,56,216
  ds_read_b128 a[236:239], v14 offset:14336
 Mvva 156,52,204
 TR 52,4,35840
 Mvva 156,56,220
  ds_read_b128 a[252:255], v15 offset:14336
 WL 11
 Mvva 160,60,192
 TR 54,4,44032
 WL 8
 Mvva 160,40,208
  s_barrier
 Mvva 164,60,196
 TR 56,1,49152
  s_add_u32 m0, s50, 32768
 Mvva 164,40,212
  buffer_load_dword v47, v44, s[32:35], s44 offen
 Mvva 168,60,200
 TR 58,1,57344
  s_add_u32 s48, s54, 1572864
 Mvva 168,40,216
  buffer_load_dwordx4 v7, s[24:27], s48 offen lds
 Mvva 172,60,204
 TR 60,1,50176
  s_add_u32 s48, s54, 1833984
 Mvva 172,40,220
  buffer_load_dwordx4 v7, s[24:27], s48 offen offset:1024 lds
 WL 7
 Mvva 176,48,192
 TR 62,1,58368
  s_add_u32 s44, s44, 1048576
 WL 4
 Mvva 176,52,208
 Mvva 180,48,196
 TR 40,2,49152
 Mvva 180,52,212
 Mvva 184,48,200
 TR 42,2,57344
 Mvva 184,52,216
 Mvva 188,48,204
 TR 48,2,50176
 Mvva 188,52,220
 WL 5
 Mvva 64,56,224
 TR 50,2,58368
 WL 4
 Mvva 64,60,240
 Mvva 68,56,228
 TR 52,3,49152
 Mvva 68,60,244
 Mvva 72,56,232
 TR 54,3,57344
 Mvva 72,60,248
 WL 2
 Mvva 76,56,236
 TR 56,3,50176
 WL 5
 Mvva 76,60,252
  buffer_load_dword v47, v44, s[32:35], s44 offen
 Mvva 80,40,224
 TR 58,3,58368
  s_add_u32 s44, s44, 1048576
 Mvva 80,48,240
 Mvva 84,40,228
 TR 60,4,49152
 Mvva 84,48,244
 Mvva 88,40,232
 TR 62,4,57344
 Mvva 88,48,248
 Mvva 92,40,236
 TR 40,4,50176
 Mvva 92,48,252
 WL 5
 Mvva 96,52,224
 TR 42,4,58368
 WL 4
 Mvva 96,56,240
  s_barrier
  s_lshl_b32 s66, s5, 2
  v_mul_f32 v64, s61, v64
 Mvva 100,52,228
 TR 48,1,51200
  s_add_u32 s48, s54, 522368
 Mvva 100,56,244
  buffer_load_dwordx4 v7, s[24:27], s48 offen offset:2048 lds
 Mvva 104,52,232
 TR 50,1,59392
  s_add_u32 s48, s54, 783488
 Mvva 104,56,248
  buffer_load_dwordx4 v7, s[24:27], s48 offen offset:3072 lds
 Mvva 108,52,236
 TR 52,1,52224
  v_mul_f32 v65, s61, v65
 Mvva 108,56,252
  buffer_load_dword v38, off, s[36:39], s66 sc1
 WL 5
 Mvva 112,60,224
 TR 54,1,60416
  v_mul_f32 v66, s61, v66
 WL 4
 Mvva 112,40,240
  v_mul_f32 v67, s61, v67
  v_mul_f32 v80, s61, v80
 Mvva 116,60,228
 TR 56,2,51200
  v_mul_f32 v81, s61, v81
 Mvva 116,40,244
  buffer_load_dword v47, v44, s[32:35], s44 offen
 Mvva 120,60,232
 TR 58,2,59392
  s_add_u32 s44, s44, 1048576
 Mvva 120,40,248
 WL 2
  v_mul_f32 v82, s61, v82
  v_mul_f32 v83, s61, v83
 Mvva 124,60,236
 TR 60,2,52224
  v_cvt_pk_bf16_f32 v64, v64, v65
 Mvva 124,40,252
 WL 5
  v_cvt_pk_bf16_f32 v65, v66, v67
  v_cvt_pk_bf16_f32 v66, v80, v81
 Mvva 128,48,224
 TR 62,2,60416
  v_cvt_pk_bf16_f32 v67, v82, v83
 Mvva 128,52,240
  v_mul_f32 v68, s61, v68
  v_mul_f32 v69, s61, v69
 Mvva 132,48,228
 TR 40,3,51200
  v_mul_f32 v70, s61, v70
 Mvva 132,52,244
  v_mul_f32 v71, s61, v71
  v_mul_f32 v84, s61, v84
 Mvva 136,48,232
 TR 42,3,59392
  v_mul_f32 v85, s61, v85
 Mvva 136,52,248
 WL 2
  v_mul_f32 v86, s61, v86
  v_mul_f32 v87, s61, v87
 Mvva 140,48,236
 TR 48,3,52224
  v_cvt_pk_bf16_f32 v68, v68, v69
 Mvva 140,52,252
 WL 5
  v_cvt_pk_bf16_f32 v69, v70, v71
  v_cvt_pk_bf16_f32 v70, v84, v85
 Mvva 144,56,224
 TR 50,3,60416
  v_cvt_pk_bf16_f32 v71, v86, v87
 Mvva 144,60,240
  v_mul_f32 v72, s61, v72
  v_mul_f32 v73, s61, v73
 Mvva 148,56,228
 TR 52,4,51200
  v_mul_f32 v74, s61, v74
 Mvva 148,60,244
  v_mul_f32 v75, s61, v75
  v_mul_f32 v88, s61, v88
 Mvva 152,56,232
 TR 54,4,59392
  v_mul_f32 v89, s61, v89
 Mvva 152,60,248
 WL 2
  v_mul_f32 v90, s61, v90
  v_mul_f32 v91, s61, v91
 Mvva 156,56,236
 TR 56,4,52224
  v_cvt_pk_bf16_f32 v72, v72, v73
 Mvva 156,60,252
 WL 5
  v_cvt_pk_bf16_f32 v73, v74, v75
  v_cvt_pk_bf16_f32 v74, v88, v89
 Mvva 160,40,224
 TR 58,4,60416
  s_waitcnt vmcnt(22)
 Mvva 160,48,240
  s_barrier
  v_cvt_pk_bf16_f32 v75, v90, v91
  v_mul_f32 v76, s61, v76
 Mvva 164,40,228
 TR 60,1,0
  s_add_u32 m0, s50, 65536
 Mvva 164,48,244
  buffer_load_dword v47, v44, s[32:35], s44 offen
 Mvva 168,40,232
 TR 62,1,8192
  s_add_u32 s48, s54, 2097152
 Mvva 168,48,248
  buffer_load_dwordx4 v7, s[24:27], s48 offen lds
 Mvva 172,40,236
 TR 40,1,1024
  s_add_u32 s48, s54, 2358272
 Mvva 172,48,252
  buffer_load_dwordx4 v7, s[24:27], s48 offen offset:1024 lds
 WL 5
 Mvva 176,52,224
 TR 42,1,9216
  s_add_u32 s44, s44, 1048576
 WL 4
 Mvva 176,56,240
  v_mul_f32 v77, s61, v77
  v_mul_f32 v78, s61, v78
 Mvva 180,52,228
 TR 48,2,0
  v_mul_f32 v79, s61, v79
 Mvva 180,56,244
  v_mul_f32 v92, s61, v92
  v_mul_f32 v93, s61, v93
 Mvva 184,52,232
 TR 50,2,8192
  v_mul_f32 v94, s61, v94
 Mvva 184,56,248
 WL 2
  v_mul_f32 v95, s61, v95
  v_cvt_pk_bf16_f32 v76, v76, v77
 Mvva 188,52,236
 TR 52,2,1024
  v_cvt_pk_bf16_f32 v77, v78, v79
 Mvva 188,56,252
 WL 5
  v_cvt_pk_bf16_f32 v78, v92, v93
  v_cvt_pk_bf16_f32 v79, v94, v95
  v_mfma_f32_16x16x32_bf16 v[192:195], a[0:3], v[60:63], 0
 TR 54,2,9216
  v_mul_f32 v96, s61, v96
 Mvav 192,16,40
  v_mul_f32 v97, s61, v97
  v_mul_f32 v98, s61, v98
  v_mfma_f32_16x16x32_bf16 v[196:199], a[4:7], v[60:63], 0
 TR 56,3,0
  v_mul_f32 v99, s61, v99
 Mvav 196,20,40
  v_mul_f32 v112, s61, v112
  v_mul_f32 v113, s61, v113
  v_mfma_f32_16x16x32_bf16 v[200:203], a[8:11], v[60:63], 0
 TR 58,3,8192
  v_mul_f32 v114, s61, v114
 Mvav 200,24,40
 WL 4
  v_mul_f32 v115, s61, v115
  v_cvt_pk_bf16_f32 v96, v96, v97
  v_mfma_f32_16x16x32_bf16 v[204:207], a[12:15], v[60:63], 0
 TR 60,3,1024
  v_cvt_pk_bf16_f32 v97, v98, v99
 Mvav 204,28,40
  buffer_load_dword v47, v44, s[32:35], s44 offen
  v_mfma_f32_16x16x32_bf16 v[224:227], a[0:3], v[48:51], 0
 TR 62,3,9216
  s_add_u32 s44, s44, 1048576
 WL 4
 Mvav 224,16,52
  v_cvt_pk_bf16_f32 v98, v112, v113
  v_cvt_pk_bf16_f32 v99, v114, v115
  v_mfma_f32_16x16x32_bf16 v[228:231], a[4:7], v[48:51], 0
 TR 40,4,0
  v_mul_f32 v100, s61, v100
 Mvav 228,20,52
  v_mul_f32 v101, s61, v101
  v_mul_f32 v102, s61, v102
  v_mfma_f32_16x16x32_bf16 v[232:235], a[8:11], v[48:51], 0
 TR 42,4,8192
  v_mul_f32 v103, s61, v103
 Mvav 232,24,52
 WL 2
  v_mul_f32 v116, s61, v116
  v_mul_f32 v117, s61, v117
  v_mfma_f32_16x16x32_bf16 v[236:239], a[12:15], v[48:51], 0
 TR 48,4,1024
  v_mul_f32 v118, s61, v118
 Mvav 236,28,52
 WL 5
  v_mul_f32 v119, s61, v119
  v_cvt_pk_bf16_f32 v100, v100, v101
  v_mfma_f32_16x16x32_bf16 v[208:211], a[0:3], v[56:59], 0
 TR 50,4,9216
  s_waitcnt vmcnt(23)
 Mvav 208,16,60
  s_barrier
  v_cvt_pk_bf16_f32 v101, v102, v103
  v_cvt_pk_bf16_f32 v102, v116, v117
  v_mfma_f32_16x16x32_bf16 v[212:215], a[4:7], v[56:59], 0
 TR 52,1,2048
  s_add_u32 s48, s54, 1046656
 Mvav 212,20,60
  buffer_load_dwordx4 v7, s[24:27], s48 offen offset:2048 lds
  v_mfma_f32_16x16x32_bf16 v[216:219], a[8:11], v[56:59], 0
 TR 54,1,10240
  s_add_u32 s48, s54, 1307776
 Mvav 216,24,60
  buffer_load_dwordx4 v7, s[24:27], s48 offen offset:3072 lds
  v_mfma_f32_16x16x32_bf16 v[220:223], a[12:15], v[56:59], 0
 TR 56,1,3072
  v_cvt_pk_bf16_f32 v103, v118, v119
 Mvav 220,28,60
 WL 5
  v_mul_f32 v104, s61, v104
  v_mul_f32 v105, s61, v105
  v_mfma_f32_16x16x32_bf16 v[240:243], a[0:3], v[40:43], 0
 TR 58,1,11264
  v_mul_f32 v106, s61, v106
 WL 4
 Mvav 240,16,48
  buffer_store_dwordx4 v[64:67], v16, s[20:23], s57 offen offset:0
  v_mfma_f32_16x16x32_bf16 v[244:247], a[4:7], v[40:43], 0
 TR 60,2,2048
  v_mul_f32 v107, s61, v107
 Mvav 244,20,48
  v_mul_f32 v120, s61, v120
  v_mul_f32 v121, s61, v121
  v_mfma_f32_16x16x32_bf16 v[248:251], a[8:11], v[40:43], 0
 TR 62,2,10240
  v_mul_f32 v122, s61, v122
 Mvav 248,24,48
 WL 2
  v_mul_f32 v123, s61, v123
  v_cvt_pk_bf16_f32 v104, v104, v105
  v_mfma_f32_16x16x32_bf16 v[252:255], a[12:15], v[40:43], 0
 TR 40,2,3072
  v_cvt_pk_bf16_f32 v105, v106, v107
 Mvav 252,28,48
 WL 5
  v_cvt_pk_bf16_f32 v106, v120, v121
  v_cvt_pk_bf16_f32 v107, v122, v123
 Mvav 192,32,52
 TR 42,2,11264
  v_mul_f32 v108, s61, v108
 Mvav 192,48,56
  v_mul_f32 v109, s61, v109
  v_mul_f32 v110, s61, v110
 Mvav 196,36,52
 TR 48,3,2048
  v_mul_f32 v111, s61, v111
 Mvav 196,52,56
  v_mul_f32 v124, s61, v124
  v_mul_f32 v125, s61, v125
 Mvav 200,40,52
 TR 50,3,10240
  v_mul_f32 v126, s61, v126
 Mvav 200,56,56
 WL 2
  v_mul_f32 v127, s61, v127
  v_cvt_pk_bf16_f32 v108, v108, v109
 Mvav 204,44,52
 TR 52,3,3072
  v_cvt_pk_bf16_f32 v109, v110, v111
 Mvav 204,60,56
 WL 5
  v_cvt_pk_bf16_f32 v110, v124, v125
  v_cvt_pk_bf16_f32 v111, v126, v127
 Mvav 224,32,60
 TR 54,3,11264
  v_mul_f32 v128, s61, v128
 Mvav 224,48,40
  v_mul_f32 v129, s61, v129
  v_mul_f32 v130, s61, v130
 Mvav 228,36,60
 TR 56,4,2048
  v_mul_f32 v131, s61, v131
 Mvav 228,52,40
  v_mul_f32 v144, s61, v144
  v_mul_f32 v145, s61, v145
 Mvav 232,40,60
 TR 58,4,10240
  v_mul_f32 v146, s61, v146
 Mvav 232,56,40
 WL 2
  v_mul_f32 v147, s61, v147
  v_cvt_pk_bf16_f32 v128, v128, v129
 Mvav 236,44,60
 TR 60,4,3072
  v_cvt_pk_bf16_f32 v129, v130, v131
 Mvav 236,60,40
 WL 5
  v_cvt_pk_bf16_f32 v130, v144, v145
  v_cvt_pk_bf16_f32 v131, v146, v147
 Mvav 208,32,48
 TR 62,4,11264
  s_waitcnt vmcnt(22)
 Mvav 208,48,52
  s_barrier
  v_mul_f32 v132, s61, v132
  v_mul_f32 v133, s61, v133
 Mvav 212,36,48
 TR 40,1,16384
  s_add_u32 m0, s50, 81920
 Mvav 212,52,52
  buffer_store_dwordx4 v[68:71], v17, s[20:23], s57 offen offset:0
 Mvav 216,40,48
 TR 42,1,24576
  s_add_u32 s48, s54, 2621440
 Mvav 216,56,52
  buffer_load_dwordx4 v7, s[24:27], s48 offen lds
 Mvav 220,44,48
 TR 48,1,17408
  s_add_u32 s48, s54, 2882560
 Mvav 220,60,52
  buffer_load_dwordx4 v7, s[24:27], s48 offen offset:1024 lds
 WL 5
 Mvav 240,32,56
 TR 50,1,25600
  v_mul_f32 v134, s61, v134
 WL 4
 Mvav 240,48,60
  v_mul_f32 v135, s61, v135
  v_mul_f32 v148, s61, v148
 Mvav 244,36,56
 TR 52,2,16384
  v_mul_f32 v149, s61, v149
 Mvav 244,52,60
  v_mul_f32 v150, s61, v150
  v_mul_f32 v151, s61, v151
 Mvav 248,40,56
 TR 54,2,24576
  v_cvt_pk_bf16_f32 v132, v132, v133
 Mvav 248,56,60
 WL 2
  v_cvt_pk_bf16_f32 v133, v134, v135
  v_cvt_pk_bf16_f32 v134, v148, v149
 Mvav 252,44,56
 TR 56,2,17408
  v_cvt_pk_bf16_f32 v135, v150, v151
 Mvav 252,60,60
 WL 5
  v_mul_f32 v136, s61, v136
  v_mul_f32 v137, s61, v137
 Mvav 192,64,40
 TR 58,2,25600
  v_mul_f32 v138, s61, v138
 Mvav 192,80,48
  v_mul_f32 v139, s61, v139
  v_mul_f32 v152, s61, v152
 Mvav 196,68,40
 TR 60,3,16384
  v_mul_f32 v153, s61, v153
 Mvav 196,84,48
  v_mul_f32 v154, s61, v154
  v_mul_f32 v155, s61, v155
 Mvav 200,72,40
 TR 62,3,24576
  v_cvt_pk_bf16_f32 v136, v136, v137
 Mvav 200,88,48
 WL 2
  v_cvt_pk_bf16_f32 v137, v138, v139
  v_cvt_pk_bf16_f32 v138, v152, v153
 Mvav 204,76,40
 TR 40,3,17408
  v_cvt_pk_bf16_f32 v139, v154, v155
 Mvav 204,92,48
 WL 5
  v_mul_f32 v140, s61, v140
  v_mul_f32 v141, s61, v141
 Mvav 224,64,52
 TR 42,3,25600
  v_mul_f32 v142, s61, v142
 Mvav 224,80,56
  v_mul_f32 v143, s61, v143
  v_mul_f32 v156, s61, v156
 Mvav 228,68,52
 TR 48,4,16384
  v_mul_f32 v157, s61, v157
 Mvav 228,84,56
  v_mul_f32 v158, s61, v158
  v_mul_f32 v159, s61, v159
 Mvav 232,72,52
 TR 50,4,24576
  s_add_u32 s49, s57, 16384
 Mvav 232,88,56
  buffer_store_dwordx4 v[72:75], v16, s[20:23], s49 offen offset:0
 Mvav 236,76,52
 TR 52,4,17408
  v_cvt_pk_bf16_f32 v140, v140, v141
 Mvav 236,92,56
 WL 5
  v_cvt_pk_bf16_f32 v141, v142, v143
  v_cvt_pk_bf16_f32 v142, v156, v157
 Mvav 208,64,60
 TR 54,4,25600
  s_waitcnt vmcnt(20)
 WL 4
 Mvav 208,80,40
  s_barrier
  v_cvt_pk_bf16_f32 v143, v158, v159
  v_mul_f32 v160, s61, v160
 Mvav 212,68,60
 TR 56,1,18432
  s_add_u32 s48, s54, 1570944
 Mvav 212,84,40
  buffer_load_dwordx4 v7, s[24:27], s48 offen offset:2048 lds
 Mvav 216,72,60
 TR 58,1,26624
  s_add_u32 s48, s54, 1832064
 Mvav 216,88,40
  buffer_load_dwordx4 v7, s[24:27], s48 offen offset:3072 lds
 Mvav 220,76,60
 TR 60,1,19456
  v_mul_f32 v161, s61, v161
 Mvav 220,92,40
 WL 5
  v_mul_f32 v162, s61, v162
  v_mul_f32 v163, s61, v163
 Mvav 240,64,48
 TR 62,1,27648
  v_mul_f32 v176, s61, v176
 WL 4
 Mvav 240,80,52
  v_mul_f32 v177, s61, v177
  v_mul_f32 v178, s61, v178
 Mvav 244,68,48
 TR 40,2,18432
  v_mul_f32 v179, s61, v179
 Mvav 244,84,52
  v_cvt_pk_bf16_f32 v160, v160, v161
  v_cvt_pk_bf16_f32 v161, v162, v163
 Mvav 248,72,48
 TR 42,2,26624
  v_cvt_pk_bf16_f32 v162, v176, v177
 Mvav 248,88,52
 WL 2
  v_cvt_pk_bf16_f32 v163, v178, v179
  v_mul_f32 v164, s61, v164
 Mvav 252,76,48
 TR 48,2,19456
  v_mul_f32 v165, s61, v165
 Mvav 252,92,52
 WL 5
  v_mul_f32 v166, s61, v166
  v_mul_f32 v167, s61, v167
  v_mfma_f32_16x16x32_bf16 v[80:83], a[0:3], v[56:59], 0
 TR 50,2,27648
  v_mul_f32 v180, s61, v180
 Mvav 80,16,60
  v_mul_f32 v181, s61, v181
  v_mul_f32 v182, s61, v182
  v_mfma_f32_16x16x32_bf16 v[84:87], a[4:7], v[56:59], 0
 TR 52,3,18432
  v_mul_f32 v183, s61, v183
 Mvav 84,20,60
  v_cvt_pk_bf16_f32 v164, v164, v165
  v_cvt_pk_bf16_f32 v165, v166, v167
  v_mfma_f32_16x16x32_bf16 v[88:91], a[8:11], v[56:59], 0
 TR 54,3,26624
  v_cvt_pk_bf16_f32 v166, v180, v181
 Mvav 88,24,60
 WL 4
  v_cvt_pk_bf16_f32 v167, v182, v183
  v_mul_f32 v168, s61, v168
  v_mfma_f32_16x16x32_bf16 v[92:95], a[12:15], v[56:59], 0
 TR 56,3,19456
  s_add_u32 s49, s57, 16384
 Mvav 92,28,60
  buffer_store_dwordx4 v[76:79], v17, s[20:23], s49 offen offset:0
  v_mfma_f32_16x16x32_bf16 v[112:115], a[0:3], v[40:43], 0
 TR 58,3,27648
  s_waitcnt vmcnt(15)
  v_readfirstlane_b32 s65, v38
 WL 4
 Mvav 112,16,48
  s_cmp_ge_u32 s65, 32
  s_cbranch_scc0 Lpoll_g
Lback_g:
  v_and_b32 v36, 15, v0
  v_mfma_f32_16x16x32_bf16 v[116:119], a[4:7], v[40:43], 0
 TR 60,4,18432
  v_lshlrev_b32 v36, 3, v36
 Mvav 116,20,48
  s_lshl_b32 s66, s63, 3
  s_and_b32 s65, s3, 1
  s_add_u32 s66, s66, s65
  v_mfma_f32_16x16x32_bf16 v[120:123], a[8:11], v[40:43], 0
 TR 62,4,26624
  s_lshl_b32 s66, s66, 7
 Mvav 120,24,48
  s_add_u32 s66, s66, 0x4400000
  v_mul_f32 v169, s61, v169
  v_mul_f32 v170, s61, v170
  v_mfma_f32_16x16x32_bf16 v[124:127], a[12:15], v[40:43], 0
 TR 40,4,19456
  v_mul_f32 v171, s61, v171
 Mvav 124,28,48
  buffer_load_dwordx2 v[20:21], v36, s[20:23], s66 offen offset:0 sc1
 WL 5
  v_mfma_f32_16x16x32_bf16 v[144:147], a[0:3], v[52:55], 0
 TR 42,4,27648
 WL 4
 Mvav 144,16,56
  s_barrier
  v_mul_f32 v184, s61, v184
  v_mul_f32 v185, s61, v185
  v_mfma_f32_16x16x32_bf16 v[148:151], a[4:7], v[52:55], 0
 TR 48,1,32768
  s_add_u32 m0, s50, 98304
 Mvav 148,20,56
  buffer_load_dwordx2 v[22:23], v36, s[20:23], s66 offen offset:256 sc1
  v_mfma_f32_16x16x32_bf16 v[152:155], a[8:11], v[52:55], 0
 TR 50,1,40960
  s_add_u32 s48, s54, 3145728
 Mvav 152,24,56
  buffer_load_dwordx4 v7, s[24:27], s48 offen lds
  v_mfma_f32_16x16x32_bf16 v[156:159], a[12:15], v[52:55], 0
 TR 52,1,33792
  s_add_u32 s48, s54, 3406848
 Mvav 156,28,56
  buffer_load_dwordx4 v7, s[24:27], s48 offen offset:1024 lds
 WL 5
  v_mfma_f32_16x16x32_bf16 v[176:179], a[0:3], v[60:63], 0
 TR 54,1,41984
  v_mul_f32 v186, s61, v186
 WL 4
 Mvav 176,16,40
  buffer_load_dwordx2 v[24:25], v36, s[20:23], s66 offen offset:512 sc1
  v_mfma_f32_16x16x32_bf16 v[180:183], a[4:7], v[60:63], 0
 TR 56,2,32768
  v_mul_f32 v187, s61, v187
  v_cvt_pk_bf16_f32 v168, v168, v169
  v_cvt_pk_bf16_f32 v169, v170, v171
  v_cvt_pk_bf16_f32 v170, v184, v185
  v_cvt_pk_bf16_f32 v171, v186, v187
 Mvav 180,20,40
  buffer_load_dwordx2 v[26:27], v36, s[20:23], s66 offen offset:768 sc1
  v_mfma_f32_16x16x32_bf16 v[184:187], a[8:11], v[60:63], 0
 TR 58,2,40960
  v_mul_f32 v172, s61, v172
  v_mul_f32 v173, s61, v173
  v_mul_f32 v174, s61, v174
  v_mul_f32 v175, s61, v175
  v_mul_f32 v188, s61, v188
  v_mul_f32 v189, s61, v189
  v_mul_f32 v190, s61, v190
  v_mul_f32 v191, s61, v191
  v_cvt_pk_bf16_f32 v172, v172, v173
  v_cvt_pk_bf16_f32 v173, v174, v175
  v_cvt_pk_bf16_f32 v174, v188, v189
  v_cvt_pk_bf16_f32 v175, v190, v191
 Mvav 184,24,40
  s_getreg_b32 s65, hwreg(HW_REG_XCC_ID, 0, 3)
  s_and_b32 s66, s4, 7
  s_lshl_b32 s66, s66, 3
  v_mfma_f32_16x16x32_bf16 v[188:191], a[12:15], v[60:63], 0
 TR 60,2,33792
  s_add_u32 s66, s66, s65
 Mvav 188,28,40
  s_and_b32 s66, s66, 60
  s_add_u32 s66, s66, 160
  s_and_b32 s65, s65, 3
 WL 5
 Mvav 192,96,48
 TR 62,2,41984
  s_add_u32 s7, s53, 16384
 WL 4
 Mvav 192,112,52
  global_load_dword v47, v46, s[100:101]
 Mvav 196,100,48
 TR 40,3,32768
  s_lshl_b32 s65, s65, 3
 Mvav 196,116,52
  buffer_load_dword v38, off, s[36:39], s66 sc1
 Mvav 200,104,48
 TR 42,3,40960
  s_lshr_b32 s10, s2, 3
 Mvav 200,120,52
  buffer_store_dwordx4 v[96:99], v16, s[20:23], s57 offen offset:1024
 Mvav 204,108,48
 TR 48,3,33792
  s_lshl_b32 s10, s10, 2
 Mvav 204,124,52
  buffer_load_dwordx4 a[0:3], v16, s[20:23], s7 offen offset:0 sc1
 WL 5
 Mvav 224,96,56
 TR 50,3,41984
  s_add_u32 s10, s10, s3
 WL 4
 Mvav 224,112,60
  s_lshl_b32 s10, s10, 3
  s_and_b32 s8, s4, 7
  s_add_u32 s10, s10, s8
 Mvav 228,100,56
 TR 52,4,32768
  s_mul_i32 s10, s10, 18432
 Mvav 228,116,60
  s_add_u32 s10, s10, 0x4500000
  s_add_u32 s8, s20, s10
  s_addc_u32 s9, s21, 0
 Mvav 232,104,56
 TR 54,4,40960
  s_movk_i32 s10, 18432
 Mvav 232,120,60
  buffer_load_dwordx4 a[4:7], v16, s[20:23], s7 offen offset:2048 sc1
 Mvav 236,108,56
 TR 56,4,33792
  v_mov_b32 v15, v16
 Mvav 236,124,60
 WL 5
 Mvav 208,96,40
 TR 58,4,41984
 WL 4
 Mvav 208,112,48
  s_barrier
 Mvav 212,100,40
 TR 60,1,34816
  s_add_u32 s48, s54, 2095232
 Mvav 212,116,48
  buffer_load_dwordx4 v7, s[24:27], s48 offen offset:2048 lds
 Mvav 216,104,40
 TR 62,1,43008
  s_add_u32 s48, s54, 2356352
 Mvav 216,120,48
  buffer_load_dwordx4 v7, s[24:27], s48 offen offset:3072 lds
 Mvav 220,108,40
 TR 40,1,35840
 WL 5
 Mvav 220,124,48
  buffer_load_dwordx4 a[8:11], v17, s[20:23], s7 offen offset:0 sc1
 Mvav 240,96,52
 TR 42,1,44032
 WL 4
 Mvav 240,112,56
  buffer_load_dwordx4 a[12:15], v17, s[20:23], s7 offen offset:2048 sc1
 Mvav 244,100,52
 TR 48,2,34816
 Mvav 244,116,56
  buffer_store_dwordx4 v[100:103], v17, s[20:23], s57 offen offset:1024
 Mvav 248,104,52
 TR 50,2,43008
 Mvav 248,120,56
 Mvav 252,108,52
 TR 52,2,35840
  s_add_u32 s7, s53, 24576
 Mvav 252,124,56
 WL 5
 Mvav 80,32,60
 TR 54,2,44032
 WL 4
 Mvav 80,48,40
 Mvav 84,36,60
 TR 56,3,34816
 Mvav 84,52,40
 Mvav 88,40,60
 TR 58,3,43008
 Mvav 88,56,40
  buffer_load_dwordx4 a[16:19], v16, s[20:23], s7 offen offset:0 sc1
 Mvav 92,44,60
 TR 60,3,35840
 Mvav 92,60,40
 WL 5
 Mvav 112,32,48
 TR 62,3,44032
 WL 4
 Mvav 112,48,52
 Mvav 116,36,48
 TR 40,4,34816
 Mvav 116,52,52
  buffer_load_dwordx4 a[20:23], v16, s[20:23], s7 offen offset:2048 sc1
 Mvav 120,40,48
 TR 42,4,43008
 Mvav 120,56,52
 Mvav 124,44,48
 TR 48,4,35840
 Mvav 124,60,52
 WL 5
 WL 3
 Mvav 144,32,56
 TR 50,4,44032
  s_waitcnt vmcnt(29)
 Mvav 144,48,60
  s_barrier
  v_xor_b32 v1, 0x10000, v1
 Mvav 148,36,56
 TR 52,1,0
  s_add_u32 m0, s50, 114688
 Mvav 148,52,60
  buffer_load_dwordx4 a[24:27], v17, s[20:23], s7 offen offset:0 sc1
 Mvav 152,40,56
 TR 54,1,8192
  s_add_u32 s48, s54, 3670016
 Mvav 152,56,60
  buffer_load_dwordx4 v7, s[24:27], s48 offen lds
 Mvav 156,44,56
 TR 56,1,1024
  s_add_u32 s48, s54, 3931136
 Mvav 156,60,60
  buffer_load_dwordx4 v7, s[24:27], s48 offen offset:1024 lds
 WL 5
 Mvav 176,32,40
 TR 58,1,9216
  s_add_u32 s49, s57, 16384
 WL 4
 Mvav 176,48,48
  v_xor_b32 v2, 0x10000, v2
 Mvav 180,36,40
 TR 60,2,0
 Mvav 180,52,48
  buffer_load_dwordx4 a[28:31], v17, s[20:23], s7 offen offset:2048 sc1
 Mvav 184,40,40
 TR 62,2,8192
 Mvav 184,56,48
  buffer_store_dwordx4 v[104:107], v16, s[20:23], s49 offen offset:1024
 Mvav 188,44,40
 TR 40,2,1024
 Mvav 188,60,48
 WL 5
 WL 3
 Mvav 192,128,52
 TR 42,2,9216
  s_add_u32 s7, s53, 32768
 Mvav 192,144,56
  v_xor_b32 v3, 0x10000, v3
 Mvav 196,132,52
 TR 48,3,0
 Mvav 196,148,56
 Mvav 200,136,52
 TR 50,3,8192
 Mvav 200,152,56
 Mvav 204,140,52
 TR 52,3,1024
 WL 5
 Mvav 204,156,56
  buffer_load_dwordx4 a[32:35], v16, s[20:23], s7 offen offset:0 sc1
 Mvav 224,128,60
 TR 54,3,9216
 WL 4
 Mvav 224,144,40
  v_xor_b32 v4, 0x10000, v4
 Mvav 228,132,60
 TR 56,4,0
 Mvav 228,148,40
 Mvav 232,136,60
 TR 58,4,8192
 WL 4
 Mvav 232,152,40
  buffer_load_dwordx4 a[36:39], v16, s[20:23], s7 offen offset:2048 sc1
 Mvav 236,140,60
 TR 60,4,1024
  s_add_u32 s49, s57, 16384
 Mvav 236,156,40
  buffer_store_dwordx4 v[108:111], v17, s[20:23], s49 offen offset:1024
 Mvav 208,128,48
 TR 62,4,9216
  s_waitcnt vmcnt(34)
 WL 4
 Mvav 208,144,52
  s_barrier
 Mvav 212,132,48
 TR 40,1,2048
  s_add_u32 s48, s54, 2619520
 Mvav 212,148,52
  buffer_load_dwordx4 v7, s[24:27], s48 offen offset:2048 lds
 Mvav 216,136,48
 TR 42,1,10240
  s_add_u32 s48, s54, 2880640
 Mvav 216,152,52
  buffer_load_dwordx4 v7, s[24:27], s48 offen offset:3072 lds
 Mvav 220,140,48
 TR 48,1,3072
 WL 5
 Mvav 220,156,52
  buffer_load_dwordx4 a[40:43], v17, s[20:23], s7 offen offset:0 sc1
 Mvav 240,128,56
 TR 50,1,11264
 WL 4
 Mvav 240,144,60
  buffer_load_dwordx4 a[44:47], v17, s[20:23], s7 offen offset:2048 sc1
 Mvav 244,132,56
 TR 52,2,2048
 Mvav 244,148,60
 Mvav 248,136,56
 TR 54,2,10240
 Mvav 248,152,60
 Mvav 252,140,56
 TR 56,2,3072
  s_add_u32 s7, s53, 40960
 Mvav 252,156,60
 WL 5
 Mvav 80,64,40
 TR 58,2,11264
 WL 4
 Mvav 80,80,48
 Mvav 84,68,40
 TR 60,3,2048
 Mvav 84,84,48
 Mvav 88,72,40
 TR 62,3,10240
 Mvav 88,88,48
  buffer_load_dwordx4 a[48:51], v16, s[20:23], s7 offen offset:0 sc1
 Mvav 92,76,40
 TR 40,3,3072
 Mvav 92,92,48
 WL 5
 Mvav 112,64,52
 TR 42,3,11264
 WL 4
 Mvav 112,80,56
  buffer_store_dwordx4 v[128:131], v16, s[20:23], s57 offen offset:2048
 Mvav 116,68,52
 TR 48,4,2048
 Mvav 116,84,56
  buffer_load_dwordx4 a[52:55], v16, s[20:23], s7 offen offset:2048 sc1
 Mvav 120,72,52
 TR 50,4,10240
 Mvav 120,88,56
 Mvav 124,76,52
 TR 52,4,3072
 Mvav 124,92,56
 WL 5
 WL 3
 Mvav 144,64,60
 TR 54,4,11264
  s_waitcnt vmcnt(37)
 Mvav 144,80,40
  s_barrier
 Mvav 148,68,60
 TR 56,1,16384
  s_add_u32 m0, s50, 49152
 Mvav 148,84,40
  buffer_load_dwordx4 a[56:59], v17, s[20:23], s7 offen offset:0 sc1
 Mvav 152,72,60
 TR 58,1,24576
  s_add_u32 s48, s54, 3145856
 Mvav 152,88,40
  buffer_load_dwordx4 v7, s[24:27], s48 offen lds
 Mvav 156,76,60
 TR 60,1,17408
  s_add_u32 s48, s54, 3406976
 Mvav 156,92,40
  buffer_load_dwordx4 v7, s[24:27], s48 offen offset:1024 lds
 WL 5
 Mvav 176,64,48
 TR 62,1,25600
 WL 4
 Mvav 176,80,52
  buffer_load_dwordx4 a[60:63], v17, s[20:23], s7 offen offset:2048 sc1
 Mvav 180,68,48
 TR 40,2,16384
 Mvav 180,84,52
 Mvav 184,72,48
 TR 42,2,24576
 Mvav 184,88,52
 Mvav 188,76,48
 TR 48,2,17408
 Mvav 188,92,52
 WL 5
 WL 3
 Mvav 192,160,56
 TR 50,2,25600
  s_add_u32 s7, s53, 49152
 Mvav 192,176,60
 Mvav 196,164,56
 TR 52,3,16384
 Mvav 196,180,60
  buffer_store_dwordx4 v[132:135], v17, s[20:23], s57 offen offset:2048
 Mvav 200,168,56
 TR 54,3,24576
 Mvav 200,184,60
 Mvav 204,172,56
 TR 56,3,17408
 WL 5
 Mvav 204,188,60
  buffer_load_dwordx4 a[64:67], v16, s[20:23], s7 offen offset:0 sc1
 Mvav 224,160,40
 TR 58,3,25600
 WL 4
 Mvav 224,176,48
 Mvav 228,164,40
 TR 60,4,16384
 Mvav 228,180,48
 Mvav 232,168,40
 TR 62,4,24576
 Mvav 232,184,48
  buffer_load_dwordx4 a[68:71], v16, s[20:23], s7 offen offset:2048 sc1
 Mvav 236,172,40
 TR 40,4,17408
 Mvav 236,188,48
 WL 5
 WL 3
 Mvav 208,160,52
 TR 42,4,25600
  s_waitcnt vmcnt(41)
 Mvav 208,176,56
  s_barrier
 Mvav 212,164,52
 TR 48,1,18432
  s_add_u32 s48, s54, 3668096
 Mvav 212,180,56
  buffer_load_dwordx4 v7, s[24:27], s48 offen offset:2048 lds
 Mvav 216,168,52
 TR 50,1,26624
  s_add_u32 s48, s54, 3929216
 Mvav 216,184,56
  buffer_load_dwordx4 v7, s[24:27], s48 offen offset:3072 lds
 Mvav 220,172,52
 TR 52,1,19456
 WL 5
 Mvav 220,188,56
  buffer_load_dwordx4 a[72:75], v17, s[20:23], s7 offen offset:0 sc1
 Mvav 240,160,60
 TR 54,1,27648
 WL 4
 Mvav 240,176,40
  buffer_load_dwordx4 a[76:79], v17, s[20:23], s7 offen offset:2048 sc1
 Mvav 244,164,60
 TR 56,2,18432
  s_waitcnt vmcnt(36)
  v_lshrrev_b32 v38, s65, v38
 Mvav 244,180,40
  v_and_b32 v38, 255, v38
 Mvav 248,168,60
 TR 58,2,26624
  v_readfirstlane_b32 s52, v38
 Mvav 248,184,40
  s_cmp_eq_u32 s52, 32
  s_cselect_b32 s52, 1, s3
  s_add_u32 s49, s57, 16384
 Mvav 252,172,60
 TR 60,2,19456
  s_add_u32 s7, s53, 57344
 Mvav 252,188,40
  buffer_store_dwordx4 v[136:139], v16, s[20:23], s49 offen offset:2048
 WL 5
 Mvav 80,96,48
 TR 62,2,27648
 WL 4
 Mvav 80,112,52
 Mvav 84,100,48
 TR 40,3,18432
 Mvav 84,116,52
 Mvav 88,104,48
 TR 42,3,26624
 Mvav 88,120,52
  buffer_load_dwordx4 a[80:83], v16, s[20:23], s7 offen offset:0 sc1
 Mvav 92,108,48
 TR 48,3,19456
 Mvav 92,124,52
 WL 5
 Mvav 112,96,56
 TR 50,3,27648
 WL 4
 Mvav 112,112,60
 Mvav 116,100,56
 TR 52,4,18432
 Mvav 116,116,60
  buffer_load_dwordx4 a[84:87], v16, s[20:23], s7 offen offset:2048 sc1
 Mvav 120,104,56
 TR 54,4,26624
 Mvav 120,120,60
 Mvav 124,108,56
 TR 56,4,19456
 Mvav 124,124,60
 WL 5
 Mvav 144,96,40
 TR 58,4,27648
 WL 4
 Mvav 144,112,48
  s_barrier
 Mvav 148,100,40
 TR 60,1,32768
  s_add_u32 m0, s50, 0
 Mvav 148,116,48
  buffer_load_dwordx4 a[88:91], v17, s[20:23], s7 offen offset:0 sc1
 Mvav 152,104,40
 TR 62,1,40960
  s_add_u32 s48, s55, 589824
 Mvav 152,120,48
  buffer_load_dwordx4 v8, s[28:31], s48 offen lds
 Mvav 156,108,40
 TR 40,1,33792
  s_add_u32 s48, s55, 883712
 Mvav 156,124,48
  buffer_load_dwordx4 v8, s[28:31], s48 offen offset:1024 lds
 WL 5
 Mvav 176,96,52
 TR 42,1,41984
  s_add_u32 s49, s57, 16384
 WL 4
 Mvav 176,112,56
  buffer_load_dwordx4 a[92:95], v17, s[20:23], s7 offen offset:2048 sc1
 Mvav 180,100,52
 TR 48,2,32768
 Mvav 180,116,56
  buffer_store_dwordx4 v[140:143], v17, s[20:23], s49 offen offset:2048
 Mvav 184,104,52
 TR 50,2,40960
 Mvav 184,120,56
 Mvav 188,108,52
 TR 52,2,33792
 Mvav 188,124,56
 WL 5
 WL 3
 Mvav 192,192,60
 TR 54,2,41984
  s_add_u32 s7, s53, 65536
 Mvav 192,208,40
 Mvav 196,196,60
 TR 56,3,32768
 Mvav 196,212,40
 Mvav 200,200,60
 TR 58,3,40960
 Mvav 200,216,40
 Mvav 204,204,60
 TR 60,3,33792
 WL 5
 Mvav 204,220,40
  buffer_load_dwordx4 a[96:99], v16, s[20:23], s7 offen offset:0 sc1
 Mvav 224,192,48
 TR 62,3,41984
 WL 4
 Mvav 224,208,52
 Mvav 228,196,48
 TR 40,4,32768
 Mvav 228,212,52
 Mvav 232,200,48
 TR 42,4,40960
 Mvav 232,216,52
  buffer_load_dwordx4 a[100:103], v16, s[20:23], s7 offen offset:2048 sc1
 Mvav 236,204,48
 TR 48,4,33792
 Mvav 236,220,52
 WL 5
 WL 3
 Mvav 208,192,56
 TR 50,4,41984
  s_waitcnt vmcnt(41)
 Mvav 208,208,60
  s_barrier
 Mvav 212,196,56
 TR 52,1,34816
  s_add_u32 s48, s55, 1177600
 Mvav 212,212,60
  buffer_load_dwordx4 v8, s[28:31], s48 offen offset:2048 lds
 Mvav 216,200,56
 TR 54,1,43008
  s_add_u32 s48, s55, 1471488
 Mvav 216,216,60
  buffer_load_dwordx4 v8, s[28:31], s48 offen offset:3072 lds
 Mvav 220,204,56
 TR 56,1,35840
 WL 5
 Mvav 220,220,60
  buffer_store_dwordx4 v[160:163], v16, s[20:23], s57 offen offset:3072
 Mvav 240,192,40
 TR 58,1,44032
 WL 4
 Mvav 240,208,48
  buffer_load_dwordx4 a[104:107], v17, s[20:23], s7 offen offset:0 sc1
 Mvav 244,196,40
 TR 60,2,34816
 Mvav 244,212,48
  buffer_load_dwordx4 a[108:111], v17, s[20:23], s7 offen offset:2048 sc1
 Mvav 248,200,40
 TR 62,2,43008
 Mvav 248,216,48
 Mvav 252,204,40
 TR 40,2,35840
  s_add_u32 s7, s53, 73728
 Mvav 252,220,48
 WL 5
 Mvav 80,128,52
 TR 42,2,44032
 WL 4
 Mvav 80,144,56
 Mvav 84,132,52
 TR 48,3,34816
 Mvav 84,148,56
 Mvav 88,136,52
 TR 50,3,43008
 Mvav 88,152,56
  buffer_load_dwordx4 a[112:115], v16, s[20:23], s7 offen offset:0 sc1
 Mvav 92,140,52
 TR 52,3,35840
 Mvav 92,156,56
 WL 5
 Mvav 112,128,60
 TR 54,3,44032
 WL 4
 Mvav 112,144,40
 Mvav 116,132,60
 TR 56,4,34816
 Mvav 116,148,40
  buffer_load_dwordx4 a[116:119], v16, s[20:23], s7 offen offset:2048 sc1
 Mvav 120,136,60
 TR 58,4,43008
 Mvav 120,152,40
  buffer_store_dwordx4 v[164:167], v17, s[20:23], s57 offen offset:3072
 Mvav 124,140,60
 TR 60,4,35840
 Mvav 124,156,40
 WL 5
 WL 3
 Mvav 144,128,48
 TR 62,4,44032
  s_waitcnt vmcnt(41)
 Mvav 144,144,52
  s_barrier
 Mvav 148,132,48
 TR 40,1,49152
  s_add_u32 m0, s50, 16384
 Mvav 148,148,52
  buffer_load_dwordx4 a[120:123], v17, s[20:23], s7 offen offset:0 sc1
 Mvav 152,136,48
 TR 42,1,57344
  s_add_u32 s48, s55, 1769472
 Mvav 152,152,52
  buffer_load_dwordx4 v8, s[28:31], s48 offen lds
 Mvav 156,140,48
 TR 48,1,50176
  s_add_u32 s48, s55, 2063360
 Mvav 156,156,52
  buffer_load_dwordx4 v8, s[28:31], s48 offen offset:1024 lds
 WL 5
 Mvav 176,128,56
 TR 50,1,58368
 WL 4
 Mvav 176,144,60
  buffer_load_dwordx4 a[124:127], v17, s[20:23], s7 offen offset:2048 sc1
 Mvav 180,132,56
 TR 52,2,49152
 Mvav 180,148,60
 Mvav 184,136,56
 TR 54,2,57344
 Mvav 184,152,60
 Mvav 188,140,56
 TR 56,2,50176
 Mvav 188,156,60
 WL 5
 WL 3
 Mvav 192,224,40
 TR 58,2,58368
  s_add_u32 s7, s53, 81920
 Mvav 192,240,48
  global_load_dword v47, v46, s[100:101]
 Mvav 196,228,40
 TR 60,3,49152
 Mvav 196,244,48
 Mvav 200,232,40
 TR 62,3,57344
  s_add_u32 s49, s57, 16384
 Mvav 200,248,48
  buffer_store_dwordx4 v[168:171], v16, s[20:23], s49 offen offset:3072
 Mvav 204,236,40
 TR 40,3,50176
 WL 5
 Mvav 204,252,48
  buffer_load_dwordx4 a[128:131], v16, s[20:23], s7 offen offset:0 sc1
 Mvav 224,224,52
 TR 42,3,58368
 WL 4
 Mvav 224,240,56
 Mvav 228,228,52
 TR 48,4,49152
 Mvav 228,244,56
  v_cvt_pk_bf16_f32 v192, v192, v193
  v_cvt_pk_bf16_f32 v193, v194, v195
 Mvav 232,232,52
 TR 50,4,57344
  v_cvt_pk_bf16_f32 v194, v196, v197
 Mvav 232,248,56
  buffer_load_dwordx4 a[132:135], v16, s[20:23], s7 offen offset:2048 sc1
 Mvav 236,236,52
 TR 52,4,50176
  v_cvt_pk_bf16_f32 v195, v198, v199
 Mvav 236,252,56
 WL 5
  v_cvt_pk_bf16_f32 v196, v200, v201
  v_cvt_pk_bf16_f32 v197, v202, v203
 Mvav 208,224,60
 TR 54,4,58368
  s_waitcnt vmcnt(42)
 WL 4
 Mvav 208,240,40
  s_barrier
  v_cvt_pk_bf16_f32 v198, v204, v205
  v_cvt_pk_bf16_f32 v199, v206, v207
 Mvav 212,228,60
 TR 56,1,51200
  s_add_u32 s48, s55, 2357248
 Mvav 212,244,40
  buffer_load_dwordx4 v8, s[28:31], s48 offen offset:2048 lds
 Mvav 216,232,60
 TR 58,1,59392
  s_add_u32 s48, s55, 2651136
 Mvav 216,248,40
  buffer_load_dwordx4 v8, s[28:31], s48 offen offset:3072 lds
 Mvav 220,236,60
 TR 60,1,52224
  v_cvt_pk_bf16_f32 v200, v224, v225
 Mvav 220,252,40
  buffer_load_dwordx4 a[136:139], v17, s[20:23], s7 offen offset:0 sc1
 WL 5
 Mvav 240,224,48
 TR 62,1,60416
  v_cvt_pk_bf16_f32 v201, v226, v227
 WL 4
 Mvav 240,240,52
  buffer_load_dwordx4 a[140:143], v17, s[20:23], s7 offen offset:2048 sc1
 Mvav 244,228,48
 TR 40,2,51200
  v_cvt_pk_bf16_f32 v202, v228, v229
 Mvav 244,244,52
  v_cvt_pk_bf16_f32 v203, v230, v231
  v_cvt_pk_bf16_f32 v204, v232, v233
 Mvav 248,232,48
 TR 42,2,59392
  v_cvt_pk_bf16_f32 v205, v234, v235
 Mvav 248,248,52
 WL 4
  v_cvt_pk_bf16_f32 v206, v236, v237
  v_cvt_pk_bf16_f32 v207, v238, v239
 Mvav 252,236,48
 TR 48,2,52224
  s_add_u32 s7, s53, 90112
 Mvav 252,252,52
  s_add_u32 s49, s57, 16384
  v_cvt_pk_bf16_f32 v208, v208, v209
  v_cvt_pk_bf16_f32 v209, v210, v211
 Mvav 80,160,56
 TR 50,2,60416
  v_cvt_pk_bf16_f32 v210, v212, v213
 WL 4
 Mvav 80,176,60
  buffer_store_dwordx4 v[172:175], v17, s[20:23], s49 offen offset:3072
 Mvav 84,164,56
 TR 52,3,51200
  v_cvt_pk_bf16_f32 v211, v214, v215
 Mvav 84,180,60
  v_cvt_pk_bf16_f32 v212, v216, v217
  v_cvt_pk_bf16_f32 v213, v218, v219
 Mvav 88,168,56
 TR 54,3,59392
  v_cvt_pk_bf16_f32 v214, v220, v221
 Mvav 88,184,60
  buffer_load_dwordx4 a[144:147], v16, s[20:23], s7 offen offset:0 sc1
 Mvav 92,172,56
 TR 56,3,52224
  v_cvt_pk_bf16_f32 v215, v222, v223
 Mvav 92,188,60
 WL 5
  v_cvt_pk_bf16_f32 v216, v240, v241
  v_cvt_pk_bf16_f32 v217, v242, v243
 Mvav 112,160,40
 TR 58,3,60416
  v_cvt_pk_bf16_f32 v218, v244, v245
 WL 4
 Mvav 112,176,48
  v_cvt_pk_bf16_f32 v219, v246, v247
  v_cvt_pk_bf16_f32 v220, v248, v249
 Mvav 116,164,40
 TR 60,4,51200
  v_cvt_pk_bf16_f32 v221, v250, v251
 Mvav 116,180,48
  buffer_load_dwordx4 a[148:151], v16, s[20:23], s7 offen offset:2048 sc1
 Mvav 120,168,40
 TR 62,4,59392
  v_cvt_pk_bf16_f32 v222, v252, v253
 Mvav 120,184,48
  v_cvt_pk_bf16_f32 v223, v254, v255
 Mvav 124,172,40
 TR 40,4,52224
 Mvav 124,188,48
 WL 5
 WL 3
 Mvav 144,160,52
 TR 42,4,60416
  s_waitcnt vmcnt(41)
 Mvav 144,176,56
  s_barrier
  v_xor_b32 v1, 0x10000, v1
 Mvav 148,164,52
 TR 48,1,49152
  s_add_u32 m0, s50, 32768
 Mvav 148,180,56
  buffer_load_dwordx4 a[152:155], v17, s[20:23], s7 offen offset:0 sc1
 Mvav 152,168,52
 TR 50,1,57344
  s_add_u32 s48, s55, 2949120
 Mvav 152,184,56
  buffer_load_dwordx4 v8, s[28:31], s48 offen lds
 Mvav 156,172,52
 TR 52,1,50176
  s_add_u32 s48, s55, 3243008
 Mvav 156,188,56
  buffer_load_dwordx4 v8, s[28:31], s48 offen offset:1024 lds
 WL 5
 Mvav 176,160,60
 TR 54,1,58368
  s_add_u32 s49, s57, 8192
 WL 4
 Mvav 176,176,40
  v_xor_b32 v2, 0x10000, v2
 Mvav 180,164,60
 TR 56,2,49152
 Mvav 180,180,40
  buffer_load_dwordx4 a[156:159], v17, s[20:23], s7 offen offset:2048 sc1
 Mvav 184,168,60
 TR 58,2,57344
 Mvav 184,184,40
  buffer_store_dwordx4 v[192:195], v16, s[20:23], s49 offen offset:0
 Mvav 188,172,60
 TR 60,2,50176
 Mvav 188,188,40
 WL 5
 WL 3
 Mvav 80,192,48
 TR 62,2,58368
  s_add_u32 s7, s53, 98304
 Mvav 80,208,52
  v_xor_b32 v3, 0x10000, v3
 Mvav 84,196,48
 TR 40,3,49152
 Mvav 84,212,52
 Mvav 88,200,48
 TR 42,3,57344
 Mvav 88,216,52
 Mvav 92,204,48
 TR 48,3,50176
 WL 5
 Mvav 92,220,52
  buffer_load_dwordx4 a[160:163], v16, s[20:23], s7 offen offset:0 sc1
 Mvav 112,192,56
 TR 50,3,58368
 WL 4
 Mvav 112,208,60
  v_xor_b32 v4, 0x10000, v4
 Mvav 116,196,56
 TR 52,4,49152
 Mvav 116,212,60
 Mvav 120,200,56
 TR 54,4,57344
 Mvav 120,216,60
  buffer_load_dwordx4 a[164:167], v16, s[20:23], s7 offen offset:2048 sc1
 Mvav 124,204,56
 TR 56,4,50176
 Mvav 124,220,60
 WL 5
 WL 3
 Mvav 144,192,40
 TR 58,4,58368
  s_waitcnt vmcnt(42)
 Mvav 144,208,48
  s_barrier
 Mvav 148,196,40
 TR 60,1,51200
  s_add_u32 s48, s55, 3536896
 Mvav 148,212,48
  buffer_load_dwordx4 v8, s[28:31], s48 offen offset:2048 lds
 Mvav 152,200,40
 TR 62,1,59392
  s_add_u32 s48, s55, 3830784
 Mvav 152,216,48
  buffer_load_dwordx4 v8, s[28:31], s48 offen offset:3072 lds
 Mvav 156,204,40
 TR 40,1,52224
  s_add_u32 s49, s57, 24576
 Mvav 156,220,48
  buffer_load_dwordx4 a[168:171], v17, s[20:23], s7 offen offset:0 sc1
 WL 5
 Mvav 176,192,52
 TR 42,1,60416
 WL 4
 Mvav 176,208,56
  buffer_load_dwordx4 a[172:175], v17, s[20:23], s7 offen offset:2048 sc1
 Mvav 180,196,52
 TR 48,2,51200
 Mvav 180,212,56
  buffer_store_dwordx4 v[196:199], v16, s[20:23], s49 offen offset:0
 Mvav 184,200,52
 TR 50,2,59392
 Mvav 184,216,56
 Mvav 188,204,52
 TR 52,2,52224
  s_add_u32 s7, s53, 106496
 Mvav 188,220,56
 WL 5
 Mvav 80,224,60
 TR 54,2,60416
 WL 4
 Mvav 80,240,40
 Mvav 84,228,60
 TR 56,3,51200
 Mvav 84,244,40
 Mvav 88,232,60
 TR 58,3,59392
 Mvav 88,248,40
  buffer_load_dwordx4 a[176:179], v16, s[20:23], s7 offen offset:0 sc1
 Mvav 92,236,60
 TR 60,3,52224
 Mvav 92,252,40
 WL 5
 Mvav 112,224,48
 TR 62,3,60416
 WL 4
 Mvav 112,240,52
 Mvav 116,228,48
 TR 40,4,51200
 Mvav 116,244,52
  buffer_load_dwordx4 a[180:183], v16, s[20:23], s7 offen offset:2048 sc1
 Mvav 120,232,48
 TR 42,4,59392
  s_add_u32 s49, s57, 8192
 Mvav 120,248,52
  buffer_store_dwordx4 v[200:203], v16, s[20:23], s49 offen offset:1024
 Mvav 124,236,48
 TR 48,4,52224
  v_cvt_pk_bf16_f32 v80, v80, v81
 Mvav 124,252,52
 WL 5
  v_cvt_pk_bf16_f32 v81, v82, v83
  v_cvt_pk_bf16_f32 v82, v84, v85
 Mvav 144,224,56
 TR 50,4,60416
  s_waitcnt vmcnt(42)
 WL 4
 Mvav 144,240,60
  s_barrier
  v_cvt_pk_bf16_f32 v83, v86, v87
  v_cvt_pk_bf16_f32 v84, v88, v89
 Mvav 148,228,56
 TR 52,1,0
  s_add_u32 m0, s50, 65536
 Mvav 148,244,60
  buffer_load_dwordx4 a[184:187], v17, s[20:23], s7 offen offset:0 sc1
 Mvav 152,232,56
 TR 54,1,8192
  s_add_u32 s48, s55, 4128768
 Mvav 152,248,60
  buffer_load_dwordx4 v8, s[28:31], s48 offen lds
 Mvav 156,236,56
 TR 56,1,1024
  s_add_u32 s48, s55, 4422656
 Mvav 156,252,60
  buffer_load_dwordx4 v8, s[28:31], s48 offen offset:1024 lds
 WL 5
 Mvav 176,224,40
 TR 58,1,9216
  v_cvt_pk_bf16_f32 v85, v90, v91
 WL 4
 Mvav 176,240,48
  buffer_load_dwordx4 a[188:191], v17, s[20:23], s7 offen offset:2048 sc1
 Mvav 180,228,40
 TR 60,2,0
  v_cvt_pk_bf16_f32 v86, v92, v93
 Mvav 180,244,48
  v_cvt_pk_bf16_f32 v87, v94, v95
  v_cvt_pk_bf16_f32 v88, v112, v113
 Mvav 184,232,40
 TR 62,2,8192
 Mvav 184,248,48
  s_add_u32 s7, s53, 114688
  v_cvt_pk_bf16_f32 v89, v114, v115
 WL 2
 Mvav 188,236,40
 TR 40,2,1024
  v_cvt_pk_bf16_f32 v90, v116, v117
 Mvav 188,252,48
 WL 5
  v_cvt_pk_bf16_f32 v91, v118, v119
  v_cvt_pk_bf16_f32 v92, v120, v121
  v_mfma_f32_16x16x32_bf16 v[64:67], v[52:55], a[0:3], 0
 TR 42,2,9216
  v_cvt_pk_bf16_f32 v93, v122, v123
 Mvva 64,56,16
  v_cvt_pk_bf16_f32 v94, v124, v125
  v_cvt_pk_bf16_f32 v95, v126, v127
  v_mfma_f32_16x16x32_bf16 v[68:71], v[52:55], a[4:7], 0
 TR 48,3,0
  v_cvt_pk_bf16_f32 v144, v144, v145
 Mvva 68,56,20
  buffer_load_dwordx4 a[192:195], v16, s[20:23], s7 offen offset:0 sc1
  v_mfma_f32_16x16x32_bf16 v[72:75], v[52:55], a[8:11], 0
 TR 50,3,8192
  v_cvt_pk_bf16_f32 v145, v146, v147
 Mvva 72,56,24
 WL 4
  v_cvt_pk_bf16_f32 v146, v148, v149
  v_cvt_pk_bf16_f32 v147, v150, v151
  v_mfma_f32_16x16x32_bf16 v[76:79], v[52:55], a[12:15], 0
 TR 52,3,1024
  s_add_u32 s49, s57, 24576
 Mvva 76,56,28
  buffer_store_dwordx4 v[204:207], v16, s[20:23], s49 offen offset:1024
  v_mfma_f32_16x16x32_bf16 v[96:99], v[60:63], a[0:3], 0
 TR 54,3,9216
  v_cvt_pk_bf16_f32 v148, v152, v153
 WL 4
 Mvva 96,40,16
  buffer_load_dwordx4 a[196:199], v16, s[20:23], s7 offen offset:2048 sc1
  v_mfma_f32_16x16x32_bf16 v[100:103], v[60:63], a[4:7], 0
 TR 56,4,0
  v_cvt_pk_bf16_f32 v149, v154, v155
 Mvva 100,40,20
  v_cvt_pk_bf16_f32 v150, v156, v157
  v_cvt_pk_bf16_f32 v151, v158, v159
  v_mfma_f32_16x16x32_bf16 v[104:107], v[60:63], a[8:11], 0
 TR 58,4,8192
  v_cvt_pk_bf16_f32 v152, v176, v177
 Mvva 104,40,24
 WL 4
  v_cvt_pk_bf16_f32 v153, v178, v179
  v_cvt_pk_bf16_f32 v154, v180, v181
  v_mfma_f32_16x16x32_bf16 v[108:111], v[60:63], a[12:15], 0
 TR 60,4,1024
  v_cvt_pk_bf16_f32 v155, v182, v183
 Mvva 108,40,28
  buffer_load_dwordx4 a[200:203], v17, s[20:23], s7 offen offset:0 sc1
  v_mfma_f32_16x16x32_bf16 v[128:131], v[48:51], a[0:3], 0
 TR 62,4,9216
  s_waitcnt vmcnt(44)
 WL 4
 Mvva 128,52,16
  s_barrier
  v_cvt_pk_bf16_f32 v156, v184, v185
  v_cvt_pk_bf16_f32 v157, v186, v187
  v_mfma_f32_16x16x32_bf16 v[132:135], v[48:51], a[4:7], 0
 TR 40,1,2048
  s_add_u32 s48, s55, 4716544
 Mvva 132,52,20
  buffer_load_dwordx4 v8, s[28:31], s48 offen offset:2048 lds
  v_mfma_f32_16x16x32_bf16 v[136:139], v[48:51], a[8:11], 0
 TR 42,1,10240
  s_add_u32 s48, s55, 5010432
 Mvva 136,52,24
  buffer_load_dwordx4 v8, s[28:31], s48 offen offset:3072 lds
  v_mfma_f32_16x16x32_bf16 v[140:143], v[48:51], a[12:15], 0
 TR 48,1,3072
  v_cvt_pk_bf16_f32 v158, v188, v189
 Mvva 140,52,28
  buffer_load_dwordx4 a[204:207], v17, s[20:23], s7 offen offset:2048 sc1
 WL 5
  v_mfma_f32_16x16x32_bf16 v[160:163], v[56:59], a[0:3], 0
 TR 50,1,11264
  v_cvt_pk_bf16_f32 v159, v190, v191
 WL 4
 Mvva 160,60,16
  v_mfma_f32_16x16x32_bf16 v[164:167], v[56:59], a[4:7], 0
 TR 52,2,2048
  s_add_u32 s7, s53, 122880
 Mvva 164,60,20
  v_mfma_f32_16x16x32_bf16 v[168:171], v[56:59], a[8:11], 0
 TR 54,2,10240
 Mvva 168,60,24
  v_mfma_f32_16x16x32_bf16 v[172:175], v[56:59], a[12:15], 0
 TR 56,2,3072
 Mvva 172,60,28
 WL 5
 WL 3
 Mvva 64,40,32
 TR 58,2,11264
  s_add_u32 s49, s57, 8192
 Mvva 64,48,48
  buffer_load_dwordx4 a[208:211], v16, s[20:23], s7 offen offset:0 sc1
 Mvva 68,40,36
 TR 60,3,2048
 Mvva 68,48,52
  buffer_store_dwordx4 v[208:211], v16, s[20:23], s49 offen offset:2048
 Mvva 72,40,40
 TR 62,3,10240
 Mvva 72,48,56
 Mvva 76,40,44
 TR 40,3,3072
 WL 5
 Mvva 76,48,60
  buffer_load_dwordx4 a[212:215], v16, s[20:23], s7 offen offset:2048 sc1
 Mvva 96,52,32
 TR 42,3,11264
 WL 4
 Mvva 96,56,48
 Mvva 100,52,36
 TR 48,4,2048
 Mvva 100,56,52
 Mvva 104,52,40
 TR 50,4,10240
 Mvva 104,56,56
  buffer_load_dwordx4 a[216:219], v17, s[20:23], s7 offen offset:0 sc1
 Mvva 108,52,44
 TR 52,4,3072
 Mvva 108,56,60
 WL 5
 WL 3
 Mvva 128,60,32
 TR 54,4,11264
  s_waitcnt vmcnt(42)
 Mvva 128,40,48
  s_barrier
 Mvva 132,60,36
 TR 56,1,16384
  s_add_u32 m0, s50, 81920
 Mvva 132,40,52
  buffer_load_dwordx4 a[220:223], v17, s[20:23], s7 offen offset:2048 sc1
 Mvva 136,60,40
 TR 58,1,24576
  s_add_u32 s48, s55, 0
 Mvva 136,40,56
  buffer_load_dwordx4 v8, s[28:31], s48 offen lds
 Mvva 140,60,44
 TR 60,1,17408
  s_add_u32 s48, s55, 293888
 Mvva 140,40,60
  buffer_load_dwordx4 v8, s[28:31], s48 offen offset:1024 lds
 WL 5
 Mvva 160,48,32
 TR 62,1,25600
  s_add_u32 s7, s53, 131072
 WL 4
 Mvva 160,52,48
 Mvva 164,48,36
 TR 40,2,16384
  s_add_u32 s49, s57, 24576
 Mvva 164,52,52
  buffer_store_dwordx4 v[212:215], v16, s[20:23], s49 offen offset:2048
 Mvva 168,48,40
 TR 42,2,24576
 Mvva 168,52,56
 Mvva 172,48,44
 TR 48,2,17408
 WL 5
 Mvva 172,52,60
  buffer_load_dwordx4 a[224:227], v16, s[20:23], s7 offen offset:0 sc1
 Mvva 64,56,64
 TR 50,2,25600
 WL 4
 Mvva 64,60,80
 Mvva 68,56,68
 TR 52,3,16384
 Mvva 68,60,84
 Mvva 72,56,72
 TR 54,3,24576
 Mvva 72,60,88
  buffer_load_dwordx4 a[228:231], v16, s[20:23], s7 offen offset:2048 sc1
 Mvva 76,56,76
 TR 56,3,17408
 Mvva 76,60,92
 WL 5
 Mvva 96,40,64
 TR 58,3,25600
 WL 4
 Mvva 96,48,80
 Mvva 100,40,68
 TR 60,4,16384
 Mvva 100,48,84
  buffer_load_dwordx4 a[232:235], v17, s[20:23], s7 offen offset:0 sc1
 Mvva 104,40,72
 TR 62,4,24576
 Mvva 104,48,88
 Mvva 108,40,76
 TR 40,4,17408
 Mvva 108,48,92
 WL 5
 WL 3
 Mvva 128,52,64
 TR 42,4,25600
  s_waitcnt vmcnt(42)
 Mvva 128,56,80
  s_barrier
 Mvva 132,52,68
 TR 48,1,18432
  s_add_u32 m0, s50, 131072
 Mvva 132,56,84
  buffer_load_dwordx4 a[236:239], v17, s[20:23], s7 offen offset:2048 sc1
 Mvva 136,52,72
 TR 50,1,26624
  s_add_u32 s48, s56, 0
 Mvva 136,56,88
  buffer_load_dwordx4 v9, s[28:31], s48 offen lds
 Mvva 140,52,76
 TR 52,1,19456
  s_add_u32 m0, s50, 83968
 Mvva 140,56,92
  s_add_u32 s48, s55, 128
  s_add_u32 s7, s53, 139264
  s_add_u32 s49, s57, 8192
 WL 5
 Mvva 160,60,64
 TR 54,1,27648
 WL 4
 Mvva 160,40,80
  buffer_load_dwordx4 v8, s[28:31], s48 offen lds
 Mvva 164,60,68
 TR 56,2,18432
  s_add_u32 m0, s50, 81920
 Mvva 164,40,84
  buffer_store_dwordx4 v[216:219], v16, s[20:23], s49 offen offset:3072
 Mvva 168,60,72
 TR 58,2,26624
 Mvva 168,40,88
  s_add_u32 s48, s55, 291968
 Mvva 172,60,76
 TR 60,2,19456
 WL 5
 Mvva 172,40,92
  buffer_load_dwordx4 v8, s[28:31], s48 offen offset:3072 lds
 Mvva 64,48,96
 TR 62,2,27648
 WL 4
 Mvva 64,52,112
  buffer_load_dwordx4 a[240:243], v16, s[20:23], s7 offen offset:0 sc1
 Mvva 68,48,100
 TR 40,3,18432
 Mvva 68,52,116
  buffer_load_dwordx4 a[244:247], v16, s[20:23], s7 offen offset:2048 sc1
 Mvva 72,48,104
 TR 42,3,26624
 Mvva 72,52,120
 Mvva 76,48,108
 TR 48,3,19456
 Mvva 76,52,124
 WL 5
 Mvva 96,56,96
 TR 50,3,27648
 WL 4
 Mvva 96,60,112
  buffer_load_dwordx4 a[248:251], v17, s[20:23], s7 offen offset:0 sc1
 Mvva 100,56,100
 TR 52,4,18432
 Mvva 100,60,116
 Mvva 104,56,104
 TR 54,4,26624
 Mvva 104,60,120
 WL 4
 WL 2
 Mvva 108,56,108
 TR 56,4,19456
  s_add_u32 s49, s57, 24576
 Mvva 108,60,124
  buffer_load_dwordx4 a[252:255], v17, s[20:23], s7 offen offset:2048 sc1
 Mvva 128,40,96
 TR 58,4,27648
  s_waitcnt vmcnt(43)
 Mvva 128,48,112
  s_barrier
 Mvva 132,40,100
 TR 60,1,32768
  s_add_u32 m0, s50, 98304
 Mvva 132,48,116
  buffer_store_dwordx4 v[220:223], v16, s[20:23], s49 offen offset:3072
 Mvva 136,40,104
 TR 62,1,40960
  s_add_u32 s48, s55, 589952
 Mvva 136,48,120
  buffer_load_dwordx4 v8, s[28:31], s48 offen lds
 Mvva 140,40,108
 TR 40,1,33792
  s_add_u32 s48, s55, 883840
 Mvva 140,48,124
  buffer_load_dwordx4 v8, s[28:31], s48 offen offset:1024 lds
 WL 5
 Mvva 160,52,96
 TR 42,1,41984
  s_add_u32 s7, s53, 0
 WL 4
 Mvva 160,56,112
 Mvva 164,52,100
 TR 48,2,32768
 Mvva 164,56,116
  buffer_load_dwordx4 v[224:227], v16, s[20:23], s7 offen offset:0 sc1
 Mvva 168,52,104
 TR 50,2,40960
 Mvva 168,56,120
  s_waitcnt vmcnt(46)
 Mvva 172,52,108
 TR 52,2,33792
 Mvva 172,56,124
 WL 5
 Mvva 64,60,128
 TR 54,2,41984
 WL 4
 Mvva 64,40,144
  buffer_load_dwordx4 v[228:231], v16, s[20:23], s7 offen offset:2048 sc1
 Mvva 68,60,132
 TR 56,3,32768
 Mvva 68,40,148
  global_load_dword v47, v46, s[100:101]
 Mvva 72,60,136
 TR 58,3,40960
 Mvva 72,40,152
 WL 2
 Mvva 76,60,140
 TR 60,3,33792
 WL 5
 Mvva 76,40,156
  buffer_load_dwordx4 v[232:235], v17, s[20:23], s7 offen offset:0 sc1
 Mvva 96,48,128
 TR 62,3,41984
  s_add_u32 s49, s57, 8192
 Mvva 96,52,144
  buffer_store_dwordx4 v[80:83], v17, s[20:23], s49 offen offset:0
 Mvva 100,48,132
 TR 40,4,32768
 Mvva 100,52,148
 Mvva 104,48,136
 TR 42,4,40960
 Mvva 104,52,152
  buffer_load_dwordx4 v[236:239], v17, s[20:23], s7 offen offset:2048 sc1
 Mvva 108,48,140
 TR 48,4,33792
 Mvva 108,52,156
 WL 5
 WL 3
 Mvva 128,56,128
 TR 50,4,41984
  s_waitcnt vmcnt(46)
 Mvva 128,60,144
  s_barrier
 Mvva 132,56,132
 TR 52,1,34816
  s_add_u32 m0, s50, 131072
 Mvva 132,60,148
  s_add_u32 s48, s56, 1178624
  s_add_u32 s7, s53, 8192
 Mvva 136,56,136
 TR 54,1,43008
 Mvva 136,60,152
  buffer_load_dwordx4 v9, s[28:31], s48 offen offset:1024 lds
 Mvva 140,56,140
 TR 56,1,35840
  s_add_u32 m0, s50, 98304
 Mvva 140,60,156
  s_add_u32 s48, s55, 1177728
 WL 5
 Mvva 160,40,128
 TR 58,1,44032
 WL 4
 Mvva 160,48,144
  buffer_load_dwordx4 v8, s[28:31], s48 offen offset:2048 lds
 Mvva 164,40,132
 TR 60,2,34816
  s_add_u32 s48, s55, 1471616
 Mvva 164,48,148
  buffer_load_dwordx4 v8, s[28:31], s48 offen offset:3072 lds
 Mvva 168,40,136
 TR 62,2,43008
  s_waitcnt vmcnt(47)
 Mvva 168,48,152
  s_waitcnt vmcnt(39)
 Mvva 172,40,140
 TR 40,2,35840
 WL 5
 Mvva 172,48,156
  buffer_load_dwordx4 v[240:243], v16, s[20:23], s7 offen offset:0 sc1
 Mvva 64,52,160
 TR 42,2,44032
 WL 4
 Mvva 64,56,176
  buffer_load_dwordx4 v[244:247], v16, s[20:23], s7 offen offset:2048 sc1
 Mvva 68,52,164
 TR 48,3,34816
  s_add_u32 s49, s57, 24576
 Mvva 68,56,180
  buffer_store_dwordx4 v[84:87], v17, s[20:23], s49 offen offset:0
 Mvva 72,52,168
 TR 50,3,43008
 Mvva 72,56,184
  buffer_load_dwordx4 v[248:251], v17, s[20:23], s7 offen offset:0 sc1
 Mvva 76,52,172
 TR 52,3,35840
 Mvva 76,56,188
 WL 5
 Mvva 96,60,160
 TR 54,3,44032
 WL 4
 Mvva 96,40,176
 Mvva 100,60,164
 TR 56,4,34816
 Mvva 100,40,180
  buffer_load_dwordx4 v[252:255], v17, s[20:23], s7 offen offset:2048 sc1
 Mvva 104,60,168
 TR 58,4,43008
 Mvva 104,40,184
 Mvva 108,60,172
 TR 60,4,35840
 Mvva 108,40,188
 WL 5
 Mvva 128,48,160
 TR 62,4,44032
 WL 4
 Mvva 128,52,176
  s_barrier
  v_xor_b32 v1, 0x10000, v1
 Mvva 132,48,164
 TR 40,1,0
  s_add_u32 m0, s50, 114688
 Mvva 132,52,180
  s_add_u32 s48, s55, 1769600
 Mvva 136,48,168
 TR 42,1,8192
 WL 4
 Mvva 136,52,184
  buffer_load_dwordx4 v8, s[28:31], s48 offen lds
 Mvva 140,48,172
 TR 48,1,1024
  s_add_u32 s48, s55, 2063488
 Mvva 140,52,188
  buffer_load_dwordx4 v8, s[28:31], s48 offen offset:1024 lds
 Mvva 160,56,160
 TR 50,1,9216
 WL 4
 Mvva 160,60,176
  v_xor_b32 v2, 0x10000, v2
 Mvva 164,56,164
 TR 52,2,0
 Mvva 164,60,180
 Mvva 168,56,168
 TR 54,2,8192
  s_waitcnt vmcnt(39)
 Mvva 168,60,184
  s_waitcnt vmcnt(34)
  s_add_u32 s49, s57, 8192
 Mvva 172,56,172
 TR 56,2,1024
 WL 5
 Mvva 172,60,188
  buffer_store_dwordx4 v[88:91], v17, s[20:23], s49 offen offset:1024
 Mvva 64,40,192
 TR 58,2,9216
 WL 4
 Mvva 64,48,208
  v_xor_b32 v3, 0x10000, v3
 Mvva 68,40,196
 TR 60,3,0
 Mvva 68,48,212
 Mvva 72,40,200
 TR 62,3,8192
 Mvva 72,48,216
 Mvva 76,40,204
 TR 40,3,1024
 Mvva 76,48,220
 WL 5
 Mvva 96,52,192
 TR 42,3,9216
 WL 4
 Mvva 96,56,208
  v_xor_b32 v4, 0x10000, v4
 Mvva 100,52,196
 TR 48,4,0
 Mvva 100,56,212
 Mvva 104,52,200
 TR 50,4,8192
 Mvva 104,56,216
 Mvva 108,52,204
 TR 52,4,1024
 Mvva 108,56,220
 WL 5
 Mvva 128,60,192
 TR 54,4,9216
 WL 4
 Mvva 128,40,208
  s_barrier
 Mvva 132,60,196
 TR 56,1,2048
  s_add_u32 m0, s50, 131072
 Mvva 132,40,212
  s_add_u32 s48, s56, 2357248
 Mvva 136,60,200
 TR 58,1,10240
 Mvva 136,40,216
  buffer_load_dwordx4 v9, s[28:31], s48 offen offset:2048 lds
 Mvva 140,60,204
 TR 60,1,3072
  s_add_u32 m0, s50, 114688
 Mvva 140,40,220
  s_add_u32 s48, s55, 2357376
  s_add_u32 s49, s57, 24576
 WL 5
 Mvva 160,48,192
 TR 62,1,11264
 WL 4
 Mvva 160,52,208
  buffer_load_dwordx4 v8, s[28:31], s48 offen offset:2048 lds
 Mvva 164,48,196
 TR 40,2,2048
  s_add_u32 s48, s55, 2651264
 Mvva 164,52,212
  buffer_load_dwordx4 v8, s[28:31], s48 offen offset:3072 lds
 Mvva 168,48,200
 TR 42,2,10240
  s_waitcnt vmcnt(31)
 Mvva 168,52,216
  s_waitcnt vmcnt(23)
  buffer_store_dwordx4 v[92:95], v17, s[20:23], s49 offen offset:1024
 Mvva 172,48,204
 TR 48,2,3072
 Mvva 172,52,220
 WL 5
 Mvva 64,56,224
 TR 50,2,11264
 WL 4
 Mvva 64,60,240
 Mvva 68,56,228
 TR 52,3,2048
 Mvva 68,60,244
 Mvva 72,56,232
 TR 54,3,10240
 Mvva 72,60,248
 Mvva 76,56,236
 TR 56,3,3072
 Mvva 76,60,252
 WL 5
 Mvva 96,40,224
 TR 58,3,11264
 WL 4
 Mvva 96,48,240
 Mvva 100,40,228
 TR 60,4,2048
 Mvva 100,48,244
 Mvva 104,40,232
 TR 62,4,10240
 Mvva 104,48,248
 Mvva 108,40,236
 TR 40,4,3072
 Mvva 108,48,252
 WL 5
 Mvva 128,52,224
 TR 42,4,11264
 WL 4
 Mvva 128,56,240
  s_barrier
  s_add_u32 s49, s57, 8192
 Mvva 132,52,228
 TR 48,1,16384
  s_add_u32 m0, s50, 49152
 Mvva 132,56,244
  buffer_store_dwordx4 v[144:147], v17, s[20:23], s49 offen offset:2048
 Mvva 136,52,232
 TR 50,1,24576
  s_add_u32 s48, s55, 2949248
 Mvva 136,56,248
  buffer_load_dwordx4 v8, s[28:31], s48 offen lds
 Mvva 140,52,236
 TR 52,1,17408
  s_add_u32 s48, s55, 3243136
 Mvva 140,56,252
  buffer_load_dwordx4 v8, s[28:31], s48 offen offset:1024 lds
 WL 5
 Mvva 160,60,224
 TR 54,1,25600
 WL 4
 Mvva 160,40,240
 Mvva 164,60,228
 TR 56,2,16384
 Mvva 164,40,244
 Mvva 168,60,232
 TR 58,2,24576
  s_waitcnt vmcnt(18)
 Mvva 168,40,248
  s_waitcnt vmcnt(10)
 Mvva 172,60,236
 TR 60,2,17408
 Mvva 172,40,252
 WL 5
 Mvvv 64,48,224
 TR 62,2,25600
 WL 4
 Mvvv 64,52,240
 Mvvv 68,48,228
 TR 40,3,16384
 Mvvv 68,52,244
 Mvvv 72,48,232
 TR 42,3,24576
 Mvvv 72,52,248
 Mvvv 76,48,236
 TR 48,3,17408
 Mvvv 76,52,252
 WL 5
 Mvvv 96,56,224
 TR 50,3,25600
 WL 4
 Mvvv 96,60,240
  v_mul_f32 v28, s62, v64
  v_mul_f32 v29, s62, v65
 Mvvv 100,56,228
 TR 52,4,16384
  s_add_u32 s49, s57, 24576
 Mvvv 100,60,244
  buffer_store_dwordx4 v[148:151], v17, s[20:23], s49 offen offset:2048
 Mvvv 104,56,232
 TR 54,4,24576
  v_mul_f32 v30, s62, v66
 Mvvv 104,60,248
  v_exp_f32 v28, v28
 Mvvv 108,56,236
 TR 56,4,17408
  v_fma_f32 v28, v28, v21, v21
 Mvvv 108,60,252
 WL 5
  v_rcp_f32 v28, v28
 Mvvv 128,40,224
 TR 58,4,25600
 WL 4
 Mvvv 128,48,240
  s_barrier
  v_exp_f32 v29, v29
 Mvvv 132,40,228
 TR 60,1,18432
  s_add_u32 m0, s50, 131072
 Mvvv 132,48,244
  s_add_u32 s48, s56, 3535872
  v_exp_f32 v30, v30
 Mvvv 136,40,232
 TR 62,1,26624
  v_mul_f32 v64, v64, v28
 Mvvv 136,48,248
  buffer_load_dwordx4 v9, s[28:31], s48 offen offset:3072 lds
 Mvvv 140,40,236
 TR 40,1,19456
  s_add_u32 m0, s50, 49152
 Mvvv 140,48,252
  s_add_u32 s48, s55, 3537024
  v_fma_f32 v29, v29, v21, v21
  v_fma_f32 v30, v30, v21, v21
 WL 5
 Mvvv 160,52,224
 TR 42,1,27648
  v_mul_f32 v31, s62, v67
 WL 4
 Mvvv 160,56,240
  buffer_load_dwordx4 v8, s[28:31], s48 offen offset:2048 lds
 Mvvv 164,52,228
 TR 48,2,18432
  s_add_u32 s48, s55, 3830912
 Mvvv 164,56,244
  buffer_load_dwordx4 v8, s[28:31], s48 offen offset:3072 lds
 Mvvv 168,52,232
 TR 50,2,26624
  v_mul_f32 v32, s62, v96
 Mvvv 168,56,248
 WL 2
  v_rcp_f32 v29, v29
 Mvvv 172,52,236
 TR 52,2,19456
  v_mul_f32 v65, v65, v29
 Mvvv 172,56,252
 WL 5
  v_rcp_f32 v30, v30
  v_mfma_f32_16x16x32_bf16 v[112:115], v[60:63], v[224:227], 0
 TR 54,2,27648
  v_mul_f32 v66, v66, v30
 Mvvv 112,40,240
  v_exp_f32 v31, v31
  v_mfma_f32_16x16x32_bf16 v[116:119], v[60:63], v[228:231], 0
 TR 56,3,18432
  v_fma_f32 v31, v31, v21, v21
 Mvvv 116,40,244
  v_rcp_f32 v31, v31
  v_mfma_f32_16x16x32_bf16 v[120:123], v[60:63], v[232:235], 0
 TR 58,3,26624
  s_add_u32 s49, s57, 8192
 Mvvv 120,40,248
  buffer_store_dwordx4 v[152:155], v17, s[20:23], s49 offen offset:3072
  v_mfma_f32_16x16x32_bf16 v[124:127], v[60:63], v[236:239], 0
 TR 60,3,19456
  v_mul_f32 v67, v67, v31
 Mvvv 124,40,252
 WL 5
  v_exp_f32 v32, v32
  v_mfma_f32_16x16x32_bf16 v[176:179], v[48:51], v[224:227], 0
 TR 62,3,27648
  v_cvt_pk_bf16_f32 v64, v64, v65
 WL 4
 Mvvv 176,52,240
  v_cvt_pk_bf16_f32 v65, v66, v67
  v_fma_f32 v32, v32, v21, v21
  v_mfma_f32_16x16x32_bf16 v[180:183], v[48:51], v[228:231], 0
 TR 40,4,18432
  v_mul_f32 v33, s62, v97
 Mvvv 180,52,244
  v_rcp_f32 v32, v32
  v_mfma_f32_16x16x32_bf16 v[184:187], v[48:51], v[232:235], 0
 TR 42,4,26624
  v_mul_f32 v96, v96, v32
 Mvvv 184,52,248
 WL 2
  v_exp_f32 v33, v33
  v_mfma_f32_16x16x32_bf16 v[188:191], v[48:51], v[236:239], 0
 TR 48,4,19456
  v_fma_f32 v33, v33, v21, v21
 Mvvv 188,52,252
 WL 5
  v_rcp_f32 v33, v33
  v_mfma_f32_16x16x32_bf16 v[192:195], v[56:59], v[224:227], 0
 TR 50,4,27648
  v_mul_f32 v97, v97, v33
 Mvvv 192,60,240
  v_mul_f32 v34, s62, v98
  v_mul_f32 v35, s62, v99
  v_mfma_f32_16x16x32_bf16 v[196:199], v[56:59], v[228:231], 0
 TR 52,5,0
  v_mul_f32 v28, s62, v68
 Mvvv 196,60,244
  v_exp_f32 v34, v34
  v_mfma_f32_16x16x32_bf16 v[200:203], v[56:59], v[232:235], 0
 TR 54,5,512
  v_fma_f32 v34, v34, v21, v21
 Mvvv 200,60,248
  v_rcp_f32 v34, v34
  v_mfma_f32_16x16x32_bf16 v[204:207], v[56:59], v[236:239], 0
 TR 56,5,4096
  v_mul_f32 v98, v98, v34
 Mvvv 204,60,252
 WL 5
  v_exp_f32 v35, v35
  v_mfma_f32_16x16x32_bf16 v[208:211], v[40:43], v[224:227], 0
 TR 58,5,4608
 WL 4
 Mvvv 208,48,240
  s_barrier
  v_exp_f32 v28, v28
  v_mfma_f32_16x16x32_bf16 v[212:215], v[40:43], v[228:231], 0
 TR 60,1,32768
  s_add_u32 m0, s50, 0
 Mvvv 212,48,244
  s_add_u32 s48, s55, 4128896
  v_fma_f32 v35, v35, v21, v21
  v_fma_f32 v28, v28, v23, v23
  v_mfma_f32_16x16x32_bf16 v[216:219], v[40:43], v[232:235], 0
 TR 62,1,40960
  v_mul_f32 v29, s62, v69
 Mvvv 216,48,248
  buffer_load_dwordx4 v8, s[28:31], s48 offen lds
  v_mfma_f32_16x16x32_bf16 v[220:223], v[40:43], v[236:239], 0
 TR 40,1,33792
  s_add_u32 s48, s55, 4422784
 Mvvv 220,48,252
  buffer_load_dwordx4 v8, s[28:31], s48 offen offset:1024 lds
 WL 5
  v_mfma_f32_16x16x32_bf16 v[80:83], v[52:55], v[224:227], 0
 TR 42,1,41984
  s_add_u32 s49, s57, 24576
 WL 4
 Mvvv 80,56,240
  buffer_store_dwordx4 v[156:159], v17, s[20:23], s49 offen offset:3072
  v_mfma_f32_16x16x32_bf16 v[84:87], v[52:55], v[228:231], 0
 TR 48,2,32768
  v_mul_f32 v30, s62, v70
 Mvvv 84,56,244
  v_rcp_f32 v35, v35
  v_mfma_f32_16x16x32_bf16 v[88:91], v[52:55], v[232:235], 0
 TR 50,2,40960
  v_mul_f32 v99, v99, v35
 Mvvv 88,56,248
 WL 2
  v_rcp_f32 v28, v28
  v_mfma_f32_16x16x32_bf16 v[92:95], v[52:55], v[236:239], 0
 TR 52,2,33792
  v_cvt_pk_bf16_f32 v66, v96, v97
 Mvvv 92,56,252
 WL 5
  v_exp_f32 v29, v29
 Mvva 112,60,0
 TR 54,2,41984
  v_cvt_pk_bf16_f32 v67, v98, v99
 Mvva 112,40,16
  buffer_store_dwordx4 v[64:67], v16, s[20:23], s59 offen offset:0 sc1
 Mvva 116,60,4
 TR 56,3,32768
  v_mul_f32 v68, v68, v28
 Mvva 116,40,20
  v_exp_f32 v30, v30
 Mvva 120,60,8
 TR 58,3,40960
  v_fma_f32 v29, v29, v23, v23
 Mvva 120,40,24
 WL 2
  v_rcp_f32 v29, v29
 Mvva 124,60,12
 TR 60,3,33792
  v_mul_f32 v69, v69, v29
 Mvva 124,40,28
 WL 5
  v_fma_f32 v30, v30, v23, v23
  v_mul_f32 v31, s62, v71
 Mvva 176,48,0
 TR 62,3,41984
  v_mul_f32 v32, s62, v100
 Mvva 176,52,16
  v_rcp_f32 v30, v30
 Mvva 180,48,4
 TR 40,4,32768
  v_mul_f32 v70, v70, v30
 Mvva 180,52,20
  v_exp_f32 v31, v31
 Mvva 184,48,8
 TR 42,4,40960
  v_fma_f32 v31, v31, v23, v23
 Mvva 184,52,24
 WL 2
  v_rcp_f32 v31, v31
 Mvva 188,48,12
 TR 48,4,33792
  v_mul_f32 v71, v71, v31
 Mvva 188,52,28
 WL 5
  v_exp_f32 v32, v32
 Mvva 192,56,0
 TR 50,4,41984
  v_cvt_pk_bf16_f32 v68, v68, v69
 Mvva 192,60,16
  v_cvt_pk_bf16_f32 v69, v70, v71
  v_fma_f32 v32, v32, v23, v23
 Mvva 196,56,4
 TR 52,5,8192
  v_mul_f32 v33, s62, v101
 Mvva 196,60,20
  v_rcp_f32 v32, v32
 Mvva 200,56,8
 TR 54,5,8704
  v_mul_f32 v100, v100, v32
 Mvva 200,60,24
  v_exp_f32 v33, v33
 Mvva 204,56,12
 TR 56,5,12288
  v_fma_f32 v33, v33, v23, v23
 Mvva 204,60,28
 WL 5
  v_rcp_f32 v33, v33
 Mvva 208,40,0
 TR 58,5,12800
 WL 4
 Mvva 208,48,16
  s_barrier
  v_mul_f32 v101, v101, v33
  v_mul_f32 v34, s62, v102
 Mvva 212,40,4
 TR 60,1,34816
  s_add_u32 m0, s50, 147456
 Mvva 212,48,20
  s_add_u32 s48, s56, 4718592
  v_exp_f32 v34, v34
 Mvva 216,40,8
 TR 62,1,43008
  v_fma_f32 v34, v34, v23, v23
 Mvva 216,48,24
  buffer_load_dwordx4 v9, s[28:31], s48 offen lds
 Mvva 220,40,12
 TR 40,1,35840
  s_add_u32 m0, s50, 0
 Mvva 220,48,28
  s_add_u32 s48, s55, 4716672
  v_rcp_f32 v34, v34
 WL 5
 Mvva 80,52,0
 TR 42,1,44032
  v_mul_f32 v102, v102, v34
 WL 4
 Mvva 80,56,16
  buffer_load_dwordx4 v8, s[28:31], s48 offen offset:2048 lds
 Mvva 84,52,4
 TR 48,2,34816
  s_add_u32 s48, s55, 5010560
 Mvva 84,56,20
  buffer_load_dwordx4 v8, s[28:31], s48 offen offset:3072 lds
 Mvva 88,52,8
 TR 50,2,43008
  v_mul_f32 v35, s62, v103
 Mvva 88,56,24
 WL 2
  v_exp_f32 v35, v35
 Mvva 92,52,12
 TR 52,2,35840
  v_fma_f32 v35, v35, v23, v23
 Mvva 92,56,28
 WL 5
  v_rcp_f32 v35, v35
 Mvva 112,60,32
 TR 54,2,44032
  v_mul_f32 v103, v103, v35
 Mvva 112,40,48
  v_cvt_pk_bf16_f32 v70, v100, v101
  v_cvt_pk_bf16_f32 v71, v102, v103
 Mvva 116,60,36
 TR 56,3,34816
  v_mul_f32 v28, s62, v72
 Mvva 116,40,52
  buffer_store_dwordx4 v[68:71], v16, s[20:23], s59 offen offset:2048 sc1
 Mvva 120,60,40
 TR 58,3,43008
  v_mul_f32 v29, s62, v73
 Mvva 120,40,56
 WL 2
  v_exp_f32 v28, v28
 Mvva 124,60,44
 TR 60,3,35840
  v_fma_f32 v28, v28, v25, v25
 Mvva 124,40,60
 WL 5
  v_rcp_f32 v28, v28
 Mvva 176,48,32
 TR 62,3,44032
  v_mul_f32 v72, v72, v28
 Mvva 176,52,48
  v_exp_f32 v29, v29
 Mvva 180,48,36
 TR 40,4,34816
  v_fma_f32 v29, v29, v25, v25
 Mvva 180,52,52
  v_rcp_f32 v29, v29
 Mvva 184,48,40
 TR 42,4,43008
  v_mul_f32 v73, v73, v29
 Mvva 184,52,56
 WL 2
  v_mul_f32 v30, s62, v74
  v_mul_f32 v31, s62, v75
 Mvva 188,48,44
 TR 48,4,35840
  v_mul_f32 v32, s62, v104
 Mvva 188,52,60
 WL 5
  v_exp_f32 v30, v30
 Mvva 192,56,32
 TR 50,4,44032
  v_fma_f32 v30, v30, v25, v25
 Mvva 192,60,48
  v_rcp_f32 v30, v30
 Mvva 196,56,36
 TR 52,5,1024
  v_mul_f32 v74, v74, v30
 Mvva 196,60,52
  v_exp_f32 v31, v31
 Mvva 200,56,40
 TR 54,5,1536
  v_fma_f32 v31, v31, v25, v25
 Mvva 200,60,56
 WL 2
  v_rcp_f32 v31, v31
 Mvva 204,56,44
 TR 56,5,5120
  v_mul_f32 v75, v75, v31
 Mvva 204,60,60
 WL 5
  v_exp_f32 v32, v32
 Mvva 208,40,32
 TR 58,5,5632
  s_waitcnt vmcnt(21)
 Mvva 208,48,48
  s_barrier
  v_cvt_pk_bf16_f32 v72, v72, v73
  v_cvt_pk_bf16_f32 v73, v74, v75
 Mvva 212,40,36
 TR 60,1,49152
  s_add_u32 m0, s50, 16384
 Mvva 212,48,52
  s_add_u32 s48, s54, 0
  v_fma_f32 v32, v32, v25, v25
  v_mul_f32 v33, s62, v105
 Mvva 216,40,40
 TR 62,1,57344
  v_mul_f32 v34, s62, v106
 Mvva 216,48,56
  buffer_load_dwordx4 v7, s[32:35], s48 offen lds
 Mvva 220,40,44
 TR 40,1,50176
  s_add_u32 s48, s54, 261120
 Mvva 220,48,60
  buffer_load_dwordx4 v7, s[32:35], s48 offen offset:1024 lds
 WL 5
 Mvva 80,52,32
 TR 42,1,58368
  v_mul_f32 v35, s62, v107
 WL 4
 Mvva 80,56,48
  v_rcp_f32 v32, v32
 Mvva 84,52,36
 TR 48,2,49152
  v_mul_f32 v104, v104, v32
 Mvva 84,56,52
  v_exp_f32 v33, v33
 Mvva 88,52,40
 TR 50,2,57344
  v_fma_f32 v33, v33, v25, v25
 Mvva 88,56,56
 WL 2
  v_rcp_f32 v33, v33
 Mvva 92,52,44
 TR 52,2,50176
  v_mul_f32 v105, v105, v33
 Mvva 92,56,60
 WL 5
  v_exp_f32 v34, v34
 Mvva 112,60,64
 TR 54,2,58368
  v_fma_f32 v34, v34, v25, v25
 Mvva 112,40,80
  global_load_dword v47, v46, s[100:101]
 Mvva 116,60,68
 TR 56,3,49152
  v_mul_f32 v28, s62, v76
 Mvva 116,40,84
  v_rcp_f32 v34, v34
 Mvva 120,60,72
 TR 58,3,57344
  v_mul_f32 v106, v106, v34
 Mvva 120,40,88
 WL 2
  v_exp_f32 v35, v35
 Mvva 124,60,76
 TR 60,3,50176
  v_fma_f32 v35, v35, v25, v25
 Mvva 124,40,92
 WL 5
  v_rcp_f32 v35, v35
 Mvva 176,48,64
 TR 62,3,58368
  v_mul_f32 v107, v107, v35
 Mvva 176,52,80
  v_exp_f32 v28, v28
 Mvva 180,48,68
 TR 40,4,49152
  v_cvt_pk_bf16_f32 v74, v104, v105
 Mvva 180,52,84
  v_cvt_pk_bf16_f32 v75, v106, v107
  v_fma_f32 v28, v28, v27, v27
 Mvva 184,48,72
 TR 42,4,57344
  v_mul_f32 v29, s62, v77
 Mvva 184,52,88
  buffer_store_dwordx4 v[72:75], v17, s[20:23], s59 offen offset:0 sc1
 Mvva 188,48,76
 TR 48,4,50176
  v_mul_f32 v30, s62, v78
 Mvva 188,52,92
 WL 5
  v_rcp_f32 v28, v28
 Mvva 192,56,64
 TR 50,4,58368
  v_mul_f32 v76, v76, v28
 WL 4
 Mvva 192,60,80
  v_exp_f32 v29, v29
 Mvva 196,56,68
 TR 52,5,9216
  v_fma_f32 v29, v29, v27, v27
 Mvva 196,60,84
  v_rcp_f32 v29, v29
 Mvva 200,56,72
 TR 54,5,9728
  v_mul_f32 v77, v77, v29
 Mvva 200,60,88
 WL 2
  v_exp_f32 v30, v30
 Mvva 204,56,76
 TR 56,5,13312
  v_fma_f32 v30, v30, v27, v27
 Mvva 204,60,92
 WL 5
  v_rcp_f32 v30, v30
 Mvva 208,40,64
 TR 58,5,13824
  s_waitcnt vmcnt(21)
 Mvva 208,48,80
  s_barrier
  v_mul_f32 v78, v78, v30
  v_mul_f32 v31, s62, v79
 Mvva 212,40,68
 TR 60,1,51200
  s_add_u32 s48, s54, 522240
 Mvva 212,48,84
  buffer_load_dwordx4 v7, s[32:35], s48 offen offset:2048 lds
 Mvva 216,40,72
 TR 62,1,59392
  s_add_u32 s48, s54, 783360
 Mvva 216,48,88
  buffer_load_dwordx4 v7, s[32:35], s48 offen offset:3072 lds
 Mvva 220,40,76
 TR 40,1,52224
  v_mul_f32 v32, s62, v108
 Mvva 220,48,92
 WL 5
  v_exp_f32 v31, v31
 Mvva 80,52,64
 TR 42,1,60416
  v_fma_f32 v31, v31, v27, v27
 WL 4
 Mvva 80,56,80
  v_rcp_f32 v31, v31
 Mvva 84,52,68
 TR 48,2,51200
  v_mul_f32 v79, v79, v31
 Mvva 84,56,84
  v_exp_f32 v32, v32
 Mvva 88,52,72
 TR 50,2,59392
  v_cvt_pk_bf16_f32 v76, v76, v77
 Mvva 88,56,88
 WL 2
  v_cvt_pk_bf16_f32 v77, v78, v79
  v_fma_f32 v32, v32, v27, v27
 Mvva 92,52,76
 TR 52,2,52224
  v_mul_f32 v33, s62, v109
 Mvva 92,56,92
 WL 5
  v_rcp_f32 v32, v32
 Mvva 112,60,96
 TR 54,2,60416
  v_mul_f32 v108, v108, v32
 Mvva 112,40,112
  v_exp_f32 v33, v33
 Mvva 116,60,100
 TR 56,3,51200
  v_fma_f32 v33, v33, v27, v27
 Mvva 116,40,116
  v_rcp_f32 v33, v33
 Mvva 120,60,104
 TR 58,3,59392
  v_mul_f32 v109, v109, v33
 Mvva 120,40,120
 WL 2
  v_mul_f32 v34, s62, v110
  v_mul_f32 v35, s62, v111
 Mvva 124,60,108
 TR 60,3,52224
  v_mul_f32 v28, s62, v128
 Mvva 124,40,124
 WL 5
  v_exp_f32 v34, v34
 Mvva 176,48,96
 TR 62,3,60416
  v_fma_f32 v34, v34, v27, v27
 Mvva 176,52,112
  v_rcp_f32 v34, v34
 Mvva 180,48,100
 TR 40,4,51200
  v_mul_f32 v110, v110, v34
 Mvva 180,52,116
  v_exp_f32 v35, v35
 Mvva 184,48,104
 TR 42,4,59392
  v_fma_f32 v35, v35, v27, v27
 Mvva 184,52,120
 WL 2
  v_rcp_f32 v35, v35
 Mvva 188,48,108
 TR 48,4,52224
  v_mul_f32 v111, v111, v35
 Mvva 188,52,124
 WL 5
  v_exp_f32 v28, v28
 Mvva 192,56,96
 TR 50,4,60416
  v_cvt_pk_bf16_f32 v78, v108, v109
 Mvva 192,60,112
  v_cvt_pk_bf16_f32 v79, v110, v111
  v_fma_f32 v28, v28, v21, v21
 Mvva 196,56,100
 TR 52,5,2048
  v_mul_f32 v29, s62, v129
 Mvva 196,60,116
  buffer_store_dwordx4 v[76:79], v17, s[20:23], s59 offen offset:2048 sc1
 Mvva 200,56,104
 TR 54,5,2560
  v_mul_f32 v30, s62, v130
 Mvva 200,60,120
 WL 2
  v_rcp_f32 v28, v28
 Mvva 204,56,108
 TR 56,5,6144
  v_mul_f32 v128, v128, v28
 Mvva 204,60,124
 WL 5
  v_exp_f32 v29, v29
 Mvva 208,40,96
 TR 58,5,6656
  s_waitcnt vmcnt(20)
 Mvva 208,48,112
  s_barrier
  v_xor_b32 v1, 0x10000, v1
  v_fma_f32 v29, v29, v21, v21
 Mvva 212,40,100
 TR 60,1,49152
  s_add_u32 m0, s50, 32768
 Mvva 212,48,116
  s_add_u32 s48, s54, 1048576
  v_rcp_f32 v29, v29
 Mvva 216,40,104
 TR 62,1,57344
  v_mul_f32 v129, v129, v29
 Mvva 216,48,120
  buffer_load_dwordx4 v7, s[32:35], s48 offen lds
 Mvva 220,40,108
 TR 40,1,50176
  s_add_u32 s48, s54, 1309696
 Mvva 220,48,124
  buffer_load_dwordx4 v7, s[32:35], s48 offen offset:1024 lds
 WL 5
 Mvva 80,52,96
 TR 42,1,58368
  v_mul_f32 v31, s62, v131
 WL 4
 Mvva 80,56,112
  v_xor_b32 v2, 0x10000, v2
  v_mul_f32 v32, s62, v160
 Mvva 84,52,100
 TR 48,2,49152
  v_mul_f32 v33, s62, v161
 Mvva 84,56,116
  v_exp_f32 v30, v30
 Mvva 88,52,104
 TR 50,2,57344
  v_fma_f32 v30, v30, v21, v21
 Mvva 88,56,120
 WL 2
  v_rcp_f32 v30, v30
 Mvva 92,52,108
 TR 52,2,50176
  v_mul_f32 v130, v130, v30
 Mvva 92,56,124
 WL 5
  v_exp_f32 v31, v31
 Mvva 112,60,128
 TR 54,2,58368
  v_fma_f32 v31, v31, v21, v21
 Mvva 112,40,144
  v_xor_b32 v3, 0x10000, v3
  v_mul_f32 v34, s62, v162
 Mvva 116,60,132
 TR 56,3,49152
  v_mul_f32 v35, s62, v163
 Mvva 116,40,148
  v_rcp_f32 v31, v31
 Mvva 120,60,136
 TR 58,3,57344
  v_mul_f32 v131, v131, v31
 Mvva 120,40,152
 WL 2
  v_exp_f32 v32, v32
 Mvva 124,60,140
 TR 60,3,50176
  v_cvt_pk_bf16_f32 v128, v128, v129
 Mvva 124,40,156
 WL 5
  v_exp_f32 v33, v33
 Mvva 176,48,128
 TR 62,3,58368
  v_cvt_pk_bf16_f32 v129, v130, v131
 Mvva 176,52,144
  v_xor_b32 v4, 0x10000, v4
  v_fma_f32 v32, v32, v21, v21
 Mvva 180,48,132
 TR 40,4,49152
  v_fma_f32 v33, v33, v21, v21
 Mvva 180,52,148
  v_rcp_f32 v32, v32
 Mvva 184,48,136
 TR 42,4,57344
  v_mul_f32 v160, v160, v32
 Mvva 184,52,152
 WL 2
  v_rcp_f32 v33, v33
 Mvva 188,48,140
 TR 48,4,50176
  v_mul_f32 v161, v161, v33
 Mvva 188,52,156
 WL 5
  v_exp_f32 v34, v34
 Mvva 192,56,128
 TR 50,4,58368
  v_fma_f32 v34, v34, v21, v21
 Mvva 192,60,144
  v_rcp_f32 v34, v34
 Mvva 196,56,132
 TR 52,5,10240
  s_waitcnt vmcnt(14)
 Mvva 196,60,148
  s_lshl_b32 s66, s4, 2
  v_lshl_add_u32 v36, v0, 8, s64
  v_mov_b32 v37, 1
 Mvva 200,56,136
 TR 54,5,10752
  s_add_u32 s66, s66, 32
 Mvva 200,60,152
  v_exp_f32 v35, v35
 Mvva 204,56,140
 TR 56,5,14336
  v_mul_f32 v162, v162, v34
 Mvva 204,60,156
 WL 5
  v_fma_f32 v35, v35, v21, v21
  v_mul_f32 v28, s62, v132
 Mvva 208,40,128
 TR 58,5,14848
 WL 4
 Mvva 208,48,144
  s_barrier
  s_cmp_eq_u32 s52, 0
  s_cbranch_scc1 Lwb_kv
Lwbb_kv:
 Mvva 212,40,132
 TR 60,1,51200
  s_add_u32 s48, s54, 1570816
 Mvva 212,48,148
  buffer_load_dwordx4 v7, s[32:35], s48 offen offset:2048 lds
 Mvva 216,40,136
 TR 62,1,59392
  s_add_u32 s48, s54, 1831936
 Mvva 216,48,152
  buffer_load_dwordx4 v7, s[32:35], s48 offen offset:3072 lds
 Mvva 220,40,140
 TR 40,1,52224
  v_mul_f32 v29, s62, v133
 Mvva 220,48,156
  buffer_atomic_add v37, v36, s[36:39], s66 offen sc1
 WL 5
 Mvva 80,52,128
 TR 42,1,60416
  v_mul_f32 v30, s62, v134
 WL 4
 Mvva 80,56,144
  v_rcp_f32 v35, v35
 Mvva 84,52,132
 TR 48,2,51200
  v_mul_f32 v163, v163, v35
 Mvva 84,56,148
  v_exp_f32 v28, v28
 Mvva 88,52,136
 TR 50,2,59392
  v_cvt_pk_bf16_f32 v130, v160, v161
 Mvva 88,56,152
 WL 4
  v_exp_f32 v29, v29
 Mvva 92,52,140
 TR 52,2,52224
  v_cvt_pk_bf16_f32 v131, v162, v163
 Mvva 92,56,156
  s_add_u32 s49, s59, 8192
  v_exp_f32 v30, v30
 Mvva 112,60,160
 TR 54,2,60416
  v_fma_f32 v28, v28, v23, v23
 WL 4
 Mvva 112,40,176
  buffer_store_dwordx4 v[128:131], v16, s[20:23], s49 offen offset:0 sc1
 Mvva 116,60,164
 TR 56,3,51200
  v_fma_f32 v29, v29, v23, v23
 Mvva 116,40,180
  v_rcp_f32 v28, v28
 Mvva 120,60,168
 TR 58,3,59392
  v_mul_f32 v132, v132, v28
 Mvva 120,40,184
 WL 2
  v_rcp_f32 v29, v29
 Mvva 124,60,172
 TR 60,3,52224
  v_mul_f32 v133, v133, v29
 Mvva 124,40,188
 WL 5
  v_fma_f32 v30, v30, v23, v23
  v_mul_f32 v31, s62, v135
 Mvva 176,48,160
 TR 62,3,60416
  v_mul_f32 v32, s62, v164
 Mvva 176,52,176
  v_rcp_f32 v30, v30
 Mvva 180,48,164
 TR 40,4,51200
  v_mul_f32 v134, v134, v30
 Mvva 180,52,180
  v_exp_f32 v31, v31
 Mvva 184,48,168
 TR 42,4,59392
  v_fma_f32 v31, v31, v23, v23
 Mvva 184,52,184
 WL 2
  v_rcp_f32 v31, v31
 Mvva 188,48,172
 TR 48,4,52224
  v_mul_f32 v135, v135, v31
 Mvva 188,52,188
 WL 5
  v_exp_f32 v32, v32
 Mvva 192,56,160
 TR 50,4,60416
  v_cvt_pk_bf16_f32 v132, v132, v133
 Mvva 192,60,176
  v_cvt_pk_bf16_f32 v133, v134, v135
  v_fma_f32 v32, v32, v23, v23
 Mvva 196,56,164
 TR 52,5,3072
  v_mul_f32 v33, s62, v165
 Mvva 196,60,180
  v_rcp_f32 v32, v32
 Mvva 200,56,168
 TR 54,5,3584
  v_mul_f32 v164, v164, v32
 Mvva 200,60,184
  v_exp_f32 v33, v33
 Mvva 204,56,172
 TR 56,5,7168
  v_fma_f32 v33, v33, v23, v23
 Mvva 204,60,188
 WL 5
  v_rcp_f32 v33, v33
 Mvva 208,40,160
 TR 58,5,7680
 WL 4
 Mvva 208,48,176
  s_barrier
  v_mul_f32 v165, v165, v33
  v_mul_f32 v34, s62, v166
 Mvva 212,40,164
 TR 60,1,0
  s_add_u32 m0, s50, 65536
 Mvva 212,48,180
  s_add_u32 s48, s54, 2097152
  v_exp_f32 v34, v34
 Mvva 216,40,168
 TR 62,1,8192
  v_fma_f32 v34, v34, v23, v23
 Mvva 216,48,184
  buffer_load_dwordx4 v7, s[32:35], s48 offen lds
 Mvva 220,40,172
 TR 40,1,1024
  s_add_u32 s48, s54, 2358272
 Mvva 220,48,188
  buffer_load_dwordx4 v7, s[32:35], s48 offen offset:1024 lds
 WL 5
 Mvva 80,52,160
 TR 42,1,9216
  v_mul_f32 v35, s62, v167
 WL 4
 Mvva 80,56,176
  v_rcp_f32 v34, v34
 Mvva 84,52,164
 TR 48,2,0
  v_mul_f32 v166, v166, v34
 Mvva 84,56,180
  v_exp_f32 v35, v35
 Mvva 88,52,168
 TR 50,2,8192
  v_fma_f32 v35, v35, v23, v23
 Mvva 88,56,184
 WL 4
  v_rcp_f32 v35, v35
 Mvva 92,52,172
 TR 52,2,1024
  v_mul_f32 v167, v167, v35
 Mvva 92,56,188
  s_add_u32 s49, s59, 8192
  v_cvt_pk_bf16_f32 v134, v164, v165
  v_cvt_pk_bf16_f32 v135, v166, v167
 Mvva 112,60,192
 TR 54,2,9216
  v_mul_f32 v28, s62, v136
 WL 4
 Mvva 112,40,208
  buffer_store_dwordx4 v[132:135], v16, s[20:23], s49 offen offset:2048 sc1
 Mvva 116,60,196
 TR 56,3,0
  v_mul_f32 v29, s62, v137
 Mvva 116,40,212
  v_exp_f32 v28, v28
 Mvva 120,60,200
 TR 58,3,8192
  v_fma_f32 v28, v28, v25, v25
 Mvva 120,40,216
 WL 2
  v_rcp_f32 v28, v28
 Mvva 124,60,204
 TR 60,3,1024
  v_mul_f32 v136, v136, v28
 Mvva 124,40,220
 WL 5
  v_exp_f32 v29, v29
 Mvva 176,48,192
 TR 62,3,9216
  v_fma_f32 v29, v29, v25, v25
 Mvva 176,52,208
  v_rcp_f32 v29, v29
 Mvva 180,48,196
 TR 40,4,0
  v_mul_f32 v137, v137, v29
 Mvva 180,52,212
  v_mul_f32 v30, s62, v138
  v_mul_f32 v31, s62, v139
 Mvva 184,48,200
 TR 42,4,8192
  v_mul_f32 v32, s62, v168
 Mvva 184,52,216
 WL 2
  v_exp_f32 v30, v30
 Mvva 188,48,204
 TR 48,4,1024
  v_fma_f32 v30, v30, v25, v25
 Mvva 188,52,220
 WL 5
  v_rcp_f32 v30, v30
 Mvva 192,56,192
 TR 50,4,9216
  v_mul_f32 v138, v138, v30
 Mvva 192,60,208
  v_exp_f32 v31, v31
 Mvva 196,56,196
 TR 52,5,11264
  v_fma_f32 v31, v31, v25, v25
 Mvva 196,60,212
  v_rcp_f32 v31, v31
 Mvva 200,56,200
 TR 54,5,11776
  v_mul_f32 v139, v139, v31
 Mvva 200,60,216
 WL 2
  v_exp_f32 v32, v32
 Mvva 204,56,204
 TR 56,5,15360
  v_cvt_pk_bf16_f32 v136, v136, v137
 Mvva 204,60,220
 WL 5
  v_cvt_pk_bf16_f32 v137, v138, v139
  v_fma_f32 v32, v32, v25, v25
 Mvva 208,40,192
 TR 58,5,15872
  s_waitcnt vmcnt(17)
 Mvva 208,48,208
  s_barrier
  v_rcp_f32 v32, v32
 Mvva 212,40,196
 TR 60,1,2048
  s_add_u32 s48, s54, 2619392
 Mvva 212,48,212
  buffer_load_dwordx4 v7, s[32:35], s48 offen offset:2048 lds
 Mvva 216,40,200
 TR 62,1,10240
  s_add_u32 s48, s54, 2880512
 Mvva 216,48,216
  buffer_load_dwordx4 v7, s[32:35], s48 offen offset:3072 lds
 Mvva 220,40,204
 TR 40,1,3072
  v_mul_f32 v168, v168, v32
 Mvva 220,48,220
 WL 5
  v_mul_f32 v33, s62, v169
  v_mul_f32 v34, s62, v170
 Mvva 80,52,192
 TR 42,1,11264
  v_mul_f32 v35, s62, v171
 WL 4
 Mvva 80,56,208
  v_exp_f32 v33, v33
 Mvva 84,52,196
 TR 48,2,2048
  v_fma_f32 v33, v33, v25, v25
 Mvva 84,56,212
  v_rcp_f32 v33, v33
 Mvva 88,52,200
 TR 50,2,10240
  v_mul_f32 v169, v169, v33
 Mvva 88,56,216
 WL 2
  v_exp_f32 v34, v34
 Mvva 92,52,204
 TR 52,2,3072
  v_fma_f32 v34, v34, v25, v25
 Mvva 92,56,220
 WL 5
  v_rcp_f32 v34, v34
 Mvva 112,60,224
 TR 54,2,11264
  v_mul_f32 v170, v170, v34
 Mvva 112,40,240
  v_exp_f32 v35, v35
 Mvva 116,60,228
 TR 56,3,2048
  v_fma_f32 v35, v35, v25, v25
 Mvva 116,40,244
  v_rcp_f32 v35, v35
 Mvva 120,60,232
 TR 58,3,10240
  v_mul_f32 v171, v171, v35
 Mvva 120,40,248
  s_add_u32 s49, s59, 8192
  v_cvt_pk_bf16_f32 v138, v168, v169
  v_cvt_pk_bf16_f32 v139, v170, v171
 Mvva 124,60,236
 TR 60,3,3072
  v_mul_f32 v28, s62, v140
 Mvva 124,40,252
  buffer_store_dwordx4 v[136:139], v17, s[20:23], s49 offen offset:0 sc1
 WL 5
 Mvva 176,48,224
 TR 62,3,11264
  v_mul_f32 v29, s62, v141
 WL 4
 Mvva 176,52,240
  v_exp_f32 v28, v28
 Mvva 180,48,228
 TR 40,4,2048
  v_fma_f32 v28, v28, v27, v27
 Mvva 180,52,244
  v_rcp_f32 v28, v28
 Mvva 184,48,232
 TR 42,4,10240
  v_mul_f32 v140, v140, v28
 Mvva 184,52,248
 WL 2
  v_exp_f32 v29, v29
 Mvva 188,48,236
 TR 48,4,3072
  v_fma_f32 v29, v29, v27, v27
 Mvva 188,52,252
 WL 5
  v_rcp_f32 v29, v29
 Mvva 192,56,224
 TR 50,4,11264
  v_mul_f32 v141, v141, v29
 Mvva 192,60,240
  v_mul_f32 v30, s62, v142
  v_mul_f32 v31, s62, v143
 Mvva 196,56,228
 TR 52,5,16384
  v_mul_f32 v32, s62, v172
 Mvva 196,60,244
  v_exp_f32 v30, v30
 Mvva 200,56,232
 TR 54,5,16896
  v_fma_f32 v30, v30, v27, v27
 Mvva 200,60,248
 WL 2
  v_rcp_f32 v30, v30
 Mvva 204,56,236
 TR 56,5,20480
  v_mul_f32 v142, v142, v30
 Mvva 204,60,252
 WL 5
  v_exp_f32 v31, v31
 Mvva 208,40,224
 TR 58,5,20992
  s_waitcnt vmcnt(17)
 Mvva 208,48,240
  s_barrier
  v_exp_f32 v32, v32
 Mvva 212,40,228
 TR 60,1,16384
  s_add_u32 m0, s50, 81920
 Mvva 212,48,244
  s_add_u32 s48, s54, 3145728
  v_fma_f32 v31, v31, v27, v27
  v_fma_f32 v32, v32, v27, v27
 Mvva 216,40,232
 TR 62,1,24576
  v_mul_f32 v33, s62, v173
 Mvva 216,48,248
  buffer_load_dwordx4 v7, s[32:35], s48 offen lds
 Mvva 220,40,236
 TR 40,1,17408
  s_add_u32 s48, s54, 3406848
 Mvva 220,48,252
  buffer_load_dwordx4 v7, s[32:35], s48 offen offset:1024 lds
 WL 5
 Mvva 80,52,224
 TR 42,1,25600
  v_mul_f32 v34, s62, v174
 WL 4
 Mvva 80,56,240
  v_rcp_f32 v31, v31
 Mvva 84,52,228
 TR 48,2,16384
  v_mul_f32 v143, v143, v31
 Mvva 84,56,244
  v_rcp_f32 v32, v32
 Mvva 88,52,232
 TR 50,2,24576
  v_cvt_pk_bf16_f32 v140, v140, v141
 Mvva 88,56,248
 WL 2
  v_exp_f32 v33, v33
 Mvva 92,52,236
 TR 52,2,17408
  v_cvt_pk_bf16_f32 v141, v142, v143
 Mvva 92,56,252
 WL 5
  v_exp_f32 v34, v34
  v_mfma_f32_16x16x32_bf16 v[144:147], v[60:63], v[224:227], 0
 TR 54,2,25600
  v_mul_f32 v172, v172, v32
 Mvvv 144,40,240
  v_fma_f32 v33, v33, v27, v27
  v_fma_f32 v34, v34, v27, v27
  v_mfma_f32_16x16x32_bf16 v[148:151], v[60:63], v[228:231], 0
 TR 56,3,16384
  v_mul_f32 v35, s62, v175
 Mvvv 148,40,244
  v_rcp_f32 v33, v33
  v_mfma_f32_16x16x32_bf16 v[152:155], v[60:63], v[232:235], 0
 TR 58,3,24576
  v_mul_f32 v173, v173, v33
 Mvvv 152,40,248
 WL 2
  v_rcp_f32 v34, v34
  v_mfma_f32_16x16x32_bf16 v[156:159], v[60:63], v[236:239], 0
 TR 60,3,17408
  v_mul_f32 v174, v174, v34
 Mvvv 156,40,252
 WL 5
  v_exp_f32 v35, v35
  v_mfma_f32_16x16x32_bf16 v[96:99], v[48:51], v[224:227], 0
 TR 62,3,25600
  v_fma_f32 v35, v35, v27, v27
 Mvvv 96,52,240
  v_rcp_f32 v35, v35
  v_mfma_f32_16x16x32_bf16 v[100:103], v[48:51], v[228:231], 0
 TR 40,4,16384
  v_mul_f32 v175, v175, v35
 Mvvv 100,52,244
  s_add_u32 s49, s59, 8192
  v_cvt_pk_bf16_f32 v142, v172, v173
  v_cvt_pk_bf16_f32 v143, v174, v175
  v_mfma_f32_16x16x32_bf16 v[104:107], v[48:51], v[232:235], 0
 TR 42,4,24576
  v_mul_f32 v28, s62, v80
 Mvvv 104,52,248
  buffer_store_dwordx4 v[140:143], v17, s[20:23], s49 offen offset:2048 sc1
  v_mfma_f32_16x16x32_bf16 v[108:111], v[48:51], v[236:239], 0
 TR 48,4,17408
  v_mul_f32 v29, s62, v81
 Mvvv 108,52,252
 WL 5
  v_exp_f32 v28, v28
  v_mfma_f32_16x16x32_bf16 v[160:163], v[56:59], v[224:227], 0
 TR 50,4,25600
  s_waitcnt vmcnt(16)
 WL 4
 Mvvv 160,60,240
  s_barrier
  v_exp_f32 v29, v29
  v_mfma_f32_16x16x32_bf16 v[164:167], v[56:59], v[228:231], 0
 TR 52,1,18432
  s_add_u32 s48, s54, 3667968
 Mvvv 164,60,244
  buffer_load_dwordx4 v7, s[32:35], s48 offen offset:2048 lds
  v_mfma_f32_16x16x32_bf16 v[168:171], v[56:59], v[232:235], 0
 TR 54,1,26624
  s_add_u32 s48, s54, 3929088
 Mvvv 168,60,248
  buffer_load_dwordx4 v7, s[32:35], s48 offen offset:3072 lds
  v_mfma_f32_16x16x32_bf16 v[172:175], v[56:59], v[236:239], 0
 TR 56,1,19456
  v_fma_f32 v28, v28, v21, v21
 Mvvv 172,60,252
 WL 5
  v_rcp_f32 v28, v28
  v_mfma_f32_16x16x32_bf16 v[64:67], v[40:43], v[224:227], 0
 TR 58,1,27648
  v_mul_f32 v80, v80, v28
 WL 4
 Mvvv 64,48,240
  v_fma_f32 v29, v29, v21, v21
  v_mul_f32 v30, s62, v82
  v_mfma_f32_16x16x32_bf16 v[68:71], v[40:43], v[228:231], 0
 TR 60,2,18432
  v_mul_f32 v31, s62, v83
 Mvvv 68,48,244
  v_rcp_f32 v29, v29
  v_mfma_f32_16x16x32_bf16 v[72:75], v[40:43], v[232:235], 0
 TR 62,2,26624
  v_mul_f32 v81, v81, v29
 Mvvv 72,48,248
 WL 2
  v_exp_f32 v30, v30
  v_mfma_f32_16x16x32_bf16 v[76:79], v[40:43], v[236:239], 0
 TR 40,2,19456
  v_fma_f32 v30, v30, v21, v21
 Mvvv 76,48,252
 WL 5
  v_rcp_f32 v30, v30
 Mvva 144,52,0
 TR 42,2,27648
  v_mul_f32 v82, v82, v30
 Mvva 144,56,16
  v_exp_f32 v31, v31
 Mvva 148,52,4
 TR 48,3,18432
  v_fma_f32 v31, v31, v21, v21
 Mvva 148,56,20
  v_rcp_f32 v31, v31
 Mvva 152,52,8
 TR 50,3,26624
  v_mul_f32 v83, v83, v31
 Mvva 152,56,24
 WL 4
  v_cvt_pk_bf16_f32 v80, v80, v81
  v_cvt_pk_bf16_f32 v81, v82, v83
 Mvva 156,52,12
 TR 52,3,19456
  v_mul_f32 v32, s62, v84
 Mvva 156,56,28
  buffer_store_dwordx2 v[80:81], v16, s[20:23], s60 offen offset:0 sc1
 Mvva 96,60,0
 TR 54,3,27648
  v_mul_f32 v33, s62, v85
 WL 4
 Mvva 96,40,16
  v_exp_f32 v32, v32
 Mvva 100,60,4
 TR 56,4,18432
  v_fma_f32 v32, v32, v23, v23
 Mvva 100,40,20
  v_rcp_f32 v32, v32
 Mvva 104,60,8
 TR 58,4,26624
  v_mul_f32 v84, v84, v32
 Mvva 104,40,24
 WL 2
  v_exp_f32 v33, v33
 Mvva 108,60,12
 TR 60,4,19456
  v_fma_f32 v33, v33, v23, v23
 Mvva 108,40,28
 WL 5
  v_rcp_f32 v33, v33
 Mvva 160,48,0
 TR 62,4,27648
  s_waitcnt vmcnt(16)
 Mvva 160,52,16
  s_barrier
  v_mul_f32 v85, v85, v33
  v_mul_f32 v34, s62, v86
 Mvva 164,48,4
 TR 40,1,32768
  s_add_u32 m0, s50, 98304
 Mvva 164,52,20
  s_add_u32 s48, s54, 4194304
  v_exp_f32 v34, v34
 Mvva 168,48,8
 TR 42,1,40960
  v_fma_f32 v34, v34, v23, v23
 Mvva 168,52,24
  buffer_load_dwordx4 v7, s[32:35], s48 offen lds
 Mvva 172,48,12
 TR 48,1,33792
  s_add_u32 s48, s54, 4455424
 Mvva 172,52,28
  buffer_load_dwordx4 v7, s[32:35], s48 offen offset:1024 lds
 WL 5
 Mvva 64,56,0
 TR 50,1,41984
  v_mul_f32 v35, s62, v87
 WL 4
 Mvva 64,60,16
  v_rcp_f32 v34, v34
 Mvva 68,56,4
 TR 52,2,32768
  v_mul_f32 v86, v86, v34
 Mvva 68,60,20
  v_exp_f32 v35, v35
 Mvva 72,56,8
 TR 54,2,40960
  v_fma_f32 v35, v35, v23, v23
 Mvva 72,60,24
 WL 2
  v_rcp_f32 v35, v35
 Mvva 76,56,12
 TR 56,2,33792
  v_mul_f32 v87, v87, v35
 Mvva 76,60,28
 WL 5
  v_cvt_pk_bf16_f32 v84, v84, v85
  v_cvt_pk_bf16_f32 v85, v86, v87
 Mvva 144,40,32
 TR 58,2,41984
  v_mul_f32 v28, s62, v88
 Mvva 144,48,48
  global_load_dword v47, v46, s[100:101]
 Mvva 148,40,36
 TR 60,3,32768
  v_mul_f32 v29, s62, v89
 Mvva 148,48,52
  buffer_store_dwordx2 v[84:85], v16, s[20:23], s60 offen offset:2048 sc1
 Mvva 152,40,40
 TR 62,3,40960
  v_mul_f32 v30, s62, v90
 Mvva 152,48,56
 WL 2
  v_exp_f32 v28, v28
 Mvva 156,40,44
 TR 40,3,33792
  v_fma_f32 v28, v28, v25, v25
 Mvva 156,48,60
 WL 5
  v_rcp_f32 v28, v28
 Mvva 96,52,32
 TR 42,3,41984
  v_mul_f32 v88, v88, v28
 Mvva 96,56,48
  v_exp_f32 v29, v29
 Mvva 100,52,36
 TR 48,4,32768
  v_fma_f32 v29, v29, v25, v25
 Mvva 100,56,52
  v_rcp_f32 v29, v29
 Mvva 104,52,40
 TR 50,4,40960
  v_mul_f32 v89, v89, v29
 Mvva 104,56,56
 WL 2
  v_exp_f32 v30, v30
 Mvva 108,52,44
 TR 52,4,33792
  v_fma_f32 v30, v30, v25, v25
 Mvva 108,56,60
 WL 5
  v_rcp_f32 v30, v30
 Mvva 160,60,32
 TR 54,4,41984
  s_waitcnt vmcnt(18)
 Mvva 160,40,48
  s_barrier
  v_mul_f32 v90, v90, v30
  v_mul_f32 v31, s62, v91
 Mvva 164,60,36
 TR 56,1,34816
  s_add_u32 m0, s50, 100352
 Mvva 164,40,52
  s_add_u32 s48, s54, 128
  v_exp_f32 v31, v31
 Mvva 168,60,40
 TR 58,1,43008
  v_fma_f32 v31, v31, v25, v25
 Mvva 168,40,56
  buffer_load_dwordx4 v7, s[32:35], s48 offen lds
 Mvva 172,60,44
 TR 60,1,35840
  s_add_u32 m0, s50, 98304
 Mvva 172,40,60
  s_add_u32 s48, s54, 259200
  v_rcp_f32 v31, v31
 WL 5
 Mvva 64,48,32
 TR 62,1,44032
  v_mul_f32 v91, v91, v31
 WL 4
 Mvva 64,52,48
  buffer_load_dwordx4 v7, s[32:35], s48 offen offset:3072 lds
 Mvva 68,48,36
 TR 40,2,34816
  v_cvt_pk_bf16_f32 v88, v88, v89
 Mvva 68,52,52
  v_cvt_pk_bf16_f32 v89, v90, v91
  v_mul_f32 v32, s62, v92
 Mvva 72,48,40
 TR 42,2,43008
  v_mul_f32 v33, s62, v93
 Mvva 72,52,56
  buffer_store_dwordx2 v[88:89], v17, s[20:23], s60 offen offset:0 sc1
 Mvva 76,48,44
 TR 48,2,35840
  v_mul_f32 v34, s62, v94
 Mvva 76,52,60
 WL 5
  v_exp_f32 v32, v32
 Mvva 144,56,64
 TR 50,2,44032
  s_lshl_b32 s66, s4, 2
 WL 4
 Mvva 144,60,80
  s_add_u32 s66, s66, 32
  v_exp_f32 v33, v33
 Mvva 148,56,68
 TR 52,3,34816
  v_fma_f32 v32, v32, v27, v27
 Mvva 148,60,84
  buffer_load_dword v38, off, s[36:39], s66 sc1
 Mvva 152,56,72
 TR 54,3,43008
  v_fma_f32 v33, v33, v27, v27
 Mvva 152,60,88
 WL 2
  v_rcp_f32 v32, v32
 Mvva 156,56,76
 TR 56,3,35840
  v_mul_f32 v92, v92, v32
 Mvva 156,60,92
 WL 5
  v_rcp_f32 v33, v33
 Mvva 96,40,64
 TR 58,3,44032
  v_mul_f32 v93, v93, v33
 Mvva 96,48,80
  v_exp_f32 v34, v34
 Mvva 100,40,68
 TR 60,4,34816
  v_fma_f32 v34, v34, v27, v27
 Mvva 100,48,84
  v_rcp_f32 v34, v34
 Mvva 104,40,72
 TR 62,4,43008
  v_mul_f32 v94, v94, v34
 Mvva 104,48,88
 WL 2
  v_mul_f32 v35, s62, v95
  v_mul_f32 v28, s62, v112
 Mvva 108,40,76
 TR 40,4,35840
  v_mul_f32 v29, s62, v113
 Mvva 108,48,92
 WL 5
  v_exp_f32 v35, v35
 Mvva 160,52,64
 TR 42,4,44032
  s_waitcnt vmcnt(18)
 Mvva 160,56,80
  s_barrier
  v_xor_b32 v1, 0x10000, v1
  v_fma_f32 v35, v35, v27, v27
 Mvva 164,52,68
 TR 48,1,0
  s_add_u32 m0, s50, 49152
 Mvva 164,56,84
  s_add_u32 s48, s54, 524416
  v_rcp_f32 v35, v35
 Mvva 168,52,72
 TR 50,1,8192
  v_mul_f32 v95, v95, v35
 Mvva 168,56,88
  buffer_load_dwordx4 v7, s[32:35], s48 offen lds
 Mvva 172,52,76
 TR 52,1,1024
  s_add_u32 s48, s54, 785536
 Mvva 172,56,92
  buffer_load_dwordx4 v7, s[32:35], s48 offen offset:1024 lds
 WL 5
 Mvva 64,60,64
 TR 54,1,9216
  v_cvt_pk_bf16_f32 v92, v92, v93
 WL 4
 Mvva 64,40,80
  v_xor_b32 v2, 0x10000, v2
  v_cvt_pk_bf16_f32 v93, v94, v95
 Mvva 68,60,68
 TR 56,2,0
  v_mul_f32 v30, s62, v114
 Mvva 68,40,84
  buffer_store_dwordx2 v[92:93], v17, s[20:23], s60 offen offset:2048 sc1
 Mvva 72,60,72
 TR 58,2,8192
  v_mul_f32 v31, s62, v115
 Mvva 72,40,88
 WL 2
  v_exp_f32 v28, v28
 Mvva 76,60,76
 TR 60,2,1024
  v_fma_f32 v28, v28, v21, v21
 Mvva 76,40,92
 WL 5
  v_rcp_f32 v28, v28
 Mvva 144,48,96
 TR 62,2,9216
  v_mul_f32 v112, v112, v28
 Mvva 144,52,112
  v_xor_b32 v3, 0x10000, v3
  v_mul_f32 v32, s62, v176
 Mvva 148,48,100
 TR 40,3,0
  v_mul_f32 v33, s62, v177
 Mvva 148,52,116
  v_exp_f32 v29, v29
 Mvva 152,48,104
 TR 42,3,8192
  v_fma_f32 v29, v29, v21, v21
 Mvva 152,52,120
 WL 2
  v_rcp_f32 v29, v29
 Mvva 156,48,108
 TR 48,3,1024
  v_mul_f32 v113, v113, v29
 Mvva 156,52,124
 WL 5
  v_exp_f32 v30, v30
 Mvva 96,56,96
 TR 50,3,9216
  v_fma_f32 v30, v30, v21, v21
 Mvva 96,60,112
  v_xor_b32 v4, 0x10000, v4
  v_mul_f32 v34, s62, v178
 Mvva 100,56,100
 TR 52,4,0
  v_mul_f32 v35, s62, v179
 Mvva 100,60,116
  v_rcp_f32 v30, v30
 Mvva 104,56,104
 TR 54,4,8192
  v_mul_f32 v114, v114, v30
 Mvva 104,60,120
 WL 2
  v_exp_f32 v31, v31
 Mvva 108,56,108
 TR 56,4,1024
  v_fma_f32 v31, v31, v21, v21
 Mvva 108,60,124
 WL 5
  v_rcp_f32 v31, v31
 Mvva 160,40,96
 TR 58,4,9216
  s_waitcnt vmcnt(18)
 Mvva 160,48,112
  s_barrier
  v_exp_f32 v32, v32
 Mvva 164,40,100
 TR 60,1,2048
  s_add_u32 s48, s54, 1046656
 Mvva 164,48,116
  buffer_load_dwordx4 v7, s[32:35], s48 offen offset:2048 lds
 Mvva 168,40,104
 TR 62,1,10240
  s_add_u32 s48, s54, 1307776
 Mvva 168,48,120
  buffer_load_dwordx4 v7, s[32:35], s48 offen offset:3072 lds
 Mvva 172,40,108
 TR 40,1,3072
  v_mul_f32 v115, v115, v31
 Mvva 172,48,124
 WL 5
  v_exp_f32 v33, v33
 Mvva 64,52,96
 TR 42,1,11264
  v_cvt_pk_bf16_f32 v112, v112, v113
 WL 4
 Mvva 64,56,112
  v_exp_f32 v34, v34
 Mvva 68,52,100
 TR 48,2,2048
  v_cvt_pk_bf16_f32 v113, v114, v115
 Mvva 68,56,116
  v_exp_f32 v35, v35
 Mvva 72,52,104
 TR 50,2,10240
  v_fma_f32 v32, v32, v21, v21
 Mvva 72,56,120
 WL 2
  v_rcp_f32 v32, v32
 Mvva 76,52,108
 TR 52,2,3072
  v_mul_f32 v176, v176, v32
 Mvva 76,56,124
 WL 5
  v_fma_f32 v33, v33, v21, v21
  v_fma_f32 v34, v34, v21, v21
 Mvva 144,60,128
 TR 54,2,11264
  v_fma_f32 v35, v35, v21, v21
 Mvva 144,40,144
  v_rcp_f32 v33, v33
 Mvva 148,60,132
 TR 56,3,2048
  v_mul_f32 v177, v177, v33
 Mvva 148,40,148
  v_rcp_f32 v34, v34
 Mvva 152,60,136
 TR 58,3,10240
  v_mul_f32 v178, v178, v34
 Mvva 152,40,152
 WL 4
  v_rcp_f32 v35, v35
 Mvva 156,60,140
 TR 60,3,3072
  v_mul_f32 v179, v179, v35
 Mvva 156,40,156
  s_add_u32 s49, s59, 16384
  v_cvt_pk_bf16_f32 v114, v176, v177
  v_cvt_pk_bf16_f32 v115, v178, v179
 Mvva 96,48,128
 TR 62,3,11264
  v_mul_f32 v28, s62, v116
 WL 4
 Mvva 96,52,144
  buffer_store_dwordx4 v[112:115], v16, s[20:23], s49 offen offset:0 sc1
 Mvva 100,48,132
 TR 40,4,2048
  v_mul_f32 v29, s62, v117
 Mvva 100,52,148
  v_exp_f32 v28, v28
 Mvva 104,48,136
 TR 42,4,10240
  v_fma_f32 v28, v28, v23, v23
 Mvva 104,52,152
 WL 2
  v_rcp_f32 v28, v28
 Mvva 108,48,140
 TR 48,4,3072
  v_mul_f32 v116, v116, v28
 Mvva 108,52,156
 WL 5
  v_exp_f32 v29, v29
 Mvva 160,56,128
 TR 50,4,11264
  s_waitcnt vmcnt(18)
 Mvva 160,60,144
  s_barrier
  v_fma_f32 v29, v29, v23, v23
  v_mul_f32 v30, s62, v118
 Mvva 164,56,132
 TR 52,1,16384
  s_add_u32 m0, s50, 0
 Mvva 164,60,148
  s_add_u32 s48, s54, 1572992
  v_rcp_f32 v29, v29
 Mvva 168,56,136
 TR 54,1,24576
  v_mul_f32 v117, v117, v29
 Mvva 168,60,152
  buffer_load_dwordx4 v7, s[32:35], s48 offen lds
 Mvva 172,56,140
 TR 56,1,17408
  s_add_u32 s48, s54, 1834112
 Mvva 172,60,156
  buffer_load_dwordx4 v7, s[32:35], s48 offen offset:1024 lds
 WL 5
 Mvva 64,40,128
 TR 58,1,25600
  v_mul_f32 v31, s62, v119
 WL 4
 Mvva 64,48,144
  v_exp_f32 v30, v30
 Mvva 68,40,132
 TR 60,2,16384
  v_fma_f32 v30, v30, v23, v23
 Mvva 68,48,148
  v_rcp_f32 v30, v30
 Mvva 72,40,136
 TR 62,2,24576
  v_mul_f32 v118, v118, v30
 Mvva 72,48,152
 WL 2
  v_exp_f32 v31, v31
 Mvva 76,40,140
 TR 40,2,17408
  v_fma_f32 v31, v31, v23, v23
 Mvva 76,48,156
 WL 5
  v_rcp_f32 v31, v31
 Mvva 144,52,160
 TR 42,2,25600
  v_mul_f32 v119, v119, v31
 Mvva 144,56,176
  v_cvt_pk_bf16_f32 v116, v116, v117
  v_cvt_pk_bf16_f32 v117, v118, v119
 Mvva 148,52,164
 TR 48,3,16384
  v_mul_f32 v32, s62, v180
 Mvva 148,56,180
  v_exp_f32 v32, v32
 Mvva 152,52,168
 TR 50,3,24576
  v_fma_f32 v32, v32, v23, v23
 Mvva 152,56,184
 WL 2
  v_rcp_f32 v32, v32
 Mvva 156,52,172
 TR 52,3,17408
  v_mul_f32 v180, v180, v32
 Mvva 156,56,188
 WL 5
  v_mul_f32 v33, s62, v181
  v_mul_f32 v34, s62, v182
 Mvva 96,60,160
 TR 54,3,25600
  v_mul_f32 v35, s62, v183
 Mvva 96,40,176
  v_exp_f32 v33, v33
 Mvva 100,60,164
 TR 56,4,16384
  v_fma_f32 v33, v33, v23, v23
 Mvva 100,40,180
  v_rcp_f32 v33, v33
 Mvva 104,60,168
 TR 58,4,24576
  v_mul_f32 v181, v181, v33
 Mvva 104,40,184
 WL 2
  v_exp_f32 v34, v34
 Mvva 108,60,172
 TR 60,4,17408
  v_fma_f32 v34, v34, v23, v23
 Mvva 108,40,188
 WL 5
  v_rcp_f32 v34, v34
 Mvva 160,48,160
 TR 62,4,25600
  s_waitcnt vmcnt(17)
 Mvva 160,52,176
  s_barrier
  v_exp_f32 v35, v35
 Mvva 164,48,164
 TR 40,1,18432
  s_add_u32 s48, s54, 2095232
 Mvva 164,52,180
  buffer_load_dwordx4 v7, s[32:35], s48 offen offset:2048 lds
 Mvva 168,48,168
 TR 42,1,26624
  s_add_u32 s48, s54, 2356352
 Mvva 168,52,184
  buffer_load_dwordx4 v7, s[32:35], s48 offen offset:3072 lds
 Mvva 172,48,172
 TR 48,1,19456
  v_mul_f32 v182, v182, v34
 Mvva 172,52,188
 WL 5
  v_fma_f32 v35, v35, v23, v23
  v_mul_f32 v28, s62, v120
 Mvva 64,56,160
 TR 50,1,27648
  v_mul_f32 v29, s62, v121
 WL 4
 Mvva 64,60,176
  v_rcp_f32 v35, v35
 Mvva 68,56,164
 TR 52,2,18432
  v_mul_f32 v183, v183, v35
 Mvva 68,60,180
  v_exp_f32 v28, v28
 Mvva 72,56,168
 TR 54,2,26624
  v_cvt_pk_bf16_f32 v118, v180, v181
 Mvva 72,60,184
 WL 4
  v_exp_f32 v29, v29
 Mvva 76,56,172
 TR 56,2,19456
  v_cvt_pk_bf16_f32 v119, v182, v183
 Mvva 76,60,188
  s_add_u32 s49, s59, 16384
  v_fma_f32 v28, v28, v25, v25
  v_fma_f32 v29, v29, v25, v25
 Mvva 144,40,192
 TR 58,2,27648
  v_mul_f32 v30, s62, v122
 WL 4
 Mvva 144,48,208
  buffer_store_dwordx4 v[116:119], v16, s[20:23], s49 offen offset:2048 sc1
 Mvva 148,40,196
 TR 60,3,18432
  v_mul_f32 v31, s62, v123
 Mvva 148,48,212
  v_rcp_f32 v28, v28
 Mvva 152,40,200
 TR 62,3,26624
  v_mul_f32 v120, v120, v28
 Mvva 152,48,216
 WL 2
  v_rcp_f32 v29, v29
 Mvva 156,40,204
 TR 40,3,19456
  v_mul_f32 v121, v121, v29
 Mvva 156,48,220
 WL 5
  v_exp_f32 v30, v30
 Mvva 96,52,192
 TR 42,3,27648
  v_fma_f32 v30, v30, v25, v25
 Mvva 96,56,208
  v_rcp_f32 v30, v30
 Mvva 100,52,196
 TR 48,4,18432
  v_mul_f32 v122, v122, v30
 Mvva 100,56,212
  v_exp_f32 v31, v31
 Mvva 104,52,200
 TR 50,4,26624
  v_fma_f32 v31, v31, v25, v25
 Mvva 104,56,216
 WL 2
  v_rcp_f32 v31, v31
 Mvva 108,52,204
 TR 52,4,19456
  v_mul_f32 v123, v123, v31
 Mvva 108,56,220
 WL 5
  v_cvt_pk_bf16_f32 v120, v120, v121
  v_cvt_pk_bf16_f32 v121, v122, v123
 Mvva 160,60,192
 TR 54,4,27648
  s_waitcnt vmcnt(17)
 Mvva 160,40,208
  s_barrier
  v_mul_f32 v32, s62, v184
  v_mul_f32 v33, s62, v185
 Mvva 164,60,196
 TR 56,1,32768
  s_add_u32 m0, s50, 16384
 Mvva 164,40,212
  s_add_u32 s48, s54, 2621568
  v_exp_f32 v32, v32
 Mvva 168,60,200
 TR 58,1,40960
  v_fma_f32 v32, v32, v25, v25
 Mvva 168,40,216
  buffer_load_dwordx4 v7, s[32:35], s48 offen lds
 Mvva 172,60,204
 TR 60,1,33792
  s_add_u32 s48, s54, 2882688
 Mvva 172,40,220
  buffer_load_dwordx4 v7, s[32:35], s48 offen offset:1024 lds
 WL 5
 Mvva 64,48,192
 TR 62,1,41984
  v_mul_f32 v34, s62, v186
 WL 4
 Mvva 64,52,208
  v_rcp_f32 v32, v32
 Mvva 68,48,196
 TR 40,2,32768
  v_mul_f32 v184, v184, v32
 Mvva 68,52,212
  v_exp_f32 v33, v33
 Mvva 72,48,200
 TR 42,2,40960
  v_fma_f32 v33, v33, v25, v25
 Mvva 72,52,216
 WL 2
  v_rcp_f32 v33, v33
 Mvva 76,48,204
 TR 48,2,33792
  v_mul_f32 v185, v185, v33
 Mvva 76,52,220
 WL 5
  v_exp_f32 v34, v34
 Mvva 144,56,224
 TR 50,2,41984
  v_fma_f32 v34, v34, v25, v25
 Mvva 144,60,240
  v_rcp_f32 v34, v34
 Mvva 148,56,228
 TR 52,3,32768
  v_mul_f32 v186, v186, v34
 Mvva 148,60,244
  s_waitcnt vmcnt(13)
  v_readfirstlane_b32 s65, v38
  v_mul_f32 v35, s62, v187
 Mvva 152,56,232
 TR 54,3,40960
  v_mul_f32 v28, s62, v124
 Mvva 152,60,248
  s_cmp_ge_u32 s65, 8
  s_cbranch_scc0 Lpoll_kv
Lback_kv:
  s_mul_i32 s68, s4, 0x104000
 Mvva 156,56,236
 TR 56,3,33792
  s_add_u32 s68, s68, 0xe000
 Mvva 156,60,252
  s_add_u32 s69, s68, s50
  s_and_b32 s65, s3, 1
  s_lshl_b32 s65, s65, 13
 WL 5
 Mvva 96,40,224
 TR 58,3,41984
  s_add_u32 s68, s68, s65
 WL 4
 Mvva 96,48,240
  s_cmp_lt_u32 s3, 2
  s_cselect_b32 s67, 65536, 0
  s_cselect_b32 s66, 4, 34
 Mvva 100,40,228
 TR 60,4,32768
  s_lshl_b32 s66, s66, 14
 Mvva 100,48,244
  s_add_u32 s67, s67, s65
  s_add_u32 s68, s68, s66
  s_lshl_b32 s66, s5, 1
 Mvva 104,40,232
 TR 62,4,40960
  s_sub_u32 s66, 15, s66
 Mvva 104,48,248
  s_mul_i32 s66, s66, 0x220000
  v_exp_f32 v35, v35
 Mvva 108,40,236
 TR 40,4,33792
  v_fma_f32 v35, v35, v25, v25
  v_rcp_f32 v35, v35
 Mvva 108,48,252
  s_add_u32 s7, s58, s66
  v_mul_f32 v187, v187, v35
  v_add_u32 v18, 65536, v16
 WL 5
 Mvva 160,52,224
 TR 42,4,41984
 WL 4
 Mvva 160,56,240
  s_barrier
  v_exp_f32 v28, v28
 Mvva 164,52,228
 TR 48,1,34816
  v_fma_f32 v28, v28, v27, v27
  v_rcp_f32 v28, v28
 Mvva 164,56,244
  v_cvt_pk_bf16_f32 v122, v184, v185
  v_cvt_pk_bf16_f32 v123, v186, v187
  v_mul_f32 v124, v124, v28
 Mvva 168,52,232
 TR 50,1,43008
  s_add_u32 s48, s54, 3143808
 Mvva 168,56,248
 WL 4
  v_mul_f32 v29, s62, v125
  v_exp_f32 v29, v29
 Mvva 172,52,236
 TR 52,1,35840
  v_fma_f32 v29, v29, v27, v27
  v_rcp_f32 v29, v29
 Mvva 172,56,252
  s_lshl_b32 s65, s65, 1
  v_mul_f32 v125, v125, v29
  v_add_u32 v19, 65536, v16
 Mvva 64,60,224
 TR 54,1,44032
  v_add_u32 v46, s65, v16
 WL 4
 Mvva 64,40,240
  s_add_u32 s49, s59, 16384
  v_mul_f32 v30, s62, v126
  v_exp_f32 v30, v30
 Mvva 68,60,228
 TR 56,2,34816
  v_fma_f32 v30, v30, v27, v27
  v_rcp_f32 v30, v30
 Mvva 68,40,244
  buffer_load_dwordx4 v7, s[32:35], s48 offen offset:2048 lds
  v_mul_f32 v126, v126, v30
 Mvva 72,60,232
 TR 58,2,43008
  s_add_u32 s48, s54, 3404928
 Mvva 72,40,248
 WL 4
  v_mul_f32 v31, s62, v127
  v_exp_f32 v31, v31
 Mvva 76,60,236
 TR 60,2,35840
  v_fma_f32 v31, v31, v27, v27
  v_rcp_f32 v31, v31
 Mvva 76,40,252
  buffer_store_dwordx4 v[120:123], v17, s[20:23], s49 offen offset:0 sc1
  v_mul_f32 v127, v127, v31
  v_mfma_f32_16x16x32_bf16 v[128:131], v[48:51], v[224:227], 0
 TR 62,2,44032
  s_lshr_b32 s65, s65, 4
 WL 4
 Mvvv 128,52,240
  v_mul_f32 v32, s62, v188
  v_exp_f32 v32, v32
  v_mfma_f32_16x16x32_bf16 v[132:135], v[48:51], v[228:231], 0
 TR 40,3,34816
  v_fma_f32 v32, v32, v27, v27
  v_rcp_f32 v32, v32
 Mvvv 132,52,244
  buffer_load_dwordx4 v7, s[32:35], s48 offen offset:3072 lds
  v_cvt_pk_bf16_f32 v124, v124, v125
  v_cvt_pk_bf16_f32 v125, v126, v127
  v_mul_f32 v188, v188, v32
  v_mfma_f32_16x16x32_bf16 v[136:139], v[48:51], v[232:235], 0
 TR 42,3,43008
  s_add_u32 s65, s65, 118784
 Mvvv 136,52,248
 WL 2
  v_mul_f32 v33, s62, v189
  v_exp_f32 v33, v33
  v_mfma_f32_16x16x32_bf16 v[140:143], v[48:51], v[236:239], 0
 TR 48,3,35840
  v_fma_f32 v33, v33, v27, v27
  v_rcp_f32 v33, v33
 Mvvv 140,52,252
 WL 5
  v_mul_f32 v189, v189, v33
  v_add_u32 v14, s65, v16
  v_mfma_f32_16x16x32_bf16 v[80:83], v[56:59], v[224:227], 0
 TR 50,3,44032
  v_mul_f32 v34, s62, v190
 Mvvv 80,60,240
  v_exp_f32 v34, v34
  v_mfma_f32_16x16x32_bf16 v[84:87], v[56:59], v[228:231], 0
 TR 52,4,34816
  v_fma_f32 v34, v34, v27, v27
  v_rcp_f32 v34, v34
 Mvvv 84,60,244
  v_mul_f32 v190, v190, v34
  v_mul_f32 v35, s62, v191
  v_mfma_f32_16x16x32_bf16 v[88:91], v[56:59], v[232:235], 0
 TR 54,4,43008
  v_mul_f32 v28, s62, v192
 Mvvv 88,60,248
 WL 2
  v_exp_f32 v35, v35
  v_mfma_f32_16x16x32_bf16 v[92:95], v[56:59], v[236:239], 0
 TR 56,4,35840
  v_fma_f32 v35, v35, v27, v27
  v_rcp_f32 v35, v35
 Mvvv 92,60,252
 WL 5
  v_mul_f32 v191, v191, v35
  v_cvt_pk_bf16_f32 v126, v188, v189
  v_mfma_f32_16x16x32_bf16 v[112:115], v[40:43], v[224:227], 0
 TR 58,4,44032
  s_waitcnt vmcnt(14)
 Mvvv 112,48,240
  s_barrier
  v_xor_b32 v1, 0x10000, v1
  v_cvt_pk_bf16_f32 v127, v190, v191
  v_mfma_f32_16x16x32_bf16 v[116:119], v[40:43], v[228:231], 0
 TR 60,1,49152
  s_add_u32 m0, s50, 32768
 Mvvv 116,48,244
  s_add_u32 s48, s54, 3670144
  s_add_u32 s49, s59, 16384
  v_mul_f32 v29, s62, v193
  v_mfma_f32_16x16x32_bf16 v[120:123], v[40:43], v[232:235], 0
 TR 62,1,57344
  buffer_store_dwordx4 v[124:127], v17, s[20:23], s49 offen offset:2048 sc1
 Mvvv 120,48,248
  buffer_load_dwordx4 v7, s[32:35], s48 offen lds
  v_mfma_f32_16x16x32_bf16 v[124:127], v[40:43], v[236:239], 0
 TR 40,1,50176
  s_add_u32 s48, s54, 3931264
 Mvvv 124,48,252
  buffer_load_dwordx4 v7, s[32:35], s48 offen offset:1024 lds
 WL 5
  v_mfma_f32_16x16x32_bf16 v[176:179], v[52:55], v[224:227], 0
 TR 42,1,58368
  v_mul_f32 v30, s62, v194
 WL 4
 Mvvv 176,56,240
  v_xor_b32 v2, 0x10000, v2
  v_mul_f32 v31, s62, v195
  v_mfma_f32_16x16x32_bf16 v[180:183], v[52:55], v[228:231], 0
 TR 48,2,49152
  v_mul_f32 v32, s62, v208
 Mvvv 180,56,244
  v_exp_f32 v28, v28
  v_mfma_f32_16x16x32_bf16 v[184:187], v[52:55], v[232:235], 0
 TR 50,2,57344
  v_fma_f32 v28, v28, v21, v21
 Mvvv 184,56,248
 WL 2
  v_rcp_f32 v28, v28
  v_mfma_f32_16x16x32_bf16 v[188:191], v[52:55], v[236:239], 0
 TR 52,2,50176
  v_mul_f32 v192, v192, v28
 Mvvv 188,56,252
 WL 5
  v_exp_f32 v29, v29
 Mvva 128,60,0
 TR 54,2,58368
  v_fma_f32 v29, v29, v21, v21
 Mvva 128,40,16
  v_xor_b32 v3, 0x10000, v3
  v_mul_f32 v33, s62, v209
 Mvva 132,60,4
 TR 56,3,49152
  v_mul_f32 v34, s62, v210
 Mvva 132,40,20
  v_rcp_f32 v29, v29
 Mvva 136,60,8
 TR 58,3,57344
  v_mul_f32 v193, v193, v29
 Mvva 136,40,24
 WL 2
  v_exp_f32 v30, v30
 Mvva 140,60,12
 TR 60,3,50176
  v_fma_f32 v30, v30, v21, v21
 Mvva 140,40,28
 WL 5
  v_rcp_f32 v30, v30
 Mvva 80,48,0
 TR 62,3,58368
  v_mul_f32 v194, v194, v30
 Mvva 80,52,16
  v_xor_b32 v4, 0x10000, v4
  v_mul_f32 v35, s62, v211
 Mvva 84,48,4
 TR 40,4,49152
  v_mul_f32 v28, s62, v196
 Mvva 84,52,20
  v_exp_f32 v31, v31
 Mvva 88,48,8
 TR 42,4,57344
  v_fma_f32 v31, v31, v21, v21
 Mvva 88,52,24
 WL 2
  v_rcp_f32 v31, v31
 Mvva 92,48,12
 TR 48,4,50176
  v_mul_f32 v195, v195, v31
 Mvva 92,52,28
 WL 5
  v_exp_f32 v32, v32
 Mvva 112,56,0
 TR 50,4,58368
  s_waitcnt vmcnt(14)
 Mvva 112,60,16
  s_barrier
  v_and_b32 v36, 15, v0
  v_lshrrev_b32 v37, 4, v0
 Mvva 116,56,4
 TR 52,1,51200
  s_add_u32 s48, s54, 4192384
 Mvva 116,60,20
  buffer_load_dwordx4 v7, s[32:35], s48 offen offset:2048 lds
 Mvva 120,56,8
 TR 54,1,59392
  s_add_u32 s48, s54, 4453504
 Mvva 120,60,24
  buffer_load_dwordx4 v7, s[32:35], s48 offen offset:3072 lds
 Mvva 124,56,12
 TR 56,1,52224
  v_lshlrev_b32 v37, 2, v37
 Mvva 124,60,28
  s_and_b32 s65, s3, 1
  s_lshl_b32 s65, s65, 4
  v_sub_u32 v36, v36, v37
 WL 5
 Mvva 176,40,0
 TR 58,1,60416
  v_add_u32 v36, s65, v36
 WL 4
 Mvva 176,48,16
  v_mov_b32 v37, 0xff800000
  v_cvt_pk_bf16_f32 v192, v192, v193
 Mvva 180,40,4
 TR 60,2,51200
  v_cvt_pk_bf16_f32 v193, v194, v195
 Mvva 180,48,20
  v_exp_f32 v33, v33
 Mvva 184,40,8
 TR 62,2,59392
  v_fma_f32 v32, v32, v21, v21
 Mvva 184,48,24
 WL 2
  v_rcp_f32 v32, v32
 Mvva 188,40,12
 TR 40,2,52224
  v_mul_f32 v208, v208, v32
 Mvva 188,48,28
 WL 5
  v_exp_f32 v34, v34
 Mvva 128,52,32
 TR 42,2,60416
  v_fma_f32 v33, v33, v21, v21
 Mvva 128,56,48
  v_rcp_f32 v33, v33
 Mvva 132,52,36
 TR 48,3,51200
  v_mul_f32 v209, v209, v33
 Mvva 132,56,52
  v_exp_f32 v35, v35
 Mvva 136,52,40
 TR 50,3,59392
  v_fma_f32 v34, v34, v21, v21
 Mvva 136,56,56
 WL 2
  v_rcp_f32 v34, v34
 Mvva 140,52,44
 TR 52,3,52224
  v_mul_f32 v210, v210, v34
 Mvva 140,56,60
 WL 5
  v_exp_f32 v28, v28
 Mvva 80,60,32
 TR 54,3,60416
  v_fma_f32 v35, v35, v21, v21
 Mvva 80,40,48
  v_rcp_f32 v35, v35
 Mvva 84,60,36
 TR 56,4,51200
  v_mul_f32 v211, v211, v35
 Mvva 84,40,52
  s_add_u32 s49, s59, 24576
  v_cvt_pk_bf16_f32 v194, v208, v209
  v_cvt_pk_bf16_f32 v195, v210, v211
 Mvva 88,60,40
 TR 58,4,59392
  v_fma_f32 v28, v28, v23, v23
 Mvva 88,40,56
  buffer_store_dwordx4 v[192:195], v16, s[20:23], s49 offen offset:0 sc1
 Mvva 92,60,44
 TR 60,4,52224
  v_mul_f32 v29, s62, v197
 Mvva 92,40,60
 WL 5
  v_rcp_f32 v28, v28
 Mvva 112,48,32
 TR 62,4,60416
  s_waitcnt vmcnt(14)
 WL 4
 Mvva 112,52,48
  s_barrier
  s_add_u32 m0, s50, 65536
  s_add_u32 s48, s69, 0
 Mvva 116,48,36
 TR 40,1,0
  v_mul_f32 v196, v196, v28
 Mvva 116,52,52
  buffer_load_dwordx4 v16, s[20:23], s48 offen offset:0 sc1 lds
 Mvva 120,48,40
 TR 42,1,8192
  v_mul_f32 v30, s62, v198
 Mvva 120,52,56
  buffer_load_dwordx4 v16, s[20:23], s48 offen offset:1024 sc1 lds
 Mvva 124,48,44
 TR 48,1,1024
  v_mul_f32 v31, s62, v199
 Mvva 124,52,60
  buffer_load_dwordx4 v16, s[20:23], s48 offen offset:2048 sc1 lds
 WL 5
 Mvva 176,56,32
 TR 50,1,9216
  v_mul_f32 v32, s62, v212
 WL 4
 Mvva 176,60,48
  buffer_load_dwordx4 v16, s[20:23], s48 offen offset:3072 sc1 lds
 Mvva 180,56,36
 TR 52,2,0
  s_add_u32 m0, s50, 81920
 Mvva 180,60,52
  s_add_u32 s48, s69, 16384
  v_exp_f32 v29, v29
 Mvva 184,56,40
 TR 54,2,8192
  v_fma_f32 v29, v29, v23, v23
 Mvva 184,60,56
  buffer_load_dwordx4 v16, s[20:23], s48 offen offset:0 sc1 lds
 Mvva 188,56,44
 TR 56,2,1024
  v_mul_f32 v33, s62, v213
 Mvva 188,60,60
  buffer_load_dwordx4 v16, s[20:23], s48 offen offset:1024 sc1 lds
 WL 5
 Mvva 128,40,64
 TR 58,2,9216
  v_mul_f32 v34, s62, v214
 WL 4
 Mvva 128,48,80
  buffer_load_dwordx4 v16, s[20:23], s48 offen offset:2048 sc1 lds
 Mvva 132,40,68
 TR 60,3,0
  v_mul_f32 v35, s62, v215
 Mvva 132,48,84
  buffer_load_dwordx4 v16, s[20:23], s48 offen offset:3072 sc1 lds
 Mvva 136,40,72
 TR 62,3,8192
  s_add_u32 m0, s50, 98304
 Mvva 136,48,88
  s_add_u32 s48, s69, 32768
  v_rcp_f32 v29, v29
 Mvva 140,40,76
 TR 40,3,1024
  v_mul_f32 v197, v197, v29
 Mvva 140,48,92
  buffer_load_dwordx4 v16, s[20:23], s48 offen offset:0 sc1 lds
 WL 5
 Mvva 80,52,64
 TR 42,3,9216
  v_mul_f32 v28, s62, v200
 WL 4
 Mvva 80,56,80
  buffer_load_dwordx4 v16, s[20:23], s48 offen offset:1024 sc1 lds
 Mvva 84,52,68
 TR 48,4,0
  v_mul_f32 v29, s62, v201
 Mvva 84,56,84
  buffer_load_dwordx4 v16, s[20:23], s48 offen offset:2048 sc1 lds
 Mvva 88,52,72
 TR 50,4,8192
  v_cvt_pk_bf16_f32 v144, v144, v145
 Mvva 88,56,88
  buffer_load_dwordx4 v16, s[20:23], s48 offen offset:3072 sc1 lds
 Mvva 92,52,76
 TR 52,4,1024
  s_add_u32 m0, s50, 114688
 Mvva 92,56,92
  s_add_u32 s48, s69, 49152
  v_exp_f32 v30, v30
 WL 5
 Mvva 112,60,64
 TR 54,4,9216
  s_waitcnt vmcnt(24)
 WL 4
 Mvva 112,40,80
  s_barrier
  v_exp_f32 v31, v31
 Mvva 116,60,68
 TR 56,1,2048
  v_fma_f32 v30, v30, v23, v23
 Mvva 116,40,84
  buffer_load_dwordx4 v16, s[20:23], s48 offen offset:0 sc1 lds
 Mvva 120,60,72
 TR 58,1,10240
  v_fma_f32 v31, v31, v23, v23
 Mvva 120,40,88
  buffer_load_dwordx4 v16, s[20:23], s48 offen offset:1024 sc1 lds
 Mvva 124,60,76
 TR 60,1,3072
  v_cvt_pk_bf16_f32 v145, v146, v147
 Mvva 124,40,92
  buffer_load_dwordx4 v16, s[20:23], s48 offen offset:2048 sc1 lds
 WL 5
 Mvva 176,48,64
 TR 62,1,11264
  v_cvt_pk_bf16_f32 v146, v96, v97
 WL 4
 Mvva 176,52,80
  buffer_load_dwordx4 v16, s[20:23], s48 offen offset:3072 sc1 lds
 Mvva 180,48,68
 TR 40,2,2048
  v_cvt_pk_bf16_f32 v147, v98, v99
 Mvva 180,52,84
  v_rcp_f32 v30, v30
 Mvva 184,48,72
 TR 42,2,10240
  v_mul_f32 v198, v198, v30
 Mvva 184,52,88
 WL 2
  v_rcp_f32 v31, v31
 Mvva 188,48,76
 TR 48,2,3072
  v_mul_f32 v199, v199, v31
 Mvva 188,52,92
 WL 5
  v_exp_f32 v32, v32
 Mvva 128,56,96
 TR 50,2,11264
  v_cvt_pk_bf16_f32 v196, v196, v197
 Mvva 128,60,112
  v_exp_f32 v33, v33
 Mvva 132,56,100
 TR 52,3,2048
  v_cvt_pk_bf16_f32 v197, v198, v199
 Mvva 132,60,116
  v_exp_f32 v34, v34
 Mvva 136,56,104
 TR 54,3,10240
  v_fma_f32 v32, v32, v23, v23
 Mvva 136,60,120
 WL 2
  v_rcp_f32 v32, v32
 Mvva 140,56,108
 TR 56,3,3072
  v_mul_f32 v212, v212, v32
 Mvva 140,60,124
 WL 5
  v_exp_f32 v35, v35
 Mvva 80,40,96
 TR 58,3,11264
  v_fma_f32 v33, v33, v23, v23
 Mvva 80,48,112
  v_rcp_f32 v33, v33
 Mvva 84,40,100
 TR 60,4,2048
  v_mul_f32 v213, v213, v33
 Mvva 84,48,116
  v_exp_f32 v28, v28
 Mvva 88,40,104
 TR 62,4,10240
  v_fma_f32 v34, v34, v23, v23
 Mvva 88,48,120
 WL 2
  v_rcp_f32 v34, v34
 Mvva 92,40,108
 TR 40,4,3072
  v_mul_f32 v214, v214, v34
 Mvva 92,48,124
 WL 5
  v_exp_f32 v29, v29
 Mvva 112,52,96
 TR 42,4,11264
  s_waitcnt vmcnt(25)
 Mvva 112,56,112
  s_barrier
  v_fma_f32 v35, v35, v23, v23
  v_fma_f32 v28, v28, v25, v25
 Mvva 116,52,100
 TR 48,1,16384
  v_fma_f32 v29, v29, v25, v25
 Mvva 116,56,116
  v_rcp_f32 v35, v35
 Mvva 120,52,104
 TR 50,1,24576
  v_mul_f32 v215, v215, v35
 Mvva 120,56,120
 WL 2
  v_rcp_f32 v28, v28
 Mvva 124,52,108
 TR 52,1,17408
  v_cvt_pk_bf16_f32 v198, v212, v213
 Mvva 124,56,124
 WL 5
  v_rcp_f32 v29, v29
 Mvva 176,60,96
 TR 54,1,25600
  v_cvt_pk_bf16_f32 v199, v214, v215
 Mvva 176,40,112
  s_add_u32 s49, s59, 24576
  v_mul_f32 v200, v200, v28
  v_mul_f32 v201, v201, v29
 Mvva 180,60,100
 TR 56,2,16384
  v_mul_f32 v30, s62, v202
 Mvva 180,40,116
  buffer_store_dwordx4 v[196:199], v16, s[20:23], s49 offen offset:2048 sc1
 Mvva 184,60,104
 TR 58,2,24576
  v_mul_f32 v31, s62, v203
 Mvva 184,40,120
 WL 2
  v_exp_f32 v30, v30
 Mvva 188,60,108
 TR 60,2,17408
  v_fma_f32 v30, v30, v25, v25
 Mvva 188,40,124
 WL 5
  v_rcp_f32 v30, v30
 Mvva 128,48,128
 TR 62,2,25600
  v_mul_f32 v202, v202, v30
 Mvva 128,52,144
  v_exp_f32 v31, v31
 Mvva 132,48,132
 TR 40,3,16384
  v_fma_f32 v31, v31, v25, v25
 Mvva 132,52,148
  v_rcp_f32 v31, v31
 Mvva 136,48,136
 TR 42,3,24576
  v_mul_f32 v203, v203, v31
 Mvva 136,52,152
 WL 2
  v_cvt_pk_bf16_f32 v200, v200, v201
  v_cvt_pk_bf16_f32 v201, v202, v203
 Mvva 140,48,140
 TR 48,3,17408
  v_mul_f32 v32, s62, v216
 Mvva 140,52,156
 WL 5
  v_exp_f32 v32, v32
 Mvva 80,56,128
 TR 50,3,25600
  v_fma_f32 v32, v32, v25, v25
 Mvva 80,60,144
  v_rcp_f32 v32, v32
 Mvva 84,56,132
 TR 52,4,16384
  v_mul_f32 v216, v216, v32
 Mvva 84,60,148
  v_mul_f32 v33, s62, v217
  v_mul_f32 v34, s62, v218
 Mvva 88,56,136
 TR 54,4,24576
  v_mul_f32 v35, s62, v219
 Mvva 88,60,152
 WL 2
  v_exp_f32 v33, v33
 Mvva 92,56,140
 TR 56,4,17408
  v_fma_f32 v33, v33, v25, v25
 Mvva 92,60,156
 WL 5
  v_rcp_f32 v33, v33
 Mvva 112,40,128
 TR 58,4,25600
  s_waitcnt vmcnt(23)
 Mvva 112,48,144
  s_barrier
  v_exp_f32 v34, v34
 Mvva 116,40,132
 TR 60,1,18432
  v_mul_f32 v217, v217, v33
 Mvva 116,48,148
  v_exp_f32 v35, v35
 Mvva 120,40,136
 TR 62,1,26624
  v_fma_f32 v34, v34, v25, v25
 Mvva 120,48,152
 WL 2
  v_rcp_f32 v34, v34
 Mvva 124,40,140
 TR 40,1,19456
  v_mul_f32 v218, v218, v34
 Mvva 124,48,156
 WL 5
  v_fma_f32 v35, v35, v25, v25
  v_mul_f32 v28, s62, v204
 Mvva 176,52,128
 TR 42,1,27648
  v_mul_f32 v29, s62, v205
 Mvva 176,56,144
  v_rcp_f32 v35, v35
 Mvva 180,52,132
 TR 48,2,18432
  v_mul_f32 v219, v219, v35
 Mvva 180,56,148
  v_exp_f32 v28, v28
 Mvva 184,52,136
 TR 50,2,26624
  v_cvt_pk_bf16_f32 v202, v216, v217
 Mvva 184,56,152
 WL 4
  v_exp_f32 v29, v29
 Mvva 188,52,140
 TR 52,2,19456
  v_cvt_pk_bf16_f32 v203, v218, v219
 Mvva 188,56,156
  s_add_u32 s49, s59, 24576
  v_fma_f32 v28, v28, v27, v27
  v_fma_f32 v29, v29, v27, v27
 Mvva 128,60,160
 TR 54,2,27648
  v_mul_f32 v30, s62, v206
 WL 4
 Mvva 128,40,176
  buffer_store_dwordx4 v[200:203], v17, s[20:23], s49 offen offset:0 sc1
 Mvva 132,60,164
 TR 56,3,18432
  v_mul_f32 v31, s62, v207
 Mvva 132,40,180
  v_rcp_f32 v28, v28
 Mvva 136,60,168
 TR 58,3,26624
  v_mul_f32 v204, v204, v28
 Mvva 136,40,184
 WL 2
  v_rcp_f32 v29, v29
 Mvva 140,60,172
 TR 60,3,19456
  v_mul_f32 v205, v205, v29
 Mvva 140,40,188
 WL 5
  v_exp_f32 v30, v30
 Mvva 80,48,160
 TR 62,3,27648
  v_fma_f32 v30, v30, v27, v27
 Mvva 80,52,176
  v_rcp_f32 v30, v30
 Mvva 84,48,164
 TR 40,4,18432
  v_mul_f32 v206, v206, v30
 Mvva 84,52,180
  v_exp_f32 v31, v31
 Mvva 88,48,168
 TR 42,4,26624
  v_fma_f32 v31, v31, v27, v27
 Mvva 88,52,184
 WL 2
  v_rcp_f32 v31, v31
 Mvva 92,48,172
 TR 48,4,19456
  v_mul_f32 v207, v207, v31
 Mvva 92,52,188
 WL 5
  v_cvt_pk_bf16_f32 v204, v204, v205
  v_cvt_pk_bf16_f32 v205, v206, v207
 Mvva 112,56,160
 TR 50,4,27648
  s_waitcnt vmcnt(21)
 Mvva 112,60,176
  s_barrier
  v_mul_f32 v32, s62, v220
  v_mul_f32 v33, s62, v221
 Mvva 116,56,164
 TR 52,1,32768
  v_mul_f32 v34, s62, v222
 Mvva 116,60,180
  v_exp_f32 v32, v32
 Mvva 120,56,168
 TR 54,1,40960
  v_fma_f32 v32, v32, v27, v27
 Mvva 120,60,184
 WL 2
  v_rcp_f32 v32, v32
 Mvva 124,56,172
 TR 56,1,33792
  v_mul_f32 v220, v220, v32
 Mvva 124,60,188
 WL 5
  v_exp_f32 v33, v33
 Mvva 176,40,160
 TR 58,1,41984
  v_fma_f32 v33, v33, v27, v27
 Mvva 176,48,176
  v_rcp_f32 v33, v33
 Mvva 180,40,164
 TR 60,2,32768
  v_mul_f32 v221, v221, v33
 Mvva 180,48,180
  v_exp_f32 v34, v34
 Mvva 184,40,168
 TR 62,2,40960
  v_fma_f32 v34, v34, v27, v27
 Mvva 184,48,184
 WL 2
  v_rcp_f32 v34, v34
 Mvva 188,40,172
 TR 40,2,33792
  v_mul_f32 v222, v222, v34
 Mvva 188,48,188
 WL 5
  v_mul_f32 v35, s62, v223
  v_cvt_pk_bf16_f32 v148, v148, v149
 Mvva 128,52,192
 TR 42,2,41984
  v_cvt_pk_bf16_f32 v149, v150, v151
 Mvva 128,56,208
  v_exp_f32 v35, v35
 Mvva 132,52,196
 TR 48,3,32768
  v_fma_f32 v35, v35, v27, v27
 Mvva 132,56,212
  v_rcp_f32 v35, v35
 Mvva 136,52,200
 TR 50,3,40960
  v_mul_f32 v223, v223, v35
 Mvva 136,56,216
  s_add_u32 s49, s59, 24576
  v_cvt_pk_bf16_f32 v206, v220, v221
  v_cvt_pk_bf16_f32 v207, v222, v223
 Mvva 140,52,204
 TR 52,3,33792
  v_cvt_pk_bf16_f32 v150, v100, v101
 Mvva 140,56,220
  buffer_store_dwordx4 v[204:207], v17, s[20:23], s49 offen offset:2048 sc1
 WL 5
 Mvva 80,60,192
 TR 54,3,41984
  v_cvt_pk_bf16_f32 v151, v102, v103
 WL 4
 Mvva 80,40,208
  v_cvt_pk_bf16_f32 v152, v152, v153
  v_cvt_pk_bf16_f32 v153, v154, v155
 Mvva 84,60,196
 TR 56,4,32768
  v_cvt_pk_bf16_f32 v154, v104, v105
 Mvva 84,40,212
  v_cvt_pk_bf16_f32 v155, v106, v107
  v_cvt_pk_bf16_f32 v156, v156, v157
 Mvva 88,60,200
 TR 58,4,40960
  v_cvt_pk_bf16_f32 v157, v158, v159
 Mvva 88,40,216
 WL 2
  v_cvt_pk_bf16_f32 v158, v108, v109
  v_cvt_pk_bf16_f32 v159, v110, v111
 Mvva 92,60,204
 TR 60,4,33792
  v_cvt_pk_bf16_f32 v160, v160, v161
 Mvva 92,40,220
 WL 5
  v_cvt_pk_bf16_f32 v161, v162, v163
  v_cvt_pk_bf16_f32 v162, v64, v65
 Mvva 112,48,192
 TR 62,4,41984
  s_waitcnt vmcnt(20)
 Mvva 112,52,208
  s_barrier
  v_cvt_pk_bf16_f32 v163, v66, v67
  v_cvt_pk_bf16_f32 v164, v164, v165
 Mvva 116,48,196
 TR 40,1,34816
  v_cvt_pk_bf16_f32 v165, v166, v167
 Mvva 116,52,212
  v_cvt_pk_bf16_f32 v166, v68, v69
  v_cvt_pk_bf16_f32 v167, v70, v71
 Mvva 120,48,200
 TR 42,1,43008
  v_cvt_pk_bf16_f32 v168, v168, v169
 Mvva 120,52,216
 WL 2
  v_cvt_pk_bf16_f32 v169, v170, v171
  v_cvt_pk_bf16_f32 v170, v72, v73
 Mvva 124,48,204
 TR 48,1,35840
  v_cvt_pk_bf16_f32 v171, v74, v75
 Mvva 124,52,220
 WL 5
  v_cvt_pk_bf16_f32 v172, v172, v173
  v_cvt_pk_bf16_f32 v173, v174, v175
 Mvva 176,56,192
 TR 50,1,44032
  v_cvt_pk_bf16_f32 v174, v76, v77
 Mvva 176,60,208
  v_cvt_pk_bf16_f32 v175, v78, v79
 Mvva 180,56,196
 TR 52,2,34816
 Mvva 180,60,212
 Mvva 184,56,200
 TR 54,2,43008
 Mvva 184,60,216
 Mvva 188,56,204
 TR 56,2,35840
 Mvva 188,60,220
 WL 5
 Mvva 128,40,224
 TR 58,2,44032
 WL 4
 Mvva 128,48,240
 Mvva 132,40,228
 TR 60,3,34816
 Mvva 132,48,244
 Mvva 136,40,232
 TR 62,3,43008
  s_waitcnt vmcnt(15)
 Mvva 136,48,248
  s_barrier
  ds_read_b128 a[144:147], v18 offset:8192
 Mvva 140,40,236
 TR 40,3,35840
 Mvva 140,48,252
  ds_read_b128 a[148:151], v18 offset:9216
 WL 7
 Mvva 80,52,224
 TR 42,3,44032
 WL 6
 Mvva 80,56,240
  ds_read_b128 a[152:155], v18 offset:10240
 Mvva 84,52,228
 TR 48,4,34816
 Mvva 84,56,244
  ds_read_b128 a[156:159], v18 offset:11264
 Mvva 88,52,232
 TR 50,4,43008
 Mvva 88,56,248
  ds_read_b128 a[160:163], v18 offset:12288
 Mvva 92,52,236
 TR 52,4,35840
 Mvva 92,56,252
  ds_read_b128 a[164:167], v18 offset:13312
 WL 11
 Mvva 112,60,224
 TR 54,4,44032
 WL 8
 Mvva 112,40,240
  v_cvt_pk_bf16_f32 v128, v128, v129
  v_cvt_pk_bf16_f32 v129, v130, v131
 Mvva 116,60,228
  v_cvt_pk_bf16_f32 v130, v80, v81
  v_cvt_pk_bf16_f32 v131, v82, v83
 Mvva 116,40,244
  v_cvt_pk_bf16_f32 v132, v132, v133
  v_cvt_pk_bf16_f32 v133, v134, v135
 Mvva 120,60,232
  v_cvt_pk_bf16_f32 v134, v84, v85
  v_cvt_pk_bf16_f32 v135, v86, v87
 Mvva 120,40,248
  v_cvt_pk_bf16_f32 v136, v136, v137
  v_cvt_pk_bf16_f32 v137, v138, v139
 Mvva 124,60,236
  v_cvt_pk_bf16_f32 v138, v88, v89
  v_cvt_pk_bf16_f32 v139, v90, v91
 Mvva 124,40,252
 WL 4
  v_cvt_pk_bf16_f32 v140, v140, v141
  v_cvt_pk_bf16_f32 v141, v142, v143
 Mvva 176,48,224
 WL 0
  v_cvt_pk_bf16_f32 v142, v92, v93
  v_cvt_pk_bf16_f32 v143, v94, v95
 Mvva 176,52,240
  ds_read_b128 a[168:171], v18 offset:14336
 Mvva 180,48,228
  ds_read_b128 a[172:175], v18 offset:15360
 Mvva 180,52,244
 Mvva 184,48,232
 Mvva 184,52,248
 Mvva 188,48,236
 Mvva 188,52,252
  v_cmp_le_i32 vcc, 0, v36
  s_nop 1
  v_cndmask_b32_e64 v240, v37, 0, vcc
  v_cmp_le_i32 vcc, 1, v36
  s_nop 1
  v_cndmask_b32_e64 v241, v37, 0, vcc
  v_cmp_le_i32 vcc, 2, v36
  s_nop 1
  v_cndmask_b32_e64 v242, v37, 0, vcc
  v_cmp_le_i32 vcc, 3, v36
  s_nop 1
  v_cndmask_b32_e64 v243, v37, 0, vcc
  v_cmp_le_i32 vcc, 16, v36
  s_nop 1
  v_cndmask_b32_e64 v244, v37, 0, vcc
  v_cmp_le_i32 vcc, 17, v36
  s_nop 1
  v_cndmask_b32_e64 v245, v37, 0, vcc
  v_cmp_le_i32 vcc, 18, v36
  s_nop 1
  v_cndmask_b32_e64 v246, v37, 0, vcc
  v_cmp_le_i32 vcc, 19, v36
  s_nop 1
  v_cndmask_b32_e64 v247, v37, 0, vcc
  v_mov_b32 v224, 0
  v_mov_b32 v225, 0
  v_mov_b32 v226, 0
  v_mov_b32 v227, 0
  v_mov_b32 v228, 0
  v_mov_b32 v229, 0
  v_mov_b32 v230, 0
  v_mov_b32 v231, 0
  v_mov_b32 v232, 0
  v_mov_b32 v233, 0
  v_mov_b32 v234, 0
  v_mov_b32 v235, 0
  v_mov_b32 v236, 0
  v_mov_b32 v237, 0
  v_mov_b32 v238, 0
  v_mov_b32 v239, 0
  v_mov_b32 v10, 0
  v_mov_b32 v11, 0
  v_mov_b32 v12, 0
  v_mov_b32 v13, 0
  v_mov_b32 v248, v240
  v_mov_b32 v249, v241
  v_mov_b32 v250, v242
  v_mov_b32 v251, v243
  v_mov_b32 v252, v244
  v_mov_b32 v253, v245
  v_mov_b32 v254, v246
  v_mov_b32 v255, v247
  v_cvt_pk_bf16_f32 v112, v112, v113
  v_cvt_pk_bf16_f32 v113, v114, v115
  v_cvt_pk_bf16_f32 v114, v176, v177
  v_cvt_pk_bf16_f32 v115, v178, v179
  v_cvt_pk_bf16_f32 v116, v116, v117
  v_cvt_pk_bf16_f32 v117, v118, v119
  v_cvt_pk_bf16_f32 v118, v180, v181
  v_cvt_pk_bf16_f32 v119, v182, v183
  v_cvt_pk_bf16_f32 v120, v120, v121
  v_cvt_pk_bf16_f32 v121, v122, v123
  v_cvt_pk_bf16_f32 v122, v184, v185
  v_cvt_pk_bf16_f32 v123, v186, v187
  v_cvt_pk_bf16_f32 v124, v124, v125
  v_cvt_pk_bf16_f32 v125, v126, v127
  v_cvt_pk_bf16_f32 v126, v188, v189
  v_cvt_pk_bf16_f32 v127, v190, v191
  s_cmp_lg_u32 s6, 0
  s_cbranch_scc1 Lpre
Lpre_back:
  s_cmp_ge_u32 s3, 2
  s_cbranch_scc1 LS
  v_mfma_f32_16x16x32_bf16 v[96:99], a[144:147], v[144:147], v[224:227]
  s_mov_b32 s69, 7
  v_lshlrev_b32 v29, 14, v0
  v_add_u32 v29, Lpre_back-Lpc0, v29
 Mvav 96,148,160
  s_lshl_b32 s54, s2, 8
  v_min_u32 v29, Lend-Lpc0-16388, v29
  v_lshl_add_u32 v40, v0, 8, s64
 Mvav 96,152,128
  global_load_dword a248, v29, s[100:101]
 Mvav 96,156,112
  s_add_u32 s54, s54, 0x4480000
  v_mov_b32 v43, 0
  v_mov_b32 v28, 0x3f803f80
  v_mfma_f32_16x16x32_bf16 v[100:103], a[156:159], v[116:119], v[228:231]
  s_mul_i32 s47, s3, 9472
  v_accvgpr_write_b32 a208, v28
  v_accvgpr_write_b32 a209, v28
 Mvav 100,152,132
 WL 0
  s_waitcnt vmcnt(12)
  s_barrier
 Mvav 100,148,164
  s_lshr_b32 s46, s4, 3
  v_accvgpr_write_b32 a210, v28
  v_accvgpr_write_b32 a211, v28
 Mvav 100,144,148
  ds_read_b128 a[212:215], v18 offset:24576
  v_mov_b32 v41, 1
  v_mfma_f32_16x16x32_bf16 v[104:107], a[144:147], v[152:155], v[232:235]
  s_add_u32 m0, s67, 0
  s_lshl_b32 s66, s5, 2
  v_add_u32 v47, 131072, v46
 Mvav 104,148,168
  ds_read_b128 a[216:219], v18 offset:25600
  s_lshl_b32 s45, s46, 15
 Mvav 104,152,136
  buffer_load_dwordx4 v16, s[20:23], s68 offen offset:0 sc1 lds
 Mvav 104,156,120
  ds_read_b128 a[220:223], v18 offset:26624
  s_sub_u32 s24, s58, s45
  v_mfma_f32_16x16x32_bf16 v[108:111], a[156:159], v[124:127], v[236:239]
  ds_write_b128 v47, v[144:147] offset:0
 Mvav 108,152,140
  ds_read_b128 a[224:227], v18 offset:27648
  s_lshl_b32 s46, s46, 8
 Mvav 108,148,172
  buffer_load_dwordx4 v16, s[20:23], s68 offen offset:1024 sc1 lds
 Mvav 108,144,156
  ds_read_b128 a[228:231], v18 offset:28672
  s_mul_i32 s44, s3, 36864
  v_mfma_f32_16x16x32_bf16 v[64:67], a[160:163], v[144:147], v[224:227]
  ds_write_b128 v47, v[160:163] offset:1024
 Mvav 64,164,160
  ds_read_b128 a[232:235], v18 offset:29696
  s_add_u32 s44, s44, s46
 Mvav 64,168,128
  buffer_load_dwordx4 v16, s[20:23], s68 offen offset:2048 sc1 lds
 Mvav 64,172,112
  ds_read_b128 a[236:239], v18 offset:30720
  s_and_b32 s46, s4, 7
  v_mfma_f32_16x16x32_bf16 v[68:71], a[172:175], v[116:119], v[228:231]
  s_mul_i32 s25, s46, 147456
  v_exp_f32 v96, v96
 Mvav 68,168,132
  ds_read_b128 a[240:243], v18 offset:31744
  s_add_u32 s25, s25, s44
 Mvav 68,164,164
  s_mul_i32 s45, s46, 49152
  v_exp_f32 v97, v97
 Mvav 68,160,148
  buffer_load_dwordx4 v16, s[20:23], s68 offen offset:3072 sc1 lds
  v_mfma_f32_16x16x32_bf16 v[72:75], a[160:163], v[152:155], v[232:235]
  s_add_u32 s68, s68, 4096
  v_exp_f32 v98, v98
 Mvav 72,164,168
  s_sub_u32 s45, s24, s45
  v_exp_f32 v99, v99
 Mvav 72,168,136
  s_sub_u32 s45, s45, 1179648
  v_exp_f32 v100, v100
 Mvav 72,172,120
  s_mul_i32 s46, s46, 368640
  v_exp_f32 v101, v101
  v_mfma_f32_16x16x32_bf16 v[76:79], a[172:175], v[124:127], v[236:239]
  s_add_u32 s44, s44, s46
  v_exp_f32 v102, v102
 Mvav 76,168,140
  s_sub_u32 s61, s5, 1
  v_exp_f32 v103, v103
 Mvav 76,164,172
  s_sub_u32 s60, s5, 2
  v_exp_f32 v104, v104
 Mvav 76,160,156
  s_mul_i32 s61, s61, s60
  v_exp_f32 v105, v105
 WL 9
  v_mfma_f32_16x16x32_bf16 v[192:195], a[212:215], v[144:147], v[224:227]
  ds_read_b128 a[176:179], v19 offset:16384
  s_add_u32 m0, s67, 4096
 WL 9
 Mvav 192,216,160
  buffer_load_dwordx4 v16, s[20:23], s68 offen offset:0 sc1 lds
 WL 8
 Mvav 192,220,128
  ds_read_b128 a[180:183], v19 offset:17408
  v_cvt_pk_bf16_f32 v80, v96, v97
 WL 7
 Mvav 192,224,112
  s_add_u32 s61, s61, s3
  v_exp_f32 v106, v106
  v_mfma_f32_16x16x32_bf16 v[196:199], a[224:227], v[116:119], v[228:231]
  ds_read_b128 a[184:187], v19 offset:18432
  v_cvt_pk_bf16_f32 v81, v98, v99
 Mvav 196,220,132
  s_mul_i32 s60, s4, 147456
  v_exp_f32 v107, v107
 Mvav 196,216,164
  ds_read_b128 a[188:191], v19 offset:19456
  v_cvt_pk_bf16_f32 v84, v100, v101
 Mvav 196,212,148
  buffer_load_dwordx4 v16, s[20:23], s68 offen offset:1024 sc1 lds
  v_mfma_f32_16x16x32_bf16 v[200:203], a[212:215], v[152:155], v[232:235]
  ds_read_b128 a[192:195], v19 offset:20480
  v_cvt_pk_bf16_f32 v85, v102, v103
 Mvav 200,216,168
  s_mul_i32 s59, s61, 3584
  v_exp_f32 v108, v108
 Mvav 200,220,136
  s_add_u32 s60, s60, s59
  v_exp_f32 v109, v109
 Mvav 200,224,120
  ds_read_b128 a[196:199], v19 offset:21504
  v_cvt_pk_bf16_f32 v88, v104, v105
  v_mfma_f32_16x16x32_bf16 v[204:207], a[224:227], v[124:127], v[236:239]
  s_lshl_b32 s61, s61, 2
  v_exp_f32 v110, v110
 Mvav 204,220,140
  ds_read_b128 a[200:203], v19 offset:22528
  v_cvt_pk_bf16_f32 v89, v106, v107
 Mvav 204,216,172
  buffer_load_dwordx4 v16, s[20:23], s68 offen offset:2048 sc1 lds
 Mvav 204,212,156
  ds_read_b128 a[204:207], v19 offset:23552
  v_cvt_pk_bf16_f32 v92, v108, v109
 WL 12
  v_mfma_f32_16x16x32_bf16 v[208:211], a[228:231], v[144:147], v[224:227]
  s_lshr_b32 s59, s4, 3
  v_exp_f32 v111, v111
 WL 10
 Mvav 208,232,160
  s_add_u32 s61, s61, s59
  v_exp_f32 v64, v64
 WL 9
 Mvav 208,236,128
  s_mul_i32 s61, s61, 3968
  v_exp_f32 v65, v65
 WL 8
 Mvav 208,240,112
  s_and_b32 s59, s4, 7
  v_exp_f32 v66, v66
  v_mfma_f32_16x16x32_bf16 v[212:215], a[240:243], v[116:119], v[228:231]
  s_mul_i32 s59, s59, 663552
  v_exp_f32 v67, v67
 Mvav 212,236,132
  buffer_load_dwordx4 v16, s[20:23], s68 offen offset:3072 sc1 lds
 Mvav 212,232,164
  s_add_u32 s68, s68, 12288
  v_exp_f32 v68, v68
 Mvav 212,228,148
  s_add_u32 s59, s59, s61
  v_exp_f32 v69, v69
  v_mfma_f32_16x16x32_bf16 v[216:219], a[228:231], v[152:155], v[232:235]
  s_sub_u32 s61, 9, s5
  v_exp_f32 v70, v70
 Mvav 216,232,168
  s_lshl_b32 s61, s61, 24
  v_exp_f32 v71, v71
 Mvav 216,236,136
  v_exp_f32 v72, v72
 Mvav 216,240,120
  v_exp_f32 v73, v73
  v_mfma_f32_16x16x32_bf16 v[220:223], a[240:243], v[124:127], v[236:239]
  v_exp_f32 v74, v74
 Mvav 220,236,140
  v_exp_f32 v75, v75
 Mvav 220,232,172
 WL 0
  s_waitcnt vmcnt(16)
  s_barrier
  v_cvt_pk_bf16_f32 v93, v110, v111
  v_cvt_pk_bf16_f32 v82, v64, v65
  v_cvt_pk_bf16_f32 v83, v66, v67
 Mvav 220,228,156
  ds_read_b128 a[144:147], v18 offset:40960
  v_cvt_pk_bf16_f32 v86, v68, v69
  v_cvt_pk_bf16_f32 v87, v70, v71
  v_mfma_f32_16x16x32_bf16 a[128:131], a[208:211], v[80:83], 0
  v_exp_f32 v76, v76
  v_exp_f32 v77, v77
  v_exp_f32 v78, v78
  v_exp_f32 v79, v79
  v_cvt_pk_bf16_f32 v90, v72, v73
  v_cvt_pk_bf16_f32 v91, v74, v75
  v_mfma_f32_16x16x32_bf16 a[132:135], a[208:211], v[84:87], 0
  ds_read_b128 a[148:151], v18 offset:41984
  v_cvt_pk_bf16_f32 v94, v76, v77
  v_cvt_pk_bf16_f32 v95, v78, v79
  v_mfma_f32_16x16x32_bf16 a[136:139], a[208:211], v[88:91], 0
  s_add_u32 m0, s67, 16384
  v_exp_f32 v192, v192
  v_mfma_f32_16x16x32_bf16 a[140:143], a[208:211], v[92:95], 0
  ds_read_b128 a[152:155], v18 offset:43008
  v_accvgpr_write_b32 a244, -1
  v_mfma_f32_16x16x32_bf16 a[12:15], a[176:179], v[92:95], 0
  buffer_load_dwordx4 v16, s[20:23], s68 offen offset:0 sc1 lds
  v_mfma_f32_16x16x32_bf16 a[8:11], a[176:179], v[88:91], 0
  ds_write_b128 v47, v[128:131] offset:2048
  v_mfma_f32_16x16x32_bf16 a[4:7], a[176:179], v[84:87], 0
  ds_read_b128 a[156:159], v18 offset:44032
  v_accvgpr_write_b32 a245, -1
  v_mfma_f32_16x16x32_bf16 a[0:3], a[176:179], v[80:83], 0
  v_exp_f32 v193, v193
  v_mfma_f32_16x16x32_bf16 a[16:19], a[180:183], v[80:83], 0
  ds_read_b128 a[160:163], v18 offset:45056
  v_cvt_pk_bf16_f32 v176, v192, v193
  v_mfma_f32_16x16x32_bf16 a[20:23], a[180:183], v[84:87], 0
  buffer_load_dwordx4 v16, s[20:23], s68 offen offset:1024 sc1 lds
  v_mfma_f32_16x16x32_bf16 a[24:27], a[180:183], v[88:91], 0
  ds_write_b128 v47, v[112:115] offset:3072
  v_mfma_f32_16x16x32_bf16 a[28:31], a[180:183], v[92:95], 0
  ds_read_b128 a[164:167], v18 offset:46080
  v_accvgpr_write_b32 a246, -1
  v_mfma_f32_16x16x32_bf16 a[44:47], a[184:187], v[92:95], 0
  ds_write_b128 v47, v[148:151] offset:4096
  v_mfma_f32_16x16x32_bf16 a[40:43], a[184:187], v[88:91], 0
  ds_read_b128 a[168:171], v18 offset:47104
  v_accvgpr_write_b32 a247, -1
  v_mfma_f32_16x16x32_bf16 a[36:39], a[184:187], v[84:87], 0
  v_exp_f32 v194, v194
  v_mfma_f32_16x16x32_bf16 a[32:35], a[184:187], v[80:83], 0
  ds_read_b128 a[172:175], v18 offset:48128
  v_lshrrev_b32 v38, 4, v0
  v_mfma_f32_16x16x32_bf16 a[48:51], a[188:191], v[80:83], 0
  buffer_load_dwordx4 v16, s[20:23], s68 offen offset:2048 sc1 lds
  v_mfma_f32_16x16x32_bf16 a[52:55], a[188:191], v[84:87], 0
  ds_write_b128 v47, v[164:167] offset:5120
  v_mfma_f32_16x16x32_bf16 a[56:59], a[188:191], v[88:91], 0
  v_exp_f32 v195, v195
  v_mfma_f32_16x16x32_bf16 a[60:63], a[188:191], v[92:95], 0
  v_exp_f32 v196, v196
  v_mfma_f32_16x16x32_bf16 a[76:79], a[192:195], v[92:95], 0
  ds_write_b128 v47, v[132:135] offset:6144
  v_mfma_f32_16x16x32_bf16 a[72:75], a[192:195], v[88:91], 0
  v_exp_f32 v197, v197
  v_mfma_f32_16x16x32_bf16 a[68:71], a[192:195], v[84:87], 0
  v_exp_f32 v198, v198
  v_mfma_f32_16x16x32_bf16 a[64:67], a[192:195], v[80:83], 0
  v_exp_f32 v199, v199
  v_mfma_f32_16x16x32_bf16 a[80:83], a[196:199], v[80:83], 0
  buffer_load_dwordx4 v16, s[20:23], s68 offen offset:3072 sc1 lds
  v_mfma_f32_16x16x32_bf16 a[84:87], a[196:199], v[84:87], 0
  ds_write_b128 v47, v[116:119] offset:7168
  v_mfma_f32_16x16x32_bf16 a[88:91], a[196:199], v[88:91], 0
  s_add_u32 s68, s68, 4096
  v_exp_f32 v200, v200
  v_mfma_f32_16x16x32_bf16 a[92:95], a[196:199], v[92:95], 0
  v_exp_f32 v201, v201
  v_mfma_f32_16x16x32_bf16 a[108:111], a[200:203], v[92:95], 0
  ds_write_b128 v47, v[152:155] offset:8192
  v_mfma_f32_16x16x32_bf16 a[104:107], a[200:203], v[88:91], 0
  v_exp_f32 v202, v202
  v_mfma_f32_16x16x32_bf16 a[100:103], a[200:203], v[84:87], 0
  v_exp_f32 v203, v203
  v_mfma_f32_16x16x32_bf16 a[96:99], a[200:203], v[80:83], 0
  v_exp_f32 v204, v204
  v_mfma_f32_16x16x32_bf16 a[112:115], a[204:207], v[80:83], 0
  ds_write_b128 v47, v[168:171] offset:9216
  v_mfma_f32_16x16x32_bf16 a[116:119], a[204:207], v[84:87], 0
  v_exp_f32 v205, v205
  v_mfma_f32_16x16x32_bf16 a[120:123], a[204:207], v[88:91], 0
 WL 13
  v_exp_f32 v206, v206
  v_mfma_f32_16x16x32_bf16 a[124:127], a[204:207], v[92:95], 0
 WL 14
  v_exp_f32 v207, v207
  v_mfma_f32_16x16x32_bf16 v[96:99], a[144:147], v[144:147], v[224:227]
  ds_read_b128 a[176:179], v19 offset:32768
  s_add_u32 m0, s67, 20480
 Mvav 96,148,160
  buffer_load_dwordx4 v16, s[20:23], s68 offen offset:0 sc1 lds
 Mvav 96,152,128
  ds_read_b128 a[180:183], v19 offset:33792
  v_cvt_pk_bf16_f32 v177, v194, v195
 WL 13
 Mvav 96,156,112
  ds_write_b128 v47, v[136:139] offset:10240
  v_mfma_f32_16x16x32_bf16 v[100:103], a[156:159], v[116:119], v[228:231]
  ds_read_b128 a[184:187], v19 offset:34816
  v_cvt_pk_bf16_f32 v180, v196, v197
 Mvav 100,152,132
  ds_write_b128 v47, v[120:123] offset:11264
 Mvav 100,148,164
  ds_read_b128 a[188:191], v19 offset:35840
  v_cvt_pk_bf16_f32 v181, v198, v199
 Mvav 100,144,148
  buffer_load_dwordx4 v16, s[20:23], s68 offen offset:1024 sc1 lds
  v_mfma_f32_16x16x32_bf16 v[104:107], a[144:147], v[152:155], v[232:235]
  ds_read_b128 a[192:195], v19 offset:36864
  v_cvt_pk_bf16_f32 v184, v200, v201
 Mvav 104,148,168
  ds_write_b128 v47, v[156:159] offset:12288
 Mvav 104,152,136
  v_exp_f32 v208, v208
 Mvav 104,156,120
  ds_read_b128 a[196:199], v19 offset:37888
  v_cvt_pk_bf16_f32 v185, v202, v203
  v_mfma_f32_16x16x32_bf16 v[108:111], a[156:159], v[124:127], v[236:239]
  ds_write_b128 v47, v[172:175] offset:13312
 Mvav 108,152,140
  ds_read_b128 a[200:203], v19 offset:38912
  v_cvt_pk_bf16_f32 v188, v204, v205
 Mvav 108,148,172
  buffer_load_dwordx4 v16, s[20:23], s68 offen offset:2048 sc1 lds
 Mvav 108,144,156
  ds_read_b128 a[204:207], v19 offset:39936
  v_cvt_pk_bf16_f32 v189, v206, v207
 WL 14
  v_mfma_f32_16x16x32_bf16 v[64:67], a[160:163], v[144:147], v[224:227]
  ds_write_b128 v47, v[140:143] offset:14336
 Mvav 64,164,160
  v_exp_f32 v209, v209
 Mvav 64,168,128
  v_exp_f32 v210, v210
 Mvav 64,172,112
  v_exp_f32 v211, v211
  v_mfma_f32_16x16x32_bf16 v[68:71], a[172:175], v[116:119], v[228:231]
  ds_write_b128 v47, v[124:127] offset:15360
 Mvav 68,168,132
  buffer_load_dwordx4 v16, s[20:23], s68 offen offset:3072 sc1 lds
 Mvav 68,164,164
  s_add_u32 s68, s68, 12288
  v_exp_f32 v212, v212
 Mvav 68,160,148
  v_exp_f32 v213, v213
  v_mfma_f32_16x16x32_bf16 v[72:75], a[160:163], v[152:155], v[232:235]
  v_exp_f32 v214, v214
 Mvav 72,164,168
  v_exp_f32 v215, v215
 Mvav 72,168,136
  v_exp_f32 v216, v216
 Mvav 72,172,120
  v_exp_f32 v217, v217
  v_mfma_f32_16x16x32_bf16 v[76:79], a[172:175], v[124:127], v[236:239]
  v_exp_f32 v218, v218
 Mvav 76,168,140
  v_exp_f32 v219, v219
 Mvav 76,164,172
 WL 0
  s_waitcnt vmcnt(20)
  s_barrier
  v_cvt_pk_bf16_f32 v178, v208, v209
  v_cvt_pk_bf16_f32 v179, v210, v211
 Mvav 76,160,156
  ds_read_b128 a[144:147], v18 offset:57344
  v_cvt_pk_bf16_f32 v182, v212, v213
  v_cvt_pk_bf16_f32 v183, v214, v215
 Maav 128,208,176
  v_exp_f32 v220, v220
  v_exp_f32 v221, v221
  v_exp_f32 v222, v222
  v_exp_f32 v223, v223
  v_cvt_pk_bf16_f32 v186, v216, v217
  v_cvt_pk_bf16_f32 v187, v218, v219
 Maav 132,208,180
  ds_read_b128 a[148:151], v18 offset:58368
  v_cvt_pk_bf16_f32 v190, v220, v221
  v_cvt_pk_bf16_f32 v191, v222, v223
 Maav 136,208,184
  s_add_u32 m0, s67, 32768
  v_exp_f32 v96, v96
 Maav 140,208,188
  ds_read_b128 a[152:155], v18 offset:59392
  v_mul_u32_u24 v38, 8960, v38
 Maav 12,176,188
  buffer_load_dwordx4 v16, s[20:23], s68 offen offset:0 sc1 lds
 Maav 8,176,184
  v_exp_f32 v97, v97
 Maav 4,176,180
  ds_read_b128 a[156:159], v18 offset:60416
  v_cvt_pk_bf16_f32 v80, v96, v97
 Maav 0,176,176
  v_exp_f32 v98, v98
 Maav 16,180,176
  ds_read_b128 a[160:163], v18 offset:61440
  v_add_u32 v1, v38, v16
 Maav 20,180,180
  buffer_load_dwordx4 v16, s[20:23], s68 offen offset:1024 sc1 lds
 Maav 24,180,184
  v_exp_f32 v99, v99
 Maav 28,180,188
  ds_read_b128 a[164:167], v18 offset:62464
  v_cvt_pk_bf16_f32 v81, v98, v99
 Maav 44,184,188
  v_exp_f32 v100, v100
 Maav 40,184,184
  ds_read_b128 a[168:171], v18 offset:63488
  v_add_u32 v2, 96, v1
 Maav 36,184,180
  v_exp_f32 v101, v101
 Maav 32,184,176
  ds_read_b128 a[172:175], v18 offset:64512
  v_cvt_pk_bf16_f32 v84, v100, v101
 Maav 48,188,176
  buffer_load_dwordx4 v16, s[20:23], s68 offen offset:2048 sc1 lds
 Maav 52,188,180
  v_exp_f32 v102, v102
 Maav 56,188,184
  v_exp_f32 v103, v103
 Maav 60,188,188
  v_exp_f32 v104, v104
 Maav 76,192,188
  v_exp_f32 v105, v105
 Maav 72,192,184
  v_exp_f32 v106, v106
 Maav 68,192,180
  v_exp_f32 v107, v107
 Maav 64,192,176
  v_exp_f32 v108, v108
 Maav 80,196,176
  buffer_load_dwordx4 v16, s[20:23], s68 offen offset:3072 sc1 lds
 Maav 84,196,180
  s_add_u32 s68, s68, 4096
  v_exp_f32 v109, v109
 Maav 88,196,184
  v_exp_f32 v110, v110
 Maav 92,196,188
  v_exp_f32 v111, v111
 Maav 108,200,188
  v_exp_f32 v64, v64
 Maav 104,200,184
  v_exp_f32 v65, v65
 Maav 100,200,180
  v_exp_f32 v66, v66
 Maav 96,200,176
  v_exp_f32 v67, v67
 Maav 112,204,176
  v_exp_f32 v68, v68
 Maav 116,204,180
  v_exp_f32 v69, v69
 Maav 120,204,184
 WL 6
  v_exp_f32 v70, v70
 Maav 124,204,188
 WL 7
  v_exp_f32 v71, v71
  v_mfma_f32_16x16x32_bf16 v[192:195], a[144:147], v[144:147], v[224:227]
  ds_read_b128 a[176:179], v19 offset:49152
  s_add_u32 m0, s67, 36864
 Mvav 192,148,160
  buffer_load_dwordx4 v16, s[20:23], s68 offen offset:0 sc1 lds
 WL 6
 Mvav 192,152,128
  ds_read_b128 a[180:183], v19 offset:50176
  v_cvt_pk_bf16_f32 v85, v102, v103
 WL 6
 Mvav 192,156,112
  v_exp_f32 v72, v72
  v_mfma_f32_16x16x32_bf16 v[196:199], a[156:159], v[116:119], v[228:231]
  ds_read_b128 a[184:187], v19 offset:51200
  v_cvt_pk_bf16_f32 v88, v104, v105
 Mvav 196,152,132
  v_exp_f32 v73, v73
 Mvav 196,148,164
  ds_read_b128 a[188:191], v19 offset:52224
  v_cvt_pk_bf16_f32 v89, v106, v107
 Mvav 196,144,148
  buffer_load_dwordx4 v16, s[20:23], s68 offen offset:1024 sc1 lds
  v_mfma_f32_16x16x32_bf16 v[200:203], a[144:147], v[152:155], v[232:235]
  ds_read_b128 a[192:195], v19 offset:53248
  v_cvt_pk_bf16_f32 v92, v108, v109
 Mvav 200,148,168
  v_exp_f32 v74, v74
 Mvav 200,152,136
  v_exp_f32 v75, v75
 Mvav 200,156,120
  ds_read_b128 a[196:199], v19 offset:54272
  v_cvt_pk_bf16_f32 v93, v110, v111
  v_mfma_f32_16x16x32_bf16 v[204:207], a[156:159], v[124:127], v[236:239]
 WL 9
  v_exp_f32 v76, v76
 Mvav 204,152,140
  ds_read_b128 a[200:203], v19 offset:55296
  v_cvt_pk_bf16_f32 v82, v64, v65
 Mvav 204,148,172
  buffer_load_dwordx4 v16, s[20:23], s68 offen offset:2048 sc1 lds
 Mvav 204,144,156
  ds_read_b128 a[204:207], v19 offset:56320
  v_cvt_pk_bf16_f32 v83, v66, v67
  v_mfma_f32_16x16x32_bf16 v[208:211], a[160:163], v[144:147], v[224:227]
 WL 10
  v_exp_f32 v77, v77
 Mvav 208,164,160
 WL 9
  v_exp_f32 v78, v78
 Mvav 208,168,128
 WL 8
  v_exp_f32 v79, v79
 Mvav 208,172,112
  v_exp_f32 v192, v192
  v_mfma_f32_16x16x32_bf16 v[212:215], a[172:175], v[116:119], v[228:231]
  v_exp_f32 v193, v193
 Mvav 212,168,132
  buffer_load_dwordx4 v16, s[20:23], s68 offen offset:3072 sc1 lds
 Mvav 212,164,164
  s_add_u32 s68, s68, 12288
  v_exp_f32 v194, v194
 Mvav 212,160,148
  v_exp_f32 v195, v195
  v_mfma_f32_16x16x32_bf16 v[216:219], a[160:163], v[152:155], v[232:235]
  v_exp_f32 v196, v196
 Mvav 216,164,168
  v_exp_f32 v197, v197
 Mvav 216,168,136
  v_exp_f32 v198, v198
 Mvav 216,172,120
  v_exp_f32 v199, v199
  v_mfma_f32_16x16x32_bf16 v[220:223], a[172:175], v[124:127], v[236:239]
  v_exp_f32 v200, v200
 Mvav 220,168,140
  v_exp_f32 v201, v201
 Mvav 220,164,172
  s_waitcnt vmcnt(25) lgkmcnt(0)
  s_waitcnt vmcnt(16)
  s_barrier
 Mvav 220,160,156
  ds_read_b128 a[144:147], v18 offset:8192
  v_cvt_pk_bf16_f32 v86, v68, v69
  v_cvt_pk_bf16_f32 v87, v70, v71
 Maav 128,208,80
  s_add_u32 m0, s67, 49152
  v_cvt_pk_bf16_f32 v90, v72, v73
  v_cvt_pk_bf16_f32 v91, v74, v75
 Maav 132,208,84
  ds_read_b128 a[148:151], v18 offset:9216
  v_cvt_pk_bf16_f32 v94, v76, v77
  v_cvt_pk_bf16_f32 v95, v78, v79
 Maav 136,208,88
  buffer_load_dwordx4 v16, s[20:23], s68 offen offset:0 sc1 lds
 Maav 140,208,92
  ds_read_b128 a[152:155], v18 offset:10240
  v_cvt_pk_bf16_f32 v176, v192, v193
 Maav 12,176,92
  buffer_atomic_add v41, v40, s[36:39], s66 offen sc1
 Maav 8,176,88
  v_exp_f32 v202, v202
 Maav 4,176,84
  ds_read_b128 a[156:159], v18 offset:11264
  v_cvt_pk_bf16_f32 v177, v194, v195
 Maav 0,176,80
  v_exp_f32 v203, v203
 Maav 16,180,80
  ds_read_b128 a[160:163], v18 offset:12288
  v_cvt_pk_bf16_f32 v180, v196, v197
 Maav 20,180,84
  buffer_load_dwordx4 v16, s[20:23], s68 offen offset:1024 sc1 lds
 Maav 24,180,88
  v_exp_f32 v204, v204
 Maav 28,180,92
  ds_read_b128 a[164:167], v18 offset:13312
  v_cvt_pk_bf16_f32 v181, v198, v199
 Maav 44,184,92
  v_exp_f32 v205, v205
 Maav 40,184,88
  ds_read_b128 a[168:171], v18 offset:14336
  v_cvt_pk_bf16_f32 v184, v200, v201
 Maav 36,184,84
  v_exp_f32 v206, v206
 Maav 32,184,80
  ds_read_b128 a[172:175], v18 offset:15360
  v_cvt_pk_bf16_f32 v185, v202, v203
 Maav 48,188,80
  buffer_load_dwordx4 v16, s[20:23], s68 offen offset:2048 sc1 lds
 Maav 52,188,84
  v_exp_f32 v207, v207
 Maav 56,188,88
  v_exp_f32 v208, v208
 Maav 60,188,92
  v_exp_f32 v209, v209
 Maav 76,192,92
  v_exp_f32 v210, v210
 Maav 72,192,88
  v_exp_f32 v211, v211
 Maav 68,192,84
  v_cvt_pk_bf16_f32 v188, v204, v205
  v_cvt_pk_bf16_f32 v189, v206, v207
 Maav 64,192,80
  v_cvt_pk_bf16_f32 v178, v208, v209
  v_cvt_pk_bf16_f32 v179, v210, v211
 Maav 80,196,80
  buffer_load_dwordx4 v16, s[20:23], s68 offen offset:3072 sc1 lds
 Maav 84,196,84
  s_add_u32 s68, s68, 4096
  v_add_u32 v3, 192, v1
  v_add_u32 v4, 288, v1
 Maav 88,196,88
  v_add_u32 v5, 4608, v1
  v_add_u32 v6, 4704, v1
 Maav 92,196,92
  s_lshr_b32 s46, s4, 3
  v_add_u32 v7, 4800, v1
  v_add_u32 v8, 4896, v1
 Maav 108,200,92
  s_mul_i32 s46, s46, 768
  s_add_u32 s46, s46, 0x6000000
  v_add_u32 v9, s46, v16
 Maav 104,200,88
  v_bfe_u32 v38, v0, 2, 3
  v_lshlrev_b32 v38, 10, v38
 Maav 100,200,84
  v_lshl_add_u32 v38, v0, 3, v38
  v_add_u32 v32, 12288, v38
 Maav 96,200,80
  v_add_u32 v33, 125952, v38
  v_add_u32 v34, 50176, v38
 Maav 112,204,80
  v_add_u32 v35, 88064, v38
  v_min_u32 v30, 30, v0
 Maav 116,204,84
  v_lshlrev_b32 v30, 7, v30
 Maav 120,204,88
 Maav 124,204,92
LloopD:
 WL 7
  v_mfma_f32_16x16x32_bf16 v[96:99], a[144:147], v[144:147], v[224:227]
  ds_read_b128 a[176:179], v19 offset:0
  s_add_u32 m0, s67, 53248
 WL 7
 Mvav 96,148,160
  buffer_load_dwordx4 v16, s[20:23], s68 offen offset:0 sc1 lds
 WL 6
 Mvav 96,152,128
  ds_read_b128 a[180:183], v19 offset:1024
  s_sub_u32 s69, s69, 1
 WL 6
 Mvav 96,156,112
  s_and_b32 s62, s61, 0xf8000000
  v_exp_f32 v212, v212
  v_mfma_f32_16x16x32_bf16 v[100:103], a[156:159], v[116:119], v[228:231]
  ds_read_b128 a[184:187], v19 offset:2048
  v_or_b32 v30, s62, v30
 Mvav 100,152,132
  s_add_u32 s61, s61, 0x1000000
  v_exp_f32 v213, v213
 Mvav 100,148,164
  ds_read_b128 a[188:191], v19 offset:3072
  v_cvt_pk_bf16_f32 v182, v212, v213
 Mvav 100,144,148
  buffer_load_dwordx4 v16, s[20:23], s68 offen offset:1024 sc1 lds
  v_mfma_f32_16x16x32_bf16 v[104:107], a[144:147], v[152:155], v[232:235]
  ds_read_b128 a[192:195], v19 offset:4096
 Mvav 104,148,168
  buffer_load_dword a248, v30, s[12:15], s59 offen
 Mvav 104,152,136
  buffer_load_dword a248, v30, s[40:43], s60 offen
 Mvav 104,156,120
  ds_read_b128 a[196:199], v19 offset:5120
  s_add_u32 s59, s59, 31744
  v_mfma_f32_16x16x32_bf16 v[108:111], a[156:159], v[124:127], v[236:239]
  s_add_u32 s60, s60, 7168
  v_exp_f32 v214, v214
 Mvav 108,152,140
  ds_read_b128 a[200:203], v19 offset:6144
 Mvav 108,148,172
  buffer_load_dwordx4 v16, s[20:23], s68 offen offset:2048 sc1 lds
 Mvav 108,144,156
  ds_read_b128 a[204:207], v19 offset:7168
 WL 11
  v_mfma_f32_16x16x32_bf16 v[64:67], a[160:163], v[144:147], v[224:227]
 WL 10
  v_exp_f32 v215, v215
 Mvav 64,164,160
 WL 9
  v_exp_f32 v216, v216
 Mvav 64,168,128
 WL 8
  v_exp_f32 v217, v217
 Mvav 64,172,112
  v_exp_f32 v218, v218
  v_mfma_f32_16x16x32_bf16 v[68:71], a[172:175], v[116:119], v[228:231]
  v_exp_f32 v219, v219
 Mvav 68,168,132
  buffer_load_dwordx4 v16, s[20:23], s68 offen offset:3072 sc1 lds
 Mvav 68,164,164
  s_add_u32 s68, s68, 12288
  v_exp_f32 v220, v220
 Mvav 68,160,148
  v_exp_f32 v221, v221
  v_mfma_f32_16x16x32_bf16 v[72:75], a[160:163], v[152:155], v[232:235]
  v_exp_f32 v222, v222
 Mvav 72,164,168
  v_exp_f32 v223, v223
 Mvav 72,168,136
  v_exp_f32 v96, v96
 Mvav 72,172,120
  v_exp_f32 v97, v97
  v_mfma_f32_16x16x32_bf16 v[76:79], a[172:175], v[124:127], v[236:239]
  v_exp_f32 v98, v98
 Mvav 76,168,140
  v_exp_f32 v99, v99
 Mvav 76,164,172
 WL 0
  s_waitcnt vmcnt(19)
  s_barrier
 Mvav 76,160,156
  ds_read_b128 a[144:147], v18 offset:24576
  v_cvt_pk_bf16_f32 v183, v214, v215
 Maav 128,208,176
  s_add_u32 m0, s67, 0
  v_cvt_pk_bf16_f32 v186, v216, v217
  v_cvt_pk_bf16_f32 v187, v218, v219
 Maav 132,208,180
  ds_read_b128 a[148:151], v18 offset:25600
  v_cvt_pk_bf16_f32 v190, v220, v221
  v_cvt_pk_bf16_f32 v191, v222, v223
 Maav 136,208,184
  buffer_load_dwordx4 v16, s[20:23], s68 offen offset:0 sc1 lds
 Maav 140,208,188
  ds_read_b128 a[152:155], v18 offset:26624
  v_cvt_pk_bf16_f32 v80, v96, v97
 Maav 12,176,188
  v_exp_f32 v100, v100
 Maav 8,176,184
  v_exp_f32 v101, v101
 Maav 4,176,180
  ds_read_b128 a[156:159], v18 offset:27648
  v_cvt_pk_bf16_f32 v81, v98, v99
 Maav 0,176,176
  v_exp_f32 v102, v102
 Maav 16,180,176
  ds_read_b128 a[160:163], v18 offset:28672
  v_cvt_pk_bf16_f32 v84, v100, v101
 Maav 20,180,180
  buffer_load_dwordx4 v16, s[20:23], s68 offen offset:1024 sc1 lds
 Maav 24,180,184
  buffer_store_dwordx4 a[244:247], v15, s[8:11], 0 offen offset:0 sc1
 Maav 28,180,188
  ds_read_b128 a[164:167], v18 offset:29696
 Maav 44,184,188
  v_exp_f32 v103, v103
 Maav 40,184,184
  ds_read_b128 a[168:171], v18 offset:30720
  v_cvt_pk_bf16_f32 v85, v102, v103
 Maav 36,184,180
  v_exp_f32 v104, v104
 Maav 32,184,176
  ds_read_b128 a[172:175], v18 offset:31744
 Maav 48,188,176
  buffer_load_dwordx4 v16, s[20:23], s68 offen offset:2048 sc1 lds
 Maav 52,188,180
  v_exp_f32 v105, v105
 Maav 56,188,184
  v_exp_f32 v106, v106
 Maav 60,188,188
  v_exp_f32 v107, v107
 Maav 76,192,188
  v_exp_f32 v108, v108
 Maav 72,192,184
  v_exp_f32 v109, v109
 Maav 68,192,180
  v_exp_f32 v110, v110
 Maav 64,192,176
  v_exp_f32 v111, v111
 Maav 80,196,176
  buffer_load_dwordx4 v16, s[20:23], s68 offen offset:3072 sc1 lds
 Maav 84,196,180
  s_add_u32 s68, s68, 4096
  v_exp_f32 v64, v64
 Maav 88,196,184
  v_exp_f32 v65, v65
 Maav 92,196,188
  v_exp_f32 v66, v66
 Maav 108,200,188
  v_exp_f32 v67, v67
 Maav 104,200,184
  v_exp_f32 v68, v68
 Maav 100,200,180
  v_exp_f32 v69, v69
 Maav 96,200,176
  v_exp_f32 v70, v70
 Maav 112,204,176
  v_exp_f32 v71, v71
 Maav 116,204,180
  v_exp_f32 v72, v72
 Maav 120,204,184
 WL 6
  v_exp_f32 v73, v73
 Maav 124,204,188
 WL 7
  v_exp_f32 v74, v74
  v_mfma_f32_16x16x32_bf16 v[192:195], a[144:147], v[144:147], v[224:227]
  ds_read_b128 a[176:179], v19 offset:16384
  s_add_u32 m0, s67, 4096
 Mvav 192,148,160
  buffer_load_dwordx4 v16, s[20:23], s68 offen offset:0 sc1 lds
 WL 6
 Mvav 192,152,128
  ds_read_b128 a[180:183], v19 offset:17408
  v_cvt_pk_bf16_f32 v88, v104, v105
 WL 6
 Mvav 192,156,112
  v_exp_f32 v75, v75
  v_mfma_f32_16x16x32_bf16 v[196:199], a[156:159], v[116:119], v[228:231]
  ds_read_b128 a[184:187], v19 offset:18432
  v_cvt_pk_bf16_f32 v89, v106, v107
 Mvav 196,152,132
  v_exp_f32 v76, v76
 Mvav 196,148,164
  ds_read_b128 a[188:191], v19 offset:19456
  v_cvt_pk_bf16_f32 v92, v108, v109
 Mvav 196,144,148
  buffer_load_dwordx4 v16, s[20:23], s68 offen offset:1024 sc1 lds
  v_mfma_f32_16x16x32_bf16 v[200:203], a[144:147], v[152:155], v[232:235]
  ds_read_b128 a[192:195], v19 offset:20480
  v_cvt_pk_bf16_f32 v93, v110, v111
 Mvav 200,148,168
  v_exp_f32 v77, v77
 Mvav 200,152,136
  v_exp_f32 v78, v78
 Mvav 200,156,120
  ds_read_b128 a[196:199], v19 offset:21504
  v_cvt_pk_bf16_f32 v82, v64, v65
  v_mfma_f32_16x16x32_bf16 v[204:207], a[156:159], v[124:127], v[236:239]
 WL 9
  v_exp_f32 v79, v79
 Mvav 204,152,140
  ds_read_b128 a[200:203], v19 offset:22528
  v_cvt_pk_bf16_f32 v83, v66, v67
 Mvav 204,148,172
  buffer_load_dwordx4 v16, s[20:23], s68 offen offset:2048 sc1 lds
 Mvav 204,144,156
  ds_read_b128 a[204:207], v19 offset:23552
  v_cvt_pk_bf16_f32 v86, v68, v69
  v_mfma_f32_16x16x32_bf16 v[208:211], a[160:163], v[144:147], v[224:227]
 WL 10
  v_exp_f32 v192, v192
 Mvav 208,164,160
 WL 9
  v_exp_f32 v193, v193
 Mvav 208,168,128
 WL 8
  v_exp_f32 v194, v194
 Mvav 208,172,112
  v_exp_f32 v195, v195
  v_mfma_f32_16x16x32_bf16 v[212:215], a[172:175], v[116:119], v[228:231]
  v_exp_f32 v196, v196
 Mvav 212,168,132
  buffer_load_dwordx4 v16, s[20:23], s68 offen offset:3072 sc1 lds
 Mvav 212,164,164
  s_add_u32 s68, s68, 12288
  v_exp_f32 v197, v197
 Mvav 212,160,148
  v_exp_f32 v198, v198
  v_mfma_f32_16x16x32_bf16 v[216:219], a[160:163], v[152:155], v[232:235]
  v_exp_f32 v199, v199
 Mvav 216,164,168
  v_exp_f32 v200, v200
 Mvav 216,168,136
  v_exp_f32 v201, v201
 Mvav 216,172,120
  v_exp_f32 v202, v202
  v_mfma_f32_16x16x32_bf16 v[220:223], a[172:175], v[124:127], v[236:239]
  v_exp_f32 v203, v203
 Mvav 220,168,140
  v_exp_f32 v204, v204
 Mvav 220,164,172
 WL 0
  s_waitcnt vmcnt(20)
  s_barrier
 Mvav 220,160,156
  ds_read_b128 a[144:147], v18 offset:40960
  v_cvt_pk_bf16_f32 v87, v70, v71
 Maav 128,208,80
  s_add_u32 m0, s67, 16384
  v_cvt_pk_bf16_f32 v90, v72, v73
  v_cvt_pk_bf16_f32 v91, v74, v75
 Maav 132,208,84
  ds_read_b128 a[148:151], v18 offset:41984
  v_cvt_pk_bf16_f32 v94, v76, v77
  v_cvt_pk_bf16_f32 v95, v78, v79
 Maav 136,208,88
  buffer_load_dwordx4 v16, s[20:23], s68 offen offset:0 sc1 lds
 Maav 140,208,92
  ds_read_b128 a[152:155], v18 offset:43008
  v_cvt_pk_bf16_f32 v176, v192, v193
 Maav 12,176,92
  v_exp_f32 v205, v205
 Maav 8,176,88
  v_exp_f32 v206, v206
 Maav 4,176,84
  ds_read_b128 a[156:159], v18 offset:44032
  v_cvt_pk_bf16_f32 v177, v194, v195
 Maav 0,176,80
  v_exp_f32 v207, v207
 Maav 16,180,80
  ds_read_b128 a[160:163], v18 offset:45056
  v_cvt_pk_bf16_f32 v180, v196, v197
 Maav 20,180,84
  buffer_load_dwordx4 v16, s[20:23], s68 offen offset:1024 sc1 lds
 Maav 24,180,88
  buffer_store_dwordx4 a[244:247], v15, s[8:11], 0 offen offset:1024 sc1
 Maav 28,180,92
  ds_read_b128 a[164:167], v18 offset:46080
  v_cvt_pk_bf16_f32 v181, v198, v199
 Maav 44,184,92
  v_exp_f32 v208, v208
 Maav 40,184,88
  ds_read_b128 a[168:171], v18 offset:47104
  v_cvt_pk_bf16_f32 v184, v200, v201
 Maav 36,184,84
  v_exp_f32 v209, v209
 Maav 32,184,80
  ds_read_b128 a[172:175], v18 offset:48128
  v_cvt_pk_bf16_f32 v185, v202, v203
 Maav 48,188,80
  buffer_load_dwordx4 v16, s[20:23], s68 offen offset:2048 sc1 lds
 Maav 52,188,84
  v_exp_f32 v210, v210
 Maav 56,188,88
  v_exp_f32 v211, v211
 Maav 60,188,92
  v_exp_f32 v212, v212
 Maav 76,192,92
  global_load_dword a248, v29, s[100:101]
 Maav 72,192,88
  v_exp_f32 v213, v213
 Maav 68,192,84
  v_exp_f32 v214, v214
 Maav 64,192,80
  v_exp_f32 v215, v215
 Maav 80,196,80
  buffer_load_dwordx4 v16, s[20:23], s68 offen offset:3072 sc1 lds
 Maav 84,196,84
  s_add_u32 s68, s68, 4096
  v_exp_f32 v216, v216
 Maav 88,196,88
  v_exp_f32 v217, v217
 Maav 92,196,92
  v_exp_f32 v218, v218
 Maav 108,200,92
  v_exp_f32 v219, v219
 Maav 104,200,88
  v_exp_f32 v220, v220
 Maav 100,200,84
  v_exp_f32 v221, v221
 Maav 96,200,80
  v_exp_f32 v222, v222
 Maav 112,204,80
  v_exp_f32 v223, v223
 Maav 116,204,84
  v_cvt_pk_bf16_f32 v188, v204, v205
  v_cvt_pk_bf16_f32 v189, v206, v207
 Maav 120,204,88
 WL 6
  v_cvt_pk_bf16_f32 v178, v208, v209
  v_cvt_pk_bf16_f32 v179, v210, v211
 Maav 124,204,92
 WL 7
  v_cvt_pk_bf16_f32 v182, v212, v213
  v_cvt_pk_bf16_f32 v183, v214, v215
  v_mfma_f32_16x16x32_bf16 v[96:99], a[144:147], v[144:147], v[224:227]
  ds_read_b128 a[176:179], v19 offset:32768
  s_add_u32 m0, s67, 20480
 Mvav 96,148,160
  buffer_load_dwordx4 v16, s[20:23], s68 offen offset:0 sc1 lds
 WL 6
 Mvav 96,152,128
  ds_read_b128 a[180:183], v19 offset:33792
  v_cvt_pk_bf16_f32 v186, v216, v217
 WL 6
 Mvav 96,156,112
  v_cvt_pk_bf16_f32 v187, v218, v219
  v_cvt_pk_bf16_f32 v190, v220, v221
  v_mfma_f32_16x16x32_bf16 v[100:103], a[156:159], v[116:119], v[228:231]
  ds_read_b128 a[184:187], v19 offset:34816
  v_cvt_pk_bf16_f32 v191, v222, v223
 Mvav 100,152,132
 Mvav 100,148,164
  ds_read_b128 a[188:191], v19 offset:35840
 Mvav 100,144,148
  buffer_load_dwordx4 v16, s[20:23], s68 offen offset:1024 sc1 lds
  v_mfma_f32_16x16x32_bf16 v[104:107], a[144:147], v[152:155], v[232:235]
  ds_read_b128 a[192:195], v19 offset:36864
 Mvav 104,148,168
 Mvav 104,152,136
 Mvav 104,156,120
  ds_read_b128 a[196:199], v19 offset:37888
  v_mfma_f32_16x16x32_bf16 v[108:111], a[156:159], v[124:127], v[236:239]
  v_exp_f32 v96, v96
 Mvav 108,152,140
  ds_read_b128 a[200:203], v19 offset:38912
 Mvav 108,148,172
  buffer_load_dwordx4 v16, s[20:23], s68 offen offset:2048 sc1 lds
 Mvav 108,144,156
  ds_read_b128 a[204:207], v19 offset:39936
 WL 11
  v_mfma_f32_16x16x32_bf16 v[64:67], a[160:163], v[144:147], v[224:227]
 WL 10
  v_exp_f32 v97, v97
 Mvav 64,164,160
 WL 9
  v_exp_f32 v98, v98
 Mvav 64,168,128
 WL 8
  v_exp_f32 v99, v99
 Mvav 64,172,112
  v_exp_f32 v100, v100
  v_mfma_f32_16x16x32_bf16 v[68:71], a[172:175], v[116:119], v[228:231]
  v_exp_f32 v101, v101
 Mvav 68,168,132
  buffer_load_dwordx4 v16, s[20:23], s68 offen offset:3072 sc1 lds
 Mvav 68,164,164
  s_add_u32 s68, s68, 12288
  v_exp_f32 v102, v102
 Mvav 68,160,148
  v_exp_f32 v103, v103
  v_mfma_f32_16x16x32_bf16 v[72:75], a[160:163], v[152:155], v[232:235]
  v_exp_f32 v104, v104
 Mvav 72,164,168
  v_exp_f32 v105, v105
 Mvav 72,168,136
  v_exp_f32 v106, v106
 Mvav 72,172,120
  v_exp_f32 v107, v107
  v_mfma_f32_16x16x32_bf16 v[76:79], a[172:175], v[124:127], v[236:239]
  v_exp_f32 v108, v108
 Mvav 76,168,140
  v_exp_f32 v109, v109
 Mvav 76,164,172
 WL 0
  s_waitcnt vmcnt(19)
  s_barrier
 Mvav 76,160,156
  ds_read_b128 a[144:147], v18 offset:57344
  v_cvt_pk_bf16_f32 v80, v96, v97
 Maav 128,208,176
  s_add_u32 m0, s67, 32768
  v_exp_f32 v110, v110
 Maav 132,208,180
  ds_read_b128 a[148:151], v18 offset:58368
  v_cvt_pk_bf16_f32 v81, v98, v99
 Maav 136,208,184
  buffer_load_dwordx4 v16, s[20:23], s68 offen offset:0 sc1 lds
 Maav 140,208,188
  ds_read_b128 a[152:155], v18 offset:59392
  v_cvt_pk_bf16_f32 v84, v100, v101
 Maav 12,176,188
  v_exp_f32 v111, v111
 Maav 8,176,184
  v_exp_f32 v64, v64
 Maav 4,176,180
  ds_read_b128 a[156:159], v18 offset:60416
  v_cvt_pk_bf16_f32 v85, v102, v103
 Maav 0,176,176
  v_exp_f32 v65, v65
 Maav 16,180,176
  ds_read_b128 a[160:163], v18 offset:61440
  v_cvt_pk_bf16_f32 v88, v104, v105
 Maav 20,180,180
  buffer_load_dwordx4 v16, s[20:23], s68 offen offset:1024 sc1 lds
 Maav 24,180,184
  buffer_store_dwordx4 a[244:247], v15, s[8:11], 0 offen offset:2048 sc1
 Maav 28,180,188
  ds_read_b128 a[164:167], v18 offset:62464
  v_cvt_pk_bf16_f32 v89, v106, v107
 Maav 44,184,188
  v_exp_f32 v66, v66
 Maav 40,184,184
  ds_read_b128 a[168:171], v18 offset:63488
  v_cvt_pk_bf16_f32 v92, v108, v109
 Maav 36,184,180
  v_exp_f32 v67, v67
 Maav 32,184,176
  ds_read_b128 a[172:175], v18 offset:64512
  v_cvt_pk_bf16_f32 v93, v110, v111
 Maav 48,188,176
  buffer_load_dwordx4 v16, s[20:23], s68 offen offset:2048 sc1 lds
 Maav 52,188,180
  v_exp_f32 v68, v68
 Maav 56,188,184
  v_exp_f32 v69, v69
 Maav 60,188,188
  v_exp_f32 v70, v70
 Maav 76,192,188
  v_exp_f32 v71, v71
 Maav 72,192,184
  v_exp_f32 v72, v72
 Maav 68,192,180
  v_exp_f32 v73, v73
 Maav 64,192,176
  v_exp_f32 v74, v74
 Maav 80,196,176
  buffer_load_dwordx4 v16, s[20:23], s68 offen offset:3072 sc1 lds
 Maav 84,196,180
  s_add_u32 s68, s68, 4096
  v_exp_f32 v75, v75
 Maav 88,196,184
  v_exp_f32 v76, v76
 Maav 92,196,188
  v_exp_f32 v77, v77
 Maav 108,200,188
  v_exp_f32 v78, v78
 Maav 104,200,184
  v_exp_f32 v79, v79
 Maav 100,200,180
  v_cvt_pk_bf16_f32 v82, v64, v65
  v_cvt_pk_bf16_f32 v83, v66, v67
 Maav 96,200,176
  v_cvt_pk_bf16_f32 v86, v68, v69
  v_cvt_pk_bf16_f32 v87, v70, v71
 Maav 112,204,176
  v_cvt_pk_bf16_f32 v90, v72, v73
  v_cvt_pk_bf16_f32 v91, v74, v75
 Maav 116,204,180
  v_cvt_pk_bf16_f32 v94, v76, v77
  v_cvt_pk_bf16_f32 v95, v78, v79
 Maav 120,204,184
 Maav 124,204,188
 WL 7
 WL 6
 WL 5
  v_mfma_f32_16x16x32_bf16 v[192:195], a[144:147], v[144:147], v[224:227]
  ds_read_b128 a[176:179], v19 offset:49152
  s_add_u32 m0, s67, 36864
 Mvav 192,148,160
  buffer_load_dwordx4 v16, s[20:23], s68 offen offset:0 sc1 lds
 Mvav 192,152,128
  ds_read_b128 a[180:183], v19 offset:50176
 WL 6
 Mvav 192,156,112
  v_mfma_f32_16x16x32_bf16 v[196:199], a[156:159], v[116:119], v[228:231]
  ds_read_b128 a[184:187], v19 offset:51200
 Mvav 196,152,132
 Mvav 196,148,164
  ds_read_b128 a[188:191], v19 offset:52224
 Mvav 196,144,148
  buffer_load_dwordx4 v16, s[20:23], s68 offen offset:1024 sc1 lds
  v_mfma_f32_16x16x32_bf16 v[200:203], a[144:147], v[152:155], v[232:235]
  ds_read_b128 a[192:195], v19 offset:53248
 Mvav 200,148,168
 Mvav 200,152,136
 Mvav 200,156,120
  ds_read_b128 a[196:199], v19 offset:54272
  v_mfma_f32_16x16x32_bf16 v[204:207], a[156:159], v[124:127], v[236:239]
  v_exp_f32 v192, v192
 Mvav 204,152,140
  ds_read_b128 a[200:203], v19 offset:55296
 Mvav 204,148,172
  buffer_load_dwordx4 v16, s[20:23], s68 offen offset:2048 sc1 lds
 Mvav 204,144,156
  ds_read_b128 a[204:207], v19 offset:56320
 WL 11
  v_mfma_f32_16x16x32_bf16 v[208:211], a[160:163], v[144:147], v[224:227]
 WL 10
  v_exp_f32 v193, v193
 Mvav 208,164,160
 WL 9
  v_exp_f32 v194, v194
 Mvav 208,168,128
 WL 8
  v_exp_f32 v195, v195
 Mvav 208,172,112
  v_exp_f32 v196, v196
  v_mfma_f32_16x16x32_bf16 v[212:215], a[172:175], v[116:119], v[228:231]
  v_exp_f32 v197, v197
 Mvav 212,168,132
  buffer_load_dwordx4 v16, s[20:23], s68 offen offset:3072 sc1 lds
 Mvav 212,164,164
  s_add_u32 s68, s68, 12288
  v_exp_f32 v198, v198
 Mvav 212,160,148
  v_exp_f32 v199, v199
  v_mfma_f32_16x16x32_bf16 v[216:219], a[160:163], v[152:155], v[232:235]
  v_exp_f32 v200, v200
 Mvav 216,164,168
  v_exp_f32 v201, v201
 Mvav 216,168,136
  v_exp_f32 v202, v202
 Mvav 216,172,120
  v_exp_f32 v203, v203
  v_mfma_f32_16x16x32_bf16 v[220:223], a[172:175], v[124:127], v[236:239]
  v_exp_f32 v204, v204
 Mvav 220,168,140
  v_exp_f32 v205, v205
 Mvav 220,164,172
 WL 0
  s_waitcnt vmcnt(19)
  s_barrier
 Mvav 220,160,156
  ds_read_b128 a[144:147], v18 offset:8192
  v_cvt_pk_bf16_f32 v176, v192, v193
 Maav 128,208,80
  s_add_u32 m0, s67, 49152
  v_exp_f32 v206, v206
 Maav 132,208,84
  ds_read_b128 a[148:151], v18 offset:9216
  v_cvt_pk_bf16_f32 v177, v194, v195
 Maav 136,208,88
  buffer_load_dwordx4 v16, s[20:23], s68 offen offset:0 sc1 lds
 Maav 140,208,92
  ds_read_b128 a[152:155], v18 offset:10240
  v_cvt_pk_bf16_f32 v180, v196, v197
 Maav 12,176,92
  v_exp_f32 v207, v207
 Maav 8,176,88
  v_exp_f32 v208, v208
 Maav 4,176,84
  ds_read_b128 a[156:159], v18 offset:11264
  v_cvt_pk_bf16_f32 v181, v198, v199
 Maav 0,176,80
  v_exp_f32 v209, v209
 Maav 16,180,80
  ds_read_b128 a[160:163], v18 offset:12288
  v_cvt_pk_bf16_f32 v184, v200, v201
 Maav 20,180,84
  buffer_load_dwordx4 v16, s[20:23], s68 offen offset:1024 sc1 lds
 Maav 24,180,88
  buffer_store_dwordx4 a[244:247], v15, s[8:11], 0 offen offset:3072 sc1
 Maav 28,180,92
  ds_read_b128 a[164:167], v18 offset:13312
  v_cvt_pk_bf16_f32 v185, v202, v203
 Maav 44,184,92
  v_exp_f32 v210, v210
 Maav 40,184,88
  ds_read_b128 a[168:171], v18 offset:14336
  v_cvt_pk_bf16_f32 v188, v204, v205
 Maav 36,184,84
  v_exp_f32 v211, v211
 Maav 32,184,80
  ds_read_b128 a[172:175], v18 offset:15360
  v_cvt_pk_bf16_f32 v189, v206, v207
 Maav 48,188,80
  buffer_load_dwordx4 v16, s[20:23], s68 offen offset:2048 sc1 lds
 Maav 52,188,84
  v_cvt_pk_bf16_f32 v178, v208, v209
  v_cvt_pk_bf16_f32 v179, v210, v211
 Maav 56,188,88
  v_add_u32 v15, 0x1000, v15
 Maav 60,188,92
 Maav 76,192,92
 Maav 72,192,88
 Maav 68,192,84
 Maav 64,192,80
 Maav 80,196,80
  buffer_load_dwordx4 v16, s[20:23], s68 offen offset:3072 sc1 lds
 Maav 84,196,84
  s_add_u32 s68, s68, 4096
 Maav 88,196,88
 Maav 92,196,92
 Maav 108,200,92
 Maav 104,200,88
 Maav 100,200,84
 Maav 96,200,80
 Maav 112,204,80
 Maav 116,204,84
 Maav 120,204,88
 Maav 124,204,92
  s_cmp_lg_u32 s69, 0
  s_cbranch_scc1 LloopD
  s_cmp_eq_u32 s5, 7
  s_cbranch_scc1 Lfinal7
  s_cmp_ge_u32 s3, 2
  s_cbranch_scc1 Lfinal
 WL 7
  v_mfma_f32_16x16x32_bf16 v[96:99], a[144:147], v[144:147], v[224:227]
  ds_read_b128 a[176:179], v19 offset:0
  v_add_u32 v47, 131072, v46
 WL 7
 Mvav 96,148,160
  buffer_load_dwordx2 v[38:39], off, s[36:39], 0 offset:224 sc1
 WL 6
 Mvav 96,152,128
  ds_read_b128 a[180:183], v19 offset:1024
 WL 6
 Mvav 96,156,112
  v_exp_f32 v212, v212
  v_mfma_f32_16x16x32_bf16 v[100:103], a[156:159], v[116:119], v[228:231]
  ds_read_b128 a[184:187], v19 offset:2048
 Mvav 100,152,132
  v_exp_f32 v213, v213
 Mvav 100,148,164
  ds_read_b128 a[188:191], v19 offset:3072
  v_cvt_pk_bf16_f32 v182, v212, v213
 Mvav 100,144,148
  v_exp_f32 v214, v214
  v_mfma_f32_16x16x32_bf16 v[104:107], a[144:147], v[152:155], v[232:235]
  ds_read_b128 a[192:195], v19 offset:4096
 Mvav 104,148,168
  v_exp_f32 v215, v215
 Mvav 104,152,136
  v_exp_f32 v216, v216
 Mvav 104,156,120
  ds_read_b128 a[196:199], v19 offset:5120
  v_cvt_pk_bf16_f32 v183, v214, v215
  v_mfma_f32_16x16x32_bf16 v[108:111], a[156:159], v[124:127], v[236:239]
  v_exp_f32 v217, v217
 Mvav 108,152,140
  ds_read_b128 a[200:203], v19 offset:6144
  v_cvt_pk_bf16_f32 v186, v216, v217
 Mvav 108,148,172
  v_exp_f32 v218, v218
 Mvav 108,144,156
  ds_read_b128 a[204:207], v19 offset:7168
 WL 11
  v_mfma_f32_16x16x32_bf16 v[64:67], a[160:163], v[144:147], v[224:227]
 WL 10
  v_exp_f32 v219, v219
 Mvav 64,164,160
 WL 9
  v_exp_f32 v220, v220
 Mvav 64,168,128
 WL 8
  v_exp_f32 v221, v221
 Mvav 64,172,112
  v_exp_f32 v222, v222
  v_mfma_f32_16x16x32_bf16 v[68:71], a[172:175], v[116:119], v[228:231]
  v_exp_f32 v223, v223
 Mvav 68,168,132
  v_exp_f32 v96, v96
 Mvav 68,164,164
  v_exp_f32 v97, v97
 Mvav 68,160,148
  v_exp_f32 v98, v98
  v_mfma_f32_16x16x32_bf16 v[72:75], a[160:163], v[152:155], v[232:235]
  v_exp_f32 v99, v99
 Mvav 72,164,168
  v_exp_f32 v100, v100
 Mvav 72,168,136
  v_exp_f32 v101, v101
 Mvav 72,172,120
  v_exp_f32 v102, v102
  v_mfma_f32_16x16x32_bf16 v[76:79], a[172:175], v[124:127], v[236:239]
  v_exp_f32 v103, v103
 Mvav 76,168,140
  v_exp_f32 v104, v104
 Mvav 76,164,172
 WL 0
  s_waitcnt vmcnt(15)
  s_barrier
 Mvav 76,160,156
  ds_read_b128 a[144:147], v18 offset:24576
  v_cvt_pk_bf16_f32 v187, v218, v219
 Maav 128,208,176
  v_exp_f32 v105, v105
 Maav 132,208,180
  ds_read_b128 a[148:151], v18 offset:25600
  v_cvt_pk_bf16_f32 v190, v220, v221
  v_cvt_pk_bf16_f32 v191, v222, v223
 Maav 136,208,184
  v_exp_f32 v106, v106
 Maav 140,208,188
  ds_read_b128 a[152:155], v18 offset:26624
  v_cvt_pk_bf16_f32 v80, v96, v97
 Maav 12,176,188
  v_exp_f32 v107, v107
 Maav 8,176,184
  v_exp_f32 v108, v108
 Maav 4,176,180
  ds_read_b128 a[156:159], v18 offset:27648
  v_cvt_pk_bf16_f32 v81, v98, v99
 Maav 0,176,176
  v_exp_f32 v109, v109
 Maav 16,180,176
  ds_read_b128 a[160:163], v18 offset:28672
  v_cvt_pk_bf16_f32 v84, v100, v101
 Maav 20,180,180
  v_exp_f32 v110, v110
 Maav 24,180,184
  v_exp_f32 v111, v111
 Maav 28,180,188
  ds_read_b128 a[164:167], v18 offset:29696
  v_cvt_pk_bf16_f32 v85, v102, v103
 Maav 44,184,188
  v_exp_f32 v64, v64
 Maav 40,184,184
  ds_read_b128 a[168:171], v18 offset:30720
  v_cvt_pk_bf16_f32 v88, v104, v105
 Maav 36,184,180
  v_exp_f32 v65, v65
 Maav 32,184,176
  ds_read_b128 a[172:175], v18 offset:31744
  v_cvt_pk_bf16_f32 v89, v106, v107
 Maav 48,188,176
  v_exp_f32 v66, v66
 Maav 52,188,180
  v_exp_f32 v67, v67
 Maav 56,188,184
  v_exp_f32 v68, v68
 Maav 60,188,188
  v_exp_f32 v69, v69
 Maav 76,192,188
  v_exp_f32 v70, v70
 Maav 72,192,184
  v_exp_f32 v71, v71
 Maav 68,192,180
  v_exp_f32 v72, v72
 Maav 64,192,176
  v_exp_f32 v73, v73
 Maav 80,196,176
  v_exp_f32 v74, v74
 Maav 84,196,180
  v_exp_f32 v75, v75
 Maav 88,196,184
  v_exp_f32 v76, v76
 Maav 92,196,188
  v_exp_f32 v77, v77
 Maav 108,200,188
  v_exp_f32 v78, v78
 Maav 104,200,184
  v_exp_f32 v79, v79
 Maav 100,200,180
  v_cvt_pk_bf16_f32 v92, v108, v109
  v_cvt_pk_bf16_f32 v93, v110, v111
 Maav 96,200,176
  v_cvt_pk_bf16_f32 v82, v64, v65
  v_cvt_pk_bf16_f32 v83, v66, v67
 Maav 112,204,176
  v_cvt_pk_bf16_f32 v86, v68, v69
  v_cvt_pk_bf16_f32 v87, v70, v71
 Maav 116,204,180
  v_cvt_pk_bf16_f32 v90, v72, v73
  v_cvt_pk_bf16_f32 v91, v74, v75
 Maav 120,204,184
 WL 7
  v_cvt_pk_bf16_f32 v94, v76, v77
  v_cvt_pk_bf16_f32 v95, v78, v79
 Maav 124,204,188
  s_waitcnt vmcnt(0)
  v_readfirstlane_b32 s28, v38
  v_readfirstlane_b32 s29, v39
  v_mfma_f32_16x16x32_bf16 v[192:195], a[144:147], v[144:147], v[224:227]
  ds_read_b128 a[176:179], v19 offset:16384
 WL 7
 Mvav 192,148,160
  s_cmp_eq_u64 s[28:29], 0
  s_cbranch_scc1 Lpoll_hL
Lback_hL:
  s_lshl_b32 s26, s4, 3
 WL 6
 Mvav 192,152,128
  ds_read_b128 a[180:183], v19 offset:17408
  s_bfm_b64 s[30:31], s26, 0
 WL 6
 Mvav 192,156,112
  s_and_b64 s[30:31], s[30:31], s[28:29]
  s_bcnt1_i32_b64 s30, s[30:31]
  s_lshl_b32 s31, s30, 14
  v_mfma_f32_16x16x32_bf16 v[196:199], a[156:159], v[116:119], v[228:231]
  ds_read_b128 a[184:187], v19 offset:18432
  s_add_u32 s45, s45, s31
 Mvav 196,152,132
  s_mul_i32 s30, s30, 73728
  s_add_u32 s44, s44, s30
  s_lshr_b64 s[28:29], s[28:29], s26
 Mvav 196,148,164
  ds_read_b128 a[188:191], v19 offset:19456
  s_and_b32 s26, s28, 255
 Mvav 196,144,148
  s_bcnt1_i32_b32 s26, s26
  s_add_u32 s46, s45, 0
  v_mfma_f32_16x16x32_bf16 v[200:203], a[144:147], v[152:155], v[232:235]
  ds_read_b128 a[192:195], v19 offset:20480
 Mvav 200,148,168
  buffer_load_dwordx4 a[212:215], v16, s[20:23], s46 offen offset:0 sc1
 Mvav 200,152,136
  buffer_load_dwordx4 a[216:219], v16, s[20:23], s46 offen offset:2048 sc1
 Mvav 200,156,120
  ds_read_b128 a[196:199], v19 offset:21504
  v_mfma_f32_16x16x32_bf16 v[204:207], a[156:159], v[124:127], v[236:239]
  buffer_load_dwordx4 a[220:223], v17, s[20:23], s46 offen offset:0 sc1
 Mvav 204,152,140
  ds_read_b128 a[200:203], v19 offset:22528
 WL 10
 Mvav 204,148,172
  buffer_load_dwordx4 a[224:227], v17, s[20:23], s46 offen offset:2048 sc1
 Mvav 204,144,156
  ds_read_b128 a[204:207], v19 offset:23552
  s_add_u32 s46, s45, 8192
  v_mfma_f32_16x16x32_bf16 v[208:211], a[160:163], v[144:147], v[224:227]
  buffer_load_dwordx4 a[228:231], v16, s[20:23], s46 offen offset:0 sc1
 WL 10
 Mvav 208,164,160
  buffer_load_dwordx4 a[232:235], v16, s[20:23], s46 offen offset:2048 sc1
 WL 9
 Mvav 208,168,128
  buffer_load_dwordx4 a[236:239], v17, s[20:23], s46 offen offset:0 sc1
 WL 8
 Mvav 208,172,112
  buffer_load_dwordx4 a[240:243], v17, s[20:23], s46 offen offset:2048 sc1
  v_mfma_f32_16x16x32_bf16 v[212:215], a[172:175], v[116:119], v[228:231]
  v_exp_f32 v200, v200
 Mvav 212,168,132
  v_exp_f32 v201, v201
 Mvav 212,164,164
  v_exp_f32 v202, v202
 Mvav 212,160,148
  v_exp_f32 v203, v203
  v_mfma_f32_16x16x32_bf16 v[216:219], a[160:163], v[152:155], v[232:235]
  v_exp_f32 v204, v204
 Mvav 216,164,168
  v_exp_f32 v205, v205
 Mvav 216,168,136
  v_exp_f32 v206, v206
 Mvav 216,172,120
  v_exp_f32 v207, v207
  v_mfma_f32_16x16x32_bf16 v[220:223], a[172:175], v[124:127], v[236:239]
  v_exp_f32 v192, v192
 Mvav 220,168,140
  v_exp_f32 v193, v193
 Mvav 220,164,172
 WL 0
  s_barrier
 Mvav 220,160,156
  s_add_u32 m0, s47, 12288
  v_exp_f32 v194, v194
 Maav 128,208,80
  ds_read_b128 a[144:147], v19 offset:32768
  v_cvt_pk_bf16_f32 v184, v200, v201
 Maav 132,208,84
  buffer_load_dwordx4 v1, s[12:15], s44 offen lds
 Maav 136,208,88
  ds_read_b128 a[148:151], v19 offset:33792
  v_cvt_pk_bf16_f32 v185, v202, v203
 Maav 140,208,92
  buffer_load_dwordx4 v2, s[12:15], s44 offen offset:1056 lds
 Maav 12,176,92
  ds_read_b128 a[152:155], v19 offset:34816
  v_cvt_pk_bf16_f32 v188, v204, v205
 Maav 8,176,88
  buffer_load_dwordx4 v3, s[12:15], s44 offen offset:2112 lds
 Maav 4,176,84
  ds_read_b128 a[156:159], v19 offset:35840
  v_cvt_pk_bf16_f32 v189, v206, v207
 Maav 0,176,80
  buffer_load_dwordx4 v4, s[12:15], s44 offen offset:3168 lds
 Maav 16,180,80
  ds_read_b128 a[160:163], v19 offset:36864
  v_cvt_pk_bf16_f32 v176, v192, v193
 Maav 20,180,84
  s_add_u32 m0, s47, 16512
  v_exp_f32 v195, v195
 Maav 24,180,88
  ds_read_b128 a[164:167], v19 offset:37888
  v_cvt_pk_bf16_f32 v177, v194, v195
 Maav 28,180,92
  buffer_load_dwordx4 v5, s[12:15], s44 offen lds
 Maav 44,184,92
  ds_read_b128 a[168:171], v19 offset:38912
 Maav 40,184,88
  buffer_load_dwordx4 v6, s[12:15], s44 offen offset:1056 lds
 Maav 36,184,84
  ds_read_b128 a[172:175], v19 offset:39936
 Maav 32,184,80
  buffer_load_dwordx4 v7, s[12:15], s44 offen offset:2112 lds
 Maav 48,188,80
  buffer_load_dwordx4 v8, s[12:15], s44 offen offset:3168 lds
 Maav 52,188,84
  s_add_u32 m0, s47, 20736
  v_exp_f32 v196, v196
 Maav 56,188,88
  buffer_load_dwordx4 v9, s[20:23], s44 offen sc1 lds
 Maav 60,188,92
  s_add_u32 s46, s45, 16384
  v_exp_f32 v197, v197
 Maav 76,192,92
  v_exp_f32 v198, v198
 Maav 72,192,88
  v_exp_f32 v199, v199
 Maav 68,192,84
  v_exp_f32 v216, v216
 Maav 64,192,80
  v_exp_f32 v217, v217
 Maav 80,196,80
  v_exp_f32 v218, v218
 Maav 84,196,84
  v_exp_f32 v219, v219
 Maav 88,196,88
  v_exp_f32 v220, v220
 Maav 92,196,92
  v_exp_f32 v221, v221
 Maav 108,200,92
  v_exp_f32 v222, v222
 Maav 104,200,88
  v_exp_f32 v223, v223
 Maav 100,200,84
  v_exp_f32 v208, v208
 Maav 96,200,80
  v_exp_f32 v209, v209
 Maav 112,204,80
  v_exp_f32 v210, v210
 Maav 116,204,84
  v_exp_f32 v211, v211
 Maav 120,204,88
 WL 6
  v_cvt_pk_bf16_f32 v180, v196, v197
  v_cvt_pk_bf16_f32 v181, v198, v199
  v_cvt_pk_bf16_f32 v186, v216, v217
  v_cvt_pk_bf16_f32 v187, v218, v219
 Maav 124,204,92
 WL 7
  v_exp_f32 v212, v212
 Maav 136,208,184
  buffer_load_dwordx4 a[176:179], v16, s[20:23], s46 offen offset:0 sc1
 Maav 8,144,184
  buffer_load_dwordx4 a[180:183], v16, s[20:23], s46 offen offset:2048 sc1
 Maav 24,148,184
  buffer_load_dwordx4 a[184:187], v17, s[20:23], s46 offen offset:0 sc1
 WL 5
 Maav 40,152,184
  buffer_load_dwordx4 a[188:191], v17, s[20:23], s46 offen offset:2048 sc1
 WL 4
 Maav 56,156,184
  s_add_u32 s46, s45, 24576
  v_exp_f32 v213, v213
 WL 3
 Maav 72,160,184
  buffer_load_dwordx4 a[192:195], v16, s[20:23], s46 offen offset:0 sc1
 WL 2
 Maav 88,164,184
  buffer_load_dwordx4 a[196:199], v16, s[20:23], s46 offen offset:2048 sc1
 WL 1
 Maav 104,168,184
 WL 0
  v_cvt_pk_bf16_f32 v190, v220, v221
  v_cvt_pk_bf16_f32 v191, v222, v223
 Maav 120,172,184
  buffer_load_dwordx4 a[200:203], v17, s[20:23], s46 offen offset:0 sc1
 Maav 140,208,188
  buffer_load_dwordx4 a[204:207], v17, s[20:23], s46 offen offset:2048 sc1
 Maav 12,144,188
  s_add_u32 s46, s45, 32768
  v_exp_f32 v214, v214
 Maav 28,148,188
  v_exp_f32 v215, v215
 Maav 44,152,188
  v_cvt_pk_bf16_f32 v178, v208, v209
  v_cvt_pk_bf16_f32 v179, v210, v211
 Maav 60,156,188
  v_cvt_pk_bf16_f32 v182, v212, v213
  v_cvt_pk_bf16_f32 v183, v214, v215
 Maav 76,160,188
  ds_read_b128 v[144:147], v47 offset:0
 Maav 92,164,188
  ds_read_b128 v[148:151], v47 offset:1024
 Maav 108,168,188
  ds_read_b128 v[152:155], v47 offset:2048
 Maav 124,172,188
  ds_read_b128 v[156:159], v47 offset:3072
 Maav 128,208,176
  ds_read_b128 v[160:163], v47 offset:4096
 Maav 0,144,176
  ds_read_b128 v[164:167], v47 offset:5120
 Maav 16,148,176
  ds_read_b128 v[168:171], v47 offset:6144
 Maav 32,152,176
  ds_read_b128 v[172:175], v47 offset:7168
 Maav 48,156,176
  ds_read_b32 v36, v14 offset:0
 Maav 64,160,176
  ds_read_b128 v[128:131], v47 offset:8192
 Maav 80,164,176
  ds_read_b128 v[132:135], v47 offset:9216
 Maav 96,168,176
  ds_read_b128 v[136:139], v47 offset:10240
 Maav 112,172,176
  ds_read_b128 v[140:143], v47 offset:11264
 Maav 132,208,180
  ds_read_b128 v[112:115], v47 offset:12288
 Maav 4,144,180
  ds_read_b128 v[116:119], v47 offset:13312
 Maav 20,148,180
  ds_read_b128 v[120:123], v47 offset:14336
 Maav 36,152,180
  ds_read_b128 v[124:127], v47 offset:15360
 Maav 52,156,180
  ds_read_b32 v37, v14 offset:4
  v_add_u32 v47, 65536, v46
 Maav 68,160,180
  ds_write_b32 v14, a136 offset:8
 Maav 84,164,180
  ds_write_b128 v47, a[8:11] offset:0
 Maav 100,168,180
  ds_write_b128 v47, a[24:27] offset:1024
 Maav 116,172,180
  ds_write_b128 v47, a[40:43] offset:2048
  ds_write_b128 v47, a[56:59] offset:3072
  ds_write_b128 v47, a[72:75] offset:4096
  ds_write_b128 v47, a[88:91] offset:5120
  ds_write_b128 v47, a[104:107] offset:6144
  ds_write_b128 v47, a[120:123] offset:7168
  ds_write_b32 v14, a140 offset:12
  ds_write_b128 v47, a[12:15] offset:8192
  ds_write_b128 v47, a[28:31] offset:9216
  ds_write_b128 v47, a[44:47] offset:10240
  ds_write_b128 v47, a[60:63] offset:11264
  ds_write_b128 v47, a[76:79] offset:12288
  ds_write_b128 v47, a[92:95] offset:13312
  ds_write_b128 v47, a[108:111] offset:14336
  ds_write_b128 v47, a[124:127] offset:15360
 WL 0
  buffer_load_dwordx4 a[144:147], v16, s[20:23], s46 offen offset:0 sc1
  s_barrier
  buffer_load_dwordx4 a[148:151], v16, s[20:23], s46 offen offset:2048 sc1
  buffer_load_dwordx4 a[152:155], v17, s[20:23], s46 offen offset:0 sc1
  buffer_load_dwordx4 a[156:159], v17, s[20:23], s46 offen offset:2048 sc1
  s_add_u32 s46, s45, 40960
  buffer_load_dwordx4 a[160:163], v16, s[20:23], s46 offen offset:0 sc1
  buffer_load_dwordx4 a[164:167], v16, s[20:23], s46 offen offset:2048 sc1
  buffer_load_dwordx4 a[168:171], v17, s[20:23], s46 offen offset:0 sc1
  buffer_load_dwordx4 a[172:175], v17, s[20:23], s46 offen offset:2048 sc1
  s_add_u32 s44, s44, 147456
  s_add_u32 m0, s47, 125952
  s_nop 0
  buffer_load_dwordx4 v1, s[12:15], s44 offen lds
  buffer_load_dwordx4 v2, s[12:15], s44 offen offset:1056 lds
  buffer_load_dwordx4 v3, s[12:15], s44 offen offset:2112 lds
  buffer_load_dwordx4 v4, s[12:15], s44 offen offset:3168 lds
  s_add_u32 m0, s47, 130176
  s_nop 0
  buffer_load_dwordx4 v5, s[12:15], s44 offen lds
  buffer_load_dwordx4 v6, s[12:15], s44 offen offset:1056 lds
  buffer_load_dwordx4 v7, s[12:15], s44 offen offset:2112 lds
  buffer_load_dwordx4 v8, s[12:15], s44 offen offset:3168 lds
  s_add_u32 m0, s47, 134400
  s_nop 0
  buffer_load_dwordx4 v9, s[20:23], s44 offen sc1 lds
  v_accvgpr_read_b32 v40, a128
  v_accvgpr_read_b32 v42, a132
  v_add_f32 v28, v40, v36
  v_subrev_u32 v29, 0x1f800000, v28
  v_rcp_f32 v28, v28
  v_max_u32 v43, v43, v29
  v_mul_f32 v28, v28, v20
  v_mov_b32 v29, v28
  v_accvgpr_read_b32 v96, a0
  v_accvgpr_read_b32 v97, a1
  v_accvgpr_read_b32 v98, a2
  v_accvgpr_read_b32 v99, a3
  v_pk_add_f32 v[144:145], v[144:145], v[96:97]
  v_pk_add_f32 v[146:147], v[146:147], v[98:99]
  v_pk_mul_f32 v[144:145], v[144:145], v[28:29]
  v_pk_mul_f32 v[146:147], v[146:147], v[28:29]
  v_accvgpr_read_b32 v100, a16
  v_accvgpr_read_b32 v101, a17
  v_accvgpr_read_b32 v102, a18
  v_accvgpr_read_b32 v103, a19
  v_pk_add_f32 v[148:149], v[148:149], v[100:101]
  v_pk_add_f32 v[150:151], v[150:151], v[102:103]
  v_pk_mul_f32 v[148:149], v[148:149], v[28:29]
  v_pk_mul_f32 v[150:151], v[150:151], v[28:29]
  v_cvt_pk_bf16_f32 v144, v144, v145
  v_cvt_pk_bf16_f32 v145, v146, v147
  v_cvt_pk_bf16_f32 v146, v148, v149
  v_cvt_pk_bf16_f32 v147, v150, v151
  buffer_store_dwordx4 v[144:147], v16, s[20:23], s58 offen offset:0 sc1
  v_accvgpr_read_b32 v104, a32
  v_accvgpr_read_b32 v105, a33
  v_accvgpr_read_b32 v106, a34
  v_accvgpr_read_b32 v107, a35
  v_pk_add_f32 v[152:153], v[152:153], v[104:105]
  v_pk_add_f32 v[154:155], v[154:155], v[106:107]
  v_pk_mul_f32 v[152:153], v[152:153], v[28:29]
  v_pk_mul_f32 v[154:155], v[154:155], v[28:29]
  v_accvgpr_read_b32 v108, a48
  v_accvgpr_read_b32 v109, a49
  v_accvgpr_read_b32 v110, a50
  v_accvgpr_read_b32 v111, a51
  v_pk_add_f32 v[156:157], v[156:157], v[108:109]
  v_pk_add_f32 v[158:159], v[158:159], v[110:111]
  v_pk_mul_f32 v[156:157], v[156:157], v[28:29]
  v_pk_mul_f32 v[158:159], v[158:159], v[28:29]
  v_cvt_pk_bf16_f32 v152, v152, v153
  v_cvt_pk_bf16_f32 v153, v154, v155
  v_cvt_pk_bf16_f32 v154, v156, v157
  v_cvt_pk_bf16_f32 v155, v158, v159
  s_add_u32 s49, s58, 8192
  buffer_store_dwordx4 v[152:155], v16, s[20:23], s49 offen offset:0 sc1
  v_accvgpr_read_b32 v64, a64
  v_accvgpr_read_b32 v65, a65
  v_accvgpr_read_b32 v66, a66
  v_accvgpr_read_b32 v67, a67
  v_pk_add_f32 v[160:161], v[160:161], v[64:65]
  v_pk_add_f32 v[162:163], v[162:163], v[66:67]
  v_pk_mul_f32 v[160:161], v[160:161], v[28:29]
  v_pk_mul_f32 v[162:163], v[162:163], v[28:29]
  v_accvgpr_read_b32 v68, a80
  v_accvgpr_read_b32 v69, a81
  v_accvgpr_read_b32 v70, a82
  v_accvgpr_read_b32 v71, a83
  v_pk_add_f32 v[164:165], v[164:165], v[68:69]
  v_pk_add_f32 v[166:167], v[166:167], v[70:71]
  v_pk_mul_f32 v[164:165], v[164:165], v[28:29]
  v_pk_mul_f32 v[166:167], v[166:167], v[28:29]
  v_cvt_pk_bf16_f32 v160, v160, v161
  v_cvt_pk_bf16_f32 v161, v162, v163
  v_cvt_pk_bf16_f32 v162, v164, v165
  v_cvt_pk_bf16_f32 v163, v166, v167
  s_add_u32 s49, s58, 16384
  buffer_store_dwordx4 v[160:163], v16, s[20:23], s49 offen offset:0 sc1
  v_accvgpr_read_b32 v72, a96
  v_accvgpr_read_b32 v73, a97
  v_accvgpr_read_b32 v74, a98
  v_accvgpr_read_b32 v75, a99
  v_pk_add_f32 v[168:169], v[168:169], v[72:73]
  v_pk_add_f32 v[170:171], v[170:171], v[74:75]
  v_pk_mul_f32 v[168:169], v[168:169], v[28:29]
  v_pk_mul_f32 v[170:171], v[170:171], v[28:29]
  v_accvgpr_read_b32 v76, a112
  v_accvgpr_read_b32 v77, a113
  v_accvgpr_read_b32 v78, a114
  v_accvgpr_read_b32 v79, a115
  v_pk_add_f32 v[172:173], v[172:173], v[76:77]
  v_pk_add_f32 v[174:175], v[174:175], v[78:79]
  v_pk_mul_f32 v[172:173], v[172:173], v[28:29]
  v_pk_mul_f32 v[174:175], v[174:175], v[28:29]
  v_cvt_pk_bf16_f32 v168, v168, v169
  v_cvt_pk_bf16_f32 v169, v170, v171
  v_cvt_pk_bf16_f32 v170, v172, v173
  v_cvt_pk_bf16_f32 v171, v174, v175
  s_add_u32 s49, s58, 24576
  buffer_store_dwordx4 v[168:171], v16, s[20:23], s49 offen offset:0 sc1
  v_add_f32 v30, v42, v37
  v_subrev_u32 v31, 0x1f800000, v30
  v_rcp_f32 v30, v30
  v_max_u32 v43, v43, v31
  v_mul_f32 v30, v30, v22
  v_mov_b32 v31, v30
  v_accvgpr_read_b32 v192, a4
  v_accvgpr_read_b32 v193, a5
  v_accvgpr_read_b32 v194, a6
  v_accvgpr_read_b32 v195, a7
  v_pk_add_f32 v[128:129], v[128:129], v[192:193]
  v_pk_add_f32 v[130:131], v[130:131], v[194:195]
  v_pk_mul_f32 v[128:129], v[128:129], v[30:31]
  v_pk_mul_f32 v[130:131], v[130:131], v[30:31]
  v_accvgpr_read_b32 v196, a20
  v_accvgpr_read_b32 v197, a21
  v_accvgpr_read_b32 v198, a22
  v_accvgpr_read_b32 v199, a23
  v_pk_add_f32 v[132:133], v[132:133], v[196:197]
  v_pk_add_f32 v[134:135], v[134:135], v[198:199]
  v_pk_mul_f32 v[132:133], v[132:133], v[30:31]
  v_pk_mul_f32 v[134:135], v[134:135], v[30:31]
  v_cvt_pk_bf16_f32 v128, v128, v129
  v_cvt_pk_bf16_f32 v129, v130, v131
  v_cvt_pk_bf16_f32 v130, v132, v133
  v_cvt_pk_bf16_f32 v131, v134, v135
  buffer_store_dwordx4 v[128:131], v16, s[20:23], s58 offen offset:2048 sc1
  v_accvgpr_read_b32 v200, a36
  v_accvgpr_read_b32 v201, a37
  v_accvgpr_read_b32 v202, a38
  v_accvgpr_read_b32 v203, a39
  v_pk_add_f32 v[136:137], v[136:137], v[200:201]
  v_pk_add_f32 v[138:139], v[138:139], v[202:203]
  v_pk_mul_f32 v[136:137], v[136:137], v[30:31]
  v_pk_mul_f32 v[138:139], v[138:139], v[30:31]
  v_accvgpr_read_b32 v204, a52
  v_accvgpr_read_b32 v205, a53
  v_accvgpr_read_b32 v206, a54
  v_accvgpr_read_b32 v207, a55
  v_pk_add_f32 v[140:141], v[140:141], v[204:205]
  v_pk_add_f32 v[142:143], v[142:143], v[206:207]
  v_pk_mul_f32 v[140:141], v[140:141], v[30:31]
  v_pk_mul_f32 v[142:143], v[142:143], v[30:31]
  v_cvt_pk_bf16_f32 v136, v136, v137
  v_cvt_pk_bf16_f32 v137, v138, v139
  v_cvt_pk_bf16_f32 v138, v140, v141
  v_cvt_pk_bf16_f32 v139, v142, v143
  s_add_u32 s49, s58, 8192
  buffer_store_dwordx4 v[136:139], v16, s[20:23], s49 offen offset:2048 sc1
  v_accvgpr_read_b32 v208, a68
  v_accvgpr_read_b32 v209, a69
  v_accvgpr_read_b32 v210, a70
  v_accvgpr_read_b32 v211, a71
  v_pk_add_f32 v[112:113], v[112:113], v[208:209]
  v_pk_add_f32 v[114:115], v[114:115], v[210:211]
  v_pk_mul_f32 v[112:113], v[112:113], v[30:31]
  v_pk_mul_f32 v[114:115], v[114:115], v[30:31]
  v_accvgpr_read_b32 v212, a84
  v_accvgpr_read_b32 v213, a85
  v_accvgpr_read_b32 v214, a86
  v_accvgpr_read_b32 v215, a87
  v_pk_add_f32 v[116:117], v[116:117], v[212:213]
  v_pk_add_f32 v[118:119], v[118:119], v[214:215]
  v_pk_mul_f32 v[116:117], v[116:117], v[30:31]
  v_pk_mul_f32 v[118:119], v[118:119], v[30:31]
  v_cvt_pk_bf16_f32 v112, v112, v113
  v_cvt_pk_bf16_f32 v113, v114, v115
  v_cvt_pk_bf16_f32 v114, v116, v117
  v_cvt_pk_bf16_f32 v115, v118, v119
  s_add_u32 s49, s58, 16384
  buffer_store_dwordx4 v[112:115], v16, s[20:23], s49 offen offset:2048 sc1
  v_accvgpr_read_b32 v216, a100
  v_accvgpr_read_b32 v217, a101
  v_accvgpr_read_b32 v218, a102
  v_accvgpr_read_b32 v219, a103
  v_pk_add_f32 v[120:121], v[120:121], v[216:217]
  v_pk_add_f32 v[122:123], v[122:123], v[218:219]
  v_pk_mul_f32 v[120:121], v[120:121], v[30:31]
  v_pk_mul_f32 v[122:123], v[122:123], v[30:31]
  v_accvgpr_read_b32 v220, a116
  v_accvgpr_read_b32 v221, a117
  v_accvgpr_read_b32 v222, a118
  v_accvgpr_read_b32 v223, a119
  v_pk_add_f32 v[124:125], v[124:125], v[220:221]
  v_pk_add_f32 v[126:127], v[126:127], v[222:223]
  v_pk_mul_f32 v[124:125], v[124:125], v[30:31]
  v_pk_mul_f32 v[126:127], v[126:127], v[30:31]
  v_cvt_pk_bf16_f32 v120, v120, v121
  v_cvt_pk_bf16_f32 v121, v122, v123
  v_cvt_pk_bf16_f32 v122, v124, v125
  v_cvt_pk_bf16_f32 v123, v126, v127
  s_add_u32 s49, s58, 24576
  buffer_store_dwordx4 v[120:123], v16, s[20:23], s49 offen offset:2048 sc1
  s_branch Ldone
LS:
  s_cmp_eq_u32 s5, 0
  s_cbranch_scc1 Lswitch0
  v_mfma_f32_16x16x32_bf16 v[96:99], a[144:147], v[144:147], v[224:227]
  s_lshr_b32 s33, s5, 1
  v_lshlrev_b32 v29, 14, v0
  v_add_u32 v29, Lpre_back-Lpc0, v29
 Mvav 96,148,160
  s_sub_u32 s33, s33, 2
  s_lshl_b32 s32, s5, 2
  v_min_u32 v29, Lend-Lpc0-16388, v29
 Mvav 96,152,128
  global_load_dword a248, v29, s[100:101]
 Mvav 96,156,112
  s_add_u32 s32, s32, s3
  v_mov_b32 v43, 0
  v_mov_b32 v28, 0x3f803f80
  v_mfma_f32_16x16x32_bf16 v[100:103], a[156:159], v[116:119], v[228:231]
  s_sub_u32 s69, s5, 1
  v_accvgpr_write_b32 a208, v28
  v_accvgpr_write_b32 a209, v28
 Mvav 100,152,132
 WL 0
  s_waitcnt vmcnt(12)
  s_barrier
 Mvav 100,148,164
  s_lshl_b32 s54, s2, 8
  v_accvgpr_write_b32 a210, v28
  v_accvgpr_write_b32 a211, v28
 Mvav 100,144,148
  ds_read_b128 a[212:215], v18 offset:24576
  s_add_u32 s54, s54, 0x4480000
  v_mfma_f32_16x16x32_bf16 v[104:107], a[144:147], v[152:155], v[232:235]
  s_cmp_eq_u32 s32, 30
  s_cselect_b32 s32, 2, -1
  s_mul_i32 s47, s3, 9472
 Mvav 104,148,168
  ds_read_b128 a[216:219], v18 offset:25600
  s_lshr_b32 s46, s4, 3
 Mvav 104,152,136
  v_cmp_gt_i32 vcc, s33, v0
  v_mov_b32 v49, 1
  v_lshlrev_b32 v50, 8, v0
  v_cndmask_b32_e64 v48, 2.0, 0, vcc
 Mvav 104,156,120
  ds_read_b128 a[220:223], v18 offset:26624
  s_lshl_b32 s45, s46, 15
  v_mfma_f32_16x16x32_bf16 v[108:111], a[156:159], v[124:127], v[236:239]
  v_cmp_gt_u32 vcc, 8, v0
  v_lshlrev_b32 v51, 2, v0
  v_mov_b32 v52, 224
  v_cndmask_b32 v51, v52, v51, vcc
 Mvav 108,152,140
  ds_read_b128 a[224:227], v18 offset:27648
  s_sub_u32 s24, s58, s45
 Mvav 108,148,172
  s_lshl_b32 s46, s46, 8
  v_exp_f32 v96, v96
 Mvav 108,144,156
  ds_read_b128 a[228:231], v18 offset:28672
  s_mul_i32 s44, s3, 36864
  v_mfma_f32_16x16x32_bf16 v[64:67], a[160:163], v[144:147], v[224:227]
  s_add_u32 s44, s44, s46
  v_exp_f32 v97, v97
 Mvav 64,164,160
  ds_read_b128 a[232:235], v18 offset:29696
  v_cvt_pk_bf16_f32 v80, v96, v97
 Mvav 64,168,128
  s_and_b32 s46, s4, 7
  v_exp_f32 v98, v98
 Mvav 64,172,112
  ds_read_b128 a[236:239], v18 offset:30720
  s_mul_i32 s25, s46, 147456
  v_mfma_f32_16x16x32_bf16 v[68:71], a[172:175], v[116:119], v[228:231]
  s_add_u32 s25, s25, s44
  v_exp_f32 v99, v99
 Mvav 68,168,132
  ds_read_b128 a[240:243], v18 offset:31744
  v_cvt_pk_bf16_f32 v81, v98, v99
 Mvav 68,164,164
  s_mul_i32 s45, s46, 49152
  v_exp_f32 v100, v100
 Mvav 68,160,148
  s_sub_u32 s45, s24, s45
  v_exp_f32 v101, v101
  v_mfma_f32_16x16x32_bf16 v[72:75], a[160:163], v[152:155], v[232:235]
  s_sub_u32 s45, s45, 1179648
  v_exp_f32 v102, v102
 Mvav 72,164,168
  s_mul_i32 s46, s46, 368640
  v_exp_f32 v103, v103
 Mvav 72,168,136
  s_add_u32 s44, s44, s46
  v_exp_f32 v104, v104
 Mvav 72,172,120
  v_exp_f32 v105, v105
  v_mfma_f32_16x16x32_bf16 v[76:79], a[172:175], v[124:127], v[236:239]
  v_exp_f32 v106, v106
 Mvav 76,168,140
  v_exp_f32 v107, v107
 Mvav 76,164,172
 WL 6
  v_exp_f32 v108, v108
 Mvav 76,160,156
 WL 7
  v_exp_f32 v109, v109
  v_mfma_f32_16x16x32_bf16 v[192:195], a[212:215], v[144:147], v[224:227]
  ds_read_b128 a[176:179], v19 offset:16384
  v_cvt_pk_bf16_f32 v84, v100, v101
 Mvav 192,216,160
 WL 6
  v_exp_f32 v110, v110
 Mvav 192,220,128
  ds_read_b128 a[180:183], v19 offset:17408
  v_cvt_pk_bf16_f32 v85, v102, v103
 WL 6
 Mvav 192,224,112
  v_exp_f32 v111, v111
  v_mfma_f32_16x16x32_bf16 v[196:199], a[224:227], v[116:119], v[228:231]
  ds_read_b128 a[184:187], v19 offset:18432
  v_cvt_pk_bf16_f32 v88, v104, v105
 Mvav 196,220,132
  v_exp_f32 v64, v64
 Mvav 196,216,164
  ds_read_b128 a[188:191], v19 offset:19456
  v_cvt_pk_bf16_f32 v89, v106, v107
 Mvav 196,212,148
  v_exp_f32 v65, v65
  v_mfma_f32_16x16x32_bf16 v[200:203], a[212:215], v[152:155], v[232:235]
  ds_read_b128 a[192:195], v19 offset:20480
  v_cvt_pk_bf16_f32 v92, v108, v109
 Mvav 200,216,168
  v_exp_f32 v66, v66
 Mvav 200,220,136
  v_exp_f32 v67, v67
 Mvav 200,224,120
  ds_read_b128 a[196:199], v19 offset:21504
  v_cvt_pk_bf16_f32 v93, v110, v111
  v_mfma_f32_16x16x32_bf16 v[204:207], a[224:227], v[124:127], v[236:239]
  v_exp_f32 v68, v68
 Mvav 204,220,140
  ds_read_b128 a[200:203], v19 offset:22528
  v_cvt_pk_bf16_f32 v82, v64, v65
 Mvav 204,216,172
 WL 10
  v_exp_f32 v69, v69
 Mvav 204,212,156
  ds_read_b128 a[204:207], v19 offset:23552
  v_cvt_pk_bf16_f32 v83, v66, v67
  v_mfma_f32_16x16x32_bf16 v[208:211], a[228:231], v[144:147], v[224:227]
 WL 10
  v_exp_f32 v70, v70
 Mvav 208,232,160
 WL 9
  v_exp_f32 v71, v71
 Mvav 208,236,128
 WL 8
  v_exp_f32 v72, v72
 Mvav 208,240,112
  v_exp_f32 v73, v73
  v_mfma_f32_16x16x32_bf16 v[212:215], a[240:243], v[116:119], v[228:231]
  v_exp_f32 v74, v74
 Mvav 212,236,132
  v_exp_f32 v75, v75
 Mvav 212,232,164
  v_exp_f32 v76, v76
 Mvav 212,228,148
  v_exp_f32 v77, v77
  v_mfma_f32_16x16x32_bf16 v[216:219], a[228:231], v[152:155], v[232:235]
  v_exp_f32 v78, v78
 Mvav 216,232,168
  v_exp_f32 v79, v79
 Mvav 216,236,136
  v_exp_f32 v192, v192
 Mvav 216,240,120
  v_exp_f32 v193, v193
  v_mfma_f32_16x16x32_bf16 v[220:223], a[240:243], v[124:127], v[236:239]
  v_exp_f32 v194, v194
 Mvav 220,236,140
  v_exp_f32 v195, v195
 Mvav 220,232,172
 WL 0
  s_waitcnt vmcnt(8)
  s_barrier
 Mvav 220,228,156
  ds_read_b128 a[144:147], v18 offset:40960
  v_cvt_pk_bf16_f32 v86, v68, v69
  v_cvt_pk_bf16_f32 v87, v70, v71
  v_mfma_f32_16x16x32_bf16 a[128:131], a[208:211], v[80:83], 0
  v_cvt_pk_bf16_f32 v90, v72, v73
  v_cvt_pk_bf16_f32 v91, v74, v75
  v_mfma_f32_16x16x32_bf16 a[132:135], a[208:211], v[84:87], 0
  ds_read_b128 a[148:151], v18 offset:41984
  v_cvt_pk_bf16_f32 v94, v76, v77
  v_cvt_pk_bf16_f32 v95, v78, v79
  v_mfma_f32_16x16x32_bf16 a[136:139], a[208:211], v[88:91], 0
  v_exp_f32 v196, v196
  v_mfma_f32_16x16x32_bf16 a[140:143], a[208:211], v[92:95], 0
  ds_read_b128 a[152:155], v18 offset:43008
  v_cvt_pk_bf16_f32 v176, v192, v193
  v_mfma_f32_16x16x32_bf16 a[12:15], a[176:179], v[92:95], 0
  v_exp_f32 v197, v197
  v_mfma_f32_16x16x32_bf16 a[8:11], a[176:179], v[88:91], 0
  v_exp_f32 v198, v198
  v_mfma_f32_16x16x32_bf16 a[4:7], a[176:179], v[84:87], 0
  ds_read_b128 a[156:159], v18 offset:44032
  v_cvt_pk_bf16_f32 v177, v194, v195
  v_mfma_f32_16x16x32_bf16 a[0:3], a[176:179], v[80:83], 0
  v_exp_f32 v199, v199
  v_mfma_f32_16x16x32_bf16 a[16:19], a[180:183], v[80:83], 0
  ds_read_b128 a[160:163], v18 offset:45056
  v_cvt_pk_bf16_f32 v180, v196, v197
  v_mfma_f32_16x16x32_bf16 a[20:23], a[180:183], v[84:87], 0
  v_exp_f32 v200, v200
  v_mfma_f32_16x16x32_bf16 a[24:27], a[180:183], v[88:91], 0
  v_exp_f32 v201, v201
  v_mfma_f32_16x16x32_bf16 a[28:31], a[180:183], v[92:95], 0
  ds_read_b128 a[164:167], v18 offset:46080
  v_cvt_pk_bf16_f32 v181, v198, v199
  v_mfma_f32_16x16x32_bf16 a[44:47], a[184:187], v[92:95], 0
  v_exp_f32 v202, v202
  v_mfma_f32_16x16x32_bf16 a[40:43], a[184:187], v[88:91], 0
  ds_read_b128 a[168:171], v18 offset:47104
  v_cvt_pk_bf16_f32 v184, v200, v201
  v_mfma_f32_16x16x32_bf16 a[36:39], a[184:187], v[84:87], 0
  v_exp_f32 v203, v203
  v_mfma_f32_16x16x32_bf16 a[32:35], a[184:187], v[80:83], 0
  ds_read_b128 a[172:175], v18 offset:48128
  v_cvt_pk_bf16_f32 v185, v202, v203
  v_mfma_f32_16x16x32_bf16 a[48:51], a[188:191], v[80:83], 0
  v_exp_f32 v204, v204
  v_mfma_f32_16x16x32_bf16 a[52:55], a[188:191], v[84:87], 0
  v_exp_f32 v205, v205
  v_mfma_f32_16x16x32_bf16 a[56:59], a[188:191], v[88:91], 0
  v_exp_f32 v206, v206
  v_mfma_f32_16x16x32_bf16 a[60:63], a[188:191], v[92:95], 0
  v_exp_f32 v207, v207
  v_mfma_f32_16x16x32_bf16 a[76:79], a[192:195], v[92:95], 0
  v_exp_f32 v208, v208
  v_mfma_f32_16x16x32_bf16 a[72:75], a[192:195], v[88:91], 0
  v_exp_f32 v209, v209
  v_mfma_f32_16x16x32_bf16 a[68:71], a[192:195], v[84:87], 0
  v_exp_f32 v210, v210
  v_mfma_f32_16x16x32_bf16 a[64:67], a[192:195], v[80:83], 0
  v_exp_f32 v211, v211
  v_mfma_f32_16x16x32_bf16 a[80:83], a[196:199], v[80:83], 0
  v_exp_f32 v212, v212
  v_mfma_f32_16x16x32_bf16 a[84:87], a[196:199], v[84:87], 0
  v_exp_f32 v213, v213
  v_mfma_f32_16x16x32_bf16 a[88:91], a[196:199], v[88:91], 0
  v_exp_f32 v214, v214
  v_mfma_f32_16x16x32_bf16 a[92:95], a[196:199], v[92:95], 0
  v_exp_f32 v215, v215
  v_mfma_f32_16x16x32_bf16 a[108:111], a[200:203], v[92:95], 0
  v_exp_f32 v216, v216
  v_mfma_f32_16x16x32_bf16 a[104:107], a[200:203], v[88:91], 0
  v_exp_f32 v217, v217
  v_mfma_f32_16x16x32_bf16 a[100:103], a[200:203], v[84:87], 0
  v_exp_f32 v218, v218
  v_mfma_f32_16x16x32_bf16 a[96:99], a[200:203], v[80:83], 0
  v_exp_f32 v219, v219
  v_mfma_f32_16x16x32_bf16 a[112:115], a[204:207], v[80:83], 0
  v_exp_f32 v220, v220
  v_mfma_f32_16x16x32_bf16 a[116:119], a[204:207], v[84:87], 0
  v_exp_f32 v221, v221
  v_mfma_f32_16x16x32_bf16 a[120:123], a[204:207], v[88:91], 0
 WL 6
  v_exp_f32 v222, v222
  v_mfma_f32_16x16x32_bf16 a[124:127], a[204:207], v[92:95], 0
 WL 7
  v_exp_f32 v223, v223
  v_mfma_f32_16x16x32_bf16 v[96:99], a[144:147], v[144:147], v[224:227]
  ds_read_b128 a[176:179], v19 offset:32768
  v_cvt_pk_bf16_f32 v188, v204, v205
 Mvav 96,148,160
 WL 6
  v_cvt_pk_bf16_f32 v189, v206, v207
  v_cvt_pk_bf16_f32 v178, v208, v209
 Mvav 96,152,128
  ds_read_b128 a[180:183], v19 offset:33792
  v_cvt_pk_bf16_f32 v179, v210, v211
 WL 6
 Mvav 96,156,112
  v_cvt_pk_bf16_f32 v182, v212, v213
  v_cvt_pk_bf16_f32 v183, v214, v215
  v_mfma_f32_16x16x32_bf16 v[100:103], a[156:159], v[116:119], v[228:231]
  ds_read_b128 a[184:187], v19 offset:34816
  v_cvt_pk_bf16_f32 v186, v216, v217
 Mvav 100,152,132
  v_cvt_pk_bf16_f32 v187, v218, v219
  v_cvt_pk_bf16_f32 v190, v220, v221
 Mvav 100,148,164
  ds_read_b128 a[188:191], v19 offset:35840
  v_cvt_pk_bf16_f32 v191, v222, v223
 Mvav 100,144,148
  v_accvgpr_write_b32 a244, -1
  v_accvgpr_write_b32 a245, -1
  v_mfma_f32_16x16x32_bf16 v[104:107], a[144:147], v[152:155], v[232:235]
  ds_read_b128 a[192:195], v19 offset:36864
  v_accvgpr_write_b32 a246, -1
 Mvav 104,148,168
  v_accvgpr_write_b32 a247, -1
  v_lshrrev_b32 v38, 4, v0
 Mvav 104,152,136
  v_mul_u32_u24 v38, 8960, v38
  v_add_u32 v1, v38, v16
 Mvav 104,156,120
  ds_read_b128 a[196:199], v19 offset:37888
  v_add_u32 v2, 96, v1
  v_mfma_f32_16x16x32_bf16 v[108:111], a[156:159], v[124:127], v[236:239]
  v_exp_f32 v96, v96
 Mvav 108,152,140
  ds_read_b128 a[200:203], v19 offset:38912
  v_add_u32 v3, 192, v1
 Mvav 108,148,172
 WL 10
  v_exp_f32 v97, v97
 Mvav 108,144,156
  ds_read_b128 a[204:207], v19 offset:39936
  v_cvt_pk_bf16_f32 v80, v96, v97
  v_mfma_f32_16x16x32_bf16 v[64:67], a[160:163], v[144:147], v[224:227]
 WL 10
  v_exp_f32 v98, v98
 Mvav 64,164,160
 WL 9
  v_exp_f32 v99, v99
 Mvav 64,168,128
 WL 8
  v_exp_f32 v100, v100
 Mvav 64,172,112
  v_exp_f32 v101, v101
  v_mfma_f32_16x16x32_bf16 v[68:71], a[172:175], v[116:119], v[228:231]
  v_exp_f32 v102, v102
 Mvav 68,168,132
  v_exp_f32 v103, v103
 Mvav 68,164,164
  v_exp_f32 v104, v104
 Mvav 68,160,148
  v_exp_f32 v105, v105
  v_mfma_f32_16x16x32_bf16 v[72:75], a[160:163], v[152:155], v[232:235]
  v_exp_f32 v106, v106
 Mvav 72,164,168
  v_exp_f32 v107, v107
 Mvav 72,168,136
  v_exp_f32 v108, v108
 Mvav 72,172,120
  v_exp_f32 v109, v109
  v_mfma_f32_16x16x32_bf16 v[76:79], a[172:175], v[124:127], v[236:239]
  v_exp_f32 v110, v110
 Mvav 76,168,140
  v_exp_f32 v111, v111
 Mvav 76,164,172
 WL 0
  s_waitcnt vmcnt(4)
  s_barrier
 Mvav 76,160,156
  ds_read_b128 a[144:147], v18 offset:57344
  v_cvt_pk_bf16_f32 v81, v98, v99
 Maav 128,208,176
  v_exp_f32 v64, v64
 Maav 132,208,180
  ds_read_b128 a[148:151], v18 offset:58368
  v_cvt_pk_bf16_f32 v84, v100, v101
 Maav 136,208,184
  v_exp_f32 v65, v65
 Maav 140,208,188
  ds_read_b128 a[152:155], v18 offset:59392
  v_cvt_pk_bf16_f32 v85, v102, v103
 Maav 12,176,188
  v_exp_f32 v66, v66
 Maav 8,176,184
  v_exp_f32 v67, v67
 Maav 4,176,180
  ds_read_b128 a[156:159], v18 offset:60416
  v_cvt_pk_bf16_f32 v88, v104, v105
 Maav 0,176,176
  v_exp_f32 v68, v68
 Maav 16,180,176
  ds_read_b128 a[160:163], v18 offset:61440
  v_cvt_pk_bf16_f32 v89, v106, v107
 Maav 20,180,180
  v_exp_f32 v69, v69
 Maav 24,180,184
  v_exp_f32 v70, v70
 Maav 28,180,188
  ds_read_b128 a[164:167], v18 offset:62464
  v_cvt_pk_bf16_f32 v92, v108, v109
 Maav 44,184,188
  v_exp_f32 v71, v71
 Maav 40,184,184
  ds_read_b128 a[168:171], v18 offset:63488
  v_cvt_pk_bf16_f32 v93, v110, v111
 Maav 36,184,180
  v_exp_f32 v72, v72
 Maav 32,184,176
  ds_read_b128 a[172:175], v18 offset:64512
  v_cvt_pk_bf16_f32 v82, v64, v65
 Maav 48,188,176
  v_exp_f32 v73, v73
 Maav 52,188,180
  v_exp_f32 v74, v74
 Maav 56,188,184
  v_exp_f32 v75, v75
 Maav 60,188,188
  v_exp_f32 v76, v76
 Maav 76,192,188
  v_exp_f32 v77, v77
 Maav 72,192,184
  v_exp_f32 v78, v78
 Maav 68,192,180
  v_exp_f32 v79, v79
 Maav 64,192,176
  v_cvt_pk_bf16_f32 v83, v66, v67
  v_cvt_pk_bf16_f32 v86, v68, v69
 Maav 80,196,176
  v_cvt_pk_bf16_f32 v87, v70, v71
  v_cvt_pk_bf16_f32 v90, v72, v73
 Maav 84,196,180
  v_cvt_pk_bf16_f32 v91, v74, v75
  v_cvt_pk_bf16_f32 v94, v76, v77
 Maav 88,196,184
  v_cvt_pk_bf16_f32 v95, v78, v79
  v_add_u32 v4, 288, v1
 Maav 92,196,188
  v_add_u32 v5, 4608, v1
  v_add_u32 v6, 4704, v1
 Maav 108,200,188
  s_lshr_b32 s46, s4, 3
  v_add_u32 v7, 4800, v1
  v_add_u32 v8, 4896, v1
 Maav 104,200,184
  s_mul_i32 s46, s46, 768
  s_add_u32 s46, s46, 0x6000000
  v_add_u32 v9, s46, v16
 Maav 100,200,180
  v_bfe_u32 v38, v0, 2, 3
  v_lshlrev_b32 v38, 10, v38
 Maav 96,200,176
  v_lshl_add_u32 v38, v0, 3, v38
  v_add_u32 v32, 12288, v38
 Maav 112,204,176
  v_add_u32 v33, 125952, v38
  v_add_u32 v34, 50176, v38
 Maav 116,204,180
  s_mov_b32 s61, 0
  v_add_u32 v35, 88064, v38
  v_mov_b32 v30, 2.0
 Maav 120,204,184
  s_mov_b32 s59, 0
  s_mov_b32 s60, 0
 Maav 124,204,188
 WL 7
  v_mfma_f32_16x16x32_bf16 v[192:195], a[144:147], v[144:147], v[224:227]
  ds_read_b128 a[176:179], v19 offset:49152
 WL 7
 Mvav 192,148,160
 WL 6
 Mvav 192,152,128
  ds_read_b128 a[180:183], v19 offset:50176
 WL 6
 Mvav 192,156,112
  v_mfma_f32_16x16x32_bf16 v[196:199], a[156:159], v[116:119], v[228:231]
  ds_read_b128 a[184:187], v19 offset:51200
 Mvav 196,152,132
 Mvav 196,148,164
  ds_read_b128 a[188:191], v19 offset:52224
 Mvav 196,144,148
  v_mfma_f32_16x16x32_bf16 v[200:203], a[144:147], v[152:155], v[232:235]
  ds_read_b128 a[192:195], v19 offset:53248
 Mvav 200,148,168
 Mvav 200,152,136
 Mvav 200,156,120
  ds_read_b128 a[196:199], v19 offset:54272
  v_mfma_f32_16x16x32_bf16 v[204:207], a[156:159], v[124:127], v[236:239]
  v_exp_f32 v192, v192
 Mvav 204,152,140
  ds_read_b128 a[200:203], v19 offset:55296
 Mvav 204,148,172
 WL 10
  v_exp_f32 v193, v193
 Mvav 204,144,156
  ds_read_b128 a[204:207], v19 offset:56320
  v_cvt_pk_bf16_f32 v176, v192, v193
  v_mfma_f32_16x16x32_bf16 v[208:211], a[160:163], v[144:147], v[224:227]
 WL 10
  v_exp_f32 v194, v194
 Mvav 208,164,160
 WL 9
  v_exp_f32 v195, v195
 Mvav 208,168,128
 WL 8
  v_exp_f32 v196, v196
 Mvav 208,172,112
  v_exp_f32 v197, v197
  v_mfma_f32_16x16x32_bf16 v[212:215], a[172:175], v[116:119], v[228:231]
  v_exp_f32 v198, v198
 Mvav 212,168,132
  v_exp_f32 v199, v199
 Mvav 212,164,164
  v_exp_f32 v200, v200
 Mvav 212,160,148
  v_exp_f32 v201, v201
  v_mfma_f32_16x16x32_bf16 v[216:219], a[160:163], v[152:155], v[232:235]
  v_exp_f32 v202, v202
 Mvav 216,164,168
  v_exp_f32 v203, v203
 Mvav 216,168,136
  v_exp_f32 v204, v204
 Mvav 216,172,120
  v_exp_f32 v205, v205
  v_mfma_f32_16x16x32_bf16 v[220:223], a[172:175], v[124:127], v[236:239]
  v_exp_f32 v206, v206
 Mvav 220,168,140
  v_exp_f32 v207, v207
 Mvav 220,164,172
  s_waitcnt vmcnt(1) lgkmcnt(0)
  s_barrier
 Mvav 220,160,156
  ds_read_b128 a[144:147], v18 offset:8192
  v_cvt_pk_bf16_f32 v177, v194, v195
 Maav 128,208,80
  v_exp_f32 v208, v208
 Maav 132,208,84
  ds_read_b128 a[148:151], v18 offset:9216
  v_cvt_pk_bf16_f32 v180, v196, v197
 Maav 136,208,88
  v_exp_f32 v209, v209
 Maav 140,208,92
  ds_read_b128 a[152:155], v18 offset:10240
  v_cvt_pk_bf16_f32 v181, v198, v199
 Maav 12,176,92
  v_exp_f32 v210, v210
 Maav 8,176,88
  v_exp_f32 v211, v211
 Maav 4,176,84
  ds_read_b128 a[156:159], v18 offset:11264
  v_cvt_pk_bf16_f32 v184, v200, v201
 Maav 0,176,80
  v_cvt_pk_bf16_f32 v185, v202, v203
  v_cvt_pk_bf16_f32 v188, v204, v205
 Maav 16,180,80
  ds_read_b128 a[160:163], v18 offset:12288
  v_cvt_pk_bf16_f32 v189, v206, v207
 Maav 20,180,84
  v_cvt_pk_bf16_f32 v178, v208, v209
  v_cvt_pk_bf16_f32 v179, v210, v211
 Maav 24,180,88
 Maav 28,180,92
  ds_read_b128 a[164:167], v18 offset:13312
 Maav 44,184,92
 Maav 40,184,88
  ds_read_b128 a[168:171], v18 offset:14336
 Maav 36,184,84
 Maav 32,184,80
  ds_read_b128 a[172:175], v18 offset:15360
 Maav 48,188,80
 Maav 52,188,84
 Maav 56,188,88
 Maav 60,188,92
 Maav 76,192,92
 Maav 72,192,88
 Maav 68,192,84
 Maav 64,192,80
 Maav 80,196,80
 Maav 84,196,84
 Maav 88,196,88
 Maav 92,196,92
 Maav 108,200,92
 Maav 104,200,88
 Maav 100,200,84
 Maav 96,200,80
 Maav 112,204,80
 Maav 116,204,84
 Maav 120,204,88
 Maav 124,204,92
  s_cmp_eq_u32 s69, 0
  s_cbranch_scc1 Lswitch
LloopN:
 WL 7
  v_mfma_f32_16x16x32_bf16 v[96:99], a[144:147], v[144:147], v[224:227]
  ds_read_b128 a[176:179], v19 offset:0
  s_sub_u32 s69, s69, 1
 WL 7
 Mvav 96,148,160
 WL 6
  v_exp_f32 v212, v212
 Mvav 96,152,128
  ds_read_b128 a[180:183], v19 offset:1024
 WL 6
 Mvav 96,156,112
  v_exp_f32 v213, v213
  v_mfma_f32_16x16x32_bf16 v[100:103], a[156:159], v[116:119], v[228:231]
  ds_read_b128 a[184:187], v19 offset:2048
  v_cvt_pk_bf16_f32 v182, v212, v213
 Mvav 100,152,132
  v_exp_f32 v214, v214
 Mvav 100,148,164
  ds_read_b128 a[188:191], v19 offset:3072
 Mvav 100,144,148
  v_exp_f32 v215, v215
  v_mfma_f32_16x16x32_bf16 v[104:107], a[144:147], v[152:155], v[232:235]
  ds_read_b128 a[192:195], v19 offset:4096
  v_cvt_pk_bf16_f32 v183, v214, v215
 Mvav 104,148,168
  v_exp_f32 v216, v216
 Mvav 104,152,136
  v_exp_f32 v217, v217
 Mvav 104,156,120
  ds_read_b128 a[196:199], v19 offset:5120
  v_cvt_pk_bf16_f32 v186, v216, v217
  v_mfma_f32_16x16x32_bf16 v[108:111], a[156:159], v[124:127], v[236:239]
  v_exp_f32 v218, v218
 Mvav 108,152,140
  ds_read_b128 a[200:203], v19 offset:6144
 Mvav 108,148,172
 WL 10
  v_exp_f32 v219, v219
 Mvav 108,144,156
  ds_read_b128 a[204:207], v19 offset:7168
  v_cvt_pk_bf16_f32 v187, v218, v219
  v_mfma_f32_16x16x32_bf16 v[64:67], a[160:163], v[144:147], v[224:227]
 WL 10
  v_exp_f32 v220, v220
 Mvav 64,164,160
 WL 9
  v_exp_f32 v221, v221
 Mvav 64,168,128
 WL 8
  v_exp_f32 v222, v222
 Mvav 64,172,112
  v_exp_f32 v223, v223
  v_mfma_f32_16x16x32_bf16 v[68:71], a[172:175], v[116:119], v[228:231]
  v_exp_f32 v96, v96
 Mvav 68,168,132
  v_exp_f32 v97, v97
 Mvav 68,164,164
  v_exp_f32 v98, v98
 Mvav 68,160,148
  v_exp_f32 v99, v99
  v_mfma_f32_16x16x32_bf16 v[72:75], a[160:163], v[152:155], v[232:235]
  v_exp_f32 v100, v100
 Mvav 72,164,168
  v_exp_f32 v101, v101
 Mvav 72,168,136
  v_exp_f32 v102, v102
 Mvav 72,172,120
  v_exp_f32 v103, v103
  v_mfma_f32_16x16x32_bf16 v[76:79], a[172:175], v[124:127], v[236:239]
  v_exp_f32 v104, v104
 Mvav 76,168,140
  v_exp_f32 v105, v105
 Mvav 76,164,172
 WL 0
  s_barrier
 Mvav 76,160,156
  ds_read_b128 a[144:147], v18 offset:24576
  v_cvt_pk_bf16_f32 v190, v220, v221
 Maav 128,208,176
  v_exp_f32 v106, v106
 Maav 132,208,180
  ds_read_b128 a[148:151], v18 offset:25600
  v_cvt_pk_bf16_f32 v191, v222, v223
 Maav 136,208,184
  v_exp_f32 v107, v107
 Maav 140,208,188
  ds_read_b128 a[152:155], v18 offset:26624
  v_cvt_pk_bf16_f32 v80, v96, v97
 Maav 12,176,188
  v_exp_f32 v108, v108
 Maav 8,176,184
  v_exp_f32 v109, v109
 Maav 4,176,180
  ds_read_b128 a[156:159], v18 offset:27648
  v_cvt_pk_bf16_f32 v81, v98, v99
 Maav 0,176,176
  v_exp_f32 v110, v110
 Maav 16,180,176
  ds_read_b128 a[160:163], v18 offset:28672
  v_cvt_pk_bf16_f32 v84, v100, v101
 Maav 20,180,180
  v_exp_f32 v111, v111
 Maav 24,180,184
  buffer_store_dwordx4 a[244:247], v15, s[8:11], 0 offen offset:0 sc1
 Maav 28,180,188
  ds_read_b128 a[164:167], v18 offset:29696
  v_cvt_pk_bf16_f32 v85, v102, v103
 Maav 44,184,188
  v_exp_f32 v64, v64
 Maav 40,184,184
  ds_read_b128 a[168:171], v18 offset:30720
  v_cvt_pk_bf16_f32 v88, v104, v105
 Maav 36,184,180
  v_exp_f32 v65, v65
 Maav 32,184,176
  ds_read_b128 a[172:175], v18 offset:31744
  v_cvt_pk_bf16_f32 v89, v106, v107
 Maav 48,188,176
  v_exp_f32 v66, v66
 Maav 52,188,180
  v_exp_f32 v67, v67
 Maav 56,188,184
  v_exp_f32 v68, v68
 Maav 60,188,188
  v_exp_f32 v69, v69
 Maav 76,192,188
  v_exp_f32 v70, v70
 Maav 72,192,184
  v_exp_f32 v71, v71
 Maav 68,192,180
  v_exp_f32 v72, v72
 Maav 64,192,176
  v_exp_f32 v73, v73
 Maav 80,196,176
  buffer_atomic_add v49, v48, s[20:23], s54 offen offset:64 sc1
 Maav 84,196,180
  v_exp_f32 v74, v74
 Maav 88,196,184
  v_exp_f32 v75, v75
 Maav 92,196,188
  v_exp_f32 v76, v76
 Maav 108,200,188
  v_exp_f32 v77, v77
 Maav 104,200,184
  v_exp_f32 v78, v78
 Maav 100,200,180
  v_exp_f32 v79, v79
 Maav 96,200,176
  v_cvt_pk_bf16_f32 v92, v108, v109
  v_cvt_pk_bf16_f32 v93, v110, v111
 Maav 112,204,176
  v_cvt_pk_bf16_f32 v82, v64, v65
  v_cvt_pk_bf16_f32 v83, v66, v67
 Maav 116,204,180
  v_cvt_pk_bf16_f32 v86, v68, v69
  v_cvt_pk_bf16_f32 v87, v70, v71
 Maav 120,204,184
 WL 5
  v_cvt_pk_bf16_f32 v90, v72, v73
  v_cvt_pk_bf16_f32 v91, v74, v75
 Maav 124,204,188
 WL 7
  v_cvt_pk_bf16_f32 v94, v76, v77
  v_cvt_pk_bf16_f32 v95, v78, v79
  v_mfma_f32_16x16x32_bf16 v[192:195], a[144:147], v[144:147], v[224:227]
  ds_read_b128 a[176:179], v19 offset:16384
 WL 7
 Mvav 192,148,160
  s_cmp_eq_u32 s69, s32
  s_cselect_b32 s34, 0, 256
  s_lshl_b32 s33, s34, 20
 Mvav 192,152,128
  ds_read_b128 a[180:183], v19 offset:17408
  s_add_u32 s33, s33, 0x448c000
 WL 6
 Mvav 192,156,112
  buffer_load_dword v52, v50, s[20:23], s33 offen offset:64 sc1
  v_mfma_f32_16x16x32_bf16 v[196:199], a[156:159], v[116:119], v[228:231]
  ds_read_b128 a[184:187], v19 offset:18432
 Mvav 196,152,132
  buffer_load_dword v53, v51, s[36:39], s34 offen sc1
 Mvav 196,148,164
  ds_read_b128 a[188:191], v19 offset:19456
 Mvav 196,144,148
  v_mfma_f32_16x16x32_bf16 v[200:203], a[144:147], v[152:155], v[232:235]
  ds_read_b128 a[192:195], v19 offset:20480
 Mvav 200,148,168
 Mvav 200,152,136
 Mvav 200,156,120
  ds_read_b128 a[196:199], v19 offset:21504
  v_mfma_f32_16x16x32_bf16 v[204:207], a[156:159], v[124:127], v[236:239]
  v_exp_f32 v192, v192
 Mvav 204,152,140
  ds_read_b128 a[200:203], v19 offset:22528
 Mvav 204,148,172
 WL 10
  v_exp_f32 v193, v193
 Mvav 204,144,156
  ds_read_b128 a[204:207], v19 offset:23552
  v_cvt_pk_bf16_f32 v176, v192, v193
  v_mfma_f32_16x16x32_bf16 v[208:211], a[160:163], v[144:147], v[224:227]
 WL 10
  v_exp_f32 v194, v194
 Mvav 208,164,160
 WL 9
  v_exp_f32 v195, v195
 Mvav 208,168,128
 WL 8
  v_exp_f32 v196, v196
 Mvav 208,172,112
  v_exp_f32 v197, v197
  v_mfma_f32_16x16x32_bf16 v[212:215], a[172:175], v[116:119], v[228:231]
  v_exp_f32 v198, v198
 Mvav 212,168,132
  v_exp_f32 v199, v199
 Mvav 212,164,164
  v_exp_f32 v200, v200
 Mvav 212,160,148
  v_exp_f32 v201, v201
  v_mfma_f32_16x16x32_bf16 v[216:219], a[160:163], v[152:155], v[232:235]
  v_exp_f32 v202, v202
 Mvav 216,164,168
  v_exp_f32 v203, v203
 Mvav 216,168,136
  v_exp_f32 v204, v204
 Mvav 216,172,120
  v_exp_f32 v205, v205
  v_mfma_f32_16x16x32_bf16 v[220:223], a[172:175], v[124:127], v[236:239]
  v_exp_f32 v206, v206
 Mvav 220,168,140
  v_exp_f32 v207, v207
 Mvav 220,164,172
 WL 0
  s_barrier
 Mvav 220,160,156
  ds_read_b128 a[144:147], v18 offset:40960
  v_cvt_pk_bf16_f32 v177, v194, v195
 Maav 128,208,80
  v_exp_f32 v208, v208
 Maav 132,208,84
  ds_read_b128 a[148:151], v18 offset:41984
  v_cvt_pk_bf16_f32 v180, v196, v197
 Maav 136,208,88
  v_exp_f32 v209, v209
 Maav 140,208,92
  ds_read_b128 a[152:155], v18 offset:43008
  v_cvt_pk_bf16_f32 v181, v198, v199
 Maav 12,176,92
  v_exp_f32 v210, v210
 Maav 8,176,88
  v_exp_f32 v211, v211
 Maav 4,176,84
  ds_read_b128 a[156:159], v18 offset:44032
  v_cvt_pk_bf16_f32 v184, v200, v201
 Maav 0,176,80
  v_exp_f32 v212, v212
 Maav 16,180,80
  ds_read_b128 a[160:163], v18 offset:45056
  v_cvt_pk_bf16_f32 v185, v202, v203
 Maav 20,180,84
  v_exp_f32 v213, v213
 Maav 24,180,88
  buffer_store_dwordx4 a[244:247], v15, s[8:11], 0 offen offset:1024 sc1
 Maav 28,180,92
  ds_read_b128 a[164:167], v18 offset:46080
  v_cvt_pk_bf16_f32 v188, v204, v205
 Maav 44,184,92
  v_exp_f32 v214, v214
 Maav 40,184,88
  ds_read_b128 a[168:171], v18 offset:47104
  v_cvt_pk_bf16_f32 v189, v206, v207
 Maav 36,184,84
  v_exp_f32 v215, v215
 Maav 32,184,80
  ds_read_b128 a[172:175], v18 offset:48128
  v_cvt_pk_bf16_f32 v178, v208, v209
 Maav 48,188,80
  v_exp_f32 v216, v216
 Maav 52,188,84
  v_exp_f32 v217, v217
 Maav 56,188,88
  v_exp_f32 v218, v218
 Maav 60,188,92
  v_exp_f32 v219, v219
 Maav 76,192,92
  global_load_dword a248, v29, s[100:101]
 Maav 72,192,88
  v_exp_f32 v220, v220
 Maav 68,192,84
  v_exp_f32 v221, v221
 Maav 64,192,80
  v_exp_f32 v222, v222
 Maav 80,196,80
  buffer_atomic_add v49, v48, s[20:23], s54 offen offset:64 sc1
 Maav 84,196,84
  v_exp_f32 v223, v223
 Maav 88,196,88
  v_cvt_pk_bf16_f32 v179, v210, v211
  v_cvt_pk_bf16_f32 v182, v212, v213
 Maav 92,196,92
  v_cvt_pk_bf16_f32 v183, v214, v215
  v_cvt_pk_bf16_f32 v186, v216, v217
 Maav 108,200,92
  v_cvt_pk_bf16_f32 v187, v218, v219
  v_cvt_pk_bf16_f32 v190, v220, v221
 Maav 104,200,88
  v_cvt_pk_bf16_f32 v191, v222, v223
 Maav 100,200,84
 Maav 96,200,80
 Maav 112,204,80
 Maav 116,204,84
 Maav 120,204,88
 Maav 124,204,92
 WL 7
  v_mfma_f32_16x16x32_bf16 v[96:99], a[144:147], v[144:147], v[224:227]
  ds_read_b128 a[176:179], v19 offset:32768
 WL 7
 Mvav 96,148,160
 WL 6
 Mvav 96,152,128
  ds_read_b128 a[180:183], v19 offset:33792
 WL 6
 Mvav 96,156,112
  v_mfma_f32_16x16x32_bf16 v[100:103], a[156:159], v[116:119], v[228:231]
  ds_read_b128 a[184:187], v19 offset:34816
 Mvav 100,152,132
 Mvav 100,148,164
  ds_read_b128 a[188:191], v19 offset:35840
 Mvav 100,144,148
  v_mfma_f32_16x16x32_bf16 v[104:107], a[144:147], v[152:155], v[232:235]
  ds_read_b128 a[192:195], v19 offset:36864
 Mvav 104,148,168
 Mvav 104,152,136
 Mvav 104,156,120
  ds_read_b128 a[196:199], v19 offset:37888
  v_mfma_f32_16x16x32_bf16 v[108:111], a[156:159], v[124:127], v[236:239]
  v_exp_f32 v96, v96
 Mvav 108,152,140
  ds_read_b128 a[200:203], v19 offset:38912
 Mvav 108,148,172
 WL 10
  v_exp_f32 v97, v97
 Mvav 108,144,156
  ds_read_b128 a[204:207], v19 offset:39936
  v_cvt_pk_bf16_f32 v80, v96, v97
  v_mfma_f32_16x16x32_bf16 v[64:67], a[160:163], v[144:147], v[224:227]
 WL 10
  v_exp_f32 v98, v98
 Mvav 64,164,160
 WL 9
  v_exp_f32 v99, v99
 Mvav 64,168,128
 WL 8
  v_exp_f32 v100, v100
 Mvav 64,172,112
  v_exp_f32 v101, v101
  v_mfma_f32_16x16x32_bf16 v[68:71], a[172:175], v[116:119], v[228:231]
  v_exp_f32 v102, v102
 Mvav 68,168,132
  v_exp_f32 v103, v103
 Mvav 68,164,164
  v_exp_f32 v104, v104
 Mvav 68,160,148
  v_exp_f32 v105, v105
  v_mfma_f32_16x16x32_bf16 v[72:75], a[160:163], v[152:155], v[232:235]
  v_exp_f32 v106, v106
 Mvav 72,164,168
  v_exp_f32 v107, v107
 Mvav 72,168,136
  v_exp_f32 v108, v108
 Mvav 72,172,120
  v_exp_f32 v109, v109
  v_mfma_f32_16x16x32_bf16 v[76:79], a[172:175], v[124:127], v[236:239]
  v_exp_f32 v110, v110
 Mvav 76,168,140
  v_exp_f32 v111, v111
 Mvav 76,164,172
 WL 0
  s_barrier
 Mvav 76,160,156
  ds_read_b128 a[144:147], v18 offset:57344
  v_cvt_pk_bf16_f32 v81, v98, v99
 Maav 128,208,176
  v_exp_f32 v64, v64
 Maav 132,208,180
  ds_read_b128 a[148:151], v18 offset:58368
  v_cvt_pk_bf16_f32 v84, v100, v101
 Maav 136,208,184
  v_exp_f32 v65, v65
 Maav 140,208,188
  ds_read_b128 a[152:155], v18 offset:59392
  v_cvt_pk_bf16_f32 v85, v102, v103
 Maav 12,176,188
  v_exp_f32 v66, v66
 Maav 8,176,184
  v_exp_f32 v67, v67
 Maav 4,176,180
  ds_read_b128 a[156:159], v18 offset:60416
  v_cvt_pk_bf16_f32 v88, v104, v105
 Maav 0,176,176
  v_exp_f32 v68, v68
 Maav 16,180,176
  ds_read_b128 a[160:163], v18 offset:61440
  v_cvt_pk_bf16_f32 v89, v106, v107
 Maav 20,180,180
  v_exp_f32 v69, v69
 Maav 24,180,184
  buffer_store_dwordx4 a[244:247], v15, s[8:11], 0 offen offset:2048 sc1
 Maav 28,180,188
  ds_read_b128 a[164:167], v18 offset:62464
  v_cvt_pk_bf16_f32 v92, v108, v109
 Maav 44,184,188
  v_exp_f32 v70, v70
 Maav 40,184,184
  ds_read_b128 a[168:171], v18 offset:63488
  v_cvt_pk_bf16_f32 v93, v110, v111
 Maav 36,184,180
  v_exp_f32 v71, v71
 Maav 32,184,176
  ds_read_b128 a[172:175], v18 offset:64512
  v_cvt_pk_bf16_f32 v82, v64, v65
 Maav 48,188,176
  v_exp_f32 v72, v72
 Maav 52,188,180
  v_exp_f32 v73, v73
 Maav 56,188,184
  v_exp_f32 v74, v74
 Maav 60,188,188
  v_exp_f32 v75, v75
 Maav 76,192,188
  v_exp_f32 v76, v76
 Maav 72,192,184
  v_exp_f32 v77, v77
 Maav 68,192,180
  v_exp_f32 v78, v78
 Maav 64,192,176
  v_exp_f32 v79, v79
 Maav 80,196,176
  buffer_atomic_add v49, v48, s[20:23], s54 offen offset:64 sc1
 Maav 84,196,180
  v_cvt_pk_bf16_f32 v83, v66, v67
  v_cvt_pk_bf16_f32 v86, v68, v69
 Maav 88,196,184
  v_cvt_pk_bf16_f32 v87, v70, v71
  v_cvt_pk_bf16_f32 v90, v72, v73
 Maav 92,196,188
  v_cvt_pk_bf16_f32 v91, v74, v75
  v_cvt_pk_bf16_f32 v94, v76, v77
 Maav 108,200,188
  v_cvt_pk_bf16_f32 v95, v78, v79
 Maav 104,200,184
  s_cmp_eq_u32 s69, s32
  s_cbranch_scc1 Lplan
Lplanb:
 Maav 100,200,180
 Maav 96,200,176
 Maav 112,204,176
 Maav 116,204,180
 Maav 120,204,184
 Maav 124,204,188
 WL 7
  v_mfma_f32_16x16x32_bf16 v[192:195], a[144:147], v[144:147], v[224:227]
  ds_read_b128 a[176:179], v19 offset:49152
 WL 7
 Mvav 192,148,160
 WL 6
 Mvav 192,152,128
  ds_read_b128 a[180:183], v19 offset:50176
 WL 6
 Mvav 192,156,112
  v_mfma_f32_16x16x32_bf16 v[196:199], a[156:159], v[116:119], v[228:231]
  ds_read_b128 a[184:187], v19 offset:51200
 Mvav 196,152,132
 Mvav 196,148,164
  ds_read_b128 a[188:191], v19 offset:52224
 Mvav 196,144,148
  v_mfma_f32_16x16x32_bf16 v[200:203], a[144:147], v[152:155], v[232:235]
  ds_read_b128 a[192:195], v19 offset:53248
 Mvav 200,148,168
 Mvav 200,152,136
 Mvav 200,156,120
  ds_read_b128 a[196:199], v19 offset:54272
  v_mfma_f32_16x16x32_bf16 v[204:207], a[156:159], v[124:127], v[236:239]
  v_exp_f32 v192, v192
 Mvav 204,152,140
  ds_read_b128 a[200:203], v19 offset:55296
 Mvav 204,148,172
 WL 10
  v_exp_f32 v193, v193
 Mvav 204,144,156
  ds_read_b128 a[204:207], v19 offset:56320
  v_cvt_pk_bf16_f32 v176, v192, v193
  v_mfma_f32_16x16x32_bf16 v[208:211], a[160:163], v[144:147], v[224:227]
 WL 10
  v_exp_f32 v194, v194
 Mvav 208,164,160
 WL 9
  v_exp_f32 v195, v195
 Mvav 208,168,128
 WL 8
  v_exp_f32 v196, v196
 Mvav 208,172,112
  v_exp_f32 v197, v197
  v_mfma_f32_16x16x32_bf16 v[212:215], a[172:175], v[116:119], v[228:231]
  v_exp_f32 v198, v198
 Mvav 212,168,132
  v_exp_f32 v199, v199
 Mvav 212,164,164
  v_exp_f32 v200, v200
 Mvav 212,160,148
  v_exp_f32 v201, v201
  v_mfma_f32_16x16x32_bf16 v[216:219], a[160:163], v[152:155], v[232:235]
  v_exp_f32 v202, v202
 Mvav 216,164,168
  v_exp_f32 v203, v203
 Mvav 216,168,136
  v_exp_f32 v204, v204
 Mvav 216,172,120
  v_exp_f32 v205, v205
  v_mfma_f32_16x16x32_bf16 v[220:223], a[172:175], v[124:127], v[236:239]
  v_exp_f32 v206, v206
 Mvav 220,168,140
  v_exp_f32 v207, v207
 Mvav 220,164,172
 WL 0
  s_barrier
 Mvav 220,160,156
  ds_read_b128 a[144:147], v18 offset:8192
  v_cvt_pk_bf16_f32 v177, v194, v195
 Maav 128,208,80
  v_exp_f32 v208, v208
 Maav 132,208,84
  ds_read_b128 a[148:151], v18 offset:9216
  v_cvt_pk_bf16_f32 v180, v196, v197
 Maav 136,208,88
  v_exp_f32 v209, v209
 Maav 140,208,92
  ds_read_b128 a[152:155], v18 offset:10240
  v_cvt_pk_bf16_f32 v181, v198, v199
 Maav 12,176,92
  v_exp_f32 v210, v210
 Maav 8,176,88
  v_exp_f32 v211, v211
 Maav 4,176,84
  ds_read_b128 a[156:159], v18 offset:11264
  v_cvt_pk_bf16_f32 v184, v200, v201
 Maav 0,176,80
  v_cvt_pk_bf16_f32 v185, v202, v203
  v_cvt_pk_bf16_f32 v188, v204, v205
 Maav 16,180,80
  ds_read_b128 a[160:163], v18 offset:12288
  v_cvt_pk_bf16_f32 v189, v206, v207
 Maav 20,180,84
  v_cvt_pk_bf16_f32 v178, v208, v209
  v_cvt_pk_bf16_f32 v179, v210, v211
 Maav 24,180,88
  buffer_store_dwordx4 a[244:247], v15, s[8:11], 0 offen offset:3072 sc1
 Maav 28,180,92
  ds_read_b128 a[164:167], v18 offset:13312
  v_add_u32 v15, 0x1000, v15
 Maav 44,184,92
 Maav 40,184,88
  ds_read_b128 a[168:171], v18 offset:14336
 Maav 36,184,84
 Maav 32,184,80
  ds_read_b128 a[172:175], v18 offset:15360
 Maav 48,188,80
 Maav 52,188,84
 Maav 56,188,88
 Maav 60,188,92
 Maav 76,192,92
 Maav 72,192,88
 Maav 68,192,84
 Maav 64,192,80
 Maav 80,196,80
  buffer_atomic_add v49, v48, s[20:23], s54 offen offset:64 sc1
 Maav 84,196,84
 Maav 88,196,88
 Maav 92,196,92
 Maav 108,200,92
 Maav 104,200,88
 Maav 100,200,84
 Maav 96,200,80
 Maav 112,204,80
 Maav 116,204,84
 Maav 120,204,88
 Maav 124,204,92
  s_cmp_lg_u32 s69, 0
  s_cbranch_scc1 LloopN
  s_cmp_eq_u32 s5, 7
  s_cbranch_scc1 Lfinal7
Lswitch:
 WL 7
  v_mfma_f32_16x16x32_bf16 v[96:99], a[144:147], v[144:147], v[248:251]
  ds_read_b128 a[176:179], v19 offset:0
  v_add_u32 v47, 131072, v46
 WL 7
 Mvav 96,148,160
 WL 6
  v_exp_f32 v212, v212
 Mvav 96,152,128
  ds_read_b128 a[180:183], v19 offset:1024
  v_and_b32 v42, 15, v0
 WL 6
 Mvav 96,156,112
  v_exp_f32 v213, v213
  v_mfma_f32_16x16x32_bf16 v[100:103], a[156:159], v[116:119], v[228:231]
  ds_read_b128 a[184:187], v19 offset:2048
  v_cvt_pk_bf16_f32 v182, v212, v213
 Mvav 100,152,132
  v_exp_f32 v214, v214
 Mvav 100,148,164
  ds_read_b128 a[188:191], v19 offset:3072
  v_lshlrev_b32 v42, 3, v42
 Mvav 100,144,148
  s_sub_u32 s66, 15, s5
  v_exp_f32 v215, v215
  v_mfma_f32_16x16x32_bf16 v[104:107], a[144:147], v[152:155], v[232:235]
  ds_read_b128 a[192:195], v19 offset:4096
  v_cvt_pk_bf16_f32 v183, v214, v215
 Mvav 104,148,168
  s_lshl_b32 s66, s66, 3
  v_exp_f32 v216, v216
 Mvav 104,152,136
  s_and_b32 s65, s3, 1
  v_exp_f32 v217, v217
 Mvav 104,156,120
  ds_read_b128 a[196:199], v19 offset:5120
  v_cvt_pk_bf16_f32 v186, v216, v217
  v_mfma_f32_16x16x32_bf16 v[108:111], a[156:159], v[124:127], v[236:239]
  s_add_u32 s66, s66, s65
  v_exp_f32 v218, v218
 Mvav 108,152,140
  ds_read_b128 a[200:203], v19 offset:6144
  s_lshl_b32 s66, s66, 7
 Mvav 108,148,172
  s_add_u32 s66, s66, 0x4400000
  v_exp_f32 v219, v219
 Mvav 108,144,156
  ds_read_b128 a[204:207], v19 offset:7168
  v_cvt_pk_bf16_f32 v187, v218, v219
 WL 11
  v_mfma_f32_16x16x32_bf16 v[64:67], a[160:163], v[144:147], v[252:255]
  buffer_load_dword v44, v42, s[20:23], s66 offen offset:512 sc1
 WL 10
 Mvav 64,164,160
  buffer_load_dword v45, v42, s[20:23], s66 offen offset:768 sc1
 WL 9
 Mvav 64,168,128
  s_sub_u32 s69, 6, s5
  v_exp_f32 v220, v220
 WL 8
 Mvav 64,172,112
  v_exp_f32 v221, v221
  v_mfma_f32_16x16x32_bf16 v[68:71], a[172:175], v[116:119], v[228:231]
  v_exp_f32 v222, v222
 Mvav 68,168,132
  v_exp_f32 v223, v223
 Mvav 68,164,164
  v_exp_f32 v96, v96
 Mvav 68,160,148
  v_exp_f32 v97, v97
  v_mfma_f32_16x16x32_bf16 v[72:75], a[160:163], v[152:155], v[232:235]
  v_exp_f32 v98, v98
 Mvav 72,164,168
  v_exp_f32 v99, v99
 Mvav 72,168,136
  v_exp_f32 v100, v100
 Mvav 72,172,120
  v_exp_f32 v101, v101
  v_mfma_f32_16x16x32_bf16 v[76:79], a[172:175], v[124:127], v[236:239]
  v_exp_f32 v102, v102
 Mvav 76,168,140
  v_exp_f32 v103, v103
 Mvav 76,164,172
 WL 0
  s_barrier
 Mvav 76,160,156
  ds_read_b128 a[144:147], v18 offset:24576
  v_cvt_pk_bf16_f32 v190, v220, v221
 Maav 128,208,176
  s_add_u32 m0, s67, 32768
  v_exp_f32 v104, v104
 Maav 132,208,180
  ds_read_b128 a[148:151], v18 offset:25600
  v_cvt_pk_bf16_f32 v191, v222, v223
 Maav 136,208,184
  buffer_load_dwordx4 v16, s[20:23], s68 offen offset:0 sc1 lds
 Maav 140,208,188
  ds_read_b128 a[152:155], v18 offset:26624
  v_cvt_pk_bf16_f32 v80, v96, v97
 Maav 12,176,188
  v_exp_f32 v105, v105
 Maav 8,176,184
  v_exp_f32 v106, v106
 Maav 4,176,180
  ds_read_b128 a[156:159], v18 offset:27648
  v_cvt_pk_bf16_f32 v81, v98, v99
 Maav 0,176,176
  v_exp_f32 v107, v107
 Maav 16,180,176
  ds_read_b128 a[160:163], v18 offset:28672
  v_cvt_pk_bf16_f32 v84, v100, v101
 Maav 20,180,180
  buffer_load_dwordx4 v16, s[20:23], s68 offen offset:1024 sc1 lds
 Maav 24,180,184
  v_exp_f32 v108, v108
 Maav 28,180,188
  ds_read_b128 a[164:167], v18 offset:29696
  v_cvt_pk_bf16_f32 v85, v102, v103
 Maav 44,184,188
  v_exp_f32 v109, v109
 Maav 40,184,184
  ds_read_b128 a[168:171], v18 offset:30720
  v_cvt_pk_bf16_f32 v88, v104, v105
 Maav 36,184,180
  v_exp_f32 v110, v110
 Maav 32,184,176
  ds_read_b128 a[172:175], v18 offset:31744
  v_cvt_pk_bf16_f32 v89, v106, v107
 Maav 48,188,176
  buffer_load_dwordx4 v16, s[20:23], s68 offen offset:2048 sc1 lds
 Maav 52,188,180
  v_exp_f32 v111, v111
 Maav 56,188,184
  v_exp_f32 v64, v64
 Maav 60,188,188
  v_exp_f32 v65, v65
 Maav 76,192,188
  v_exp_f32 v66, v66
 Maav 72,192,184
  v_exp_f32 v67, v67
 Maav 68,192,180
  v_exp_f32 v68, v68
 Maav 64,192,176
  v_exp_f32 v69, v69
 Maav 80,196,176
  buffer_load_dwordx4 v16, s[20:23], s68 offen offset:3072 sc1 lds
 Maav 84,196,180
  s_add_u32 s68, s68, 4096
  v_add_f32 v248, v240, v228
  v_add_f32 v249, v241, v228
 Maav 88,196,184
  v_add_f32 v250, v242, v228
  v_add_f32 v251, v243, v228
 Maav 92,196,188
  v_add_f32 v252, v244, v228
  v_add_f32 v253, v245, v228
 Maav 108,200,188
  v_add_f32 v254, v246, v228
  v_add_f32 v255, v247, v228
 Maav 104,200,184
  v_exp_f32 v70, v70
 Maav 100,200,180
  v_exp_f32 v71, v71
 Maav 96,200,176
  v_exp_f32 v72, v72
 Maav 112,204,176
  v_exp_f32 v73, v73
 Maav 116,204,180
  v_exp_f32 v74, v74
 Maav 120,204,184
 WL 6
  v_exp_f32 v75, v75
 Maav 124,204,188
 WL 7
  v_exp_f32 v76, v76
  v_mfma_f32_16x16x32_bf16 v[196:199], a[144:147], v[148:151], v[248:251]
  ds_read_b128 a[176:179], v19 offset:16384
  s_add_u32 m0, s67, 36864
 Mvav 196,148,164
  buffer_load_dwordx4 v16, s[20:23], s68 offen offset:0 sc1 lds
 WL 6
 Mvav 196,152,132
  ds_read_b128 a[180:183], v19 offset:17408
  v_cvt_pk_bf16_f32 v92, v108, v109
 WL 6
 Mvav 196,156,116
  v_exp_f32 v77, v77
  v_mfma_f32_16x16x32_bf16 v[200:203], a[156:159], v[120:123], v[232:235]
  v_exp_f32 v78, v78
 Mvav 200,152,136
  ds_read_b128 a[184:187], v19 offset:18432
  v_cvt_pk_bf16_f32 v93, v110, v111
 Mvav 200,148,168
  v_exp_f32 v79, v79
 Mvav 200,144,152
  ds_read_b128 a[188:191], v19 offset:19456
  v_cvt_pk_bf16_f32 v82, v64, v65
  v_mfma_f32_16x16x32_bf16 v[204:207], a[144:147], v[156:159], v[236:239]
  buffer_load_dwordx4 v16, s[20:23], s68 offen offset:1024 sc1 lds
 Mvav 204,148,172
 WL 6
  v_cvt_pk_bf16_f32 v83, v66, v67
  v_cvt_pk_bf16_f32 v86, v68, v69
 Mvav 204,152,140
  ds_read_b128 a[192:195], v19 offset:20480
  v_cvt_pk_bf16_f32 v87, v70, v71
 Mvav 204,156,124
 WL 8
  v_exp_f32 v196, v196
  v_mfma_f32_16x16x32_bf16 v[212:215], a[160:163], v[148:151], v[252:255]
  ds_read_b128 a[196:199], v19 offset:21504
  v_cvt_pk_bf16_f32 v90, v72, v73
 Mvav 212,164,164
 WL 7
  v_exp_f32 v197, v197
 Mvav 212,168,132
 WL 6
  v_exp_f32 v198, v198
 Mvav 212,172,116
  ds_read_b128 a[200:203], v19 offset:22528
  v_cvt_pk_bf16_f32 v91, v74, v75
  v_mfma_f32_16x16x32_bf16 v[216:219], a[172:175], v[120:123], v[232:235]
  buffer_load_dwordx4 v16, s[20:23], s68 offen offset:2048 sc1 lds
 Mvav 216,168,136
  ds_read_b128 a[204:207], v19 offset:23552
  v_cvt_pk_bf16_f32 v94, v76, v77
 Mvav 216,164,168
  v_exp_f32 v199, v199
 Mvav 216,160,152
  v_exp_f32 v200, v200
  v_mfma_f32_16x16x32_bf16 v[220:223], a[160:163], v[156:159], v[236:239]
  v_exp_f32 v201, v201
 Mvav 220,164,172
  v_exp_f32 v202, v202
 Mvav 220,168,140
  v_exp_f32 v203, v203
 Mvav 220,172,124
  buffer_load_dwordx4 v16, s[20:23], s68 offen offset:3072 sc1 lds
  s_add_u32 s68, s68, 12288
  v_exp_f32 v204, v204
  v_cvt_pk_bf16_f32 v95, v78, v79
  v_exp_f32 v205, v205
  v_cvt_pk_bf16_f32 v180, v196, v197
  v_exp_f32 v206, v206
  v_cvt_pk_bf16_f32 v181, v198, v199
  v_exp_f32 v207, v207
  v_cvt_pk_bf16_f32 v184, v200, v201
  v_exp_f32 v212, v212
  v_cvt_pk_bf16_f32 v185, v202, v203
  v_exp_f32 v213, v213
  v_cvt_pk_bf16_f32 v188, v204, v205
  v_exp_f32 v214, v214
  v_cvt_pk_bf16_f32 v189, v206, v207
  v_exp_f32 v215, v215
  v_cvt_pk_bf16_f32 v182, v212, v213
  v_exp_f32 v216, v216
  v_cvt_pk_bf16_f32 v183, v214, v215
 WL 0
  s_barrier
  v_mov_b32 v224, v10
  ds_read_b128 a[144:147], v18 offset:40960
  v_exp_f32 v217, v217
 Maav 128,208,80
  s_add_u32 m0, s67, 49152
  v_exp_f32 v218, v218
 Maav 132,208,84
  ds_read_b128 a[148:151], v18 offset:41984
  v_cvt_pk_bf16_f32 v186, v216, v217
 Maav 136,208,88
  buffer_load_dwordx4 v16, s[20:23], s68 offen offset:0 sc1 lds
 Maav 140,208,92
  ds_read_b128 a[152:155], v18 offset:43008
  v_mov_b32 v225, v10
 Maav 12,176,92
  v_exp_f32 v219, v219
 Maav 8,176,88
  v_exp_f32 v220, v220
 Maav 4,176,84
  ds_read_b128 a[156:159], v18 offset:44032
  v_cvt_pk_bf16_f32 v187, v218, v219
 Maav 0,176,80
  v_exp_f32 v221, v221
 Maav 16,180,80
  ds_read_b128 a[160:163], v18 offset:45056
  v_cvt_pk_bf16_f32 v190, v220, v221
 Maav 20,180,84
  buffer_load_dwordx4 v16, s[20:23], s68 offen offset:1024 sc1 lds
 Maav 24,180,88
  v_exp_f32 v222, v222
 Maav 28,180,92
  ds_read_b128 a[164:167], v18 offset:46080
  v_mov_b32 v226, v10
 Maav 44,184,92
  v_exp_f32 v223, v223
 Maav 40,184,88
  ds_read_b128 a[168:171], v18 offset:47104
  v_cvt_pk_bf16_f32 v191, v222, v223
 Maav 36,184,84
  v_mov_b32 v227, v10
  v_mov_b32 v228, v11
 Maav 32,184,80
  ds_read_b128 a[172:175], v18 offset:48128
  v_mov_b32 v229, v11
 Maav 48,188,80
  buffer_load_dwordx4 v16, s[20:23], s68 offen offset:2048 sc1 lds
 Maav 52,188,84
  v_mov_b32 v230, v11
  v_mov_b32 v231, v11
 Maav 56,188,88
 Maav 60,188,92
 Maav 76,192,92
 Maav 72,192,88
 Maav 68,192,84
 Maav 64,192,80
 Maav 80,196,80
  buffer_load_dwordx4 v16, s[20:23], s68 offen offset:3072 sc1 lds
 Maav 84,196,84
  s_add_u32 s68, s68, 4096
  v_add_f32 v248, v240, v232
  v_add_f32 v249, v241, v232
 Maav 88,196,88
  v_add_f32 v250, v242, v232
  v_add_f32 v251, v243, v232
 Maav 92,196,92
  v_add_f32 v252, v244, v232
  v_add_f32 v253, v245, v232
 Maav 108,200,92
  v_add_f32 v254, v246, v232
  v_add_f32 v255, v247, v232
 Maav 104,200,88
 Maav 100,200,84
 Maav 96,200,80
 Maav 112,204,80
 Maav 116,204,84
 Maav 120,204,88
 Maav 124,204,92
 WL 7
 WL 6
 WL 5
  v_mfma_f32_16x16x32_bf16 v[104:107], a[144:147], v[152:155], v[248:251]
  ds_read_b128 a[176:179], v19 offset:32768
  s_add_u32 m0, s67, 53248
 Mvav 104,148,168
  buffer_load_dwordx4 v16, s[20:23], s68 offen offset:0 sc1 lds
 Mvav 104,152,136
  ds_read_b128 a[180:183], v19 offset:33792
 WL 6
 Mvav 104,156,120
  v_mfma_f32_16x16x32_bf16 v[108:111], a[156:159], v[124:127], v[236:239]
  v_accvgpr_read_b32 v40, a128
  v_subrev_u32 v41, 0x1f800000, v40
 Mvav 108,152,140
  ds_read_b128 a[184:187], v19 offset:34816
 WL 5
 Mvav 108,148,172
 WL 6
  v_rcp_f32 v40, v40
 Mvav 108,144,156
  ds_read_b128 a[188:191], v19 offset:35840
  v_max_u32 v43, v43, v41
  v_mfma_f32_16x16x32_bf16 v[72:75], a[160:163], v[152:155], v[252:255]
  buffer_load_dwordx4 v16, s[20:23], s68 offen offset:1024 sc1 lds
 Mvav 72,164,168
 WL 5
  v_exp_f32 v104, v104
 Mvav 72,168,136
  ds_read_b128 a[192:195], v19 offset:36864
  v_mul_f32 v40, v40, v20
 WL 5
 Mvav 72,172,120
  v_exp_f32 v105, v105
  v_mfma_f32_16x16x32_bf16 v[76:79], a[172:175], v[124:127], v[236:239]
  v_exp_f32 v106, v106
 Mvav 76,168,140
  ds_read_b128 a[196:199], v19 offset:37888
  v_cvt_pk_bf16_f32 v88, v104, v105
 Mvav 76,164,172
  v_exp_f32 v107, v107
 Mvav 76,160,156
  ds_read_b128 a[200:203], v19 offset:38912
  v_cvt_pk_bf16_f32 v89, v106, v107
  buffer_load_dwordx4 v16, s[20:23], s68 offen offset:2048 sc1 lds
  v_accvgpr_read_b32 v48, a0
  v_exp_f32 v108, v108
  v_accvgpr_read_b32 v49, a1
  ds_read_b128 a[204:207], v19 offset:39936
  v_exp_f32 v109, v109
  v_exp_f32 v110, v110
  v_cvt_pk_bf16_f32 v92, v108, v109
  v_exp_f32 v111, v111
  v_mov_b32 v232, v12
  v_exp_f32 v72, v72
  v_cvt_pk_bf16_f32 v93, v110, v111
  v_exp_f32 v73, v73
  v_mov_b32 v233, v12
  v_exp_f32 v74, v74
  v_cvt_pk_bf16_f32 v90, v72, v73
  buffer_load_dwordx4 v16, s[20:23], s68 offen offset:3072 sc1 lds
  s_add_u32 s68, s68, 12288
  v_exp_f32 v75, v75
  v_mov_b32 v234, v12
  v_exp_f32 v76, v76
  v_cvt_pk_bf16_f32 v91, v74, v75
  v_exp_f32 v77, v77
  v_mov_b32 v235, v12
  v_exp_f32 v78, v78
  v_cvt_pk_bf16_f32 v94, v76, v77
  v_exp_f32 v79, v79
  v_accvgpr_read_b32 v50, a2
  v_cvt_pk_bf16_f32 v95, v78, v79
  v_accvgpr_read_b32 v51, a3
  v_pk_mul_f32 v[48:49], v[48:49], v[40:41] op_sel_hi:[1,0]
  v_pk_mul_f32 v[50:51], v[50:51], v[40:41] op_sel_hi:[1,0]
  v_cvt_pk_bf16_f32 v48, v48, v49
  v_cvt_pk_bf16_f32 v49, v50, v51
  v_accvgpr_read_b32 v52, a16
  v_accvgpr_read_b32 v53, a17
  v_accvgpr_read_b32 v54, a18
  v_accvgpr_read_b32 v55, a19
  v_pk_mul_f32 v[52:53], v[52:53], v[40:41] op_sel_hi:[1,0]
  v_pk_mul_f32 v[54:55], v[54:55], v[40:41] op_sel_hi:[1,0]
 WL 0
  s_barrier
  v_cvt_pk_bf16_f32 v50, v52, v53
  ds_read_b128 a[144:147], v18 offset:57344
  v_cvt_pk_bf16_f32 v51, v54, v55
 Maav 132,208,180
  ds_read_b128 a[148:151], v18 offset:58368
  s_add_u32 m0, s67, 0
 Maav 136,208,184
  buffer_store_dwordx4 v[48:51], v16, s[20:23], s58 offen offset:0 sc1
 Maav 140,208,188
  ds_read_b128 a[152:155], v18 offset:59392
  v_accvgpr_read_b32 v56, a32
 Maav 12,176,188
  ds_read_b128 a[156:159], v18 offset:60416
  v_accvgpr_read_b32 v57, a33
 Maav 8,176,184
  buffer_load_dwordx4 v16, s[20:23], s68 offen offset:0 sc1 lds
 Maav 4,176,180
  ds_read_b128 a[160:163], v18 offset:61440
  v_accvgpr_read_b32 v58, a34
 Maav 20,180,180
  ds_read_b128 a[164:167], v18 offset:62464
  v_accvgpr_read_b32 v59, a35
 Maav 24,180,184
  buffer_load_dwordx4 v16, s[20:23], s68 offen offset:1024 sc1 lds
 Maav 28,180,188
  ds_read_b128 a[168:171], v18 offset:63488
  v_pk_mul_f32 v[56:57], v[56:57], v[40:41] op_sel_hi:[1,0]
 Maav 44,184,188
  ds_read_b128 a[172:175], v18 offset:64512
  v_add_u32 v18, -65536, v18
 Maav 40,184,184
  ds_read_b128 v[144:147], v47 offset:0
  v_pk_mul_f32 v[58:59], v[58:59], v[40:41] op_sel_hi:[1,0]
 Maav 36,184,180
  buffer_load_dwordx4 v16, s[20:23], s68 offen offset:2048 sc1 lds
 Maav 52,188,180
  ds_read_b128 v[160:163], v47 offset:1024
  v_cvt_pk_bf16_f32 v56, v56, v57
 Maav 56,188,184
  ds_read_b128 v[128:131], v47 offset:2048
  v_cvt_pk_bf16_f32 v57, v58, v59
 Maav 60,188,188
  ds_read_b128 v[112:115], v47 offset:3072
  v_accvgpr_read_b32 v60, a48
 Maav 76,192,188
  v_add_f32 v248, v240, v236
  v_add_f32 v249, v241, v236
 Maav 72,192,184
  v_add_f32 v250, v242, v236
  v_add_f32 v251, v243, v236
 Maav 68,192,180
  buffer_load_dwordx4 v16, s[20:23], s68 offen offset:3072 sc1 lds
 Maav 84,196,180
  s_add_u32 s68, s68, 4096
  v_add_f32 v252, v244, v236
  v_add_f32 v253, v245, v236
 Maav 88,196,184
  v_add_f32 v254, v246, v236
  v_add_f32 v255, v247, v236
 Maav 92,196,188
  ds_read_b128 v[148:151], v47 offset:4096
  v_accvgpr_read_b32 v61, a49
 Maav 108,200,188
  ds_read_b128 v[164:167], v47 offset:5120
  v_accvgpr_read_b32 v62, a50
 Maav 104,200,184
  ds_read_b128 v[132:135], v47 offset:6144
  v_accvgpr_read_b32 v63, a51
 Maav 100,200,180
  ds_read_b128 v[116:119], v47 offset:7168
  v_pk_mul_f32 v[60:61], v[60:61], v[40:41] op_sel_hi:[1,0]
 Maav 116,204,180
  ds_read_b128 v[152:155], v47 offset:8192
  v_pk_mul_f32 v[62:63], v[62:63], v[40:41] op_sel_hi:[1,0]
 Maav 120,204,184
  ds_read_b128 v[168:171], v47 offset:9216
  v_cvt_pk_bf16_f32 v58, v60, v61
 Maav 124,204,188
  ds_read_b128 v[136:139], v47 offset:10240
  v_cvt_pk_bf16_f32 v59, v62, v63
 WL 14
  v_mfma_f32_16x16x32_bf16 v[204:207], a[144:147], v[156:159], v[248:251]
  ds_read_b128 a[176:179], v19 offset:49152
  s_add_u32 m0, s67, 4096
 Mvav 204,148,172
  buffer_load_dwordx4 v16, s[20:23], s68 offen offset:0 sc1 lds
 Mvav 204,152,140
  ds_read_b128 v[120:123], v47 offset:11264
  s_add_u32 s49, s58, 8192
 Mvav 204,156,124
  ds_read_b128 a[180:183], v19 offset:50176
 WL 14
  v_mfma_f32_16x16x32_bf16 v[220:223], a[160:163], v[156:159], v[252:255]
  buffer_store_dwordx4 v[56:59], v16, s[20:23], s49 offen offset:0 sc1
 Mvav 220,164,172
  v_accvgpr_read_b32 v48, a64
  v_accvgpr_read_b32 v49, a65
 Mvav 220,168,140
  ds_read_b128 a[184:187], v19 offset:51200
  v_accvgpr_read_b32 v50, a66
 Mvav 220,172,124
  v_exp_f32 v204, v204
  ds_read_b128 v[156:159], v47 offset:12288
  v_exp_f32 v205, v205
  ds_read_b128 a[188:191], v19 offset:52224
  v_exp_f32 v206, v206
  buffer_load_dwordx4 v16, s[20:23], s68 offen offset:1024 sc1 lds
  v_cvt_pk_bf16_f32 v188, v204, v205
  ds_read_b128 v[172:175], v47 offset:13312
  v_exp_f32 v207, v207
  ds_read_b128 a[192:195], v19 offset:53248
  v_exp_f32 v220, v220
  v_exp_f32 v221, v221
  v_cvt_pk_bf16_f32 v189, v206, v207
  v_exp_f32 v222, v222
  v_cvt_pk_bf16_f32 v190, v220, v221
  ds_read_b128 a[196:199], v19 offset:54272
  v_exp_f32 v223, v223
  ds_read_b128 v[140:143], v47 offset:14336
  v_cvt_pk_bf16_f32 v191, v222, v223
  v_mov_b32 v236, v13
  ds_read_b128 v[124:127], v47 offset:15360
  v_mov_b32 v237, v13
  v_mov_b32 v238, v13
  ds_read_b128 a[200:203], v19 offset:55296
  v_mov_b32 v239, v13
  v_add_f32 v248, v240, v224
  buffer_load_dwordx4 v16, s[20:23], s68 offen offset:2048 sc1 lds
  v_add_f32 v249, v241, v224
  v_add_f32 v250, v242, v224
  v_add_f32 v251, v243, v224
  v_add_f32 v252, v244, v224
  ds_read_b128 a[204:207], v19 offset:56320
  v_add_f32 v253, v245, v224
  v_add_f32 v254, v246, v224
  v_add_f32 v255, v247, v224
  v_accvgpr_read_b32 v51, a67
  v_pk_mul_f32 v[48:49], v[48:49], v[40:41] op_sel_hi:[1,0]
  v_pk_mul_f32 v[50:51], v[50:51], v[40:41] op_sel_hi:[1,0]
  v_cvt_pk_bf16_f32 v48, v48, v49
  v_cvt_pk_bf16_f32 v49, v50, v51
  v_accvgpr_read_b32 v52, a80
  v_accvgpr_read_b32 v53, a81
  v_accvgpr_read_b32 v54, a82
  v_accvgpr_read_b32 v55, a83
  v_pk_mul_f32 v[52:53], v[52:53], v[40:41] op_sel_hi:[1,0]
  v_pk_mul_f32 v[54:55], v[54:55], v[40:41] op_sel_hi:[1,0]
  s_add_u32 s49, s58, 16384
  v_cvt_pk_bf16_f32 v50, v52, v53
  v_cvt_pk_bf16_f32 v51, v54, v55
  buffer_load_dwordx4 v16, s[20:23], s68 offen offset:3072 sc1 lds
  s_add_u32 s68, s68, 12288
  buffer_store_dwordx4 v[48:51], v16, s[20:23], s49 offen offset:0 sc1
  v_accvgpr_read_b32 v56, a96
  v_accvgpr_read_b32 v57, a97
  v_accvgpr_read_b32 v58, a98
  v_accvgpr_read_b32 v59, a99
  v_pk_mul_f32 v[56:57], v[56:57], v[40:41] op_sel_hi:[1,0]
  v_pk_mul_f32 v[58:59], v[58:59], v[40:41] op_sel_hi:[1,0]
  v_cvt_pk_bf16_f32 v56, v56, v57
  v_cvt_pk_bf16_f32 v57, v58, v59
  v_accvgpr_read_b32 v60, a112
  v_accvgpr_read_b32 v61, a113
  v_accvgpr_read_b32 v62, a114
  v_accvgpr_read_b32 v63, a115
  v_pk_mul_f32 v[60:61], v[60:61], v[40:41] op_sel_hi:[1,0]
  v_pk_mul_f32 v[62:63], v[62:63], v[40:41] op_sel_hi:[1,0]
  v_cvt_pk_bf16_f32 v58, v60, v61
  s_add_u32 s49, s58, 24576
  v_cvt_pk_bf16_f32 v59, v62, v63
  buffer_store_dwordx4 v[56:59], v16, s[20:23], s49 offen offset:0 sc1
  v_accvgpr_read_b32 v40, a132
  v_subrev_u32 v41, 0x1f800000, v40
  v_rcp_f32 v40, v40
  v_max_u32 v43, v43, v41
  v_mul_f32 v40, v40, v22
  v_accvgpr_read_b32 v48, a4
  v_accvgpr_read_b32 v49, a5
 WL 0
  s_waitcnt vmcnt(20)
  s_barrier
  v_accvgpr_read_b32 v50, a6
  ds_read_b128 a[144:147], v18 offset:40960
  ds_read_b128 a[148:151], v18 offset:41984
 Maav 136,208,88
  ds_read_b128 a[152:155], v18 offset:43008
  s_add_u32 m0, s67, 16384
 Maav 140,208,92
  ds_read_b128 a[156:159], v18 offset:44032
  v_accvgpr_read_b32 v51, a7
 Maav 12,176,92
  ds_read_b128 a[160:163], v18 offset:45056
  v_pk_mul_f32 v[48:49], v[48:49], v[40:41] op_sel_hi:[1,0]
 Maav 8,176,88
  ds_read_b128 a[164:167], v18 offset:46080
  v_pk_mul_f32 v[50:51], v[50:51], v[40:41] op_sel_hi:[1,0]
 Maav 24,180,88
  ds_read_b128 a[168:171], v18 offset:47104
  v_cvt_pk_bf16_f32 v48, v48, v49
 Maav 28,180,92
  ds_read_b128 a[172:175], v18 offset:48128
  v_cvt_pk_bf16_f32 v49, v50, v51
 Maav 44,184,92
  buffer_load_dwordx4 v16, s[20:23], s68 offen offset:0 sc1 lds
 Maav 40,184,88
  buffer_load_dwordx4 v16, s[20:23], s68 offen offset:1024 sc1 lds
 Maav 56,188,88
  buffer_load_dwordx4 v16, s[20:23], s68 offen offset:2048 sc1 lds
 Maav 60,188,92
  v_accvgpr_read_b32 v52, a20
  v_accvgpr_read_b32 v53, a21
 Maav 76,192,92
  buffer_load_dwordx4 v16, s[20:23], s68 offen offset:3072 sc1 lds
 Maav 72,192,88
  s_add_u32 s68, s68, 4096
  v_accvgpr_read_b32 v54, a22
  v_accvgpr_read_b32 v55, a23
 Maav 88,196,88
  v_pk_mul_f32 v[52:53], v[52:53], v[40:41] op_sel_hi:[1,0]
  v_pk_mul_f32 v[54:55], v[54:55], v[40:41] op_sel_hi:[1,0]
 Maav 92,196,92
  v_cvt_pk_bf16_f32 v50, v52, v53
  v_cvt_pk_bf16_f32 v51, v54, v55
 Maav 108,200,92
  buffer_store_dwordx4 v[48:51], v16, s[20:23], s58 offen offset:2048 sc1
 Maav 104,200,88
  v_accvgpr_read_b32 v56, a36
  v_accvgpr_read_b32 v57, a37
 Maav 120,204,88
 WL 6
  v_accvgpr_read_b32 v58, a38
  v_accvgpr_read_b32 v59, a39
 Maav 124,204,92
 WL 7
  v_pk_mul_f32 v[56:57], v[56:57], v[40:41] op_sel_hi:[1,0]
  v_pk_mul_f32 v[58:59], v[58:59], v[40:41] op_sel_hi:[1,0]
  v_mfma_f32_16x16x32_bf16 v[96:99], a[144:147], v[144:147], v[224:227]
  ds_read_b128 a[176:179], v19 offset:0
  s_add_u32 m0, s67, 20480
 Mvav 96,148,160
  buffer_load_dwordx4 v16, s[20:23], s68 offen offset:0 sc1 lds
 WL 6
 Mvav 96,152,128
 WL 5
  v_cvt_pk_bf16_f32 v56, v56, v57
  v_cvt_pk_bf16_f32 v57, v58, v59
 Mvav 96,156,112
  v_accvgpr_read_b32 v60, a52
  v_accvgpr_read_b32 v61, a53
  v_mfma_f32_16x16x32_bf16 v[100:103], a[156:159], v[116:119], v[228:231]
  ds_read_b128 a[180:183], v19 offset:1024
  v_accvgpr_read_b32 v62, a54
 Mvav 100,152,132
  v_accvgpr_read_b32 v63, a55
  v_pk_mul_f32 v[60:61], v[60:61], v[40:41] op_sel_hi:[1,0]
 Mvav 100,148,164
  v_pk_mul_f32 v[62:63], v[62:63], v[40:41] op_sel_hi:[1,0]
  v_cvt_pk_bf16_f32 v58, v60, v61
 Mvav 100,144,148
  s_add_u32 s49, s58, 8192
  v_cvt_pk_bf16_f32 v59, v62, v63
  v_mfma_f32_16x16x32_bf16 v[104:107], a[144:147], v[152:155], v[232:235]
  ds_read_b128 a[184:187], v19 offset:2048
 Mvav 104,148,168
  buffer_store_dwordx4 v[56:59], v16, s[20:23], s49 offen offset:2048 sc1
 Mvav 104,152,136
  v_accvgpr_read_b32 v48, a68
  v_accvgpr_read_b32 v49, a69
 Mvav 104,156,120
  v_exp_f32 v96, v96
  v_mfma_f32_16x16x32_bf16 v[108:111], a[156:159], v[124:127], v[236:239]
  ds_read_b128 a[188:191], v19 offset:3072
  v_accvgpr_read_b32 v50, a70
 Mvav 108,152,140
  buffer_load_dwordx4 v16, s[20:23], s68 offen offset:1024 sc1 lds
 Mvav 108,148,172
 WL 6
  v_exp_f32 v97, v97
 Mvav 108,144,156
 WL 7
  v_exp_f32 v98, v98
  v_mfma_f32_16x16x32_bf16 v[64:67], a[160:163], v[144:147], v[224:227]
  ds_read_b128 a[192:195], v19 offset:4096
  v_cvt_pk_bf16_f32 v80, v96, v97
 Mvav 64,164,160
 WL 6
  v_exp_f32 v99, v99
 Mvav 64,168,128
 WL 5
  v_exp_f32 v100, v100
 Mvav 64,172,112
  v_exp_f32 v101, v101
  v_mfma_f32_16x16x32_bf16 v[68:71], a[172:175], v[116:119], v[228:231]
  v_exp_f32 v102, v102
 Mvav 68,168,132
  ds_read_b128 a[196:199], v19 offset:5120
  v_cvt_pk_bf16_f32 v81, v98, v99
 Mvav 68,164,164
  v_exp_f32 v103, v103
 Mvav 68,160,148
  v_exp_f32 v104, v104
  v_mfma_f32_16x16x32_bf16 v[72:75], a[160:163], v[152:155], v[232:235]
  buffer_load_dwordx4 v16, s[20:23], s68 offen offset:2048 sc1 lds
 Mvav 72,164,168
  ds_read_b128 a[200:203], v19 offset:6144
  v_cvt_pk_bf16_f32 v84, v100, v101
 Mvav 72,168,136
  v_exp_f32 v105, v105
 Mvav 72,172,120
  v_exp_f32 v106, v106
  v_mfma_f32_16x16x32_bf16 v[76:79], a[172:175], v[124:127], v[236:239]
  v_exp_f32 v107, v107
 Mvav 76,168,140
  ds_read_b128 a[204:207], v19 offset:7168
  v_cvt_pk_bf16_f32 v85, v102, v103
 Mvav 76,164,172
  v_exp_f32 v108, v108
 Mvav 76,160,156
  v_exp_f32 v109, v109
  v_exp_f32 v110, v110
  v_cvt_pk_bf16_f32 v88, v104, v105
  v_exp_f32 v111, v111
  v_cvt_pk_bf16_f32 v89, v106, v107
  v_exp_f32 v64, v64
  v_cvt_pk_bf16_f32 v92, v108, v109
  v_exp_f32 v65, v65
  v_cvt_pk_bf16_f32 v93, v110, v111
  buffer_load_dwordx4 v16, s[20:23], s68 offen offset:3072 sc1 lds
  s_add_u32 s68, s68, 12288
  v_exp_f32 v66, v66
  v_cvt_pk_bf16_f32 v82, v64, v65
  v_exp_f32 v67, v67
  v_add_u32 v19, -65536, v19
  v_exp_f32 v68, v68
  v_cvt_pk_bf16_f32 v83, v66, v67
  v_exp_f32 v69, v69
  v_accvgpr_read_b32 v51, a71
  v_exp_f32 v70, v70
  v_cvt_pk_bf16_f32 v86, v68, v69
  v_exp_f32 v71, v71
  v_pk_mul_f32 v[48:49], v[48:49], v[40:41] op_sel_hi:[1,0]
  v_exp_f32 v72, v72
  v_cvt_pk_bf16_f32 v87, v70, v71
  v_exp_f32 v73, v73
  v_pk_mul_f32 v[50:51], v[50:51], v[40:41] op_sel_hi:[1,0]
  v_exp_f32 v74, v74
  v_cvt_pk_bf16_f32 v90, v72, v73
  v_exp_f32 v75, v75
  v_cvt_pk_bf16_f32 v48, v48, v49
  v_exp_f32 v76, v76
  v_cvt_pk_bf16_f32 v91, v74, v75
  v_exp_f32 v77, v77
  v_cvt_pk_bf16_f32 v49, v50, v51
  v_exp_f32 v78, v78
  v_cvt_pk_bf16_f32 v94, v76, v77
 WL 0
  s_waitcnt vmcnt(22)
  s_barrier
  v_accvgpr_read_b32 v52, a84
  ds_read_b128 a[144:147], v18 offset:57344
  ds_read_b128 a[148:151], v18 offset:58368
 Maav 140,208,188
  ds_read_b128 a[152:155], v18 offset:59392
  s_add_u32 m0, s67, 32768
 Maav 12,176,188
  ds_read_b128 a[156:159], v18 offset:60416
  v_accvgpr_read_b32 v53, a85
 Maav 28,180,188
  ds_read_b128 a[160:163], v18 offset:61440
  v_accvgpr_read_b32 v54, a86
 Maav 44,184,188
  ds_read_b128 a[164:167], v18 offset:62464
  v_accvgpr_read_b32 v55, a87
 Maav 60,188,188
  ds_read_b128 a[168:171], v18 offset:63488
  v_pk_mul_f32 v[52:53], v[52:53], v[40:41] op_sel_hi:[1,0]
 Maav 76,192,188
  ds_read_b128 a[172:175], v18 offset:64512
  v_pk_mul_f32 v[54:55], v[54:55], v[40:41] op_sel_hi:[1,0]
 Maav 92,196,188
  buffer_load_dwordx4 v16, s[20:23], s68 offen offset:0 sc1 lds
 Maav 108,200,188
  buffer_load_dwordx4 v16, s[20:23], s68 offen offset:1024 sc1 lds
 Maav 124,204,188
  buffer_load_dwordx4 v16, s[20:23], s68 offen offset:2048 sc1 lds
  buffer_load_dwordx4 v16, s[20:23], s68 offen offset:3072 sc1 lds
  s_add_u32 s68, s68, 4096
 WL 7
  v_mfma_f32_16x16x32_bf16 v[192:195], a[144:147], v[144:147], v[224:227]
  ds_read_b128 a[176:179], v19 offset:49152
  s_add_u32 m0, s67, 36864
 WL 7
 Mvav 192,148,160
  buffer_load_dwordx4 v16, s[20:23], s68 offen offset:0 sc1 lds
 WL 6
 Mvav 192,152,128
 WL 5
  v_exp_f32 v79, v79
 Mvav 192,156,112
  v_cvt_pk_bf16_f32 v95, v78, v79
  v_cvt_pk_bf16_f32 v50, v52, v53
  v_mfma_f32_16x16x32_bf16 v[196:199], a[156:159], v[116:119], v[228:231]
  s_add_u32 s49, s58, 16384
  v_cvt_pk_bf16_f32 v51, v54, v55
 Mvav 196,152,132
  ds_read_b128 a[180:183], v19 offset:50176
 Mvav 196,148,164
  buffer_store_dwordx4 v[48:51], v16, s[20:23], s49 offen offset:2048 sc1
 Mvav 196,144,148
  v_accvgpr_read_b32 v56, a100
  v_accvgpr_read_b32 v57, a101
  v_mfma_f32_16x16x32_bf16 v[200:203], a[144:147], v[152:155], v[232:235]
  v_accvgpr_read_b32 v58, a102
  v_accvgpr_read_b32 v59, a103
 Mvav 200,148,168
  v_pk_mul_f32 v[56:57], v[56:57], v[40:41] op_sel_hi:[1,0]
  v_pk_mul_f32 v[58:59], v[58:59], v[40:41] op_sel_hi:[1,0]
 Mvav 200,152,136
  ds_read_b128 a[184:187], v19 offset:51200
  v_cvt_pk_bf16_f32 v56, v56, v57
 Mvav 200,156,120
  v_exp_f32 v192, v192
  v_mfma_f32_16x16x32_bf16 v[204:207], a[156:159], v[124:127], v[236:239]
  v_exp_f32 v193, v193
 Mvav 204,152,140
 WL 6
  v_exp_f32 v194, v194
 Mvav 204,148,172
  buffer_load_dwordx4 v16, s[20:23], s68 offen offset:1024 sc1 lds
 Mvav 204,144,156
  ds_read_b128 a[188:191], v19 offset:52224
  v_cvt_pk_bf16_f32 v176, v192, v193
  v_mfma_f32_16x16x32_bf16 v[208:211], a[160:163], v[144:147], v[224:227]
 WL 6
  v_exp_f32 v195, v195
 Mvav 208,164,160
 WL 5
  v_exp_f32 v196, v196
 Mvav 208,168,128
 WL 4
  v_exp_f32 v197, v197
 Mvav 208,172,112
  v_exp_f32 v198, v198
  v_mfma_f32_16x16x32_bf16 v[212:215], a[172:175], v[116:119], v[228:231]
  ds_read_b128 a[192:195], v19 offset:53248
  v_cvt_pk_bf16_f32 v177, v194, v195
 Mvav 212,168,132
  v_exp_f32 v199, v199
 Mvav 212,164,164
  v_exp_f32 v200, v200
 Mvav 212,160,148
  v_exp_f32 v201, v201
  v_mfma_f32_16x16x32_bf16 v[216:219], a[160:163], v[152:155], v[232:235]
  v_exp_f32 v202, v202
 Mvav 216,164,168
  ds_read_b128 a[196:199], v19 offset:54272
  v_cvt_pk_bf16_f32 v180, v196, v197
 Mvav 216,168,136
  v_exp_f32 v203, v203
 Mvav 216,172,120
  v_exp_f32 v204, v204
  v_mfma_f32_16x16x32_bf16 v[220:223], a[172:175], v[124:127], v[236:239]
  buffer_load_dwordx4 v16, s[20:23], s68 offen offset:2048 sc1 lds
 Mvav 220,168,140
  v_exp_f32 v205, v205
 Mvav 220,164,172
  ds_read_b128 a[200:203], v19 offset:55296
  v_cvt_pk_bf16_f32 v181, v198, v199
 Mvav 220,160,156
  v_exp_f32 v206, v206
  v_exp_f32 v207, v207
  v_cvt_pk_bf16_f32 v184, v200, v201
  v_exp_f32 v208, v208
  v_cvt_pk_bf16_f32 v185, v202, v203
  v_exp_f32 v209, v209
  v_cvt_pk_bf16_f32 v188, v204, v205
  ds_read_b128 a[204:207], v19 offset:56320
  v_exp_f32 v210, v210
  v_exp_f32 v211, v211
  v_cvt_pk_bf16_f32 v189, v206, v207
  v_cvt_pk_bf16_f32 v178, v208, v209
  v_cvt_pk_bf16_f32 v179, v210, v211
  v_cvt_pk_bf16_f32 v57, v58, v59
  v_accvgpr_read_b32 v60, a116
  v_accvgpr_read_b32 v61, a117
  v_accvgpr_read_b32 v62, a118
  v_accvgpr_read_b32 v63, a119
  v_pk_mul_f32 v[60:61], v[60:61], v[40:41] op_sel_hi:[1,0]
  v_pk_mul_f32 v[62:63], v[62:63], v[40:41] op_sel_hi:[1,0]
  s_add_u32 s49, s58, 24576
  v_cvt_pk_bf16_f32 v58, v60, v61
  v_cvt_pk_bf16_f32 v59, v62, v63
  buffer_store_dwordx4 v[56:59], v16, s[20:23], s49 offen offset:2048 sc1
  buffer_load_dwordx4 v16, s[20:23], s68 offen offset:3072 sc1 lds
  s_add_u32 s68, s68, 12288
  v_accvgpr_read_b32 v40, a136
  v_subrev_u32 v41, 0x1f800000, v40
  v_rcp_f32 v40, v40
  v_max_u32 v43, v43, v41
  v_mul_f32 v40, v40, v24
  v_accvgpr_read_b32 v48, a8
  v_accvgpr_read_b32 v49, a9
  v_accvgpr_read_b32 v50, a10
  v_accvgpr_read_b32 v51, a11
  v_pk_mul_f32 v[48:49], v[48:49], v[40:41] op_sel_hi:[1,0]
  v_pk_mul_f32 v[50:51], v[50:51], v[40:41] op_sel_hi:[1,0]
  v_cvt_pk_bf16_f32 v48, v48, v49
  v_cvt_pk_bf16_f32 v49, v50, v51
  v_accvgpr_read_b32 v52, a24
  v_accvgpr_read_b32 v53, a25
  v_accvgpr_read_b32 v54, a26
  v_accvgpr_read_b32 v55, a27
  v_pk_mul_f32 v[52:53], v[52:53], v[40:41] op_sel_hi:[1,0]
  v_pk_mul_f32 v[54:55], v[54:55], v[40:41] op_sel_hi:[1,0]
  v_cvt_pk_bf16_f32 v50, v52, v53
  v_cvt_pk_bf16_f32 v51, v54, v55
  buffer_store_dwordx4 v[48:51], v17, s[20:23], s58 offen offset:0 sc1
  v_accvgpr_read_b32 v56, a40
  v_accvgpr_read_b32 v57, a41
  v_accvgpr_read_b32 v58, a42
  v_accvgpr_read_b32 v59, a43
  v_pk_mul_f32 v[56:57], v[56:57], v[40:41] op_sel_hi:[1,0]
  v_pk_mul_f32 v[58:59], v[58:59], v[40:41] op_sel_hi:[1,0]
  v_cvt_pk_bf16_f32 v56, v56, v57
  v_cvt_pk_bf16_f32 v57, v58, v59
  v_accvgpr_read_b32 v60, a56
  v_accvgpr_read_b32 v61, a57
  v_accvgpr_read_b32 v62, a58
  v_accvgpr_read_b32 v63, a59
  v_pk_mul_f32 v[60:61], v[60:61], v[40:41] op_sel_hi:[1,0]
  v_pk_mul_f32 v[62:63], v[62:63], v[40:41] op_sel_hi:[1,0]
  v_cvt_pk_bf16_f32 v58, v60, v61
  s_add_u32 s49, s58, 8192
  v_cvt_pk_bf16_f32 v59, v62, v63
  buffer_store_dwordx4 v[56:59], v17, s[20:23], s49 offen offset:0 sc1
 WL 0
  s_waitcnt vmcnt(24)
  s_barrier
  v_accvgpr_read_b32 v48, a72
  ds_read_b128 a[144:147], v18 offset:8192
  v_accvgpr_read_b32 v49, a73
  v_accvgpr_read_b32 v50, a74
  v_mfma_f32_16x16x32_bf16 a[128:131], a[208:211], v[80:83], 0
  s_add_u32 m0, s67, 49152
  v_accvgpr_read_b32 v51, a75
  v_pk_mul_f32 v[48:49], v[48:49], v[40:41] op_sel_hi:[1,0]
  v_mfma_f32_16x16x32_bf16 a[0:3], a[176:179], v[80:83], 0
  ds_read_b128 a[148:151], v18 offset:9216
  v_pk_mul_f32 v[50:51], v[50:51], v[40:41] op_sel_hi:[1,0]
  v_mfma_f32_16x16x32_bf16 a[16:19], a[180:183], v[80:83], 0
  buffer_load_dwordx4 v16, s[20:23], s68 offen offset:0 sc1 lds
  v_mfma_f32_16x16x32_bf16 a[32:35], a[184:187], v[80:83], 0
  ds_read_b128 a[152:155], v18 offset:10240
  v_cvt_pk_bf16_f32 v48, v48, v49
  v_mfma_f32_16x16x32_bf16 a[48:51], a[188:191], v[80:83], 0
  v_cvt_pk_bf16_f32 v49, v50, v51
  v_accvgpr_read_b32 v52, a88
  v_mfma_f32_16x16x32_bf16 a[64:67], a[192:195], v[80:83], 0
  v_accvgpr_read_b32 v53, a89
  v_accvgpr_read_b32 v54, a90
  v_mfma_f32_16x16x32_bf16 a[80:83], a[196:199], v[80:83], 0
  ds_read_b128 a[156:159], v18 offset:11264
  v_accvgpr_read_b32 v55, a91
  v_mfma_f32_16x16x32_bf16 a[96:99], a[200:203], v[80:83], 0
  v_pk_mul_f32 v[52:53], v[52:53], v[40:41] op_sel_hi:[1,0]
  v_pk_mul_f32 v[54:55], v[54:55], v[40:41] op_sel_hi:[1,0]
  v_mfma_f32_16x16x32_bf16 a[112:115], a[204:207], v[80:83], 0
  ds_read_b128 a[160:163], v18 offset:12288
  v_cvt_pk_bf16_f32 v50, v52, v53
  v_mfma_f32_16x16x32_bf16 a[132:135], a[208:211], v[84:87], 0
  buffer_load_dwordx4 v16, s[20:23], s68 offen offset:1024 sc1 lds
  v_mfma_f32_16x16x32_bf16 a[4:7], a[176:179], v[84:87], 0
  s_add_u32 s49, s58, 16384
  v_cvt_pk_bf16_f32 v51, v54, v55
  v_mfma_f32_16x16x32_bf16 a[20:23], a[180:183], v[84:87], 0
  ds_read_b128 a[164:167], v18 offset:13312
  v_mfma_f32_16x16x32_bf16 a[36:39], a[184:187], v[84:87], 0
  buffer_store_dwordx4 v[48:51], v17, s[20:23], s49 offen offset:0 sc1
  v_mfma_f32_16x16x32_bf16 a[52:55], a[188:191], v[84:87], 0
  ds_read_b128 a[168:171], v18 offset:14336
  v_accvgpr_read_b32 v56, a104
  v_mfma_f32_16x16x32_bf16 a[68:71], a[192:195], v[84:87], 0
  v_accvgpr_read_b32 v57, a105
  v_accvgpr_read_b32 v58, a106
  v_mfma_f32_16x16x32_bf16 a[84:87], a[196:199], v[84:87], 0
  ds_read_b128 a[172:175], v18 offset:15360
  v_accvgpr_read_b32 v59, a107
  v_mfma_f32_16x16x32_bf16 a[100:103], a[200:203], v[84:87], 0
  buffer_load_dwordx4 v16, s[20:23], s68 offen offset:2048 sc1 lds
  v_mfma_f32_16x16x32_bf16 a[116:119], a[204:207], v[84:87], 0
  v_pk_mul_f32 v[56:57], v[56:57], v[40:41] op_sel_hi:[1,0]
  v_pk_mul_f32 v[58:59], v[58:59], v[40:41] op_sel_hi:[1,0]
  v_mfma_f32_16x16x32_bf16 a[136:139], a[208:211], v[88:91], 0
  v_cvt_pk_bf16_f32 v56, v56, v57
  v_cvt_pk_bf16_f32 v57, v58, v59
  v_mfma_f32_16x16x32_bf16 a[8:11], a[176:179], v[88:91], 0
  v_accvgpr_read_b32 v60, a120
  v_accvgpr_read_b32 v61, a121
  v_mfma_f32_16x16x32_bf16 a[24:27], a[180:183], v[88:91], 0
  v_accvgpr_read_b32 v62, a122
  v_accvgpr_read_b32 v63, a123
  v_mfma_f32_16x16x32_bf16 a[40:43], a[184:187], v[88:91], 0
  v_pk_mul_f32 v[60:61], v[60:61], v[40:41] op_sel_hi:[1,0]
  v_pk_mul_f32 v[62:63], v[62:63], v[40:41] op_sel_hi:[1,0]
  v_mfma_f32_16x16x32_bf16 a[56:59], a[188:191], v[88:91], 0
  s_add_u32 s49, s58, 24576
  v_cvt_pk_bf16_f32 v58, v60, v61
  v_cvt_pk_bf16_f32 v59, v62, v63
  v_mfma_f32_16x16x32_bf16 a[72:75], a[192:195], v[88:91], 0
  buffer_store_dwordx4 v[56:59], v17, s[20:23], s49 offen offset:0 sc1
  v_mfma_f32_16x16x32_bf16 a[88:91], a[196:199], v[88:91], 0
  buffer_load_dwordx4 v16, s[20:23], s68 offen offset:3072 sc1 lds
  v_mfma_f32_16x16x32_bf16 a[104:107], a[200:203], v[88:91], 0
  s_add_u32 s68, s68, 4096
  v_accvgpr_read_b32 v40, a140
  v_subrev_u32 v41, 0x1f800000, v40
  v_mfma_f32_16x16x32_bf16 a[120:123], a[204:207], v[88:91], 0
  v_rcp_f32 v40, v40
  v_max_u32 v43, v43, v41
  v_mul_f32 v40, v40, v26
  v_accvgpr_read_b32 v48, a12
  v_accvgpr_read_b32 v49, a13
  v_accvgpr_read_b32 v50, a14
  v_accvgpr_read_b32 v51, a15
  v_mfma_f32_16x16x32_bf16 a[140:143], a[208:211], v[92:95], 0
  v_pk_mul_f32 v[48:49], v[48:49], v[40:41] op_sel_hi:[1,0]
  v_pk_mul_f32 v[50:51], v[50:51], v[40:41] op_sel_hi:[1,0]
  v_cvt_pk_bf16_f32 v48, v48, v49
  v_cvt_pk_bf16_f32 v49, v50, v51
  v_accvgpr_read_b32 v52, a28
  v_accvgpr_read_b32 v53, a29
  v_accvgpr_read_b32 v54, a30
  v_accvgpr_read_b32 v55, a31
  v_mfma_f32_16x16x32_bf16 a[12:15], a[176:179], v[92:95], 0
  v_pk_mul_f32 v[52:53], v[52:53], v[40:41] op_sel_hi:[1,0]
  v_pk_mul_f32 v[54:55], v[54:55], v[40:41] op_sel_hi:[1,0]
  v_cvt_pk_bf16_f32 v50, v52, v53
  v_cvt_pk_bf16_f32 v51, v54, v55
  buffer_store_dwordx4 v[48:51], v17, s[20:23], s58 offen offset:2048 sc1
  v_accvgpr_read_b32 v56, a44
  v_accvgpr_read_b32 v57, a45
  v_accvgpr_read_b32 v58, a46
  v_accvgpr_read_b32 v59, a47
  v_mfma_f32_16x16x32_bf16 a[28:31], a[180:183], v[92:95], 0
  v_pk_mul_f32 v[56:57], v[56:57], v[40:41] op_sel_hi:[1,0]
  v_pk_mul_f32 v[58:59], v[58:59], v[40:41] op_sel_hi:[1,0]
  v_cvt_pk_bf16_f32 v56, v56, v57
  v_cvt_pk_bf16_f32 v57, v58, v59
  v_accvgpr_read_b32 v60, a60
  v_accvgpr_read_b32 v61, a61
  v_accvgpr_read_b32 v62, a62
  v_accvgpr_read_b32 v63, a63
  v_mfma_f32_16x16x32_bf16 a[44:47], a[184:187], v[92:95], 0
  s_add_u32 s49, s58, 8192
  v_pk_mul_f32 v[60:61], v[60:61], v[40:41] op_sel_hi:[1,0]
  v_pk_mul_f32 v[62:63], v[62:63], v[40:41] op_sel_hi:[1,0]
  v_cvt_pk_bf16_f32 v58, v60, v61
  v_cvt_pk_bf16_f32 v59, v62, v63
  buffer_store_dwordx4 v[56:59], v17, s[20:23], s49 offen offset:2048 sc1
  v_accvgpr_read_b32 v48, a76
  v_accvgpr_read_b32 v49, a77
  v_accvgpr_read_b32 v50, a78
  v_accvgpr_read_b32 v51, a79
  v_mfma_f32_16x16x32_bf16 a[60:63], a[188:191], v[92:95], 0
  v_pk_mul_f32 v[48:49], v[48:49], v[40:41] op_sel_hi:[1,0]
  v_pk_mul_f32 v[50:51], v[50:51], v[40:41] op_sel_hi:[1,0]
  v_cvt_pk_bf16_f32 v48, v48, v49
  v_cvt_pk_bf16_f32 v49, v50, v51
  v_accvgpr_read_b32 v52, a92
  v_accvgpr_read_b32 v53, a93
  v_accvgpr_read_b32 v54, a94
  v_accvgpr_read_b32 v55, a95
  v_mfma_f32_16x16x32_bf16 a[76:79], a[192:195], v[92:95], 0
  s_add_u32 s49, s58, 16384
  v_pk_mul_f32 v[52:53], v[52:53], v[40:41] op_sel_hi:[1,0]
  v_pk_mul_f32 v[54:55], v[54:55], v[40:41] op_sel_hi:[1,0]
  v_cvt_pk_bf16_f32 v50, v52, v53
  v_cvt_pk_bf16_f32 v51, v54, v55
  buffer_store_dwordx4 v[48:51], v17, s[20:23], s49 offen offset:2048 sc1
  v_accvgpr_read_b32 v56, a108
  v_accvgpr_read_b32 v57, a109
  v_accvgpr_read_b32 v58, a110
  v_accvgpr_read_b32 v59, a111
  v_mfma_f32_16x16x32_bf16 a[92:95], a[196:199], v[92:95], 0
  v_pk_mul_f32 v[56:57], v[56:57], v[40:41] op_sel_hi:[1,0]
  v_pk_mul_f32 v[58:59], v[58:59], v[40:41] op_sel_hi:[1,0]
  v_cvt_pk_bf16_f32 v56, v56, v57
  v_cvt_pk_bf16_f32 v57, v58, v59
  v_accvgpr_read_b32 v60, a124
  v_accvgpr_read_b32 v61, a125
  v_accvgpr_read_b32 v62, a126
  v_accvgpr_read_b32 v63, a127
  v_mfma_f32_16x16x32_bf16 a[108:111], a[200:203], v[92:95], 0
  v_pk_mul_f32 v[60:61], v[60:61], v[40:41] op_sel_hi:[1,0]
  v_pk_mul_f32 v[62:63], v[62:63], v[40:41] op_sel_hi:[1,0]
  v_mfma_f32_16x16x32_bf16 a[124:127], a[204:207], v[92:95], 0
  s_add_u32 s49, s58, 24576
  v_cvt_pk_bf16_f32 v58, v60, v61
  v_cvt_pk_bf16_f32 v59, v62, v63
  buffer_store_dwordx4 v[56:59], v17, s[20:23], s49 offen offset:2048 sc1
  s_cmp_lg_u32 s69, 0
  s_cbranch_scc1 LloopD
Lfinal:
 WL 7
  v_mfma_f32_16x16x32_bf16 v[96:99], a[144:147], v[144:147], v[248:251]
  ds_read_b128 a[176:179], v19 offset:0
  s_add_u32 m0, s67, 53248
 WL 7
 Mvav 96,148,160
  buffer_load_dwordx4 v16, s[20:23], s68 offen offset:0 sc1 lds
 WL 6
 Mvav 96,152,128
  ds_read_b128 a[180:183], v19 offset:1024
  v_add_u32 v47, 131072, v46
 WL 6
 Mvav 96,156,112
  v_exp_f32 v212, v212
  v_mfma_f32_16x16x32_bf16 v[100:103], a[156:159], v[116:119], v[228:231]
  ds_read_b128 a[184:187], v19 offset:2048
 Mvav 100,152,132
  v_exp_f32 v213, v213
 Mvav 100,148,164
  ds_read_b128 a[188:191], v19 offset:3072
  v_cvt_pk_bf16_f32 v182, v212, v213
 Mvav 100,144,148
  buffer_load_dwordx4 v16, s[20:23], s68 offen offset:1024 sc1 lds
  v_mfma_f32_16x16x32_bf16 v[104:107], a[144:147], v[152:155], v[232:235]
  ds_read_b128 a[192:195], v19 offset:4096
 Mvav 104,148,168
  v_exp_f32 v214, v214
 Mvav 104,152,136
  v_exp_f32 v215, v215
 Mvav 104,156,120
  ds_read_b128 a[196:199], v19 offset:5120
  v_cvt_pk_bf16_f32 v183, v214, v215
  v_mfma_f32_16x16x32_bf16 v[108:111], a[156:159], v[124:127], v[236:239]
  v_exp_f32 v216, v216
 Mvav 108,152,140
  ds_read_b128 a[200:203], v19 offset:6144
 Mvav 108,148,172
  buffer_load_dwordx4 v16, s[20:23], s68 offen offset:2048 sc1 lds
 Mvav 108,144,156
  ds_read_b128 a[204:207], v19 offset:7168
 WL 11
  v_mfma_f32_16x16x32_bf16 v[64:67], a[160:163], v[144:147], v[252:255]
 WL 10
  v_exp_f32 v217, v217
 Mvav 64,164,160
 WL 9
  v_exp_f32 v218, v218
 Mvav 64,168,128
 WL 8
  v_exp_f32 v219, v219
 Mvav 64,172,112
  v_exp_f32 v220, v220
  v_mfma_f32_16x16x32_bf16 v[68:71], a[172:175], v[116:119], v[228:231]
  v_exp_f32 v221, v221
 Mvav 68,168,132
  buffer_load_dwordx4 v16, s[20:23], s68 offen offset:3072 sc1 lds
 Mvav 68,164,164
  s_add_u32 s68, s68, 12288
  v_exp_f32 v222, v222
 Mvav 68,160,148
  v_exp_f32 v223, v223
  v_mfma_f32_16x16x32_bf16 v[72:75], a[160:163], v[152:155], v[232:235]
  v_exp_f32 v96, v96
 Mvav 72,164,168
  v_exp_f32 v97, v97
 Mvav 72,168,136
  v_exp_f32 v98, v98
 Mvav 72,172,120
  v_exp_f32 v99, v99
  v_mfma_f32_16x16x32_bf16 v[76:79], a[172:175], v[124:127], v[236:239]
  v_exp_f32 v100, v100
 Mvav 76,168,140
  v_exp_f32 v101, v101
 Mvav 76,164,172
 WL 0
  s_waitcnt vmcnt(18)
  s_barrier
 Mvav 76,160,156
  ds_read_b128 a[144:147], v18 offset:24576
  v_cvt_pk_bf16_f32 v186, v216, v217
 Maav 128,208,176
  s_add_u32 m0, s67, 0
  v_cvt_pk_bf16_f32 v187, v218, v219
  v_cvt_pk_bf16_f32 v190, v220, v221
 Maav 132,208,180
  ds_read_b128 a[148:151], v18 offset:25600
  v_cvt_pk_bf16_f32 v191, v222, v223
 Maav 136,208,184
  buffer_load_dwordx4 v16, s[20:23], s68 offen offset:0 sc1 lds
 Maav 140,208,188
  ds_read_b128 a[152:155], v18 offset:26624
  v_cvt_pk_bf16_f32 v80, v96, v97
 Maav 12,176,188
  v_exp_f32 v102, v102
 Maav 8,176,184
  v_exp_f32 v103, v103
 Maav 4,176,180
  ds_read_b128 a[156:159], v18 offset:27648
  v_cvt_pk_bf16_f32 v81, v98, v99
 Maav 0,176,176
  v_exp_f32 v104, v104
 Maav 16,180,176
  ds_read_b128 a[160:163], v18 offset:28672
  v_cvt_pk_bf16_f32 v84, v100, v101
 Maav 20,180,180
  buffer_load_dwordx4 v16, s[20:23], s68 offen offset:1024 sc1 lds
 Maav 24,180,184
  v_exp_f32 v105, v105
 Maav 28,180,188
  ds_read_b128 a[164:167], v18 offset:29696
  v_cvt_pk_bf16_f32 v85, v102, v103
 Maav 44,184,188
  v_exp_f32 v106, v106
 Maav 40,184,184
  ds_read_b128 a[168:171], v18 offset:30720
  v_cvt_pk_bf16_f32 v88, v104, v105
 Maav 36,184,180
  v_exp_f32 v107, v107
 Maav 32,184,176
  ds_read_b128 a[172:175], v18 offset:31744
  v_cvt_pk_bf16_f32 v89, v106, v107
 Maav 48,188,176
  buffer_load_dwordx4 v16, s[20:23], s68 offen offset:2048 sc1 lds
 Maav 52,188,180
  v_exp_f32 v108, v108
 Maav 56,188,184
  v_exp_f32 v109, v109
 Maav 60,188,188
  v_exp_f32 v110, v110
 Maav 76,192,188
  v_exp_f32 v111, v111
 Maav 72,192,184
  v_exp_f32 v64, v64
 Maav 68,192,180
  v_exp_f32 v65, v65
 Maav 64,192,176
  v_exp_f32 v66, v66
 Maav 80,196,176
  buffer_load_dwordx4 v16, s[20:23], s68 offen offset:3072 sc1 lds
 Maav 84,196,180
  s_add_u32 s68, s68, 4096
  v_add_f32 v248, v240, v228
  v_add_f32 v249, v241, v228
 Maav 88,196,184
  v_add_f32 v250, v242, v228
  v_add_f32 v251, v243, v228
 Maav 92,196,188
  v_add_f32 v252, v244, v228
  v_add_f32 v253, v245, v228
 Maav 108,200,188
  v_add_f32 v254, v246, v228
  v_add_f32 v255, v247, v228
 Maav 104,200,184
  v_exp_f32 v67, v67
 Maav 100,200,180
  v_exp_f32 v68, v68
 Maav 96,200,176
  v_exp_f32 v69, v69
 Maav 112,204,176
  v_exp_f32 v70, v70
 Maav 116,204,180
  v_exp_f32 v71, v71
 Maav 120,204,184
 WL 6
  v_exp_f32 v72, v72
 Maav 124,204,188
 WL 7
  v_exp_f32 v73, v73
  v_mfma_f32_16x16x32_bf16 v[196:199], a[144:147], v[148:151], v[248:251]
  ds_read_b128 a[176:179], v19 offset:16384
  s_add_u32 m0, s67, 4096
 Mvav 196,148,164
  buffer_load_dwordx4 v16, s[20:23], s68 offen offset:0 sc1 lds
 WL 6
 Mvav 196,152,132
  ds_read_b128 a[180:183], v19 offset:17408
  v_cvt_pk_bf16_f32 v92, v108, v109
 WL 6
 Mvav 196,156,116
  buffer_load_dwordx2 v[38:39], off, s[36:39], 0 offset:224 sc1
  v_mfma_f32_16x16x32_bf16 v[200:203], a[156:159], v[120:123], v[232:235]
  ds_read_b128 a[184:187], v19 offset:18432
  v_cvt_pk_bf16_f32 v93, v110, v111
 Mvav 200,152,136
  v_exp_f32 v74, v74
 Mvav 200,148,168
  ds_read_b128 a[188:191], v19 offset:19456
  v_cvt_pk_bf16_f32 v82, v64, v65
 Mvav 200,144,152
  buffer_load_dwordx4 v16, s[20:23], s68 offen offset:1024 sc1 lds
  v_mfma_f32_16x16x32_bf16 v[204:207], a[144:147], v[156:159], v[236:239]
  ds_read_b128 a[192:195], v19 offset:20480
  v_cvt_pk_bf16_f32 v83, v66, v67
 Mvav 204,148,172
  v_exp_f32 v75, v75
 Mvav 204,152,140
 WL 8
  v_exp_f32 v76, v76
 Mvav 204,156,124
  ds_read_b128 a[196:199], v19 offset:21504
  v_cvt_pk_bf16_f32 v86, v68, v69
  v_mfma_f32_16x16x32_bf16 v[212:215], a[160:163], v[148:151], v[252:255]
 WL 8
  v_exp_f32 v77, v77
 Mvav 212,164,164
  ds_read_b128 a[200:203], v19 offset:22528
  v_cvt_pk_bf16_f32 v87, v70, v71
 WL 8
 Mvav 212,168,132
  buffer_load_dwordx4 v16, s[20:23], s68 offen offset:2048 sc1 lds
 WL 7
 Mvav 212,172,116
  ds_read_b128 a[204:207], v19 offset:23552
  v_cvt_pk_bf16_f32 v90, v72, v73
  v_mfma_f32_16x16x32_bf16 v[216:219], a[172:175], v[120:123], v[232:235]
  v_exp_f32 v78, v78
 Mvav 216,168,136
  v_exp_f32 v79, v79
 Mvav 216,164,168
  v_exp_f32 v196, v196
 Mvav 216,160,152
  v_exp_f32 v197, v197
  v_mfma_f32_16x16x32_bf16 v[220:223], a[160:163], v[156:159], v[236:239]
  v_exp_f32 v198, v198
 Mvav 220,164,172
  buffer_load_dwordx4 v16, s[20:23], s68 offen offset:3072 sc1 lds
 Mvav 220,168,140
  s_add_u32 s68, s68, 12288
  v_exp_f32 v199, v199
 Mvav 220,172,124
  v_exp_f32 v200, v200
  v_exp_f32 v201, v201
  v_cvt_pk_bf16_f32 v91, v74, v75
  v_exp_f32 v202, v202
  v_cvt_pk_bf16_f32 v94, v76, v77
  v_exp_f32 v203, v203
  v_cvt_pk_bf16_f32 v95, v78, v79
  v_exp_f32 v204, v204
  v_cvt_pk_bf16_f32 v180, v196, v197
  v_exp_f32 v205, v205
  v_cvt_pk_bf16_f32 v181, v198, v199
  v_exp_f32 v206, v206
  v_cvt_pk_bf16_f32 v184, v200, v201
 WL 0
  s_waitcnt vmcnt(18)
  s_barrier
  v_cvt_pk_bf16_f32 v185, v202, v203
  ds_read_b128 a[144:147], v18 offset:40960
  v_exp_f32 v207, v207
 Maav 128,208,80
  v_exp_f32 v212, v212
 Maav 132,208,84
  ds_read_b128 a[148:151], v18 offset:41984
  v_cvt_pk_bf16_f32 v188, v204, v205
 Maav 136,208,88
  v_exp_f32 v213, v213
 Maav 140,208,92
  ds_read_b128 a[152:155], v18 offset:43008
  v_cvt_pk_bf16_f32 v189, v206, v207
 Maav 12,176,92
  v_exp_f32 v214, v214
 Maav 8,176,88
  v_exp_f32 v215, v215
 Maav 4,176,84
  ds_read_b128 a[156:159], v18 offset:44032
  v_cvt_pk_bf16_f32 v182, v212, v213
 Maav 0,176,80
  v_exp_f32 v216, v216
 Maav 16,180,80
  ds_read_b128 a[160:163], v18 offset:45056
  v_cvt_pk_bf16_f32 v183, v214, v215
 Maav 20,180,84
  v_exp_f32 v217, v217
 Maav 24,180,88
  v_exp_f32 v218, v218
 Maav 28,180,92
  ds_read_b128 a[164:167], v18 offset:46080
  v_cvt_pk_bf16_f32 v186, v216, v217
 Maav 44,184,92
  v_exp_f32 v219, v219
 Maav 40,184,88
  ds_read_b128 a[168:171], v18 offset:47104
  v_cvt_pk_bf16_f32 v187, v218, v219
 Maav 36,184,84
  v_exp_f32 v220, v220
 Maav 32,184,80
  ds_read_b128 a[172:175], v18 offset:48128
 Maav 48,188,80
  v_exp_f32 v221, v221
 Maav 52,188,84
  v_exp_f32 v222, v222
 Maav 56,188,88
  v_exp_f32 v223, v223
 Maav 60,188,92
  v_cvt_pk_bf16_f32 v190, v220, v221
  v_cvt_pk_bf16_f32 v191, v222, v223
 Maav 76,192,92
 Maav 72,192,88
 Maav 68,192,84
 Maav 64,192,80
 Maav 80,196,80
  v_add_f32 v248, v240, v232
  v_add_f32 v249, v241, v232
 Maav 84,196,84
  v_add_f32 v250, v242, v232
  v_add_f32 v251, v243, v232
 Maav 88,196,88
  v_add_f32 v252, v244, v232
  v_add_f32 v253, v245, v232
 Maav 92,196,92
  v_add_f32 v254, v246, v232
  v_add_f32 v255, v247, v232
 Maav 108,200,92
  s_waitcnt vmcnt(3)
  v_readfirstlane_b32 s28, v38
  v_readfirstlane_b32 s29, v39
 Maav 104,200,88
  s_cmp_eq_u64 s[28:29], 0
  s_cbranch_scc1 Lpoll_hS
Lback_hS:
  s_lshl_b32 s26, s4, 3
 Maav 100,200,84
  s_bfm_b64 s[30:31], s26, 0
  s_and_b64 s[30:31], s[30:31], s[28:29]
  s_bcnt1_i32_b64 s30, s[30:31]
 Maav 96,200,80
  s_lshl_b32 s31, s30, 14
  s_add_u32 s45, s45, s31
  s_mul_i32 s30, s30, 73728
 Maav 112,204,80
  s_add_u32 s44, s44, s30
  s_lshr_b64 s[28:29], s[28:29], s26
  s_and_b32 s26, s28, 255
 Maav 116,204,84
  s_bcnt1_i32_b32 s26, s26
  s_add_u32 s46, s45, 0
 WL 7
 Maav 120,204,88
  buffer_load_dwordx4 a[212:215], v16, s[20:23], s46 offen offset:0 sc1
 Maav 124,204,92
  buffer_load_dwordx4 a[216:219], v16, s[20:23], s46 offen offset:2048 sc1
  v_mfma_f32_16x16x32_bf16 v[104:107], a[144:147], v[152:155], v[248:251]
  ds_read_b128 a[176:179], v19 offset:32768
 WL 7
 Mvav 104,148,168
  buffer_load_dwordx4 a[220:223], v17, s[20:23], s46 offen offset:0 sc1
 WL 6
 Mvav 104,152,136
  ds_read_b128 a[180:183], v19 offset:33792
 WL 6
 Mvav 104,156,120
  buffer_load_dwordx4 a[224:227], v17, s[20:23], s46 offen offset:2048 sc1
  v_mfma_f32_16x16x32_bf16 v[108:111], a[156:159], v[124:127], v[236:239]
  ds_read_b128 a[184:187], v19 offset:34816
  s_add_u32 s46, s45, 8192
 Mvav 108,152,140
  ds_write_b128 v47, a[0:3] offset:0
 Mvav 108,148,172
  ds_read_b128 a[188:191], v19 offset:35840
 WL 8
 Mvav 108,144,156
  ds_write_b128 v47, a[16:19] offset:1024
  v_mfma_f32_16x16x32_bf16 v[72:75], a[160:163], v[152:155], v[252:255]
  ds_read_b128 a[192:195], v19 offset:36864
 WL 9
 Mvav 72,164,168
  ds_write_b128 v47, a[32:35] offset:2048
 WL 9
 Mvav 72,168,136
  ds_write_b128 v47, a[48:51] offset:3072
 WL 9
 Mvav 72,172,120
  ds_read_b128 a[196:199], v19 offset:37888
  v_mfma_f32_16x16x32_bf16 v[76:79], a[172:175], v[124:127], v[236:239]
  ds_write_b128 v47, a[64:67] offset:4096
 Mvav 76,168,140
  ds_read_b128 a[200:203], v19 offset:38912
 Mvav 76,164,172
  ds_write_b128 v47, a[80:83] offset:5120
 Mvav 76,160,156
  ds_read_b128 a[204:207], v19 offset:39936
  ds_write_b128 v47, a[96:99] offset:6144
  ds_write_b128 v47, a[112:115] offset:7168
  ds_write_b32 v14, a128 offset:0
  buffer_load_dwordx4 a[228:231], v16, s[20:23], s46 offen offset:0 sc1
  buffer_load_dwordx4 a[232:235], v16, s[20:23], s46 offen offset:2048 sc1
  buffer_load_dwordx4 a[236:239], v17, s[20:23], s46 offen offset:0 sc1
  buffer_load_dwordx4 a[240:243], v17, s[20:23], s46 offen offset:2048 sc1
  v_exp_f32 v104, v104
  v_exp_f32 v105, v105
  v_exp_f32 v106, v106
  v_cvt_pk_bf16_f32 v88, v104, v105
  v_exp_f32 v107, v107
  v_exp_f32 v108, v108
  v_cvt_pk_bf16_f32 v89, v106, v107
  v_exp_f32 v109, v109
  v_exp_f32 v110, v110
  v_cvt_pk_bf16_f32 v92, v108, v109
 WL 3
  s_barrier
  ds_read_b128 a[144:147], v18 offset:57344
  v_exp_f32 v111, v111
 Maav 132,208,180
  ds_read_b128 a[148:151], v18 offset:58368
  v_cvt_pk_bf16_f32 v93, v110, v111
 Maav 136,208,184
  v_exp_f32 v72, v72
 Maav 140,208,188
  ds_read_b128 a[152:155], v18 offset:59392
 Maav 12,176,188
  ds_read_b128 a[156:159], v18 offset:60416
 Maav 8,176,184
  v_exp_f32 v73, v73
 Maav 4,176,180
  ds_read_b128 a[160:163], v18 offset:61440
  v_cvt_pk_bf16_f32 v90, v72, v73
 Maav 20,180,180
  ds_read_b128 a[164:167], v18 offset:62464
 Maav 24,180,184
  v_exp_f32 v74, v74
 Maav 28,180,188
  ds_read_b128 a[168:171], v18 offset:63488
 Maav 44,184,188
  ds_read_b128 a[172:175], v18 offset:64512
 Maav 40,184,184
  v_exp_f32 v75, v75
 Maav 36,184,180
  v_exp_f32 v76, v76
 Maav 52,188,180
  v_exp_f32 v77, v77
 Maav 56,188,184
  v_exp_f32 v78, v78
 Maav 60,188,188
  v_exp_f32 v79, v79
 Maav 76,192,188
  v_add_f32 v248, v240, v236
  v_add_f32 v249, v241, v236
 Maav 72,192,184
  v_add_f32 v250, v242, v236
  v_add_f32 v251, v243, v236
 Maav 68,192,180
  v_add_f32 v252, v244, v236
  v_add_f32 v253, v245, v236
 Maav 84,196,180
  v_add_f32 v254, v246, v236
  v_add_f32 v255, v247, v236
 Maav 88,196,184
  v_cvt_pk_bf16_f32 v91, v74, v75
  v_cvt_pk_bf16_f32 v94, v76, v77
 Maav 92,196,188
  v_cvt_pk_bf16_f32 v95, v78, v79
 Maav 108,200,188
 Maav 104,200,184
 Maav 100,200,180
 Maav 116,204,180
 Maav 120,204,184
 Maav 124,204,188
 WL 7
  v_mfma_f32_16x16x32_bf16 v[204:207], a[144:147], v[156:159], v[248:251]
  ds_read_b128 a[176:179], v19 offset:49152
 WL 7
 Mvav 204,148,172
 WL 6
 Mvav 204,152,140
 WL 5
 Mvav 204,156,124
  ds_read_b128 a[180:183], v19 offset:50176
 WL 5
  v_mfma_f32_16x16x32_bf16 v[220:223], a[160:163], v[156:159], v[252:255]
 WL 4
 WL 3
 Mvav 220,164,172
  ds_write_b128 v47, a[4:7] offset:8192
 Mvav 220,168,140
  ds_read_b128 a[184:187], v19 offset:51200
 WL 4
 Mvav 220,172,124
  ds_write_b128 v47, a[20:23] offset:9216
  ds_write_b128 v47, a[36:39] offset:10240
  ds_read_b128 a[188:191], v19 offset:52224
  v_exp_f32 v204, v204
  ds_write_b128 v47, a[52:55] offset:11264
  ds_write_b128 v47, a[68:71] offset:12288
  ds_read_b128 a[192:195], v19 offset:53248
  v_exp_f32 v205, v205
  ds_write_b128 v47, a[84:87] offset:13312
  v_cvt_pk_bf16_f32 v188, v204, v205
  ds_write_b128 v47, a[100:103] offset:14336
  ds_read_b128 a[196:199], v19 offset:54272
  v_exp_f32 v206, v206
  ds_write_b128 v47, a[116:119] offset:15360
  ds_write_b32 v14, a132 offset:4
  ds_read_b128 a[200:203], v19 offset:55296
  v_exp_f32 v207, v207
  v_exp_f32 v220, v220
  v_cvt_pk_bf16_f32 v189, v206, v207
  v_exp_f32 v221, v221
  ds_read_b128 a[204:207], v19 offset:56320
  v_exp_f32 v222, v222
  v_exp_f32 v223, v223
  v_cvt_pk_bf16_f32 v190, v220, v221
  v_cvt_pk_bf16_f32 v191, v222, v223
 WL 0
  s_waitcnt vmcnt(8)
  s_barrier
  s_add_u32 m0, s47, 12288
  s_nop 0
  buffer_load_dwordx4 v1, s[12:15], s44 offen lds
 Maav 136,208,88
  ds_read_b128 a[144:147], v19 offset:0
 Maav 140,208,92
  buffer_load_dwordx4 v2, s[12:15], s44 offen offset:1056 lds
 Maav 12,176,92
  ds_read_b128 a[148:151], v19 offset:1024
 Maav 8,176,88
  buffer_load_dwordx4 v3, s[12:15], s44 offen offset:2112 lds
 Maav 24,180,88
  ds_read_b128 a[152:155], v19 offset:2048
 Maav 28,180,92
  buffer_load_dwordx4 v4, s[12:15], s44 offen offset:3168 lds
 Maav 44,184,92
  ds_read_b128 a[156:159], v19 offset:3072
  s_add_u32 m0, s47, 16512
 Maav 40,184,88
  buffer_load_dwordx4 v5, s[12:15], s44 offen lds
 Maav 56,188,88
  ds_read_b128 a[160:163], v19 offset:4096
 Maav 60,188,92
  buffer_load_dwordx4 v6, s[12:15], s44 offen offset:1056 lds
 Maav 76,192,92
  ds_read_b128 a[164:167], v19 offset:5120
 Maav 72,192,88
  buffer_load_dwordx4 v7, s[12:15], s44 offen offset:2112 lds
 Maav 88,196,88
  ds_read_b128 a[168:171], v19 offset:6144
 Maav 92,196,92
  buffer_load_dwordx4 v8, s[12:15], s44 offen offset:3168 lds
 Maav 108,200,92
  ds_read_b128 a[172:175], v19 offset:7168
  s_add_u32 m0, s47, 20736
 Maav 104,200,88
  buffer_load_dwordx4 v9, s[20:23], s44 offen sc1 lds
 Maav 120,204,88
  s_add_u32 s46, s45, 16384
 Maav 124,204,92
 WL 7
 WL 6
 WL 5
 Maav 140,208,188
  buffer_load_dwordx4 a[176:179], v16, s[20:23], s46 offen offset:0 sc1
 Maav 12,144,188
  buffer_load_dwordx4 a[180:183], v16, s[20:23], s46 offen offset:2048 sc1
 Maav 28,148,188
  buffer_load_dwordx4 a[184:187], v17, s[20:23], s46 offen offset:0 sc1
 Maav 44,152,188
  buffer_load_dwordx4 a[188:191], v17, s[20:23], s46 offen offset:2048 sc1
 WL 4
 Maav 60,156,188
  s_add_u32 s46, s45, 24576
 WL 3
 WL 2
 Maav 76,160,188
  buffer_load_dwordx4 a[192:195], v16, s[20:23], s46 offen offset:0 sc1
 Maav 92,164,188
  buffer_load_dwordx4 a[196:199], v16, s[20:23], s46 offen offset:2048 sc1
 WL 1
 Maav 108,168,188
  buffer_load_dwordx4 a[200:203], v17, s[20:23], s46 offen offset:0 sc1
 WL 0
 Maav 124,172,188
  buffer_load_dwordx4 a[204:207], v17, s[20:23], s46 offen offset:2048 sc1
  s_add_u32 s46, s45, 32768
  buffer_load_dwordx4 a[144:147], v16, s[20:23], s46 offen offset:0 sc1
  buffer_load_dwordx4 a[148:151], v16, s[20:23], s46 offen offset:2048 sc1
  v_accvgpr_read_b32 v144, a8
  buffer_load_dwordx4 a[152:155], v17, s[20:23], s46 offen offset:0 sc1
  v_accvgpr_read_b32 v145, a9
  buffer_load_dwordx4 a[156:159], v17, s[20:23], s46 offen offset:2048 sc1
  s_add_u32 s46, s45, 40960
  buffer_load_dwordx4 a[160:163], v16, s[20:23], s46 offen offset:0 sc1
  v_accvgpr_read_b32 v146, a10
  buffer_load_dwordx4 a[164:167], v16, s[20:23], s46 offen offset:2048 sc1
  v_accvgpr_read_b32 v147, a11
  buffer_load_dwordx4 a[168:171], v17, s[20:23], s46 offen offset:0 sc1
  v_accvgpr_read_b32 v148, a24
  buffer_load_dwordx4 a[172:175], v17, s[20:23], s46 offen offset:2048 sc1
  v_accvgpr_read_b32 v149, a25
  v_accvgpr_read_b32 v150, a26
  v_accvgpr_read_b32 v151, a27
  v_accvgpr_read_b32 v152, a40
  v_accvgpr_read_b32 v153, a41
  v_accvgpr_read_b32 v154, a42
  v_accvgpr_read_b32 v155, a43
  v_accvgpr_read_b32 v156, a56
  v_accvgpr_read_b32 v157, a57
  v_accvgpr_read_b32 v158, a58
  v_accvgpr_read_b32 v159, a59
  v_accvgpr_read_b32 v160, a72
  v_accvgpr_read_b32 v161, a73
  v_accvgpr_read_b32 v162, a74
  v_accvgpr_read_b32 v163, a75
  v_accvgpr_read_b32 v164, a88
  v_accvgpr_read_b32 v165, a89
  v_accvgpr_read_b32 v166, a90
  v_accvgpr_read_b32 v167, a91
  v_accvgpr_read_b32 v168, a104
  v_accvgpr_read_b32 v169, a105
  v_accvgpr_read_b32 v170, a106
  v_accvgpr_read_b32 v171, a107
  v_accvgpr_read_b32 v172, a120
  v_accvgpr_read_b32 v173, a121
  v_accvgpr_read_b32 v174, a122
  v_accvgpr_read_b32 v175, a123
  v_accvgpr_read_b32 v40, a136
  v_accvgpr_read_b32 v128, a12
  v_accvgpr_read_b32 v129, a13
  v_accvgpr_read_b32 v130, a14
  v_accvgpr_read_b32 v131, a15
  v_accvgpr_read_b32 v132, a28
  v_accvgpr_read_b32 v133, a29
  v_accvgpr_read_b32 v134, a30
  v_accvgpr_read_b32 v135, a31
  v_accvgpr_read_b32 v136, a44
  v_accvgpr_read_b32 v137, a45
  v_accvgpr_read_b32 v138, a46
  v_accvgpr_read_b32 v139, a47
  v_accvgpr_read_b32 v140, a60
  v_accvgpr_read_b32 v141, a61
  v_accvgpr_read_b32 v142, a62
  v_accvgpr_read_b32 v143, a63
  v_accvgpr_read_b32 v112, a76
  v_accvgpr_read_b32 v113, a77
  v_accvgpr_read_b32 v114, a78
  v_accvgpr_read_b32 v115, a79
  v_accvgpr_read_b32 v116, a92
  v_accvgpr_read_b32 v117, a93
  v_accvgpr_read_b32 v118, a94
  v_accvgpr_read_b32 v119, a95
  v_accvgpr_read_b32 v120, a108
  v_accvgpr_read_b32 v121, a109
  v_accvgpr_read_b32 v122, a110
  v_accvgpr_read_b32 v123, a111
  v_accvgpr_read_b32 v124, a124
  v_accvgpr_read_b32 v125, a125
  v_accvgpr_read_b32 v126, a126
  v_accvgpr_read_b32 v127, a127
  v_accvgpr_read_b32 v42, a140
  s_barrier
  v_add_u32 v47, 65536, v46
  ds_read_b32 v36, v14 offset:8
  ds_read_b128 v[96:99], v47 offset:0
  ds_read_b128 v[100:103], v47 offset:1024
  ds_read_b128 v[104:107], v47 offset:2048
  ds_read_b128 v[108:111], v47 offset:3072
  ds_read_b128 v[64:67], v47 offset:4096
  ds_read_b128 v[68:71], v47 offset:5120
  ds_read_b128 v[72:75], v47 offset:6144
  ds_read_b128 v[76:79], v47 offset:7168
  ds_read_b32 v37, v14 offset:12
  ds_read_b128 v[192:195], v47 offset:8192
  ds_read_b128 v[196:199], v47 offset:9216
  ds_read_b128 v[200:203], v47 offset:10240
  ds_read_b128 v[204:207], v47 offset:11264
  ds_read_b128 v[208:211], v47 offset:12288
  ds_read_b128 v[212:215], v47 offset:13312
  ds_read_b128 v[216:219], v47 offset:14336
  ds_read_b128 v[220:223], v47 offset:15360
  s_add_u32 s44, s44, 147456
  s_add_u32 m0, s47, 125952
  s_nop 0
  buffer_load_dwordx4 v1, s[12:15], s44 offen lds
  buffer_load_dwordx4 v2, s[12:15], s44 offen offset:1056 lds
  buffer_load_dwordx4 v3, s[12:15], s44 offen offset:2112 lds
  buffer_load_dwordx4 v4, s[12:15], s44 offen offset:3168 lds
  s_add_u32 m0, s47, 130176
  s_nop 0
  buffer_load_dwordx4 v5, s[12:15], s44 offen lds
  buffer_load_dwordx4 v6, s[12:15], s44 offen offset:1056 lds
  buffer_load_dwordx4 v7, s[12:15], s44 offen offset:2112 lds
  buffer_load_dwordx4 v8, s[12:15], s44 offen offset:3168 lds
  s_add_u32 m0, s47, 134400
  s_nop 0
  buffer_load_dwordx4 v9, s[20:23], s44 offen sc1 lds
 WL 14
  v_add_f32 v28, v40, v36
  v_subrev_u32 v29, 0x1f800000, v28
  v_rcp_f32 v28, v28
  v_max_u32 v43, v43, v29
  v_mul_f32 v28, v28, v44
  v_mov_b32 v29, v28
  v_pk_add_f32 v[144:145], v[144:145], v[96:97]
  v_pk_add_f32 v[146:147], v[146:147], v[98:99]
  v_pk_mul_f32 v[144:145], v[144:145], v[28:29]
  v_pk_mul_f32 v[146:147], v[146:147], v[28:29]
  v_pk_add_f32 v[148:149], v[148:149], v[100:101]
  v_pk_add_f32 v[150:151], v[150:151], v[102:103]
  v_pk_mul_f32 v[148:149], v[148:149], v[28:29]
  v_pk_mul_f32 v[150:151], v[150:151], v[28:29]
  v_cvt_pk_bf16_f32 v144, v144, v145
  v_cvt_pk_bf16_f32 v145, v146, v147
  v_cvt_pk_bf16_f32 v146, v148, v149
  v_cvt_pk_bf16_f32 v147, v150, v151
  buffer_store_dwordx4 v[144:147], v17, s[20:23], s7 offen offset:0 sc1
  v_pk_add_f32 v[152:153], v[152:153], v[104:105]
  v_pk_add_f32 v[154:155], v[154:155], v[106:107]
  v_pk_mul_f32 v[152:153], v[152:153], v[28:29]
  v_pk_mul_f32 v[154:155], v[154:155], v[28:29]
 WL 13
  v_pk_add_f32 v[156:157], v[156:157], v[108:109]
  v_pk_add_f32 v[158:159], v[158:159], v[110:111]
  v_pk_mul_f32 v[156:157], v[156:157], v[28:29]
  v_pk_mul_f32 v[158:159], v[158:159], v[28:29]
  v_cvt_pk_bf16_f32 v152, v152, v153
  v_cvt_pk_bf16_f32 v153, v154, v155
  v_cvt_pk_bf16_f32 v154, v156, v157
  v_cvt_pk_bf16_f32 v155, v158, v159
  s_add_u32 s49, s7, 8192
  buffer_store_dwordx4 v[152:155], v17, s[20:23], s49 offen offset:0 sc1
 WL 12
  v_pk_add_f32 v[160:161], v[160:161], v[64:65]
  v_pk_add_f32 v[162:163], v[162:163], v[66:67]
  v_pk_mul_f32 v[160:161], v[160:161], v[28:29]
  v_pk_mul_f32 v[162:163], v[162:163], v[28:29]
 WL 11
  v_pk_add_f32 v[164:165], v[164:165], v[68:69]
  v_pk_add_f32 v[166:167], v[166:167], v[70:71]
  v_pk_mul_f32 v[164:165], v[164:165], v[28:29]
  v_pk_mul_f32 v[166:167], v[166:167], v[28:29]
  v_cvt_pk_bf16_f32 v160, v160, v161
  v_cvt_pk_bf16_f32 v161, v162, v163
  v_cvt_pk_bf16_f32 v162, v164, v165
  v_cvt_pk_bf16_f32 v163, v166, v167
  s_add_u32 s49, s7, 16384
  buffer_store_dwordx4 v[160:163], v17, s[20:23], s49 offen offset:0 sc1
 WL 10
  v_pk_add_f32 v[168:169], v[168:169], v[72:73]
  v_pk_add_f32 v[170:171], v[170:171], v[74:75]
  v_pk_mul_f32 v[168:169], v[168:169], v[28:29]
  v_pk_mul_f32 v[170:171], v[170:171], v[28:29]
 WL 9
  v_pk_add_f32 v[172:173], v[172:173], v[76:77]
  v_pk_add_f32 v[174:175], v[174:175], v[78:79]
  v_pk_mul_f32 v[172:173], v[172:173], v[28:29]
  v_pk_mul_f32 v[174:175], v[174:175], v[28:29]
  v_cvt_pk_bf16_f32 v168, v168, v169
  v_cvt_pk_bf16_f32 v169, v170, v171
  v_cvt_pk_bf16_f32 v170, v172, v173
  v_cvt_pk_bf16_f32 v171, v174, v175
  s_add_u32 s49, s7, 24576
  buffer_store_dwordx4 v[168:171], v17, s[20:23], s49 offen offset:0 sc1
 WL 8
  v_add_f32 v30, v42, v37
  v_subrev_u32 v31, 0x1f800000, v30
  v_rcp_f32 v30, v30
  v_max_u32 v43, v43, v31
  v_mul_f32 v30, v30, v45
  v_mov_b32 v31, v30
 WL 7
  v_pk_add_f32 v[128:129], v[128:129], v[192:193]
  v_pk_add_f32 v[130:131], v[130:131], v[194:195]
  v_pk_mul_f32 v[128:129], v[128:129], v[30:31]
  v_pk_mul_f32 v[130:131], v[130:131], v[30:31]
 WL 6
  v_pk_add_f32 v[132:133], v[132:133], v[196:197]
  v_pk_add_f32 v[134:135], v[134:135], v[198:199]
  v_pk_mul_f32 v[132:133], v[132:133], v[30:31]
  v_pk_mul_f32 v[134:135], v[134:135], v[30:31]
  v_cvt_pk_bf16_f32 v128, v128, v129
  v_cvt_pk_bf16_f32 v129, v130, v131
  v_cvt_pk_bf16_f32 v130, v132, v133
  v_cvt_pk_bf16_f32 v131, v134, v135
  buffer_store_dwordx4 v[128:131], v17, s[20:23], s7 offen offset:2048 sc1
 WL 5
  v_pk_add_f32 v[136:137], v[136:137], v[200:201]
  v_pk_add_f32 v[138:139], v[138:139], v[202:203]
  v_pk_mul_f32 v[136:137], v[136:137], v[30:31]
  v_pk_mul_f32 v[138:139], v[138:139], v[30:31]
 WL 4
  v_pk_add_f32 v[140:141], v[140:141], v[204:205]
  v_pk_add_f32 v[142:143], v[142:143], v[206:207]
  v_pk_mul_f32 v[140:141], v[140:141], v[30:31]
  v_pk_mul_f32 v[142:143], v[142:143], v[30:31]
  v_cvt_pk_bf16_f32 v136, v136, v137
  v_cvt_pk_bf16_f32 v137, v138, v139
  v_cvt_pk_bf16_f32 v138, v140, v141
  v_cvt_pk_bf16_f32 v139, v142, v143
  s_add_u32 s49, s7, 8192
  buffer_store_dwordx4 v[136:139], v17, s[20:23], s49 offen offset:2048 sc1
 WL 3
  v_pk_add_f32 v[112:113], v[112:113], v[208:209]
  v_pk_add_f32 v[114:115], v[114:115], v[210:211]
  v_pk_mul_f32 v[112:113], v[112:113], v[30:31]
  v_pk_mul_f32 v[114:115], v[114:115], v[30:31]
 WL 2
  v_pk_add_f32 v[116:117], v[116:117], v[212:213]
  v_pk_add_f32 v[118:119], v[118:119], v[214:215]
  v_pk_mul_f32 v[116:117], v[116:117], v[30:31]
  v_pk_mul_f32 v[118:119], v[118:119], v[30:31]
  v_cvt_pk_bf16_f32 v112, v112, v113
  v_cvt_pk_bf16_f32 v113, v114, v115
  v_cvt_pk_bf16_f32 v114, v116, v117
  v_cvt_pk_bf16_f32 v115, v118, v119
  s_add_u32 s49, s7, 16384
  buffer_store_dwordx4 v[112:115], v17, s[20:23], s49 offen offset:2048 sc1
 WL 1
  v_pk_add_f32 v[120:121], v[120:121], v[216:217]
  v_pk_add_f32 v[122:123], v[122:123], v[218:219]
  v_pk_mul_f32 v[120:121], v[120:121], v[30:31]
  v_pk_mul_f32 v[122:123], v[122:123], v[30:31]
 WL 0
  v_pk_add_f32 v[124:125], v[124:125], v[220:221]
  v_pk_add_f32 v[126:127], v[126:127], v[222:223]
  v_pk_mul_f32 v[124:125], v[124:125], v[30:31]
  v_pk_mul_f32 v[126:127], v[126:127], v[30:31]
  v_cvt_pk_bf16_f32 v120, v120, v121
  v_cvt_pk_bf16_f32 v121, v122, v123
  v_cvt_pk_bf16_f32 v122, v124, v125
  v_cvt_pk_bf16_f32 v123, v126, v127
  s_add_u32 s49, s7, 24576
  buffer_store_dwordx4 v[120:123], v17, s[20:23], s49 offen offset:2048 sc1
  s_branch Ldone
Lswitch0:
  v_mfma_f32_16x16x32_bf16 v[96:99], a[144:147], v[144:147], v[248:251]
  s_lshl_b32 s54, s2, 8
  v_lshlrev_b32 v29, 14, v0
  v_add_u32 v29, Lpre_back-Lpc0, v29
 Mvav 96,148,160
  s_add_u32 s54, s54, 0x4480000
  v_min_u32 v29, Lend-Lpc0-16388, v29
  v_add_u32 v47, 131072, v46
 Mvav 96,152,128
  global_load_dword a248, v29, s[100:101]
 Mvav 96,156,112
  s_mul_i32 s47, s3, 9472
  v_mov_b32 v43, 0
  v_mov_b32 v28, 0x3f803f80
  v_mfma_f32_16x16x32_bf16 v[100:103], a[156:159], v[116:119], v[228:231]
  s_lshr_b32 s46, s4, 3
  v_accvgpr_write_b32 a208, v28
  v_accvgpr_write_b32 a209, v28
 Mvav 100,152,132
 WL 0
  s_waitcnt vmcnt(12)
  s_barrier
 Mvav 100,148,164
  s_lshl_b32 s45, s46, 15
  v_accvgpr_write_b32 a210, v28
  v_accvgpr_write_b32 a211, v28
 Mvav 100,144,148
  ds_read_b128 a[212:215], v18 offset:24576
  v_and_b32 v42, 15, v0
  v_mfma_f32_16x16x32_bf16 v[104:107], a[144:147], v[152:155], v[232:235]
  s_add_u32 m0, s67, 32768
  s_sub_u32 s66, 15, s5
  v_lshlrev_b32 v42, 3, v42
 Mvav 104,148,168
  ds_read_b128 a[216:219], v18 offset:25600
  s_lshl_b32 s66, s66, 3
 Mvav 104,152,136
  buffer_load_dwordx4 v16, s[20:23], s68 offen offset:0 sc1 lds
 Mvav 104,156,120
  ds_read_b128 a[220:223], v18 offset:26624
  s_and_b32 s65, s3, 1
  v_mfma_f32_16x16x32_bf16 v[108:111], a[156:159], v[124:127], v[236:239]
  s_add_u32 s66, s66, s65
  v_exp_f32 v96, v96
 Mvav 108,152,140
  ds_read_b128 a[224:227], v18 offset:27648
  s_lshl_b32 s66, s66, 7
 Mvav 108,148,172
  buffer_load_dwordx4 v16, s[20:23], s68 offen offset:1024 sc1 lds
 Mvav 108,144,156
  ds_read_b128 a[228:231], v18 offset:28672
  s_add_u32 s66, s66, 0x4400000
  v_mfma_f32_16x16x32_bf16 v[64:67], a[160:163], v[144:147], v[252:255]
  buffer_load_dword v44, v42, s[20:23], s66 offen offset:512 sc1
 Mvav 64,164,160
  ds_read_b128 a[232:235], v18 offset:29696
  s_sub_u32 s24, s58, s45
 Mvav 64,168,128
  buffer_load_dwordx4 v16, s[20:23], s68 offen offset:2048 sc1 lds
 Mvav 64,172,112
  ds_read_b128 a[236:239], v18 offset:30720
  s_lshl_b32 s46, s46, 8
  v_mfma_f32_16x16x32_bf16 v[68:71], a[172:175], v[116:119], v[228:231]
  buffer_load_dword v45, v42, s[20:23], s66 offen offset:768 sc1
 Mvav 68,168,132
  ds_read_b128 a[240:243], v18 offset:31744
  s_sub_u32 s69, 6, s5
 Mvav 68,164,164
  s_mul_i32 s44, s3, 36864
  v_exp_f32 v97, v97
 Mvav 68,160,148
  buffer_load_dwordx4 v16, s[20:23], s68 offen offset:3072 sc1 lds
  v_mfma_f32_16x16x32_bf16 v[72:75], a[160:163], v[152:155], v[232:235]
  s_add_u32 s68, s68, 4096
  v_exp_f32 v98, v98
 Mvav 72,164,168
  s_add_u32 s44, s44, s46
  v_exp_f32 v99, v99
 Mvav 72,168,136
  s_and_b32 s46, s4, 7
  v_exp_f32 v100, v100
 Mvav 72,172,120
  s_mul_i32 s25, s46, 147456
  v_exp_f32 v101, v101
  v_mfma_f32_16x16x32_bf16 v[76:79], a[172:175], v[124:127], v[236:239]
  s_add_u32 s25, s25, s44
  v_add_f32 v248, v240, v228
  v_add_f32 v249, v241, v228
 Mvav 76,168,140
  s_mul_i32 s45, s46, 49152
  v_add_f32 v250, v242, v228
  v_add_f32 v251, v243, v228
 Mvav 76,164,172
  s_sub_u32 s45, s24, s45
  v_add_f32 v252, v244, v228
  v_add_f32 v253, v245, v228
 Mvav 76,160,156
  s_sub_u32 s45, s45, 1179648
  v_add_f32 v254, v246, v228
  v_add_f32 v255, v247, v228
 WL 7
  v_mfma_f32_16x16x32_bf16 v[196:199], a[212:215], v[148:151], v[248:251]
  ds_read_b128 a[176:179], v19 offset:16384
  s_add_u32 m0, s67, 36864
 WL 7
 Mvav 196,216,164
  buffer_load_dwordx4 v16, s[20:23], s68 offen offset:0 sc1 lds
 WL 6
 Mvav 196,220,132
  ds_read_b128 a[180:183], v19 offset:17408
  v_cvt_pk_bf16_f32 v80, v96, v97
 WL 6
 Mvav 196,224,116
  s_mul_i32 s46, s46, 368640
  v_exp_f32 v102, v102
  v_mfma_f32_16x16x32_bf16 v[200:203], a[224:227], v[120:123], v[232:235]
  ds_read_b128 a[184:187], v19 offset:18432
  v_cvt_pk_bf16_f32 v81, v98, v99
 Mvav 200,220,136
  s_add_u32 s44, s44, s46
  v_exp_f32 v103, v103
 Mvav 200,216,168
  v_exp_f32 v104, v104
 Mvav 200,212,152
  ds_read_b128 a[188:191], v19 offset:19456
  v_cvt_pk_bf16_f32 v84, v100, v101
  v_mfma_f32_16x16x32_bf16 v[204:207], a[212:215], v[156:159], v[236:239]
  buffer_load_dwordx4 v16, s[20:23], s68 offen offset:1024 sc1 lds
 Mvav 204,216,172
  ds_read_b128 a[192:195], v19 offset:20480
  v_cvt_pk_bf16_f32 v85, v102, v103
 Mvav 204,220,140
 WL 7
  v_exp_f32 v105, v105
 Mvav 204,224,124
 WL 8
  v_exp_f32 v106, v106
  v_mfma_f32_16x16x32_bf16 v[212:215], a[228:231], v[148:151], v[252:255]
  ds_read_b128 a[196:199], v19 offset:21504
  v_cvt_pk_bf16_f32 v88, v104, v105
 Mvav 212,232,164
 WL 7
  v_exp_f32 v107, v107
 Mvav 212,236,132
  ds_read_b128 a[200:203], v19 offset:22528
  v_cvt_pk_bf16_f32 v89, v106, v107
 WL 7
 Mvav 212,240,116
  buffer_load_dwordx4 v16, s[20:23], s68 offen offset:2048 sc1 lds
  v_mfma_f32_16x16x32_bf16 v[216:219], a[240:243], v[120:123], v[232:235]
  ds_read_b128 a[204:207], v19 offset:23552
  v_mov_b32 v224, v10
 Mvav 216,236,136
  v_exp_f32 v108, v108
 Mvav 216,232,168
  v_exp_f32 v109, v109
 Mvav 216,228,152
  v_exp_f32 v110, v110
  v_mfma_f32_16x16x32_bf16 v[220:223], a[228:231], v[156:159], v[236:239]
  v_exp_f32 v111, v111
 Mvav 220,232,172
  v_exp_f32 v64, v64
 Mvav 220,236,140
  buffer_load_dwordx4 v16, s[20:23], s68 offen offset:3072 sc1 lds
 Mvav 220,240,124
  s_add_u32 s68, s68, 12288
  v_exp_f32 v65, v65
  v_exp_f32 v66, v66
  v_cvt_pk_bf16_f32 v92, v108, v109
  v_exp_f32 v67, v67
  v_cvt_pk_bf16_f32 v93, v110, v111
  v_exp_f32 v68, v68
  v_cvt_pk_bf16_f32 v82, v64, v65
  v_exp_f32 v69, v69
  v_cvt_pk_bf16_f32 v83, v66, v67
  v_exp_f32 v70, v70
  v_cvt_pk_bf16_f32 v86, v68, v69
  v_exp_f32 v71, v71
  v_mov_b32 v225, v10
  v_exp_f32 v72, v72
  v_cvt_pk_bf16_f32 v87, v70, v71
  v_exp_f32 v73, v73
  v_mov_b32 v226, v10
 WL 0
  s_waitcnt vmcnt(18)
  s_barrier
  v_cvt_pk_bf16_f32 v90, v72, v73
  ds_read_b128 a[144:147], v18 offset:40960
  v_exp_f32 v74, v74
  v_exp_f32 v75, v75
  v_mfma_f32_16x16x32_bf16 a[128:131], a[208:211], v[80:83], 0
  v_exp_f32 v76, v76
  v_exp_f32 v77, v77
  v_exp_f32 v78, v78
  v_exp_f32 v79, v79
  v_cvt_pk_bf16_f32 v91, v74, v75
  v_mfma_f32_16x16x32_bf16 a[132:135], a[208:211], v[84:87], 0
  ds_read_b128 a[148:151], v18 offset:41984
  v_cvt_pk_bf16_f32 v94, v76, v77
  v_cvt_pk_bf16_f32 v95, v78, v79
  v_mfma_f32_16x16x32_bf16 a[136:139], a[208:211], v[88:91], 0
  s_add_u32 m0, s67, 49152
  v_exp_f32 v196, v196
  v_mfma_f32_16x16x32_bf16 a[140:143], a[208:211], v[92:95], 0
  ds_read_b128 a[152:155], v18 offset:43008
  v_mov_b32 v227, v10
  v_mfma_f32_16x16x32_bf16 a[12:15], a[176:179], v[92:95], 0
  buffer_load_dwordx4 v16, s[20:23], s68 offen offset:0 sc1 lds
  v_mfma_f32_16x16x32_bf16 a[8:11], a[176:179], v[88:91], 0
  v_exp_f32 v197, v197
  v_mfma_f32_16x16x32_bf16 a[4:7], a[176:179], v[84:87], 0
  ds_read_b128 a[156:159], v18 offset:44032
  v_cvt_pk_bf16_f32 v180, v196, v197
  v_mfma_f32_16x16x32_bf16 a[0:3], a[176:179], v[80:83], 0
  v_exp_f32 v198, v198
  v_mfma_f32_16x16x32_bf16 a[16:19], a[180:183], v[80:83], 0
  ds_read_b128 a[160:163], v18 offset:45056
  v_mov_b32 v228, v11
  v_mfma_f32_16x16x32_bf16 a[20:23], a[180:183], v[84:87], 0
  buffer_load_dwordx4 v16, s[20:23], s68 offen offset:1024 sc1 lds
  v_mfma_f32_16x16x32_bf16 a[24:27], a[180:183], v[88:91], 0
  v_exp_f32 v199, v199
  v_mfma_f32_16x16x32_bf16 a[28:31], a[180:183], v[92:95], 0
  ds_read_b128 a[164:167], v18 offset:46080
  v_cvt_pk_bf16_f32 v181, v198, v199
  v_mfma_f32_16x16x32_bf16 a[44:47], a[184:187], v[92:95], 0
  v_exp_f32 v200, v200
  v_mfma_f32_16x16x32_bf16 a[40:43], a[184:187], v[88:91], 0
  ds_read_b128 a[168:171], v18 offset:47104
  v_mov_b32 v229, v11
  v_mfma_f32_16x16x32_bf16 a[36:39], a[184:187], v[84:87], 0
  v_exp_f32 v201, v201
  v_mfma_f32_16x16x32_bf16 a[32:35], a[184:187], v[80:83], 0
  ds_read_b128 a[172:175], v18 offset:48128
  v_cvt_pk_bf16_f32 v184, v200, v201
  v_mfma_f32_16x16x32_bf16 a[48:51], a[188:191], v[80:83], 0
  buffer_load_dwordx4 v16, s[20:23], s68 offen offset:2048 sc1 lds
  v_mfma_f32_16x16x32_bf16 a[52:55], a[188:191], v[84:87], 0
  v_exp_f32 v202, v202
  v_mfma_f32_16x16x32_bf16 a[56:59], a[188:191], v[88:91], 0
  v_exp_f32 v203, v203
  v_mfma_f32_16x16x32_bf16 a[60:63], a[188:191], v[92:95], 0
  v_exp_f32 v204, v204
  v_mfma_f32_16x16x32_bf16 a[76:79], a[192:195], v[92:95], 0
  v_exp_f32 v205, v205
  v_mfma_f32_16x16x32_bf16 a[72:75], a[192:195], v[88:91], 0
  v_exp_f32 v206, v206
  v_mfma_f32_16x16x32_bf16 a[68:71], a[192:195], v[84:87], 0
  v_exp_f32 v207, v207
  v_mfma_f32_16x16x32_bf16 a[64:67], a[192:195], v[80:83], 0
  v_exp_f32 v212, v212
  v_mfma_f32_16x16x32_bf16 a[80:83], a[196:199], v[80:83], 0
  buffer_load_dwordx4 v16, s[20:23], s68 offen offset:3072 sc1 lds
  v_mfma_f32_16x16x32_bf16 a[84:87], a[196:199], v[84:87], 0
  s_add_u32 s68, s68, 4096
  v_add_f32 v248, v240, v232
  v_add_f32 v249, v241, v232
  v_mfma_f32_16x16x32_bf16 a[88:91], a[196:199], v[88:91], 0
  v_add_f32 v250, v242, v232
  v_add_f32 v251, v243, v232
  v_mfma_f32_16x16x32_bf16 a[92:95], a[196:199], v[92:95], 0
  v_add_f32 v252, v244, v232
  v_add_f32 v253, v245, v232
  v_mfma_f32_16x16x32_bf16 a[108:111], a[200:203], v[92:95], 0
  v_add_f32 v254, v246, v232
  v_add_f32 v255, v247, v232
  v_mfma_f32_16x16x32_bf16 a[104:107], a[200:203], v[88:91], 0
  v_exp_f32 v213, v213
  v_mfma_f32_16x16x32_bf16 a[100:103], a[200:203], v[84:87], 0
  v_exp_f32 v214, v214
  v_mfma_f32_16x16x32_bf16 a[96:99], a[200:203], v[80:83], 0
  v_exp_f32 v215, v215
  v_mfma_f32_16x16x32_bf16 a[112:115], a[204:207], v[80:83], 0
  v_exp_f32 v216, v216
  v_mfma_f32_16x16x32_bf16 a[116:119], a[204:207], v[84:87], 0
  v_exp_f32 v217, v217
  v_mfma_f32_16x16x32_bf16 a[120:123], a[204:207], v[88:91], 0
 WL 6
  v_exp_f32 v218, v218
  v_mfma_f32_16x16x32_bf16 a[124:127], a[204:207], v[92:95], 0
 WL 7
  v_exp_f32 v219, v219
  v_mfma_f32_16x16x32_bf16 v[104:107], a[144:147], v[152:155], v[248:251]
  ds_read_b128 a[176:179], v19 offset:32768
  s_add_u32 m0, s67, 53248
 Mvav 104,148,168
  buffer_load_dwordx4 v16, s[20:23], s68 offen offset:0 sc1 lds
 WL 6
 Mvav 104,152,136
  ds_read_b128 a[180:183], v19 offset:33792
  v_cvt_pk_bf16_f32 v185, v202, v203
 WL 6
 Mvav 104,156,120
  v_exp_f32 v220, v220
  v_mfma_f32_16x16x32_bf16 v[108:111], a[156:159], v[124:127], v[236:239]
  v_exp_f32 v221, v221
 Mvav 108,152,140
  ds_read_b128 a[184:187], v19 offset:34816
  v_cvt_pk_bf16_f32 v188, v204, v205
 Mvav 108,148,172
 WL 6
  v_exp_f32 v222, v222
 Mvav 108,144,156
  ds_read_b128 a[188:191], v19 offset:35840
  v_cvt_pk_bf16_f32 v189, v206, v207
  v_mfma_f32_16x16x32_bf16 v[72:75], a[160:163], v[152:155], v[252:255]
  buffer_load_dwordx4 v16, s[20:23], s68 offen offset:1024 sc1 lds
 WL 6
 Mvav 72,164,168
 WL 5
  v_exp_f32 v223, v223
 Mvav 72,168,136
  ds_read_b128 a[192:195], v19 offset:36864
  v_cvt_pk_bf16_f32 v182, v212, v213
 WL 5
 Mvav 72,172,120
  v_exp_f32 v104, v104
  v_mfma_f32_16x16x32_bf16 v[76:79], a[172:175], v[124:127], v[236:239]
  v_exp_f32 v105, v105
 Mvav 76,168,140
  ds_read_b128 a[196:199], v19 offset:37888
  v_cvt_pk_bf16_f32 v183, v214, v215
 Mvav 76,164,172
  v_exp_f32 v106, v106
 Mvav 76,160,156
  ds_read_b128 a[200:203], v19 offset:38912
  v_cvt_pk_bf16_f32 v186, v216, v217
  buffer_load_dwordx4 v16, s[20:23], s68 offen offset:2048 sc1 lds
  v_cvt_pk_bf16_f32 v187, v218, v219
  v_exp_f32 v107, v107
  v_cvt_pk_bf16_f32 v190, v220, v221
  ds_read_b128 a[204:207], v19 offset:39936
  v_exp_f32 v108, v108
  v_exp_f32 v109, v109
  v_cvt_pk_bf16_f32 v191, v222, v223
  v_exp_f32 v110, v110
  v_cvt_pk_bf16_f32 v88, v104, v105
  v_exp_f32 v111, v111
  v_cvt_pk_bf16_f32 v89, v106, v107
  v_exp_f32 v72, v72
  v_cvt_pk_bf16_f32 v92, v108, v109
  v_exp_f32 v73, v73
  v_cvt_pk_bf16_f32 v93, v110, v111
  buffer_load_dwordx4 v16, s[20:23], s68 offen offset:3072 sc1 lds
  s_add_u32 s68, s68, 12288
  v_exp_f32 v74, v74
  v_cvt_pk_bf16_f32 v90, v72, v73
  v_exp_f32 v75, v75
  v_mov_b32 v230, v11
  v_exp_f32 v76, v76
  v_cvt_pk_bf16_f32 v91, v74, v75
  v_exp_f32 v77, v77
  v_mov_b32 v231, v11
  v_exp_f32 v78, v78
  v_cvt_pk_bf16_f32 v94, v76, v77
  v_exp_f32 v79, v79
  v_mov_b32 v232, v12
  v_cvt_pk_bf16_f32 v95, v78, v79
  v_mov_b32 v233, v12
  v_mov_b32 v234, v12
  v_mov_b32 v235, v12
  v_accvgpr_read_b32 v40, a128
  v_subrev_u32 v41, 0x1f800000, v40
  v_rcp_f32 v40, v40
  v_max_u32 v43, v43, v41
 WL 0
  s_waitcnt vmcnt(22)
  s_barrier
  v_mul_f32 v40, v40, v20
  ds_read_b128 a[144:147], v18 offset:57344
  v_accvgpr_read_b32 v48, a0
  v_accvgpr_read_b32 v49, a1
 Maav 132,208,180
  ds_read_b128 a[148:151], v18 offset:58368
  s_add_u32 m0, s67, 0
 Maav 136,208,184
  buffer_load_dwordx4 v16, s[20:23], s68 offen offset:0 sc1 lds
 Maav 140,208,188
  ds_read_b128 a[152:155], v18 offset:59392
  v_accvgpr_read_b32 v50, a2
 Maav 12,176,188
  ds_read_b128 a[156:159], v18 offset:60416
  v_accvgpr_read_b32 v51, a3
 Maav 8,176,184
  ds_read_b128 v[144:147], v47 offset:0
  v_pk_mul_f32 v[48:49], v[48:49], v[40:41] op_sel_hi:[1,0]
 Maav 4,176,180
  ds_read_b128 a[160:163], v18 offset:61440
  v_pk_mul_f32 v[50:51], v[50:51], v[40:41] op_sel_hi:[1,0]
 Maav 20,180,180
  ds_read_b128 a[164:167], v18 offset:62464
  v_cvt_pk_bf16_f32 v48, v48, v49
 Maav 24,180,184
  buffer_load_dwordx4 v16, s[20:23], s68 offen offset:1024 sc1 lds
 Maav 28,180,188
  ds_read_b128 a[168:171], v18 offset:63488
  v_cvt_pk_bf16_f32 v49, v50, v51
 Maav 44,184,188
  ds_read_b128 a[172:175], v18 offset:64512
  v_add_u32 v18, -65536, v18
 Maav 40,184,184
  ds_read_b128 v[160:163], v47 offset:1024
  v_accvgpr_read_b32 v52, a16
 Maav 36,184,180
  buffer_load_dwordx4 v16, s[20:23], s68 offen offset:2048 sc1 lds
 Maav 52,188,180
  ds_read_b128 v[128:131], v47 offset:2048
  v_accvgpr_read_b32 v53, a17
 Maav 56,188,184
  ds_read_b128 v[112:115], v47 offset:3072
  v_accvgpr_read_b32 v54, a18
 Maav 60,188,188
  ds_read_b128 v[148:151], v47 offset:4096
  v_accvgpr_read_b32 v55, a19
 Maav 76,192,188
  v_add_f32 v248, v240, v236
  v_add_f32 v249, v241, v236
 Maav 72,192,184
  v_add_f32 v250, v242, v236
  v_add_f32 v251, v243, v236
 Maav 68,192,180
  buffer_load_dwordx4 v16, s[20:23], s68 offen offset:3072 sc1 lds
 Maav 84,196,180
  s_add_u32 s68, s68, 4096
  v_add_f32 v252, v244, v236
  v_add_f32 v253, v245, v236
 Maav 88,196,184
  v_add_f32 v254, v246, v236
  v_add_f32 v255, v247, v236
 Maav 92,196,188
  ds_read_b128 v[164:167], v47 offset:5120
  v_pk_mul_f32 v[52:53], v[52:53], v[40:41] op_sel_hi:[1,0]
 Maav 108,200,188
  ds_read_b128 v[132:135], v47 offset:6144
  v_pk_mul_f32 v[54:55], v[54:55], v[40:41] op_sel_hi:[1,0]
 Maav 104,200,184
  ds_read_b128 v[116:119], v47 offset:7168
  v_cvt_pk_bf16_f32 v50, v52, v53
 Maav 100,200,180
  ds_read_b128 v[152:155], v47 offset:8192
  v_cvt_pk_bf16_f32 v51, v54, v55
 Maav 116,204,180
  buffer_store_dwordx4 v[48:51], v16, s[20:23], s58 offen offset:0 sc1
 Maav 120,204,184
  ds_read_b128 v[168:171], v47 offset:9216
  v_accvgpr_read_b32 v56, a32
 Maav 124,204,188
  ds_read_b128 v[136:139], v47 offset:10240
  v_accvgpr_read_b32 v57, a33
 WL 14
  v_mfma_f32_16x16x32_bf16 v[204:207], a[144:147], v[156:159], v[248:251]
  ds_read_b128 a[176:179], v19 offset:49152
  s_add_u32 m0, s67, 4096
 Mvav 204,148,172
  buffer_load_dwordx4 v16, s[20:23], s68 offen offset:0 sc1 lds
 Mvav 204,152,140
  ds_read_b128 v[120:123], v47 offset:11264
  v_accvgpr_read_b32 v58, a34
 Mvav 204,156,124
  ds_read_b128 a[180:183], v19 offset:50176
  v_accvgpr_read_b32 v59, a35
 WL 14
  v_mfma_f32_16x16x32_bf16 v[220:223], a[160:163], v[156:159], v[252:255]
  v_pk_mul_f32 v[56:57], v[56:57], v[40:41] op_sel_hi:[1,0]
  v_pk_mul_f32 v[58:59], v[58:59], v[40:41] op_sel_hi:[1,0]
 Mvav 220,164,172
 WL 13
  v_cvt_pk_bf16_f32 v56, v56, v57
  v_cvt_pk_bf16_f32 v57, v58, v59
 Mvav 220,168,140
  ds_read_b128 a[184:187], v19 offset:51200
  v_accvgpr_read_b32 v60, a48
 Mvav 220,172,124
  v_exp_f32 v204, v204
  ds_read_b128 v[156:159], v47 offset:12288
  v_exp_f32 v205, v205
  ds_read_b128 a[188:191], v19 offset:52224
  v_exp_f32 v206, v206
  buffer_load_dwordx4 v16, s[20:23], s68 offen offset:1024 sc1 lds
  v_cvt_pk_bf16_f32 v188, v204, v205
  ds_read_b128 v[172:175], v47 offset:13312
  v_exp_f32 v207, v207
  v_exp_f32 v220, v220
  v_cvt_pk_bf16_f32 v189, v206, v207
  ds_read_b128 a[192:195], v19 offset:53248
  v_exp_f32 v221, v221
  v_exp_f32 v222, v222
  v_cvt_pk_bf16_f32 v190, v220, v221
  ds_read_b128 v[140:143], v47 offset:14336
  v_exp_f32 v223, v223
  ds_read_b128 a[196:199], v19 offset:54272
  v_cvt_pk_bf16_f32 v191, v222, v223
  v_mov_b32 v236, v13
  ds_read_b128 v[124:127], v47 offset:15360
  v_mov_b32 v237, v13
  v_mov_b32 v238, v13
  v_mov_b32 v239, v13
  v_add_f32 v248, v240, v224
  v_add_f32 v249, v241, v224
  ds_read_b128 a[200:203], v19 offset:55296
  v_add_f32 v250, v242, v224
  v_add_f32 v251, v243, v224
  buffer_load_dwordx4 v16, s[20:23], s68 offen offset:2048 sc1 lds
  v_add_f32 v252, v244, v224
  v_add_f32 v253, v245, v224
  v_add_f32 v254, v246, v224
  v_add_f32 v255, v247, v224
  v_accvgpr_read_b32 v61, a49
  v_accvgpr_read_b32 v62, a50
  v_accvgpr_read_b32 v63, a51
  ds_read_b128 a[204:207], v19 offset:56320
  v_pk_mul_f32 v[60:61], v[60:61], v[40:41] op_sel_hi:[1,0]
  v_pk_mul_f32 v[62:63], v[62:63], v[40:41] op_sel_hi:[1,0]
  s_add_u32 s49, s58, 8192
  v_cvt_pk_bf16_f32 v58, v60, v61
  v_cvt_pk_bf16_f32 v59, v62, v63
  v_accvgpr_write_b32 a244, -1
  buffer_store_dwordx4 v[56:59], v16, s[20:23], s49 offen offset:0 sc1
  v_accvgpr_read_b32 v48, a64
  v_accvgpr_read_b32 v49, a65
  v_accvgpr_read_b32 v50, a66
  v_accvgpr_read_b32 v51, a67
  v_pk_mul_f32 v[48:49], v[48:49], v[40:41] op_sel_hi:[1,0]
  v_pk_mul_f32 v[50:51], v[50:51], v[40:41] op_sel_hi:[1,0]
  v_cvt_pk_bf16_f32 v48, v48, v49
  v_cvt_pk_bf16_f32 v49, v50, v51
  v_accvgpr_read_b32 v52, a80
  buffer_load_dwordx4 v16, s[20:23], s68 offen offset:3072 sc1 lds
  s_add_u32 s68, s68, 12288
  v_accvgpr_read_b32 v53, a81
  v_accvgpr_read_b32 v54, a82
  v_accvgpr_read_b32 v55, a83
  v_pk_mul_f32 v[52:53], v[52:53], v[40:41] op_sel_hi:[1,0]
  v_pk_mul_f32 v[54:55], v[54:55], v[40:41] op_sel_hi:[1,0]
  v_cvt_pk_bf16_f32 v50, v52, v53
  s_add_u32 s49, s58, 16384
  v_cvt_pk_bf16_f32 v51, v54, v55
  v_accvgpr_write_b32 a245, -1
  v_accvgpr_write_b32 a246, -1
  buffer_store_dwordx4 v[48:51], v16, s[20:23], s49 offen offset:0 sc1
  v_accvgpr_read_b32 v56, a96
  v_accvgpr_read_b32 v57, a97
  v_accvgpr_read_b32 v58, a98
  v_accvgpr_read_b32 v59, a99
  v_pk_mul_f32 v[56:57], v[56:57], v[40:41] op_sel_hi:[1,0]
  v_pk_mul_f32 v[58:59], v[58:59], v[40:41] op_sel_hi:[1,0]
  v_cvt_pk_bf16_f32 v56, v56, v57
  v_cvt_pk_bf16_f32 v57, v58, v59
  v_accvgpr_read_b32 v60, a112
  v_accvgpr_read_b32 v61, a113
  v_accvgpr_read_b32 v62, a114
  v_accvgpr_read_b32 v63, a115
  v_pk_mul_f32 v[60:61], v[60:61], v[40:41] op_sel_hi:[1,0]
  v_pk_mul_f32 v[62:63], v[62:63], v[40:41] op_sel_hi:[1,0]
  v_cvt_pk_bf16_f32 v58, v60, v61
  s_add_u32 s49, s58, 24576
  v_cvt_pk_bf16_f32 v59, v62, v63
  v_accvgpr_write_b32 a247, -1
  v_lshrrev_b32 v38, 4, v0
  buffer_store_dwordx4 v[56:59], v16, s[20:23], s49 offen offset:0 sc1
  s_waitcnt vmcnt(31) lgkmcnt(0)
  s_waitcnt vmcnt(20)
  s_barrier
  v_accvgpr_read_b32 v40, a132
  ds_read_b128 a[144:147], v18 offset:40960
  ds_read_b128 a[148:151], v18 offset:41984
 Maav 136,208,88
  ds_read_b128 a[152:155], v18 offset:43008
  s_add_u32 m0, s67, 16384
 Maav 140,208,92
  ds_read_b128 a[156:159], v18 offset:44032
  v_subrev_u32 v41, 0x1f800000, v40
 Maav 12,176,92
  ds_read_b128 a[160:163], v18 offset:45056
  v_mul_u32_u24 v38, 8960, v38
 Maav 8,176,88
  ds_read_b128 a[164:167], v18 offset:46080
  v_add_u32 v1, v38, v16
 Maav 24,180,88
  ds_read_b128 a[168:171], v18 offset:47104
  v_add_u32 v2, 96, v1
 Maav 28,180,92
  ds_read_b128 a[172:175], v18 offset:48128
  v_add_u32 v3, 192, v1
 Maav 44,184,92
  buffer_load_dwordx4 v16, s[20:23], s68 offen offset:0 sc1 lds
 Maav 40,184,88
  buffer_load_dwordx4 v16, s[20:23], s68 offen offset:1024 sc1 lds
 Maav 56,188,88
  buffer_load_dwordx4 v16, s[20:23], s68 offen offset:2048 sc1 lds
 Maav 60,188,92
  v_rcp_f32 v40, v40
 Maav 76,192,92
  buffer_load_dwordx4 v16, s[20:23], s68 offen offset:3072 sc1 lds
 Maav 72,192,88
  s_add_u32 s68, s68, 4096
  v_max_u32 v43, v43, v41
  v_mul_f32 v40, v40, v22
 Maav 88,196,88
  v_accvgpr_read_b32 v48, a4
  v_accvgpr_read_b32 v49, a5
 Maav 92,196,92
  v_accvgpr_read_b32 v50, a6
  v_accvgpr_read_b32 v51, a7
 Maav 108,200,92
  v_pk_mul_f32 v[48:49], v[48:49], v[40:41] op_sel_hi:[1,0]
  v_pk_mul_f32 v[50:51], v[50:51], v[40:41] op_sel_hi:[1,0]
 Maav 104,200,88
  v_cvt_pk_bf16_f32 v48, v48, v49
  v_cvt_pk_bf16_f32 v49, v50, v51
 Maav 120,204,88
 WL 6
  v_accvgpr_read_b32 v52, a20
  v_accvgpr_read_b32 v53, a21
 Maav 124,204,92
 WL 7
  v_accvgpr_read_b32 v54, a22
  v_accvgpr_read_b32 v55, a23
  v_mfma_f32_16x16x32_bf16 v[96:99], a[144:147], v[144:147], v[224:227]
  ds_read_b128 a[176:179], v19 offset:0
  s_add_u32 m0, s67, 20480
 Mvav 96,148,160
  buffer_load_dwordx4 v16, s[20:23], s68 offen offset:0 sc1 lds
 WL 6
 Mvav 96,152,128
 WL 5
  v_pk_mul_f32 v[52:53], v[52:53], v[40:41] op_sel_hi:[1,0]
  v_pk_mul_f32 v[54:55], v[54:55], v[40:41] op_sel_hi:[1,0]
 Mvav 96,156,112
  v_cvt_pk_bf16_f32 v50, v52, v53
  v_cvt_pk_bf16_f32 v51, v54, v55
  v_mfma_f32_16x16x32_bf16 v[100:103], a[156:159], v[116:119], v[228:231]
  ds_read_b128 a[180:183], v19 offset:1024
  v_add_u32 v4, 288, v1
 Mvav 100,152,132
  buffer_store_dwordx4 v[48:51], v16, s[20:23], s58 offen offset:2048 sc1
 Mvav 100,148,164
  v_accvgpr_read_b32 v56, a36
  v_accvgpr_read_b32 v57, a37
 Mvav 100,144,148
  v_accvgpr_read_b32 v58, a38
  v_accvgpr_read_b32 v59, a39
  v_mfma_f32_16x16x32_bf16 v[104:107], a[144:147], v[152:155], v[232:235]
  ds_read_b128 a[184:187], v19 offset:2048
  v_pk_mul_f32 v[56:57], v[56:57], v[40:41] op_sel_hi:[1,0]
 Mvav 104,148,168
  v_pk_mul_f32 v[58:59], v[58:59], v[40:41] op_sel_hi:[1,0]
  v_cvt_pk_bf16_f32 v56, v56, v57
 Mvav 104,152,136
  v_cvt_pk_bf16_f32 v57, v58, v59
  v_accvgpr_read_b32 v60, a52
 Mvav 104,156,120
  v_exp_f32 v96, v96
  v_mfma_f32_16x16x32_bf16 v[108:111], a[156:159], v[124:127], v[236:239]
  buffer_load_dwordx4 v16, s[20:23], s68 offen offset:1024 sc1 lds
 Mvav 108,152,140
  ds_read_b128 a[188:191], v19 offset:3072
  v_accvgpr_read_b32 v61, a53
 Mvav 108,148,172
 WL 5
  v_exp_f32 v97, v97
 Mvav 108,144,156
 WL 7
  v_exp_f32 v98, v98
  v_mfma_f32_16x16x32_bf16 v[64:67], a[160:163], v[144:147], v[224:227]
 WL 6
  v_exp_f32 v99, v99
 Mvav 64,164,160
  ds_read_b128 a[192:195], v19 offset:4096
  v_cvt_pk_bf16_f32 v80, v96, v97
 Mvav 64,168,128
 WL 5
  v_exp_f32 v100, v100
 Mvav 64,172,112
  v_exp_f32 v101, v101
  v_mfma_f32_16x16x32_bf16 v[68:71], a[172:175], v[116:119], v[228:231]
  v_exp_f32 v102, v102
 Mvav 68,168,132
  v_exp_f32 v103, v103
 Mvav 68,164,164
  ds_read_b128 a[196:199], v19 offset:5120
  v_cvt_pk_bf16_f32 v81, v98, v99
 Mvav 68,160,148
  v_exp_f32 v104, v104
  v_mfma_f32_16x16x32_bf16 v[72:75], a[160:163], v[152:155], v[232:235]
  v_exp_f32 v105, v105
 Mvav 72,164,168
  buffer_load_dwordx4 v16, s[20:23], s68 offen offset:2048 sc1 lds
 Mvav 72,168,136
  ds_read_b128 a[200:203], v19 offset:6144
  v_cvt_pk_bf16_f32 v84, v100, v101
 Mvav 72,172,120
  v_exp_f32 v106, v106
  v_mfma_f32_16x16x32_bf16 v[76:79], a[172:175], v[124:127], v[236:239]
  v_exp_f32 v107, v107
 Mvav 76,168,140
  v_exp_f32 v108, v108
 Mvav 76,164,172
  ds_read_b128 a[204:207], v19 offset:7168
  v_cvt_pk_bf16_f32 v85, v102, v103
 Mvav 76,160,156
  v_exp_f32 v109, v109
  v_exp_f32 v110, v110
  v_cvt_pk_bf16_f32 v88, v104, v105
  v_exp_f32 v111, v111
  v_cvt_pk_bf16_f32 v89, v106, v107
  v_exp_f32 v64, v64
  v_cvt_pk_bf16_f32 v92, v108, v109
  v_exp_f32 v65, v65
  v_cvt_pk_bf16_f32 v93, v110, v111
  v_exp_f32 v66, v66
  v_cvt_pk_bf16_f32 v82, v64, v65
  buffer_load_dwordx4 v16, s[20:23], s68 offen offset:3072 sc1 lds
  s_add_u32 s68, s68, 12288
  v_exp_f32 v67, v67
  v_add_u32 v19, -65536, v19
  v_exp_f32 v68, v68
  v_cvt_pk_bf16_f32 v83, v66, v67
  v_exp_f32 v69, v69
  v_accvgpr_read_b32 v62, a54
  v_exp_f32 v70, v70
  v_cvt_pk_bf16_f32 v86, v68, v69
  v_exp_f32 v71, v71
  v_accvgpr_read_b32 v63, a55
  v_exp_f32 v72, v72
  v_cvt_pk_bf16_f32 v87, v70, v71
  v_exp_f32 v73, v73
  v_pk_mul_f32 v[60:61], v[60:61], v[40:41] op_sel_hi:[1,0]
  v_exp_f32 v74, v74
  v_cvt_pk_bf16_f32 v90, v72, v73
  v_exp_f32 v75, v75
  v_pk_mul_f32 v[62:63], v[62:63], v[40:41] op_sel_hi:[1,0]
  v_exp_f32 v76, v76
  v_cvt_pk_bf16_f32 v91, v74, v75
  v_exp_f32 v77, v77
  v_cvt_pk_bf16_f32 v58, v60, v61
  v_exp_f32 v78, v78
  v_cvt_pk_bf16_f32 v94, v76, v77
  s_add_u32 s49, s58, 8192
  v_exp_f32 v79, v79
  v_cvt_pk_bf16_f32 v59, v62, v63
  buffer_store_dwordx4 v[56:59], v16, s[20:23], s49 offen offset:2048 sc1
 WL 0
  s_waitcnt vmcnt(22)
  s_barrier
  v_cvt_pk_bf16_f32 v95, v78, v79
  ds_read_b128 a[144:147], v18 offset:57344
  ds_read_b128 a[148:151], v18 offset:58368
 Maav 140,208,188
  ds_read_b128 a[152:155], v18 offset:59392
  s_add_u32 m0, s67, 32768
 Maav 12,176,188
  ds_read_b128 a[156:159], v18 offset:60416
  v_accvgpr_read_b32 v48, a68
 Maav 28,180,188
  ds_read_b128 a[160:163], v18 offset:61440
  v_accvgpr_read_b32 v49, a69
 Maav 44,184,188
  ds_read_b128 a[164:167], v18 offset:62464
  v_accvgpr_read_b32 v50, a70
 Maav 60,188,188
  ds_read_b128 a[168:171], v18 offset:63488
  v_accvgpr_read_b32 v51, a71
 Maav 76,192,188
  ds_read_b128 a[172:175], v18 offset:64512
  v_pk_mul_f32 v[48:49], v[48:49], v[40:41] op_sel_hi:[1,0]
 Maav 92,196,188
  buffer_load_dwordx4 v16, s[20:23], s68 offen offset:0 sc1 lds
 Maav 108,200,188
  buffer_load_dwordx4 v16, s[20:23], s68 offen offset:1024 sc1 lds
 Maav 124,204,188
  buffer_load_dwordx4 v16, s[20:23], s68 offen offset:2048 sc1 lds
  buffer_load_dwordx4 v16, s[20:23], s68 offen offset:3072 sc1 lds
  s_add_u32 s68, s68, 4096
 WL 7
  v_mfma_f32_16x16x32_bf16 v[192:195], a[144:147], v[144:147], v[224:227]
  ds_read_b128 a[176:179], v19 offset:49152
  s_add_u32 m0, s67, 36864
 WL 7
 Mvav 192,148,160
  buffer_load_dwordx4 v16, s[20:23], s68 offen offset:0 sc1 lds
 WL 6
 Mvav 192,152,128
 WL 5
  v_pk_mul_f32 v[50:51], v[50:51], v[40:41] op_sel_hi:[1,0]
  v_cvt_pk_bf16_f32 v48, v48, v49
 Mvav 192,156,112
  v_cvt_pk_bf16_f32 v49, v50, v51
  v_accvgpr_read_b32 v52, a84
  v_mfma_f32_16x16x32_bf16 v[196:199], a[156:159], v[116:119], v[228:231]
  v_accvgpr_read_b32 v53, a85
  v_accvgpr_read_b32 v54, a86
 Mvav 196,152,132
  ds_read_b128 a[180:183], v19 offset:50176
  v_accvgpr_read_b32 v55, a87
 Mvav 196,148,164
  v_pk_mul_f32 v[52:53], v[52:53], v[40:41] op_sel_hi:[1,0]
  v_pk_mul_f32 v[54:55], v[54:55], v[40:41] op_sel_hi:[1,0]
 Mvav 196,144,148
  s_add_u32 s49, s58, 16384
  v_cvt_pk_bf16_f32 v50, v52, v53
  v_cvt_pk_bf16_f32 v51, v54, v55
  v_mfma_f32_16x16x32_bf16 v[200:203], a[144:147], v[152:155], v[232:235]
  buffer_store_dwordx4 v[48:51], v16, s[20:23], s49 offen offset:2048 sc1
 Mvav 200,148,168
  v_accvgpr_read_b32 v56, a100
  v_accvgpr_read_b32 v57, a101
 Mvav 200,152,136
  ds_read_b128 a[184:187], v19 offset:51200
  v_accvgpr_read_b32 v58, a102
 Mvav 200,156,120
  v_exp_f32 v192, v192
  v_mfma_f32_16x16x32_bf16 v[204:207], a[156:159], v[124:127], v[236:239]
  v_exp_f32 v193, v193
 Mvav 204,152,140
 WL 6
  v_exp_f32 v194, v194
 Mvav 204,148,172
  buffer_load_dwordx4 v16, s[20:23], s68 offen offset:1024 sc1 lds
 Mvav 204,144,156
  ds_read_b128 a[188:191], v19 offset:52224
  v_cvt_pk_bf16_f32 v176, v192, v193
  v_mfma_f32_16x16x32_bf16 v[208:211], a[160:163], v[144:147], v[224:227]
 WL 6
  v_exp_f32 v195, v195
 Mvav 208,164,160
 WL 5
  v_exp_f32 v196, v196
 Mvav 208,168,128
 WL 4
  v_exp_f32 v197, v197
 Mvav 208,172,112
  v_exp_f32 v198, v198
  v_mfma_f32_16x16x32_bf16 v[212:215], a[172:175], v[116:119], v[228:231]
  ds_read_b128 a[192:195], v19 offset:53248
  v_cvt_pk_bf16_f32 v177, v194, v195
 Mvav 212,168,132
  v_exp_f32 v199, v199
 Mvav 212,164,164
  v_exp_f32 v200, v200
 Mvav 212,160,148
  v_exp_f32 v201, v201
  v_mfma_f32_16x16x32_bf16 v[216:219], a[160:163], v[152:155], v[232:235]
  v_exp_f32 v202, v202
 Mvav 216,164,168
  ds_read_b128 a[196:199], v19 offset:54272
  v_cvt_pk_bf16_f32 v180, v196, v197
 Mvav 216,168,136
  v_exp_f32 v203, v203
 Mvav 216,172,120
  v_exp_f32 v204, v204
  v_mfma_f32_16x16x32_bf16 v[220:223], a[172:175], v[124:127], v[236:239]
  buffer_load_dwordx4 v16, s[20:23], s68 offen offset:2048 sc1 lds
 Mvav 220,168,140
  v_exp_f32 v205, v205
 Mvav 220,164,172
  ds_read_b128 a[200:203], v19 offset:55296
  v_cvt_pk_bf16_f32 v181, v198, v199
 Mvav 220,160,156
  v_exp_f32 v206, v206
  v_exp_f32 v207, v207
  v_cvt_pk_bf16_f32 v184, v200, v201
  v_exp_f32 v208, v208
  v_cvt_pk_bf16_f32 v185, v202, v203
  v_exp_f32 v209, v209
  v_cvt_pk_bf16_f32 v188, v204, v205
  ds_read_b128 a[204:207], v19 offset:56320
  v_exp_f32 v210, v210
  v_exp_f32 v211, v211
  v_cvt_pk_bf16_f32 v189, v206, v207
  v_cvt_pk_bf16_f32 v178, v208, v209
  v_cvt_pk_bf16_f32 v179, v210, v211
  v_accvgpr_read_b32 v59, a103
  v_pk_mul_f32 v[56:57], v[56:57], v[40:41] op_sel_hi:[1,0]
  v_pk_mul_f32 v[58:59], v[58:59], v[40:41] op_sel_hi:[1,0]
  v_cvt_pk_bf16_f32 v56, v56, v57
  v_cvt_pk_bf16_f32 v57, v58, v59
  v_accvgpr_read_b32 v60, a116
  v_accvgpr_read_b32 v61, a117
  v_accvgpr_read_b32 v62, a118
  v_accvgpr_read_b32 v63, a119
  v_pk_mul_f32 v[60:61], v[60:61], v[40:41] op_sel_hi:[1,0]
  s_add_u32 s49, s58, 24576
  v_pk_mul_f32 v[62:63], v[62:63], v[40:41] op_sel_hi:[1,0]
  v_cvt_pk_bf16_f32 v58, v60, v61
  v_cvt_pk_bf16_f32 v59, v62, v63
  buffer_load_dwordx4 v16, s[20:23], s68 offen offset:3072 sc1 lds
  s_add_u32 s68, s68, 12288
  buffer_store_dwordx4 v[56:59], v16, s[20:23], s49 offen offset:2048 sc1
  v_accvgpr_read_b32 v40, a136
  v_subrev_u32 v41, 0x1f800000, v40
  v_add_u32 v5, 4608, v1
  v_rcp_f32 v40, v40
  v_max_u32 v43, v43, v41
  v_mul_f32 v40, v40, v24
  v_accvgpr_read_b32 v48, a8
  v_accvgpr_read_b32 v49, a9
  v_accvgpr_read_b32 v50, a10
  v_accvgpr_read_b32 v51, a11
  v_pk_mul_f32 v[48:49], v[48:49], v[40:41] op_sel_hi:[1,0]
  v_pk_mul_f32 v[50:51], v[50:51], v[40:41] op_sel_hi:[1,0]
  v_cvt_pk_bf16_f32 v48, v48, v49
  v_cvt_pk_bf16_f32 v49, v50, v51
  v_accvgpr_read_b32 v52, a24
  v_accvgpr_read_b32 v53, a25
  v_accvgpr_read_b32 v54, a26
  v_accvgpr_read_b32 v55, a27
  v_pk_mul_f32 v[52:53], v[52:53], v[40:41] op_sel_hi:[1,0]
  v_pk_mul_f32 v[54:55], v[54:55], v[40:41] op_sel_hi:[1,0]
  v_cvt_pk_bf16_f32 v50, v52, v53
  v_cvt_pk_bf16_f32 v51, v54, v55
  v_add_u32 v6, 4704, v1
  buffer_store_dwordx4 v[48:51], v17, s[20:23], s58 offen offset:0 sc1
  v_accvgpr_read_b32 v56, a40
  v_accvgpr_read_b32 v57, a41
  v_accvgpr_read_b32 v58, a42
  v_accvgpr_read_b32 v59, a43
  v_pk_mul_f32 v[56:57], v[56:57], v[40:41] op_sel_hi:[1,0]
  v_pk_mul_f32 v[58:59], v[58:59], v[40:41] op_sel_hi:[1,0]
  v_cvt_pk_bf16_f32 v56, v56, v57
  v_cvt_pk_bf16_f32 v57, v58, v59
  v_accvgpr_read_b32 v60, a56
  v_accvgpr_read_b32 v61, a57
  v_accvgpr_read_b32 v62, a58
  v_accvgpr_read_b32 v63, a59
  v_pk_mul_f32 v[60:61], v[60:61], v[40:41] op_sel_hi:[1,0]
  v_pk_mul_f32 v[62:63], v[62:63], v[40:41] op_sel_hi:[1,0]
  v_cvt_pk_bf16_f32 v58, v60, v61
 WL 0
  s_waitcnt vmcnt(23)
  s_barrier
  v_cvt_pk_bf16_f32 v59, v62, v63
  ds_read_b128 a[144:147], v18 offset:8192
  s_add_u32 s49, s58, 8192
  v_add_u32 v7, 4800, v1
  v_mfma_f32_16x16x32_bf16 a[128:131], a[208:211], v[80:83], 0
  buffer_store_dwordx4 v[56:59], v17, s[20:23], s49 offen offset:0 sc1
  v_mfma_f32_16x16x32_bf16 a[0:3], a[176:179], v[80:83], 0
  ds_read_b128 a[148:151], v18 offset:9216
  s_add_u32 m0, s67, 49152
  v_mfma_f32_16x16x32_bf16 a[16:19], a[180:183], v[80:83], 0
  buffer_load_dwordx4 v16, s[20:23], s68 offen offset:0 sc1 lds
  v_mfma_f32_16x16x32_bf16 a[32:35], a[184:187], v[80:83], 0
  ds_read_b128 a[152:155], v18 offset:10240
  v_accvgpr_read_b32 v48, a72
  v_mfma_f32_16x16x32_bf16 a[48:51], a[188:191], v[80:83], 0
  v_accvgpr_read_b32 v49, a73
  v_accvgpr_read_b32 v50, a74
  v_mfma_f32_16x16x32_bf16 a[64:67], a[192:195], v[80:83], 0
  v_accvgpr_read_b32 v51, a75
  v_pk_mul_f32 v[48:49], v[48:49], v[40:41] op_sel_hi:[1,0]
  v_mfma_f32_16x16x32_bf16 a[80:83], a[196:199], v[80:83], 0
  ds_read_b128 a[156:159], v18 offset:11264
  v_pk_mul_f32 v[50:51], v[50:51], v[40:41] op_sel_hi:[1,0]
  v_mfma_f32_16x16x32_bf16 a[96:99], a[200:203], v[80:83], 0
  v_cvt_pk_bf16_f32 v48, v48, v49
  v_cvt_pk_bf16_f32 v49, v50, v51
  v_mfma_f32_16x16x32_bf16 a[112:115], a[204:207], v[80:83], 0
  ds_read_b128 a[160:163], v18 offset:12288
  v_accvgpr_read_b32 v52, a88
  v_mfma_f32_16x16x32_bf16 a[132:135], a[208:211], v[84:87], 0
  buffer_load_dwordx4 v16, s[20:23], s68 offen offset:1024 sc1 lds
  v_mfma_f32_16x16x32_bf16 a[4:7], a[176:179], v[84:87], 0
  v_accvgpr_read_b32 v53, a89
  v_accvgpr_read_b32 v54, a90
  v_mfma_f32_16x16x32_bf16 a[20:23], a[180:183], v[84:87], 0
  ds_read_b128 a[164:167], v18 offset:13312
  v_accvgpr_read_b32 v55, a91
  v_mfma_f32_16x16x32_bf16 a[36:39], a[184:187], v[84:87], 0
  v_pk_mul_f32 v[52:53], v[52:53], v[40:41] op_sel_hi:[1,0]
  v_pk_mul_f32 v[54:55], v[54:55], v[40:41] op_sel_hi:[1,0]
  v_mfma_f32_16x16x32_bf16 a[52:55], a[188:191], v[84:87], 0
  ds_read_b128 a[168:171], v18 offset:14336
  v_cvt_pk_bf16_f32 v50, v52, v53
  v_mfma_f32_16x16x32_bf16 a[68:71], a[192:195], v[84:87], 0
  s_add_u32 s49, s58, 16384
  v_cvt_pk_bf16_f32 v51, v54, v55
  v_add_u32 v8, 4896, v1
  v_mfma_f32_16x16x32_bf16 a[84:87], a[196:199], v[84:87], 0
  ds_read_b128 a[172:175], v18 offset:15360
  s_lshr_b32 s46, s4, 3
  v_mfma_f32_16x16x32_bf16 a[100:103], a[200:203], v[84:87], 0
  buffer_store_dwordx4 v[48:51], v17, s[20:23], s49 offen offset:0 sc1
  v_mfma_f32_16x16x32_bf16 a[116:119], a[204:207], v[84:87], 0
  buffer_load_dwordx4 v16, s[20:23], s68 offen offset:2048 sc1 lds
  v_mfma_f32_16x16x32_bf16 a[136:139], a[208:211], v[88:91], 0
  s_mul_i32 s46, s46, 768
  v_accvgpr_read_b32 v56, a104
  v_accvgpr_read_b32 v57, a105
  v_mfma_f32_16x16x32_bf16 a[8:11], a[176:179], v[88:91], 0
  s_add_u32 s46, s46, 0x6000000
  v_accvgpr_read_b32 v58, a106
  v_accvgpr_read_b32 v59, a107
  v_mfma_f32_16x16x32_bf16 a[24:27], a[180:183], v[88:91], 0
  v_pk_mul_f32 v[56:57], v[56:57], v[40:41] op_sel_hi:[1,0]
  v_pk_mul_f32 v[58:59], v[58:59], v[40:41] op_sel_hi:[1,0]
  v_mfma_f32_16x16x32_bf16 a[40:43], a[184:187], v[88:91], 0
  v_cvt_pk_bf16_f32 v56, v56, v57
  v_cvt_pk_bf16_f32 v57, v58, v59
  v_mfma_f32_16x16x32_bf16 a[56:59], a[188:191], v[88:91], 0
  v_accvgpr_read_b32 v60, a120
  v_accvgpr_read_b32 v61, a121
  v_mfma_f32_16x16x32_bf16 a[72:75], a[192:195], v[88:91], 0
  v_accvgpr_read_b32 v62, a122
  v_accvgpr_read_b32 v63, a123
  v_mfma_f32_16x16x32_bf16 a[88:91], a[196:199], v[88:91], 0
  buffer_load_dwordx4 v16, s[20:23], s68 offen offset:3072 sc1 lds
  v_mfma_f32_16x16x32_bf16 a[104:107], a[200:203], v[88:91], 0
  s_add_u32 s49, s58, 24576
  v_pk_mul_f32 v[60:61], v[60:61], v[40:41] op_sel_hi:[1,0]
  v_pk_mul_f32 v[62:63], v[62:63], v[40:41] op_sel_hi:[1,0]
  v_cvt_pk_bf16_f32 v58, v60, v61
  v_cvt_pk_bf16_f32 v59, v62, v63
  buffer_store_dwordx4 v[56:59], v17, s[20:23], s49 offen offset:0 sc1
  v_accvgpr_read_b32 v40, a140
  v_mfma_f32_16x16x32_bf16 a[120:123], a[204:207], v[88:91], 0
  v_subrev_u32 v41, 0x1f800000, v40
  v_rcp_f32 v40, v40
  v_max_u32 v43, v43, v41
  v_mul_f32 v40, v40, v26
  v_accvgpr_read_b32 v48, a12
  v_accvgpr_read_b32 v49, a13
  v_accvgpr_read_b32 v50, a14
  v_accvgpr_read_b32 v51, a15
  v_mfma_f32_16x16x32_bf16 a[140:143], a[208:211], v[92:95], 0
  v_pk_mul_f32 v[48:49], v[48:49], v[40:41] op_sel_hi:[1,0]
  v_pk_mul_f32 v[50:51], v[50:51], v[40:41] op_sel_hi:[1,0]
  v_cvt_pk_bf16_f32 v48, v48, v49
  v_cvt_pk_bf16_f32 v49, v50, v51
  v_accvgpr_read_b32 v52, a28
  v_accvgpr_read_b32 v53, a29
  v_accvgpr_read_b32 v54, a30
  v_accvgpr_read_b32 v55, a31
  v_mfma_f32_16x16x32_bf16 a[12:15], a[176:179], v[92:95], 0
  v_pk_mul_f32 v[52:53], v[52:53], v[40:41] op_sel_hi:[1,0]
  v_pk_mul_f32 v[54:55], v[54:55], v[40:41] op_sel_hi:[1,0]
  v_cvt_pk_bf16_f32 v50, v52, v53
  v_cvt_pk_bf16_f32 v51, v54, v55
  buffer_store_dwordx4 v[48:51], v17, s[20:23], s58 offen offset:2048 sc1
  v_accvgpr_read_b32 v56, a44
  v_accvgpr_read_b32 v57, a45
  v_accvgpr_read_b32 v58, a46
  v_accvgpr_read_b32 v59, a47
  v_mfma_f32_16x16x32_bf16 a[28:31], a[180:183], v[92:95], 0
  v_pk_mul_f32 v[56:57], v[56:57], v[40:41] op_sel_hi:[1,0]
  v_pk_mul_f32 v[58:59], v[58:59], v[40:41] op_sel_hi:[1,0]
  v_cvt_pk_bf16_f32 v56, v56, v57
  v_cvt_pk_bf16_f32 v57, v58, v59
  v_accvgpr_read_b32 v60, a60
  v_accvgpr_read_b32 v61, a61
  v_accvgpr_read_b32 v62, a62
  v_accvgpr_read_b32 v63, a63
  v_mfma_f32_16x16x32_bf16 a[44:47], a[184:187], v[92:95], 0
  s_add_u32 s49, s58, 8192
  v_pk_mul_f32 v[60:61], v[60:61], v[40:41] op_sel_hi:[1,0]
  v_pk_mul_f32 v[62:63], v[62:63], v[40:41] op_sel_hi:[1,0]
  v_cvt_pk_bf16_f32 v58, v60, v61
  v_cvt_pk_bf16_f32 v59, v62, v63
  buffer_store_dwordx4 v[56:59], v17, s[20:23], s49 offen offset:2048 sc1
  v_accvgpr_read_b32 v48, a76
  v_accvgpr_read_b32 v49, a77
  v_accvgpr_read_b32 v50, a78
  v_accvgpr_read_b32 v51, a79
  v_mfma_f32_16x16x32_bf16 a[60:63], a[188:191], v[92:95], 0
  v_pk_mul_f32 v[48:49], v[48:49], v[40:41] op_sel_hi:[1,0]
  v_pk_mul_f32 v[50:51], v[50:51], v[40:41] op_sel_hi:[1,0]
  v_cvt_pk_bf16_f32 v48, v48, v49
  v_cvt_pk_bf16_f32 v49, v50, v51
  v_accvgpr_read_b32 v52, a92
  v_accvgpr_read_b32 v53, a93
  v_accvgpr_read_b32 v54, a94
  v_accvgpr_read_b32 v55, a95
  v_mfma_f32_16x16x32_bf16 a[76:79], a[192:195], v[92:95], 0
  s_add_u32 s49, s58, 16384
  v_pk_mul_f32 v[52:53], v[52:53], v[40:41] op_sel_hi:[1,0]
  v_pk_mul_f32 v[54:55], v[54:55], v[40:41] op_sel_hi:[1,0]
  v_cvt_pk_bf16_f32 v50, v52, v53
  v_cvt_pk_bf16_f32 v51, v54, v55
  buffer_store_dwordx4 v[48:51], v17, s[20:23], s49 offen offset:2048 sc1
  v_accvgpr_read_b32 v56, a108
  v_accvgpr_read_b32 v57, a109
  v_accvgpr_read_b32 v58, a110
  v_accvgpr_read_b32 v59, a111
  v_mfma_f32_16x16x32_bf16 a[92:95], a[196:199], v[92:95], 0
  v_pk_mul_f32 v[56:57], v[56:57], v[40:41] op_sel_hi:[1,0]
  v_pk_mul_f32 v[58:59], v[58:59], v[40:41] op_sel_hi:[1,0]
  v_cvt_pk_bf16_f32 v56, v56, v57
  v_cvt_pk_bf16_f32 v57, v58, v59
  v_accvgpr_read_b32 v60, a124
  v_accvgpr_read_b32 v61, a125
  v_accvgpr_read_b32 v62, a126
  v_accvgpr_read_b32 v63, a127
  v_mfma_f32_16x16x32_bf16 a[108:111], a[200:203], v[92:95], 0
  s_add_u32 s68, s68, 4096
  v_pk_mul_f32 v[60:61], v[60:61], v[40:41] op_sel_hi:[1,0]
  v_pk_mul_f32 v[62:63], v[62:63], v[40:41] op_sel_hi:[1,0]
  v_mfma_f32_16x16x32_bf16 a[124:127], a[204:207], v[92:95], 0
  s_add_u32 s49, s58, 24576
  v_cvt_pk_bf16_f32 v58, v60, v61
  v_cvt_pk_bf16_f32 v59, v62, v63
  buffer_store_dwordx4 v[56:59], v17, s[20:23], s49 offen offset:2048 sc1
  v_add_u32 v9, s46, v16
  v_bfe_u32 v38, v0, 2, 3
  v_lshlrev_b32 v38, 10, v38
  v_lshl_add_u32 v38, v0, 3, v38
  v_add_u32 v32, 12288, v38
  v_add_u32 v33, 125952, v38
  s_mov_b32 s61, 0
  v_add_u32 v34, 50176, v38
  v_add_u32 v35, 88064, v38
  v_mov_b32 v30, 2.0
  s_mov_b32 s59, 0
  s_mov_b32 s60, 0
  s_branch LloopD
Lfinal7:
 WL 7
  v_mfma_f32_16x16x32_bf16 v[96:99], a[144:147], v[144:147], v[248:251]
  ds_read_b128 a[176:179], v19 offset:0
  s_add_u32 m0, s67, 53248
 WL 7
 Mvav 96,148,160
  buffer_load_dwordx4 v16, s[20:23], s68 offen offset:0 sc1 lds
 WL 6
 Mvav 96,152,128
  ds_read_b128 a[180:183], v19 offset:1024
 WL 6
 Mvav 96,156,112
  buffer_load_dwordx2 v[38:39], off, s[36:39], 0 offset:224 sc1
  v_mfma_f32_16x16x32_bf16 v[100:103], a[156:159], v[116:119], v[228:231]
  ds_read_b128 a[184:187], v19 offset:2048
 Mvav 100,152,132
  v_exp_f32 v212, v212
 Mvav 100,148,164
  ds_read_b128 a[188:191], v19 offset:3072
 Mvav 100,144,148
  buffer_load_dwordx4 v16, s[20:23], s68 offen offset:1024 sc1 lds
  v_mfma_f32_16x16x32_bf16 v[104:107], a[144:147], v[152:155], v[232:235]
  ds_read_b128 a[192:195], v19 offset:4096
 Mvav 104,148,168
  v_exp_f32 v213, v213
 Mvav 104,152,136
  v_exp_f32 v214, v214
 Mvav 104,156,120
  ds_read_b128 a[196:199], v19 offset:5120
  v_cvt_pk_bf16_f32 v182, v212, v213
  v_mfma_f32_16x16x32_bf16 v[108:111], a[156:159], v[124:127], v[236:239]
  v_exp_f32 v215, v215
 Mvav 108,152,140
  ds_read_b128 a[200:203], v19 offset:6144
  v_cvt_pk_bf16_f32 v183, v214, v215
 Mvav 108,148,172
  buffer_load_dwordx4 v16, s[20:23], s68 offen offset:2048 sc1 lds
 Mvav 108,144,156
  ds_read_b128 a[204:207], v19 offset:7168
 WL 11
  v_mfma_f32_16x16x32_bf16 v[64:67], a[160:163], v[144:147], v[252:255]
 WL 10
  v_exp_f32 v216, v216
 Mvav 64,164,160
 WL 9
  v_exp_f32 v217, v217
 Mvav 64,168,128
 WL 8
  v_exp_f32 v218, v218
 Mvav 64,172,112
  v_exp_f32 v219, v219
  v_mfma_f32_16x16x32_bf16 v[68:71], a[172:175], v[116:119], v[228:231]
  v_exp_f32 v220, v220
 Mvav 68,168,132
  buffer_load_dwordx4 v16, s[20:23], s68 offen offset:3072 sc1 lds
 Mvav 68,164,164
  s_add_u32 s68, s68, 12288
  v_exp_f32 v221, v221
 Mvav 68,160,148
  v_exp_f32 v222, v222
  v_mfma_f32_16x16x32_bf16 v[72:75], a[160:163], v[152:155], v[232:235]
  v_exp_f32 v223, v223
 Mvav 72,164,168
  v_exp_f32 v96, v96
 Mvav 72,168,136
  v_exp_f32 v97, v97
 Mvav 72,172,120
  v_exp_f32 v98, v98
  v_mfma_f32_16x16x32_bf16 v[76:79], a[172:175], v[124:127], v[236:239]
  v_exp_f32 v99, v99
 Mvav 76,168,140
  v_exp_f32 v100, v100
 Mvav 76,164,172
 WL 0
  s_waitcnt vmcnt(19)
  s_barrier
 Mvav 76,160,156
  ds_read_b128 a[144:147], v18 offset:24576
  v_cvt_pk_bf16_f32 v186, v216, v217
 Maav 128,208,176
  s_add_u32 m0, s67, 0
  v_cvt_pk_bf16_f32 v187, v218, v219
  v_cvt_pk_bf16_f32 v190, v220, v221
 Maav 132,208,180
  ds_read_b128 a[148:151], v18 offset:25600
  v_cvt_pk_bf16_f32 v191, v222, v223
 Maav 136,208,184
  buffer_load_dwordx4 v16, s[20:23], s68 offen offset:0 sc1 lds
 Maav 140,208,188
  ds_read_b128 a[152:155], v18 offset:26624
  v_cvt_pk_bf16_f32 v80, v96, v97
 Maav 12,176,188
  v_exp_f32 v101, v101
 Maav 8,176,184
  v_exp_f32 v102, v102
 Maav 4,176,180
  ds_read_b128 a[156:159], v18 offset:27648
  v_cvt_pk_bf16_f32 v81, v98, v99
 Maav 0,176,176
  v_exp_f32 v103, v103
 Maav 16,180,176
  ds_read_b128 a[160:163], v18 offset:28672
  v_cvt_pk_bf16_f32 v84, v100, v101
 Maav 20,180,180
  buffer_load_dwordx4 v16, s[20:23], s68 offen offset:1024 sc1 lds
 Maav 24,180,184
  v_exp_f32 v104, v104
 Maav 28,180,188
  ds_read_b128 a[164:167], v18 offset:29696
  v_cvt_pk_bf16_f32 v85, v102, v103
 Maav 44,184,188
  v_exp_f32 v105, v105
 Maav 40,184,184
  ds_read_b128 a[168:171], v18 offset:30720
  v_cvt_pk_bf16_f32 v88, v104, v105
 Maav 36,184,180
  v_exp_f32 v106, v106
 Maav 32,184,176
  ds_read_b128 a[172:175], v18 offset:31744
 Maav 48,188,176
  buffer_load_dwordx4 v16, s[20:23], s68 offen offset:2048 sc1 lds
 Maav 52,188,180
  v_exp_f32 v107, v107
 Maav 56,188,184
  v_exp_f32 v108, v108
 Maav 60,188,188
  v_exp_f32 v109, v109
 Maav 76,192,188
  v_exp_f32 v110, v110
 Maav 72,192,184
  v_exp_f32 v111, v111
 Maav 68,192,180
  v_exp_f32 v64, v64
 Maav 64,192,176
  v_exp_f32 v65, v65
 Maav 80,196,176
  buffer_load_dwordx4 v16, s[20:23], s68 offen offset:3072 sc1 lds
 Maav 84,196,180
  s_add_u32 s68, s68, 4096
  v_add_f32 v248, v240, v228
  v_add_f32 v249, v241, v228
 Maav 88,196,184
  v_add_f32 v250, v242, v228
  v_add_f32 v251, v243, v228
 Maav 92,196,188
  v_add_f32 v252, v244, v228
  v_add_f32 v253, v245, v228
 Maav 108,200,188
  v_add_f32 v254, v246, v228
  v_add_f32 v255, v247, v228
 Maav 104,200,184
  v_exp_f32 v66, v66
 Maav 100,200,180
  v_exp_f32 v67, v67
 Maav 96,200,176
  v_exp_f32 v68, v68
 Maav 112,204,176
  v_exp_f32 v69, v69
 Maav 116,204,180
  v_exp_f32 v70, v70
 Maav 120,204,184
 WL 6
  v_exp_f32 v71, v71
 Maav 124,204,188
 WL 7
  v_exp_f32 v72, v72
  v_mfma_f32_16x16x32_bf16 v[196:199], a[144:147], v[148:151], v[248:251]
  ds_read_b128 a[176:179], v19 offset:16384
  s_add_u32 m0, s67, 4096
 Mvav 196,148,164
  ds_read_b128 a[180:183], v19 offset:17408
  v_cvt_pk_bf16_f32 v89, v106, v107
 WL 7
 Mvav 196,152,132
  ds_read_b128 a[184:187], v19 offset:18432
  v_cvt_pk_bf16_f32 v92, v108, v109
 WL 7
 Mvav 196,156,116
  buffer_load_dwordx4 v16, s[20:23], s68 offen offset:0 sc1 lds
  v_mfma_f32_16x16x32_bf16 v[200:203], a[156:159], v[120:123], v[232:235]
  ds_read_b128 a[188:191], v19 offset:19456
  v_cvt_pk_bf16_f32 v93, v110, v111
 Mvav 200,152,136
  ds_read_b128 a[192:195], v19 offset:20480
  v_cvt_pk_bf16_f32 v82, v64, v65
 Mvav 200,148,168
  buffer_load_dwordx4 v16, s[20:23], s68 offen offset:1024 sc1 lds
 Mvav 200,144,152
  ds_read_b128 a[196:199], v19 offset:21504
  v_cvt_pk_bf16_f32 v83, v66, v67
  v_mfma_f32_16x16x32_bf16 v[204:207], a[144:147], v[156:159], v[236:239]
  ds_read_b128 a[200:203], v19 offset:22528
  v_cvt_pk_bf16_f32 v86, v68, v69
 Mvav 204,148,172
  ds_read_b128 a[204:207], v19 offset:23552
  v_cvt_pk_bf16_f32 v87, v70, v71
 Mvav 204,152,140
  buffer_load_dwordx4 v16, s[20:23], s68 offen offset:2048 sc1 lds
 Mvav 204,156,124
 WL 11
  v_exp_f32 v73, v73
  v_mfma_f32_16x16x32_bf16 v[212:215], a[160:163], v[148:151], v[252:255]
 WL 10
  v_exp_f32 v74, v74
 Mvav 212,164,164
 WL 9
  v_exp_f32 v75, v75
 Mvav 212,168,132
 WL 8
  v_exp_f32 v76, v76
 Mvav 212,172,116
  buffer_load_dwordx4 v16, s[20:23], s68 offen offset:3072 sc1 lds
  v_mfma_f32_16x16x32_bf16 v[216:219], a[172:175], v[120:123], v[232:235]
  s_add_u32 s68, s68, 12288
  v_exp_f32 v77, v77
 Mvav 216,168,136
  v_exp_f32 v78, v78
 Mvav 216,164,168
  v_exp_f32 v79, v79
 Mvav 216,160,152
  v_exp_f32 v196, v196
  v_mfma_f32_16x16x32_bf16 v[220:223], a[160:163], v[156:159], v[236:239]
  v_exp_f32 v197, v197
 Mvav 220,164,172
  v_exp_f32 v198, v198
 Mvav 220,168,140
 WL 0
  s_waitcnt vmcnt(18)
  s_barrier
 Mvav 220,172,124
  ds_read_b128 a[144:147], v18 offset:40960
  v_cvt_pk_bf16_f32 v90, v72, v73
 Maav 128,208,80
  v_cvt_pk_bf16_f32 v91, v74, v75
  v_cvt_pk_bf16_f32 v94, v76, v77
 Maav 132,208,84
  ds_read_b128 a[148:151], v18 offset:41984
  v_cvt_pk_bf16_f32 v95, v78, v79
 Maav 136,208,88
  v_exp_f32 v199, v199
 Maav 140,208,92
  ds_read_b128 a[152:155], v18 offset:43008
  v_cvt_pk_bf16_f32 v180, v196, v197
 Maav 12,176,92
  v_exp_f32 v200, v200
 Maav 8,176,88
  v_exp_f32 v201, v201
 Maav 4,176,84
  ds_read_b128 a[156:159], v18 offset:44032
  v_cvt_pk_bf16_f32 v181, v198, v199
 Maav 0,176,80
  v_exp_f32 v202, v202
 Maav 16,180,80
  ds_read_b128 a[160:163], v18 offset:45056
  v_cvt_pk_bf16_f32 v184, v200, v201
 Maav 20,180,84
  v_exp_f32 v203, v203
 Maav 24,180,88
  v_exp_f32 v204, v204
 Maav 28,180,92
  ds_read_b128 a[164:167], v18 offset:46080
  v_cvt_pk_bf16_f32 v185, v202, v203
 Maav 44,184,92
  v_exp_f32 v205, v205
 Maav 40,184,88
  ds_read_b128 a[168:171], v18 offset:47104
  v_cvt_pk_bf16_f32 v188, v204, v205
 Maav 36,184,84
  v_exp_f32 v206, v206
 Maav 32,184,80
  ds_read_b128 a[172:175], v18 offset:48128
  s_waitcnt vmcnt(11)
  v_readfirstlane_b32 s28, v38
 Maav 48,188,80
  ds_read_b128 a[176:179], v19 offset:32768
  v_readfirstlane_b32 s29, v39
 Maav 52,188,84
  ds_read_b128 a[180:183], v19 offset:33792
 Maav 56,188,88
  ds_read_b128 a[184:187], v19 offset:34816
 Maav 60,188,92
  ds_read_b128 a[188:191], v19 offset:35840
 Maav 76,192,92
  v_exp_f32 v207, v207
 Maav 72,192,88
  v_exp_f32 v212, v212
 Maav 68,192,84
  v_exp_f32 v213, v213
 Maav 64,192,80
  ds_read_b128 a[192:195], v19 offset:36864
  v_cvt_pk_bf16_f32 v189, v206, v207
 Maav 80,196,80
  v_add_f32 v248, v240, v232
  v_add_f32 v249, v241, v232
 Maav 84,196,84
  v_add_f32 v250, v242, v232
  v_add_f32 v251, v243, v232
 Maav 88,196,88
  v_add_f32 v252, v244, v232
  v_add_f32 v253, v245, v232
 Maav 92,196,92
  ds_read_b128 a[196:199], v19 offset:37888
  v_add_f32 v254, v246, v232
 Maav 108,200,92
  v_add_f32 v255, v247, v232
  v_cvt_pk_bf16_f32 v182, v212, v213
 Maav 104,200,88
  v_exp_f32 v214, v214
 Maav 100,200,84
  v_exp_f32 v215, v215
 Maav 96,200,80
  ds_read_b128 a[200:203], v19 offset:38912
  v_cvt_pk_bf16_f32 v183, v214, v215
 Maav 112,204,80
  v_exp_f32 v216, v216
 Maav 116,204,84
  v_exp_f32 v217, v217
 Maav 120,204,88
 WL 13
  v_exp_f32 v218, v218
 Maav 124,204,92
  ds_read_b128 a[204:207], v19 offset:39936
  v_cvt_pk_bf16_f32 v186, v216, v217
  v_mfma_f32_16x16x32_bf16 v[104:107], a[144:147], v[152:155], v[248:251]
  v_exp_f32 v219, v219
 Mvav 104,148,168
 WL 13
  v_exp_f32 v220, v220
 Mvav 104,152,136
 WL 12
  v_exp_f32 v221, v221
 Mvav 104,156,120
  v_exp_f32 v222, v222
  v_mfma_f32_16x16x32_bf16 v[108:111], a[156:159], v[124:127], v[236:239]
  v_exp_f32 v223, v223
 Mvav 108,152,140
  v_cvt_pk_bf16_f32 v187, v218, v219
  v_cvt_pk_bf16_f32 v190, v220, v221
 Mvav 108,148,172
  v_cvt_pk_bf16_f32 v191, v222, v223
  v_accvgpr_read_b32 v40, a128
 Mvav 108,144,156
 WL 11
  v_exp_f32 v104, v104
  v_mfma_f32_16x16x32_bf16 v[72:75], a[160:163], v[152:155], v[252:255]
 WL 10
  v_exp_f32 v105, v105
 Mvav 72,164,168
 WL 9
  v_exp_f32 v106, v106
 Mvav 72,168,136
 WL 8
  v_exp_f32 v107, v107
 Mvav 72,172,120
  v_exp_f32 v108, v108
  v_mfma_f32_16x16x32_bf16 v[76:79], a[172:175], v[124:127], v[236:239]
  v_exp_f32 v109, v109
 Mvav 76,168,140
  v_exp_f32 v110, v110
 Mvav 76,164,172
 WL 0
  s_waitcnt vmcnt(8)
  s_barrier
 Mvav 76,160,156
  ds_read_b128 a[144:147], v18 offset:57344
  v_cvt_pk_bf16_f32 v88, v104, v105
 Maav 132,208,180
  ds_read_b128 a[148:151], v18 offset:58368
  v_cvt_pk_bf16_f32 v89, v106, v107
 Maav 136,208,184
  v_exp_f32 v111, v111
 Maav 140,208,188
  ds_read_b128 a[152:155], v18 offset:59392
  v_cvt_pk_bf16_f32 v92, v108, v109
 Maav 12,176,188
  ds_read_b128 a[156:159], v18 offset:60416
  v_cvt_pk_bf16_f32 v93, v110, v111
 Maav 8,176,184
  v_exp_f32 v72, v72
 Maav 4,176,180
  ds_read_b128 a[160:163], v18 offset:61440
  v_subrev_u32 v41, 0x1f800000, v40
 Maav 20,180,180
  ds_read_b128 a[164:167], v18 offset:62464
 Maav 24,180,184
  v_exp_f32 v73, v73
 Maav 28,180,188
  ds_read_b128 a[168:171], v18 offset:63488
  v_cvt_pk_bf16_f32 v90, v72, v73
 Maav 44,184,188
  ds_read_b128 a[172:175], v18 offset:64512
 Maav 40,184,184
  ds_read_b128 a[176:179], v19 offset:49152
 Maav 36,184,180
  ds_read_b128 a[180:183], v19 offset:50176
 Maav 52,188,180
  ds_read_b128 a[184:187], v19 offset:51200
 Maav 56,188,184
  v_exp_f32 v74, v74
 Maav 60,188,188
  ds_read_b128 a[188:191], v19 offset:52224
 Maav 76,192,188
  v_add_f32 v248, v240, v236
  v_add_f32 v249, v241, v236
 Maav 72,192,184
  v_add_f32 v250, v242, v236
  v_add_f32 v251, v243, v236
 Maav 68,192,180
  ds_read_b128 a[192:195], v19 offset:53248
  v_add_f32 v252, v244, v236
 Maav 84,196,180
  v_add_f32 v253, v245, v236
  v_add_f32 v254, v246, v236
 Maav 88,196,184
  v_add_f32 v255, v247, v236
 Maav 92,196,188
  ds_read_b128 a[196:199], v19 offset:54272
 Maav 108,200,188
  v_exp_f32 v75, v75
 Maav 104,200,184
  v_exp_f32 v76, v76
 Maav 100,200,180
  ds_read_b128 a[200:203], v19 offset:55296
  v_cvt_pk_bf16_f32 v91, v74, v75
 Maav 116,204,180
  v_exp_f32 v77, v77
 Maav 120,204,184
 WL 13
  v_exp_f32 v78, v78
 Maav 124,204,188
  ds_read_b128 a[204:207], v19 offset:56320
  v_cvt_pk_bf16_f32 v94, v76, v77
  v_mfma_f32_16x16x32_bf16 v[204:207], a[144:147], v[156:159], v[248:251]
  v_exp_f32 v79, v79
 Mvav 204,148,172
  v_cvt_pk_bf16_f32 v95, v78, v79
 WL 13
 Mvav 204,152,140
  s_cmp_eq_u64 s[28:29], 0
  s_cbranch_scc1 Lpoll_h7
Lback_h7:
  s_lshl_b32 s26, s4, 3
 WL 12
 Mvav 204,156,124
  s_bfm_b64 s[30:31], s26, 0
  s_and_b64 s[30:31], s[30:31], s[28:29]
  s_bcnt1_i32_b64 s30, s[30:31]
 WL 11
  v_mfma_f32_16x16x32_bf16 v[220:223], a[160:163], v[156:159], v[252:255]
  s_lshl_b32 s31, s30, 14
  s_add_u32 s45, s45, s31
  s_mul_i32 s30, s30, 73728
 WL 10
 Mvav 220,164,172
  s_add_u32 s44, s44, s30
  s_lshr_b64 s[28:29], s[28:29], s26
  s_and_b32 s26, s28, 255
 WL 9
 Mvav 220,168,140
 WL 0
  s_waitcnt vmcnt(0)
  s_barrier
 Mvav 220,172,124
  s_bcnt1_i32_b32 s26, s26
  v_exp_f32 v204, v204
 Maav 136,208,88
  ds_read_b128 a[144:147], v19 offset:0
  s_add_u32 s46, s45, 0
 Maav 140,208,92
  buffer_load_dwordx4 a[212:215], v16, s[20:23], s46 offen offset:0 sc1
 Maav 12,176,92
  ds_read_b128 a[148:151], v19 offset:1024
 Maav 8,176,88
  buffer_load_dwordx4 a[216:219], v16, s[20:23], s46 offen offset:2048 sc1
 Maav 24,180,88
  ds_read_b128 a[152:155], v19 offset:2048
 Maav 28,180,92
  buffer_load_dwordx4 a[220:223], v17, s[20:23], s46 offen offset:0 sc1
 Maav 44,184,92
  ds_read_b128 a[156:159], v19 offset:3072
 Maav 40,184,88
  buffer_load_dwordx4 a[224:227], v17, s[20:23], s46 offen offset:2048 sc1
 Maav 56,188,88
  ds_read_b128 a[160:163], v19 offset:4096
  s_add_u32 s46, s45, 8192
 Maav 60,188,92
  buffer_load_dwordx4 a[228:231], v16, s[20:23], s46 offen offset:0 sc1
 Maav 76,192,92
  ds_read_b128 a[164:167], v19 offset:5120
 Maav 72,192,88
  buffer_load_dwordx4 a[232:235], v16, s[20:23], s46 offen offset:2048 sc1
 Maav 88,196,88
  ds_read_b128 a[168:171], v19 offset:6144
 Maav 92,196,92
  buffer_load_dwordx4 a[236:239], v17, s[20:23], s46 offen offset:0 sc1
 Maav 108,200,92
  ds_read_b128 a[172:175], v19 offset:7168
 Maav 104,200,88
  v_exp_f32 v205, v205
  v_exp_f32 v206, v206
  v_exp_f32 v207, v207
  v_exp_f32 v220, v220
  v_exp_f32 v221, v221
  v_exp_f32 v222, v222
  v_exp_f32 v223, v223
 Maav 120,204,88
 WL 7
  v_cvt_pk_bf16_f32 v188, v204, v205
  v_cvt_pk_bf16_f32 v189, v206, v207
  v_cvt_pk_bf16_f32 v190, v220, v221
  v_cvt_pk_bf16_f32 v191, v222, v223
 Maav 124,204,92
  buffer_load_dwordx4 a[240:243], v17, s[20:23], s46 offen offset:2048 sc1
 Maav 140,208,188
  s_add_u32 m0, s47, 12288
  v_rcp_f32 v40, v40
 Maav 12,144,188
  buffer_load_dwordx4 v1, s[12:15], s44 offen lds
 WL 6
 Maav 28,148,188
  buffer_load_dwordx4 v2, s[12:15], s44 offen offset:1056 lds
 WL 5
 Maav 44,152,188
  buffer_load_dwordx4 v3, s[12:15], s44 offen offset:2112 lds
 WL 4
 Maav 60,156,188
  buffer_load_dwordx4 v4, s[12:15], s44 offen offset:3168 lds
 WL 3
 Maav 76,160,188
  s_add_u32 m0, s47, 16512
  v_max_u32 v43, v43, v41
  v_mul_f32 v40, v40, v20
 WL 2
 Maav 92,164,188
  buffer_load_dwordx4 v5, s[12:15], s44 offen lds
 WL 1
 Maav 108,168,188
  buffer_load_dwordx4 v6, s[12:15], s44 offen offset:1056 lds
 WL 0
 Maav 124,172,188
  buffer_load_dwordx4 v7, s[12:15], s44 offen offset:2112 lds
  buffer_load_dwordx4 v8, s[12:15], s44 offen offset:3168 lds
  s_add_u32 m0, s47, 20736
  s_nop 0
  buffer_load_dwordx4 v9, s[20:23], s44 offen sc1 lds
  s_add_u32 s46, s45, 16384
  buffer_load_dwordx4 a[176:179], v16, s[20:23], s46 offen offset:0 sc1
  v_accvgpr_read_b32 v48, a0
  buffer_load_dwordx4 a[180:183], v16, s[20:23], s46 offen offset:2048 sc1
  v_accvgpr_read_b32 v49, a1
  buffer_load_dwordx4 a[184:187], v17, s[20:23], s46 offen offset:0 sc1
  v_accvgpr_read_b32 v50, a2
  buffer_load_dwordx4 a[188:191], v17, s[20:23], s46 offen offset:2048 sc1
  s_add_u32 s46, s45, 24576
  buffer_load_dwordx4 a[192:195], v16, s[20:23], s46 offen offset:0 sc1
  v_accvgpr_read_b32 v51, a3
  buffer_load_dwordx4 a[196:199], v16, s[20:23], s46 offen offset:2048 sc1
  v_pk_mul_f32 v[48:49], v[48:49], v[40:41] op_sel_hi:[1,0]
  buffer_load_dwordx4 a[200:203], v17, s[20:23], s46 offen offset:0 sc1
  v_pk_mul_f32 v[50:51], v[50:51], v[40:41] op_sel_hi:[1,0]
  buffer_load_dwordx4 a[204:207], v17, s[20:23], s46 offen offset:2048 sc1
  s_add_u32 s46, s45, 32768
  buffer_load_dwordx4 a[144:147], v16, s[20:23], s46 offen offset:0 sc1
  v_cvt_pk_bf16_f32 v48, v48, v49
  buffer_load_dwordx4 a[148:151], v16, s[20:23], s46 offen offset:2048 sc1
  v_cvt_pk_bf16_f32 v49, v50, v51
  buffer_load_dwordx4 a[152:155], v17, s[20:23], s46 offen offset:0 sc1
  v_accvgpr_read_b32 v52, a16
  buffer_load_dwordx4 a[156:159], v17, s[20:23], s46 offen offset:2048 sc1
  s_add_u32 s46, s45, 40960
  buffer_load_dwordx4 a[160:163], v16, s[20:23], s46 offen offset:0 sc1
  v_accvgpr_read_b32 v53, a17
  buffer_load_dwordx4 a[164:167], v16, s[20:23], s46 offen offset:2048 sc1
  v_accvgpr_read_b32 v54, a18
  buffer_load_dwordx4 a[168:171], v17, s[20:23], s46 offen offset:0 sc1
  v_accvgpr_read_b32 v55, a19
  buffer_load_dwordx4 a[172:175], v17, s[20:23], s46 offen offset:2048 sc1
  s_add_u32 s44, s44, 147456
  s_add_u32 m0, s47, 125952
  v_pk_mul_f32 v[52:53], v[52:53], v[40:41] op_sel_hi:[1,0]
  v_pk_mul_f32 v[54:55], v[54:55], v[40:41] op_sel_hi:[1,0]
  v_cvt_pk_bf16_f32 v50, v52, v53
  buffer_load_dwordx4 v1, s[12:15], s44 offen lds
  v_cvt_pk_bf16_f32 v51, v54, v55
  buffer_load_dwordx4 v2, s[12:15], s44 offen offset:1056 lds
  buffer_store_dwordx4 v[48:51], v16, s[20:23], s58 offen offset:0 sc1
  buffer_load_dwordx4 v3, s[12:15], s44 offen offset:2112 lds
  v_accvgpr_read_b32 v56, a32
  buffer_load_dwordx4 v4, s[12:15], s44 offen offset:3168 lds
  s_add_u32 m0, s47, 130176
  s_nop 0
  buffer_load_dwordx4 v5, s[12:15], s44 offen lds
  v_accvgpr_read_b32 v57, a33
  buffer_load_dwordx4 v6, s[12:15], s44 offen offset:1056 lds
  s_cmp_lt_u32 s3, 2
  s_cbranch_scc1 Lb7_0
  s_barrier
Lb7_0:
  v_accvgpr_read_b32 v58, a34
  buffer_load_dwordx4 v7, s[12:15], s44 offen offset:2112 lds
  v_accvgpr_read_b32 v59, a35
  buffer_load_dwordx4 v8, s[12:15], s44 offen offset:3168 lds
  s_add_u32 m0, s47, 134400
  s_nop 0
  buffer_load_dwordx4 v9, s[20:23], s44 offen sc1 lds
  v_pk_mul_f32 v[56:57], v[56:57], v[40:41] op_sel_hi:[1,0]
  v_pk_mul_f32 v[58:59], v[58:59], v[40:41] op_sel_hi:[1,0]
  v_cvt_pk_bf16_f32 v56, v56, v57
  v_cvt_pk_bf16_f32 v57, v58, v59
  v_accvgpr_read_b32 v60, a48
  v_accvgpr_read_b32 v61, a49
  v_accvgpr_read_b32 v62, a50
  v_accvgpr_read_b32 v63, a51
  v_pk_mul_f32 v[60:61], v[60:61], v[40:41] op_sel_hi:[1,0]
  v_pk_mul_f32 v[62:63], v[62:63], v[40:41] op_sel_hi:[1,0]
  s_add_u32 s49, s58, 8192
  v_cvt_pk_bf16_f32 v58, v60, v61
  v_cvt_pk_bf16_f32 v59, v62, v63
  buffer_store_dwordx4 v[56:59], v16, s[20:23], s49 offen offset:0 sc1
  v_accvgpr_read_b32 v48, a64
  v_accvgpr_read_b32 v49, a65
  v_accvgpr_read_b32 v50, a66
  v_accvgpr_read_b32 v51, a67
  v_pk_mul_f32 v[48:49], v[48:49], v[40:41] op_sel_hi:[1,0]
  v_pk_mul_f32 v[50:51], v[50:51], v[40:41] op_sel_hi:[1,0]
  v_cvt_pk_bf16_f32 v48, v48, v49
  v_cvt_pk_bf16_f32 v49, v50, v51
  v_accvgpr_read_b32 v52, a80
  v_accvgpr_read_b32 v53, a81
  v_accvgpr_read_b32 v54, a82
  v_accvgpr_read_b32 v55, a83
  v_pk_mul_f32 v[52:53], v[52:53], v[40:41] op_sel_hi:[1,0]
  v_pk_mul_f32 v[54:55], v[54:55], v[40:41] op_sel_hi:[1,0]
  v_cvt_pk_bf16_f32 v50, v52, v53
  s_add_u32 s49, s58, 16384
  v_cvt_pk_bf16_f32 v51, v54, v55
  buffer_store_dwordx4 v[48:51], v16, s[20:23], s49 offen offset:0 sc1
  v_accvgpr_read_b32 v56, a96
  v_accvgpr_read_b32 v57, a97
  v_accvgpr_read_b32 v58, a98
  v_accvgpr_read_b32 v59, a99
  v_pk_mul_f32 v[56:57], v[56:57], v[40:41] op_sel_hi:[1,0]
  v_pk_mul_f32 v[58:59], v[58:59], v[40:41] op_sel_hi:[1,0]
  v_cvt_pk_bf16_f32 v56, v56, v57
  v_cvt_pk_bf16_f32 v57, v58, v59
  v_accvgpr_read_b32 v60, a112
  v_accvgpr_read_b32 v61, a113
  v_accvgpr_read_b32 v62, a114
  v_accvgpr_read_b32 v63, a115
  v_pk_mul_f32 v[60:61], v[60:61], v[40:41] op_sel_hi:[1,0]
  v_pk_mul_f32 v[62:63], v[62:63], v[40:41] op_sel_hi:[1,0]
  v_cvt_pk_bf16_f32 v58, v60, v61
  s_add_u32 s49, s58, 24576
  v_cvt_pk_bf16_f32 v59, v62, v63
  buffer_store_dwordx4 v[56:59], v16, s[20:23], s49 offen offset:0 sc1
  v_accvgpr_read_b32 v40, a132
  v_subrev_u32 v41, 0x1f800000, v40
  v_rcp_f32 v40, v40
  v_max_u32 v43, v43, v41
  v_mul_f32 v40, v40, v22
  v_accvgpr_read_b32 v48, a4
  v_accvgpr_read_b32 v49, a5
  v_accvgpr_read_b32 v50, a6
  v_accvgpr_read_b32 v51, a7
  v_pk_mul_f32 v[48:49], v[48:49], v[40:41] op_sel_hi:[1,0]
  v_pk_mul_f32 v[50:51], v[50:51], v[40:41] op_sel_hi:[1,0]
  v_cvt_pk_bf16_f32 v48, v48, v49
  v_cvt_pk_bf16_f32 v49, v50, v51
  v_accvgpr_read_b32 v52, a20
  v_accvgpr_read_b32 v53, a21
  v_accvgpr_read_b32 v54, a22
  v_accvgpr_read_b32 v55, a23
  v_pk_mul_f32 v[52:53], v[52:53], v[40:41] op_sel_hi:[1,0]
  v_pk_mul_f32 v[54:55], v[54:55], v[40:41] op_sel_hi:[1,0]
  v_cvt_pk_bf16_f32 v50, v52, v53
  v_cvt_pk_bf16_f32 v51, v54, v55
  buffer_store_dwordx4 v[48:51], v16, s[20:23], s58 offen offset:2048 sc1
  v_accvgpr_read_b32 v56, a36
  v_accvgpr_read_b32 v57, a37
  v_accvgpr_read_b32 v58, a38
  v_accvgpr_read_b32 v59, a39
  v_pk_mul_f32 v[56:57], v[56:57], v[40:41] op_sel_hi:[1,0]
  v_pk_mul_f32 v[58:59], v[58:59], v[40:41] op_sel_hi:[1,0]
  v_cvt_pk_bf16_f32 v56, v56, v57
  v_cvt_pk_bf16_f32 v57, v58, v59
  v_accvgpr_read_b32 v60, a52
  v_accvgpr_read_b32 v61, a53
  v_accvgpr_read_b32 v62, a54
  v_accvgpr_read_b32 v63, a55
  v_pk_mul_f32 v[60:61], v[60:61], v[40:41] op_sel_hi:[1,0]
  v_pk_mul_f32 v[62:63], v[62:63], v[40:41] op_sel_hi:[1,0]
  v_cvt_pk_bf16_f32 v58, v60, v61
  s_add_u32 s49, s58, 8192
  v_cvt_pk_bf16_f32 v59, v62, v63
  buffer_store_dwordx4 v[56:59], v16, s[20:23], s49 offen offset:2048 sc1
  v_accvgpr_read_b32 v48, a68
  v_accvgpr_read_b32 v49, a69
  v_accvgpr_read_b32 v50, a70
  v_accvgpr_read_b32 v51, a71
  v_pk_mul_f32 v[48:49], v[48:49], v[40:41] op_sel_hi:[1,0]
  v_pk_mul_f32 v[50:51], v[50:51], v[40:41] op_sel_hi:[1,0]
  v_cvt_pk_bf16_f32 v48, v48, v49
  v_cvt_pk_bf16_f32 v49, v50, v51
  v_accvgpr_read_b32 v52, a84
  v_accvgpr_read_b32 v53, a85
  v_accvgpr_read_b32 v54, a86
  v_accvgpr_read_b32 v55, a87
  v_pk_mul_f32 v[52:53], v[52:53], v[40:41] op_sel_hi:[1,0]
  v_pk_mul_f32 v[54:55], v[54:55], v[40:41] op_sel_hi:[1,0]
  v_cvt_pk_bf16_f32 v50, v52, v53
  s_add_u32 s49, s58, 16384
  v_cvt_pk_bf16_f32 v51, v54, v55
  buffer_store_dwordx4 v[48:51], v16, s[20:23], s49 offen offset:2048 sc1
  v_accvgpr_read_b32 v56, a100
  v_accvgpr_read_b32 v57, a101
  v_accvgpr_read_b32 v58, a102
  v_accvgpr_read_b32 v59, a103
  v_pk_mul_f32 v[56:57], v[56:57], v[40:41] op_sel_hi:[1,0]
  v_pk_mul_f32 v[58:59], v[58:59], v[40:41] op_sel_hi:[1,0]
  v_cvt_pk_bf16_f32 v56, v56, v57
  v_cvt_pk_bf16_f32 v57, v58, v59
  v_accvgpr_read_b32 v60, a116
  v_accvgpr_read_b32 v61, a117
  v_accvgpr_read_b32 v62, a118
  v_accvgpr_read_b32 v63, a119
  v_pk_mul_f32 v[60:61], v[60:61], v[40:41] op_sel_hi:[1,0]
  v_pk_mul_f32 v[62:63], v[62:63], v[40:41] op_sel_hi:[1,0]
  v_cvt_pk_bf16_f32 v58, v60, v61
  s_add_u32 s49, s58, 24576
  v_cvt_pk_bf16_f32 v59, v62, v63
  buffer_store_dwordx4 v[56:59], v16, s[20:23], s49 offen offset:2048 sc1
  v_accvgpr_read_b32 v40, a136
  v_subrev_u32 v41, 0x1f800000, v40
  v_rcp_f32 v40, v40
  v_max_u32 v43, v43, v41
  v_mul_f32 v40, v40, v24
  v_accvgpr_read_b32 v48, a8
  v_accvgpr_read_b32 v49, a9
  v_accvgpr_read_b32 v50, a10
  v_accvgpr_read_b32 v51, a11
  v_pk_mul_f32 v[48:49], v[48:49], v[40:41] op_sel_hi:[1,0]
  v_pk_mul_f32 v[50:51], v[50:51], v[40:41] op_sel_hi:[1,0]
  v_cvt_pk_bf16_f32 v48, v48, v49
  v_cvt_pk_bf16_f32 v49, v50, v51
  v_accvgpr_read_b32 v52, a24
  v_accvgpr_read_b32 v53, a25
  v_accvgpr_read_b32 v54, a26
  v_accvgpr_read_b32 v55, a27
  v_pk_mul_f32 v[52:53], v[52:53], v[40:41] op_sel_hi:[1,0]
  v_pk_mul_f32 v[54:55], v[54:55], v[40:41] op_sel_hi:[1,0]
  v_cvt_pk_bf16_f32 v50, v52, v53
  s_cmp_lt_u32 s3, 2
  s_cbranch_scc1 Lb7_1
  s_barrier
Lb7_1:
  v_cvt_pk_bf16_f32 v51, v54, v55
  buffer_store_dwordx4 v[48:51], v17, s[20:23], s58 offen offset:0 sc1
  v_accvgpr_read_b32 v56, a40
  v_accvgpr_read_b32 v57, a41
  v_accvgpr_read_b32 v58, a42
  v_accvgpr_read_b32 v59, a43
  v_pk_mul_f32 v[56:57], v[56:57], v[40:41] op_sel_hi:[1,0]
  v_pk_mul_f32 v[58:59], v[58:59], v[40:41] op_sel_hi:[1,0]
  v_cvt_pk_bf16_f32 v56, v56, v57
  v_cvt_pk_bf16_f32 v57, v58, v59
  v_accvgpr_read_b32 v60, a56
  v_accvgpr_read_b32 v61, a57
  v_accvgpr_read_b32 v62, a58
  v_accvgpr_read_b32 v63, a59
  v_pk_mul_f32 v[60:61], v[60:61], v[40:41] op_sel_hi:[1,0]
  v_pk_mul_f32 v[62:63], v[62:63], v[40:41] op_sel_hi:[1,0]
  v_cvt_pk_bf16_f32 v58, v60, v61
  s_add_u32 s49, s58, 8192
  v_cvt_pk_bf16_f32 v59, v62, v63
  buffer_store_dwordx4 v[56:59], v17, s[20:23], s49 offen offset:0 sc1
  v_accvgpr_read_b32 v48, a72
  v_accvgpr_read_b32 v49, a73
  v_accvgpr_read_b32 v50, a74
  v_accvgpr_read_b32 v51, a75
  v_pk_mul_f32 v[48:49], v[48:49], v[40:41] op_sel_hi:[1,0]
  v_pk_mul_f32 v[50:51], v[50:51], v[40:41] op_sel_hi:[1,0]
  v_cvt_pk_bf16_f32 v48, v48, v49
  v_cvt_pk_bf16_f32 v49, v50, v51
  v_accvgpr_read_b32 v52, a88
  v_accvgpr_read_b32 v53, a89
  v_accvgpr_read_b32 v54, a90
  v_accvgpr_read_b32 v55, a91
  v_pk_mul_f32 v[52:53], v[52:53], v[40:41] op_sel_hi:[1,0]
  v_pk_mul_f32 v[54:55], v[54:55], v[40:41] op_sel_hi:[1,0]
  v_cvt_pk_bf16_f32 v50, v52, v53
  s_add_u32 s49, s58, 16384
  v_cvt_pk_bf16_f32 v51, v54, v55
  buffer_store_dwordx4 v[48:51], v17, s[20:23], s49 offen offset:0 sc1
  v_accvgpr_read_b32 v56, a104
  v_accvgpr_read_b32 v57, a105
  v_accvgpr_read_b32 v58, a106
  v_accvgpr_read_b32 v59, a107
  v_pk_mul_f32 v[56:57], v[56:57], v[40:41] op_sel_hi:[1,0]
  v_pk_mul_f32 v[58:59], v[58:59], v[40:41] op_sel_hi:[1,0]
  v_cvt_pk_bf16_f32 v56, v56, v57
  v_cvt_pk_bf16_f32 v57, v58, v59
  v_accvgpr_read_b32 v60, a120
  v_accvgpr_read_b32 v61, a121
  v_accvgpr_read_b32 v62, a122
  v_accvgpr_read_b32 v63, a123
  v_pk_mul_f32 v[60:61], v[60:61], v[40:41] op_sel_hi:[1,0]
  v_pk_mul_f32 v[62:63], v[62:63], v[40:41] op_sel_hi:[1,0]
  v_cvt_pk_bf16_f32 v58, v60, v61
  s_add_u32 s49, s58, 24576
  v_cvt_pk_bf16_f32 v59, v62, v63
  buffer_store_dwordx4 v[56:59], v17, s[20:23], s49 offen offset:0 sc1
  v_accvgpr_read_b32 v40, a140
  v_subrev_u32 v41, 0x1f800000, v40
  v_rcp_f32 v40, v40
  v_max_u32 v43, v43, v41
  v_mul_f32 v40, v40, v26
  v_accvgpr_read_b32 v48, a12
  v_accvgpr_read_b32 v49, a13
  v_accvgpr_read_b32 v50, a14
  v_accvgpr_read_b32 v51, a15
  v_pk_mul_f32 v[48:49], v[48:49], v[40:41] op_sel_hi:[1,0]
  v_pk_mul_f32 v[50:51], v[50:51], v[40:41] op_sel_hi:[1,0]
  v_cvt_pk_bf16_f32 v48, v48, v49
  v_cvt_pk_bf16_f32 v49, v50, v51
  v_accvgpr_read_b32 v52, a28
  v_accvgpr_read_b32 v53, a29
  v_accvgpr_read_b32 v54, a30
  v_accvgpr_read_b32 v55, a31
  v_pk_mul_f32 v[52:53], v[52:53], v[40:41] op_sel_hi:[1,0]
  v_pk_mul_f32 v[54:55], v[54:55], v[40:41] op_sel_hi:[1,0]
  v_cvt_pk_bf16_f32 v50, v52, v53
  v_cvt_pk_bf16_f32 v51, v54, v55
  buffer_store_dwordx4 v[48:51], v17, s[20:23], s58 offen offset:2048 sc1
  v_accvgpr_read_b32 v56, a44
  v_accvgpr_read_b32 v57, a45
  v_accvgpr_read_b32 v58, a46
  v_accvgpr_read_b32 v59, a47
  v_pk_mul_f32 v[56:57], v[56:57], v[40:41] op_sel_hi:[1,0]
  v_pk_mul_f32 v[58:59], v[58:59], v[40:41] op_sel_hi:[1,0]
  v_cvt_pk_bf16_f32 v56, v56, v57
  v_cvt_pk_bf16_f32 v57, v58, v59
  v_accvgpr_read_b32 v60, a60
  v_accvgpr_read_b32 v61, a61
  v_accvgpr_read_b32 v62, a62
  v_accvgpr_read_b32 v63, a63
  v_pk_mul_f32 v[60:61], v[60:61], v[40:41] op_sel_hi:[1,0]
  v_pk_mul_f32 v[62:63], v[62:63], v[40:41] op_sel_hi:[1,0]
  v_cvt_pk_bf16_f32 v58, v60, v61
  s_add_u32 s49, s58, 8192
  v_cvt_pk_bf16_f32 v59, v62, v63
  buffer_store_dwordx4 v[56:59], v17, s[20:23], s49 offen offset:2048 sc1
  v_accvgpr_read_b32 v48, a76
  v_accvgpr_read_b32 v49, a77
  v_accvgpr_read_b32 v50, a78
  v_accvgpr_read_b32 v51, a79
  v_pk_mul_f32 v[48:49], v[48:49], v[40:41] op_sel_hi:[1,0]
  v_pk_mul_f32 v[50:51], v[50:51], v[40:41] op_sel_hi:[1,0]
  v_cvt_pk_bf16_f32 v48, v48, v49
  v_cvt_pk_bf16_f32 v49, v50, v51
  v_accvgpr_read_b32 v52, a92
  v_accvgpr_read_b32 v53, a93
  v_accvgpr_read_b32 v54, a94
  v_accvgpr_read_b32 v55, a95
  v_pk_mul_f32 v[52:53], v[52:53], v[40:41] op_sel_hi:[1,0]
  v_pk_mul_f32 v[54:55], v[54:55], v[40:41] op_sel_hi:[1,0]
  v_cvt_pk_bf16_f32 v50, v52, v53
  s_add_u32 s49, s58, 16384
  v_cvt_pk_bf16_f32 v51, v54, v55
  buffer_store_dwordx4 v[48:51], v17, s[20:23], s49 offen offset:2048 sc1
  v_accvgpr_read_b32 v56, a108
  v_accvgpr_read_b32 v57, a109
  v_accvgpr_read_b32 v58, a110
  v_accvgpr_read_b32 v59, a111
  v_pk_mul_f32 v[56:57], v[56:57], v[40:41] op_sel_hi:[1,0]
  v_pk_mul_f32 v[58:59], v[58:59], v[40:41] op_sel_hi:[1,0]
  v_cvt_pk_bf16_f32 v56, v56, v57
  v_cvt_pk_bf16_f32 v57, v58, v59
  v_accvgpr_read_b32 v60, a124
  v_accvgpr_read_b32 v61, a125
  v_accvgpr_read_b32 v62, a126
  v_accvgpr_read_b32 v63, a127
  v_pk_mul_f32 v[60:61], v[60:61], v[40:41] op_sel_hi:[1,0]
  v_pk_mul_f32 v[62:63], v[62:63], v[40:41] op_sel_hi:[1,0]
  v_cvt_pk_bf16_f32 v58, v60, v61
  s_add_u32 s49, s58, 24576
  v_cvt_pk_bf16_f32 v59, v62, v63
  s_cmp_lt_u32 s3, 2
  s_cbranch_scc1 Lb7_2
  s_barrier
Lb7_2:
  buffer_store_dwordx4 v[56:59], v17, s[20:23], s49 offen offset:2048 sc1
  s_cmp_lt_u32 s3, 2
  s_cbranch_scc1 Ldone
  s_barrier
  s_branch Ldone
Lpoll_g:
  buffer_load_dword v38, off, s[36:39], s66 sc1
  s_waitcnt vmcnt(0)
  v_readfirstlane_b32 s65, v38
  s_nop 1
  s_cmp_ge_u32 s65, 32
  s_cbranch_scc1 Lback_g
  s_branch Lpoll_g
Lwb_kv:
  buffer_wbl2 sc1
  s_waitcnt vmcnt(0)
  s_branch Lwbb_kv
Lpoll_kv:
  buffer_load_dword v38, off, s[36:39], s66 sc1
  s_waitcnt vmcnt(0)
  v_readfirstlane_b32 s65, v38
  s_nop 1
  s_cmp_ge_u32 s65, 8
  s_cbranch_scc1 Lback_kv
  s_branch Lpoll_kv
Lpoll_hL:
  buffer_load_dwordx2 v[38:39], off, s[36:39], 0 offset:224 sc1
  s_waitcnt vmcnt(0)
  v_readfirstlane_b32 s28, v38
  v_readfirstlane_b32 s29, v39
  s_nop 1
  s_cmp_eq_u64 s[28:29], 0
  s_cbranch_scc0 Lback_hL
  s_branch Lpoll_hL
Lplan:
  s_waitcnt vmcnt(5)
Lplan1:
  v_readlane_b32 s30, v53, 8
  v_cmp_gt_u32 vcc, 64, v53
  s_cmp_lg_u32 s30, 0
  s_cbranch_scc1 Lplanb
  s_and_b32 s30, vcc_lo, 255
  s_cbranch_scc0 Lplan2
  buffer_load_dword v52, v50, s[20:23], s33 offen offset:64 sc1
  buffer_load_dword v53, v51, s[36:39], 0 offen sc1
  s_waitcnt vmcnt(0)
  s_branch Lplan1
Lplan2:
  v_and_b32 v52, 255, v52
  v_mov_b32 v54, v52
  s_nop 1
  v_permlane32_swap_b32 v54, v52
  s_nop 1
  v_add_u32 v52, v52, v54
  v_mov_b32 v54, v52
  s_nop 1
  v_permlane16_swap_b32 v54, v52
  s_nop 1
  v_add_u32 v52, v52, v54
  s_nop 1
  v_add_u32_dpp v52, v52, v52 row_ror:8 row_mask:0xf bank_mask:0xf
  v_mul_u32_u24 v52, 11, v52
  v_or_b32 v52, 7, v52
  v_and_b32 v54, 7, v0
  v_sub_u32 v52, v54, v52
  v_lshrrev_b32 v55, 3, v0
  v_lshlrev_b32 v55, 2, v55
  ds_bpermute_b32 v55, v55, v52
  v_lshlrev_b32 v54, 7, v54
  v_mov_b32 v56, 0
 WL 0
  v_add_u32 v55, v55, v54
  v_add_u32 v55, 128, v55
  v_readlane_b32 s30, v52, 0
  s_nop 1
  v_subrev_u32 v54, s30, v55
  v_ashrrev_i32 v54, 7, v54
  v_med3_i32 v54, v54, 0, 7
  v_add_u32 v56, v56, v54
  v_readlane_b32 s30, v52, 1
  s_nop 1
  v_subrev_u32 v54, s30, v55
  v_ashrrev_i32 v54, 7, v54
  v_med3_i32 v54, v54, 0, 7
  v_add_u32 v56, v56, v54
  v_readlane_b32 s30, v52, 2
  s_nop 1
  v_subrev_u32 v54, s30, v55
  v_ashrrev_i32 v54, 7, v54
  v_med3_i32 v54, v54, 0, 7
  v_add_u32 v56, v56, v54
  v_readlane_b32 s30, v52, 3
  s_nop 1
  v_subrev_u32 v54, s30, v55
  v_ashrrev_i32 v54, 7, v54
  v_med3_i32 v54, v54, 0, 7
  v_add_u32 v56, v56, v54
  v_readlane_b32 s30, v52, 4
  s_nop 1
  v_subrev_u32 v54, s30, v55
  v_ashrrev_i32 v54, 7, v54
  v_med3_i32 v54, v54, 0, 7
  v_add_u32 v56, v56, v54
  v_readlane_b32 s30, v52, 5
  s_nop 1
  v_subrev_u32 v54, s30, v55
  v_ashrrev_i32 v54, 7, v54
  v_med3_i32 v54, v54, 0, 7
  v_add_u32 v56, v56, v54
  v_readlane_b32 s30, v52, 6
  s_nop 1
  v_subrev_u32 v54, s30, v55
  v_ashrrev_i32 v54, 7, v54
  v_med3_i32 v54, v54, 0, 7
  v_add_u32 v56, v56, v54
  v_readlane_b32 s30, v52, 7
  s_nop 1
  v_subrev_u32 v54, s30, v55
  v_ashrrev_i32 v54, 7, v54
  v_med3_i32 v54, v54, 0, 7
  v_add_u32 v56, v56, v54
  v_cmp_ge_u32 vcc, 32, v56
  v_mov_b32 v54, 0
  v_mov_b32 v55, 0
  s_and_b32 s30, vcc_lo, 0x7f7f7f7f
  s_and_b32 s31, vcc_hi, 0x7f7f7f7f
  v_mov_b32 v52, s30
  v_mov_b32 v53, s31
  buffer_atomic_cmpswap_x2 v[52:55], v48, s[36:39], 0 offen offset:224 sc1
  s_branch Lplanb
Lpoll_hS:
  buffer_load_dwordx2 v[38:39], off, s[36:39], 0 offset:224 sc1
  s_waitcnt vmcnt(0)
  v_readfirstlane_b32 s28, v38
  v_readfirstlane_b32 s29, v39
  s_nop 1
  s_cmp_eq_u64 s[28:29], 0
  s_cbranch_scc0 Lback_hS
  s_branch Lpoll_hS
Lpoll_h7:
  buffer_load_dwordx2 v[38:39], off, s[36:39], 0 offset:224 sc1
  s_waitcnt vmcnt(0)
  v_readfirstlane_b32 s28, v38
  v_readfirstlane_b32 s29, v39
  s_nop 1
  s_cmp_eq_u64 s[28:29], 0
  s_cbranch_scc0 Lback_h7
  s_branch Lpoll_h7
Lend1:
Lexit1:
  s_endpgm
Lrestart1:
  s_branch Lstart
Lpre:
  s_waitcnt vmcnt(0) lgkmcnt(0)
  s_nop 7
  s_mul_i32 s44, s4, 0x104000
  s_add_u32 s44, s44, 0x10000
  s_lshl_b32 s45, s63, 2
  s_sub_u32 s45, 0, s45
  v_mov_b32 v53, 0xff800000
  v_mov_b32 v48, v53
  v_mov_b32 v49, v53
  v_mov_b32 v50, v53
  v_mov_b32 v51, v53
  v_mov_b32 v192, 0
  v_mov_b32 v193, 0
  v_mov_b32 v194, 0
  v_mov_b32 v195, 0
  v_mov_b32 v196, 0
  v_mov_b32 v197, 0
  v_mov_b32 v198, 0
  v_mov_b32 v199, 0
  v_mov_b32 v200, 0
  v_mov_b32 v201, 0
  v_mov_b32 v202, 0
  v_mov_b32 v203, 0
  v_mov_b32 v204, 0
  v_mov_b32 v205, 0
  v_mov_b32 v206, 0
  v_mov_b32 v207, 0
  v_mov_b32 v208, 0
  v_mov_b32 v209, 0
  v_mov_b32 v210, 0
  v_mov_b32 v211, 0
  v_mov_b32 v212, 0
  v_mov_b32 v213, 0
  v_mov_b32 v214, 0
  v_mov_b32 v215, 0
  v_mov_b32 v216, 0
  v_mov_b32 v217, 0
  v_mov_b32 v218, 0
  v_mov_b32 v219, 0
  v_mov_b32 v220, 0
  v_mov_b32 v221, 0
  v_mov_b32 v222, 0
  v_mov_b32 v223, 0
Lpre_loop:
  buffer_load_dwordx4 a[176:179], v16, s[20:23], s44 offen offset:0 sc1
  buffer_load_dwordx4 a[180:183], v16, s[20:23], s44 offen offset:1024 sc1
  buffer_load_dwordx4 a[184:187], v16, s[20:23], s44 offen offset:2048 sc1
  buffer_load_dwordx4 a[188:191], v16, s[20:23], s44 offen offset:3072 sc1
  buffer_load_dwordx4 a[192:195], v17, s[20:23], s44 offen offset:0 sc1
  buffer_load_dwordx4 a[196:199], v17, s[20:23], s44 offen offset:1024 sc1
  buffer_load_dwordx4 a[200:203], v17, s[20:23], s44 offen offset:2048 sc1
  buffer_load_dwordx4 a[204:207], v17, s[20:23], s44 offen offset:3072 sc1
  s_cmp_eq_i32 s45, 0
  s_cbranch_scc0 Lpre_0
  v_mov_b32 v192, v240
  v_mov_b32 v193, v241
  v_mov_b32 v194, v242
  v_mov_b32 v195, v243
  v_mov_b32 v208, v244
  v_mov_b32 v209, v245
  v_mov_b32 v210, v246
  v_mov_b32 v211, v247
Lpre_0:
  s_cmp_eq_i32 s45, 1
  s_cbranch_scc0 Lpre_1
  v_mov_b32 v196, v240
  v_mov_b32 v192, v53
  v_mov_b32 v197, v241
  v_mov_b32 v193, v53
  v_mov_b32 v198, v242
  v_mov_b32 v194, v53
  v_mov_b32 v199, v243
  v_mov_b32 v195, v53
  v_mov_b32 v212, v244
  v_mov_b32 v208, v53
  v_mov_b32 v213, v245
  v_mov_b32 v209, v53
  v_mov_b32 v214, v246
  v_mov_b32 v210, v53
  v_mov_b32 v215, v247
  v_mov_b32 v211, v53
Lpre_1:
  s_cmp_eq_i32 s45, 2
  s_cbranch_scc0 Lpre_2
  v_mov_b32 v200, v240
  v_mov_b32 v196, v53
  v_mov_b32 v201, v241
  v_mov_b32 v197, v53
  v_mov_b32 v202, v242
  v_mov_b32 v198, v53
  v_mov_b32 v203, v243
  v_mov_b32 v199, v53
  v_mov_b32 v216, v244
  v_mov_b32 v212, v53
  v_mov_b32 v217, v245
  v_mov_b32 v213, v53
  v_mov_b32 v218, v246
  v_mov_b32 v214, v53
  v_mov_b32 v219, v247
  v_mov_b32 v215, v53
Lpre_2:
  s_cmp_eq_i32 s45, 3
  s_cbranch_scc0 Lpre_3
  v_mov_b32 v204, v240
  v_mov_b32 v200, v53
  v_mov_b32 v205, v241
  v_mov_b32 v201, v53
  v_mov_b32 v206, v242
  v_mov_b32 v202, v53
  v_mov_b32 v207, v243
  v_mov_b32 v203, v53
  v_mov_b32 v220, v244
  v_mov_b32 v216, v53
  v_mov_b32 v221, v245
  v_mov_b32 v217, v53
  v_mov_b32 v222, v246
  v_mov_b32 v218, v53
  v_mov_b32 v223, v247
  v_mov_b32 v219, v53
Lpre_3:
  s_waitcnt vmcnt(0)
  s_nop 1
  v_mfma_f32_16x16x32_bf16 v[96:99], a[176:179], v[144:147], v[192:195]
  v_mfma_f32_16x16x32_bf16 v[100:103], a[176:179], v[148:151], v[196:199]
  v_mfma_f32_16x16x32_bf16 v[104:107], a[176:179], v[152:155], v[200:203]
  v_mfma_f32_16x16x32_bf16 v[108:111], a[176:179], v[156:159], v[204:207]
 Mvav 96,180,160
 Mvav 100,180,164
 Mvav 104,180,168
 Mvav 108,180,172
 Mvav 96,184,128
 Mvav 100,184,132
 Mvav 104,184,136
 Mvav 108,184,140
 Mvav 96,188,112
 Mvav 100,188,116
 Mvav 104,188,120
 Mvav 108,188,124
  v_mfma_f32_16x16x32_bf16 v[64:67], a[192:195], v[144:147], v[208:211]
  v_mfma_f32_16x16x32_bf16 v[68:71], a[192:195], v[148:151], v[212:215]
  v_mfma_f32_16x16x32_bf16 v[72:75], a[192:195], v[152:155], v[216:219]
  v_mfma_f32_16x16x32_bf16 v[76:79], a[192:195], v[156:159], v[220:223]
 Mvav 64,196,160
 Mvav 68,196,164
 Mvav 72,196,168
 Mvav 76,196,172
 Mvav 64,200,128
 Mvav 68,200,132
 Mvav 72,200,136
 Mvav 76,200,140
 Mvav 64,204,112
 Mvav 68,204,116
 Mvav 72,204,120
 Mvav 76,204,124
  s_nop 7
  s_nop 7
  v_max3_f32 v48, v96, v97, v48
  v_max3_f32 v48, v98, v99, v48
  v_max3_f32 v49, v100, v101, v49
  v_max3_f32 v49, v102, v103, v49
  v_max3_f32 v50, v104, v105, v50
  v_max3_f32 v50, v106, v107, v50
  v_max3_f32 v51, v108, v109, v51
  v_max3_f32 v51, v110, v111, v51
  v_max3_f32 v48, v64, v65, v48
  v_max3_f32 v48, v66, v67, v48
  v_max3_f32 v49, v68, v69, v49
  v_max3_f32 v49, v70, v71, v49
  v_max3_f32 v50, v72, v73, v50
  v_max3_f32 v50, v74, v75, v50
  v_max3_f32 v51, v76, v77, v51
  v_max3_f32 v51, v78, v79, v51
  s_add_u32 s44, s44, 16384
  s_add_i32 s45, s45, 1
  s_cmp_lt_i32 s45, 4
  s_cbranch_scc1 Lpre_loop
  v_mov_b32 v52, v48
  s_nop 1
  v_permlane16_swap_b32 v52, v48
  s_nop 1
  v_max_f32 v48, v48, v52
  v_mov_b32 v52, v48
  s_nop 1
  v_permlane32_swap_b32 v52, v48
  s_nop 1
  v_max_f32 v48, v48, v52
  v_sub_f32 v48, 0, v48
  v_mov_b32 v224, v48
  v_mov_b32 v225, v48
  v_mov_b32 v226, v48
  v_mov_b32 v227, v48
  v_mov_b32 v52, v49
  s_nop 1
  v_permlane16_swap_b32 v52, v49
  s_nop 1
  v_max_f32 v49, v49, v52
  v_mov_b32 v52, v49
  s_nop 1
  v_permlane32_swap_b32 v52, v49
  s_nop 1
  v_max_f32 v49, v49, v52
  v_sub_f32 v49, 0, v49
  v_mov_b32 v228, v49
  v_mov_b32 v229, v49
  v_mov_b32 v230, v49
  v_mov_b32 v231, v49
  v_mov_b32 v52, v50
  s_nop 1
  v_permlane16_swap_b32 v52, v50
  s_nop 1
  v_max_f32 v50, v50, v52
  v_mov_b32 v52, v50
  s_nop 1
  v_permlane32_swap_b32 v52, v50
  s_nop 1
  v_max_f32 v50, v50, v52
  v_sub_f32 v50, 0, v50
  v_mov_b32 v232, v50
  v_mov_b32 v233, v50
  v_mov_b32 v234, v50
  v_mov_b32 v235, v50
  v_mov_b32 v52, v51
  s_nop 1
  v_permlane16_swap_b32 v52, v51
  s_nop 1
  v_max_f32 v51, v51, v52
  v_mov_b32 v52, v51
  s_nop 1
  v_permlane32_swap_b32 v52, v51
  s_nop 1
  v_max_f32 v51, v51, v52
  v_sub_f32 v51, 0, v51
  v_mov_b32 v236, v51
  v_mov_b32 v237, v51
  v_mov_b32 v238, v51
  v_mov_b32 v239, v51
  v_add_f32 v248, v240, v48
  v_add_f32 v249, v241, v48
  v_add_f32 v250, v242, v48
  v_add_f32 v251, v243, v48
  v_add_f32 v252, v244, v48
  v_add_f32 v253, v245, v48
  v_add_f32 v254, v246, v48
  v_add_f32 v255, v247, v48
  s_lshr_b32 s44, s3, 1
  s_lshl_b32 s44, s44, 10
  v_add_u32 v47, 131072, v46
  v_add_u32 v52, s44, v47
  ds_write_b128 v52, v[48:51]
 WL 0
  s_barrier
  ds_read_b128 v[10:13], v47
 WL 0
  s_branch Lpre_back
Lp4_5:
  v_cmp_lt_u32 vcc, 0x40000000, v43
  s_lshr_b32 s65, s6, 8
  s_lshl_b32 s66, s3, 2
  v_mov_b32 v246, s66
  s_cmp_lg_u64 vcc, 0
  s_cselect_b32 s66, 1, 0
  s_andn2_b32 s66, s66, s65
  v_mov_b32 v245, s66
  ds_write_b32 v246, v245
  v_and_b32 v246, 3, v0
  v_lshlrev_b32 v246, 2, v246
  v_lshlrev_b32 v59, 3, v0
  v_add_u32 v56, 20736, v59
  v_add_u32 v57, 134400, v59
  v_add_u32 v58, 58624, v59
  v_add_u32 v59, 96512, v59
 WL 0
  s_waitcnt vmcnt(33)
  s_barrier
 TR 208,32,0
 TR 210,32,512
 TR 212,32,9472
 TR 214,32,9984
 TR 216,32,32
 TR 218,32,544
 TR 220,32,9504
 TR 222,32,10016
 TR 224,32,64
 TR 226,32,576
 TR 228,32,9536
 TR 230,32,10048
  ds_read_b32 v245, v246
 WL 11
  v_mfma_f32_16x16x32_bf16 v[64:67], v[208:211], a[212:215], 0
  s_add_u32 s46, s45, 49152
  v_lshlrev_b32 v249, 14, v0
  v_add_u32 v249, Lp4_5-Lpc0, v249
 WL 9
 Mvva 64,212,228
  buffer_load_dwordx4 a[0:3], v16, s[20:23], s46 offen offset:0 sc1
  v_mfma_f32_16x16x32_bf16 v[68:71], v[208:211], a[216:219], 0
  v_min_u32 v249, Lp4e_5-Lpc0-16388, v249
 Mvva 68,212,232
  v_mfma_f32_16x16x32_bf16 v[72:75], v[208:211], a[220:223], 0
  buffer_load_dwordx4 a[4:7], v16, s[20:23], s46 offen offset:2048 sc1
 Mvva 72,212,236
  v_mfma_f32_16x16x32_bf16 v[76:79], v[208:211], a[224:227], 0
 TR 208,32,96
 Mvva 76,212,240
 WL 8
  v_mfma_f32_16x16x32_bf16 v[80:83], v[216:219], a[212:215], 0
 TR 210,32,608
 WL 7
 Mvva 80,220,228
  buffer_load_dwordx4 a[8:11], v17, s[20:23], s46 offen offset:0 sc1
  v_mfma_f32_16x16x32_bf16 v[84:87], v[216:219], a[216:219], 0
 TR 212,32,9568
 Mvva 84,220,232
 WL 3
  v_cmp_ne_u32 vcc, 0, v245
  s_nop 4
  s_cbranch_vccnz Lrestart
  v_mfma_f32_16x16x32_bf16 v[88:91], v[216:219], a[220:223], 0
 TR 214,32,10080
 Mvva 88,220,236
  s_cmp_lg_u32 s3, 0
  s_cselect_b32 s64, 256, 0
  s_and_b32 s66, s2, 0xe7
  v_mfma_f32_16x16x32_bf16 v[92:95], v[216:219], a[224:227], 0
 TR 216,32,128
  s_lshl_b32 s66, s66, 6
 Mvva 92,220,240
  buffer_load_dwordx4 a[12:15], v17, s[20:23], s46 offen offset:2048 sc1
  v_mfma_f32_16x16x32_bf16 v[96:99], v[224:227], a[212:215], 0
 TR 218,32,640
  s_lshr_b32 s65, s4, 3
 Mvva 96,228,228
  s_add_u32 s46, s45, 57344
  s_add_u32 s66, s66, s65
  s_lshl_b32 s66, s66, 2
  v_mfma_f32_16x16x32_bf16 v[100:103], v[224:227], a[216:219], 0
 TR 220,32,9600
  s_add_u32 s66, s66, 0x4480010
 Mvva 100,228,232
  buffer_load_dwordx4 a[16:19], v16, s[20:23], s46 offen offset:0 sc1
  v_mfma_f32_16x16x32_bf16 v[104:107], v[224:227], a[220:223], 0
 TR 222,32,10112
  s_lshl_b32 s65, s64, 20
 Mvva 104,228,236
  global_load_dword a248, v249, s[100:101]
  v_mfma_f32_16x16x32_bf16 v[108:111], v[224:227], a[224:227], 0
 TR 224,32,160
  s_add_u32 s66, s66, s65
 Mvva 108,228,240
 WL 7
  v_cmp_gt_u32 vcc, 4, v0
  v_lshlrev_b32 v245, 11, v0
  v_mov_b32 v246, 1
  v_cndmask_b32 v245, -1, v245, vcc
  v_mfma_f32_16x16x32_bf16 v[112:115], v[208:211], a[212:215], 0
 TR 226,32,672
 WL 6
 Mvva 112,212,228
  buffer_load_dwordx4 a[20:23], v16, s[20:23], s46 offen offset:2048 sc1
  v_mfma_f32_16x16x32_bf16 v[116:119], v[208:211], a[216:219], 0
 TR 228,32,9632
 Mvva 116,212,232
  v_mfma_f32_16x16x32_bf16 v[120:123], v[208:211], a[220:223], 0
 TR 230,32,10144
 Mvva 120,212,236
  buffer_load_dwordx4 a[24:27], v17, s[20:23], s46 offen offset:0 sc1
  v_mfma_f32_16x16x32_bf16 v[124:127], v[208:211], a[224:227], 0
 TR 208,32,192
  s_add_u32 s44, s44, 147456
 Mvva 124,212,240
  s_lshr_b32 s30, s3, 1
 WL 7
  v_mfma_f32_16x16x32_bf16 v[128:131], v[216:219], a[212:215], 0
 TR 210,32,704
 WL 6
 Mvva 128,220,228
  s_lshl_b32 s30, s30, 28
  v_mfma_f32_16x16x32_bf16 v[132:135], v[216:219], a[216:219], 0
 TR 212,32,9664
 Mvva 132,220,232
  buffer_load_dwordx4 a[28:31], v17, s[20:23], s46 offen offset:2048 sc1
  v_mfma_f32_16x16x32_bf16 v[136:139], v[216:219], a[220:223], 0
 TR 214,32,10176
  s_add_u32 s44, s44, s30
 Mvva 136,220,236
  s_add_u32 m0, s47, 50176
  v_mfma_f32_16x16x32_bf16 v[140:143], v[216:219], a[224:227], 0
 TR 216,32,224
 WL 7
 Mvva 140,220,240
  buffer_load_dwordx4 v1, s[12:15], s44 offen lds
  v_mfma_f32_16x16x32_bf16 v[144:147], v[224:227], a[212:215], 0
 TR 218,32,736
 WL 6
 Mvva 144,228,228
  v_mfma_f32_16x16x32_bf16 v[148:151], v[224:227], a[216:219], 0
 TR 220,32,9696
 Mvva 148,228,232
  buffer_load_dwordx4 v2, s[12:15], s44 offen offset:1056 lds
  v_mfma_f32_16x16x32_bf16 v[152:155], v[224:227], a[220:223], 0
 TR 222,32,10208
 Mvva 152,228,236
  buffer_load_dwordx4 v3, s[12:15], s44 offen offset:2112 lds
  v_mfma_f32_16x16x32_bf16 v[156:159], v[224:227], a[224:227], 0
 TR 224,56,0
 WL 7
 Mvva 156,228,240
  buffer_load_dwordx4 v4, s[12:15], s44 offen offset:3168 lds
  v_mfma_f32_16x16x32_bf16 v[160:163], v[208:211], a[212:215], 0
 TR 226,56,512
  s_add_u32 m0, s47, 54400
 WL 6
 Mvva 160,212,228
  buffer_load_dwordx4 v5, s[12:15], s44 offen lds
  v_mfma_f32_16x16x32_bf16 v[164:167], v[208:211], a[216:219], 0
 TR 228,56,9472
 Mvva 164,212,232
  buffer_load_dwordx4 v6, s[12:15], s44 offen offset:1056 lds
  v_mfma_f32_16x16x32_bf16 v[168:171], v[208:211], a[220:223], 0
 TR 230,56,9984
 Mvva 168,212,236
  v_mfma_f32_16x16x32_bf16 v[172:175], v[208:211], a[224:227], 0
 TR 208,32,18944
 WL 7
 Mvva 172,212,240
  buffer_load_dwordx4 v7, s[12:15], s44 offen offset:2112 lds
  v_mfma_f32_16x16x32_bf16 v[176:179], v[216:219], a[212:215], 0
 TR 210,32,19456
 WL 6
 Mvva 176,220,228
  buffer_load_dwordx4 v8, s[12:15], s44 offen offset:3168 lds
  v_mfma_f32_16x16x32_bf16 v[180:183], v[216:219], a[216:219], 0
 TR 212,32,28416
  s_add_u32 m0, s47, 58624
 Mvva 180,220,232
  buffer_load_dwordx4 v9, s[20:23], s44 offen sc1 lds
  v_mfma_f32_16x16x32_bf16 v[184:187], v[216:219], a[220:223], 0
 TR 214,32,28928
  s_add_u32 s46, s45, 65536
 Mvva 184,220,236
  buffer_load_dwordx4 a[32:35], v16, s[20:23], s46 offen offset:0 sc1
  v_mfma_f32_16x16x32_bf16 v[188:191], v[216:219], a[224:227], 0
 TR 216,32,18976
 Mvva 188,220,240
 WL 7
  v_mfma_f32_16x16x32_bf16 v[192:195], v[224:227], a[212:215], 0
 TR 218,32,19488
 WL 6
 Mvva 192,228,228
  v_mfma_f32_16x16x32_bf16 v[196:199], v[224:227], a[216:219], 0
 TR 220,32,28448
 Mvva 196,228,232
  buffer_load_dwordx4 a[36:39], v16, s[20:23], s46 offen offset:2048 sc1
  v_mfma_f32_16x16x32_bf16 v[200:203], v[224:227], a[220:223], 0
 TR 222,32,28960
  s_waitcnt vmcnt(45)
 Mvva 200,228,236
  v_mfma_f32_16x16x32_bf16 v[204:207], v[224:227], a[224:227], 0
 TR 224,32,19008
 WL 7
 Mvva 204,228,240
  buffer_load_dwordx4 a[40:43], v17, s[20:23], s46 offen offset:0 sc1
 Mvva 64,208,176
 TR 226,32,19520
 WL 6
 Mvva 64,212,192
 Mvva 68,208,180
 TR 228,32,28480
 Mvva 68,212,196
 Mvva 72,208,184
 TR 230,32,28992
 Mvva 72,212,200
  buffer_load_dwordx4 a[44:47], v17, s[20:23], s46 offen offset:2048 sc1
 Mvva 76,208,188
 TR 208,32,19040
 Mvva 76,212,204
  s_add_u32 s46, s45, 73728
 WL 7
 Mvva 80,216,176
 TR 210,32,19552
 WL 6
 Mvva 80,220,192
  buffer_load_dwordx4 a[48:51], v16, s[20:23], s46 offen offset:0 sc1
 Mvva 84,216,180
 TR 212,32,28512
 Mvva 84,220,196
 Mvva 88,216,184
 TR 214,32,29024
 Mvva 88,220,200
 Mvva 92,216,188
 TR 216,32,19072
 WL 7
 Mvva 92,220,204
  buffer_load_dwordx4 a[52:55], v16, s[20:23], s46 offen offset:2048 sc1
 Mvva 96,224,176
 TR 218,32,19584
 WL 6
 Mvva 96,228,192
 Mvva 100,224,180
 TR 220,32,28544
 Mvva 100,228,196
  buffer_load_dwordx4 a[56:59], v17, s[20:23], s46 offen offset:0 sc1
 Mvva 104,224,184
 TR 222,32,29056
 Mvva 104,228,200
 Mvva 108,224,188
 TR 224,32,19104
 Mvva 108,228,204
  s_mov_b32 s44, s25
 WL 7
 Mvva 112,208,176
 TR 226,32,19616
 WL 6
 Mvva 112,212,192
  buffer_load_dwordx4 a[60:63], v17, s[20:23], s46 offen offset:2048 sc1
 Mvva 116,208,180
 TR 228,32,28576
  v_add_u32 v9, 4096, v9
 Mvva 116,212,196
  s_add_u32 m0, s47, 88064
 Mvva 120,208,184
 TR 230,32,29088
 Mvva 120,212,200
  buffer_load_dwordx4 v1, s[40:43], s44 offen lds
 Mvva 124,208,188
 TR 208,32,19136
 Mvva 124,212,204
 WL 7
 Mvva 128,216,176
 TR 210,32,19648
 WL 6
 Mvva 128,220,192
 Mvva 132,216,180
 TR 212,32,28608
 Mvva 132,220,196
  buffer_load_dwordx4 v2, s[40:43], s44 offen offset:1056 lds
 Mvva 136,216,184
 TR 214,32,29120
 Mvva 136,220,200
 Mvva 140,216,188
 TR 216,32,19168
 WL 7
 Mvva 140,220,204
  buffer_load_dwordx4 v3, s[40:43], s44 offen offset:2112 lds
 Mvva 144,224,176
 TR 218,32,19680
 WL 6
 Mvva 144,228,192
 Mvva 148,224,180
 TR 220,32,28640
 Mvva 148,228,196
 Mvva 152,224,184
 TR 222,32,29152
 Mvva 152,228,200
  buffer_load_dwordx4 v4, s[40:43], s44 offen offset:3168 lds
 Mvva 156,224,188
 TR 224,56,18944
 Mvva 156,228,204
  s_add_u32 m0, s47, 92288
 WL 7
 WL 5
 Mvva 160,208,176
 TR 226,56,19456
  v_and_b32 v247, 3, v0
 Mvva 160,212,192
  buffer_load_dwordx4 v5, s[40:43], s44 offen lds
 Mvva 164,208,180
 TR 228,56,28416
  v_lshlrev_b32 v247, 2, v247
 Mvva 164,212,196
  buffer_load_dword v248, v247, s[20:23], s54 offen offset:16 sc1
 Mvva 168,208,184
 TR 230,56,28928
 Mvva 168,212,200
 Mvva 172,208,188
  buffer_load_dwordx4 v6, s[40:43], s44 offen offset:1056 lds
 Mvva 172,212,204
 WL 6
 Mvva 176,216,176
 WL 4
 Mvva 176,220,192
  s_waitcnt vmcnt(33) lgkmcnt(0)
  s_barrier
 Mvva 180,216,180
 TR 208,33,0
 Mvva 180,220,196
 TR 210,33,512
 Mvva 184,216,184
 TR 212,33,9472
 Mvva 184,220,200
 TR 214,33,9984
 Mvva 188,216,188
 TR 216,33,32
 Mvva 188,220,204
  buffer_load_dwordx4 v7, s[40:43], s44 offen offset:2112 lds
 Mvva 192,224,176
 TR 218,33,544
 Mvva 192,228,192
  buffer_load_dwordx4 v8, s[40:43], s44 offen offset:3168 lds
 Mvva 196,224,180
 TR 220,33,9504
 Mvva 196,228,196
  buffer_store_dword v246, v245, s[20:23], s66 offen sc1
 Mvva 200,224,184
 TR 222,33,10016
 WL 6
 Mvva 200,228,200
  s_add_u32 m0, s47, 96512
  s_lshr_b32 s55, s2, 3
  s_lshl_b32 s55, s55, 2
 Mvva 204,224,188
 TR 224,33,64
  s_bfe_u32 s65, s4, 0x20001
 Mvva 204,228,204
  buffer_load_dwordx4 v9, s[20:23], s44 offen sc1 lds
 Mvva 64,208,144
 TR 226,33,576
  s_add_u32 s44, s44, 1179648
 WL 6
 Mvva 64,212,160
  s_add_u32 m0, s47, 12288
  s_add_u32 s55, s55, s65
  s_lshl_b32 s55, s55, 4
 Mvva 68,208,148
 TR 228,33,9536
  s_and_b32 s65, s4, 1
 Mvva 68,212,164
  buffer_load_dwordx4 v1, s[40:43], s44 offen lds
 Mvva 72,208,152
 TR 230,33,10048
  s_add_u32 s55, s55, s65
 Mvva 72,212,168
  s_mul_i32 s55, s55, 9216
  s_add_u32 s55, s55, 0x4500000
  s_and_b32 s65, s4, 7
 Mvva 76,208,156
 TR 208,33,96
  s_movk_i32 s50, 8192
 Mvva 76,212,172
  buffer_load_dwordx4 v2, s[40:43], s44 offen offset:1056 lds
 WL 7
 Mvva 80,216,144
 TR 210,33,608
  s_movk_i32 s51, 16384
 WL 6
 Mvva 80,220,160
  s_and_b32 s66, s2, 0xf8
  s_lshl_b32 s56, s3, 1
  s_add_u32 s66, s66, s56
 Mvva 84,216,148
 TR 212,33,9568
  s_lshl_b32 s66, s66, 6
 Mvva 84,220,164
  buffer_load_dwordx4 v3, s[40:43], s44 offen offset:2112 lds
 Mvva 88,216,152
 TR 214,33,10080
  s_add_u32 s66, s66, s65
 Mvva 88,220,168
  s_lshl_b32 s66, s66, 2
  s_add_u32 s66, s66, 0x4480020
 Mvva 92,216,156
 TR 216,33,128
 WL 5
 Mvva 92,220,172
 WL 7
  v_cmp_gt_u32 vcc, 2, v0
  v_lshlrev_b32 v245, 8, v0
  v_mov_b32 v246, 1
  v_cndmask_b32 v245, -1, v245, vcc
 Mvva 96,224,144
 TR 218,33,640
  s_sub_u32 s56, 15, s5
 Mvva 96,228,160
  buffer_load_dwordx4 v4, s[40:43], s44 offen offset:3168 lds
 Mvva 100,224,148
 TR 220,33,9600
 Mvva 100,228,164
  s_add_u32 m0, s47, 16512
  s_cmp_lt_u32 s65, 4
  s_cselect_b32 s56, s56, s5
 Mvva 104,224,152
 TR 222,33,10112
  s_lshl_b32 s56, s56, 3
 Mvva 104,228,168
  buffer_load_dwordx4 v5, s[40:43], s44 offen lds
 Mvva 108,224,156
 TR 224,33,160
  s_bfe_u32 s69, s65, 0x10001
 Mvva 108,228,172
  s_add_u32 s56, s56, s69
  s_and_b32 s69, s65, 1
  s_lshl_b32 s69, s69, 2
 WL 7
 Mvva 112,208,144
 TR 226,33,672
  s_add_u32 s56, s56, s69
 WL 6
 Mvva 112,212,160
  s_mul_i32 s56, s56, 18432
  s_lshr_b32 s69, s4, 3
  s_mul_i32 s31, s69, 224
 Mvva 116,208,148
 TR 228,33,9632
  s_lshl_b32 s69, s69, 8
 Mvva 116,212,164
  buffer_load_dwordx4 v6, s[40:43], s44 offen offset:1056 lds
 Mvva 120,208,152
 TR 230,33,10144
  s_add_u32 s56, s56, s69
 Mvva 120,212,168
  s_lshl_b32 s69, s3, 10
  v_add_u32 v28, s69, v16
  s_lshl_b32 s69, s3, 8
 Mvva 124,208,156
 TR 208,33,192
  s_add_u32 s69, s69, 4096
 Mvva 124,212,172
  buffer_load_dwordx4 v7, s[40:43], s44 offen offset:2112 lds
 WL 7
 Mvva 128,216,144
 TR 210,33,704
  v_lshl_add_u32 v29, v0, 2, s69
 WL 6
 Mvva 128,220,160
  v_and_b32 v36, 15, v0
  v_mul_u32_u24 v36, 1152, v36
 Mvva 132,216,148
 TR 212,33,9664
  v_lshrrev_b32 v37, 4, v0
 Mvva 132,220,164
  s_lshl_b32 s69, s3, 5
  v_lshl_add_u32 v36, v37, 3, v36
  v_add_u32 v30, s69, v36
 Mvva 136,216,152
 TR 214,33,10176
  v_lshrrev_b32 v36, 2, v0
 Mvva 136,220,168
  buffer_load_dwordx4 v8, s[40:43], s44 offen offset:3168 lds
 Mvva 140,216,156
 TR 216,33,224
  v_bfe_u32 v37, v0, 1, 1
 Mvva 140,220,172
  s_add_u32 m0, s47, 20736
  v_lshl_add_u32 v36, v37, 5, v36
  v_mul_u32_u24 v36, 1152, v36
 WL 7
 Mvva 144,224,144
 TR 218,33,736
  v_and_b32 v37, 1, v0
 WL 6
 Mvva 144,228,160
  buffer_load_dwordx4 v9, s[20:23], s44 offen sc1 lds
 Mvva 148,224,148
 TR 220,33,9696
  v_lshl_add_u32 v36, v37, 2, v36
 Mvva 148,228,164
  s_lshl_b32 s69, s3, 3
  s_add_u32 s69, s69, 1024
  s_sub_u32 s69, s69, s31
 Mvva 152,224,152
 TR 222,33,10208
  v_add_u32 v31, s69, v36
 Mvva 152,228,168
  s_mov_b32 s57, 0xffff
  s_add_u32 s69, s56, 36864
 Mvva 156,224,156
 TR 224,57,0
 WL 7
 Mvva 156,228,172
  buffer_store_dword v246, v245, s[20:23], s66 offen sc1
 Mvva 160,208,144
 TR 226,57,512
 WL 6
 Mvva 160,212,160
 Mvva 164,208,148
 TR 228,57,9472
 Mvva 164,212,164
 Mvva 168,208,152
 TR 230,57,9984
 Mvva 168,212,168
 Mvva 172,208,156
 TR 208,33,18944
 Mvva 172,212,172
 WL 7
 Mvva 176,216,144
 TR 210,33,19456
 WL 6
 Mvva 176,220,160
 Mvva 180,216,148
 TR 212,33,28416
 Mvva 180,220,164
 Mvva 184,216,152
 TR 214,33,28928
 Mvva 184,220,168
  s_waitcnt vmcnt(15)
  v_cmp_gt_u32 vcc, 1, v248
  s_nop 4
  s_cbranch_vccnz Lpoll_ctx_5
Lback_ctx_5:
 Mvva 188,216,156
 TR 216,33,18976
 Mvva 188,220,172
 WL 7
 WL 5
 Mvva 192,224,144
 TR 218,33,19488
  s_add_u32 s46, s24, 0
 Mvva 192,228,160
 Mvva 196,224,148
 TR 220,33,28448
 Mvva 196,228,164
  buffer_load_dwordx4 a[64:67], v16, s[20:23], s46 offen offset:0 sc1
 Mvva 200,224,152
 TR 222,33,28960
 Mvva 200,228,168
 Mvva 204,224,156
 TR 224,33,19008
 WL 7
 Mvva 204,228,172
  buffer_load_dwordx4 a[68:71], v16, s[20:23], s46 offen offset:2048 sc1
 Mvva 64,208,0
 TR 226,33,19520
 WL 6
 Mvva 64,212,16
 Mvva 68,208,4
 TR 228,33,28480
 Mvva 68,212,20
  buffer_load_dwordx4 a[72:75], v17, s[20:23], s46 offen offset:0 sc1
 Mvva 72,208,8
 TR 230,33,28992
 Mvva 72,212,24
 Mvva 76,208,12
 TR 208,33,19040
 Mvva 76,212,28
 WL 7
 Mvva 80,216,0
 TR 210,33,19552
 WL 6
 Mvva 80,220,16
  buffer_load_dwordx4 a[76:79], v17, s[20:23], s46 offen offset:2048 sc1
 Mvva 84,216,4
 TR 212,33,28512
 Mvva 84,220,20
  s_add_u32 s46, s24, 8192
 Mvva 88,216,8
 TR 214,33,29024
 Mvva 88,220,24
  buffer_load_dwordx4 a[80:83], v16, s[20:23], s46 offen offset:0 sc1
 Mvva 92,216,12
 TR 216,33,19072
 Mvva 92,220,28
 WL 7
 Mvva 96,224,0
 TR 218,33,19584
 WL 6
 Mvva 96,228,16
 Mvva 100,224,4
 TR 220,33,28544
 Mvva 100,228,20
  buffer_load_dwordx4 a[84:87], v16, s[20:23], s46 offen offset:2048 sc1
 Mvva 104,224,8
 TR 222,33,29056
 Mvva 104,228,24
  global_load_dword a248, v249, s[100:101]
 Mvva 108,224,12
 TR 224,33,19104
 WL 7
 Mvva 108,228,28
  buffer_load_dwordx4 a[88:91], v17, s[20:23], s46 offen offset:0 sc1
 Mvva 112,208,0
 TR 226,33,19616
 WL 6
 Mvva 112,212,16
 Mvva 116,208,4
 TR 228,33,28576
 Mvva 116,212,20
 Mvva 120,208,8
 TR 230,33,29088
 Mvva 120,212,24
  buffer_load_dwordx4 a[92:95], v17, s[20:23], s46 offen offset:2048 sc1
 Mvva 124,208,12
 TR 208,33,19136
 Mvva 124,212,28
  s_add_u32 s46, s24, 16384
 WL 7
 Mvva 128,216,0
 TR 210,33,19648
 WL 6
 Mvva 128,220,16
  buffer_load_dwordx4 a[96:99], v16, s[20:23], s46 offen offset:0 sc1
 Mvva 132,216,4
 TR 212,33,28608
 Mvva 132,220,20
 Mvva 136,216,8
 TR 214,33,29120
 Mvva 136,220,24
 Mvva 140,216,12
 TR 216,33,19168
 WL 7
 Mvva 140,220,28
  buffer_load_dwordx4 a[100:103], v16, s[20:23], s46 offen offset:2048 sc1
 Mvva 144,224,0
 TR 218,33,19680
 WL 6
 Mvva 144,228,16
 Mvva 148,224,4
 TR 220,33,28640
 Mvva 148,228,20
  buffer_load_dwordx4 a[104:107], v17, s[20:23], s46 offen offset:0 sc1
 Mvva 152,224,8
 TR 222,33,29152
 Mvva 152,228,24
 Mvva 156,224,12
 TR 224,57,18944
 Mvva 156,228,28
 WL 7
 Mvva 160,208,0
 TR 226,57,19456
 WL 6
 Mvva 160,212,16
  buffer_load_dwordx4 a[108:111], v17, s[20:23], s46 offen offset:2048 sc1
 Mvva 164,208,4
 TR 228,57,28416
 Mvva 164,212,20
  s_add_u32 s46, s24, 24576
 Mvva 168,208,8
 TR 230,57,28928
 Mvva 168,212,24
  buffer_load_dwordx4 a[112:115], v16, s[20:23], s46 offen offset:0 sc1
 Mvva 172,208,12
 Mvva 172,212,28
 WL 6
 Mvva 176,216,0
 WL 4
 Mvva 176,220,16
 WL 0
  s_barrier
 Mvva 180,216,4
 TR 208,34,0
 Mvva 180,220,20
 TR 210,34,512
 Mvva 184,216,8
 TR 212,34,9472
 Mvva 184,220,24
 TR 214,34,9984
 Mvva 188,216,12
 TR 216,34,32
 Mvva 188,220,28
  buffer_load_dwordx4 a[116:119], v16, s[20:23], s46 offen offset:2048 sc1
 Mvva 192,224,0
 TR 218,34,544
 Mvva 192,228,16
  buffer_load_dwordx4 a[120:123], v17, s[20:23], s46 offen offset:0 sc1
 Mvva 196,224,4
 TR 220,34,9504
 Mvva 196,228,20
 Mvva 200,224,8
 TR 222,34,10016
 Mvva 200,228,24
  buffer_load_dwordx4 a[124:127], v17, s[20:23], s46 offen offset:2048 sc1
 Mvva 204,224,12
 TR 224,34,64
 Mvva 204,228,28
  s_add_u32 s46, s24, 32768
 WL 7
 Mvva 64,208,32
 TR 226,34,576
 WL 6
 Mvva 64,212,48
  buffer_load_dwordx4 a[128:131], v16, s[20:23], s46 offen offset:0 sc1
 Mvva 68,208,36
 TR 228,34,9536
 Mvva 68,212,52
 Mvva 72,208,40
 TR 230,34,10048
 Mvva 72,212,56
 Mvva 76,208,44
 TR 208,34,96
 WL 7
 Mvva 76,212,60
  buffer_load_dwordx4 a[132:135], v16, s[20:23], s46 offen offset:2048 sc1
 Mvva 80,216,32
 TR 210,34,608
 WL 6
 Mvva 80,220,48
 Mvva 84,216,36
 TR 212,34,9568
 Mvva 84,220,52
  buffer_load_dwordx4 a[136:139], v17, s[20:23], s46 offen offset:0 sc1
 Mvva 88,216,40
 TR 214,34,10080
 Mvva 88,220,56
 Mvva 92,216,44
 TR 216,34,128
 Mvva 92,220,60
 WL 7
 Mvva 96,224,32
 TR 218,34,640
 WL 6
 Mvva 96,228,48
  buffer_load_dwordx4 a[140:143], v17, s[20:23], s46 offen offset:2048 sc1
 Mvva 100,224,36
 TR 220,34,9600
 Mvva 100,228,52
  s_add_u32 s46, s24, 40960
 Mvva 104,224,40
 TR 222,34,10112
 Mvva 104,228,56
  buffer_load_dwordx4 v[40:43], v16, s[20:23], s46 offen offset:0 sc1
 Mvva 108,224,44
 TR 224,34,160
 Mvva 108,228,60
 WL 7
 Mvva 112,208,32
 TR 226,34,672
 WL 6
 Mvva 112,212,48
  buffer_load_dwordx4 v[44:47], v16, s[20:23], s46 offen offset:2048 sc1
 Mvva 116,208,36
 TR 228,34,9632
 Mvva 116,212,52
 Mvva 120,208,40
 TR 230,34,10144
 Mvva 120,212,56
 Mvva 124,208,44
 TR 208,34,192
 WL 7
 Mvva 124,212,60
  buffer_load_dwordx4 v[48:51], v17, s[20:23], s46 offen offset:0 sc1
 Mvva 128,216,32
 TR 210,34,704
 WL 6
 Mvva 128,220,48
 Mvva 132,216,36
 TR 212,34,9664
 Mvva 132,220,52
  buffer_load_dwordx4 v[52:55], v17, s[20:23], s46 offen offset:2048 sc1
 Mvva 136,216,40
 TR 214,34,10176
 Mvva 136,220,56
 Mvva 140,216,44
 TR 216,34,224
  s_add_u32 s46, s24, 49152
 Mvva 140,220,60
 WL 7
 Mvva 144,224,32
 TR 218,34,736
 WL 6
 Mvva 144,228,48
  buffer_load_dwordx4 a[212:215], v16, s[20:23], s46 offen offset:0 sc1
 Mvva 148,224,36
 TR 220,34,9696
 Mvva 148,228,52
 Mvva 152,224,40
 TR 222,34,10208
 Mvva 152,228,56
  buffer_load_dwordx4 a[216:219], v16, s[20:23], s46 offen offset:2048 sc1
 Mvva 156,224,44
 TR 224,58,0
 Mvva 156,228,60
 WL 7
 Mvva 160,208,32
 TR 226,58,512
 WL 6
 Mvva 160,212,48
 Mvva 164,208,36
 TR 228,58,9472
 Mvva 164,212,52
  buffer_load_dwordx4 a[220:223], v17, s[20:23], s46 offen offset:0 sc1
 Mvva 168,208,40
 TR 230,58,9984
 Mvva 168,212,56
 Mvva 172,208,44
 WL 6
 Mvva 172,212,60
  buffer_load_dwordx4 a[224:227], v17, s[20:23], s46 offen offset:2048 sc1
 Mvva 176,216,32
 WL 4
 Mvva 176,220,48
 WL 0
  s_waitcnt vmcnt(39)
  s_barrier
 Mvva 180,216,36
 TR 208,35,0
  s_add_u32 s46, s24, 57344
 Mvva 180,220,52
 TR 210,35,512
 Mvva 184,216,40
 TR 212,35,9472
 Mvva 184,220,56
 TR 214,35,9984
 Mvva 188,216,44
 TR 216,35,32
 Mvva 188,220,60
  buffer_load_dwordx4 a[228:231], v16, s[20:23], s46 offen offset:0 sc1
 Mvva 192,224,32
 TR 218,35,544
 Mvva 192,228,48
  buffer_load_dwordx4 a[232:235], v16, s[20:23], s46 offen offset:2048 sc1
 Mvva 196,224,36
 TR 220,35,9504
 Mvva 196,228,52
 Mvva 200,224,40
 TR 222,35,10016
  s_waitcnt vmcnt(22)
 Mvva 200,228,56
 Mvva 204,224,44
 TR 224,35,64
 WL 7
 Mvva 204,228,60
  buffer_load_dwordx4 a[236:239], v17, s[20:23], s46 offen offset:0 sc1
 Mvva 64,208,64
 TR 226,35,576
 WL 6
 Mvva 64,212,80
 Mvva 68,208,68
 TR 228,35,9536
 Mvva 68,212,84
  buffer_load_dwordx4 a[240:243], v17, s[20:23], s46 offen offset:2048 sc1
 Mvva 72,208,72
 TR 230,35,10048
  s_add_u32 s44, s44, 1179648
 Mvva 72,212,88
 Mvva 76,208,76
 TR 208,35,96
  s_add_u32 m0, s47, 125952
 Mvva 76,212,92
 WL 7
 Mvva 80,216,64
 TR 210,35,608
 WL 6
 Mvva 80,220,80
  buffer_load_dwordx4 v1, s[40:43], s44 offen lds
 Mvva 84,216,68
 TR 212,35,9568
 Mvva 84,220,84
 Mvva 88,216,72
 TR 214,35,10080
 Mvva 88,220,88
  buffer_load_dwordx4 v2, s[40:43], s44 offen offset:1056 lds
 Mvva 92,216,76
 TR 216,35,128
 Mvva 92,220,92
 WL 7
 Mvva 96,224,64
 TR 218,35,640
 WL 6
 Mvva 96,228,80
 Mvva 100,224,68
 TR 220,35,9600
 Mvva 100,228,84
  buffer_load_dwordx4 v3, s[40:43], s44 offen offset:2112 lds
 Mvva 104,224,72
 TR 222,35,10112
 Mvva 104,228,88
 Mvva 108,224,76
 TR 224,35,160
 WL 7
 Mvva 108,228,92
  buffer_load_dwordx4 v4, s[40:43], s44 offen offset:3168 lds
 Mvva 112,208,64
 TR 226,35,672
 WL 6
 Mvva 112,212,80
 Mvva 116,208,68
 TR 228,35,9632
  s_add_u32 m0, s47, 130176
 Mvva 116,212,84
 Mvva 120,208,72
 TR 230,35,10144
 Mvva 120,212,88
  buffer_load_dwordx4 v5, s[40:43], s44 offen lds
 Mvva 124,208,76
 TR 208,35,192
 Mvva 124,212,92
 WL 7
 Mvva 128,216,64
 TR 210,35,704
 WL 6
 Mvva 128,220,80
  buffer_load_dwordx4 v6, s[40:43], s44 offen offset:1056 lds
 Mvva 132,216,68
 TR 212,35,9664
 Mvva 132,220,84
 Mvva 136,216,72
 TR 214,35,10176
 Mvva 136,220,88
 Mvva 140,216,76
 TR 216,35,224
 WL 7
 Mvva 140,220,92
  buffer_load_dwordx4 v7, s[40:43], s44 offen offset:2112 lds
 Mvva 144,224,64
 TR 218,35,736
 WL 6
 Mvva 144,228,80
 Mvva 148,224,68
 TR 220,35,9696
 Mvva 148,228,84
  buffer_load_dwordx4 v8, s[40:43], s44 offen offset:3168 lds
 Mvva 152,224,72
 TR 222,35,10208
 Mvva 152,228,88
  s_add_u32 m0, s47, 134400
 Mvva 156,224,76
 TR 224,59,0
 WL 7
 Mvva 156,228,92
  buffer_load_dwordx4 v9, s[20:23], s44 offen sc1 lds
 Mvva 160,208,64
 TR 226,59,512
 WL 6
 Mvva 160,212,80
 Mvva 164,208,68
 TR 228,59,9472
  s_add_u32 s46, s24, 65536
 Mvva 164,212,84
 Mvva 168,208,72
 TR 230,59,9984
 Mvva 168,212,88
  buffer_load_dwordx4 a[176:179], v16, s[20:23], s46 offen offset:0 sc1
 Mvva 172,208,76
 TR 208,35,18944
 Mvva 172,212,92
 WL 7
 Mvva 176,216,64
 TR 210,35,19456
 WL 6
 Mvva 176,220,80
  buffer_load_dwordx4 a[180:183], v16, s[20:23], s46 offen offset:2048 sc1
 Mvva 180,216,68
 TR 212,35,28416
 Mvva 180,220,84
 Mvva 184,216,72
 TR 214,35,28928
 Mvva 184,220,88
 Mvva 188,216,76
 TR 216,35,18976
 WL 7
 Mvva 188,220,92
  buffer_load_dwordx4 a[184:187], v17, s[20:23], s46 offen offset:0 sc1
 Mvva 192,224,64
 TR 218,35,19488
 WL 6
 Mvva 192,228,80
 Mvva 196,224,68
 TR 220,35,28448
 Mvva 196,228,84
  buffer_load_dwordx4 a[188:191], v17, s[20:23], s46 offen offset:2048 sc1
 Mvva 200,224,72
 TR 222,35,28960
  s_waitcnt vmcnt(29)
 Mvva 200,228,88
 Mvva 204,224,76
 TR 224,35,19008
  s_add_u32 s46, s24, 73728
 Mvva 204,228,92
 WL 7
 Mvva 64,208,96
 TR 226,35,19520
 WL 6
 Mvva 64,212,112
  buffer_load_dwordx4 a[192:195], v16, s[20:23], s46 offen offset:0 sc1
 Mvva 68,208,100
 TR 228,35,28480
 Mvva 68,212,116
 Mvva 72,208,104
 TR 230,35,28992
 Mvva 72,212,120
  buffer_load_dwordx4 a[196:199], v16, s[20:23], s46 offen offset:2048 sc1
 Mvva 76,208,108
 TR 208,35,19040
 Mvva 76,212,124
 WL 7
 Mvva 80,216,96
 TR 210,35,19552
 WL 6
 Mvva 80,220,112
 Mvva 84,216,100
 TR 212,35,28512
 Mvva 84,220,116
  buffer_load_dwordx4 a[200:203], v17, s[20:23], s46 offen offset:0 sc1
 Mvva 88,216,104
 TR 214,35,29024
 Mvva 88,220,120
 WL 4
 Mvva 92,216,108
 TR 216,35,19072
 WL 7
 Mvva 92,220,124
  buffer_load_dwordx4 a[204:207], v17, s[20:23], s46 offen offset:2048 sc1
 Mvva 96,224,96
 TR 218,35,19584
  s_add_u32 s44, s44, 1179648
 Mvva 96,228,112
 Mvva 100,224,100
 TR 220,35,28544
  s_add_u32 m0, s47, 50176
 Mvva 100,228,116
 Mvva 104,224,104
 TR 222,35,29056
 Mvva 104,228,120
  buffer_load_dwordx4 v1, s[40:43], s44 offen lds
 Mvva 108,224,108
 TR 224,35,19104
 Mvva 108,228,124
 WL 7
 Mvva 112,208,96
 TR 226,35,19616
 WL 6
 Mvva 112,212,112
  buffer_load_dwordx4 v2, s[40:43], s44 offen offset:1056 lds
 Mvva 116,208,100
 TR 228,35,28576
 Mvva 116,212,116
 Mvva 120,208,104
 TR 230,35,29088
 Mvva 120,212,120
 Mvva 124,208,108
 TR 208,35,19136
 WL 7
 Mvva 124,212,124
  buffer_load_dwordx4 v3, s[40:43], s44 offen offset:2112 lds
 Mvva 128,216,96
 TR 210,35,19648
 WL 6
 Mvva 128,220,112
 Mvva 132,216,100
 TR 212,35,28608
 Mvva 132,220,116
  buffer_load_dwordx4 v4, s[40:43], s44 offen offset:3168 lds
 Mvva 136,216,104
 TR 214,35,29120
 Mvva 136,220,120
  global_load_dword a248, v249, s[100:101]
 Mvva 140,216,108
 TR 216,35,19168
  s_add_u32 m0, s47, 54400
 Mvva 140,220,124
 WL 7
 Mvva 144,224,96
 TR 218,35,19680
 WL 6
 Mvva 144,228,112
  buffer_load_dwordx4 v5, s[40:43], s44 offen lds
 Mvva 148,224,100
 TR 220,35,28640
 Mvva 148,228,116
 Mvva 152,224,104
 TR 222,35,29152
 Mvva 152,228,120
  buffer_load_dwordx4 v6, s[40:43], s44 offen offset:1056 lds
 Mvva 156,224,108
 TR 224,59,18944
 Mvva 156,228,124
 WL 7
 Mvva 160,208,96
 TR 226,59,19456
 WL 6
 Mvva 160,212,112
 Mvva 164,208,100
 TR 228,59,28416
 Mvva 164,212,116
  buffer_load_dwordx4 v7, s[40:43], s44 offen offset:2112 lds
 Mvva 168,208,104
 TR 230,59,28928
 Mvva 168,212,120
 Mvva 172,208,108
 WL 6
 Mvva 172,212,124
  buffer_load_dwordx4 v8, s[40:43], s44 offen offset:3168 lds
 Mvva 176,216,96
 WL 4
 Mvva 176,220,112
 WL 0
  s_barrier
 Mvva 180,216,100
 TR 208,32,0
  s_add_u32 m0, s47, 58624
 Mvva 180,220,116
 TR 210,32,512
 Mvva 184,216,104
 TR 212,32,9472
 Mvva 184,220,120
 TR 214,32,9984
 Mvva 188,216,108
 TR 216,32,32
 Mvva 188,220,124
  buffer_load_dwordx4 v9, s[20:23], s44 offen sc1 lds
 Mvva 192,224,96
 TR 218,32,544
  s_add_u32 s46, s24, 81920
 Mvva 192,228,112
  buffer_load_dwordx4 a[144:147], v16, s[20:23], s46 offen offset:0 sc1
 Mvva 196,224,100
 TR 220,32,9504
 Mvva 196,228,116
 Mvva 200,224,104
 TR 222,32,10016
  s_waitcnt vmcnt(36)
 Mvva 200,228,120
 Mvva 204,224,108
 TR 224,32,64
 WL 7
 Mvva 204,228,124
  buffer_load_dwordx4 a[148:151], v16, s[20:23], s46 offen offset:2048 sc1
 Mvva 64,208,128
 TR 226,32,576
 WL 6
 Mvvv 64,212,40
 Mvva 68,208,132
 TR 228,32,9536
 Mvvv 68,212,44
  buffer_load_dwordx4 a[152:155], v17, s[20:23], s46 offen offset:0 sc1
 Mvva 72,208,136
 TR 230,32,10048
 Mvvv 72,212,48
 Mvva 76,208,140
 TR 208,32,96
 WL 7
 Mvvv 76,212,52
  buffer_load_dwordx4 a[156:159], v17, s[20:23], s46 offen offset:2048 sc1
 Mvva 80,216,128
 TR 210,32,608
 WL 6
 Mvvv 80,220,40
 Mvva 84,216,132
 TR 212,32,9568
  s_add_u32 s46, s24, 90112
 Mvvv 84,220,44
 Mvva 88,216,136
 TR 214,32,10080
 Mvvv 88,220,48
  buffer_load_dwordx4 a[160:163], v16, s[20:23], s46 offen offset:0 sc1
 Mvva 92,216,140
 TR 216,32,128
 Mvvv 92,220,52
 WL 7
 Mvva 96,224,128
 TR 218,32,640
 WL 6
 Mvvv 96,228,40
  buffer_load_dwordx4 a[164:167], v16, s[20:23], s46 offen offset:2048 sc1
 Mvva 100,224,132
 TR 220,32,9600
 Mvvv 100,228,44
 Mvva 104,224,136
 TR 222,32,10112
 Mvvv 104,228,48
 Mvva 108,224,140
 TR 224,32,160
 WL 7
 Mvvv 108,228,52
  buffer_load_dwordx4 a[168:171], v17, s[20:23], s46 offen offset:0 sc1
 Mvva 112,208,128
 TR 226,32,672
 WL 6
 Mvvv 112,212,40
 Mvva 116,208,132
 TR 228,32,9632
 Mvvv 116,212,44
  buffer_load_dwordx4 a[172:175], v17, s[20:23], s46 offen offset:2048 sc1
 Mvva 120,208,136
 TR 230,32,10144
 Mvvv 120,212,48
 Mvva 124,208,140
 TR 208,32,192
  s_add_u32 s46, s24, 98304
 Mvvv 124,212,52
 WL 7
 Mvva 128,216,128
 TR 210,32,704
 WL 6
 Mvvv 128,220,40
  buffer_load_dwordx4 a[0:3], v16, s[20:23], s46 offen offset:0 sc1
 Mvva 132,216,132
 TR 212,32,9664
 Mvvv 132,220,44
 Mvva 136,216,136
 TR 214,32,10176
 Mvvv 136,220,48
  buffer_load_dwordx4 a[4:7], v16, s[20:23], s46 offen offset:2048 sc1
 Mvva 140,216,140
 TR 216,32,224
 Mvvv 140,220,52
 WL 7
 Mvva 144,224,128
 TR 218,32,736
 WL 6
 Mvvv 144,228,40
 Mvva 148,224,132
 TR 220,32,9696
 Mvvv 148,228,44
  buffer_load_dwordx4 a[8:11], v17, s[20:23], s46 offen offset:0 sc1
 Mvva 152,224,136
 TR 222,32,10208
 Mvvv 152,228,48
 Mvva 156,224,140
 TR 224,56,0
 WL 7
 Mvvv 156,228,52
  buffer_load_dwordx4 a[12:15], v17, s[20:23], s46 offen offset:2048 sc1
 Mvva 160,208,128
 TR 226,56,512
 WL 6
 Mvvv 160,212,40
 Mvva 164,208,132
 TR 228,56,9472
  s_add_u32 s46, s24, 106496
 Mvvv 164,212,44
 Mvva 168,208,136
 TR 230,56,9984
 Mvvv 168,212,48
  buffer_load_dwordx4 a[16:19], v16, s[20:23], s46 offen offset:0 sc1
 Mvva 172,208,140
 TR 208,32,18944
 Mvvv 172,212,52
 WL 7
 Mvva 176,216,128
 TR 210,32,19456
 WL 6
 Mvvv 176,220,40
  buffer_load_dwordx4 a[20:23], v16, s[20:23], s46 offen offset:2048 sc1
 Mvva 180,216,132
 TR 212,32,28416
 Mvvv 180,220,44
 Mvva 184,216,136
 TR 214,32,28928
 Mvvv 184,220,48
 Mvva 188,216,140
 TR 216,32,18976
 WL 7
 Mvvv 188,220,52
  buffer_load_dwordx4 a[24:27], v17, s[20:23], s46 offen offset:0 sc1
 Mvva 192,224,128
 TR 218,32,19488
 WL 6
 Mvvv 192,228,40
 Mvva 196,224,132
 TR 220,32,28448
 Mvvv 196,228,44
  buffer_load_dwordx4 a[28:31], v17, s[20:23], s46 offen offset:2048 sc1
 Mvva 200,224,136
 TR 222,32,28960
  s_waitcnt vmcnt(43)
 Mvvv 200,228,48
 Mvva 204,224,140
 TR 224,32,19008
  s_add_u32 s46, s24, 114688
 Mvvv 204,228,52
 WL 7
 Mvva 64,208,212
 TR 226,32,19520
 WL 6
 Mvva 64,212,228
  buffer_load_dwordx4 a[32:35], v16, s[20:23], s46 offen offset:0 sc1
 Mvva 68,208,216
 TR 228,32,28480
 Mvva 68,212,232
 Mvva 72,208,220
 TR 230,32,28992
 Mvva 72,212,236
  buffer_load_dwordx4 a[36:39], v16, s[20:23], s46 offen offset:2048 sc1
 Mvva 76,208,224
 TR 208,32,19040
 Mvva 76,212,240
 WL 7
 Mvva 80,216,212
 TR 210,32,19552
 WL 6
 Mvva 80,220,228
 Mvva 84,216,216
 TR 212,32,28512
 Mvva 84,220,232
  buffer_load_dwordx4 a[40:43], v17, s[20:23], s46 offen offset:0 sc1
 Mvva 88,216,220
 TR 214,32,29024
 Mvva 88,220,236
 Mvva 92,216,224
 TR 216,32,19072
 WL 7
 Mvva 92,220,240
  buffer_load_dwordx4 a[44:47], v17, s[20:23], s46 offen offset:2048 sc1
 Mvva 96,224,212
 TR 218,32,19584
 WL 6
 Mvva 96,228,228
 Mvva 100,224,216
 TR 220,32,28544
  s_add_u32 s46, s24, 122880
 Mvva 100,228,232
 Mvva 104,224,220
 TR 222,32,29056
 Mvva 104,228,236
  buffer_load_dwordx4 a[48:51], v16, s[20:23], s46 offen offset:0 sc1
 Mvva 108,224,224
 TR 224,32,19104
 Mvva 108,228,240
 WL 7
 Mvva 112,208,212
 TR 226,32,19616
 WL 6
 Mvva 112,212,228
  buffer_load_dwordx4 a[52:55], v16, s[20:23], s46 offen offset:2048 sc1
 Mvva 116,208,216
 TR 228,32,28576
 Mvva 116,212,232
 Mvva 120,208,220
 TR 230,32,29088
 Mvva 120,212,236
 Mvva 124,208,224
 TR 208,32,19136
 WL 7
 Mvva 124,212,240
  buffer_load_dwordx4 a[56:59], v17, s[20:23], s46 offen offset:0 sc1
 Mvva 128,216,212
 TR 210,32,19648
 WL 6
 Mvva 128,220,228
 Mvva 132,216,216
 TR 212,32,28608
 Mvva 132,220,232
  buffer_load_dwordx4 a[60:63], v17, s[20:23], s46 offen offset:2048 sc1
 Mvva 136,216,220
 TR 214,32,29120
 Mvva 136,220,236
 Mvva 140,216,224
 TR 216,32,19168
 Mvva 140,220,240
 WL 7
 Mvva 144,224,212
 TR 218,32,19680
 WL 6
 Mvva 144,228,228
 Mvva 148,224,216
 TR 220,32,28640
 Mvva 148,228,232
 Mvva 152,224,220
 TR 222,32,29152
 Mvva 152,228,236
 Mvva 156,224,224
 TR 224,56,18944
 Mvva 156,228,240
 WL 7
 Mvva 160,208,212
 TR 226,56,19456
 WL 6
 Mvva 160,212,228
 Mvva 164,208,216
 TR 228,56,28416
 Mvva 164,212,232
 Mvva 168,208,220
 TR 230,56,28928
 Mvva 168,212,236
 Mvva 172,208,224
 Mvva 172,212,240
 WL 6
 Mvva 176,216,212
 WL 4
 Mvva 176,220,228
 WL 0
  s_waitcnt vmcnt(42)
  s_barrier
 Mvva 180,216,216
 TR 208,33,0
 Mvva 180,220,232
 TR 210,33,512
 Mvva 184,216,220
 TR 212,33,9472
  v_mov_b32 v246, 2
 Mvva 184,220,236
 TR 214,33,9984
 Mvva 188,216,224
 TR 216,33,18944
 Mvva 188,220,240
 Mvva 192,224,212
 TR 218,33,19456
 Mvva 192,228,228
 Mvva 196,224,216
 TR 220,33,28416
 Mvva 196,228,232
 Mvva 200,224,220
 TR 222,33,28928
  s_waitcnt vmcnt(34)
 Mvva 200,228,236
 Mvva 204,224,224
 Mvva 204,228,240
 WL 6
 Mvva 64,208,176
 WL 4
 Mvva 64,212,192
 WL 0
  s_waitcnt vmcnt(24)
  s_barrier
 Mvva 68,208,180
 TR 224,34,0
 Mvva 68,212,196
 TR 226,34,512
 Mvva 72,208,184
 TR 228,34,9472
  s_waitcnt vmcnt(16)
 Mvva 72,212,200
 TR 230,34,9984
 Mvva 76,208,188
 TR 208,34,18944
 Mvva 76,212,204
  global_load_dword a248, v249, s[100:101]
 Mvva 64,216,144
 TR 210,34,19456
 Mvva 64,220,160
 Mvva 68,216,148
 TR 212,34,28416
 Mvva 68,220,164
 Mvva 72,216,152
 TR 214,34,28928
  s_waitcnt vmcnt(9)
 Mvva 72,220,168
 Mvva 76,216,156
 TR 216,33,32
 Mvva 76,220,172
 WL 7
 Mvva 64,224,0
 TR 218,33,544
 WL 6
 Mvva 64,228,16
 Mvva 68,224,4
 TR 220,33,9504
 Mvva 68,228,20
 Mvva 72,224,8
 TR 222,33,10016
  s_waitcnt vmcnt(1)
 Mvva 72,228,24
 Mvva 76,224,12
 TR 224,33,18976
 Mvva 76,228,28
 WL 7
 Mvva 64,208,32
 TR 226,33,19488
 WL 6
 Mvva 64,212,48
 Mvva 68,208,36
 TR 228,33,28448
 Mvva 68,212,52
 Mvva 72,208,40
 TR 230,33,28960
 Mvva 72,212,56
 Mvva 76,208,44
 TR 208,34,32
 Mvva 76,212,60
 WL 7
 WL 5
 Mvva 80,216,176
 TR 210,34,544
  v_cvt_pk_bf16_f32 v64, v64, v65
 Mvva 80,220,192
  v_cvt_pk_bf16_f32 v65, v66, v67
  v_cvt_pk_bf16_f32 v66, v68, v69
 Mvva 84,216,180
 TR 212,34,9504
  v_cvt_pk_bf16_f32 v67, v70, v71
 Mvva 84,220,196
  v_min_u32 v64, -2, v64
  v_min_u32 v65, -2, v65
 Mvva 88,216,184
 TR 214,34,10016
  v_min_u32 v66, -2, v66
 Mvva 88,220,200
  v_min_u32 v67, -2, v67
 WL 4
 Mvva 92,216,188
 TR 216,34,18976
 WL 7
 Mvva 92,220,204
  buffer_store_dwordx4 v[64:67], v16, s[8:11], 0 offen offset:0 sc1
 Mvva 80,224,144
 TR 218,34,19488
  v_and_b32 v247, 7, v0
 Mvva 80,228,160
  v_lshlrev_b32 v247, 2, v247
  v_cvt_pk_bf16_f32 v72, v72, v73
 Mvva 84,224,148
 TR 220,34,28448
  v_cvt_pk_bf16_f32 v73, v74, v75
 Mvva 84,228,164
  buffer_load_dword v248, v247, s[20:23], s54 offen offset:32 sc1
 Mvva 88,224,152
 TR 222,34,28960
  v_cvt_pk_bf16_f32 v74, v76, v77
 Mvva 88,228,168
  v_cvt_pk_bf16_f32 v75, v78, v79
  v_min_u32 v72, -2, v72
 Mvva 92,224,156
 TR 224,33,64
  v_min_u32 v73, -2, v73
 Mvva 92,228,172
 WL 7
  v_min_u32 v74, -2, v74
  v_min_u32 v75, -2, v75
 Mvva 80,208,0
 TR 226,33,576
 WL 6
 Mvva 80,212,16
  buffer_store_dwordx4 v[72:75], v16, s[8:11], s50 offen offset:1024 sc1
 Mvva 84,208,4
 TR 228,33,9536
 Mvva 84,212,20
 Mvva 88,208,8
 TR 230,33,10048
 Mvva 88,212,24
 Mvva 92,208,12
 TR 208,33,19008
 Mvva 92,212,28
 WL 7
 Mvva 80,216,32
 TR 210,33,19520
 WL 6
 Mvva 80,220,48
 Mvva 84,216,36
 TR 212,33,28480
 Mvva 84,220,52
 Mvva 88,216,40
 TR 214,33,28992
 Mvva 88,220,56
 Mvva 92,216,44
 TR 216,34,64
 Mvva 92,220,60
 WL 7
 WL 5
 Mvva 96,224,176
 TR 218,34,576
  v_cvt_pk_bf16_f32 v80, v80, v81
 Mvva 96,228,192
  v_cvt_pk_bf16_f32 v81, v82, v83
  v_cvt_pk_bf16_f32 v82, v84, v85
 Mvva 100,224,180
 TR 220,34,9536
  v_cvt_pk_bf16_f32 v83, v86, v87
 Mvva 100,228,196
  v_min_u32 v80, -2, v80
  v_min_u32 v81, -2, v81
 Mvva 104,224,184
 TR 222,34,10048
  v_min_u32 v82, -2, v82
 Mvva 104,228,200
  v_min_u32 v83, -2, v83
 WL 4
 Mvva 108,224,188
 TR 224,34,19008
 WL 7
 Mvva 108,228,204
  buffer_store_dwordx4 v[80:83], v16, s[8:11], 0 offen offset:1024 sc1
 Mvva 96,208,144
 TR 226,34,19520
  v_cvt_pk_bf16_f32 v88, v88, v89
 Mvva 96,212,160
  v_cvt_pk_bf16_f32 v89, v90, v91
  v_cvt_pk_bf16_f32 v90, v92, v93
 Mvva 100,208,148
 TR 228,34,28480
  v_cvt_pk_bf16_f32 v91, v94, v95
 Mvva 100,212,164
  v_min_u32 v88, -2, v88
  v_min_u32 v89, -2, v89
 Mvva 104,208,152
 TR 230,34,28992
  v_min_u32 v90, -2, v90
 Mvva 104,212,168
  v_min_u32 v91, -2, v91
 Mvva 108,208,156
 TR 208,33,96
 WL 7
 Mvva 108,212,172
  buffer_store_dwordx4 v[88:91], v16, s[8:11], s50 offen offset:2048 sc1
 Mvva 96,216,0
 TR 210,33,608
 WL 6
 Mvva 96,220,16
 Mvva 100,216,4
 TR 212,33,9568
 Mvva 100,220,20
 Mvva 104,216,8
 TR 214,33,10080
 Mvva 104,220,24
 Mvva 108,216,12
 TR 216,33,19040
 Mvva 108,220,28
 WL 7
 Mvva 96,224,32
 TR 218,33,19552
 WL 6
 Mvva 96,228,48
 Mvva 100,224,36
 TR 220,33,28512
 Mvva 100,228,52
 Mvva 104,224,40
 TR 222,33,29024
 Mvva 104,228,56
 Mvva 108,224,44
 TR 224,34,96
 Mvva 108,228,60
 WL 7
 WL 5
 Mvva 112,208,176
 TR 226,34,608
  v_cvt_pk_bf16_f32 v96, v96, v97
 Mvva 112,212,192
  v_cvt_pk_bf16_f32 v97, v98, v99
  v_cvt_pk_bf16_f32 v98, v100, v101
 Mvva 116,208,180
 TR 228,34,9568
  v_cvt_pk_bf16_f32 v99, v102, v103
 Mvva 116,212,196
  v_min_u32 v96, -2, v96
  v_min_u32 v97, -2, v97
 Mvva 120,208,184
 TR 230,34,10080
  v_min_u32 v98, -2, v98
 Mvva 120,212,200
  v_min_u32 v99, -2, v99
 WL 4
 Mvva 124,208,188
 TR 208,34,19040
 WL 7
 Mvva 124,212,204
  buffer_store_dwordx4 v[96:99], v16, s[8:11], 0 offen offset:2048 sc1
 Mvva 112,216,144
 TR 210,34,19552
  v_cvt_pk_bf16_f32 v104, v104, v105
 Mvva 112,220,160
  v_cvt_pk_bf16_f32 v105, v106, v107
  v_cvt_pk_bf16_f32 v106, v108, v109
 Mvva 116,216,148
 TR 212,34,28512
  v_cvt_pk_bf16_f32 v107, v110, v111
 Mvva 116,220,164
  v_min_u32 v104, -2, v104
  v_min_u32 v105, -2, v105
 Mvva 120,216,152
 TR 214,34,29024
  v_min_u32 v106, -2, v106
 Mvva 120,220,168
  v_min_u32 v107, -2, v107
 Mvva 124,216,156
 TR 216,33,128
 WL 7
 Mvva 124,220,172
  buffer_store_dwordx4 v[104:107], v16, s[8:11], s50 offen offset:3072 sc1
 Mvva 112,224,0
 TR 218,33,640
 WL 6
 Mvva 112,228,16
 Mvva 116,224,4
 TR 220,33,9600
 Mvva 116,228,20
 Mvva 120,224,8
 TR 222,33,10112
 Mvva 120,228,24
 Mvva 124,224,12
 TR 224,33,19072
 Mvva 124,228,28
 WL 7
 Mvva 112,208,32
 TR 226,33,19584
 WL 6
 Mvva 112,212,48
 Mvva 116,208,36
 TR 228,33,28544
 Mvva 116,212,52
 Mvva 120,208,40
 TR 230,33,29056
 Mvva 120,212,56
 Mvva 124,208,44
 TR 208,34,128
 Mvva 124,212,60
 WL 7
 WL 5
 Mvva 128,216,176
 TR 210,34,640
  v_cvt_pk_bf16_f32 v112, v112, v113
 Mvva 128,220,192
  v_cvt_pk_bf16_f32 v113, v114, v115
  v_cvt_pk_bf16_f32 v114, v116, v117
 Mvva 132,216,180
 TR 212,34,9600
  v_cvt_pk_bf16_f32 v115, v118, v119
 Mvva 132,220,196
  v_min_u32 v112, -2, v112
  v_min_u32 v113, -2, v113
 Mvva 136,216,184
 TR 214,34,10112
  v_min_u32 v114, -2, v114
 Mvva 136,220,200
  v_min_u32 v115, -2, v115
 WL 4
 Mvva 140,216,188
 TR 216,34,19072
 WL 7
 Mvva 140,220,204
  buffer_store_dwordx4 v[112:115], v16, s[8:11], 0 offen offset:3072 sc1
 Mvva 128,224,144
 TR 218,34,19584
  v_cvt_pk_bf16_f32 v120, v120, v121
 Mvva 128,228,160
  v_cvt_pk_bf16_f32 v121, v122, v123
  v_cvt_pk_bf16_f32 v122, v124, v125
 Mvva 132,224,148
 TR 220,34,28544
  v_cvt_pk_bf16_f32 v123, v126, v127
 Mvva 132,228,164
  v_min_u32 v120, -2, v120
  v_min_u32 v121, -2, v121
 Mvva 136,224,152
 TR 222,34,29056
  v_min_u32 v122, -2, v122
 Mvva 136,228,168
  v_min_u32 v123, -2, v123
 Mvva 140,224,156
 TR 224,33,160
 WL 7
 Mvva 140,228,172
  buffer_store_dwordx4 v[120:123], v17, s[8:11], s50 offen offset:0 sc1
 Mvva 128,208,0
 TR 226,33,672
 WL 6
 Mvva 128,212,16
 Mvva 132,208,4
 TR 228,33,9632
 Mvva 132,212,20
 Mvva 136,208,8
 TR 230,33,10144
 Mvva 136,212,24
 Mvva 140,208,12
 TR 208,33,19104
 Mvva 140,212,28
 WL 7
 Mvva 128,216,32
 TR 210,33,19616
 WL 6
 Mvva 128,220,48
 Mvva 132,216,36
 TR 212,33,28576
 Mvva 132,220,52
  s_waitcnt vmcnt(7)
  v_cmp_gt_u32 vcc, 1, v248
  s_nop 4
  s_cbranch_vccnz Lpoll_pz_5
Lback_pz_5:
 Mvva 136,216,40
 TR 214,33,29088
 Mvva 136,220,56
 WL 6
 WL 4
 Mvva 140,216,44
 TR 216,34,160
  s_add_u32 s46, s55, 0
 Mvva 140,220,60
  buffer_load_dwordx4 v[64:67], v28, s[20:23], s46 offen sc1
 Mvva 144,224,176
 TR 218,34,672
  v_cvt_pk_bf16_f32 v128, v128, v129
 Mvva 144,228,192
  v_cvt_pk_bf16_f32 v129, v130, v131
  v_cvt_pk_bf16_f32 v130, v132, v133
 Mvva 148,224,180
 TR 220,34,9632
  v_cvt_pk_bf16_f32 v131, v134, v135
 Mvva 148,228,196
  v_min_u32 v128, -2, v128
  v_min_u32 v129, -2, v129
 Mvva 152,224,184
 TR 222,34,10144
  v_min_u32 v130, -2, v130
 Mvva 152,228,200
  v_min_u32 v131, -2, v131
 WL 4
 Mvva 156,224,188
 TR 224,34,19104
 WL 7
 Mvva 156,228,204
  buffer_store_dwordx4 v[128:131], v17, s[8:11], 0 offen offset:0 sc1
 Mvva 144,208,144
 TR 226,34,19616
  v_cvt_pk_bf16_f32 v136, v136, v137
 Mvva 144,212,160
  s_add_u32 s46, s55, 18432
  v_cvt_pk_bf16_f32 v137, v138, v139
  v_cvt_pk_bf16_f32 v138, v140, v141
 Mvva 148,208,148
 TR 228,34,28576
  v_cvt_pk_bf16_f32 v139, v142, v143
 Mvva 148,212,164
  buffer_load_dwordx4 v[68:71], v28, s[20:23], s46 offen sc1
 Mvva 152,208,152
 TR 230,34,29088
  v_min_u32 v136, -2, v136
 Mvva 152,212,168
 WL 6
  v_min_u32 v137, -2, v137
  v_min_u32 v138, -2, v138
 Mvva 156,208,156
 TR 208,33,192
  v_min_u32 v139, -2, v139
 Mvva 156,212,172
  buffer_store_dwordx4 v[136:139], v17, s[8:11], s50 offen offset:1024 sc1
 Mvva 144,216,0
 TR 210,33,704
 WL 6
 Mvva 144,220,16
 Mvva 148,216,4
 TR 212,33,9664
  s_add_u32 s46, s55, 36864
 Mvva 148,220,20
  buffer_load_dwordx4 v[72:75], v28, s[20:23], s46 offen sc1
 Mvva 152,216,8
 TR 214,33,10176
 Mvva 152,220,24
 Mvva 156,216,12
 TR 216,33,19136
 Mvva 156,220,28
 WL 7
 Mvva 144,224,32
 TR 218,33,19648
 WL 6
 Mvva 144,228,48
 Mvva 148,224,36
 TR 220,33,28608
 Mvva 148,228,52
 Mvva 152,224,40
 TR 222,33,29120
  s_add_u32 s46, s55, 55296
 Mvva 152,228,56
  buffer_load_dwordx4 v[76:79], v28, s[20:23], s46 offen sc1
 Mvva 156,224,44
 TR 224,34,192
 Mvva 156,228,60
 WL 7
 WL 5
 Mvva 160,208,176
 TR 226,34,704
  v_cvt_pk_bf16_f32 v144, v144, v145
 Mvva 160,212,192
  v_cvt_pk_bf16_f32 v145, v146, v147
  v_cvt_pk_bf16_f32 v146, v148, v149
 Mvva 164,208,180
 TR 228,34,9664
  v_cvt_pk_bf16_f32 v147, v150, v151
 Mvva 164,212,196
  v_min_u32 v144, -2, v144
  v_min_u32 v145, -2, v145
 Mvva 168,208,184
 TR 230,34,10176
  v_min_u32 v146, -2, v146
 Mvva 168,212,200
 WL 4
  v_min_u32 v147, -2, v147
 WL 6
 Mvva 172,208,188
 TR 208,34,19136
  s_add_u32 s46, s55, 73728
 Mvva 172,212,204
  buffer_store_dwordx4 v[144:147], v17, s[8:11], 0 offen offset:1024 sc1
 Mvva 160,216,144
 TR 210,34,19648
  v_cvt_pk_bf16_f32 v152, v152, v153
 Mvva 160,220,160
  buffer_load_dwordx4 v[80:83], v28, s[20:23], s46 offen sc1
 Mvva 164,216,148
 TR 212,34,28608
  v_cvt_pk_bf16_f32 v153, v154, v155
 Mvva 164,220,164
  v_cvt_pk_bf16_f32 v154, v156, v157
  v_cvt_pk_bf16_f32 v155, v158, v159
 Mvva 168,216,152
 TR 214,34,29120
  v_min_u32 v152, -2, v152
 Mvva 168,220,168
 WL 6
  v_min_u32 v153, -2, v153
  v_min_u32 v154, -2, v154
 Mvva 172,216,156
 TR 216,33,224
  v_min_u32 v155, -2, v155
 Mvva 172,220,172
  buffer_store_dwordx4 v[152:155], v17, s[8:11], s50 offen offset:2048 sc1
 Mvva 160,224,0
 TR 218,33,736
  s_add_u32 s46, s55, 92160
 WL 6
 Mvva 160,228,16
  buffer_load_dwordx4 v[84:87], v28, s[20:23], s46 offen sc1
 Mvva 164,224,4
 TR 220,33,9696
 Mvva 164,228,20
 Mvva 168,224,8
 TR 222,33,10208
 Mvva 168,228,24
 Mvva 172,224,12
 TR 224,33,19168
 Mvva 172,228,28
 WL 7
 Mvva 160,208,32
 TR 226,33,19680
 WL 6
 Mvva 160,212,48
 Mvva 164,208,36
 TR 228,33,28640
  s_add_u32 s46, s55, 110592
 Mvva 164,212,52
  buffer_load_dword v248, v247, s[20:23], s54 offen offset:32 sc1
 Mvva 168,208,40
 TR 230,33,29152
  v_mov_b32 v128, 0
 Mvva 168,212,56
  buffer_load_dwordx4 v[88:91], v28, s[20:23], s46 offen sc1
 Mvva 172,208,44
 TR 208,34,224
  v_mov_b32 v129, 0
 Mvva 172,212,60
 WL 7
  v_mov_b32 v130, 0
  v_mov_b32 v131, 0
 Mvva 176,216,176
 TR 210,34,736
  v_cvt_pk_bf16_f32 v160, v160, v161
 WL 6
 Mvva 176,220,192
  v_cvt_pk_bf16_f32 v161, v162, v163
  v_cvt_pk_bf16_f32 v162, v164, v165
 Mvva 180,216,180
 TR 212,34,9696
  v_cvt_pk_bf16_f32 v163, v166, v167
 Mvva 180,220,196
  v_min_u32 v160, -2, v160
  v_min_u32 v161, -2, v161
 Mvva 184,216,184
 TR 214,34,10208
  v_min_u32 v162, -2, v162
 Mvva 184,220,200
  s_add_u32 s46, s55, 129024
  v_min_u32 v163, -2, v163
  v_mov_b32 v132, 0
 Mvva 188,216,188
 TR 216,34,19168
  v_mov_b32 v133, 0
 Mvva 188,220,204
  buffer_store_dwordx4 v[160:163], v17, s[8:11], 0 offen offset:2048 sc1
  buffer_load_dwordx4 v[92:95], v28, s[20:23], s46 offen sc1
 WL 7
 Mvva 176,224,144
 TR 218,34,19680
  v_cvt_pk_bf16_f32 v168, v168, v169
 WL 6
 Mvva 176,228,160
  v_cvt_pk_bf16_f32 v169, v170, v171
  v_cvt_pk_bf16_f32 v170, v172, v173
 Mvva 180,224,148
 TR 220,34,28640
  v_cvt_pk_bf16_f32 v171, v174, v175
 Mvva 180,228,164
  v_min_u32 v168, -2, v168
  v_min_u32 v169, -2, v169
 Mvva 184,224,152
 TR 222,34,29152
  v_min_u32 v170, -2, v170
 Mvva 184,228,168
 WL 6
  v_min_u32 v171, -2, v171
  v_mov_b32 v134, 0
 Mvva 188,224,156
 TR 224,57,0
  v_mov_b32 v135, 0
 Mvva 188,228,172
  buffer_store_dwordx4 v[168:171], v17, s[8:11], s50 offen offset:3072 sc1
 Mvva 176,208,0
 TR 226,57,512
  v_mov_b32 v136, 0
 WL 6
 Mvva 176,212,16
  v_mov_b32 v137, 0
  v_mov_b32 v138, 0
 Mvva 180,208,4
 TR 228,57,9472
  v_mov_b32 v139, 0
 Mvva 180,212,20
  v_mov_b32 v140, 0
  v_mov_b32 v141, 0
 Mvva 184,208,8
 TR 230,57,9984
  v_mov_b32 v142, 0
 Mvva 184,212,24
  v_mov_b32 v143, 0
  v_mov_b32 v144, 0
 Mvva 188,208,12
 TR 208,57,18944
  v_mov_b32 v145, 0
 Mvva 188,212,28
 WL 7
 Mvva 176,216,32
 TR 210,57,19456
 WL 6
 Mvva 176,220,48
  buffer_store_dword v246, v245, s[20:23], s66 offen sc1
 Mvva 180,216,36
 TR 212,57,28416
 Mvva 180,220,52
 Mvva 184,216,40
 TR 214,57,28928
 Mvva 184,220,56
 Mvva 188,216,44
 TR 216,58,0
 Mvva 188,220,60
 WL 7
 WL 5
 Mvva 192,224,176
 TR 218,58,512
  v_cvt_pk_bf16_f32 v176, v176, v177
 Mvva 192,228,192
  v_cvt_pk_bf16_f32 v177, v178, v179
  v_cvt_pk_bf16_f32 v178, v180, v181
 Mvva 196,224,180
 TR 220,58,9472
  v_cvt_pk_bf16_f32 v179, v182, v183
 Mvva 196,228,196
  v_min_u32 v176, -2, v176
  v_min_u32 v177, -2, v177
 Mvva 200,224,184
 TR 222,58,9984
  v_min_u32 v178, -2, v178
 Mvva 200,228,200
  v_min_u32 v179, -2, v179
 WL 4
 Mvva 204,224,188
 TR 224,58,18944
 WL 7
 Mvva 204,228,204
  buffer_store_dwordx4 v[176:179], v17, s[8:11], 0 offen offset:3072 sc1
 Mvva 192,208,144
 TR 226,58,19456
  v_cvt_pk_bf16_f32 v184, v184, v185
 Mvva 192,212,160
  v_cvt_pk_bf16_f32 v185, v186, v187
  v_cvt_pk_bf16_f32 v186, v188, v189
 Mvva 196,208,148
 TR 228,58,28416
  v_cvt_pk_bf16_f32 v187, v190, v191
 Mvva 196,212,164
  v_min_u32 v184, -2, v184
  v_min_u32 v185, -2, v185
 Mvva 200,208,152
 TR 230,58,28928
  v_min_u32 v186, -2, v186
 Mvva 200,212,168
  v_min_u32 v187, -2, v187
 Mvva 204,208,156
  buffer_store_dwordx4 v[184:187], v16, s[8:11], s51 offen offset:0 sc1
 Mvva 204,212,172
 WL 6
 Mvva 192,216,0
 WL 4
 Mvva 192,220,16
 Mvva 196,216,4
 Mvva 196,220,20
 Mvva 200,216,8
 Mvva 200,220,24
 Mvva 204,216,12
 Mvva 204,220,28
 WL 2
 Mvva 192,224,32
 WL 0
 Mvva 192,228,48
 Mvva 196,224,36
 Mvva 196,228,52
 Mvva 200,224,40
 Mvva 200,228,56
 Mvva 204,224,44
 Mvva 204,228,60
  s_nop 1
  v_cvt_pk_bf16_f32 v192, v192, v193
  v_cvt_pk_bf16_f32 v193, v194, v195
  v_cvt_pk_bf16_f32 v194, v196, v197
  v_cvt_pk_bf16_f32 v195, v198, v199
  v_min_u32 v192, -2, v192
  v_min_u32 v193, -2, v193
  v_min_u32 v194, -2, v194
  v_min_u32 v195, -2, v195
  buffer_store_dwordx4 v[192:195], v16, s[8:11], s50 offen offset:0 sc1
  v_cvt_pk_bf16_f32 v200, v200, v201
  v_cvt_pk_bf16_f32 v201, v202, v203
  v_cvt_pk_bf16_f32 v202, v204, v205
  v_cvt_pk_bf16_f32 v203, v206, v207
  v_min_u32 v200, -2, v200
  v_min_u32 v201, -2, v201
  v_min_u32 v202, -2, v202
  v_min_u32 v203, -2, v203
  buffer_store_dwordx4 v[200:203], v16, s[8:11], s51 offen offset:1024 sc1
  s_waitcnt vmcnt(9)
  v_cmp_gt_u32 vcc, 2, v248
  s_nop 4
  s_cbranch_vccnz Lpoll_red_5
Lback_red_5:
  s_add_u32 s46, s55, 4096
  buffer_load_dwordx4 v[96:99], v28, s[20:23], s46 offen sc1
  buffer_load_dword v232, v29, s[20:23], s46 offen sc1
  s_add_u32 s46, s55, 22528
  buffer_load_dwordx4 v[100:103], v28, s[20:23], s46 offen sc1
  buffer_load_dword v233, v29, s[20:23], s46 offen sc1
  s_add_u32 s46, s55, 40960
  buffer_load_dwordx4 v[104:107], v28, s[20:23], s46 offen sc1
  buffer_load_dword v234, v29, s[20:23], s46 offen sc1
  s_add_u32 s46, s55, 59392
  buffer_load_dwordx4 v[108:111], v28, s[20:23], s46 offen sc1
  buffer_load_dword v235, v29, s[20:23], s46 offen sc1
  s_add_u32 s46, s55, 77824
  buffer_load_dwordx4 v[112:115], v28, s[20:23], s46 offen sc1
  buffer_load_dword v236, v29, s[20:23], s46 offen sc1
  s_add_u32 s46, s55, 96256
  buffer_load_dwordx4 v[116:119], v28, s[20:23], s46 offen sc1
  buffer_load_dword v237, v29, s[20:23], s46 offen sc1
  s_add_u32 s46, s55, 114688
  buffer_load_dwordx4 v[120:123], v28, s[20:23], s46 offen sc1
  buffer_load_dword v238, v29, s[20:23], s46 offen sc1
  s_add_u32 s46, s55, 133120
  buffer_load_dwordx4 v[124:127], v28, s[20:23], s46 offen sc1
  buffer_load_dword v239, v29, s[20:23], s46 offen sc1
  s_load_dwordx2 s[16:17], s[0:1], 80
  s_mov_b32 s18, 0x240000
  s_mov_b32 s19, 0x00020000
Lchk_5:
  s_bitcmp1_b32 s57, 0
  s_cbranch_scc0 Lskip0_5
  v_max3_u32 v36, v64, v65, v66
  v_max3_u32 v36, v36, v67, v67
  v_cmp_eq_u32 vcc, -1, v36
  s_nop 4
  s_cbranch_vccnz Lskip0_5
  v_lshlrev_b32 v36, 16, v64
  v_and_b32 v37, 0xffff0000, v64
  v_pk_add_f32 v[128:129], v[128:129], v[36:37]
  v_lshlrev_b32 v36, 16, v65
  v_and_b32 v37, 0xffff0000, v65
  v_pk_add_f32 v[130:131], v[130:131], v[36:37]
  v_lshlrev_b32 v36, 16, v66
  v_and_b32 v37, 0xffff0000, v66
  v_pk_add_f32 v[132:133], v[132:133], v[36:37]
  v_lshlrev_b32 v36, 16, v67
  v_and_b32 v37, 0xffff0000, v67
  v_pk_add_f32 v[134:135], v[134:135], v[36:37]
  s_bitset0_b32 s57, 0
Lskip0_5:
  s_bitcmp1_b32 s57, 1
  s_cbranch_scc0 Lskip1_5
  v_max3_u32 v36, v68, v69, v70
  v_max3_u32 v36, v36, v71, v71
  v_cmp_eq_u32 vcc, -1, v36
  s_nop 4
  s_cbranch_vccnz Lskip1_5
  v_lshlrev_b32 v36, 16, v68
  v_and_b32 v37, 0xffff0000, v68
  v_pk_add_f32 v[128:129], v[128:129], v[36:37]
  v_lshlrev_b32 v36, 16, v69
  v_and_b32 v37, 0xffff0000, v69
  v_pk_add_f32 v[130:131], v[130:131], v[36:37]
  v_lshlrev_b32 v36, 16, v70
  v_and_b32 v37, 0xffff0000, v70
  v_pk_add_f32 v[132:133], v[132:133], v[36:37]
  v_lshlrev_b32 v36, 16, v71
  v_and_b32 v37, 0xffff0000, v71
  v_pk_add_f32 v[134:135], v[134:135], v[36:37]
  s_bitset0_b32 s57, 1
Lskip1_5:
  s_bitcmp1_b32 s57, 2
  s_cbranch_scc0 Lskip2_5
  v_max3_u32 v36, v72, v73, v74
  v_max3_u32 v36, v36, v75, v75
  v_cmp_eq_u32 vcc, -1, v36
  s_nop 4
  s_cbranch_vccnz Lskip2_5
  v_lshlrev_b32 v36, 16, v72
  v_and_b32 v37, 0xffff0000, v72
  v_pk_add_f32 v[128:129], v[128:129], v[36:37]
  v_lshlrev_b32 v36, 16, v73
  v_and_b32 v37, 0xffff0000, v73
  v_pk_add_f32 v[130:131], v[130:131], v[36:37]
  v_lshlrev_b32 v36, 16, v74
  v_and_b32 v37, 0xffff0000, v74
  v_pk_add_f32 v[132:133], v[132:133], v[36:37]
  v_lshlrev_b32 v36, 16, v75
  v_and_b32 v37, 0xffff0000, v75
  v_pk_add_f32 v[134:135], v[134:135], v[36:37]
  s_bitset0_b32 s57, 2
Lskip2_5:
  s_bitcmp1_b32 s57, 3
  s_cbranch_scc0 Lskip3_5
  v_max3_u32 v36, v76, v77, v78
  v_max3_u32 v36, v36, v79, v79
  v_cmp_eq_u32 vcc, -1, v36
  s_nop 4
  s_cbranch_vccnz Lskip3_5
  v_lshlrev_b32 v36, 16, v76
  v_and_b32 v37, 0xffff0000, v76
  v_pk_add_f32 v[128:129], v[128:129], v[36:37]
  v_lshlrev_b32 v36, 16, v77
  v_and_b32 v37, 0xffff0000, v77
  v_pk_add_f32 v[130:131], v[130:131], v[36:37]
  v_lshlrev_b32 v36, 16, v78
  v_and_b32 v37, 0xffff0000, v78
  v_pk_add_f32 v[132:133], v[132:133], v[36:37]
  v_lshlrev_b32 v36, 16, v79
  v_and_b32 v37, 0xffff0000, v79
  v_pk_add_f32 v[134:135], v[134:135], v[36:37]
  s_bitset0_b32 s57, 3
Lskip3_5:
  s_bitcmp1_b32 s57, 4
  s_cbranch_scc0 Lskip4_5
  v_max3_u32 v36, v80, v81, v82
  v_max3_u32 v36, v36, v83, v83
  v_cmp_eq_u32 vcc, -1, v36
  s_nop 4
  s_cbranch_vccnz Lskip4_5
  v_lshlrev_b32 v36, 16, v80
  v_and_b32 v37, 0xffff0000, v80
  v_pk_add_f32 v[128:129], v[128:129], v[36:37]
  v_lshlrev_b32 v36, 16, v81
  v_and_b32 v37, 0xffff0000, v81
  v_pk_add_f32 v[130:131], v[130:131], v[36:37]
  v_lshlrev_b32 v36, 16, v82
  v_and_b32 v37, 0xffff0000, v82
  v_pk_add_f32 v[132:133], v[132:133], v[36:37]
  v_lshlrev_b32 v36, 16, v83
  v_and_b32 v37, 0xffff0000, v83
  v_pk_add_f32 v[134:135], v[134:135], v[36:37]
  s_bitset0_b32 s57, 4
Lskip4_5:
  s_bitcmp1_b32 s57, 5
  s_cbranch_scc0 Lskip5_5
  v_max3_u32 v36, v84, v85, v86
  v_max3_u32 v36, v36, v87, v87
  v_cmp_eq_u32 vcc, -1, v36
  s_nop 4
  s_cbranch_vccnz Lskip5_5
  v_lshlrev_b32 v36, 16, v84
  v_and_b32 v37, 0xffff0000, v84
  v_pk_add_f32 v[128:129], v[128:129], v[36:37]
  v_lshlrev_b32 v36, 16, v85
  v_and_b32 v37, 0xffff0000, v85
  v_pk_add_f32 v[130:131], v[130:131], v[36:37]
  v_lshlrev_b32 v36, 16, v86
  v_and_b32 v37, 0xffff0000, v86
  v_pk_add_f32 v[132:133], v[132:133], v[36:37]
  v_lshlrev_b32 v36, 16, v87
  v_and_b32 v37, 0xffff0000, v87
  v_pk_add_f32 v[134:135], v[134:135], v[36:37]
  s_bitset0_b32 s57, 5
Lskip5_5:
  s_bitcmp1_b32 s57, 6
  s_cbranch_scc0 Lskip6_5
  s_waitcnt vmcnt(24)
  v_max3_u32 v36, v88, v89, v90
  v_max3_u32 v36, v36, v91, v91
  v_cmp_eq_u32 vcc, -1, v36
  s_nop 4
  s_cbranch_vccnz Lskip6_5
  v_lshlrev_b32 v36, 16, v88
  v_and_b32 v37, 0xffff0000, v88
  v_pk_add_f32 v[128:129], v[128:129], v[36:37]
  v_lshlrev_b32 v36, 16, v89
  v_and_b32 v37, 0xffff0000, v89
  v_pk_add_f32 v[130:131], v[130:131], v[36:37]
  v_lshlrev_b32 v36, 16, v90
  v_and_b32 v37, 0xffff0000, v90
  v_pk_add_f32 v[132:133], v[132:133], v[36:37]
  v_lshlrev_b32 v36, 16, v91
  v_and_b32 v37, 0xffff0000, v91
  v_pk_add_f32 v[134:135], v[134:135], v[36:37]
  s_bitset0_b32 s57, 6
Lskip6_5:
  s_bitcmp1_b32 s57, 7
  s_cbranch_scc0 Lskip7_5
  s_waitcnt vmcnt(22)
  v_max3_u32 v36, v92, v93, v94
  v_max3_u32 v36, v36, v95, v95
  v_cmp_eq_u32 vcc, -1, v36
  s_nop 4
  s_cbranch_vccnz Lskip7_5
  v_lshlrev_b32 v36, 16, v92
  v_and_b32 v37, 0xffff0000, v92
  v_pk_add_f32 v[128:129], v[128:129], v[36:37]
  v_lshlrev_b32 v36, 16, v93
  v_and_b32 v37, 0xffff0000, v93
  v_pk_add_f32 v[130:131], v[130:131], v[36:37]
  v_lshlrev_b32 v36, 16, v94
  v_and_b32 v37, 0xffff0000, v94
  v_pk_add_f32 v[132:133], v[132:133], v[36:37]
  v_lshlrev_b32 v36, 16, v95
  v_and_b32 v37, 0xffff0000, v95
  v_pk_add_f32 v[134:135], v[134:135], v[36:37]
  s_bitset0_b32 s57, 7
Lskip7_5:
  s_bitcmp1_b32 s57, 8
  s_cbranch_scc0 Lskip8_5
  s_waitcnt vmcnt(15)
  v_max3_u32 v36, v96, v97, v98
  s_waitcnt vmcnt(14)
  v_max3_u32 v36, v36, v99, v232
  v_cmp_eq_u32 vcc, -1, v36
  s_nop 4
  s_cbranch_vccnz Lskip8_5
  v_lshlrev_b32 v36, 16, v96
  v_and_b32 v37, 0xffff0000, v96
  v_pk_add_f32 v[136:137], v[136:137], v[36:37]
  v_lshlrev_b32 v36, 16, v97
  v_and_b32 v37, 0xffff0000, v97
  v_pk_add_f32 v[138:139], v[138:139], v[36:37]
  v_lshlrev_b32 v36, 16, v98
  v_and_b32 v37, 0xffff0000, v98
  v_pk_add_f32 v[140:141], v[140:141], v[36:37]
  v_lshlrev_b32 v36, 16, v99
  v_and_b32 v37, 0xffff0000, v99
  v_pk_add_f32 v[142:143], v[142:143], v[36:37]
  v_lshlrev_b32 v36, 16, v232
  v_and_b32 v37, 0xffff0000, v232
  v_pk_add_f32 v[144:145], v[144:145], v[36:37]
  s_bitset0_b32 s57, 8
Lskip8_5:
  s_bitcmp1_b32 s57, 9
  s_cbranch_scc0 Lskip9_5
  s_waitcnt vmcnt(13)
  v_max3_u32 v36, v100, v101, v102
  s_waitcnt vmcnt(12)
  v_max3_u32 v36, v36, v103, v233
  v_cmp_eq_u32 vcc, -1, v36
  s_nop 4
  s_cbranch_vccnz Lskip9_5
  v_lshlrev_b32 v36, 16, v100
  v_and_b32 v37, 0xffff0000, v100
  v_pk_add_f32 v[136:137], v[136:137], v[36:37]
  v_lshlrev_b32 v36, 16, v101
  v_and_b32 v37, 0xffff0000, v101
  v_pk_add_f32 v[138:139], v[138:139], v[36:37]
  v_lshlrev_b32 v36, 16, v102
  v_and_b32 v37, 0xffff0000, v102
  v_pk_add_f32 v[140:141], v[140:141], v[36:37]
  v_lshlrev_b32 v36, 16, v103
  v_and_b32 v37, 0xffff0000, v103
  v_pk_add_f32 v[142:143], v[142:143], v[36:37]
  v_lshlrev_b32 v36, 16, v233
  v_and_b32 v37, 0xffff0000, v233
  v_pk_add_f32 v[144:145], v[144:145], v[36:37]
  s_bitset0_b32 s57, 9
Lskip9_5:
  s_bitcmp1_b32 s57, 10
  s_cbranch_scc0 Lskip10_5
  s_waitcnt vmcnt(11)
  v_max3_u32 v36, v104, v105, v106
  s_waitcnt vmcnt(10)
  v_max3_u32 v36, v36, v107, v234
  v_cmp_eq_u32 vcc, -1, v36
  s_nop 4
  s_cbranch_vccnz Lskip10_5
  v_lshlrev_b32 v36, 16, v104
  v_and_b32 v37, 0xffff0000, v104
  v_pk_add_f32 v[136:137], v[136:137], v[36:37]
  v_lshlrev_b32 v36, 16, v105
  v_and_b32 v37, 0xffff0000, v105
  v_pk_add_f32 v[138:139], v[138:139], v[36:37]
  v_lshlrev_b32 v36, 16, v106
  v_and_b32 v37, 0xffff0000, v106
  v_pk_add_f32 v[140:141], v[140:141], v[36:37]
  v_lshlrev_b32 v36, 16, v107
  v_and_b32 v37, 0xffff0000, v107
  v_pk_add_f32 v[142:143], v[142:143], v[36:37]
  v_lshlrev_b32 v36, 16, v234
  v_and_b32 v37, 0xffff0000, v234
  v_pk_add_f32 v[144:145], v[144:145], v[36:37]
  s_bitset0_b32 s57, 10
Lskip10_5:
  s_bitcmp1_b32 s57, 11
  s_cbranch_scc0 Lskip11_5
  s_waitcnt vmcnt(9)
  v_max3_u32 v36, v108, v109, v110
  s_waitcnt vmcnt(8)
  v_max3_u32 v36, v36, v111, v235
  v_cmp_eq_u32 vcc, -1, v36
  s_nop 4
  s_cbranch_vccnz Lskip11_5
  v_lshlrev_b32 v36, 16, v108
  v_and_b32 v37, 0xffff0000, v108
  v_pk_add_f32 v[136:137], v[136:137], v[36:37]
  v_lshlrev_b32 v36, 16, v109
  v_and_b32 v37, 0xffff0000, v109
  v_pk_add_f32 v[138:139], v[138:139], v[36:37]
  v_lshlrev_b32 v36, 16, v110
  v_and_b32 v37, 0xffff0000, v110
  v_pk_add_f32 v[140:141], v[140:141], v[36:37]
  v_lshlrev_b32 v36, 16, v111
  v_and_b32 v37, 0xffff0000, v111
  v_pk_add_f32 v[142:143], v[142:143], v[36:37]
  v_lshlrev_b32 v36, 16, v235
  v_and_b32 v37, 0xffff0000, v235
  v_pk_add_f32 v[144:145], v[144:145], v[36:37]
  s_bitset0_b32 s57, 11
Lskip11_5:
  s_bitcmp1_b32 s57, 12
  s_cbranch_scc0 Lskip12_5
  s_waitcnt vmcnt(7)
  v_max3_u32 v36, v112, v113, v114
  s_waitcnt vmcnt(6)
  v_max3_u32 v36, v36, v115, v236
  v_cmp_eq_u32 vcc, -1, v36
  s_nop 4
  s_cbranch_vccnz Lskip12_5
  v_lshlrev_b32 v36, 16, v112
  v_and_b32 v37, 0xffff0000, v112
  v_pk_add_f32 v[136:137], v[136:137], v[36:37]
  v_lshlrev_b32 v36, 16, v113
  v_and_b32 v37, 0xffff0000, v113
  v_pk_add_f32 v[138:139], v[138:139], v[36:37]
  v_lshlrev_b32 v36, 16, v114
  v_and_b32 v37, 0xffff0000, v114
  v_pk_add_f32 v[140:141], v[140:141], v[36:37]
  v_lshlrev_b32 v36, 16, v115
  v_and_b32 v37, 0xffff0000, v115
  v_pk_add_f32 v[142:143], v[142:143], v[36:37]
  v_lshlrev_b32 v36, 16, v236
  v_and_b32 v37, 0xffff0000, v236
  v_pk_add_f32 v[144:145], v[144:145], v[36:37]
  s_bitset0_b32 s57, 12
Lskip12_5:
  s_bitcmp1_b32 s57, 13
  s_cbranch_scc0 Lskip13_5
  s_waitcnt vmcnt(5)
  v_max3_u32 v36, v116, v117, v118
  s_waitcnt vmcnt(4)
  v_max3_u32 v36, v36, v119, v237
  v_cmp_eq_u32 vcc, -1, v36
  s_nop 4
  s_cbranch_vccnz Lskip13_5
  v_lshlrev_b32 v36, 16, v116
  v_and_b32 v37, 0xffff0000, v116
  v_pk_add_f32 v[136:137], v[136:137], v[36:37]
  v_lshlrev_b32 v36, 16, v117
  v_and_b32 v37, 0xffff0000, v117
  v_pk_add_f32 v[138:139], v[138:139], v[36:37]
  v_lshlrev_b32 v36, 16, v118
  v_and_b32 v37, 0xffff0000, v118
  v_pk_add_f32 v[140:141], v[140:141], v[36:37]
  v_lshlrev_b32 v36, 16, v119
  v_and_b32 v37, 0xffff0000, v119
  v_pk_add_f32 v[142:143], v[142:143], v[36:37]
  v_lshlrev_b32 v36, 16, v237
  v_and_b32 v37, 0xffff0000, v237
  v_pk_add_f32 v[144:145], v[144:145], v[36:37]
  s_bitset0_b32 s57, 13
Lskip13_5:
  s_bitcmp1_b32 s57, 14
  s_cbranch_scc0 Lskip14_5
  s_waitcnt vmcnt(3)
  v_max3_u32 v36, v120, v121, v122
  s_waitcnt vmcnt(2)
  v_max3_u32 v36, v36, v123, v238
  v_cmp_eq_u32 vcc, -1, v36
  s_nop 4
  s_cbranch_vccnz Lskip14_5
  v_lshlrev_b32 v36, 16, v120
  v_and_b32 v37, 0xffff0000, v120
  v_pk_add_f32 v[136:137], v[136:137], v[36:37]
  v_lshlrev_b32 v36, 16, v121
  v_and_b32 v37, 0xffff0000, v121
  v_pk_add_f32 v[138:139], v[138:139], v[36:37]
  v_lshlrev_b32 v36, 16, v122
  v_and_b32 v37, 0xffff0000, v122
  v_pk_add_f32 v[140:141], v[140:141], v[36:37]
  v_lshlrev_b32 v36, 16, v123
  v_and_b32 v37, 0xffff0000, v123
  v_pk_add_f32 v[142:143], v[142:143], v[36:37]
  v_lshlrev_b32 v36, 16, v238
  v_and_b32 v37, 0xffff0000, v238
  v_pk_add_f32 v[144:145], v[144:145], v[36:37]
  s_bitset0_b32 s57, 14
Lskip14_5:
  s_bitcmp1_b32 s57, 15
  s_cbranch_scc0 Lskip15_5
  s_waitcnt vmcnt(1)
  v_max3_u32 v36, v124, v125, v126
  s_waitcnt vmcnt(0)
  v_max3_u32 v36, v36, v127, v239
  v_cmp_eq_u32 vcc, -1, v36
  s_nop 4
  s_cbranch_vccnz Lskip15_5
  v_lshlrev_b32 v36, 16, v124
  v_and_b32 v37, 0xffff0000, v124
  v_pk_add_f32 v[136:137], v[136:137], v[36:37]
  v_lshlrev_b32 v36, 16, v125
  v_and_b32 v37, 0xffff0000, v125
  v_pk_add_f32 v[138:139], v[138:139], v[36:37]
  v_lshlrev_b32 v36, 16, v126
  v_and_b32 v37, 0xffff0000, v126
  v_pk_add_f32 v[140:141], v[140:141], v[36:37]
  v_lshlrev_b32 v36, 16, v127
  v_and_b32 v37, 0xffff0000, v127
  v_pk_add_f32 v[142:143], v[142:143], v[36:37]
  v_lshlrev_b32 v36, 16, v239
  v_and_b32 v37, 0xffff0000, v239
  v_pk_add_f32 v[144:145], v[144:145], v[36:37]
  s_bitset0_b32 s57, 15
Lskip15_5:
  s_cmp_lg_u32 s57, 0
  s_cbranch_scc1 Lretry_5
  v_cvt_pk_bf16_f32 v64, v128, v129
  v_cvt_pk_bf16_f32 v65, v130, v131
  v_cvt_pk_bf16_f32 v66, v132, v133
  v_cvt_pk_bf16_f32 v67, v134, v135
  v_cvt_pk_bf16_f32 v68, v136, v137
  v_cvt_pk_bf16_f32 v69, v138, v139
  v_cvt_pk_bf16_f32 v70, v140, v141
  v_cvt_pk_bf16_f32 v71, v142, v143
  v_cvt_pk_bf16_f32 v72, v144, v145
 WL 0
  buffer_store_dwordx2 v[64:65], v30, s[16:19], s56 offen offset:0
  buffer_store_dwordx2 v[66:67], v30, s[16:19], s69 offen offset:0
  buffer_store_dwordx2 v[68:69], v30, s[16:19], s56 offen offset:128
  buffer_store_dwordx2 v[70:71], v30, s[16:19], s69 offen offset:128
  buffer_store_dword v72, v31, s[16:19], s56 offen
Lexit_5:
  s_endpgm
Lpoll_ctx_5:
  buffer_load_dword v248, v247, s[20:23], s54 offen offset:16 sc1
  s_waitcnt vmcnt(0)
  v_cmp_gt_u32 vcc, 1, v248
  s_nop 4
  s_cbranch_vccz Lback_ctx_5
  s_branch Lpoll_ctx_5
Lpoll_pz_5:
  buffer_load_dword v248, v247, s[20:23], s54 offen offset:32 sc1
  s_waitcnt vmcnt(0)
  v_cmp_gt_u32 vcc, 1, v248
  s_nop 4
  s_cbranch_vccz Lback_pz_5
  s_branch Lpoll_pz_5
Lpoll_red_5:
  buffer_load_dword v248, v247, s[20:23], s54 offen offset:32 sc1
  s_waitcnt vmcnt(0)
  v_cmp_gt_u32 vcc, 2, v248
  s_nop 4
  s_cbranch_vccz Lback_red_5
  s_branch Lpoll_red_5
Lretry_5:
  s_bitcmp1_b32 s57, 0
  s_cbranch_scc0 Lrskip0_5
  s_add_u32 s46, s55, 0
  buffer_load_dwordx4 v[64:67], v28, s[20:23], s46 offen sc1
Lrskip0_5:
  s_bitcmp1_b32 s57, 1
  s_cbranch_scc0 Lrskip1_5
  s_add_u32 s46, s55, 18432
  buffer_load_dwordx4 v[68:71], v28, s[20:23], s46 offen sc1
Lrskip1_5:
  s_bitcmp1_b32 s57, 2
  s_cbranch_scc0 Lrskip2_5
  s_add_u32 s46, s55, 36864
  buffer_load_dwordx4 v[72:75], v28, s[20:23], s46 offen sc1
Lrskip2_5:
  s_bitcmp1_b32 s57, 3
  s_cbranch_scc0 Lrskip3_5
  s_add_u32 s46, s55, 55296
  buffer_load_dwordx4 v[76:79], v28, s[20:23], s46 offen sc1
Lrskip3_5:
  s_bitcmp1_b32 s57, 4
  s_cbranch_scc0 Lrskip4_5
  s_add_u32 s46, s55, 73728
  buffer_load_dwordx4 v[80:83], v28, s[20:23], s46 offen sc1
Lrskip4_5:
  s_bitcmp1_b32 s57, 5
  s_cbranch_scc0 Lrskip5_5
  s_add_u32 s46, s55, 92160
  buffer_load_dwordx4 v[84:87], v28, s[20:23], s46 offen sc1
Lrskip5_5:
  s_bitcmp1_b32 s57, 6
  s_cbranch_scc0 Lrskip6_5
  s_add_u32 s46, s55, 110592
  buffer_load_dwordx4 v[88:91], v28, s[20:23], s46 offen sc1
Lrskip6_5:
  s_bitcmp1_b32 s57, 7
  s_cbranch_scc0 Lrskip7_5
  s_add_u32 s46, s55, 129024
  buffer_load_dwordx4 v[92:95], v28, s[20:23], s46 offen sc1
Lrskip7_5:
  s_bitcmp1_b32 s57, 8
  s_cbranch_scc0 Lrskip8_5
  s_add_u32 s46, s55, 4096
  buffer_load_dwordx4 v[96:99], v28, s[20:23], s46 offen sc1
  buffer_load_dword v232, v29, s[20:23], s46 offen sc1
Lrskip8_5:
  s_bitcmp1_b32 s57, 9
  s_cbranch_scc0 Lrskip9_5
  s_add_u32 s46, s55, 22528
  buffer_load_dwordx4 v[100:103], v28, s[20:23], s46 offen sc1
  buffer_load_dword v233, v29, s[20:23], s46 offen sc1
Lrskip9_5:
  s_bitcmp1_b32 s57, 10
  s_cbranch_scc0 Lrskip10_5
  s_add_u32 s46, s55, 40960
  buffer_load_dwordx4 v[104:107], v28, s[20:23], s46 offen sc1
  buffer_load_dword v234, v29, s[20:23], s46 offen sc1
Lrskip10_5:
  s_bitcmp1_b32 s57, 11
  s_cbranch_scc0 Lrskip11_5
  s_add_u32 s46, s55, 59392
  buffer_load_dwordx4 v[108:111], v28, s[20:23], s46 offen sc1
  buffer_load_dword v235, v29, s[20:23], s46 offen sc1
Lrskip11_5:
  s_bitcmp1_b32 s57, 12
  s_cbranch_scc0 Lrskip12_5
  s_add_u32 s46, s55, 77824
  buffer_load_dwordx4 v[112:115], v28, s[20:23], s46 offen sc1
  buffer_load_dword v236, v29, s[20:23], s46 offen sc1
Lrskip12_5:
  s_bitcmp1_b32 s57, 13
  s_cbranch_scc0 Lrskip13_5
  s_add_u32 s46, s55, 96256
  buffer_load_dwordx4 v[116:119], v28, s[20:23], s46 offen sc1
  buffer_load_dword v237, v29, s[20:23], s46 offen sc1
Lrskip13_5:
  s_bitcmp1_b32 s57, 14
  s_cbranch_scc0 Lrskip14_5
  s_add_u32 s46, s55, 114688
  buffer_load_dwordx4 v[120:123], v28, s[20:23], s46 offen sc1
  buffer_load_dword v238, v29, s[20:23], s46 offen sc1
Lrskip14_5:
  s_bitcmp1_b32 s57, 15
  s_cbranch_scc0 Lrskip15_5
  s_add_u32 s46, s55, 133120
  buffer_load_dwordx4 v[124:127], v28, s[20:23], s46 offen sc1
  buffer_load_dword v239, v29, s[20:23], s46 offen sc1
Lrskip15_5:
  s_waitcnt vmcnt(0)
  s_branch Lchk_5
Lp4e_5:
Lp4_6:
  v_cmp_lt_u32 vcc, 0x40000000, v43
  s_lshr_b32 s65, s6, 8
  s_lshl_b32 s66, s3, 2
  v_mov_b32 v246, s66
  s_cmp_lg_u64 vcc, 0
  s_cselect_b32 s66, 1, 0
  s_andn2_b32 s66, s66, s65
  v_mov_b32 v245, s66
  ds_write_b32 v246, v245
  v_and_b32 v246, 3, v0
  v_lshlrev_b32 v246, 2, v246
  v_lshlrev_b32 v59, 3, v0
  v_add_u32 v56, 20736, v59
  v_add_u32 v57, 134400, v59
  v_add_u32 v58, 58624, v59
  v_add_u32 v59, 96512, v59
 WL 0
  s_waitcnt vmcnt(33)
  s_barrier
 TR 208,32,0
 TR 210,32,512
 TR 212,32,9472
 TR 214,32,9984
 TR 216,32,32
 TR 218,32,544
 TR 220,32,9504
 TR 222,32,10016
 TR 224,32,64
 TR 226,32,576
 TR 228,32,9536
 TR 230,32,10048
  ds_read_b32 v245, v246
 WL 11
  v_mfma_f32_16x16x32_bf16 v[64:67], v[208:211], a[212:215], 0
  s_add_u32 s46, s45, 49152
  v_lshlrev_b32 v249, 14, v0
  v_add_u32 v249, Lp4_6-Lpc0, v249
 WL 9
 Mvva 64,212,228
  buffer_load_dwordx4 a[0:3], v16, s[20:23], s46 offen offset:0 sc1
  v_mfma_f32_16x16x32_bf16 v[68:71], v[208:211], a[216:219], 0
  v_min_u32 v249, Lp4e_6-Lpc0-16388, v249
 Mvva 68,212,232
  v_mfma_f32_16x16x32_bf16 v[72:75], v[208:211], a[220:223], 0
 Mvva 72,212,236
  buffer_load_dwordx4 a[4:7], v16, s[20:23], s46 offen offset:2048 sc1
  v_mfma_f32_16x16x32_bf16 v[76:79], v[208:211], a[224:227], 0
 TR 208,32,96
 Mvva 76,212,240
 WL 8
  v_mfma_f32_16x16x32_bf16 v[80:83], v[216:219], a[212:215], 0
 TR 210,32,608
 WL 7
 Mvva 80,220,228
 WL 2
  v_cmp_ne_u32 vcc, 0, v245
  s_nop 4
  s_cbranch_vccnz Lrestart
  v_mfma_f32_16x16x32_bf16 v[84:87], v[216:219], a[216:219], 0
 TR 212,32,9568
 Mvva 84,220,232
  buffer_load_dwordx4 a[8:11], v17, s[20:23], s46 offen offset:0 sc1
  v_mfma_f32_16x16x32_bf16 v[88:91], v[216:219], a[220:223], 0
 TR 214,32,10080
 Mvva 88,220,236
  s_cmp_lg_u32 s3, 0
  s_cselect_b32 s64, 256, 0
  s_and_b32 s66, s2, 0xe7
  v_mfma_f32_16x16x32_bf16 v[92:95], v[216:219], a[224:227], 0
 TR 216,32,128
  s_lshl_b32 s66, s66, 6
 Mvva 92,220,240
  buffer_load_dwordx4 a[12:15], v17, s[20:23], s46 offen offset:2048 sc1
  v_mfma_f32_16x16x32_bf16 v[96:99], v[224:227], a[212:215], 0
 TR 218,32,640
  s_lshr_b32 s65, s4, 3
 Mvva 96,228,228
  s_add_u32 s66, s66, s65
  s_lshl_b32 s66, s66, 2
  s_add_u32 s66, s66, 0x4480010
  v_mfma_f32_16x16x32_bf16 v[100:103], v[224:227], a[216:219], 0
 TR 220,32,9600
  s_add_u32 s46, s45, 57344
 Mvva 100,228,232
  s_lshl_b32 s65, s64, 20
  s_add_u32 s66, s66, s65
  v_mfma_f32_16x16x32_bf16 v[104:107], v[224:227], a[220:223], 0
 TR 222,32,10112
 Mvva 104,228,236
  buffer_load_dwordx4 a[16:19], v16, s[20:23], s46 offen offset:0 sc1
  v_mfma_f32_16x16x32_bf16 v[108:111], v[224:227], a[224:227], 0
 TR 224,32,160
 Mvva 108,228,240
 WL 7
  v_cmp_gt_u32 vcc, 4, v0
  v_lshlrev_b32 v245, 11, v0
  v_mov_b32 v246, 1
  v_cndmask_b32 v245, -1, v245, vcc
  v_mfma_f32_16x16x32_bf16 v[112:115], v[208:211], a[212:215], 0
 TR 226,32,672
 WL 6
 Mvva 112,212,228
  buffer_load_dwordx4 a[20:23], v16, s[20:23], s46 offen offset:2048 sc1
  v_mfma_f32_16x16x32_bf16 v[116:119], v[208:211], a[216:219], 0
 TR 228,32,9632
 Mvva 116,212,232
  global_load_dword a248, v249, s[100:101]
  v_mfma_f32_16x16x32_bf16 v[120:123], v[208:211], a[220:223], 0
 TR 230,32,10144
 Mvva 120,212,236
  v_mfma_f32_16x16x32_bf16 v[124:127], v[208:211], a[224:227], 0
 TR 208,32,192
 WL 7
 Mvva 124,212,240
  buffer_load_dwordx4 a[24:27], v17, s[20:23], s46 offen offset:0 sc1
  v_mfma_f32_16x16x32_bf16 v[128:131], v[216:219], a[212:215], 0
 TR 210,32,704
 WL 6
 Mvva 128,220,228
  v_mfma_f32_16x16x32_bf16 v[132:135], v[216:219], a[216:219], 0
 TR 212,32,9664
 Mvva 132,220,232
  buffer_load_dwordx4 a[28:31], v17, s[20:23], s46 offen offset:2048 sc1
  v_mfma_f32_16x16x32_bf16 v[136:139], v[216:219], a[220:223], 0
 TR 214,32,10176
  s_add_u32 s44, s44, 147456
 Mvva 136,220,236
  v_mfma_f32_16x16x32_bf16 v[140:143], v[216:219], a[224:227], 0
 TR 216,32,224
  s_add_u32 m0, s47, 50176
 Mvva 140,220,240
 WL 7
  v_mfma_f32_16x16x32_bf16 v[144:147], v[224:227], a[212:215], 0
 TR 218,32,736
 WL 6
 Mvva 144,228,228
  buffer_load_dwordx4 v1, s[12:15], s44 offen lds
  v_mfma_f32_16x16x32_bf16 v[148:151], v[224:227], a[216:219], 0
 TR 220,32,9696
 Mvva 148,228,232
  v_mfma_f32_16x16x32_bf16 v[152:155], v[224:227], a[220:223], 0
 TR 222,32,10208
 Mvva 152,228,236
  buffer_load_dwordx4 v2, s[12:15], s44 offen offset:1056 lds
  v_mfma_f32_16x16x32_bf16 v[156:159], v[224:227], a[224:227], 0
 TR 224,56,0
 Mvva 156,228,240
 WL 7
  v_mfma_f32_16x16x32_bf16 v[160:163], v[208:211], a[212:215], 0
 TR 226,56,512
 WL 6
 Mvva 160,212,228
  v_mfma_f32_16x16x32_bf16 v[164:167], v[208:211], a[216:219], 0
 TR 228,56,9472
 Mvva 164,212,232
  buffer_load_dwordx4 v3, s[12:15], s44 offen offset:2112 lds
  v_mfma_f32_16x16x32_bf16 v[168:171], v[208:211], a[220:223], 0
 TR 230,56,9984
 Mvva 168,212,236
  v_mfma_f32_16x16x32_bf16 v[172:175], v[208:211], a[224:227], 0
 TR 208,32,18944
 WL 7
 Mvva 172,212,240
  buffer_load_dwordx4 v4, s[12:15], s44 offen offset:3168 lds
  v_mfma_f32_16x16x32_bf16 v[176:179], v[216:219], a[212:215], 0
 TR 210,32,19456
 WL 6
 Mvva 176,220,228
  v_mfma_f32_16x16x32_bf16 v[180:183], v[216:219], a[216:219], 0
 TR 212,32,28416
  s_add_u32 m0, s47, 54400
 Mvva 180,220,232
  v_mfma_f32_16x16x32_bf16 v[184:187], v[216:219], a[220:223], 0
 TR 214,32,28928
 Mvva 184,220,236
  buffer_load_dwordx4 v5, s[12:15], s44 offen lds
  v_mfma_f32_16x16x32_bf16 v[188:191], v[216:219], a[224:227], 0
 TR 216,32,18976
 Mvva 188,220,240
 WL 7
  v_mfma_f32_16x16x32_bf16 v[192:195], v[224:227], a[212:215], 0
 TR 218,32,19488
 WL 6
 Mvva 192,228,228
  buffer_load_dwordx4 v6, s[12:15], s44 offen offset:1056 lds
  v_mfma_f32_16x16x32_bf16 v[196:199], v[224:227], a[216:219], 0
 TR 220,32,28448
 Mvva 196,228,232
  v_mfma_f32_16x16x32_bf16 v[200:203], v[224:227], a[220:223], 0
 TR 222,32,28960
  s_waitcnt vmcnt(40)
 Mvva 200,228,236
  v_mfma_f32_16x16x32_bf16 v[204:207], v[224:227], a[224:227], 0
 TR 224,32,19008
 WL 7
 Mvva 204,228,240
  buffer_load_dwordx4 v7, s[12:15], s44 offen offset:2112 lds
 Mvva 64,208,176
 TR 226,32,19520
 WL 6
 Mvva 64,212,192
 Mvva 68,208,180
 TR 228,32,28480
 Mvva 68,212,196
  buffer_load_dwordx4 v8, s[12:15], s44 offen offset:3168 lds
 Mvva 72,208,184
 TR 230,32,28992
 Mvva 72,212,200
 Mvva 76,208,188
 TR 208,32,19040
  s_add_u32 m0, s47, 58624
 Mvva 76,212,204
 WL 7
 Mvva 80,216,176
 TR 210,32,19552
 WL 6
 Mvva 80,220,192
  buffer_load_dwordx4 v9, s[20:23], s44 offen sc1 lds
 Mvva 84,216,180
 TR 212,32,28512
 Mvva 84,220,196
  s_add_u32 s46, s45, 65536
 Mvva 88,216,184
 TR 214,32,29024
 Mvva 88,220,200
  buffer_load_dwordx4 a[32:35], v16, s[20:23], s46 offen offset:0 sc1
 Mvva 92,216,188
 TR 216,32,19072
 Mvva 92,220,204
 WL 7
 Mvva 96,224,176
 TR 218,32,19584
 WL 6
 Mvva 96,228,192
 Mvva 100,224,180
 TR 220,32,28544
 Mvva 100,228,196
  buffer_load_dwordx4 a[36:39], v16, s[20:23], s46 offen offset:2048 sc1
 Mvva 104,224,184
 TR 222,32,29056
 Mvva 104,228,200
 Mvva 108,224,188
 TR 224,32,19104
 WL 7
 Mvva 108,228,204
  buffer_load_dwordx4 a[40:43], v17, s[20:23], s46 offen offset:0 sc1
 Mvva 112,208,176
 TR 226,32,19616
 WL 6
 Mvva 112,212,192
 Mvva 116,208,180
 TR 228,32,28576
 Mvva 116,212,196
 Mvva 120,208,184
 TR 230,32,29088
 Mvva 120,212,200
  buffer_load_dwordx4 a[44:47], v17, s[20:23], s46 offen offset:2048 sc1
 Mvva 124,208,188
 TR 208,32,19136
 Mvva 124,212,204
  s_add_u32 s46, s45, 73728
 WL 7
 Mvva 128,216,176
 TR 210,32,19648
 WL 6
 Mvva 128,220,192
  buffer_load_dwordx4 a[48:51], v16, s[20:23], s46 offen offset:0 sc1
 Mvva 132,216,180
 TR 212,32,28608
 Mvva 132,220,196
 Mvva 136,216,184
 TR 214,32,29120
 Mvva 136,220,200
 Mvva 140,216,188
 TR 216,32,19168
 WL 7
 Mvva 140,220,204
  buffer_load_dwordx4 a[52:55], v16, s[20:23], s46 offen offset:2048 sc1
 Mvva 144,224,176
 TR 218,32,19680
 WL 6
 Mvva 144,228,192
 Mvva 148,224,180
 TR 220,32,28640
 Mvva 148,228,196
  buffer_load_dwordx4 a[56:59], v17, s[20:23], s46 offen offset:0 sc1
 Mvva 152,224,184
 TR 222,32,29152
 Mvva 152,228,200
 Mvva 156,224,188
 TR 224,56,18944
 Mvva 156,228,204
 WL 7
 Mvva 160,208,176
 TR 226,56,19456
 WL 6
 Mvva 160,212,192
  buffer_load_dwordx4 a[60:63], v17, s[20:23], s46 offen offset:2048 sc1
 Mvva 164,208,180
 TR 228,56,28416
 Mvva 164,212,196
  s_add_u32 s46, s45, 81920
 Mvva 168,208,184
 TR 230,56,28928
 Mvva 168,212,200
  buffer_load_dwordx4 a[64:67], v16, s[20:23], s46 offen offset:0 sc1
 Mvva 172,208,188
 Mvva 172,212,204
 WL 6
 Mvva 176,216,176
 WL 4
 Mvva 176,220,192
  s_waitcnt vmcnt(27) lgkmcnt(0)
  s_barrier
 Mvva 180,216,180
 TR 208,33,0
 Mvva 180,220,196
 TR 210,33,512
 Mvva 184,216,184
 TR 212,33,9472
 Mvva 184,220,200
 TR 214,33,9984
 Mvva 188,216,188
 TR 216,33,32
 Mvva 188,220,204
  buffer_load_dwordx4 a[68:71], v16, s[20:23], s46 offen offset:2048 sc1
 Mvva 192,224,176
 TR 218,33,544
 Mvva 192,228,192
  buffer_load_dwordx4 a[72:75], v17, s[20:23], s46 offen offset:0 sc1
 Mvva 196,224,180
 TR 220,33,9504
 Mvva 196,228,196
  buffer_store_dword v246, v245, s[20:23], s66 offen sc1
 Mvva 200,224,184
 TR 222,33,10016
 WL 6
 Mvva 200,228,200
  buffer_load_dwordx4 a[76:79], v17, s[20:23], s46 offen offset:2048 sc1
 Mvva 204,224,188
 TR 224,33,64
  s_lshr_b32 s55, s2, 3
 Mvva 204,228,204
  s_add_u32 s46, s45, 90112
  s_lshl_b32 s55, s55, 2
  s_bfe_u32 s65, s4, 0x20001
 Mvva 64,208,144
 TR 226,33,576
  s_add_u32 s55, s55, s65
 WL 6
 Mvva 64,212,160
  buffer_load_dwordx4 a[80:83], v16, s[20:23], s46 offen offset:0 sc1
 Mvva 68,208,148
 TR 228,33,9536
  s_lshl_b32 s55, s55, 4
 Mvva 68,212,164
  s_and_b32 s65, s4, 1
  s_add_u32 s55, s55, s65
  s_mul_i32 s55, s55, 9216
 Mvva 72,208,152
 TR 230,33,10048
  s_add_u32 s55, s55, 0x4500000
 Mvva 72,212,168
  s_and_b32 s65, s4, 7
  s_movk_i32 s50, 8192
  s_movk_i32 s51, 16384
 Mvva 76,208,156
 TR 208,33,96
  s_and_b32 s66, s2, 0xf8
 Mvva 76,212,172
  buffer_load_dwordx4 a[84:87], v16, s[20:23], s46 offen offset:2048 sc1
 WL 7
 Mvva 80,216,144
 TR 210,33,608
  s_lshl_b32 s56, s3, 1
 WL 6
 Mvva 80,220,160
  s_add_u32 s66, s66, s56
  s_lshl_b32 s66, s66, 6
  s_add_u32 s66, s66, s65
 Mvva 84,216,148
 TR 212,33,9568
  s_lshl_b32 s66, s66, 2
 Mvva 84,220,164
  buffer_load_dwordx4 a[88:91], v17, s[20:23], s46 offen offset:0 sc1
 Mvva 88,216,152
 TR 214,33,10080
  s_add_u32 s66, s66, 0x4480020
 Mvva 88,220,168
 WL 6
  v_cmp_gt_u32 vcc, 2, v0
  v_lshlrev_b32 v245, 8, v0
  v_mov_b32 v246, 1
  v_cndmask_b32 v245, -1, v245, vcc
 Mvva 92,216,156
 TR 216,33,128
  s_sub_u32 s56, 15, s5
 Mvva 92,220,172
  s_mov_b32 s44, s25
  s_cmp_lt_u32 s65, 4
  s_cselect_b32 s56, s56, s5
 Mvva 96,224,144
 TR 218,33,640
  s_lshl_b32 s56, s56, 3
 WL 6
 Mvva 96,228,160
  buffer_load_dwordx4 a[92:95], v17, s[20:23], s46 offen offset:2048 sc1
 Mvva 100,224,148
 TR 220,33,9600
  v_add_u32 v9, 4096, v9
 Mvva 100,228,164
  s_add_u32 m0, s47, 88064
  s_bfe_u32 s69, s65, 0x10001
  s_add_u32 s56, s56, s69
 Mvva 104,224,152
 TR 222,33,10112
  s_and_b32 s69, s65, 1
 Mvva 104,228,168
  buffer_load_dwordx4 v1, s[40:43], s44 offen lds
 Mvva 108,224,156
 TR 224,33,160
  s_lshl_b32 s69, s69, 2
 Mvva 108,228,172
  s_add_u32 s56, s56, s69
  s_mul_i32 s56, s56, 18432
  s_lshr_b32 s69, s4, 3
 WL 7
 Mvva 112,208,144
 TR 226,33,672
  s_mul_i32 s31, s69, 224
 WL 6
 Mvva 112,212,160
  s_lshl_b32 s69, s69, 8
  s_add_u32 s56, s56, s69
  s_lshl_b32 s69, s3, 10
 Mvva 116,208,148
 TR 228,33,9632
  v_add_u32 v28, s69, v16
 Mvva 116,212,164
  buffer_load_dwordx4 v2, s[40:43], s44 offen offset:1056 lds
 Mvva 120,208,152
 TR 230,33,10144
  s_lshl_b32 s69, s3, 8
 Mvva 120,212,168
  s_add_u32 s69, s69, 4096
  v_lshl_add_u32 v29, v0, 2, s69
  v_and_b32 v36, 15, v0
 Mvva 124,208,156
 TR 208,33,192
  v_mul_u32_u24 v36, 1152, v36
 Mvva 124,212,172
  buffer_load_dwordx4 v3, s[40:43], s44 offen offset:2112 lds
 WL 7
 Mvva 128,216,144
 TR 210,33,704
  v_lshrrev_b32 v37, 4, v0
 WL 6
 Mvva 128,220,160
  s_lshl_b32 s69, s3, 5
  v_lshl_add_u32 v36, v37, 3, v36
  v_add_u32 v30, s69, v36
 Mvva 132,216,148
 TR 212,33,9664
  v_lshrrev_b32 v36, 2, v0
 Mvva 132,220,164
  v_bfe_u32 v37, v0, 1, 1
  v_lshl_add_u32 v36, v37, 5, v36
 Mvva 136,216,152
 TR 214,33,10176
  v_mul_u32_u24 v36, 1152, v36
 Mvva 136,220,168
  buffer_load_dwordx4 v4, s[40:43], s44 offen offset:3168 lds
 Mvva 140,216,156
 TR 216,33,224
  v_and_b32 v37, 1, v0
 Mvva 140,220,172
  s_add_u32 m0, s47, 92288
  s_lshl_b32 s69, s3, 3
  v_lshl_add_u32 v36, v37, 2, v36
 WL 7
 Mvva 144,224,144
 TR 218,33,736
  s_add_u32 s69, s69, 1024
 WL 6
 Mvva 144,228,160
  buffer_load_dwordx4 v5, s[40:43], s44 offen lds
 Mvva 148,224,148
 TR 220,33,9696
  s_sub_u32 s69, s69, s31
 Mvva 148,228,164
  s_mov_b32 s57, 0xffff
  v_add_u32 v31, s69, v36
  s_add_u32 s69, s56, 36864
 Mvva 152,224,152
 TR 222,33,10208
 WL 6
 Mvva 152,228,168
  buffer_store_dword v246, v245, s[20:23], s66 offen sc1
 Mvva 156,224,156
 TR 224,57,0
  v_and_b32 v247, 3, v0
 Mvva 156,228,172
  buffer_load_dwordx4 v6, s[40:43], s44 offen offset:1056 lds
 Mvva 160,208,144
 TR 226,57,512
  v_lshlrev_b32 v247, 2, v247
 WL 6
 Mvva 160,212,160
  buffer_load_dword v248, v247, s[20:23], s54 offen offset:16 sc1
 Mvva 164,208,148
 TR 228,57,9472
 Mvva 164,212,164
  buffer_load_dwordx4 v7, s[40:43], s44 offen offset:2112 lds
 Mvva 168,208,152
 TR 230,57,9984
 Mvva 168,212,168
 Mvva 172,208,156
 TR 208,33,18944
 Mvva 172,212,172
 WL 7
 Mvva 176,216,144
 TR 210,33,19456
 WL 6
 Mvva 176,220,160
  buffer_load_dwordx4 v8, s[40:43], s44 offen offset:3168 lds
 Mvva 180,216,148
 TR 212,33,28416
 Mvva 180,220,164
  s_add_u32 m0, s47, 96512
 Mvva 184,216,152
 TR 214,33,28928
 Mvva 184,220,168
  buffer_load_dwordx4 v9, s[20:23], s44 offen sc1 lds
 Mvva 188,216,156
 TR 216,33,18976
  s_add_u32 s44, s44, 1179648
 Mvva 188,220,172
 WL 7
 WL 5
 Mvva 192,224,144
 TR 218,33,19488
  s_add_u32 m0, s47, 12288
 Mvva 192,228,160
 Mvva 196,224,148
 TR 220,33,28448
 Mvva 196,228,164
  buffer_load_dwordx4 v1, s[40:43], s44 offen lds
 Mvva 200,224,152
 TR 222,33,28960
  s_waitcnt vmcnt(38)
 Mvva 200,228,168
 Mvva 204,224,156
 TR 224,33,19008
 WL 7
 Mvva 204,228,172
  buffer_load_dwordx4 v2, s[40:43], s44 offen offset:1056 lds
 Mvva 64,208,0
 TR 226,33,19520
 WL 6
 Mvva 64,212,16
 Mvva 68,208,4
 TR 228,33,28480
 Mvva 68,212,20
 Mvva 72,208,8
 TR 230,33,28992
 Mvva 72,212,24
  buffer_load_dwordx4 v3, s[40:43], s44 offen offset:2112 lds
 Mvva 76,208,12
 TR 208,33,19040
 Mvva 76,212,28
 WL 7
 Mvva 80,216,0
 TR 210,33,19552
 WL 6
 Mvva 80,220,16
  buffer_load_dwordx4 v4, s[40:43], s44 offen offset:3168 lds
 Mvva 84,216,4
 TR 212,33,28512
 Mvva 84,220,20
 Mvva 88,216,8
 TR 214,33,29024
  s_add_u32 m0, s47, 16512
 Mvva 88,220,24
 Mvva 92,216,12
 TR 216,33,19072
 WL 7
 Mvva 92,220,28
  buffer_load_dwordx4 v5, s[40:43], s44 offen lds
 Mvva 96,224,0
 TR 218,33,19584
 WL 6
 Mvva 96,228,16
 Mvva 100,224,4
 TR 220,33,28544
 Mvva 100,228,20
  buffer_load_dwordx4 v6, s[40:43], s44 offen offset:1056 lds
 Mvva 104,224,8
 TR 222,33,29056
 Mvva 104,228,24
 Mvva 108,224,12
 TR 224,33,19104
 Mvva 108,228,28
 WL 7
 Mvva 112,208,0
 TR 226,33,19616
 WL 6
 Mvva 112,212,16
  buffer_load_dwordx4 v7, s[40:43], s44 offen offset:2112 lds
 Mvva 116,208,4
 TR 228,33,28576
 Mvva 116,212,20
 Mvva 120,208,8
 TR 230,33,29088
 Mvva 120,212,24
  buffer_load_dwordx4 v8, s[40:43], s44 offen offset:3168 lds
 Mvva 124,208,12
 TR 208,33,19136
 Mvva 124,212,28
 WL 7
 WL 5
 Mvva 128,216,0
 TR 210,33,19648
  s_add_u32 m0, s47, 20736
 Mvva 128,220,16
 Mvva 132,216,4
 TR 212,33,28608
 Mvva 132,220,20
  buffer_load_dwordx4 v9, s[20:23], s44 offen sc1 lds
 Mvva 136,216,8
 TR 214,33,29120
 Mvva 136,220,24
  global_load_dword a248, v249, s[100:101]
 Mvva 140,216,12
 TR 216,33,19168
 Mvva 140,220,28
 WL 7
 Mvva 144,224,0
 TR 218,33,19680
 WL 6
 Mvva 144,228,16
 Mvva 148,224,4
 TR 220,33,28640
 Mvva 148,228,20
 Mvva 152,224,8
 TR 222,33,29152
 Mvva 152,228,24
 Mvva 156,224,12
 TR 224,57,18944
 Mvva 156,228,28
 WL 7
 Mvva 160,208,0
 TR 226,57,19456
 WL 6
 Mvva 160,212,16
 Mvva 164,208,4
 TR 228,57,28416
 Mvva 164,212,20
 Mvva 168,208,8
 TR 230,57,28928
 Mvva 168,212,24
 Mvva 172,208,12
 Mvva 172,212,28
 WL 6
 Mvva 176,216,0
 WL 4
 Mvva 176,220,16
 WL 0
  s_waitcnt vmcnt(38)
  s_barrier
 Mvva 180,216,4
 TR 208,34,0
  s_add_u32 s44, s44, 1179648
 Mvva 180,220,20
 TR 210,34,512
  s_add_u32 m0, s47, 125952
 Mvva 184,216,8
 TR 212,34,9472
 Mvva 184,220,24
 TR 214,34,9984
 Mvva 188,216,12
 TR 216,34,32
 Mvva 188,220,28
  buffer_load_dwordx4 v1, s[40:43], s44 offen lds
 Mvva 192,224,0
 TR 218,34,544
 Mvva 192,228,16
  s_waitcnt vmcnt(14)
  v_cmp_gt_u32 vcc, 1, v248
  s_nop 4
  s_cbranch_vccnz Lpoll_ctx_6
Lback_ctx_6:
 Mvva 196,224,4
 TR 220,34,9504
  s_add_u32 s46, s24, 0
 Mvva 196,228,20
  buffer_load_dwordx4 a[96:99], v16, s[20:23], s46 offen offset:0 sc1
 Mvva 200,224,8
 TR 222,34,10016
 Mvva 200,228,24
  buffer_load_dwordx4 a[100:103], v16, s[20:23], s46 offen offset:2048 sc1
 Mvva 204,224,12
 TR 224,34,64
 Mvva 204,228,28
 WL 7
 Mvva 64,208,32
 TR 226,34,576
 WL 6
 Mvva 64,212,48
 Mvva 68,208,36
 TR 228,34,9536
 Mvva 68,212,52
  buffer_load_dwordx4 a[104:107], v17, s[20:23], s46 offen offset:0 sc1
 Mvva 72,208,40
 TR 230,34,10048
 Mvva 72,212,56
 Mvva 76,208,44
 TR 208,34,96
 WL 7
 Mvva 76,212,60
  buffer_load_dwordx4 a[108:111], v17, s[20:23], s46 offen offset:2048 sc1
 Mvva 80,216,32
 TR 210,34,608
 WL 6
 Mvva 80,220,48
 Mvva 84,216,36
 TR 212,34,9568
  s_add_u32 s46, s24, 8192
 Mvva 84,220,52
 Mvva 88,216,40
 TR 214,34,10080
 Mvva 88,220,56
  buffer_load_dwordx4 a[112:115], v16, s[20:23], s46 offen offset:0 sc1
 Mvva 92,216,44
 TR 216,34,128
 Mvva 92,220,60
 WL 7
 Mvva 96,224,32
 TR 218,34,640
 WL 6
 Mvva 96,228,48
  buffer_load_dwordx4 a[116:119], v16, s[20:23], s46 offen offset:2048 sc1
 Mvva 100,224,36
 TR 220,34,9600
 Mvva 100,228,52
 Mvva 104,224,40
 TR 222,34,10112
 Mvva 104,228,56
 Mvva 108,224,44
 TR 224,34,160
 WL 7
 Mvva 108,228,60
  buffer_load_dwordx4 a[120:123], v17, s[20:23], s46 offen offset:0 sc1
 Mvva 112,208,32
 TR 226,34,672
 WL 6
 Mvva 112,212,48
 Mvva 116,208,36
 TR 228,34,9632
 Mvva 116,212,52
  buffer_load_dwordx4 a[124:127], v17, s[20:23], s46 offen offset:2048 sc1
 Mvva 120,208,40
 TR 230,34,10144
 Mvva 120,212,56
 Mvva 124,208,44
 TR 208,34,192
  s_add_u32 s46, s24, 16384
 Mvva 124,212,60
 WL 7
 Mvva 128,216,32
 TR 210,34,704
 WL 6
 Mvva 128,220,48
  buffer_load_dwordx4 a[128:131], v16, s[20:23], s46 offen offset:0 sc1
 Mvva 132,216,36
 TR 212,34,9664
 Mvva 132,220,52
 Mvva 136,216,40
 TR 214,34,10176
 Mvva 136,220,56
  buffer_load_dwordx4 a[132:135], v16, s[20:23], s46 offen offset:2048 sc1
 Mvva 140,216,44
 TR 216,34,224
 Mvva 140,220,60
 WL 7
 Mvva 144,224,32
 TR 218,34,736
 WL 6
 Mvva 144,228,48
 Mvva 148,224,36
 TR 220,34,9696
 Mvva 148,228,52
  buffer_load_dwordx4 a[136:139], v17, s[20:23], s46 offen offset:0 sc1
 Mvva 152,224,40
 TR 222,34,10208
 Mvva 152,228,56
 Mvva 156,224,44
 TR 224,58,0
 WL 7
 Mvva 156,228,60
  buffer_load_dwordx4 a[140:143], v17, s[20:23], s46 offen offset:2048 sc1
 Mvva 160,208,32
 TR 226,58,512
 WL 6
 Mvva 160,212,48
 Mvva 164,208,36
 TR 228,58,9472
  s_add_u32 s46, s24, 24576
 Mvva 164,212,52
 Mvva 168,208,40
 TR 230,58,9984
 Mvva 168,212,56
  buffer_load_dwordx4 v[40:43], v16, s[20:23], s46 offen offset:0 sc1
 Mvva 172,208,44
 TR 208,34,18944
 Mvva 172,212,60
 WL 7
 Mvva 176,216,32
 TR 210,34,19456
 WL 6
 Mvva 176,220,48
  buffer_load_dwordx4 v[44:47], v16, s[20:23], s46 offen offset:2048 sc1
 Mvva 180,216,36
 TR 212,34,28416
 Mvva 180,220,52
 Mvva 184,216,40
 TR 214,34,28928
 Mvva 184,220,56
 Mvva 188,216,44
 TR 216,34,18976
 WL 7
 Mvva 188,220,60
  buffer_load_dwordx4 v[48:51], v17, s[20:23], s46 offen offset:0 sc1
 Mvva 192,224,32
 TR 218,34,19488
 WL 6
 Mvva 192,228,48
 Mvva 196,224,36
 TR 220,34,28448
 Mvva 196,228,52
  buffer_load_dwordx4 v[52:55], v17, s[20:23], s46 offen offset:2048 sc1
 Mvva 200,224,40
 TR 222,34,28960
 Mvva 200,228,56
 Mvva 204,224,44
 TR 224,34,19008
  s_add_u32 s46, s24, 32768
 Mvva 204,228,60
 WL 7
 Mvva 64,208,64
 TR 226,34,19520
 WL 6
 Mvva 64,212,80
  buffer_load_dwordx4 a[212:215], v16, s[20:23], s46 offen offset:0 sc1
 Mvva 68,208,68
 TR 228,34,28480
 Mvva 68,212,84
 Mvva 72,208,72
 TR 230,34,28992
 Mvva 72,212,88
  buffer_load_dwordx4 a[216:219], v16, s[20:23], s46 offen offset:2048 sc1
 Mvva 76,208,76
 TR 208,34,19040
 Mvva 76,212,92
 WL 7
 Mvva 80,216,64
 TR 210,34,19552
 WL 6
 Mvva 80,220,80
 Mvva 84,216,68
 TR 212,34,28512
 Mvva 84,220,84
  buffer_load_dwordx4 a[220:223], v17, s[20:23], s46 offen offset:0 sc1
 Mvva 88,216,72
 TR 214,34,29024
 Mvva 88,220,88
 Mvva 92,216,76
 TR 216,34,19072
 WL 7
 Mvva 92,220,92
  buffer_load_dwordx4 a[224:227], v17, s[20:23], s46 offen offset:2048 sc1
 Mvva 96,224,64
 TR 218,34,19584
 WL 6
 Mvva 96,228,80
 Mvva 100,224,68
 TR 220,34,28544
  s_add_u32 s46, s24, 40960
 Mvva 100,228,84
 Mvva 104,224,72
 TR 222,34,29056
 Mvva 104,228,88
  buffer_load_dwordx4 a[228:231], v16, s[20:23], s46 offen offset:0 sc1
 Mvva 108,224,76
 TR 224,34,19104
 Mvva 108,228,92
 WL 7
 Mvva 112,208,64
 TR 226,34,19616
 WL 6
 Mvva 112,212,80
  buffer_load_dwordx4 a[232:235], v16, s[20:23], s46 offen offset:2048 sc1
 Mvva 116,208,68
 TR 228,34,28576
 Mvva 116,212,84
 Mvva 120,208,72
 TR 230,34,29088
 Mvva 120,212,88
 Mvva 124,208,76
 TR 208,34,19136
 WL 7
 Mvva 124,212,92
  buffer_load_dwordx4 a[236:239], v17, s[20:23], s46 offen offset:0 sc1
 Mvva 128,216,64
 TR 210,34,19648
 WL 6
 Mvva 128,220,80
 Mvva 132,216,68
 TR 212,34,28608
 Mvva 132,220,84
  buffer_load_dwordx4 a[240:243], v17, s[20:23], s46 offen offset:2048 sc1
 Mvva 136,216,72
 TR 214,34,29120
 Mvva 136,220,88
 Mvva 140,216,76
 TR 216,34,19168
  s_add_u32 s46, s24, 49152
 Mvva 140,220,92
 WL 7
 Mvva 144,224,64
 TR 218,34,19680
 WL 6
 Mvva 144,228,80
  buffer_load_dwordx4 a[176:179], v16, s[20:23], s46 offen offset:0 sc1
 Mvva 148,224,68
 TR 220,34,28640
 Mvva 148,228,84
 Mvva 152,224,72
 TR 222,34,29152
 Mvva 152,228,88
  buffer_load_dwordx4 a[180:183], v16, s[20:23], s46 offen offset:2048 sc1
 Mvva 156,224,76
 TR 224,58,18944
 Mvva 156,228,92
 WL 7
 Mvva 160,208,64
 TR 226,58,19456
 WL 6
 Mvva 160,212,80
 Mvva 164,208,68
 TR 228,58,28416
 Mvva 164,212,84
  buffer_load_dwordx4 a[184:187], v17, s[20:23], s46 offen offset:0 sc1
 Mvva 168,208,72
 TR 230,58,28928
 Mvva 168,212,88
 Mvva 172,208,76
 WL 6
 Mvva 172,212,92
  buffer_load_dwordx4 a[188:191], v17, s[20:23], s46 offen offset:2048 sc1
 Mvva 176,216,64
 WL 4
 Mvva 176,220,80
 WL 0
  s_waitcnt vmcnt(39)
  s_barrier
 Mvva 180,216,68
 TR 208,35,0
  s_add_u32 s46, s24, 57344
 Mvva 180,220,84
 TR 210,35,512
 Mvva 184,216,72
 TR 212,35,9472
 Mvva 184,220,88
 TR 214,35,9984
 Mvva 188,216,76
 TR 216,35,32
 Mvva 188,220,92
  buffer_load_dwordx4 a[192:195], v16, s[20:23], s46 offen offset:0 sc1
 Mvva 192,224,64
 TR 218,35,544
 Mvva 192,228,80
  buffer_load_dwordx4 a[196:199], v16, s[20:23], s46 offen offset:2048 sc1
 Mvva 196,224,68
 TR 220,35,9504
 Mvva 196,228,84
 Mvva 200,224,72
 TR 222,35,10016
  s_waitcnt vmcnt(22)
 Mvva 200,228,88
 Mvva 204,224,76
 TR 224,35,64
 WL 7
 Mvva 204,228,92
  buffer_load_dwordx4 a[200:203], v17, s[20:23], s46 offen offset:0 sc1
 Mvva 64,208,96
 TR 226,35,576
 WL 6
 Mvva 64,212,112
 Mvva 68,208,100
 TR 228,35,9536
 Mvva 68,212,116
  buffer_load_dwordx4 a[204:207], v17, s[20:23], s46 offen offset:2048 sc1
 Mvva 72,208,104
 TR 230,35,10048
 Mvva 72,212,120
 Mvva 76,208,108
 TR 208,35,96
 Mvva 76,212,124
 WL 7
 Mvva 80,216,96
 TR 210,35,608
 WL 6
 Mvva 80,220,112
  buffer_load_dwordx4 v2, s[40:43], s44 offen offset:1056 lds
 Mvva 84,216,100
 TR 212,35,9568
 Mvva 84,220,116
 Mvva 88,216,104
 TR 214,35,10080
 Mvva 88,220,120
  buffer_load_dwordx4 v3, s[40:43], s44 offen offset:2112 lds
 Mvva 92,216,108
 TR 216,35,128
 Mvva 92,220,124
 WL 7
 Mvva 96,224,96
 TR 218,35,640
 WL 6
 Mvva 96,228,112
 Mvva 100,224,100
 TR 220,35,9600
 Mvva 100,228,116
  buffer_load_dwordx4 v4, s[40:43], s44 offen offset:3168 lds
 Mvva 104,224,104
 TR 222,35,10112
 Mvva 104,228,120
  s_add_u32 m0, s47, 130176
 Mvva 108,224,108
 TR 224,35,160
 WL 7
 Mvva 108,228,124
  buffer_load_dwordx4 v5, s[40:43], s44 offen lds
 Mvva 112,208,96
 TR 226,35,672
 WL 6
 Mvva 112,212,112
 Mvva 116,208,100
 TR 228,35,9632
 Mvva 116,212,116
 Mvva 120,208,104
 TR 230,35,10144
 Mvva 120,212,120
  buffer_load_dwordx4 v6, s[40:43], s44 offen offset:1056 lds
 Mvva 124,208,108
 TR 208,35,192
 Mvva 124,212,124
 WL 7
 Mvva 128,216,96
 TR 210,35,704
 WL 6
 Mvva 128,220,112
  buffer_load_dwordx4 v7, s[40:43], s44 offen offset:2112 lds
 Mvva 132,216,100
 TR 212,35,9664
 Mvva 132,220,116
 Mvva 136,216,104
 TR 214,35,10176
 Mvva 136,220,120
 Mvva 140,216,108
 TR 216,35,224
 WL 7
 Mvva 140,220,124
  buffer_load_dwordx4 v8, s[40:43], s44 offen offset:3168 lds
 Mvva 144,224,96
 TR 218,35,736
 WL 6
 Mvva 144,228,112
  s_add_u32 m0, s47, 134400
 Mvva 148,224,100
 TR 220,35,9696
 Mvva 148,228,116
  buffer_load_dwordx4 v9, s[20:23], s44 offen sc1 lds
 Mvva 152,224,104
 TR 222,35,10208
 Mvva 152,228,120
 Mvva 156,224,108
 TR 224,59,0
  s_add_u32 s46, s24, 65536
 Mvva 156,228,124
 WL 7
 Mvva 160,208,96
 TR 226,59,512
 WL 6
 Mvva 160,212,112
  buffer_load_dwordx4 a[144:147], v16, s[20:23], s46 offen offset:0 sc1
 Mvva 164,208,100
 TR 228,59,9472
 Mvva 164,212,116
 Mvva 168,208,104
 TR 230,59,9984
 Mvva 168,212,120
  buffer_load_dwordx4 a[148:151], v16, s[20:23], s46 offen offset:2048 sc1
 Mvva 172,208,108
 TR 208,35,18944
 Mvva 172,212,124
 WL 7
 Mvva 176,216,96
 TR 210,35,19456
 WL 6
 Mvva 176,220,112
 Mvva 180,216,100
 TR 212,35,28416
 Mvva 180,220,116
  buffer_load_dwordx4 a[152:155], v17, s[20:23], s46 offen offset:0 sc1
 Mvva 184,216,104
 TR 214,35,28928
 Mvva 184,220,120
 Mvva 188,216,108
 TR 216,35,18976
 WL 7
 Mvva 188,220,124
  buffer_load_dwordx4 a[156:159], v17, s[20:23], s46 offen offset:2048 sc1
 Mvva 192,224,96
 TR 218,35,19488
 WL 6
 Mvva 192,228,112
 Mvva 196,224,100
 TR 220,35,28448
  s_add_u32 s46, s24, 73728
 Mvva 196,228,116
 Mvva 200,224,104
 TR 222,35,28960
  s_waitcnt vmcnt(28)
 Mvva 200,228,120
  buffer_load_dwordx4 a[160:163], v16, s[20:23], s46 offen offset:0 sc1
 Mvva 204,224,108
 TR 224,35,19008
 Mvva 204,228,124
 WL 7
 Mvva 64,208,128
 TR 226,35,19520
 WL 6
 Mvvv 64,212,40
  buffer_load_dwordx4 a[164:167], v16, s[20:23], s46 offen offset:2048 sc1
 Mvva 68,208,132
 TR 228,35,28480
 Mvvv 68,212,44
  global_load_dword a248, v249, s[100:101]
 Mvva 72,208,136
 TR 230,35,28992
 Mvvv 72,212,48
 Mvva 76,208,140
 TR 208,35,19040
 WL 7
 Mvvv 76,212,52
  buffer_load_dwordx4 a[168:171], v17, s[20:23], s46 offen offset:0 sc1
 Mvva 80,216,128
 TR 210,35,19552
 WL 6
 Mvvv 80,220,40
 Mvva 84,216,132
 TR 212,35,28512
 Mvvv 84,220,44
  buffer_load_dwordx4 a[172:175], v17, s[20:23], s46 offen offset:2048 sc1
 Mvva 88,216,136
 TR 214,35,29024
  s_add_u32 s44, s44, 1179648
 Mvvv 88,220,48
 Mvva 92,216,140
 TR 216,35,19072
  s_add_u32 m0, s47, 50176
 Mvvv 92,220,52
 WL 7
 Mvva 96,224,128
 TR 218,35,19584
 WL 6
 Mvvv 96,228,40
  buffer_load_dwordx4 v1, s[40:43], s44 offen lds
 Mvva 100,224,132
 TR 220,35,28544
 Mvvv 100,228,44
 Mvva 104,224,136
 TR 222,35,29056
 Mvvv 104,228,48
  buffer_load_dwordx4 v2, s[40:43], s44 offen offset:1056 lds
 Mvva 108,224,140
 TR 224,35,19104
 Mvvv 108,228,52
 WL 7
 Mvva 112,208,128
 TR 226,35,19616
 WL 6
 Mvvv 112,212,40
 Mvva 116,208,132
 TR 228,35,28576
 Mvvv 116,212,44
  buffer_load_dwordx4 v3, s[40:43], s44 offen offset:2112 lds
 Mvva 120,208,136
 TR 230,35,29088
 Mvvv 120,212,48
 Mvva 124,208,140
 TR 208,35,19136
 WL 7
 Mvvv 124,212,52
  buffer_load_dwordx4 v4, s[40:43], s44 offen offset:3168 lds
 Mvva 128,216,128
 TR 210,35,19648
 WL 6
 Mvvv 128,220,40
 Mvva 132,216,132
 TR 212,35,28608
  s_add_u32 m0, s47, 54400
 Mvvv 132,220,44
 Mvva 136,216,136
 TR 214,35,29120
 Mvvv 136,220,48
  buffer_load_dwordx4 v5, s[40:43], s44 offen lds
 Mvva 140,216,140
 TR 216,35,19168
 Mvvv 140,220,52
 WL 7
 Mvva 144,224,128
 TR 218,35,19680
 WL 6
 Mvvv 144,228,40
  buffer_load_dwordx4 v6, s[40:43], s44 offen offset:1056 lds
 Mvva 148,224,132
 TR 220,35,28640
 Mvvv 148,228,44
 Mvva 152,224,136
 TR 222,35,29152
 Mvvv 152,228,48
 Mvva 156,224,140
 TR 224,59,18944
 WL 7
 Mvvv 156,228,52
  buffer_load_dwordx4 v7, s[40:43], s44 offen offset:2112 lds
 Mvva 160,208,128
 TR 226,59,19456
 WL 6
 Mvvv 160,212,40
 Mvva 164,208,132
 TR 228,59,28416
 Mvvv 164,212,44
  buffer_load_dwordx4 v8, s[40:43], s44 offen offset:3168 lds
 Mvva 168,208,136
 TR 230,59,28928
 Mvvv 168,212,48
 Mvva 172,208,140
  s_add_u32 m0, s47, 58624
 Mvvv 172,212,52
 WL 6
 WL 4
 Mvva 176,216,128
  buffer_load_dwordx4 v9, s[20:23], s44 offen sc1 lds
 Mvvv 176,220,40
 WL 0
  s_barrier
 Mvva 180,216,132
 TR 208,32,0
 Mvvv 180,220,44
 TR 210,32,512
  s_add_u32 s46, s24, 81920
 Mvva 184,216,136
 TR 212,32,9472
 Mvvv 184,220,48
 TR 214,32,9984
 Mvva 188,216,140
 TR 216,32,32
 Mvvv 188,220,52
  buffer_load_dwordx4 a[0:3], v16, s[20:23], s46 offen offset:0 sc1
 Mvva 192,224,128
 TR 218,32,544
 Mvvv 192,228,40
 Mvva 196,224,132
 TR 220,32,9504
 Mvvv 196,228,44
  buffer_load_dwordx4 a[4:7], v16, s[20:23], s46 offen offset:2048 sc1
 Mvva 200,224,136
 TR 222,32,10016
  s_waitcnt vmcnt(36)
 Mvvv 200,228,48
 Mvva 204,224,140
 TR 224,32,64
 WL 7
 Mvvv 204,228,52
  buffer_load_dwordx4 a[8:11], v17, s[20:23], s46 offen offset:0 sc1
 Mvva 64,208,212
 TR 226,32,576
 WL 6
 Mvva 64,212,228
 Mvva 68,208,216
 TR 228,32,9536
 Mvva 68,212,232
 Mvva 72,208,220
 TR 230,32,10048
 Mvva 72,212,236
  buffer_load_dwordx4 a[12:15], v17, s[20:23], s46 offen offset:2048 sc1
 Mvva 76,208,224
 TR 208,32,96
 Mvva 76,212,240
  s_add_u32 s46, s24, 90112
 WL 7
 Mvva 80,216,212
 TR 210,32,608
 WL 6
 Mvva 80,220,228
  buffer_load_dwordx4 a[16:19], v16, s[20:23], s46 offen offset:0 sc1
 Mvva 84,216,216
 TR 212,32,9568
 Mvva 84,220,232
 Mvva 88,216,220
 TR 214,32,10080
 Mvva 88,220,236
 Mvva 92,216,224
 TR 216,32,128
 WL 7
 Mvva 92,220,240
  buffer_load_dwordx4 a[20:23], v16, s[20:23], s46 offen offset:2048 sc1
 Mvva 96,224,212
 TR 218,32,640
 WL 6
 Mvva 96,228,228
 Mvva 100,224,216
 TR 220,32,9600
 Mvva 100,228,232
  buffer_load_dwordx4 a[24:27], v17, s[20:23], s46 offen offset:0 sc1
 Mvva 104,224,220
 TR 222,32,10112
 Mvva 104,228,236
 Mvva 108,224,224
 TR 224,32,160
 Mvva 108,228,240
 WL 7
 Mvva 112,208,212
 TR 226,32,672
 WL 6
 Mvva 112,212,228
  buffer_load_dwordx4 a[28:31], v17, s[20:23], s46 offen offset:2048 sc1
 Mvva 116,208,216
 TR 228,32,9632
 Mvva 116,212,232
  s_add_u32 s46, s24, 98304
 Mvva 120,208,220
 TR 230,32,10144
 Mvva 120,212,236
  buffer_load_dwordx4 a[32:35], v16, s[20:23], s46 offen offset:0 sc1
 Mvva 124,208,224
 TR 208,32,192
 Mvva 124,212,240
 WL 7
 Mvva 128,216,212
 TR 210,32,704
 WL 6
 Mvva 128,220,228
 Mvva 132,216,216
 TR 212,32,9664
 Mvva 132,220,232
  buffer_load_dwordx4 a[36:39], v16, s[20:23], s46 offen offset:2048 sc1
 Mvva 136,216,220
 TR 214,32,10176
 Mvva 136,220,236
 Mvva 140,216,224
 TR 216,32,224
 WL 7
 Mvva 140,220,240
  buffer_load_dwordx4 a[40:43], v17, s[20:23], s46 offen offset:0 sc1
 Mvva 144,224,212
 TR 218,32,736
 WL 6
 Mvva 144,228,228
 Mvva 148,224,216
 TR 220,32,9696
 Mvva 148,228,232
 Mvva 152,224,220
 TR 222,32,10208
 Mvva 152,228,236
  buffer_load_dwordx4 a[44:47], v17, s[20:23], s46 offen offset:2048 sc1
 Mvva 156,224,224
 TR 224,56,0
 Mvva 156,228,240
  s_add_u32 s46, s24, 106496
 WL 7
 Mvva 160,208,212
 TR 226,56,512
 WL 6
 Mvva 160,212,228
  buffer_load_dwordx4 a[48:51], v16, s[20:23], s46 offen offset:0 sc1
 Mvva 164,208,216
 TR 228,56,9472
 Mvva 164,212,232
 Mvva 168,208,220
 TR 230,56,9984
 Mvva 168,212,236
 Mvva 172,208,224
 TR 208,32,18944
 WL 7
 Mvva 172,212,240
  buffer_load_dwordx4 a[52:55], v16, s[20:23], s46 offen offset:2048 sc1
 Mvva 176,216,212
 TR 210,32,19456
 WL 6
 Mvva 176,220,228
 Mvva 180,216,216
 TR 212,32,28416
 Mvva 180,220,232
  buffer_load_dwordx4 a[56:59], v17, s[20:23], s46 offen offset:0 sc1
 Mvva 184,216,220
 TR 214,32,28928
 Mvva 184,220,236
 Mvva 188,216,224
 TR 216,32,18976
 Mvva 188,220,240
 WL 7
 Mvva 192,224,212
 TR 218,32,19488
 WL 6
 Mvva 192,228,228
  buffer_load_dwordx4 a[60:63], v17, s[20:23], s46 offen offset:2048 sc1
 Mvva 196,224,216
 TR 220,32,28448
 Mvva 196,228,232
  s_add_u32 s46, s24, 114688
 Mvva 200,224,220
 TR 222,32,28960
  s_waitcnt vmcnt(42)
 Mvva 200,228,236
  buffer_load_dwordx4 a[64:67], v16, s[20:23], s46 offen offset:0 sc1
 Mvva 204,224,224
 TR 224,32,19008
 Mvva 204,228,240
 WL 7
 Mvva 64,208,176
 TR 226,32,19520
 WL 6
 Mvva 64,212,192
 Mvva 68,208,180
 TR 228,32,28480
 Mvva 68,212,196
  buffer_load_dwordx4 a[68:71], v16, s[20:23], s46 offen offset:2048 sc1
 Mvva 72,208,184
 TR 230,32,28992
 Mvva 72,212,200
 Mvva 76,208,188
 TR 208,32,19040
 WL 7
 Mvva 76,212,204
  buffer_load_dwordx4 a[72:75], v17, s[20:23], s46 offen offset:0 sc1
 Mvva 80,216,176
 TR 210,32,19552
 WL 6
 Mvva 80,220,192
 Mvva 84,216,180
 TR 212,32,28512
 Mvva 84,220,196
 Mvva 88,216,184
 TR 214,32,29024
 Mvva 88,220,200
  buffer_load_dwordx4 a[76:79], v17, s[20:23], s46 offen offset:2048 sc1
 Mvva 92,216,188
 TR 216,32,19072
 Mvva 92,220,204
  s_add_u32 s46, s24, 122880
 WL 7
 Mvva 96,224,176
 TR 218,32,19584
 WL 6
 Mvva 96,228,192
  buffer_load_dwordx4 a[80:83], v16, s[20:23], s46 offen offset:0 sc1
 Mvva 100,224,180
 TR 220,32,28544
 Mvva 100,228,196
 Mvva 104,224,184
 TR 222,32,29056
 Mvva 104,228,200
 Mvva 108,224,188
 TR 224,32,19104
 WL 7
 Mvva 108,228,204
  buffer_load_dwordx4 a[84:87], v16, s[20:23], s46 offen offset:2048 sc1
 Mvva 112,208,176
 TR 226,32,19616
 WL 6
 Mvva 112,212,192
 Mvva 116,208,180
 TR 228,32,28576
 Mvva 116,212,196
  buffer_load_dwordx4 a[88:91], v17, s[20:23], s46 offen offset:0 sc1
 Mvva 120,208,184
 TR 230,32,29088
 Mvva 120,212,200
 Mvva 124,208,188
 TR 208,32,19136
 Mvva 124,212,204
 WL 7
 Mvva 128,216,176
 TR 210,32,19648
 WL 6
 Mvva 128,220,192
  buffer_load_dwordx4 a[92:95], v17, s[20:23], s46 offen offset:2048 sc1
 Mvva 132,216,180
 TR 212,32,28608
 Mvva 132,220,196
 Mvva 136,216,184
 TR 214,32,29120
 Mvva 136,220,200
 Mvva 140,216,188
 TR 216,32,19168
 Mvva 140,220,204
 WL 7
 Mvva 144,224,176
 TR 218,32,19680
 WL 6
 Mvva 144,228,192
 Mvva 148,224,180
 TR 220,32,28640
 Mvva 148,228,196
 Mvva 152,224,184
 TR 222,32,29152
 Mvva 152,228,200
 Mvva 156,224,188
 TR 224,56,18944
 Mvva 156,228,204
 WL 7
 Mvva 160,208,176
 TR 226,56,19456
 WL 6
 Mvva 160,212,192
 Mvva 164,208,180
 TR 228,56,28416
 Mvva 164,212,196
 Mvva 168,208,184
 TR 230,56,28928
 Mvva 168,212,200
 Mvva 172,208,188
 Mvva 172,212,204
 WL 6
 Mvva 176,216,176
 WL 4
 Mvva 176,220,192
 WL 0
  s_waitcnt vmcnt(42)
  s_barrier
 Mvva 180,216,180
 TR 208,33,0
 Mvva 180,220,196
 TR 210,33,512
 Mvva 184,216,184
 TR 212,33,9472
  v_mov_b32 v246, 2
 Mvva 184,220,200
 TR 214,33,9984
 Mvva 188,216,188
 TR 216,33,18944
 Mvva 188,220,204
  global_load_dword a248, v249, s[100:101]
 Mvva 192,224,176
 TR 218,33,19456
 Mvva 192,228,192
 Mvva 196,224,180
 TR 220,33,28416
 Mvva 196,228,196
 Mvva 200,224,184
 TR 222,33,28928
  s_waitcnt vmcnt(34)
 Mvva 200,228,200
 Mvva 204,224,188
 Mvva 204,228,204
 WL 6
 Mvva 64,208,144
 WL 4
 Mvva 64,212,160
 WL 0
  s_waitcnt vmcnt(25)
  s_barrier
 Mvva 68,208,148
 TR 224,34,0
 Mvva 68,212,164
 TR 226,34,512
 Mvva 72,208,152
 TR 228,34,9472
  s_waitcnt vmcnt(17)
 Mvva 72,212,168
 TR 230,34,9984
 Mvva 76,208,156
 TR 208,34,18944
 Mvva 76,212,172
 Mvva 64,216,0
 TR 210,34,19456
 Mvva 64,220,16
 Mvva 68,216,4
 TR 212,34,28416
 Mvva 68,220,20
 Mvva 72,216,8
 TR 214,34,28928
  s_waitcnt vmcnt(9)
 Mvva 72,220,24
 Mvva 76,216,12
 TR 216,33,32
 Mvva 76,220,28
 WL 7
 Mvva 64,224,32
 TR 218,33,544
 WL 6
 Mvva 64,228,48
 Mvva 68,224,36
 TR 220,33,9504
 Mvva 68,228,52
 Mvva 72,224,40
 TR 222,33,10016
  s_waitcnt vmcnt(1)
 Mvva 72,228,56
 Mvva 76,224,44
 TR 224,33,18976
 Mvva 76,228,60
 WL 7
 Mvva 64,208,64
 TR 226,33,19488
 WL 6
 Mvva 64,212,80
 Mvva 68,208,68
 TR 228,33,28448
 Mvva 68,212,84
 Mvva 72,208,72
 TR 230,33,28960
 Mvva 72,212,88
 Mvva 76,208,76
 TR 208,34,32
 Mvva 76,212,92
 WL 7
 WL 5
 Mvva 80,216,144
 TR 210,34,544
  v_cvt_pk_bf16_f32 v64, v64, v65
 Mvva 80,220,160
  v_cvt_pk_bf16_f32 v65, v66, v67
  v_cvt_pk_bf16_f32 v66, v68, v69
 Mvva 84,216,148
 TR 212,34,9504
  v_cvt_pk_bf16_f32 v67, v70, v71
 Mvva 84,220,164
  v_min_u32 v64, -2, v64
  v_min_u32 v65, -2, v65
 Mvva 88,216,152
 TR 214,34,10016
  v_min_u32 v66, -2, v66
 Mvva 88,220,168
  v_min_u32 v67, -2, v67
 WL 4
 Mvva 92,216,156
 TR 216,34,18976
 WL 7
 Mvva 92,220,172
  buffer_store_dwordx4 v[64:67], v16, s[8:11], 0 offen offset:0 sc1
 Mvva 80,224,0
 TR 218,34,19488
  v_and_b32 v247, 7, v0
 Mvva 80,228,16
  v_lshlrev_b32 v247, 2, v247
  v_cvt_pk_bf16_f32 v72, v72, v73
 Mvva 84,224,4
 TR 220,34,28448
  v_cvt_pk_bf16_f32 v73, v74, v75
 Mvva 84,228,20
  buffer_load_dword v248, v247, s[20:23], s54 offen offset:32 sc1
 Mvva 88,224,8
 TR 222,34,28960
  v_cvt_pk_bf16_f32 v74, v76, v77
 Mvva 88,228,24
  v_cvt_pk_bf16_f32 v75, v78, v79
  v_min_u32 v72, -2, v72
 Mvva 92,224,12
 TR 224,33,64
  v_min_u32 v73, -2, v73
 Mvva 92,228,28
 WL 7
  v_min_u32 v74, -2, v74
  v_min_u32 v75, -2, v75
 Mvva 80,208,32
 TR 226,33,576
 WL 6
 Mvva 80,212,48
  buffer_store_dwordx4 v[72:75], v16, s[8:11], s50 offen offset:1024 sc1
 Mvva 84,208,36
 TR 228,33,9536
 Mvva 84,212,52
 Mvva 88,208,40
 TR 230,33,10048
 Mvva 88,212,56
 Mvva 92,208,44
 TR 208,33,19008
 Mvva 92,212,60
 WL 7
 Mvva 80,216,64
 TR 210,33,19520
 WL 6
 Mvva 80,220,80
 Mvva 84,216,68
 TR 212,33,28480
 Mvva 84,220,84
 Mvva 88,216,72
 TR 214,33,28992
 Mvva 88,220,88
 Mvva 92,216,76
 TR 216,34,64
 Mvva 92,220,92
 WL 7
 WL 5
 Mvva 96,224,144
 TR 218,34,576
  v_cvt_pk_bf16_f32 v80, v80, v81
 Mvva 96,228,160
  v_cvt_pk_bf16_f32 v81, v82, v83
  v_cvt_pk_bf16_f32 v82, v84, v85
 Mvva 100,224,148
 TR 220,34,9536
  v_cvt_pk_bf16_f32 v83, v86, v87
 Mvva 100,228,164
  v_min_u32 v80, -2, v80
  v_min_u32 v81, -2, v81
 Mvva 104,224,152
 TR 222,34,10048
  v_min_u32 v82, -2, v82
 Mvva 104,228,168
  v_min_u32 v83, -2, v83
 WL 4
 Mvva 108,224,156
 TR 224,34,19008
 WL 7
 Mvva 108,228,172
  buffer_store_dwordx4 v[80:83], v16, s[8:11], 0 offen offset:1024 sc1
 Mvva 96,208,0
 TR 226,34,19520
  v_cvt_pk_bf16_f32 v88, v88, v89
 Mvva 96,212,16
  v_cvt_pk_bf16_f32 v89, v90, v91
  v_cvt_pk_bf16_f32 v90, v92, v93
 Mvva 100,208,4
 TR 228,34,28480
  v_cvt_pk_bf16_f32 v91, v94, v95
 Mvva 100,212,20
  v_min_u32 v88, -2, v88
  v_min_u32 v89, -2, v89
 Mvva 104,208,8
 TR 230,34,28992
  v_min_u32 v90, -2, v90
 Mvva 104,212,24
  v_min_u32 v91, -2, v91
 Mvva 108,208,12
 TR 208,33,96
 WL 7
 Mvva 108,212,28
  buffer_store_dwordx4 v[88:91], v16, s[8:11], s50 offen offset:2048 sc1
 Mvva 96,216,32
 TR 210,33,608
 WL 6
 Mvva 96,220,48
 Mvva 100,216,36
 TR 212,33,9568
 Mvva 100,220,52
 Mvva 104,216,40
 TR 214,33,10080
 Mvva 104,220,56
 Mvva 108,216,44
 TR 216,33,19040
 Mvva 108,220,60
 WL 7
 Mvva 96,224,64
 TR 218,33,19552
 WL 6
 Mvva 96,228,80
 Mvva 100,224,68
 TR 220,33,28512
 Mvva 100,228,84
 Mvva 104,224,72
 TR 222,33,29024
 Mvva 104,228,88
 Mvva 108,224,76
 TR 224,34,96
 Mvva 108,228,92
 WL 7
 WL 5
 Mvva 112,208,144
 TR 226,34,608
  v_cvt_pk_bf16_f32 v96, v96, v97
 Mvva 112,212,160
  v_cvt_pk_bf16_f32 v97, v98, v99
  v_cvt_pk_bf16_f32 v98, v100, v101
 Mvva 116,208,148
 TR 228,34,9568
  v_cvt_pk_bf16_f32 v99, v102, v103
 Mvva 116,212,164
  v_min_u32 v96, -2, v96
  v_min_u32 v97, -2, v97
 Mvva 120,208,152
 TR 230,34,10080
  v_min_u32 v98, -2, v98
 Mvva 120,212,168
  v_min_u32 v99, -2, v99
 WL 4
 Mvva 124,208,156
 TR 208,34,19040
 WL 7
 Mvva 124,212,172
  buffer_store_dwordx4 v[96:99], v16, s[8:11], 0 offen offset:2048 sc1
 Mvva 112,216,0
 TR 210,34,19552
  v_cvt_pk_bf16_f32 v104, v104, v105
 Mvva 112,220,16
  v_cvt_pk_bf16_f32 v105, v106, v107
  v_cvt_pk_bf16_f32 v106, v108, v109
 Mvva 116,216,4
 TR 212,34,28512
  v_cvt_pk_bf16_f32 v107, v110, v111
 Mvva 116,220,20
  v_min_u32 v104, -2, v104
  v_min_u32 v105, -2, v105
 Mvva 120,216,8
 TR 214,34,29024
  v_min_u32 v106, -2, v106
 Mvva 120,220,24
  v_min_u32 v107, -2, v107
 Mvva 124,216,12
 TR 216,33,128
 WL 7
 Mvva 124,220,28
  buffer_store_dwordx4 v[104:107], v16, s[8:11], s50 offen offset:3072 sc1
 Mvva 112,224,32
 TR 218,33,640
 WL 6
 Mvva 112,228,48
 Mvva 116,224,36
 TR 220,33,9600
 Mvva 116,228,52
 Mvva 120,224,40
 TR 222,33,10112
 Mvva 120,228,56
 Mvva 124,224,44
 TR 224,33,19072
 Mvva 124,228,60
 WL 7
 Mvva 112,208,64
 TR 226,33,19584
 WL 6
 Mvva 112,212,80
 Mvva 116,208,68
 TR 228,33,28544
 Mvva 116,212,84
 Mvva 120,208,72
 TR 230,33,29056
 Mvva 120,212,88
 Mvva 124,208,76
 TR 208,34,128
 Mvva 124,212,92
 WL 7
 WL 5
 Mvva 128,216,144
 TR 210,34,640
  v_cvt_pk_bf16_f32 v112, v112, v113
 Mvva 128,220,160
  v_cvt_pk_bf16_f32 v113, v114, v115
  v_cvt_pk_bf16_f32 v114, v116, v117
 Mvva 132,216,148
 TR 212,34,9600
  v_cvt_pk_bf16_f32 v115, v118, v119
 Mvva 132,220,164
  v_min_u32 v112, -2, v112
  v_min_u32 v113, -2, v113
 Mvva 136,216,152
 TR 214,34,10112
  v_min_u32 v114, -2, v114
 Mvva 136,220,168
  v_min_u32 v115, -2, v115
 WL 4
 Mvva 140,216,156
 TR 216,34,19072
 WL 7
 Mvva 140,220,172
  buffer_store_dwordx4 v[112:115], v16, s[8:11], 0 offen offset:3072 sc1
 Mvva 128,224,0
 TR 218,34,19584
  v_cvt_pk_bf16_f32 v120, v120, v121
 Mvva 128,228,16
  v_cvt_pk_bf16_f32 v121, v122, v123
  v_cvt_pk_bf16_f32 v122, v124, v125
 Mvva 132,224,4
 TR 220,34,28544
  v_cvt_pk_bf16_f32 v123, v126, v127
 Mvva 132,228,20
  v_min_u32 v120, -2, v120
  v_min_u32 v121, -2, v121
 Mvva 136,224,8
 TR 222,34,29056
  v_min_u32 v122, -2, v122
 Mvva 136,228,24
  v_min_u32 v123, -2, v123
 Mvva 140,224,12
 TR 224,33,160
 WL 7
 Mvva 140,228,28
  buffer_store_dwordx4 v[120:123], v17, s[8:11], s50 offen offset:0 sc1
 Mvva 128,208,32
 TR 226,33,672
 WL 6
 Mvva 128,212,48
 Mvva 132,208,36
 TR 228,33,9632
 Mvva 132,212,52
 Mvva 136,208,40
 TR 230,33,10144
 Mvva 136,212,56
 Mvva 140,208,44
 TR 208,33,19104
 Mvva 140,212,60
 WL 7
 Mvva 128,216,64
 TR 210,33,19616
 WL 6
 Mvva 128,220,80
 Mvva 132,216,68
 TR 212,33,28576
 Mvva 132,220,84
  s_waitcnt vmcnt(7)
  v_cmp_gt_u32 vcc, 1, v248
  s_nop 4
  s_cbranch_vccnz Lpoll_pz_6
Lback_pz_6:
 Mvva 136,216,72
 TR 214,33,29088
 Mvva 136,220,88
 WL 6
 WL 4
 Mvva 140,216,76
 TR 216,34,160
  s_add_u32 s46, s55, 0
 Mvva 140,220,92
  buffer_load_dwordx4 v[64:67], v28, s[20:23], s46 offen sc1
 Mvva 144,224,144
 TR 218,34,672
  v_cvt_pk_bf16_f32 v128, v128, v129
 Mvva 144,228,160
  v_cvt_pk_bf16_f32 v129, v130, v131
  v_cvt_pk_bf16_f32 v130, v132, v133
 Mvva 148,224,148
 TR 220,34,9632
  v_cvt_pk_bf16_f32 v131, v134, v135
 Mvva 148,228,164
  v_min_u32 v128, -2, v128
  v_min_u32 v129, -2, v129
 Mvva 152,224,152
 TR 222,34,10144
  v_min_u32 v130, -2, v130
 Mvva 152,228,168
  v_min_u32 v131, -2, v131
 WL 4
 Mvva 156,224,156
 TR 224,34,19104
 WL 7
 Mvva 156,228,172
  buffer_store_dwordx4 v[128:131], v17, s[8:11], 0 offen offset:0 sc1
 Mvva 144,208,0
 TR 226,34,19616
  v_cvt_pk_bf16_f32 v136, v136, v137
 Mvva 144,212,16
  s_add_u32 s46, s55, 18432
  v_cvt_pk_bf16_f32 v137, v138, v139
  v_cvt_pk_bf16_f32 v138, v140, v141
 Mvva 148,208,4
 TR 228,34,28576
  v_cvt_pk_bf16_f32 v139, v142, v143
 Mvva 148,212,20
  buffer_load_dwordx4 v[68:71], v28, s[20:23], s46 offen sc1
 Mvva 152,208,8
 TR 230,34,29088
  v_min_u32 v136, -2, v136
 Mvva 152,212,24
 WL 6
  v_min_u32 v137, -2, v137
  v_min_u32 v138, -2, v138
 Mvva 156,208,12
 TR 208,33,192
  v_min_u32 v139, -2, v139
 Mvva 156,212,28
  buffer_store_dwordx4 v[136:139], v17, s[8:11], s50 offen offset:1024 sc1
 Mvva 144,216,32
 TR 210,33,704
 WL 6
 Mvva 144,220,48
 Mvva 148,216,36
 TR 212,33,9664
  s_add_u32 s46, s55, 36864
 Mvva 148,220,52
  buffer_load_dwordx4 v[72:75], v28, s[20:23], s46 offen sc1
 Mvva 152,216,40
 TR 214,33,10176
 Mvva 152,220,56
 Mvva 156,216,44
 TR 216,33,19136
 Mvva 156,220,60
 WL 7
 Mvva 144,224,64
 TR 218,33,19648
 WL 6
 Mvva 144,228,80
 Mvva 148,224,68
 TR 220,33,28608
 Mvva 148,228,84
 Mvva 152,224,72
 TR 222,33,29120
  s_add_u32 s46, s55, 55296
 Mvva 152,228,88
  buffer_load_dwordx4 v[76:79], v28, s[20:23], s46 offen sc1
 Mvva 156,224,76
 TR 224,34,192
 Mvva 156,228,92
 WL 7
 WL 5
 Mvva 160,208,144
 TR 226,34,704
  v_cvt_pk_bf16_f32 v144, v144, v145
 Mvva 160,212,160
  v_cvt_pk_bf16_f32 v145, v146, v147
  v_cvt_pk_bf16_f32 v146, v148, v149
 Mvva 164,208,148
 TR 228,34,9664
  v_cvt_pk_bf16_f32 v147, v150, v151
 Mvva 164,212,164
  v_min_u32 v144, -2, v144
  v_min_u32 v145, -2, v145
 Mvva 168,208,152
 TR 230,34,10176
  v_min_u32 v146, -2, v146
 Mvva 168,212,168
 WL 4
  v_min_u32 v147, -2, v147
 WL 6
 Mvva 172,208,156
 TR 208,34,19136
  s_add_u32 s46, s55, 73728
 Mvva 172,212,172
  buffer_store_dwordx4 v[144:147], v17, s[8:11], 0 offen offset:1024 sc1
 Mvva 160,216,0
 TR 210,34,19648
  v_cvt_pk_bf16_f32 v152, v152, v153
 Mvva 160,220,16
  buffer_load_dwordx4 v[80:83], v28, s[20:23], s46 offen sc1
 Mvva 164,216,4
 TR 212,34,28608
  v_cvt_pk_bf16_f32 v153, v154, v155
 Mvva 164,220,20
  v_cvt_pk_bf16_f32 v154, v156, v157
  v_cvt_pk_bf16_f32 v155, v158, v159
 Mvva 168,216,8
 TR 214,34,29120
  v_min_u32 v152, -2, v152
 Mvva 168,220,24
 WL 6
  v_min_u32 v153, -2, v153
  v_min_u32 v154, -2, v154
 Mvva 172,216,12
 TR 216,33,224
  v_min_u32 v155, -2, v155
 Mvva 172,220,28
  buffer_store_dwordx4 v[152:155], v17, s[8:11], s50 offen offset:2048 sc1
 Mvva 160,224,32
 TR 218,33,736
  s_add_u32 s46, s55, 92160
 WL 6
 Mvva 160,228,48
  buffer_load_dwordx4 v[84:87], v28, s[20:23], s46 offen sc1
 Mvva 164,224,36
 TR 220,33,9696
 Mvva 164,228,52
 Mvva 168,224,40
 TR 222,33,10208
 Mvva 168,228,56
 Mvva 172,224,44
 TR 224,33,19168
 Mvva 172,228,60
 WL 7
 Mvva 160,208,64
 TR 226,33,19680
 WL 6
 Mvva 160,212,80
 Mvva 164,208,68
 TR 228,33,28640
  s_add_u32 s46, s55, 110592
 Mvva 164,212,84
  buffer_load_dword v248, v247, s[20:23], s54 offen offset:32 sc1
 Mvva 168,208,72
 TR 230,33,29152
  v_mov_b32 v128, 0
 Mvva 168,212,88
  buffer_load_dwordx4 v[88:91], v28, s[20:23], s46 offen sc1
 Mvva 172,208,76
 TR 208,34,224
  v_mov_b32 v129, 0
 Mvva 172,212,92
 WL 7
  v_mov_b32 v130, 0
  v_mov_b32 v131, 0
 Mvva 176,216,144
 TR 210,34,736
  v_cvt_pk_bf16_f32 v160, v160, v161
 WL 6
 Mvva 176,220,160
  v_cvt_pk_bf16_f32 v161, v162, v163
  v_cvt_pk_bf16_f32 v162, v164, v165
 Mvva 180,216,148
 TR 212,34,9696
  v_cvt_pk_bf16_f32 v163, v166, v167
 Mvva 180,220,164
  v_min_u32 v160, -2, v160
  v_min_u32 v161, -2, v161
 Mvva 184,216,152
 TR 214,34,10208
  v_min_u32 v162, -2, v162
 Mvva 184,220,168
  s_add_u32 s46, s55, 129024
  v_min_u32 v163, -2, v163
  v_mov_b32 v132, 0
 Mvva 188,216,156
 TR 216,34,19168
  v_mov_b32 v133, 0
 Mvva 188,220,172
  buffer_store_dwordx4 v[160:163], v17, s[8:11], 0 offen offset:2048 sc1
  buffer_load_dwordx4 v[92:95], v28, s[20:23], s46 offen sc1
 WL 7
 Mvva 176,224,0
 TR 218,34,19680
  v_cvt_pk_bf16_f32 v168, v168, v169
 WL 6
 Mvva 176,228,16
  v_cvt_pk_bf16_f32 v169, v170, v171
  v_cvt_pk_bf16_f32 v170, v172, v173
 Mvva 180,224,4
 TR 220,34,28640
  v_cvt_pk_bf16_f32 v171, v174, v175
 Mvva 180,228,20
  v_min_u32 v168, -2, v168
  v_min_u32 v169, -2, v169
 Mvva 184,224,8
 TR 222,34,29152
  v_min_u32 v170, -2, v170
 Mvva 184,228,24
 WL 6
  v_min_u32 v171, -2, v171
  v_mov_b32 v134, 0
 Mvva 188,224,12
 TR 224,57,0
  v_mov_b32 v135, 0
 Mvva 188,228,28
  buffer_store_dwordx4 v[168:171], v17, s[8:11], s50 offen offset:3072 sc1
 Mvva 176,208,32
 TR 226,57,512
  v_mov_b32 v136, 0
 WL 6
 Mvva 176,212,48
  v_mov_b32 v137, 0
  v_mov_b32 v138, 0
 Mvva 180,208,36
 TR 228,57,9472
  v_mov_b32 v139, 0
 Mvva 180,212,52
  v_mov_b32 v140, 0
  v_mov_b32 v141, 0
 Mvva 184,208,40
 TR 230,57,9984
  v_mov_b32 v142, 0
 Mvva 184,212,56
  v_mov_b32 v143, 0
  v_mov_b32 v144, 0
 Mvva 188,208,44
 TR 208,57,18944
  v_mov_b32 v145, 0
 Mvva 188,212,60
 WL 7
 Mvva 176,216,64
 TR 210,57,19456
 WL 6
 Mvva 176,220,80
  buffer_store_dword v246, v245, s[20:23], s66 offen sc1
 Mvva 180,216,68
 TR 212,57,28416
 Mvva 180,220,84
 Mvva 184,216,72
 TR 214,57,28928
 Mvva 184,220,88
 Mvva 188,216,76
 TR 216,58,0
 Mvva 188,220,92
 WL 7
 WL 5
 Mvva 192,224,144
 TR 218,58,512
  v_cvt_pk_bf16_f32 v176, v176, v177
 Mvva 192,228,160
  v_cvt_pk_bf16_f32 v177, v178, v179
  v_cvt_pk_bf16_f32 v178, v180, v181
 Mvva 196,224,148
 TR 220,58,9472
  v_cvt_pk_bf16_f32 v179, v182, v183
 Mvva 196,228,164
  v_min_u32 v176, -2, v176
  v_min_u32 v177, -2, v177
 Mvva 200,224,152
 TR 222,58,9984
  v_min_u32 v178, -2, v178
 Mvva 200,228,168
  v_min_u32 v179, -2, v179
 WL 4
 Mvva 204,224,156
 TR 224,58,18944
 WL 7
 Mvva 204,228,172
  buffer_store_dwordx4 v[176:179], v17, s[8:11], 0 offen offset:3072 sc1
 Mvva 192,208,0
 TR 226,58,19456
  v_cvt_pk_bf16_f32 v184, v184, v185
 Mvva 192,212,16
  v_cvt_pk_bf16_f32 v185, v186, v187
  v_cvt_pk_bf16_f32 v186, v188, v189
 Mvva 196,208,4
 TR 228,58,28416
  v_cvt_pk_bf16_f32 v187, v190, v191
 Mvva 196,212,20
  v_min_u32 v184, -2, v184
  v_min_u32 v185, -2, v185
 Mvva 200,208,8
 TR 230,58,28928
  v_min_u32 v186, -2, v186
 Mvva 200,212,24
  v_min_u32 v187, -2, v187
 Mvva 204,208,12
  buffer_store_dwordx4 v[184:187], v16, s[8:11], s51 offen offset:0 sc1
 Mvva 204,212,28
 WL 6
 Mvva 192,216,32
 WL 4
 Mvva 192,220,48
 Mvva 196,216,36
 Mvva 196,220,52
 Mvva 200,216,40
 Mvva 200,220,56
 Mvva 204,216,44
 Mvva 204,220,60
 WL 2
 Mvva 192,224,64
 WL 0
 Mvva 192,228,80
 Mvva 196,224,68
 Mvva 196,228,84
 Mvva 200,224,72
 Mvva 200,228,88
 Mvva 204,224,76
 Mvva 204,228,92
  s_nop 1
  v_cvt_pk_bf16_f32 v192, v192, v193
  v_cvt_pk_bf16_f32 v193, v194, v195
  v_cvt_pk_bf16_f32 v194, v196, v197
  v_cvt_pk_bf16_f32 v195, v198, v199
  v_min_u32 v192, -2, v192
  v_min_u32 v193, -2, v193
  v_min_u32 v194, -2, v194
  v_min_u32 v195, -2, v195
  buffer_store_dwordx4 v[192:195], v16, s[8:11], s50 offen offset:0 sc1
  v_cvt_pk_bf16_f32 v200, v200, v201
  v_cvt_pk_bf16_f32 v201, v202, v203
  v_cvt_pk_bf16_f32 v202, v204, v205
  v_cvt_pk_bf16_f32 v203, v206, v207
  v_min_u32 v200, -2, v200
  v_min_u32 v201, -2, v201
  v_min_u32 v202, -2, v202
  v_min_u32 v203, -2, v203
  buffer_store_dwordx4 v[200:203], v16, s[8:11], s51 offen offset:1024 sc1
  s_waitcnt vmcnt(9)
  v_cmp_gt_u32 vcc, 2, v248
  s_nop 4
  s_cbranch_vccnz Lpoll_red_6
Lback_red_6:
  s_add_u32 s46, s55, 4096
  buffer_load_dwordx4 v[96:99], v28, s[20:23], s46 offen sc1
  buffer_load_dword v232, v29, s[20:23], s46 offen sc1
  s_add_u32 s46, s55, 22528
  buffer_load_dwordx4 v[100:103], v28, s[20:23], s46 offen sc1
  buffer_load_dword v233, v29, s[20:23], s46 offen sc1
  s_add_u32 s46, s55, 40960
  buffer_load_dwordx4 v[104:107], v28, s[20:23], s46 offen sc1
  buffer_load_dword v234, v29, s[20:23], s46 offen sc1
  s_add_u32 s46, s55, 59392
  buffer_load_dwordx4 v[108:111], v28, s[20:23], s46 offen sc1
  buffer_load_dword v235, v29, s[20:23], s46 offen sc1
  s_add_u32 s46, s55, 77824
  buffer_load_dwordx4 v[112:115], v28, s[20:23], s46 offen sc1
  buffer_load_dword v236, v29, s[20:23], s46 offen sc1
  s_add_u32 s46, s55, 96256
  buffer_load_dwordx4 v[116:119], v28, s[20:23], s46 offen sc1
  buffer_load_dword v237, v29, s[20:23], s46 offen sc1
  s_add_u32 s46, s55, 114688
  buffer_load_dwordx4 v[120:123], v28, s[20:23], s46 offen sc1
  buffer_load_dword v238, v29, s[20:23], s46 offen sc1
  s_add_u32 s46, s55, 133120
  buffer_load_dwordx4 v[124:127], v28, s[20:23], s46 offen sc1
  buffer_load_dword v239, v29, s[20:23], s46 offen sc1
  s_load_dwordx2 s[16:17], s[0:1], 80
  s_mov_b32 s18, 0x240000
  s_mov_b32 s19, 0x00020000
Lchk_6:
  s_bitcmp1_b32 s57, 0
  s_cbranch_scc0 Lskip0_6
  v_max3_u32 v36, v64, v65, v66
  v_max3_u32 v36, v36, v67, v67
  v_cmp_eq_u32 vcc, -1, v36
  s_nop 4
  s_cbranch_vccnz Lskip0_6
  v_lshlrev_b32 v36, 16, v64
  v_and_b32 v37, 0xffff0000, v64
  v_pk_add_f32 v[128:129], v[128:129], v[36:37]
  v_lshlrev_b32 v36, 16, v65
  v_and_b32 v37, 0xffff0000, v65
  v_pk_add_f32 v[130:131], v[130:131], v[36:37]
  v_lshlrev_b32 v36, 16, v66
  v_and_b32 v37, 0xffff0000, v66
  v_pk_add_f32 v[132:133], v[132:133], v[36:37]
  v_lshlrev_b32 v36, 16, v67
  v_and_b32 v37, 0xffff0000, v67
  v_pk_add_f32 v[134:135], v[134:135], v[36:37]
  s_bitset0_b32 s57, 0
Lskip0_6:
  s_bitcmp1_b32 s57, 1
  s_cbranch_scc0 Lskip1_6
  v_max3_u32 v36, v68, v69, v70
  v_max3_u32 v36, v36, v71, v71
  v_cmp_eq_u32 vcc, -1, v36
  s_nop 4
  s_cbranch_vccnz Lskip1_6
  v_lshlrev_b32 v36, 16, v68
  v_and_b32 v37, 0xffff0000, v68
  v_pk_add_f32 v[128:129], v[128:129], v[36:37]
  v_lshlrev_b32 v36, 16, v69
  v_and_b32 v37, 0xffff0000, v69
  v_pk_add_f32 v[130:131], v[130:131], v[36:37]
  v_lshlrev_b32 v36, 16, v70
  v_and_b32 v37, 0xffff0000, v70
  v_pk_add_f32 v[132:133], v[132:133], v[36:37]
  v_lshlrev_b32 v36, 16, v71
  v_and_b32 v37, 0xffff0000, v71
  v_pk_add_f32 v[134:135], v[134:135], v[36:37]
  s_bitset0_b32 s57, 1
Lskip1_6:
  s_bitcmp1_b32 s57, 2
  s_cbranch_scc0 Lskip2_6
  v_max3_u32 v36, v72, v73, v74
  v_max3_u32 v36, v36, v75, v75
  v_cmp_eq_u32 vcc, -1, v36
  s_nop 4
  s_cbranch_vccnz Lskip2_6
  v_lshlrev_b32 v36, 16, v72
  v_and_b32 v37, 0xffff0000, v72
  v_pk_add_f32 v[128:129], v[128:129], v[36:37]
  v_lshlrev_b32 v36, 16, v73
  v_and_b32 v37, 0xffff0000, v73
  v_pk_add_f32 v[130:131], v[130:131], v[36:37]
  v_lshlrev_b32 v36, 16, v74
  v_and_b32 v37, 0xffff0000, v74
  v_pk_add_f32 v[132:133], v[132:133], v[36:37]
  v_lshlrev_b32 v36, 16, v75
  v_and_b32 v37, 0xffff0000, v75
  v_pk_add_f32 v[134:135], v[134:135], v[36:37]
  s_bitset0_b32 s57, 2
Lskip2_6:
  s_bitcmp1_b32 s57, 3
  s_cbranch_scc0 Lskip3_6
  v_max3_u32 v36, v76, v77, v78
  v_max3_u32 v36, v36, v79, v79
  v_cmp_eq_u32 vcc, -1, v36
  s_nop 4
  s_cbranch_vccnz Lskip3_6
  v_lshlrev_b32 v36, 16, v76
  v_and_b32 v37, 0xffff0000, v76
  v_pk_add_f32 v[128:129], v[128:129], v[36:37]
  v_lshlrev_b32 v36, 16, v77
  v_and_b32 v37, 0xffff0000, v77
  v_pk_add_f32 v[130:131], v[130:131], v[36:37]
  v_lshlrev_b32 v36, 16, v78
  v_and_b32 v37, 0xffff0000, v78
  v_pk_add_f32 v[132:133], v[132:133], v[36:37]
  v_lshlrev_b32 v36, 16, v79
  v_and_b32 v37, 0xffff0000, v79
  v_pk_add_f32 v[134:135], v[134:135], v[36:37]
  s_bitset0_b32 s57, 3
Lskip3_6:
  s_bitcmp1_b32 s57, 4
  s_cbranch_scc0 Lskip4_6
  v_max3_u32 v36, v80, v81, v82
  v_max3_u32 v36, v36, v83, v83
  v_cmp_eq_u32 vcc, -1, v36
  s_nop 4
  s_cbranch_vccnz Lskip4_6
  v_lshlrev_b32 v36, 16, v80
  v_and_b32 v37, 0xffff0000, v80
  v_pk_add_f32 v[128:129], v[128:129], v[36:37]
  v_lshlrev_b32 v36, 16, v81
  v_and_b32 v37, 0xffff0000, v81
  v_pk_add_f32 v[130:131], v[130:131], v[36:37]
  v_lshlrev_b32 v36, 16, v82
  v_and_b32 v37, 0xffff0000, v82
  v_pk_add_f32 v[132:133], v[132:133], v[36:37]
  v_lshlrev_b32 v36, 16, v83
  v_and_b32 v37, 0xffff0000, v83
  v_pk_add_f32 v[134:135], v[134:135], v[36:37]
  s_bitset0_b32 s57, 4
Lskip4_6:
  s_bitcmp1_b32 s57, 5
  s_cbranch_scc0 Lskip5_6
  v_max3_u32 v36, v84, v85, v86
  v_max3_u32 v36, v36, v87, v87
  v_cmp_eq_u32 vcc, -1, v36
  s_nop 4
  s_cbranch_vccnz Lskip5_6
  v_lshlrev_b32 v36, 16, v84
  v_and_b32 v37, 0xffff0000, v84
  v_pk_add_f32 v[128:129], v[128:129], v[36:37]
  v_lshlrev_b32 v36, 16, v85
  v_and_b32 v37, 0xffff0000, v85
  v_pk_add_f32 v[130:131], v[130:131], v[36:37]
  v_lshlrev_b32 v36, 16, v86
  v_and_b32 v37, 0xffff0000, v86
  v_pk_add_f32 v[132:133], v[132:133], v[36:37]
  v_lshlrev_b32 v36, 16, v87
  v_and_b32 v37, 0xffff0000, v87
  v_pk_add_f32 v[134:135], v[134:135], v[36:37]
  s_bitset0_b32 s57, 5
Lskip5_6:
  s_bitcmp1_b32 s57, 6
  s_cbranch_scc0 Lskip6_6
  s_waitcnt vmcnt(24)
  v_max3_u32 v36, v88, v89, v90
  v_max3_u32 v36, v36, v91, v91
  v_cmp_eq_u32 vcc, -1, v36
  s_nop 4
  s_cbranch_vccnz Lskip6_6
  v_lshlrev_b32 v36, 16, v88
  v_and_b32 v37, 0xffff0000, v88
  v_pk_add_f32 v[128:129], v[128:129], v[36:37]
  v_lshlrev_b32 v36, 16, v89
  v_and_b32 v37, 0xffff0000, v89
  v_pk_add_f32 v[130:131], v[130:131], v[36:37]
  v_lshlrev_b32 v36, 16, v90
  v_and_b32 v37, 0xffff0000, v90
  v_pk_add_f32 v[132:133], v[132:133], v[36:37]
  v_lshlrev_b32 v36, 16, v91
  v_and_b32 v37, 0xffff0000, v91
  v_pk_add_f32 v[134:135], v[134:135], v[36:37]
  s_bitset0_b32 s57, 6
Lskip6_6:
  s_bitcmp1_b32 s57, 7
  s_cbranch_scc0 Lskip7_6
  s_waitcnt vmcnt(22)
  v_max3_u32 v36, v92, v93, v94
  v_max3_u32 v36, v36, v95, v95
  v_cmp_eq_u32 vcc, -1, v36
  s_nop 4
  s_cbranch_vccnz Lskip7_6
  v_lshlrev_b32 v36, 16, v92
  v_and_b32 v37, 0xffff0000, v92
  v_pk_add_f32 v[128:129], v[128:129], v[36:37]
  v_lshlrev_b32 v36, 16, v93
  v_and_b32 v37, 0xffff0000, v93
  v_pk_add_f32 v[130:131], v[130:131], v[36:37]
  v_lshlrev_b32 v36, 16, v94
  v_and_b32 v37, 0xffff0000, v94
  v_pk_add_f32 v[132:133], v[132:133], v[36:37]
  v_lshlrev_b32 v36, 16, v95
  v_and_b32 v37, 0xffff0000, v95
  v_pk_add_f32 v[134:135], v[134:135], v[36:37]
  s_bitset0_b32 s57, 7
Lskip7_6:
  s_bitcmp1_b32 s57, 8
  s_cbranch_scc0 Lskip8_6
  s_waitcnt vmcnt(15)
  v_max3_u32 v36, v96, v97, v98
  s_waitcnt vmcnt(14)
  v_max3_u32 v36, v36, v99, v232
  v_cmp_eq_u32 vcc, -1, v36
  s_nop 4
  s_cbranch_vccnz Lskip8_6
  v_lshlrev_b32 v36, 16, v96
  v_and_b32 v37, 0xffff0000, v96
  v_pk_add_f32 v[136:137], v[136:137], v[36:37]
  v_lshlrev_b32 v36, 16, v97
  v_and_b32 v37, 0xffff0000, v97
  v_pk_add_f32 v[138:139], v[138:139], v[36:37]
  v_lshlrev_b32 v36, 16, v98
  v_and_b32 v37, 0xffff0000, v98
  v_pk_add_f32 v[140:141], v[140:141], v[36:37]
  v_lshlrev_b32 v36, 16, v99
  v_and_b32 v37, 0xffff0000, v99
  v_pk_add_f32 v[142:143], v[142:143], v[36:37]
  v_lshlrev_b32 v36, 16, v232
  v_and_b32 v37, 0xffff0000, v232
  v_pk_add_f32 v[144:145], v[144:145], v[36:37]
  s_bitset0_b32 s57, 8
Lskip8_6:
  s_bitcmp1_b32 s57, 9
  s_cbranch_scc0 Lskip9_6
  s_waitcnt vmcnt(13)
  v_max3_u32 v36, v100, v101, v102
  s_waitcnt vmcnt(12)
  v_max3_u32 v36, v36, v103, v233
  v_cmp_eq_u32 vcc, -1, v36
  s_nop 4
  s_cbranch_vccnz Lskip9_6
  v_lshlrev_b32 v36, 16, v100
  v_and_b32 v37, 0xffff0000, v100
  v_pk_add_f32 v[136:137], v[136:137], v[36:37]
  v_lshlrev_b32 v36, 16, v101
  v_and_b32 v37, 0xffff0000, v101
  v_pk_add_f32 v[138:139], v[138:139], v[36:37]
  v_lshlrev_b32 v36, 16, v102
  v_and_b32 v37, 0xffff0000, v102
  v_pk_add_f32 v[140:141], v[140:141], v[36:37]
  v_lshlrev_b32 v36, 16, v103
  v_and_b32 v37, 0xffff0000, v103
  v_pk_add_f32 v[142:143], v[142:143], v[36:37]
  v_lshlrev_b32 v36, 16, v233
  v_and_b32 v37, 0xffff0000, v233
  v_pk_add_f32 v[144:145], v[144:145], v[36:37]
  s_bitset0_b32 s57, 9
Lskip9_6:
  s_bitcmp1_b32 s57, 10
  s_cbranch_scc0 Lskip10_6
  s_waitcnt vmcnt(11)
  v_max3_u32 v36, v104, v105, v106
  s_waitcnt vmcnt(10)
  v_max3_u32 v36, v36, v107, v234
  v_cmp_eq_u32 vcc, -1, v36
  s_nop 4
  s_cbranch_vccnz Lskip10_6
  v_lshlrev_b32 v36, 16, v104
  v_and_b32 v37, 0xffff0000, v104
  v_pk_add_f32 v[136:137], v[136:137], v[36:37]
  v_lshlrev_b32 v36, 16, v105
  v_and_b32 v37, 0xffff0000, v105
  v_pk_add_f32 v[138:139], v[138:139], v[36:37]
  v_lshlrev_b32 v36, 16, v106
  v_and_b32 v37, 0xffff0000, v106
  v_pk_add_f32 v[140:141], v[140:141], v[36:37]
  v_lshlrev_b32 v36, 16, v107
  v_and_b32 v37, 0xffff0000, v107
  v_pk_add_f32 v[142:143], v[142:143], v[36:37]
  v_lshlrev_b32 v36, 16, v234
  v_and_b32 v37, 0xffff0000, v234
  v_pk_add_f32 v[144:145], v[144:145], v[36:37]
  s_bitset0_b32 s57, 10
Lskip10_6:
  s_bitcmp1_b32 s57, 11
  s_cbranch_scc0 Lskip11_6
  s_waitcnt vmcnt(9)
  v_max3_u32 v36, v108, v109, v110
  s_waitcnt vmcnt(8)
  v_max3_u32 v36, v36, v111, v235
  v_cmp_eq_u32 vcc, -1, v36
  s_nop 4
  s_cbranch_vccnz Lskip11_6
  v_lshlrev_b32 v36, 16, v108
  v_and_b32 v37, 0xffff0000, v108
  v_pk_add_f32 v[136:137], v[136:137], v[36:37]
  v_lshlrev_b32 v36, 16, v109
  v_and_b32 v37, 0xffff0000, v109
  v_pk_add_f32 v[138:139], v[138:139], v[36:37]
  v_lshlrev_b32 v36, 16, v110
  v_and_b32 v37, 0xffff0000, v110
  v_pk_add_f32 v[140:141], v[140:141], v[36:37]
  v_lshlrev_b32 v36, 16, v111
  v_and_b32 v37, 0xffff0000, v111
  v_pk_add_f32 v[142:143], v[142:143], v[36:37]
  v_lshlrev_b32 v36, 16, v235
  v_and_b32 v37, 0xffff0000, v235
  v_pk_add_f32 v[144:145], v[144:145], v[36:37]
  s_bitset0_b32 s57, 11
Lskip11_6:
  s_bitcmp1_b32 s57, 12
  s_cbranch_scc0 Lskip12_6
  s_waitcnt vmcnt(7)
  v_max3_u32 v36, v112, v113, v114
  s_waitcnt vmcnt(6)
  v_max3_u32 v36, v36, v115, v236
  v_cmp_eq_u32 vcc, -1, v36
  s_nop 4
  s_cbranch_vccnz Lskip12_6
  v_lshlrev_b32 v36, 16, v112
  v_and_b32 v37, 0xffff0000, v112
  v_pk_add_f32 v[136:137], v[136:137], v[36:37]
  v_lshlrev_b32 v36, 16, v113
  v_and_b32 v37, 0xffff0000, v113
  v_pk_add_f32 v[138:139], v[138:139], v[36:37]
  v_lshlrev_b32 v36, 16, v114
  v_and_b32 v37, 0xffff0000, v114
  v_pk_add_f32 v[140:141], v[140:141], v[36:37]
  v_lshlrev_b32 v36, 16, v115
  v_and_b32 v37, 0xffff0000, v115
  v_pk_add_f32 v[142:143], v[142:143], v[36:37]
  v_lshlrev_b32 v36, 16, v236
  v_and_b32 v37, 0xffff0000, v236
  v_pk_add_f32 v[144:145], v[144:145], v[36:37]
  s_bitset0_b32 s57, 12
Lskip12_6:
  s_bitcmp1_b32 s57, 13
  s_cbranch_scc0 Lskip13_6
  s_waitcnt vmcnt(5)
  v_max3_u32 v36, v116, v117, v118
  s_waitcnt vmcnt(4)
  v_max3_u32 v36, v36, v119, v237
  v_cmp_eq_u32 vcc, -1, v36
  s_nop 4
  s_cbranch_vccnz Lskip13_6
  v_lshlrev_b32 v36, 16, v116
  v_and_b32 v37, 0xffff0000, v116
  v_pk_add_f32 v[136:137], v[136:137], v[36:37]
  v_lshlrev_b32 v36, 16, v117
  v_and_b32 v37, 0xffff0000, v117
  v_pk_add_f32 v[138:139], v[138:139], v[36:37]
  v_lshlrev_b32 v36, 16, v118
  v_and_b32 v37, 0xffff0000, v118
  v_pk_add_f32 v[140:141], v[140:141], v[36:37]
  v_lshlrev_b32 v36, 16, v119
  v_and_b32 v37, 0xffff0000, v119
  v_pk_add_f32 v[142:143], v[142:143], v[36:37]
  v_lshlrev_b32 v36, 16, v237
  v_and_b32 v37, 0xffff0000, v237
  v_pk_add_f32 v[144:145], v[144:145], v[36:37]
  s_bitset0_b32 s57, 13
Lskip13_6:
  s_bitcmp1_b32 s57, 14
  s_cbranch_scc0 Lskip14_6
  s_waitcnt vmcnt(3)
  v_max3_u32 v36, v120, v121, v122
  s_waitcnt vmcnt(2)
  v_max3_u32 v36, v36, v123, v238
  v_cmp_eq_u32 vcc, -1, v36
  s_nop 4
  s_cbranch_vccnz Lskip14_6
  v_lshlrev_b32 v36, 16, v120
  v_and_b32 v37, 0xffff0000, v120
  v_pk_add_f32 v[136:137], v[136:137], v[36:37]
  v_lshlrev_b32 v36, 16, v121
  v_and_b32 v37, 0xffff0000, v121
  v_pk_add_f32 v[138:139], v[138:139], v[36:37]
  v_lshlrev_b32 v36, 16, v122
  v_and_b32 v37, 0xffff0000, v122
  v_pk_add_f32 v[140:141], v[140:141], v[36:37]
  v_lshlrev_b32 v36, 16, v123
  v_and_b32 v37, 0xffff0000, v123
  v_pk_add_f32 v[142:143], v[142:143], v[36:37]
  v_lshlrev_b32 v36, 16, v238
  v_and_b32 v37, 0xffff0000, v238
  v_pk_add_f32 v[144:145], v[144:145], v[36:37]
  s_bitset0_b32 s57, 14
Lskip14_6:
  s_bitcmp1_b32 s57, 15
  s_cbranch_scc0 Lskip15_6
  s_waitcnt vmcnt(1)
  v_max3_u32 v36, v124, v125, v126
  s_waitcnt vmcnt(0)
  v_max3_u32 v36, v36, v127, v239
  v_cmp_eq_u32 vcc, -1, v36
  s_nop 4
  s_cbranch_vccnz Lskip15_6
  v_lshlrev_b32 v36, 16, v124
  v_and_b32 v37, 0xffff0000, v124
  v_pk_add_f32 v[136:137], v[136:137], v[36:37]
  v_lshlrev_b32 v36, 16, v125
  v_and_b32 v37, 0xffff0000, v125
  v_pk_add_f32 v[138:139], v[138:139], v[36:37]
  v_lshlrev_b32 v36, 16, v126
  v_and_b32 v37, 0xffff0000, v126
  v_pk_add_f32 v[140:141], v[140:141], v[36:37]
  v_lshlrev_b32 v36, 16, v127
  v_and_b32 v37, 0xffff0000, v127
  v_pk_add_f32 v[142:143], v[142:143], v[36:37]
  v_lshlrev_b32 v36, 16, v239
  v_and_b32 v37, 0xffff0000, v239
  v_pk_add_f32 v[144:145], v[144:145], v[36:37]
  s_bitset0_b32 s57, 15
Lskip15_6:
  s_cmp_lg_u32 s57, 0
  s_cbranch_scc1 Lretry_6
  v_cvt_pk_bf16_f32 v64, v128, v129
  v_cvt_pk_bf16_f32 v65, v130, v131
  v_cvt_pk_bf16_f32 v66, v132, v133
  v_cvt_pk_bf16_f32 v67, v134, v135
  v_cvt_pk_bf16_f32 v68, v136, v137
  v_cvt_pk_bf16_f32 v69, v138, v139
  v_cvt_pk_bf16_f32 v70, v140, v141
  v_cvt_pk_bf16_f32 v71, v142, v143
  v_cvt_pk_bf16_f32 v72, v144, v145
 WL 0
  buffer_store_dwordx2 v[64:65], v30, s[16:19], s56 offen offset:0
  buffer_store_dwordx2 v[66:67], v30, s[16:19], s69 offen offset:0
  buffer_store_dwordx2 v[68:69], v30, s[16:19], s56 offen offset:128
  buffer_store_dwordx2 v[70:71], v30, s[16:19], s69 offen offset:128
  buffer_store_dword v72, v31, s[16:19], s56 offen
Lexit_6:
  s_endpgm
Lpoll_ctx_6:
  buffer_load_dword v248, v247, s[20:23], s54 offen offset:16 sc1
  s_waitcnt vmcnt(0)
  v_cmp_gt_u32 vcc, 1, v248
  s_nop 4
  s_cbranch_vccz Lback_ctx_6
  s_branch Lpoll_ctx_6
Lpoll_pz_6:
  buffer_load_dword v248, v247, s[20:23], s54 offen offset:32 sc1
  s_waitcnt vmcnt(0)
  v_cmp_gt_u32 vcc, 1, v248
  s_nop 4
  s_cbranch_vccz Lback_pz_6
  s_branch Lpoll_pz_6
Lpoll_red_6:
  buffer_load_dword v248, v247, s[20:23], s54 offen offset:32 sc1
  s_waitcnt vmcnt(0)
  v_cmp_gt_u32 vcc, 2, v248
  s_nop 4
  s_cbranch_vccz Lback_red_6
  s_branch Lpoll_red_6
Lretry_6:
  s_bitcmp1_b32 s57, 0
  s_cbranch_scc0 Lrskip0_6
  s_add_u32 s46, s55, 0
  buffer_load_dwordx4 v[64:67], v28, s[20:23], s46 offen sc1
Lrskip0_6:
  s_bitcmp1_b32 s57, 1
  s_cbranch_scc0 Lrskip1_6
  s_add_u32 s46, s55, 18432
  buffer_load_dwordx4 v[68:71], v28, s[20:23], s46 offen sc1
Lrskip1_6:
  s_bitcmp1_b32 s57, 2
  s_cbranch_scc0 Lrskip2_6
  s_add_u32 s46, s55, 36864
  buffer_load_dwordx4 v[72:75], v28, s[20:23], s46 offen sc1
Lrskip2_6:
  s_bitcmp1_b32 s57, 3
  s_cbranch_scc0 Lrskip3_6
  s_add_u32 s46, s55, 55296
  buffer_load_dwordx4 v[76:79], v28, s[20:23], s46 offen sc1
Lrskip3_6:
  s_bitcmp1_b32 s57, 4
  s_cbranch_scc0 Lrskip4_6
  s_add_u32 s46, s55, 73728
  buffer_load_dwordx4 v[80:83], v28, s[20:23], s46 offen sc1
Lrskip4_6:
  s_bitcmp1_b32 s57, 5
  s_cbranch_scc0 Lrskip5_6
  s_add_u32 s46, s55, 92160
  buffer_load_dwordx4 v[84:87], v28, s[20:23], s46 offen sc1
Lrskip5_6:
  s_bitcmp1_b32 s57, 6
  s_cbranch_scc0 Lrskip6_6
  s_add_u32 s46, s55, 110592
  buffer_load_dwordx4 v[88:91], v28, s[20:23], s46 offen sc1
Lrskip6_6:
  s_bitcmp1_b32 s57, 7
  s_cbranch_scc0 Lrskip7_6
  s_add_u32 s46, s55, 129024
  buffer_load_dwordx4 v[92:95], v28, s[20:23], s46 offen sc1
Lrskip7_6:
  s_bitcmp1_b32 s57, 8
  s_cbranch_scc0 Lrskip8_6
  s_add_u32 s46, s55, 4096
  buffer_load_dwordx4 v[96:99], v28, s[20:23], s46 offen sc1
  buffer_load_dword v232, v29, s[20:23], s46 offen sc1
Lrskip8_6:
  s_bitcmp1_b32 s57, 9
  s_cbranch_scc0 Lrskip9_6
  s_add_u32 s46, s55, 22528
  buffer_load_dwordx4 v[100:103], v28, s[20:23], s46 offen sc1
  buffer_load_dword v233, v29, s[20:23], s46 offen sc1
Lrskip9_6:
  s_bitcmp1_b32 s57, 10
  s_cbranch_scc0 Lrskip10_6
  s_add_u32 s46, s55, 40960
  buffer_load_dwordx4 v[104:107], v28, s[20:23], s46 offen sc1
  buffer_load_dword v234, v29, s[20:23], s46 offen sc1
Lrskip10_6:
  s_bitcmp1_b32 s57, 11
  s_cbranch_scc0 Lrskip11_6
  s_add_u32 s46, s55, 59392
  buffer_load_dwordx4 v[108:111], v28, s[20:23], s46 offen sc1
  buffer_load_dword v235, v29, s[20:23], s46 offen sc1
Lrskip11_6:
  s_bitcmp1_b32 s57, 12
  s_cbranch_scc0 Lrskip12_6
  s_add_u32 s46, s55, 77824
  buffer_load_dwordx4 v[112:115], v28, s[20:23], s46 offen sc1
  buffer_load_dword v236, v29, s[20:23], s46 offen sc1
Lrskip12_6:
  s_bitcmp1_b32 s57, 13
  s_cbranch_scc0 Lrskip13_6
  s_add_u32 s46, s55, 96256
  buffer_load_dwordx4 v[116:119], v28, s[20:23], s46 offen sc1
  buffer_load_dword v237, v29, s[20:23], s46 offen sc1
Lrskip13_6:
  s_bitcmp1_b32 s57, 14
  s_cbranch_scc0 Lrskip14_6
  s_add_u32 s46, s55, 114688
  buffer_load_dwordx4 v[120:123], v28, s[20:23], s46 offen sc1
  buffer_load_dword v238, v29, s[20:23], s46 offen sc1
Lrskip14_6:
  s_bitcmp1_b32 s57, 15
  s_cbranch_scc0 Lrskip15_6
  s_add_u32 s46, s55, 133120
  buffer_load_dwordx4 v[124:127], v28, s[20:23], s46 offen sc1
  buffer_load_dword v239, v29, s[20:23], s46 offen sc1
Lrskip15_6:
  s_waitcnt vmcnt(0)
  s_branch Lchk_6
Lp4e_6:
Lp4_7:
  v_cmp_lt_u32 vcc, 0x40000000, v43
  s_lshr_b32 s65, s6, 8
  s_lshl_b32 s66, s3, 2
  v_mov_b32 v246, s66
  s_cmp_lg_u64 vcc, 0
  s_cselect_b32 s66, 1, 0
  s_andn2_b32 s66, s66, s65
  v_mov_b32 v245, s66
  ds_write_b32 v246, v245
  v_and_b32 v246, 3, v0
  v_lshlrev_b32 v246, 2, v246
  v_lshlrev_b32 v59, 3, v0
  v_add_u32 v56, 20736, v59
  v_add_u32 v57, 134400, v59
  v_add_u32 v58, 58624, v59
  v_add_u32 v59, 96512, v59
 WL 0
  s_waitcnt vmcnt(33)
  s_barrier
 TR 208,32,0
 TR 210,32,512
 TR 212,32,9472
 TR 214,32,9984
 TR 216,32,32
 TR 218,32,544
 TR 220,32,9504
 TR 222,32,10016
 TR 224,32,64
 TR 226,32,576
 TR 228,32,9536
 TR 230,32,10048
  ds_read_b32 v245, v246
 WL 11
  v_mfma_f32_16x16x32_bf16 v[64:67], v[208:211], a[212:215], 0
  s_add_u32 s46, s45, 49152
  v_lshlrev_b32 v249, 14, v0
  v_add_u32 v249, Lp4_7-Lpc0, v249
 WL 9
 Mvva 64,212,228
  buffer_load_dwordx4 a[0:3], v16, s[20:23], s46 offen offset:0 sc1
  v_mfma_f32_16x16x32_bf16 v[68:71], v[208:211], a[216:219], 0
  v_min_u32 v249, Lp4e_7-Lpc0-16388, v249
 Mvva 68,212,232
  v_mfma_f32_16x16x32_bf16 v[72:75], v[208:211], a[220:223], 0
  buffer_load_dwordx4 a[4:7], v16, s[20:23], s46 offen offset:2048 sc1
 Mvva 72,212,236
  v_mfma_f32_16x16x32_bf16 v[76:79], v[208:211], a[224:227], 0
 TR 208,32,96
 Mvva 76,212,240
 WL 8
  v_mfma_f32_16x16x32_bf16 v[80:83], v[216:219], a[212:215], 0
 TR 210,32,608
 WL 7
 Mvva 80,220,228
  buffer_load_dwordx4 a[8:11], v17, s[20:23], s46 offen offset:0 sc1
  v_mfma_f32_16x16x32_bf16 v[84:87], v[216:219], a[216:219], 0
 TR 212,32,9568
 Mvva 84,220,232
 WL 3
  v_cmp_ne_u32 vcc, 0, v245
  s_nop 4
  s_cbranch_vccnz Lrestart
  v_mfma_f32_16x16x32_bf16 v[88:91], v[216:219], a[220:223], 0
 TR 214,32,10080
 Mvva 88,220,236
  buffer_load_dwordx4 a[12:15], v17, s[20:23], s46 offen offset:2048 sc1
  v_mfma_f32_16x16x32_bf16 v[92:95], v[216:219], a[224:227], 0
 TR 216,32,128
 Mvva 92,220,240
  s_cmp_lg_u32 s3, 0
  s_cselect_b32 s64, 256, 0
  s_and_b32 s66, s2, 0xe7
  v_mfma_f32_16x16x32_bf16 v[96:99], v[224:227], a[212:215], 0
 TR 218,32,640
  s_add_u32 s46, s45, 57344
 Mvva 96,228,228
  s_lshl_b32 s66, s66, 6
  s_lshr_b32 s65, s4, 3
  s_add_u32 s66, s66, s65
  v_mfma_f32_16x16x32_bf16 v[100:103], v[224:227], a[216:219], 0
 TR 220,32,9600
  s_lshl_b32 s66, s66, 2
 Mvva 100,228,232
  buffer_load_dwordx4 a[16:19], v16, s[20:23], s46 offen offset:0 sc1
  v_mfma_f32_16x16x32_bf16 v[104:107], v[224:227], a[220:223], 0
 TR 222,32,10112
  s_add_u32 s66, s66, 0x4480010
 Mvva 104,228,236
  global_load_dword a248, v249, s[100:101]
  v_mfma_f32_16x16x32_bf16 v[108:111], v[224:227], a[224:227], 0
 TR 224,32,160
  s_lshl_b32 s65, s64, 20
 Mvva 108,228,240
  buffer_load_dwordx4 a[20:23], v16, s[20:23], s46 offen offset:2048 sc1
 WL 7
  v_mfma_f32_16x16x32_bf16 v[112:115], v[208:211], a[212:215], 0
 TR 226,32,672
  s_add_u32 s66, s66, s65
 WL 6
 Mvva 112,212,228
  v_cmp_gt_u32 vcc, 4, v0
  v_lshlrev_b32 v245, 11, v0
  v_mov_b32 v246, 1
  v_cndmask_b32 v245, -1, v245, vcc
  v_mfma_f32_16x16x32_bf16 v[116:119], v[208:211], a[216:219], 0
 TR 228,32,9632
 Mvva 116,212,232
  buffer_load_dwordx4 a[24:27], v17, s[20:23], s46 offen offset:0 sc1
  v_mfma_f32_16x16x32_bf16 v[120:123], v[208:211], a[220:223], 0
 TR 230,32,10144
 Mvva 120,212,236
  v_mfma_f32_16x16x32_bf16 v[124:127], v[208:211], a[224:227], 0
 TR 208,32,192
 Mvva 124,212,240
 WL 7
 WL 5
  v_mfma_f32_16x16x32_bf16 v[128:131], v[216:219], a[212:215], 0
 TR 210,32,704
  s_add_u32 s44, s44, 147456
 Mvva 128,220,228
  buffer_load_dwordx4 a[28:31], v17, s[20:23], s46 offen offset:2048 sc1
  v_mfma_f32_16x16x32_bf16 v[132:135], v[216:219], a[216:219], 0
 TR 212,32,9664
  s_add_u32 m0, s47, 50176
 Mvva 132,220,232
  v_mfma_f32_16x16x32_bf16 v[136:139], v[216:219], a[220:223], 0
 TR 214,32,10176
 Mvva 136,220,236
  buffer_load_dwordx4 v1, s[12:15], s44 offen lds
  v_mfma_f32_16x16x32_bf16 v[140:143], v[216:219], a[224:227], 0
 TR 216,32,224
 Mvva 140,220,240
 WL 7
  v_mfma_f32_16x16x32_bf16 v[144:147], v[224:227], a[212:215], 0
 TR 218,32,736
 WL 6
 Mvva 144,228,228
  buffer_load_dwordx4 v2, s[12:15], s44 offen offset:1056 lds
  v_mfma_f32_16x16x32_bf16 v[148:151], v[224:227], a[216:219], 0
 TR 220,32,9696
 Mvva 148,228,232
  v_mfma_f32_16x16x32_bf16 v[152:155], v[224:227], a[220:223], 0
 TR 222,32,10208
 Mvva 152,228,236
  v_mfma_f32_16x16x32_bf16 v[156:159], v[224:227], a[224:227], 0
 TR 224,56,0
 WL 7
 Mvva 156,228,240
  buffer_load_dwordx4 v3, s[12:15], s44 offen offset:2112 lds
  v_mfma_f32_16x16x32_bf16 v[160:163], v[208:211], a[212:215], 0
 TR 226,56,512
 WL 6
 Mvva 160,212,228
  v_mfma_f32_16x16x32_bf16 v[164:167], v[208:211], a[216:219], 0
 TR 228,56,9472
 Mvva 164,212,232
  buffer_load_dwordx4 v4, s[12:15], s44 offen offset:3168 lds
  v_mfma_f32_16x16x32_bf16 v[168:171], v[208:211], a[220:223], 0
 TR 230,56,9984
 Mvva 168,212,236
  s_add_u32 m0, s47, 54400
  v_mfma_f32_16x16x32_bf16 v[172:175], v[208:211], a[224:227], 0
 TR 208,32,18944
 WL 7
 Mvva 172,212,240
  buffer_load_dwordx4 v5, s[12:15], s44 offen lds
  v_mfma_f32_16x16x32_bf16 v[176:179], v[216:219], a[212:215], 0
 TR 210,32,19456
 WL 6
 Mvva 176,220,228
  v_mfma_f32_16x16x32_bf16 v[180:183], v[216:219], a[216:219], 0
 TR 212,32,28416
 Mvva 180,220,232
  buffer_load_dwordx4 v6, s[12:15], s44 offen offset:1056 lds
  v_mfma_f32_16x16x32_bf16 v[184:187], v[216:219], a[220:223], 0
 TR 214,32,28928
 Mvva 184,220,236
  v_mfma_f32_16x16x32_bf16 v[188:191], v[216:219], a[224:227], 0
 TR 216,32,18976
 Mvva 188,220,240
 WL 7
  v_mfma_f32_16x16x32_bf16 v[192:195], v[224:227], a[212:215], 0
 TR 218,32,19488
 WL 6
 Mvva 192,228,228
  buffer_load_dwordx4 v7, s[12:15], s44 offen offset:2112 lds
  v_mfma_f32_16x16x32_bf16 v[196:199], v[224:227], a[216:219], 0
 TR 220,32,28448
 Mvva 196,228,232
  v_mfma_f32_16x16x32_bf16 v[200:203], v[224:227], a[220:223], 0
 TR 222,32,28960
  s_waitcnt vmcnt(41)
 Mvva 200,228,236
  buffer_load_dwordx4 v8, s[12:15], s44 offen offset:3168 lds
  v_mfma_f32_16x16x32_bf16 v[204:207], v[224:227], a[224:227], 0
 TR 224,32,19008
 Mvva 204,228,240
  s_add_u32 m0, s47, 58624
 WL 7
 Mvva 64,208,176
 TR 226,32,19520
 WL 6
 Mvva 64,212,192
  buffer_load_dwordx4 v9, s[20:23], s44 offen sc1 lds
 Mvva 68,208,180
 TR 228,32,28480
 Mvva 68,212,196
 Mvva 72,208,184
 TR 230,32,28992
  s_add_u32 s46, s45, 65536
 Mvva 72,212,200
 Mvva 76,208,188
 TR 208,32,19040
 WL 7
 Mvva 76,212,204
  buffer_load_dwordx4 a[32:35], v16, s[20:23], s46 offen offset:0 sc1
 Mvva 80,216,176
 TR 210,32,19552
 WL 6
 Mvva 80,220,192
 Mvva 84,216,180
 TR 212,32,28512
 Mvva 84,220,196
  buffer_load_dwordx4 a[36:39], v16, s[20:23], s46 offen offset:2048 sc1
 Mvva 88,216,184
 TR 214,32,29024
 Mvva 88,220,200
 Mvva 92,216,188
 TR 216,32,19072
 WL 7
 Mvva 92,220,204
  buffer_load_dwordx4 a[40:43], v17, s[20:23], s46 offen offset:0 sc1
 Mvva 96,224,176
 TR 218,32,19584
 WL 6
 Mvva 96,228,192
 Mvva 100,224,180
 TR 220,32,28544
 Mvva 100,228,196
 Mvva 104,224,184
 TR 222,32,29056
 Mvva 104,228,200
  buffer_load_dwordx4 a[44:47], v17, s[20:23], s46 offen offset:2048 sc1
 Mvva 108,224,188
 TR 224,32,19104
  s_add_u32 s46, s45, 73728
 Mvva 108,228,204
 WL 7
 Mvva 112,208,176
 TR 226,32,19616
 WL 6
 Mvva 112,212,192
  buffer_load_dwordx4 a[48:51], v16, s[20:23], s46 offen offset:0 sc1
 Mvva 116,208,180
 TR 228,32,28576
 Mvva 116,212,196
 Mvva 120,208,184
 TR 230,32,29088
 Mvva 120,212,200
  buffer_load_dwordx4 a[52:55], v16, s[20:23], s46 offen offset:2048 sc1
 Mvva 124,208,188
 TR 208,32,19136
 Mvva 124,212,204
 WL 7
 Mvva 128,216,176
 TR 210,32,19648
 WL 6
 Mvva 128,220,192
  buffer_load_dwordx4 a[56:59], v17, s[20:23], s46 offen offset:0 sc1
 Mvva 132,216,180
 TR 212,32,28608
 Mvva 132,220,196
 Mvva 136,216,184
 TR 214,32,29120
 Mvva 136,220,200
 Mvva 140,216,188
 TR 216,32,19168
 WL 7
 Mvva 140,220,204
  buffer_load_dwordx4 a[60:63], v17, s[20:23], s46 offen offset:2048 sc1
 Mvva 144,224,176
 TR 218,32,19680
 WL 6
 Mvva 144,228,192
  s_add_u32 s46, s45, 81920
 Mvva 148,224,180
 TR 220,32,28640
 Mvva 148,228,196
  buffer_load_dwordx4 a[64:67], v16, s[20:23], s46 offen offset:0 sc1
 Mvva 152,224,184
 TR 222,32,29152
 Mvva 152,228,200
 Mvva 156,224,188
 TR 224,56,18944
 WL 7
 Mvva 156,228,204
  buffer_load_dwordx4 a[68:71], v16, s[20:23], s46 offen offset:2048 sc1
 Mvva 160,208,176
 TR 226,56,19456
 WL 6
 Mvva 160,212,192
 Mvva 164,208,180
 TR 228,56,28416
 Mvva 164,212,196
 Mvva 168,208,184
 TR 230,56,28928
 Mvva 168,212,200
  buffer_load_dwordx4 a[72:75], v17, s[20:23], s46 offen offset:0 sc1
 Mvva 172,208,188
 Mvva 172,212,204
 WL 6
 WL 4
 Mvva 176,216,176
  buffer_load_dwordx4 a[76:79], v17, s[20:23], s46 offen offset:2048 sc1
 Mvva 176,220,192
  s_waitcnt vmcnt(30) lgkmcnt(0)
  s_barrier
 Mvva 180,216,180
 TR 208,33,0
 Mvva 180,220,196
 TR 210,33,512
  s_add_u32 s46, s45, 90112
 Mvva 184,216,184
 TR 212,33,9472
 Mvva 184,220,200
 TR 214,33,9984
 Mvva 188,216,188
 TR 216,33,32
 Mvva 188,220,204
  buffer_load_dwordx4 a[80:83], v16, s[20:23], s46 offen offset:0 sc1
 Mvva 192,224,176
 TR 218,33,544
 Mvva 192,228,192
  buffer_store_dword v246, v245, s[20:23], s66 offen sc1
 Mvva 196,224,180
 TR 220,33,9504
  s_lshr_b32 s55, s2, 3
 Mvva 196,228,196
  buffer_load_dwordx4 a[84:87], v16, s[20:23], s46 offen offset:2048 sc1
 Mvva 200,224,184
 TR 222,33,10016
 WL 6
 Mvva 200,228,200
  s_add_u32 s44, s44, 147456
  s_lshl_b32 s55, s55, 2
  s_bfe_u32 s65, s4, 0x20001
 Mvva 204,224,188
 TR 224,33,64
  s_add_u32 s55, s55, s65
 Mvva 204,228,204
  buffer_load_dwordx4 a[88:91], v17, s[20:23], s46 offen offset:0 sc1
 Mvva 64,208,144
 TR 226,33,576
  s_lshr_b32 s30, s3, 1
 WL 6
 Mvva 64,212,160
  s_lshl_b32 s30, s30, 28
  s_lshl_b32 s55, s55, 4
  s_and_b32 s65, s4, 1
 Mvva 68,208,148
 TR 228,33,9536
  s_add_u32 s55, s55, s65
 Mvva 68,212,164
  buffer_load_dwordx4 a[92:95], v17, s[20:23], s46 offen offset:2048 sc1
 Mvva 72,208,152
 TR 230,33,10048
  s_add_u32 s44, s44, s30
 Mvva 72,212,168
  s_add_u32 m0, s47, 88064
  s_mul_i32 s55, s55, 9216
  s_add_u32 s55, s55, 0x4500000
 Mvva 76,208,156
 TR 208,33,96
  s_and_b32 s65, s4, 7
 Mvva 76,212,172
  buffer_load_dwordx4 v1, s[12:15], s44 offen lds
 WL 7
 Mvva 80,216,144
 TR 210,33,608
  s_movk_i32 s50, 8192
 WL 6
 Mvva 80,220,160
  s_movk_i32 s51, 16384
  s_and_b32 s66, s2, 0xf8
  s_lshl_b32 s56, s3, 1
 Mvva 84,216,148
 TR 212,33,9568
  s_add_u32 s66, s66, s56
 Mvva 84,220,164
  buffer_load_dwordx4 v2, s[12:15], s44 offen offset:1056 lds
 Mvva 88,216,152
 TR 214,33,10080
  s_lshl_b32 s66, s66, 6
 Mvva 88,220,168
  buffer_load_dwordx4 v3, s[12:15], s44 offen offset:2112 lds
 Mvva 92,216,156
 TR 216,33,128
  s_add_u32 s66, s66, s65
 Mvva 92,220,172
  buffer_load_dwordx4 v4, s[12:15], s44 offen offset:3168 lds
 WL 7
 Mvva 96,224,144
 TR 218,33,640
  s_add_u32 m0, s47, 92288
 WL 6
 Mvva 96,228,160
  buffer_load_dwordx4 v5, s[12:15], s44 offen lds
 Mvva 100,224,148
 TR 220,33,9600
  s_lshl_b32 s66, s66, 2
 Mvva 100,228,164
  buffer_load_dwordx4 v6, s[12:15], s44 offen offset:1056 lds
 Mvva 104,224,152
 TR 222,33,10112
  s_add_u32 s66, s66, 0x4480020
 Mvva 104,228,168
  buffer_load_dwordx4 v7, s[12:15], s44 offen offset:2112 lds
 Mvva 108,224,156
 TR 224,33,160
 WL 7
 Mvva 108,228,172
  buffer_load_dwordx4 v8, s[12:15], s44 offen offset:3168 lds
 Mvva 112,208,144
 TR 226,33,672
  s_add_u32 m0, s47, 96512
 WL 6
 Mvva 112,212,160
  v_cmp_gt_u32 vcc, 2, v0
  v_lshlrev_b32 v245, 8, v0
  v_mov_b32 v246, 1
  v_cndmask_b32 v245, -1, v245, vcc
 Mvva 116,208,148
 TR 228,33,9632
  s_add_u32 s46, s45, 98304
 Mvva 116,212,164
  buffer_load_dwordx4 v9, s[20:23], s44 offen sc1 lds
 Mvva 120,208,152
 TR 230,33,10144
  s_sub_u32 s56, 15, s5
 Mvva 120,212,168
  buffer_load_dwordx4 a[96:99], v16, s[20:23], s46 offen offset:0 sc1
 Mvva 124,208,156
 TR 208,33,192
 WL 7
 Mvva 124,212,172
  s_cmp_lt_u32 s65, 4
  s_cselect_b32 s56, s56, s5
  s_lshl_b32 s56, s56, 3
 Mvva 128,216,144
 TR 210,33,704
  s_bfe_u32 s69, s65, 0x10001
 WL 6
 Mvva 128,220,160
  buffer_load_dwordx4 a[100:103], v16, s[20:23], s46 offen offset:2048 sc1
 Mvva 132,216,148
 TR 212,33,9664
  s_add_u32 s56, s56, s69
 Mvva 132,220,164
  s_and_b32 s69, s65, 1
  s_lshl_b32 s69, s69, 2
  s_add_u32 s56, s56, s69
 Mvva 136,216,152
 TR 214,33,10176
  s_mul_i32 s56, s56, 18432
 Mvva 136,220,168
  buffer_load_dwordx4 a[104:107], v17, s[20:23], s46 offen offset:0 sc1
 Mvva 140,216,156
 TR 216,33,224
  s_lshr_b32 s69, s4, 3
 Mvva 140,220,172
  s_mul_i32 s31, s69, 224
  s_lshl_b32 s69, s69, 8
  s_add_u32 s56, s56, s69
 WL 7
 Mvva 144,224,144
 TR 218,33,736
  s_lshl_b32 s69, s3, 10
 WL 6
 Mvva 144,228,160
  v_add_u32 v28, s69, v16
  s_lshl_b32 s69, s3, 8
 Mvva 148,224,148
 TR 220,33,9696
  s_add_u32 s69, s69, 4096
 Mvva 148,228,164
  buffer_load_dwordx4 a[108:111], v17, s[20:23], s46 offen offset:2048 sc1
 Mvva 152,224,152
 TR 222,33,10208
  s_add_u32 s46, s45, 106496
 Mvva 152,228,168
 WL 6
  v_lshl_add_u32 v29, v0, 2, s69
  v_and_b32 v36, 15, v0
 Mvva 156,224,156
 TR 224,57,0
  v_mul_u32_u24 v36, 1152, v36
 Mvva 156,228,172
  buffer_load_dwordx4 a[112:115], v16, s[20:23], s46 offen offset:0 sc1
 Mvva 160,208,144
 TR 226,57,512
  v_lshrrev_b32 v37, 4, v0
 WL 6
 Mvva 160,212,160
  s_lshl_b32 s69, s3, 5
  v_lshl_add_u32 v36, v37, 3, v36
  v_add_u32 v30, s69, v36
 Mvva 164,208,148
 TR 228,57,9472
  v_and_b32 v247, 3, v0
 Mvva 164,212,164
  buffer_load_dwordx4 a[116:119], v16, s[20:23], s46 offen offset:2048 sc1
 Mvva 168,208,152
 TR 230,57,9984
  v_lshlrev_b32 v247, 2, v247
 Mvva 168,212,168
  buffer_load_dword v248, v247, s[20:23], s54 offen offset:16 sc1
 Mvva 172,208,156
 TR 208,33,18944
  v_lshrrev_b32 v36, 2, v0
 Mvva 172,212,172
 WL 7
  v_bfe_u32 v37, v0, 1, 1
  v_lshl_add_u32 v36, v37, 5, v36
 Mvva 176,216,144
 TR 210,33,19456
  v_mul_u32_u24 v36, 1152, v36
 WL 6
 Mvva 176,220,160
  buffer_load_dwordx4 a[120:123], v17, s[20:23], s46 offen offset:0 sc1
 Mvva 180,216,148
 TR 212,33,28416
  v_and_b32 v37, 1, v0
 Mvva 180,220,164
  s_mov_b32 s44, s25
  s_lshl_b32 s69, s3, 3
  v_lshl_add_u32 v36, v37, 2, v36
 Mvva 184,216,152
 TR 214,33,28928
  s_add_u32 s69, s69, 1024
 Mvva 184,220,168
  buffer_load_dwordx4 a[124:127], v17, s[20:23], s46 offen offset:2048 sc1
 Mvva 188,216,156
 TR 216,33,18976
  v_add_u32 v9, 4096, v9
 Mvva 188,220,172
  s_add_u32 m0, s47, 12288
  s_sub_u32 s69, s69, s31
  v_add_u32 v31, s69, v36
 WL 7
 Mvva 192,224,144
 TR 218,33,19488
  s_mov_b32 s57, 0xffff
 WL 6
 Mvva 192,228,160
  buffer_load_dwordx4 v1, s[40:43], s44 offen lds
 Mvva 196,224,148
 TR 220,33,28448
  s_add_u32 s69, s56, 36864
 Mvva 196,228,164
 Mvva 200,224,152
 TR 222,33,28960
  s_waitcnt vmcnt(45)
 Mvva 200,228,168
  buffer_load_dwordx4 v2, s[40:43], s44 offen offset:1056 lds
 Mvva 204,224,156
 TR 224,33,19008
 WL 7
 Mvva 204,228,172
  buffer_store_dword v246, v245, s[20:23], s66 offen sc1
 Mvva 64,208,0
 TR 226,33,19520
 WL 6
 Mvva 64,212,16
 Mvva 68,208,4
 TR 228,33,28480
 Mvva 68,212,20
  buffer_load_dwordx4 v3, s[40:43], s44 offen offset:2112 lds
 Mvva 72,208,8
 TR 230,33,28992
 Mvva 72,212,24
 Mvva 76,208,12
 TR 208,33,19040
 WL 7
 Mvva 76,212,28
  buffer_load_dwordx4 v4, s[40:43], s44 offen offset:3168 lds
 Mvva 80,216,0
 TR 210,33,19552
 WL 6
 Mvva 80,220,16
  s_add_u32 m0, s47, 16512
 Mvva 84,216,4
 TR 212,33,28512
 Mvva 84,220,20
  buffer_load_dwordx4 v5, s[40:43], s44 offen lds
 Mvva 88,216,8
 TR 214,33,29024
 Mvva 88,220,24
 Mvva 92,216,12
 TR 216,33,19072
 Mvva 92,220,28
 WL 7
 Mvva 96,224,0
 TR 218,33,19584
 WL 6
 Mvva 96,228,16
  buffer_load_dwordx4 v6, s[40:43], s44 offen offset:1056 lds
 Mvva 100,224,4
 TR 220,33,28544
 Mvva 100,228,20
 Mvva 104,224,8
 TR 222,33,29056
 Mvva 104,228,24
  buffer_load_dwordx4 v7, s[40:43], s44 offen offset:2112 lds
 Mvva 108,224,12
 TR 224,33,19104
 Mvva 108,228,28
 WL 7
 Mvva 112,208,0
 TR 226,33,19616
 WL 6
 Mvva 112,212,16
  buffer_load_dwordx4 v8, s[40:43], s44 offen offset:3168 lds
 Mvva 116,208,4
 TR 228,33,28576
 Mvva 116,212,20
 Mvva 120,208,8
 TR 230,33,29088
  s_add_u32 m0, s47, 20736
 Mvva 120,212,24
 Mvva 124,208,12
 TR 208,33,19136
 WL 7
 Mvva 124,212,28
  buffer_load_dwordx4 v9, s[20:23], s44 offen sc1 lds
 Mvva 128,216,0
 TR 210,33,19648
 WL 6
 Mvva 128,220,16
 Mvva 132,216,4
 TR 212,33,28608
 Mvva 132,220,20
 Mvva 136,216,8
 TR 214,33,29120
 Mvva 136,220,24
 Mvva 140,216,12
 TR 216,33,19168
 Mvva 140,220,28
 WL 7
 Mvva 144,224,0
 TR 218,33,19680
 WL 6
 Mvva 144,228,16
 Mvva 148,224,4
 TR 220,33,28640
 Mvva 148,228,20
 Mvva 152,224,8
 TR 222,33,29152
 Mvva 152,228,24
 Mvva 156,224,12
 TR 224,57,18944
 Mvva 156,228,28
 WL 7
 Mvva 160,208,0
 TR 226,57,19456
 WL 6
 Mvva 160,212,16
 Mvva 164,208,4
 TR 228,57,28416
 Mvva 164,212,20
 Mvva 168,208,8
 TR 230,57,28928
 Mvva 168,212,24
 Mvva 172,208,12
  global_load_dword a248, v249, s[100:101]
 Mvva 172,212,28
 WL 6
 Mvva 176,216,0
 WL 4
 Mvva 176,220,16
 WL 0
  s_waitcnt vmcnt(46)
  s_barrier
 Mvva 180,216,4
 TR 208,34,0
  s_add_u32 s44, s44, 1179648
 Mvva 180,220,20
 TR 210,34,512
  s_add_u32 m0, s47, 125952
 Mvva 184,216,8
 TR 212,34,9472
 Mvva 184,220,24
 TR 214,34,9984
 Mvva 188,216,12
 TR 216,34,32
 Mvva 188,220,28
  buffer_load_dwordx4 v1, s[40:43], s44 offen lds
 Mvva 192,224,0
 TR 218,34,544
 Mvva 192,228,16
  buffer_load_dwordx4 v2, s[40:43], s44 offen offset:1056 lds
 Mvva 196,224,4
 TR 220,34,9504
 Mvva 196,228,20
  s_waitcnt vmcnt(15)
  v_cmp_gt_u32 vcc, 1, v248
  s_nop 4
  s_cbranch_vccnz Lpoll_ctx_7
Lback_ctx_7:
 Mvva 200,224,8
 TR 222,34,10016
 Mvva 200,228,24
  s_add_u32 s46, s24, 0
 Mvva 204,224,12
 TR 224,34,64
 WL 7
 Mvva 204,228,28
  buffer_load_dwordx4 a[128:131], v16, s[20:23], s46 offen offset:0 sc1
 Mvva 64,208,32
 TR 226,34,576
 WL 6
 Mvva 64,212,48
  buffer_load_dwordx4 a[132:135], v16, s[20:23], s46 offen offset:2048 sc1
 Mvva 68,208,36
 TR 228,34,9536
 Mvva 68,212,52
 Mvva 72,208,40
 TR 230,34,10048
 Mvva 72,212,56
  buffer_load_dwordx4 a[136:139], v17, s[20:23], s46 offen offset:0 sc1
 Mvva 76,208,44
 TR 208,34,96
 Mvva 76,212,60
 WL 7
 Mvva 80,216,32
 TR 210,34,608
 WL 6
 Mvva 80,220,48
 Mvva 84,216,36
 TR 212,34,9568
 Mvva 84,220,52
  buffer_load_dwordx4 a[140:143], v17, s[20:23], s46 offen offset:2048 sc1
 Mvva 88,216,40
 TR 214,34,10080
  s_add_u32 s46, s24, 8192
 Mvva 88,220,56
 Mvva 92,216,44
 TR 216,34,128
 WL 7
 Mvva 92,220,60
  buffer_load_dwordx4 v[40:43], v16, s[20:23], s46 offen offset:0 sc1
 Mvva 96,224,32
 TR 218,34,640
 WL 6
 Mvva 96,228,48
 Mvva 100,224,36
 TR 220,34,9600
 Mvva 100,228,52
  buffer_load_dwordx4 v[44:47], v16, s[20:23], s46 offen offset:2048 sc1
 Mvva 104,224,40
 TR 222,34,10112
 Mvva 104,228,56
 Mvva 108,224,44
 TR 224,34,160
 WL 7
 Mvva 108,228,60
  buffer_load_dwordx4 v[48:51], v17, s[20:23], s46 offen offset:0 sc1
 Mvva 112,208,32
 TR 226,34,672
 WL 6
 Mvva 112,212,48
 Mvva 116,208,36
 TR 228,34,9632
 Mvva 116,212,52
 Mvva 120,208,40
 TR 230,34,10144
 Mvva 120,212,56
  buffer_load_dwordx4 v[52:55], v17, s[20:23], s46 offen offset:2048 sc1
 Mvva 124,208,44
 TR 208,34,192
 Mvva 124,212,60
  s_add_u32 s46, s24, 16384
 WL 7
 Mvva 128,216,32
 TR 210,34,704
 WL 6
 Mvva 128,220,48
  buffer_load_dwordx4 a[212:215], v16, s[20:23], s46 offen offset:0 sc1
 Mvva 132,216,36
 TR 212,34,9664
 Mvva 132,220,52
 Mvva 136,216,40
 TR 214,34,10176
 Mvva 136,220,56
  buffer_load_dwordx4 a[216:219], v16, s[20:23], s46 offen offset:2048 sc1
 Mvva 140,216,44
 TR 216,34,224
 Mvva 140,220,60
 WL 7
 Mvva 144,224,32
 TR 218,34,736
 WL 6
 Mvva 144,228,48
 Mvva 148,224,36
 TR 220,34,9696
 Mvva 148,228,52
  buffer_load_dwordx4 a[220:223], v17, s[20:23], s46 offen offset:0 sc1
 Mvva 152,224,40
 TR 222,34,10208
 Mvva 152,228,56
 Mvva 156,224,44
 TR 224,58,0
 WL 7
 Mvva 156,228,60
  buffer_load_dwordx4 a[224:227], v17, s[20:23], s46 offen offset:2048 sc1
 Mvva 160,208,32
 TR 226,58,512
 WL 6
 Mvva 160,212,48
  s_add_u32 s46, s24, 24576
 Mvva 164,208,36
 TR 228,58,9472
 Mvva 164,212,52
  buffer_load_dwordx4 a[228:231], v16, s[20:23], s46 offen offset:0 sc1
 Mvva 168,208,40
 TR 230,58,9984
 Mvva 168,212,56
 Mvva 172,208,44
 TR 208,34,18944
 Mvva 172,212,60
 WL 7
 Mvva 176,216,32
 TR 210,34,19456
 WL 6
 Mvva 176,220,48
  buffer_load_dwordx4 a[232:235], v16, s[20:23], s46 offen offset:2048 sc1
 Mvva 180,216,36
 TR 212,34,28416
 Mvva 180,220,52
 Mvva 184,216,40
 TR 214,34,28928
 Mvva 184,220,56
  buffer_load_dwordx4 a[236:239], v17, s[20:23], s46 offen offset:0 sc1
 Mvva 188,216,44
 TR 216,34,18976
 Mvva 188,220,60
 WL 7
 Mvva 192,224,32
 TR 218,34,19488
 WL 6
 Mvva 192,228,48
  buffer_load_dwordx4 a[240:243], v17, s[20:23], s46 offen offset:2048 sc1
 Mvva 196,224,36
 TR 220,34,28448
 Mvva 196,228,52
 Mvva 200,224,40
 TR 222,34,28960
 Mvva 200,228,56
  buffer_load_dwordx4 v3, s[40:43], s44 offen offset:2112 lds
 Mvva 204,224,44
 TR 224,34,19008
 Mvva 204,228,60
 WL 7
 Mvva 64,208,64
 TR 226,34,19520
 WL 6
 Mvva 64,212,80
 Mvva 68,208,68
 TR 228,34,28480
 Mvva 68,212,84
  buffer_load_dwordx4 v4, s[40:43], s44 offen offset:3168 lds
 Mvva 72,208,72
 TR 230,34,28992
 Mvva 72,212,88
  s_add_u32 m0, s47, 130176
 Mvva 76,208,76
 TR 208,34,19040
 WL 7
 Mvva 76,212,92
  buffer_load_dwordx4 v5, s[40:43], s44 offen lds
 Mvva 80,216,64
 TR 210,34,19552
 WL 6
 Mvva 80,220,80
 Mvva 84,216,68
 TR 212,34,28512
 Mvva 84,220,84
  buffer_load_dwordx4 v6, s[40:43], s44 offen offset:1056 lds
 Mvva 88,216,72
 TR 214,34,29024
 Mvva 88,220,88
 Mvva 92,216,76
 TR 216,34,19072
 Mvva 92,220,92
 WL 7
 Mvva 96,224,64
 TR 218,34,19584
 WL 6
 Mvva 96,228,80
  buffer_load_dwordx4 v7, s[40:43], s44 offen offset:2112 lds
 Mvva 100,224,68
 TR 220,34,28544
 Mvva 100,228,84
 Mvva 104,224,72
 TR 222,34,29056
 Mvva 104,228,88
  buffer_load_dwordx4 v8, s[40:43], s44 offen offset:3168 lds
 Mvva 108,224,76
 TR 224,34,19104
 Mvva 108,228,92
  s_add_u32 m0, s47, 134400
 WL 7
 Mvva 112,208,64
 TR 226,34,19616
 WL 6
 Mvva 112,212,80
  buffer_load_dwordx4 v9, s[20:23], s44 offen sc1 lds
 Mvva 116,208,68
 TR 228,34,28576
 Mvva 116,212,84
 Mvva 120,208,72
 TR 230,34,29088
  s_add_u32 s46, s24, 32768
 Mvva 120,212,88
 Mvva 124,208,76
 TR 208,34,19136
 WL 7
 Mvva 124,212,92
  buffer_load_dwordx4 a[176:179], v16, s[20:23], s46 offen offset:0 sc1
 Mvva 128,216,64
 TR 210,34,19648
 WL 6
 Mvva 128,220,80
 Mvva 132,216,68
 TR 212,34,28608
 Mvva 132,220,84
  buffer_load_dwordx4 a[180:183], v16, s[20:23], s46 offen offset:2048 sc1
 Mvva 136,216,72
 TR 214,34,29120
 Mvva 136,220,88
 Mvva 140,216,76
 TR 216,34,19168
 WL 7
 Mvva 140,220,92
  buffer_load_dwordx4 a[184:187], v17, s[20:23], s46 offen offset:0 sc1
 Mvva 144,224,64
 TR 218,34,19680
 WL 6
 Mvva 144,228,80
 Mvva 148,224,68
 TR 220,34,28640
 Mvva 148,228,84
  buffer_load_dwordx4 a[188:191], v17, s[20:23], s46 offen offset:2048 sc1
 Mvva 152,224,72
 TR 222,34,29152
 Mvva 152,228,88
 Mvva 156,224,76
 TR 224,58,18944
  s_add_u32 s46, s24, 40960
 Mvva 156,228,92
 WL 7
 Mvva 160,208,64
 TR 226,58,19456
 WL 6
 Mvva 160,212,80
  buffer_load_dwordx4 a[192:195], v16, s[20:23], s46 offen offset:0 sc1
 Mvva 164,208,68
 TR 228,58,28416
 Mvva 164,212,84
 Mvva 168,208,72
 TR 230,58,28928
 Mvva 168,212,88
  buffer_load_dwordx4 a[196:199], v16, s[20:23], s46 offen offset:2048 sc1
 Mvva 172,208,76
 Mvva 172,212,92
 WL 6
 Mvva 176,216,64
 WL 4
 Mvva 176,220,80
 WL 0
  s_barrier
 Mvva 180,216,68
 TR 208,35,0
 Mvva 180,220,84
 TR 210,35,512
 Mvva 184,216,72
 TR 212,35,9472
 Mvva 184,220,88
 TR 214,35,9984
 Mvva 188,216,76
 TR 216,35,32
  s_add_u32 s44, s44, 1179648
 Mvva 188,220,92
  buffer_load_dwordx4 a[200:203], v17, s[20:23], s46 offen offset:0 sc1
 Mvva 192,224,64
 TR 218,35,544
  s_add_u32 m0, s47, 50176
 Mvva 192,228,80
  buffer_load_dwordx4 a[204:207], v17, s[20:23], s46 offen offset:2048 sc1
 Mvva 196,224,68
 TR 220,35,9504
 Mvva 196,228,84
  buffer_load_dwordx4 v1, s[40:43], s44 offen lds
 Mvva 200,224,72
 TR 222,35,10016
  s_waitcnt vmcnt(45)
 Mvva 200,228,88
 Mvva 204,224,76
 TR 224,35,64
 WL 7
 Mvva 204,228,92
  buffer_load_dwordx4 v2, s[40:43], s44 offen offset:1056 lds
 Mvva 64,208,96
 TR 226,35,576
 WL 6
 Mvva 64,212,112
 Mvva 68,208,100
 TR 228,35,9536
 Mvva 68,212,116
 Mvva 72,208,104
 TR 230,35,10048
 Mvva 72,212,120
  buffer_load_dwordx4 v3, s[40:43], s44 offen offset:2112 lds
 Mvva 76,208,108
 TR 208,35,96
 Mvva 76,212,124
 WL 7
 Mvva 80,216,96
 TR 210,35,608
 WL 6
 Mvva 80,220,112
  buffer_load_dwordx4 v4, s[40:43], s44 offen offset:3168 lds
 Mvva 84,216,100
 TR 212,35,9568
 Mvva 84,220,116
  s_add_u32 m0, s47, 54400
 Mvva 88,216,104
 TR 214,35,10080
 Mvva 88,220,120
  buffer_load_dwordx4 v5, s[40:43], s44 offen lds
 Mvva 92,216,108
 TR 216,35,128
 Mvva 92,220,124
 WL 7
 Mvva 96,224,96
 TR 218,35,640
 WL 6
 Mvva 96,228,112
  buffer_load_dwordx4 v6, s[40:43], s44 offen offset:1056 lds
 Mvva 100,224,100
 TR 220,35,9600
 Mvva 100,228,116
 Mvva 104,224,104
 TR 222,35,10112
 Mvva 104,228,120
 Mvva 108,224,108
 TR 224,35,160
 WL 7
 Mvva 108,228,124
  buffer_load_dwordx4 v7, s[40:43], s44 offen offset:2112 lds
 Mvva 112,208,96
 TR 226,35,672
 WL 6
 Mvva 112,212,112
 Mvva 116,208,100
 TR 228,35,9632
 Mvva 116,212,116
  buffer_load_dwordx4 v8, s[40:43], s44 offen offset:3168 lds
 Mvva 120,208,104
 TR 230,35,10144
 Mvva 120,212,120
  s_add_u32 m0, s47, 58624
 Mvva 124,208,108
 TR 208,35,192
 WL 7
 Mvva 124,212,124
  buffer_load_dwordx4 v9, s[20:23], s44 offen sc1 lds
 Mvva 128,216,96
 TR 210,35,704
 WL 6
 Mvva 128,220,112
 Mvva 132,216,100
 TR 212,35,9664
  s_add_u32 s46, s24, 49152
 Mvva 132,220,116
 Mvva 136,216,104
 TR 214,35,10176
 Mvva 136,220,120
  buffer_load_dwordx4 a[144:147], v16, s[20:23], s46 offen offset:0 sc1
 Mvva 140,216,108
 TR 216,35,224
 Mvva 140,220,124
 WL 7
 Mvva 144,224,96
 TR 218,35,736
 WL 6
 Mvva 144,228,112
  buffer_load_dwordx4 a[148:151], v16, s[20:23], s46 offen offset:2048 sc1
 Mvva 148,224,100
 TR 220,35,9696
 Mvva 148,228,116
 Mvva 152,224,104
 TR 222,35,10208
 Mvva 152,228,120
  buffer_load_dwordx4 a[152:155], v17, s[20:23], s46 offen offset:0 sc1
 Mvva 156,224,108
 TR 224,59,0
 Mvva 156,228,124
 WL 7
 Mvva 160,208,96
 TR 226,59,512
 WL 6
 Mvva 160,212,112
 Mvva 164,208,100
 TR 228,59,9472
 Mvva 164,212,116
  buffer_load_dwordx4 a[156:159], v17, s[20:23], s46 offen offset:2048 sc1
 Mvva 168,208,104
 TR 230,59,9984
  s_add_u32 s46, s24, 57344
 Mvva 168,212,120
 Mvva 172,208,108
  buffer_load_dwordx4 a[160:163], v16, s[20:23], s46 offen offset:0 sc1
 Mvva 172,212,124
 WL 6
 Mvva 176,216,96
 WL 4
 Mvva 176,220,112
 WL 0
  s_waitcnt vmcnt(48)
  s_barrier
 Mvva 180,216,100
 TR 208,32,0
 Mvva 180,220,116
 TR 210,32,512
 Mvva 184,216,104
 TR 212,32,9472
 Mvva 184,220,120
 TR 214,32,9984
 Mvva 188,216,108
 TR 216,32,32
 Mvva 188,220,124
  buffer_load_dwordx4 a[164:167], v16, s[20:23], s46 offen offset:2048 sc1
 Mvva 192,224,96
 TR 218,32,544
 Mvva 192,228,112
  buffer_load_dwordx4 a[168:171], v17, s[20:23], s46 offen offset:0 sc1
 Mvva 196,224,100
 TR 220,32,9504
 Mvva 196,228,116
 Mvva 200,224,104
 TR 222,32,10016
  s_waitcnt vmcnt(39)
 Mvva 200,228,120
  buffer_load_dwordx4 a[172:175], v17, s[20:23], s46 offen offset:2048 sc1
 Mvva 204,224,108
 TR 224,32,64
 Mvva 204,228,124
  s_add_u32 s46, s24, 65536
 WL 7
 Mvva 64,208,128
 TR 226,32,576
 WL 6
 Mvvv 64,212,40
  buffer_load_dwordx4 a[0:3], v16, s[20:23], s46 offen offset:0 sc1
 Mvva 68,208,132
 TR 228,32,9536
 Mvvv 68,212,44
 Mvva 72,208,136
 TR 230,32,10048
 Mvvv 72,212,48
  buffer_load_dwordx4 a[4:7], v16, s[20:23], s46 offen offset:2048 sc1
 Mvva 76,208,140
 TR 208,32,96
 Mvvv 76,212,52
 WL 7
 Mvva 80,216,128
 TR 210,32,608
 WL 6
 Mvvv 80,220,40
 Mvva 84,216,132
 TR 212,32,9568
 Mvvv 84,220,44
  buffer_load_dwordx4 a[8:11], v17, s[20:23], s46 offen offset:0 sc1
 Mvva 88,216,136
 TR 214,32,10080
 Mvvv 88,220,48
 Mvva 92,216,140
 TR 216,32,128
 WL 7
 Mvvv 92,220,52
  buffer_load_dwordx4 a[12:15], v17, s[20:23], s46 offen offset:2048 sc1
 Mvva 96,224,128
 TR 218,32,640
 WL 6
 Mvvv 96,228,40
  s_add_u32 s46, s24, 73728
 Mvva 100,224,132
 TR 220,32,9600
 Mvvv 100,228,44
  buffer_load_dwordx4 a[16:19], v16, s[20:23], s46 offen offset:0 sc1
 Mvva 104,224,136
 TR 222,32,10112
 Mvvv 104,228,48
 Mvva 108,224,140
 TR 224,32,160
 Mvvv 108,228,52
 WL 7
 Mvva 112,208,128
 TR 226,32,672
 WL 6
 Mvvv 112,212,40
  buffer_load_dwordx4 a[20:23], v16, s[20:23], s46 offen offset:2048 sc1
 Mvva 116,208,132
 TR 228,32,9632
 Mvvv 116,212,44
 Mvva 120,208,136
 TR 230,32,10144
 Mvvv 120,212,48
  buffer_load_dwordx4 a[24:27], v17, s[20:23], s46 offen offset:0 sc1
 Mvva 124,208,140
 TR 208,32,192
 Mvvv 124,212,52
 WL 7
 Mvva 128,216,128
 TR 210,32,704
 WL 6
 Mvvv 128,220,40
  buffer_load_dwordx4 a[28:31], v17, s[20:23], s46 offen offset:2048 sc1
 Mvva 132,216,132
 TR 212,32,9664
  s_add_u32 s44, s44, 1179648
 Mvvv 132,220,44
  s_add_u32 m0, s47, 88064
 Mvva 136,216,136
 TR 214,32,10176
 Mvvv 136,220,48
  buffer_load_dwordx4 v1, s[40:43], s44 offen lds
 Mvva 140,216,140
 TR 216,32,224
 WL 7
 Mvvv 140,220,52
  global_load_dword a248, v249, s[100:101]
 Mvva 144,224,128
 TR 218,32,736
 WL 6
 Mvvv 144,228,40
 Mvva 148,224,132
 TR 220,32,9696
 Mvvv 148,228,44
  buffer_load_dwordx4 v2, s[40:43], s44 offen offset:1056 lds
 Mvva 152,224,136
 TR 222,32,10208
 Mvvv 152,228,48
 Mvva 156,224,140
 TR 224,56,0
 WL 7
 Mvvv 156,228,52
  buffer_load_dwordx4 v3, s[40:43], s44 offen offset:2112 lds
 Mvva 160,208,128
 TR 226,56,512
 WL 6
 Mvvv 160,212,40
 Mvva 164,208,132
 TR 228,56,9472
 Mvvv 164,212,44
  buffer_load_dwordx4 v4, s[40:43], s44 offen offset:3168 lds
 Mvva 168,208,136
 TR 230,56,9984
 Mvvv 168,212,48
 Mvva 172,208,140
 TR 208,32,18944
  s_add_u32 m0, s47, 92288
 Mvvv 172,212,52
 WL 7
 Mvva 176,216,128
 TR 210,32,19456
 WL 6
 Mvvv 176,220,40
  buffer_load_dwordx4 v5, s[40:43], s44 offen lds
 Mvva 180,216,132
 TR 212,32,28416
 Mvvv 180,220,44
 Mvva 184,216,136
 TR 214,32,28928
 Mvvv 184,220,48
  buffer_load_dwordx4 v6, s[40:43], s44 offen offset:1056 lds
 Mvva 188,216,140
 TR 216,32,18976
 Mvvv 188,220,52
 WL 7
 Mvva 192,224,128
 TR 218,32,19488
 WL 6
 Mvvv 192,228,40
  buffer_load_dwordx4 v7, s[40:43], s44 offen offset:2112 lds
 Mvva 196,224,132
 TR 220,32,28448
 Mvvv 196,228,44
 Mvva 200,224,136
 TR 222,32,28960
  s_waitcnt vmcnt(48)
 Mvvv 200,228,48
 WL 4
 Mvva 204,224,140
 TR 224,32,19008
 WL 7
 Mvvv 204,228,52
  buffer_load_dwordx4 v8, s[40:43], s44 offen offset:3168 lds
 Mvva 64,208,212
 TR 226,32,19520
  s_add_u32 m0, s47, 96512
 Mvva 64,212,228
 Mvva 68,208,216
 TR 228,32,28480
 Mvva 68,212,232
  buffer_load_dwordx4 v9, s[20:23], s44 offen sc1 lds
 Mvva 72,208,220
 TR 230,32,28992
 Mvva 72,212,236
  s_add_u32 s46, s24, 81920
 Mvva 76,208,224
 TR 208,32,19040
 WL 7
 Mvva 76,212,240
  buffer_load_dwordx4 a[32:35], v16, s[20:23], s46 offen offset:0 sc1
 Mvva 80,216,212
 TR 210,32,19552
 WL 6
 Mvva 80,220,228
 Mvva 84,216,216
 TR 212,32,28512
 Mvva 84,220,232
  buffer_load_dwordx4 a[36:39], v16, s[20:23], s46 offen offset:2048 sc1
 Mvva 88,216,220
 TR 214,32,29024
 Mvva 88,220,236
 Mvva 92,216,224
 TR 216,32,19072
 Mvva 92,220,240
 WL 7
 Mvva 96,224,212
 TR 218,32,19584
 WL 6
 Mvva 96,228,228
  buffer_load_dwordx4 a[40:43], v17, s[20:23], s46 offen offset:0 sc1
 Mvva 100,224,216
 TR 220,32,28544
 Mvva 100,228,232
 Mvva 104,224,220
 TR 222,32,29056
 Mvva 104,228,236
  buffer_load_dwordx4 a[44:47], v17, s[20:23], s46 offen offset:2048 sc1
 Mvva 108,224,224
 TR 224,32,19104
 Mvva 108,228,240
  s_add_u32 s46, s24, 90112
 WL 7
 Mvva 112,208,212
 TR 226,32,19616
 WL 6
 Mvva 112,212,228
  buffer_load_dwordx4 a[48:51], v16, s[20:23], s46 offen offset:0 sc1
 Mvva 116,208,216
 TR 228,32,28576
 Mvva 116,212,232
 Mvva 120,208,220
 TR 230,32,29088
 Mvva 120,212,236
 Mvva 124,208,224
 TR 208,32,19136
 WL 7
 Mvva 124,212,240
  buffer_load_dwordx4 a[52:55], v16, s[20:23], s46 offen offset:2048 sc1
 Mvva 128,216,212
 TR 210,32,19648
 WL 6
 Mvva 128,220,228
 Mvva 132,216,216
 TR 212,32,28608
 Mvva 132,220,232
  buffer_load_dwordx4 a[56:59], v17, s[20:23], s46 offen offset:0 sc1
 Mvva 136,216,220
 TR 214,32,29120
 Mvva 136,220,236
 Mvva 140,216,224
 TR 216,32,19168
 WL 7
 Mvva 140,220,240
  buffer_load_dwordx4 a[60:63], v17, s[20:23], s46 offen offset:2048 sc1
 Mvva 144,224,212
 TR 218,32,19680
 WL 6
 Mvva 144,228,228
 Mvva 148,224,216
 TR 220,32,28640
  s_add_u32 s46, s24, 98304
 Mvva 148,228,232
 Mvva 152,224,220
 TR 222,32,29152
 Mvva 152,228,236
  buffer_load_dwordx4 a[64:67], v16, s[20:23], s46 offen offset:0 sc1
 Mvva 156,224,224
 TR 224,56,18944
 Mvva 156,228,240
 WL 7
 Mvva 160,208,212
 TR 226,56,19456
 WL 6
 Mvva 160,212,228
  buffer_load_dwordx4 a[68:71], v16, s[20:23], s46 offen offset:2048 sc1
 Mvva 164,208,216
 TR 228,56,28416
 Mvva 164,212,232
 Mvva 168,208,220
 TR 230,56,28928
 Mvva 168,212,236
  buffer_load_dwordx4 a[72:75], v17, s[20:23], s46 offen offset:0 sc1
 Mvva 172,208,224
 Mvva 172,212,240
 WL 6
 Mvva 176,216,212
 WL 4
 Mvva 176,220,228
 WL 0
  s_waitcnt vmcnt(54)
  s_barrier
 Mvva 180,216,216
 TR 208,33,0
 Mvva 180,220,232
 TR 210,33,512
 Mvva 184,216,220
 TR 212,33,9472
 Mvva 184,220,236
 TR 214,33,9984
 Mvva 188,216,224
 TR 216,33,32
 Mvva 188,220,240
  buffer_load_dwordx4 a[76:79], v17, s[20:23], s46 offen offset:2048 sc1
 Mvva 192,224,212
 TR 218,33,544
  s_add_u32 s46, s24, 106496
 Mvva 192,228,228
  buffer_load_dwordx4 a[80:83], v16, s[20:23], s46 offen offset:0 sc1
 Mvva 196,224,216
 TR 220,33,9504
 Mvva 196,228,232
  buffer_load_dwordx4 a[84:87], v16, s[20:23], s46 offen offset:2048 sc1
 Mvva 200,224,220
 TR 222,33,10016
  s_waitcnt vmcnt(49)
 Mvva 200,228,236
 Mvva 204,224,224
 TR 224,33,64
 WL 7
 Mvva 204,228,240
  buffer_load_dwordx4 a[88:91], v17, s[20:23], s46 offen offset:0 sc1
 Mvva 64,208,176
 TR 226,33,576
 WL 6
 Mvva 64,212,192
 Mvva 68,208,180
 TR 228,33,9536
 Mvva 68,212,196
 Mvva 72,208,184
 TR 230,33,10048
 Mvva 72,212,200
  buffer_load_dwordx4 a[92:95], v17, s[20:23], s46 offen offset:2048 sc1
 Mvva 76,208,188
 TR 208,33,96
  s_add_u32 s46, s24, 114688
 Mvva 76,212,204
 WL 7
 Mvva 80,216,176
 TR 210,33,608
 WL 6
 Mvva 80,220,192
  buffer_load_dwordx4 a[96:99], v16, s[20:23], s46 offen offset:0 sc1
 Mvva 84,216,180
 TR 212,33,9568
 Mvva 84,220,196
 Mvva 88,216,184
 TR 214,33,10080
 Mvva 88,220,200
  buffer_load_dwordx4 a[100:103], v16, s[20:23], s46 offen offset:2048 sc1
 Mvva 92,216,188
 TR 216,33,128
 Mvva 92,220,204
 WL 7
 Mvva 96,224,176
 TR 218,33,640
 WL 6
 Mvva 96,228,192
 Mvva 100,224,180
 TR 220,33,9600
 Mvva 100,228,196
  buffer_load_dwordx4 a[104:107], v17, s[20:23], s46 offen offset:0 sc1
 Mvva 104,224,184
 TR 222,33,10112
 Mvva 104,228,200
 Mvva 108,224,188
 TR 224,33,160
 WL 7
 Mvva 108,228,204
  buffer_load_dwordx4 a[108:111], v17, s[20:23], s46 offen offset:2048 sc1
 Mvva 112,208,176
 TR 226,33,672
 WL 6
 Mvva 112,212,192
  s_add_u32 s46, s24, 122880
 Mvva 116,208,180
 TR 228,33,9632
 Mvva 116,212,196
  buffer_load_dwordx4 a[112:115], v16, s[20:23], s46 offen offset:0 sc1
 Mvva 120,208,184
 TR 230,33,10144
 Mvva 120,212,200
 Mvva 124,208,188
 TR 208,33,192
 WL 7
 Mvva 124,212,204
  buffer_load_dwordx4 a[116:119], v16, s[20:23], s46 offen offset:2048 sc1
 Mvva 128,216,176
 TR 210,33,704
 WL 6
 Mvva 128,220,192
 Mvva 132,216,180
 TR 212,33,9664
 Mvva 132,220,196
 Mvva 136,216,184
 TR 214,33,10176
 Mvva 136,220,200
  buffer_load_dwordx4 a[120:123], v17, s[20:23], s46 offen offset:0 sc1
 Mvva 140,216,188
 TR 216,33,224
 Mvva 140,220,204
 WL 7
 Mvva 144,224,176
 TR 218,33,736
 WL 6
 Mvva 144,228,192
  buffer_load_dwordx4 a[124:127], v17, s[20:23], s46 offen offset:2048 sc1
 Mvva 148,224,180
 TR 220,33,9696
 Mvva 148,228,196
 Mvva 152,224,184
 TR 222,33,10208
 Mvva 152,228,200
 Mvva 156,224,188
 TR 224,57,0
 Mvva 156,228,204
 WL 7
 Mvva 160,208,176
 TR 226,57,512
 WL 6
 Mvva 160,212,192
 Mvva 164,208,180
 TR 228,57,9472
 Mvva 164,212,196
 Mvva 168,208,184
 TR 230,57,9984
 Mvva 168,212,200
 Mvva 172,208,188
 TR 208,33,18944
 Mvva 172,212,204
 WL 7
 Mvva 176,216,176
 TR 210,33,19456
 WL 6
 Mvva 176,220,192
 Mvva 180,216,180
 TR 212,33,28416
 Mvva 180,220,196
 Mvva 184,216,184
 TR 214,33,28928
 Mvva 184,220,200
 Mvva 188,216,188
 Mvva 188,220,204
 WL 6
 Mvva 192,224,176
 WL 4
 Mvva 192,228,192
 WL 0
  s_waitcnt vmcnt(50)
  s_barrier
 Mvva 196,224,180
 TR 216,34,0
 Mvva 196,228,196
 TR 218,34,512
 Mvva 200,224,184
 TR 220,34,9472
  s_waitcnt vmcnt(42)
 Mvva 200,228,200
 TR 222,34,9984
 Mvva 204,224,188
 TR 224,34,18944
 Mvva 204,228,204
 Mvva 64,208,144
 TR 226,34,19456
 Mvva 64,212,160
 Mvva 68,208,148
 TR 228,34,28416
 Mvva 68,212,164
 Mvva 72,208,152
 TR 230,34,28928
  s_waitcnt vmcnt(34)
 Mvva 72,212,168
 Mvva 76,208,156
 Mvva 76,212,172
 WL 6
 Mvva 64,216,0
 WL 4
 Mvva 64,220,16
 WL 0
  s_waitcnt vmcnt(24)
  s_barrier
 Mvva 68,216,4
 TR 208,35,0
 Mvva 68,220,20
 TR 210,35,512
 Mvva 72,216,8
 TR 212,35,9472
  s_waitcnt vmcnt(16)
 Mvva 72,220,24
 TR 214,35,9984
 Mvva 76,216,12
 TR 216,35,18944
 Mvva 76,220,28
 Mvva 64,224,32
 TR 218,35,19456
 Mvva 64,228,48
 Mvva 68,224,36
 TR 220,35,28416
 Mvva 68,228,52
 Mvva 72,224,40
 TR 222,35,28928
  s_waitcnt vmcnt(8)
 Mvva 72,228,56
 Mvva 76,224,44
 TR 224,33,18976
 Mvva 76,228,60
 WL 7
 Mvva 64,208,64
 TR 226,33,19488
 WL 6
 Mvva 64,212,80
 Mvva 68,208,68
 TR 228,33,28448
 Mvva 68,212,84
 Mvva 72,208,72
 TR 230,33,28960
  s_waitcnt vmcnt(0)
 Mvva 72,212,88
 Mvva 76,208,76
 TR 208,34,32
 Mvva 76,212,92
 WL 7
 Mvva 64,216,96
 TR 210,34,544
 WL 6
 Mvva 64,220,112
 Mvva 68,216,100
 TR 212,34,9504
 Mvva 68,220,116
 Mvva 72,216,104
 TR 214,34,10016
 Mvva 72,220,120
  global_load_dword a248, v249, s[100:101]
 Mvva 76,216,108
 TR 216,34,18976
 Mvva 76,220,124
 WL 7
 WL 5
 Mvva 80,224,144
 TR 218,34,19488
  v_and_b32 v247, 7, v0
 Mvva 80,228,160
  v_lshlrev_b32 v247, 2, v247
  v_cvt_pk_bf16_f32 v64, v64, v65
 Mvva 84,224,148
 TR 220,34,28448
  v_cvt_pk_bf16_f32 v65, v66, v67
 Mvva 84,228,164
  buffer_load_dword v248, v247, s[20:23], s54 offen offset:32 sc1
 Mvva 88,224,152
 TR 222,34,28960
  v_cvt_pk_bf16_f32 v66, v68, v69
 Mvva 88,228,168
  v_cvt_pk_bf16_f32 v67, v70, v71
  v_min_u32 v64, -2, v64
 Mvva 92,224,156
 TR 224,35,32
  v_min_u32 v65, -2, v65
 Mvva 92,228,172
 WL 7
  v_min_u32 v66, -2, v66
  v_min_u32 v67, -2, v67
 Mvva 80,208,0
 TR 226,35,544
 WL 6
 Mvva 80,212,16
  buffer_store_dwordx4 v[64:67], v16, s[8:11], 0 offen offset:0 sc1
 Mvva 84,208,4
 TR 228,35,9504
  v_cvt_pk_bf16_f32 v72, v72, v73
 Mvva 84,212,20
  v_cvt_pk_bf16_f32 v73, v74, v75
  v_cvt_pk_bf16_f32 v74, v76, v77
 Mvva 88,208,8
 TR 230,35,10016
  v_cvt_pk_bf16_f32 v75, v78, v79
 Mvva 88,212,24
  v_min_u32 v72, -2, v72
  v_min_u32 v73, -2, v73
 Mvva 92,208,12
 TR 208,35,18976
  v_min_u32 v74, -2, v74
 Mvva 92,212,28
  v_min_u32 v75, -2, v75
 WL 7
 Mvva 80,216,32
 TR 210,35,19488
 WL 6
 Mvva 80,220,48
  buffer_store_dwordx4 v[72:75], v16, s[8:11], s50 offen offset:1024 sc1
 Mvva 84,216,36
 TR 212,35,28448
 Mvva 84,220,52
 Mvva 88,216,40
 TR 214,35,28960
  v_mov_b32 v246, 2
 Mvva 88,220,56
 Mvva 92,216,44
 TR 216,33,19008
 Mvva 92,220,60
 WL 7
 Mvva 80,224,64
 TR 218,33,19520
 WL 6
 Mvva 80,228,80
 Mvva 84,224,68
 TR 220,33,28480
 Mvva 84,228,84
 Mvva 88,224,72
 TR 222,33,28992
 Mvva 88,228,88
 Mvva 92,224,76
 TR 224,34,64
 Mvva 92,228,92
 WL 7
 Mvva 80,208,96
 TR 226,34,576
 WL 6
 Mvva 80,212,112
 Mvva 84,208,100
 TR 228,34,9536
 Mvva 84,212,116
 Mvva 88,208,104
 TR 230,34,10048
 Mvva 88,212,120
 Mvva 92,208,108
 TR 208,34,19008
 Mvva 92,212,124
 WL 7
 WL 5
 Mvva 96,216,144
 TR 210,34,19520
  v_cvt_pk_bf16_f32 v80, v80, v81
 Mvva 96,220,160
  v_cvt_pk_bf16_f32 v81, v82, v83
  v_cvt_pk_bf16_f32 v82, v84, v85
 Mvva 100,216,148
 TR 212,34,28480
  v_cvt_pk_bf16_f32 v83, v86, v87
 Mvva 100,220,164
  v_min_u32 v80, -2, v80
  v_min_u32 v81, -2, v81
 Mvva 104,216,152
 TR 214,34,28992
  v_min_u32 v82, -2, v82
 Mvva 104,220,168
  v_min_u32 v83, -2, v83
 WL 4
 Mvva 108,216,156
 TR 216,35,64
 WL 7
 Mvva 108,220,172
  buffer_store_dwordx4 v[80:83], v16, s[8:11], 0 offen offset:1024 sc1
 Mvva 96,224,0
 TR 218,35,576
  v_cvt_pk_bf16_f32 v88, v88, v89
 Mvva 96,228,16
  v_cvt_pk_bf16_f32 v89, v90, v91
  v_cvt_pk_bf16_f32 v90, v92, v93
 Mvva 100,224,4
 TR 220,35,9536
  v_cvt_pk_bf16_f32 v91, v94, v95
 Mvva 100,228,20
  v_min_u32 v88, -2, v88
  v_min_u32 v89, -2, v89
 Mvva 104,224,8
 TR 222,35,10048
  v_min_u32 v90, -2, v90
 Mvva 104,228,24
  v_min_u32 v91, -2, v91
 Mvva 108,224,12
 TR 224,35,19008
 WL 7
 Mvva 108,228,28
  buffer_store_dwordx4 v[88:91], v16, s[8:11], s50 offen offset:2048 sc1
 Mvva 96,208,32
 TR 226,35,19520
 WL 6
 Mvva 96,212,48
 Mvva 100,208,36
 TR 228,35,28480
 Mvva 100,212,52
 Mvva 104,208,40
 TR 230,35,28992
 Mvva 104,212,56
 Mvva 108,208,44
 TR 208,33,19040
 Mvva 108,212,60
 WL 7
 Mvva 96,216,64
 TR 210,33,19552
 WL 6
 Mvva 96,220,80
 Mvva 100,216,68
 TR 212,33,28512
 Mvva 100,220,84
 Mvva 104,216,72
 TR 214,33,29024
 Mvva 104,220,88
 Mvva 108,216,76
 TR 216,34,96
 Mvva 108,220,92
 WL 7
 Mvva 96,224,96
 TR 218,34,608
 WL 6
 Mvva 96,228,112
 Mvva 100,224,100
 TR 220,34,9568
 Mvva 100,228,116
 Mvva 104,224,104
 TR 222,34,10080
 Mvva 104,228,120
 Mvva 108,224,108
 TR 224,34,19040
 Mvva 108,228,124
 WL 7
 WL 5
 Mvva 112,208,144
 TR 226,34,19552
  v_cvt_pk_bf16_f32 v96, v96, v97
 Mvva 112,212,160
  v_cvt_pk_bf16_f32 v97, v98, v99
  v_cvt_pk_bf16_f32 v98, v100, v101
 Mvva 116,208,148
 TR 228,34,28512
  v_cvt_pk_bf16_f32 v99, v102, v103
 Mvva 116,212,164
  v_min_u32 v96, -2, v96
  v_min_u32 v97, -2, v97
 Mvva 120,208,152
 TR 230,34,29024
  v_min_u32 v98, -2, v98
 Mvva 120,212,168
  v_min_u32 v99, -2, v99
 WL 4
 Mvva 124,208,156
 TR 208,35,96
 WL 7
 Mvva 124,212,172
  buffer_store_dwordx4 v[96:99], v16, s[8:11], 0 offen offset:2048 sc1
 Mvva 112,216,0
 TR 210,35,608
  v_cvt_pk_bf16_f32 v104, v104, v105
 Mvva 112,220,16
  v_cvt_pk_bf16_f32 v105, v106, v107
  v_cvt_pk_bf16_f32 v106, v108, v109
 Mvva 116,216,4
 TR 212,35,9568
  v_cvt_pk_bf16_f32 v107, v110, v111
 Mvva 116,220,20
  v_min_u32 v104, -2, v104
  v_min_u32 v105, -2, v105
 Mvva 120,216,8
 TR 214,35,10080
  v_min_u32 v106, -2, v106
 Mvva 120,220,24
  v_min_u32 v107, -2, v107
 Mvva 124,216,12
 TR 216,35,19040
 WL 7
 Mvva 124,220,28
  buffer_store_dwordx4 v[104:107], v16, s[8:11], s50 offen offset:3072 sc1
 Mvva 112,224,32
 TR 218,35,19552
 WL 6
 Mvva 112,228,48
 Mvva 116,224,36
 TR 220,35,28512
 Mvva 116,228,52
 Mvva 120,224,40
 TR 222,35,29024
 Mvva 120,228,56
 Mvva 124,224,44
 TR 224,33,19072
 Mvva 124,228,60
 WL 7
 Mvva 112,208,64
 TR 226,33,19584
 WL 6
 Mvva 112,212,80
 Mvva 116,208,68
 TR 228,33,28544
 Mvva 116,212,84
 Mvva 120,208,72
 TR 230,33,29056
 Mvva 120,212,88
 Mvva 124,208,76
 TR 208,34,128
 Mvva 124,212,92
 WL 7
 Mvva 112,216,96
 TR 210,34,640
 WL 6
 Mvva 112,220,112
 Mvva 116,216,100
 TR 212,34,9600
 Mvva 116,220,116
 Mvva 120,216,104
 TR 214,34,10112
 Mvva 120,220,120
 Mvva 124,216,108
 TR 216,34,19072
 Mvva 124,220,124
 WL 7
 WL 5
 Mvva 128,224,144
 TR 218,34,19584
  v_cvt_pk_bf16_f32 v112, v112, v113
 Mvva 128,228,160
  v_cvt_pk_bf16_f32 v113, v114, v115
  v_cvt_pk_bf16_f32 v114, v116, v117
 Mvva 132,224,148
 TR 220,34,28544
  v_cvt_pk_bf16_f32 v115, v118, v119
 Mvva 132,228,164
  v_min_u32 v112, -2, v112
  v_min_u32 v113, -2, v113
 Mvva 136,224,152
 TR 222,34,29056
  v_min_u32 v114, -2, v114
 Mvva 136,228,168
  v_min_u32 v115, -2, v115
 WL 4
 Mvva 140,224,156
 TR 224,35,128
 WL 7
 Mvva 140,228,172
  buffer_store_dwordx4 v[112:115], v16, s[8:11], 0 offen offset:3072 sc1
 Mvva 128,208,0
 TR 226,35,640
  v_cvt_pk_bf16_f32 v120, v120, v121
 Mvva 128,212,16
  v_cvt_pk_bf16_f32 v121, v122, v123
  v_cvt_pk_bf16_f32 v122, v124, v125
 Mvva 132,208,4
 TR 228,35,9600
  v_cvt_pk_bf16_f32 v123, v126, v127
 Mvva 132,212,20
  v_min_u32 v120, -2, v120
  v_min_u32 v121, -2, v121
 Mvva 136,208,8
 TR 230,35,10112
  v_min_u32 v122, -2, v122
 Mvva 136,212,24
  v_min_u32 v123, -2, v123
 Mvva 140,208,12
 TR 208,35,19072
 WL 7
 Mvva 140,212,28
  buffer_store_dwordx4 v[120:123], v17, s[8:11], s50 offen offset:0 sc1
 Mvva 128,216,32
 TR 210,35,19584
 WL 6
 Mvva 128,220,48
 Mvva 132,216,36
 TR 212,35,28544
 Mvva 132,220,52
 Mvva 136,216,40
 TR 214,35,29056
 Mvva 136,220,56
 Mvva 140,216,44
 TR 216,33,19104
 Mvva 140,220,60
 WL 7
 Mvva 128,224,64
 TR 218,33,19616
 WL 6
 Mvva 128,228,80
 Mvva 132,224,68
 TR 220,33,28576
 Mvva 132,228,84
 Mvva 136,224,72
 TR 222,33,29088
 Mvva 136,228,88
 Mvva 140,224,76
 TR 224,34,160
 Mvva 140,228,92
 WL 7
 Mvva 128,208,96
 TR 226,34,672
 WL 6
 Mvva 128,212,112
 Mvva 132,208,100
 TR 228,34,9632
 Mvva 132,212,116
 Mvva 136,208,104
 TR 230,34,10144
 Mvva 136,212,120
 Mvva 140,208,108
 TR 208,34,19104
 Mvva 140,212,124
 WL 7
 WL 5
 Mvva 144,216,144
 TR 210,34,19616
  v_cvt_pk_bf16_f32 v128, v128, v129
 Mvva 144,220,160
  v_cvt_pk_bf16_f32 v129, v130, v131
  v_cvt_pk_bf16_f32 v130, v132, v133
 Mvva 148,216,148
 TR 212,34,28576
  v_cvt_pk_bf16_f32 v131, v134, v135
 Mvva 148,220,164
  v_min_u32 v128, -2, v128
  v_min_u32 v129, -2, v129
 Mvva 152,216,152
 TR 214,34,29088
  v_min_u32 v130, -2, v130
 Mvva 152,220,168
  v_min_u32 v131, -2, v131
 WL 4
 Mvva 156,216,156
 TR 216,35,160
 WL 7
 Mvva 156,220,172
  buffer_store_dwordx4 v[128:131], v17, s[8:11], 0 offen offset:0 sc1
 Mvva 144,224,0
 TR 218,35,672
  v_cvt_pk_bf16_f32 v136, v136, v137
 Mvva 144,228,16
  v_cvt_pk_bf16_f32 v137, v138, v139
  v_cvt_pk_bf16_f32 v138, v140, v141
 Mvva 148,224,4
 TR 220,35,9632
  v_cvt_pk_bf16_f32 v139, v142, v143
 Mvva 148,228,20
  v_min_u32 v136, -2, v136
  v_min_u32 v137, -2, v137
 Mvva 152,224,8
 TR 222,35,10144
  v_min_u32 v138, -2, v138
 Mvva 152,228,24
  v_min_u32 v139, -2, v139
 Mvva 156,224,12
 TR 224,35,19104
 WL 7
 Mvva 156,228,28
  buffer_store_dwordx4 v[136:139], v17, s[8:11], s50 offen offset:1024 sc1
 Mvva 144,208,32
 TR 226,35,19616
 WL 6
 Mvva 144,212,48
 Mvva 148,208,36
 TR 228,35,28576
 Mvva 148,212,52
 Mvva 152,208,40
 TR 230,35,29088
 Mvva 152,212,56
 Mvva 156,208,44
 TR 208,33,19136
 Mvva 156,212,60
 WL 7
 Mvva 144,216,64
 TR 210,33,19648
 WL 6
 Mvva 144,220,80
 Mvva 148,216,68
 TR 212,33,28608
 Mvva 148,220,84
  s_waitcnt vmcnt(10)
  v_cmp_gt_u32 vcc, 1, v248
  s_nop 4
  s_cbranch_vccnz Lpoll_pz_7
Lback_pz_7:
 Mvva 152,216,72
 TR 214,33,29120
 Mvva 152,220,88
 WL 6
 Mvva 156,216,76
 TR 216,34,192
  s_add_u32 s46, s55, 0
 Mvva 156,220,92
  buffer_load_dwordx4 v[64:67], v28, s[20:23], s46 offen sc1
 Mvva 144,224,96
 TR 218,34,704
 WL 6
 Mvva 144,228,112
 Mvva 148,224,100
 TR 220,34,9664
 Mvva 148,228,116
 Mvva 152,224,104
 TR 222,34,10176
 Mvva 152,228,120
 Mvva 156,224,108
 TR 224,34,19136
 Mvva 156,228,124
 WL 7
 WL 5
 Mvva 160,208,144
 TR 226,34,19648
  v_cvt_pk_bf16_f32 v144, v144, v145
 Mvva 160,212,160
  s_add_u32 s46, s55, 18432
  v_cvt_pk_bf16_f32 v145, v146, v147
  v_cvt_pk_bf16_f32 v146, v148, v149
 Mvva 164,208,148
 TR 228,34,28608
  v_cvt_pk_bf16_f32 v147, v150, v151
 Mvva 164,212,164
  buffer_load_dwordx4 v[68:71], v28, s[20:23], s46 offen sc1
 Mvva 168,208,152
 TR 230,34,29120
  v_min_u32 v144, -2, v144
 Mvva 168,212,168
 WL 6
  v_min_u32 v145, -2, v145
  v_min_u32 v146, -2, v146
 Mvva 172,208,156
 TR 208,35,192
  v_min_u32 v147, -2, v147
 Mvva 172,212,172
  buffer_store_dwordx4 v[144:147], v17, s[8:11], 0 offen offset:1024 sc1
 Mvva 160,216,0
 TR 210,35,704
  v_cvt_pk_bf16_f32 v152, v152, v153
 WL 6
 Mvva 160,220,16
  v_cvt_pk_bf16_f32 v153, v154, v155
  v_cvt_pk_bf16_f32 v154, v156, v157
 Mvva 164,216,4
 TR 212,35,9664
  v_cvt_pk_bf16_f32 v155, v158, v159
 Mvva 164,220,20
  s_add_u32 s46, s55, 36864
  v_min_u32 v152, -2, v152
  v_min_u32 v153, -2, v153
 Mvva 168,216,8
 TR 214,35,10176
  v_min_u32 v154, -2, v154
 Mvva 168,220,24
  buffer_load_dwordx4 v[72:75], v28, s[20:23], s46 offen sc1
 Mvva 172,216,12
 TR 216,35,19136
  v_min_u32 v155, -2, v155
 Mvva 172,220,28
  buffer_store_dwordx4 v[152:155], v17, s[8:11], s50 offen offset:2048 sc1
 WL 7
 Mvva 160,224,32
 TR 218,35,19648
 WL 6
 Mvva 160,228,48
 Mvva 164,224,36
 TR 220,35,28608
 Mvva 164,228,52
 Mvva 168,224,40
 TR 222,35,29120
  s_add_u32 s46, s55, 55296
 Mvva 168,228,56
  buffer_load_dwordx4 v[76:79], v28, s[20:23], s46 offen sc1
 Mvva 172,224,44
 TR 224,33,19168
 Mvva 172,228,60
 WL 7
 Mvva 160,208,64
 TR 226,33,19680
 WL 6
 Mvva 160,212,80
 Mvva 164,208,68
 TR 228,33,28640
 Mvva 164,212,84
  v_mov_b32 v128, 0
  v_mov_b32 v129, 0
 Mvva 168,208,72
 TR 230,33,29152
  v_mov_b32 v130, 0
 Mvva 168,212,88
 WL 6
  v_mov_b32 v131, 0
  v_mov_b32 v132, 0
 Mvva 172,208,76
 TR 208,34,224
  s_add_u32 s46, s55, 73728
 Mvva 172,212,92
  buffer_load_dwordx4 v[80:83], v28, s[20:23], s46 offen sc1
 Mvva 160,216,96
 TR 210,34,736
  v_mov_b32 v133, 0
 WL 6
 Mvva 160,220,112
  v_mov_b32 v134, 0
  v_mov_b32 v135, 0
 Mvva 164,216,100
 TR 212,34,9696
  v_mov_b32 v136, 0
 Mvva 164,220,116
  v_mov_b32 v137, 0
  v_mov_b32 v138, 0
 Mvva 168,216,104
 TR 214,34,10208
  v_mov_b32 v139, 0
 Mvva 168,220,120
 WL 4
  v_mov_b32 v140, 0
  v_mov_b32 v141, 0
 Mvva 172,216,108
 TR 216,34,19168
  v_mov_b32 v142, 0
 Mvva 172,220,124
 WL 7
  v_mov_b32 v143, 0
  v_mov_b32 v144, 0
 Mvva 176,224,144
 TR 218,34,19680
  v_cvt_pk_bf16_f32 v160, v160, v161
 Mvva 176,228,160
  s_add_u32 s46, s55, 92160
  v_cvt_pk_bf16_f32 v161, v162, v163
  v_cvt_pk_bf16_f32 v162, v164, v165
 Mvva 180,224,148
 TR 220,34,28640
  v_cvt_pk_bf16_f32 v163, v166, v167
 Mvva 180,228,164
  buffer_load_dwordx4 v[84:87], v28, s[20:23], s46 offen sc1
 Mvva 184,224,152
 TR 222,34,29152
  v_min_u32 v160, -2, v160
 Mvva 184,228,168
 WL 6
  v_min_u32 v161, -2, v161
  v_min_u32 v162, -2, v162
 Mvva 188,224,156
 TR 224,35,224
  v_min_u32 v163, -2, v163
 Mvva 188,228,172
  buffer_store_dwordx4 v[160:163], v17, s[8:11], 0 offen offset:2048 sc1
 Mvva 176,208,0
 TR 226,35,736
  v_cvt_pk_bf16_f32 v168, v168, v169
 WL 6
 Mvva 176,212,16
  v_cvt_pk_bf16_f32 v169, v170, v171
  v_cvt_pk_bf16_f32 v170, v172, v173
 Mvva 180,208,4
 TR 228,35,9696
  v_cvt_pk_bf16_f32 v171, v174, v175
 Mvva 180,212,20
  buffer_load_dword v248, v247, s[20:23], s54 offen offset:32 sc1
 Mvva 184,208,8
 TR 230,35,10208
  v_min_u32 v168, -2, v168
 Mvva 184,212,24
  s_add_u32 s46, s55, 110592
  v_min_u32 v169, -2, v169
  v_min_u32 v170, -2, v170
 Mvva 188,208,12
 TR 208,35,19168
  v_min_u32 v171, -2, v171
 Mvva 188,212,28
  buffer_load_dwordx4 v[88:91], v28, s[20:23], s46 offen sc1
 WL 7
 Mvva 176,216,32
 TR 210,35,19680
  v_mov_b32 v145, 0
 WL 6
 Mvva 176,220,48
  buffer_store_dwordx4 v[168:171], v17, s[8:11], s50 offen offset:3072 sc1
 Mvva 180,216,36
 TR 212,35,28640
 Mvva 180,220,52
 Mvva 184,216,40
 TR 214,35,29152
  s_add_u32 s46, s55, 129024
 Mvva 184,220,56
  buffer_load_dwordx4 v[92:95], v28, s[20:23], s46 offen sc1
 Mvva 188,216,44
 TR 216,57,18944
 Mvva 188,220,60
 WL 7
 Mvva 176,224,64
 TR 218,57,19456
 WL 6
 Mvva 176,228,80
 Mvva 180,224,68
 TR 220,57,28416
 Mvva 180,228,84
 Mvva 184,224,72
 TR 222,57,28928
 Mvva 184,228,88
 Mvva 188,224,76
 TR 224,58,0
 Mvva 188,228,92
 WL 7
 Mvva 176,208,96
 TR 226,58,512
 WL 6
 Mvva 176,212,112
 Mvva 180,208,100
 TR 228,58,9472
 Mvva 180,212,116
 Mvva 184,208,104
 TR 230,58,9984
 Mvva 184,212,120
 Mvva 188,208,108
 TR 208,58,18944
 Mvva 188,212,124
 WL 7
 WL 5
 Mvva 192,216,144
 TR 210,58,19456
  v_cvt_pk_bf16_f32 v176, v176, v177
 Mvva 192,220,160
  buffer_store_dword v246, v245, s[20:23], s66 offen sc1
 Mvva 196,216,148
 TR 212,58,28416
  v_cvt_pk_bf16_f32 v177, v178, v179
 Mvva 196,220,164
  v_cvt_pk_bf16_f32 v178, v180, v181
  v_cvt_pk_bf16_f32 v179, v182, v183
 Mvva 200,216,152
 TR 214,58,28928
  v_min_u32 v176, -2, v176
 Mvva 200,220,168
 WL 6
  v_min_u32 v177, -2, v177
  v_min_u32 v178, -2, v178
 Mvva 204,216,156
 TR 216,59,0
  v_min_u32 v179, -2, v179
 Mvva 204,220,172
  buffer_store_dwordx4 v[176:179], v17, s[8:11], 0 offen offset:3072 sc1
 Mvva 192,224,0
 TR 218,59,512
  v_cvt_pk_bf16_f32 v184, v184, v185
 WL 6
 Mvva 192,228,16
  v_cvt_pk_bf16_f32 v185, v186, v187
  v_cvt_pk_bf16_f32 v186, v188, v189
 Mvva 196,224,4
 TR 220,59,9472
  v_cvt_pk_bf16_f32 v187, v190, v191
 Mvva 196,228,20
  v_min_u32 v184, -2, v184
  v_min_u32 v185, -2, v185
 Mvva 200,224,8
 TR 222,59,9984
  v_min_u32 v186, -2, v186
 Mvva 200,228,24
  v_min_u32 v187, -2, v187
 Mvva 204,224,12
 TR 224,59,18944
 WL 7
 Mvva 204,228,28
  buffer_store_dwordx4 v[184:187], v16, s[8:11], s51 offen offset:0 sc1
 Mvva 192,208,32
 TR 226,59,19456
 WL 6
 Mvva 192,212,48
 Mvva 196,208,36
 TR 228,59,28416
 Mvva 196,212,52
 Mvva 200,208,40
 TR 230,59,28928
 Mvva 200,212,56
 Mvva 204,208,44
 Mvva 204,212,60
 WL 6
 Mvva 192,216,64
 WL 4
 Mvva 192,220,80
 Mvva 196,216,68
 Mvva 196,220,84
 Mvva 200,216,72
 Mvva 200,220,88
 Mvva 204,216,76
 Mvva 204,220,92
 WL 2
 Mvva 192,224,96
 WL 0
 Mvva 192,228,112
 Mvva 196,224,100
 Mvva 196,228,116
 Mvva 200,224,104
 Mvva 200,228,120
 Mvva 204,224,108
 Mvva 204,228,124
  s_nop 1
  v_cvt_pk_bf16_f32 v192, v192, v193
  v_cvt_pk_bf16_f32 v193, v194, v195
  v_cvt_pk_bf16_f32 v194, v196, v197
  v_cvt_pk_bf16_f32 v195, v198, v199
  v_min_u32 v192, -2, v192
  v_min_u32 v193, -2, v193
  v_min_u32 v194, -2, v194
  v_min_u32 v195, -2, v195
  buffer_store_dwordx4 v[192:195], v16, s[8:11], s50 offen offset:0 sc1
  v_cvt_pk_bf16_f32 v200, v200, v201
  v_cvt_pk_bf16_f32 v201, v202, v203
  v_cvt_pk_bf16_f32 v202, v204, v205
  v_cvt_pk_bf16_f32 v203, v206, v207
  v_min_u32 v200, -2, v200
  v_min_u32 v201, -2, v201
  v_min_u32 v202, -2, v202
  v_min_u32 v203, -2, v203
  buffer_store_dwordx4 v[200:203], v16, s[8:11], s51 offen offset:1024 sc1
  s_waitcnt vmcnt(8)
  v_cmp_gt_u32 vcc, 2, v248
  s_nop 4
  s_cbranch_vccnz Lpoll_red_7
Lback_red_7:
  s_add_u32 s46, s55, 4096
  buffer_load_dwordx4 v[96:99], v28, s[20:23], s46 offen sc1
  buffer_load_dword v232, v29, s[20:23], s46 offen sc1
  s_add_u32 s46, s55, 22528
  buffer_load_dwordx4 v[100:103], v28, s[20:23], s46 offen sc1
  buffer_load_dword v233, v29, s[20:23], s46 offen sc1
  s_add_u32 s46, s55, 40960
  buffer_load_dwordx4 v[104:107], v28, s[20:23], s46 offen sc1
  buffer_load_dword v234, v29, s[20:23], s46 offen sc1
  s_add_u32 s46, s55, 59392
  buffer_load_dwordx4 v[108:111], v28, s[20:23], s46 offen sc1
  buffer_load_dword v235, v29, s[20:23], s46 offen sc1
  s_add_u32 s46, s55, 77824
  buffer_load_dwordx4 v[112:115], v28, s[20:23], s46 offen sc1
  buffer_load_dword v236, v29, s[20:23], s46 offen sc1
  s_add_u32 s46, s55, 96256
  buffer_load_dwordx4 v[116:119], v28, s[20:23], s46 offen sc1
  buffer_load_dword v237, v29, s[20:23], s46 offen sc1
  s_add_u32 s46, s55, 114688
  buffer_load_dwordx4 v[120:123], v28, s[20:23], s46 offen sc1
  buffer_load_dword v238, v29, s[20:23], s46 offen sc1
  s_add_u32 s46, s55, 133120
  buffer_load_dwordx4 v[124:127], v28, s[20:23], s46 offen sc1
  buffer_load_dword v239, v29, s[20:23], s46 offen sc1
  s_load_dwordx2 s[16:17], s[0:1], 80
  s_mov_b32 s18, 0x240000
  s_mov_b32 s19, 0x00020000
Lchk_7:
  s_bitcmp1_b32 s57, 0
  s_cbranch_scc0 Lskip0_7
  v_max3_u32 v36, v64, v65, v66
  v_max3_u32 v36, v36, v67, v67
  v_cmp_eq_u32 vcc, -1, v36
  s_nop 4
  s_cbranch_vccnz Lskip0_7
  v_lshlrev_b32 v36, 16, v64
  v_and_b32 v37, 0xffff0000, v64
  v_pk_add_f32 v[128:129], v[128:129], v[36:37]
  v_lshlrev_b32 v36, 16, v65
  v_and_b32 v37, 0xffff0000, v65
  v_pk_add_f32 v[130:131], v[130:131], v[36:37]
  v_lshlrev_b32 v36, 16, v66
  v_and_b32 v37, 0xffff0000, v66
  v_pk_add_f32 v[132:133], v[132:133], v[36:37]
  v_lshlrev_b32 v36, 16, v67
  v_and_b32 v37, 0xffff0000, v67
  v_pk_add_f32 v[134:135], v[134:135], v[36:37]
  s_bitset0_b32 s57, 0
Lskip0_7:
  s_bitcmp1_b32 s57, 1
  s_cbranch_scc0 Lskip1_7
  v_max3_u32 v36, v68, v69, v70
  v_max3_u32 v36, v36, v71, v71
  v_cmp_eq_u32 vcc, -1, v36
  s_nop 4
  s_cbranch_vccnz Lskip1_7
  v_lshlrev_b32 v36, 16, v68
  v_and_b32 v37, 0xffff0000, v68
  v_pk_add_f32 v[128:129], v[128:129], v[36:37]
  v_lshlrev_b32 v36, 16, v69
  v_and_b32 v37, 0xffff0000, v69
  v_pk_add_f32 v[130:131], v[130:131], v[36:37]
  v_lshlrev_b32 v36, 16, v70
  v_and_b32 v37, 0xffff0000, v70
  v_pk_add_f32 v[132:133], v[132:133], v[36:37]
  v_lshlrev_b32 v36, 16, v71
  v_and_b32 v37, 0xffff0000, v71
  v_pk_add_f32 v[134:135], v[134:135], v[36:37]
  s_bitset0_b32 s57, 1
Lskip1_7:
  s_bitcmp1_b32 s57, 2
  s_cbranch_scc0 Lskip2_7
  v_max3_u32 v36, v72, v73, v74
  v_max3_u32 v36, v36, v75, v75
  v_cmp_eq_u32 vcc, -1, v36
  s_nop 4
  s_cbranch_vccnz Lskip2_7
  v_lshlrev_b32 v36, 16, v72
  v_and_b32 v37, 0xffff0000, v72
  v_pk_add_f32 v[128:129], v[128:129], v[36:37]
  v_lshlrev_b32 v36, 16, v73
  v_and_b32 v37, 0xffff0000, v73
  v_pk_add_f32 v[130:131], v[130:131], v[36:37]
  v_lshlrev_b32 v36, 16, v74
  v_and_b32 v37, 0xffff0000, v74
  v_pk_add_f32 v[132:133], v[132:133], v[36:37]
  v_lshlrev_b32 v36, 16, v75
  v_and_b32 v37, 0xffff0000, v75
  v_pk_add_f32 v[134:135], v[134:135], v[36:37]
  s_bitset0_b32 s57, 2
Lskip2_7:
  s_bitcmp1_b32 s57, 3
  s_cbranch_scc0 Lskip3_7
  v_max3_u32 v36, v76, v77, v78
  v_max3_u32 v36, v36, v79, v79
  v_cmp_eq_u32 vcc, -1, v36
  s_nop 4
  s_cbranch_vccnz Lskip3_7
  v_lshlrev_b32 v36, 16, v76
  v_and_b32 v37, 0xffff0000, v76
  v_pk_add_f32 v[128:129], v[128:129], v[36:37]
  v_lshlrev_b32 v36, 16, v77
  v_and_b32 v37, 0xffff0000, v77
  v_pk_add_f32 v[130:131], v[130:131], v[36:37]
  v_lshlrev_b32 v36, 16, v78
  v_and_b32 v37, 0xffff0000, v78
  v_pk_add_f32 v[132:133], v[132:133], v[36:37]
  v_lshlrev_b32 v36, 16, v79
  v_and_b32 v37, 0xffff0000, v79
  v_pk_add_f32 v[134:135], v[134:135], v[36:37]
  s_bitset0_b32 s57, 3
Lskip3_7:
  s_bitcmp1_b32 s57, 4
  s_cbranch_scc0 Lskip4_7
  v_max3_u32 v36, v80, v81, v82
  v_max3_u32 v36, v36, v83, v83
  v_cmp_eq_u32 vcc, -1, v36
  s_nop 4
  s_cbranch_vccnz Lskip4_7
  v_lshlrev_b32 v36, 16, v80
  v_and_b32 v37, 0xffff0000, v80
  v_pk_add_f32 v[128:129], v[128:129], v[36:37]
  v_lshlrev_b32 v36, 16, v81
  v_and_b32 v37, 0xffff0000, v81
  v_pk_add_f32 v[130:131], v[130:131], v[36:37]
  v_lshlrev_b32 v36, 16, v82
  v_and_b32 v37, 0xffff0000, v82
  v_pk_add_f32 v[132:133], v[132:133], v[36:37]
  v_lshlrev_b32 v36, 16, v83
  v_and_b32 v37, 0xffff0000, v83
  v_pk_add_f32 v[134:135], v[134:135], v[36:37]
  s_bitset0_b32 s57, 4
Lskip4_7:
  s_bitcmp1_b32 s57, 5
  s_cbranch_scc0 Lskip5_7
  v_max3_u32 v36, v84, v85, v86
  v_max3_u32 v36, v36, v87, v87
  v_cmp_eq_u32 vcc, -1, v36
  s_nop 4
  s_cbranch_vccnz Lskip5_7
  v_lshlrev_b32 v36, 16, v84
  v_and_b32 v37, 0xffff0000, v84
  v_pk_add_f32 v[128:129], v[128:129], v[36:37]
  v_lshlrev_b32 v36, 16, v85
  v_and_b32 v37, 0xffff0000, v85
  v_pk_add_f32 v[130:131], v[130:131], v[36:37]
  v_lshlrev_b32 v36, 16, v86
  v_and_b32 v37, 0xffff0000, v86
  v_pk_add_f32 v[132:133], v[132:133], v[36:37]
  v_lshlrev_b32 v36, 16, v87
  v_and_b32 v37, 0xffff0000, v87
  v_pk_add_f32 v[134:135], v[134:135], v[36:37]
  s_bitset0_b32 s57, 5
Lskip5_7:
  s_bitcmp1_b32 s57, 6
  s_cbranch_scc0 Lskip6_7
  s_waitcnt vmcnt(23)
  v_max3_u32 v36, v88, v89, v90
  v_max3_u32 v36, v36, v91, v91
  v_cmp_eq_u32 vcc, -1, v36
  s_nop 4
  s_cbranch_vccnz Lskip6_7
  v_lshlrev_b32 v36, 16, v88
  v_and_b32 v37, 0xffff0000, v88
  v_pk_add_f32 v[128:129], v[128:129], v[36:37]
  v_lshlrev_b32 v36, 16, v89
  v_and_b32 v37, 0xffff0000, v89
  v_pk_add_f32 v[130:131], v[130:131], v[36:37]
  v_lshlrev_b32 v36, 16, v90
  v_and_b32 v37, 0xffff0000, v90
  v_pk_add_f32 v[132:133], v[132:133], v[36:37]
  v_lshlrev_b32 v36, 16, v91
  v_and_b32 v37, 0xffff0000, v91
  v_pk_add_f32 v[134:135], v[134:135], v[36:37]
  s_bitset0_b32 s57, 6
Lskip6_7:
  s_bitcmp1_b32 s57, 7
  s_cbranch_scc0 Lskip7_7
  s_waitcnt vmcnt(21)
  v_max3_u32 v36, v92, v93, v94
  v_max3_u32 v36, v36, v95, v95
  v_cmp_eq_u32 vcc, -1, v36
  s_nop 4
  s_cbranch_vccnz Lskip7_7
  v_lshlrev_b32 v36, 16, v92
  v_and_b32 v37, 0xffff0000, v92
  v_pk_add_f32 v[128:129], v[128:129], v[36:37]
  v_lshlrev_b32 v36, 16, v93
  v_and_b32 v37, 0xffff0000, v93
  v_pk_add_f32 v[130:131], v[130:131], v[36:37]
  v_lshlrev_b32 v36, 16, v94
  v_and_b32 v37, 0xffff0000, v94
  v_pk_add_f32 v[132:133], v[132:133], v[36:37]
  v_lshlrev_b32 v36, 16, v95
  v_and_b32 v37, 0xffff0000, v95
  v_pk_add_f32 v[134:135], v[134:135], v[36:37]
  s_bitset0_b32 s57, 7
Lskip7_7:
  s_bitcmp1_b32 s57, 8
  s_cbranch_scc0 Lskip8_7
  s_waitcnt vmcnt(15)
  v_max3_u32 v36, v96, v97, v98
  s_waitcnt vmcnt(14)
  v_max3_u32 v36, v36, v99, v232
  v_cmp_eq_u32 vcc, -1, v36
  s_nop 4
  s_cbranch_vccnz Lskip8_7
  v_lshlrev_b32 v36, 16, v96
  v_and_b32 v37, 0xffff0000, v96
  v_pk_add_f32 v[136:137], v[136:137], v[36:37]
  v_lshlrev_b32 v36, 16, v97
  v_and_b32 v37, 0xffff0000, v97
  v_pk_add_f32 v[138:139], v[138:139], v[36:37]
  v_lshlrev_b32 v36, 16, v98
  v_and_b32 v37, 0xffff0000, v98
  v_pk_add_f32 v[140:141], v[140:141], v[36:37]
  v_lshlrev_b32 v36, 16, v99
  v_and_b32 v37, 0xffff0000, v99
  v_pk_add_f32 v[142:143], v[142:143], v[36:37]
  v_lshlrev_b32 v36, 16, v232
  v_and_b32 v37, 0xffff0000, v232
  v_pk_add_f32 v[144:145], v[144:145], v[36:37]
  s_bitset0_b32 s57, 8
Lskip8_7:
  s_bitcmp1_b32 s57, 9
  s_cbranch_scc0 Lskip9_7
  s_waitcnt vmcnt(13)
  v_max3_u32 v36, v100, v101, v102
  s_waitcnt vmcnt(12)
  v_max3_u32 v36, v36, v103, v233
  v_cmp_eq_u32 vcc, -1, v36
  s_nop 4
  s_cbranch_vccnz Lskip9_7
  v_lshlrev_b32 v36, 16, v100
  v_and_b32 v37, 0xffff0000, v100
  v_pk_add_f32 v[136:137], v[136:137], v[36:37]
  v_lshlrev_b32 v36, 16, v101
  v_and_b32 v37, 0xffff0000, v101
  v_pk_add_f32 v[138:139], v[138:139], v[36:37]
  v_lshlrev_b32 v36, 16, v102
  v_and_b32 v37, 0xffff0000, v102
  v_pk_add_f32 v[140:141], v[140:141], v[36:37]
  v_lshlrev_b32 v36, 16, v103
  v_and_b32 v37, 0xffff0000, v103
  v_pk_add_f32 v[142:143], v[142:143], v[36:37]
  v_lshlrev_b32 v36, 16, v233
  v_and_b32 v37, 0xffff0000, v233
  v_pk_add_f32 v[144:145], v[144:145], v[36:37]
  s_bitset0_b32 s57, 9
Lskip9_7:
  s_bitcmp1_b32 s57, 10
  s_cbranch_scc0 Lskip10_7
  s_waitcnt vmcnt(11)
  v_max3_u32 v36, v104, v105, v106
  s_waitcnt vmcnt(10)
  v_max3_u32 v36, v36, v107, v234
  v_cmp_eq_u32 vcc, -1, v36
  s_nop 4
  s_cbranch_vccnz Lskip10_7
  v_lshlrev_b32 v36, 16, v104
  v_and_b32 v37, 0xffff0000, v104
  v_pk_add_f32 v[136:137], v[136:137], v[36:37]
  v_lshlrev_b32 v36, 16, v105
  v_and_b32 v37, 0xffff0000, v105
  v_pk_add_f32 v[138:139], v[138:139], v[36:37]
  v_lshlrev_b32 v36, 16, v106
  v_and_b32 v37, 0xffff0000, v106
  v_pk_add_f32 v[140:141], v[140:141], v[36:37]
  v_lshlrev_b32 v36, 16, v107
  v_and_b32 v37, 0xffff0000, v107
  v_pk_add_f32 v[142:143], v[142:143], v[36:37]
  v_lshlrev_b32 v36, 16, v234
  v_and_b32 v37, 0xffff0000, v234
  v_pk_add_f32 v[144:145], v[144:145], v[36:37]
  s_bitset0_b32 s57, 10
Lskip10_7:
  s_bitcmp1_b32 s57, 11
  s_cbranch_scc0 Lskip11_7
  s_waitcnt vmcnt(9)
  v_max3_u32 v36, v108, v109, v110
  s_waitcnt vmcnt(8)
  v_max3_u32 v36, v36, v111, v235
  v_cmp_eq_u32 vcc, -1, v36
  s_nop 4
  s_cbranch_vccnz Lskip11_7
  v_lshlrev_b32 v36, 16, v108
  v_and_b32 v37, 0xffff0000, v108
  v_pk_add_f32 v[136:137], v[136:137], v[36:37]
  v_lshlrev_b32 v36, 16, v109
  v_and_b32 v37, 0xffff0000, v109
  v_pk_add_f32 v[138:139], v[138:139], v[36:37]
  v_lshlrev_b32 v36, 16, v110
  v_and_b32 v37, 0xffff0000, v110
  v_pk_add_f32 v[140:141], v[140:141], v[36:37]
  v_lshlrev_b32 v36, 16, v111
  v_and_b32 v37, 0xffff0000, v111
  v_pk_add_f32 v[142:143], v[142:143], v[36:37]
  v_lshlrev_b32 v36, 16, v235
  v_and_b32 v37, 0xffff0000, v235
  v_pk_add_f32 v[144:145], v[144:145], v[36:37]
  s_bitset0_b32 s57, 11
Lskip11_7:
  s_bitcmp1_b32 s57, 12
  s_cbranch_scc0 Lskip12_7
  s_waitcnt vmcnt(7)
  v_max3_u32 v36, v112, v113, v114
  s_waitcnt vmcnt(6)
  v_max3_u32 v36, v36, v115, v236
  v_cmp_eq_u32 vcc, -1, v36
  s_nop 4
  s_cbranch_vccnz Lskip12_7
  v_lshlrev_b32 v36, 16, v112
  v_and_b32 v37, 0xffff0000, v112
  v_pk_add_f32 v[136:137], v[136:137], v[36:37]
  v_lshlrev_b32 v36, 16, v113
  v_and_b32 v37, 0xffff0000, v113
  v_pk_add_f32 v[138:139], v[138:139], v[36:37]
  v_lshlrev_b32 v36, 16, v114
  v_and_b32 v37, 0xffff0000, v114
  v_pk_add_f32 v[140:141], v[140:141], v[36:37]
  v_lshlrev_b32 v36, 16, v115
  v_and_b32 v37, 0xffff0000, v115
  v_pk_add_f32 v[142:143], v[142:143], v[36:37]
  v_lshlrev_b32 v36, 16, v236
  v_and_b32 v37, 0xffff0000, v236
  v_pk_add_f32 v[144:145], v[144:145], v[36:37]
  s_bitset0_b32 s57, 12
Lskip12_7:
  s_bitcmp1_b32 s57, 13
  s_cbranch_scc0 Lskip13_7
  s_waitcnt vmcnt(5)
  v_max3_u32 v36, v116, v117, v118
  s_waitcnt vmcnt(4)
  v_max3_u32 v36, v36, v119, v237
  v_cmp_eq_u32 vcc, -1, v36
  s_nop 4
  s_cbranch_vccnz Lskip13_7
  v_lshlrev_b32 v36, 16, v116
  v_and_b32 v37, 0xffff0000, v116
  v_pk_add_f32 v[136:137], v[136:137], v[36:37]
  v_lshlrev_b32 v36, 16, v117
  v_and_b32 v37, 0xffff0000, v117
  v_pk_add_f32 v[138:139], v[138:139], v[36:37]
  v_lshlrev_b32 v36, 16, v118
  v_and_b32 v37, 0xffff0000, v118
  v_pk_add_f32 v[140:141], v[140:141], v[36:37]
  v_lshlrev_b32 v36, 16, v119
  v_and_b32 v37, 0xffff0000, v119
  v_pk_add_f32 v[142:143], v[142:143], v[36:37]
  v_lshlrev_b32 v36, 16, v237
  v_and_b32 v37, 0xffff0000, v237
  v_pk_add_f32 v[144:145], v[144:145], v[36:37]
  s_bitset0_b32 s57, 13
Lskip13_7:
  s_bitcmp1_b32 s57, 14
  s_cbranch_scc0 Lskip14_7
  s_waitcnt vmcnt(3)
  v_max3_u32 v36, v120, v121, v122
  s_waitcnt vmcnt(2)
  v_max3_u32 v36, v36, v123, v238
  v_cmp_eq_u32 vcc, -1, v36
  s_nop 4
  s_cbranch_vccnz Lskip14_7
  v_lshlrev_b32 v36, 16, v120
  v_and_b32 v37, 0xffff0000, v120
  v_pk_add_f32 v[136:137], v[136:137], v[36:37]
  v_lshlrev_b32 v36, 16, v121
  v_and_b32 v37, 0xffff0000, v121
  v_pk_add_f32 v[138:139], v[138:139], v[36:37]
  v_lshlrev_b32 v36, 16, v122
  v_and_b32 v37, 0xffff0000, v122
  v_pk_add_f32 v[140:141], v[140:141], v[36:37]
  v_lshlrev_b32 v36, 16, v123
  v_and_b32 v37, 0xffff0000, v123
  v_pk_add_f32 v[142:143], v[142:143], v[36:37]
  v_lshlrev_b32 v36, 16, v238
  v_and_b32 v37, 0xffff0000, v238
  v_pk_add_f32 v[144:145], v[144:145], v[36:37]
  s_bitset0_b32 s57, 14
Lskip14_7:
  s_bitcmp1_b32 s57, 15
  s_cbranch_scc0 Lskip15_7
  s_waitcnt vmcnt(1)
  v_max3_u32 v36, v124, v125, v126
  s_waitcnt vmcnt(0)
  v_max3_u32 v36, v36, v127, v239
  v_cmp_eq_u32 vcc, -1, v36
  s_nop 4
  s_cbranch_vccnz Lskip15_7
  v_lshlrev_b32 v36, 16, v124
  v_and_b32 v37, 0xffff0000, v124
  v_pk_add_f32 v[136:137], v[136:137], v[36:37]
  v_lshlrev_b32 v36, 16, v125
  v_and_b32 v37, 0xffff0000, v125
  v_pk_add_f32 v[138:139], v[138:139], v[36:37]
  v_lshlrev_b32 v36, 16, v126
  v_and_b32 v37, 0xffff0000, v126
  v_pk_add_f32 v[140:141], v[140:141], v[36:37]
  v_lshlrev_b32 v36, 16, v127
  v_and_b32 v37, 0xffff0000, v127
  v_pk_add_f32 v[142:143], v[142:143], v[36:37]
  v_lshlrev_b32 v36, 16, v239
  v_and_b32 v37, 0xffff0000, v239
  v_pk_add_f32 v[144:145], v[144:145], v[36:37]
  s_bitset0_b32 s57, 15
Lskip15_7:
  s_cmp_lg_u32 s57, 0
  s_cbranch_scc1 Lretry_7
  v_cvt_pk_bf16_f32 v64, v128, v129
  v_cvt_pk_bf16_f32 v65, v130, v131
  v_cvt_pk_bf16_f32 v66, v132, v133
  v_cvt_pk_bf16_f32 v67, v134, v135
  v_cvt_pk_bf16_f32 v68, v136, v137
  v_cvt_pk_bf16_f32 v69, v138, v139
  v_cvt_pk_bf16_f32 v70, v140, v141
  v_cvt_pk_bf16_f32 v71, v142, v143
  v_cvt_pk_bf16_f32 v72, v144, v145
 WL 0
  buffer_store_dwordx2 v[64:65], v30, s[16:19], s56 offen offset:0
  buffer_store_dwordx2 v[66:67], v30, s[16:19], s69 offen offset:0
  buffer_store_dwordx2 v[68:69], v30, s[16:19], s56 offen offset:128
  buffer_store_dwordx2 v[70:71], v30, s[16:19], s69 offen offset:128
  buffer_store_dword v72, v31, s[16:19], s56 offen
Lexit_7:
  s_endpgm
Lpoll_ctx_7:
  buffer_load_dword v248, v247, s[20:23], s54 offen offset:16 sc1
  s_waitcnt vmcnt(0)
  v_cmp_gt_u32 vcc, 1, v248
  s_nop 4
  s_cbranch_vccz Lback_ctx_7
  s_branch Lpoll_ctx_7
Lpoll_pz_7:
  buffer_load_dword v248, v247, s[20:23], s54 offen offset:32 sc1
  s_waitcnt vmcnt(0)
  v_cmp_gt_u32 vcc, 1, v248
  s_nop 4
  s_cbranch_vccz Lback_pz_7
  s_branch Lpoll_pz_7
Lpoll_red_7:
  buffer_load_dword v248, v247, s[20:23], s54 offen offset:32 sc1
  s_waitcnt vmcnt(0)
  v_cmp_gt_u32 vcc, 2, v248
  s_nop 4
  s_cbranch_vccz Lback_red_7
  s_branch Lpoll_red_7
Lretry_7:
  s_bitcmp1_b32 s57, 0
  s_cbranch_scc0 Lrskip0_7
  s_add_u32 s46, s55, 0
  buffer_load_dwordx4 v[64:67], v28, s[20:23], s46 offen sc1
Lrskip0_7:
  s_bitcmp1_b32 s57, 1
  s_cbranch_scc0 Lrskip1_7
  s_add_u32 s46, s55, 18432
  buffer_load_dwordx4 v[68:71], v28, s[20:23], s46 offen sc1
Lrskip1_7:
  s_bitcmp1_b32 s57, 2
  s_cbranch_scc0 Lrskip2_7
  s_add_u32 s46, s55, 36864
  buffer_load_dwordx4 v[72:75], v28, s[20:23], s46 offen sc1
Lrskip2_7:
  s_bitcmp1_b32 s57, 3
  s_cbranch_scc0 Lrskip3_7
  s_add_u32 s46, s55, 55296
  buffer_load_dwordx4 v[76:79], v28, s[20:23], s46 offen sc1
Lrskip3_7:
  s_bitcmp1_b32 s57, 4
  s_cbranch_scc0 Lrskip4_7
  s_add_u32 s46, s55, 73728
  buffer_load_dwordx4 v[80:83], v28, s[20:23], s46 offen sc1
Lrskip4_7:
  s_bitcmp1_b32 s57, 5
  s_cbranch_scc0 Lrskip5_7
  s_add_u32 s46, s55, 92160
  buffer_load_dwordx4 v[84:87], v28, s[20:23], s46 offen sc1
Lrskip5_7:
  s_bitcmp1_b32 s57, 6
  s_cbranch_scc0 Lrskip6_7
  s_add_u32 s46, s55, 110592
  buffer_load_dwordx4 v[88:91], v28, s[20:23], s46 offen sc1
Lrskip6_7:
  s_bitcmp1_b32 s57, 7
  s_cbranch_scc0 Lrskip7_7
  s_add_u32 s46, s55, 129024
  buffer_load_dwordx4 v[92:95], v28, s[20:23], s46 offen sc1
Lrskip7_7:
  s_bitcmp1_b32 s57, 8
  s_cbranch_scc0 Lrskip8_7
  s_add_u32 s46, s55, 4096
  buffer_load_dwordx4 v[96:99], v28, s[20:23], s46 offen sc1
  buffer_load_dword v232, v29, s[20:23], s46 offen sc1
Lrskip8_7:
  s_bitcmp1_b32 s57, 9
  s_cbranch_scc0 Lrskip9_7
  s_add_u32 s46, s55, 22528
  buffer_load_dwordx4 v[100:103], v28, s[20:23], s46 offen sc1
  buffer_load_dword v233, v29, s[20:23], s46 offen sc1
Lrskip9_7:
  s_bitcmp1_b32 s57, 10
  s_cbranch_scc0 Lrskip10_7
  s_add_u32 s46, s55, 40960
  buffer_load_dwordx4 v[104:107], v28, s[20:23], s46 offen sc1
  buffer_load_dword v234, v29, s[20:23], s46 offen sc1
Lrskip10_7:
  s_bitcmp1_b32 s57, 11
  s_cbranch_scc0 Lrskip11_7
  s_add_u32 s46, s55, 59392
  buffer_load_dwordx4 v[108:111], v28, s[20:23], s46 offen sc1
  buffer_load_dword v235, v29, s[20:23], s46 offen sc1
Lrskip11_7:
  s_bitcmp1_b32 s57, 12
  s_cbranch_scc0 Lrskip12_7
  s_add_u32 s46, s55, 77824
  buffer_load_dwordx4 v[112:115], v28, s[20:23], s46 offen sc1
  buffer_load_dword v236, v29, s[20:23], s46 offen sc1
Lrskip12_7:
  s_bitcmp1_b32 s57, 13
  s_cbranch_scc0 Lrskip13_7
  s_add_u32 s46, s55, 96256
  buffer_load_dwordx4 v[116:119], v28, s[20:23], s46 offen sc1
  buffer_load_dword v237, v29, s[20:23], s46 offen sc1
Lrskip13_7:
  s_bitcmp1_b32 s57, 14
  s_cbranch_scc0 Lrskip14_7
  s_add_u32 s46, s55, 114688
  buffer_load_dwordx4 v[120:123], v28, s[20:23], s46 offen sc1
  buffer_load_dword v238, v29, s[20:23], s46 offen sc1
Lrskip14_7:
  s_bitcmp1_b32 s57, 15
  s_cbranch_scc0 Lrskip15_7
  s_add_u32 s46, s55, 133120
  buffer_load_dwordx4 v[124:127], v28, s[20:23], s46 offen sc1
  buffer_load_dword v239, v29, s[20:23], s46 offen sc1
Lrskip15_7:
  s_waitcnt vmcnt(0)
  s_branch Lchk_7
Lp4e_7:
Lrestart:
  s_waitcnt vmcnt(0) lgkmcnt(0)
  s_barrier
  s_movk_i32 s6, 256
  s_branch Lrestart1
Ldone:
  s_cmp_eq_u32 s26, 3
  s_cbranch_scc1 Lp4_8
  s_cmp_eq_u32 s26, 5
  s_cbranch_scc1 Lp4_10
  s_cmp_eq_u32 s26, 2
  s_cbranch_scc1 Lp4_7
  s_cmp_eq_u32 s26, 6
  s_cbranch_scc1 Lp4_11
  s_cmp_eq_u32 s26, 1
  s_cbranch_scc1 Lp4_6
  s_cmp_eq_u32 s26, 0
  s_cbranch_scc1 Lp4_5
  s_cmp_eq_u32 s26, 7
  s_cbranch_scc1 Lp4_12
Lp4_9:
  v_cmp_lt_u32 vcc, 0x40000000, v43
  s_lshr_b32 s65, s6, 8
  s_lshl_b32 s66, s3, 2
  v_mov_b32 v246, s66
  s_cmp_lg_u64 vcc, 0
  s_cselect_b32 s66, 1, 0
  s_andn2_b32 s66, s66, s65
  v_mov_b32 v245, s66
  ds_write_b32 v246, v245
  v_and_b32 v246, 3, v0
  v_lshlrev_b32 v246, 2, v246
  v_lshlrev_b32 v59, 3, v0
  v_add_u32 v56, 20736, v59
  v_add_u32 v57, 134400, v59
  v_add_u32 v58, 58624, v59
  v_add_u32 v59, 96512, v59
 WL 0
  s_waitcnt vmcnt(33)
  s_barrier
 TR 208,32,0
 TR 210,32,512
 TR 212,32,9472
 TR 214,32,9984
 TR 216,32,32
 TR 218,32,544
 TR 220,32,9504
 TR 222,32,10016
 TR 224,32,64
 TR 226,32,576
 TR 228,32,9536
 TR 230,32,10048
  ds_read_b32 v245, v246
 WL 11
  v_mfma_f32_16x16x32_bf16 v[64:67], v[208:211], a[212:215], 0
  s_add_u32 s46, s45, 49152
  v_lshlrev_b32 v249, 14, v0
  v_add_u32 v249, Lp4_9-Lpc0, v249
 WL 9
 Mvva 64,212,228
  buffer_load_dwordx4 a[0:3], v16, s[20:23], s46 offen offset:0 sc1
  v_mfma_f32_16x16x32_bf16 v[68:71], v[208:211], a[216:219], 0
  v_min_u32 v249, Lp4e_9-Lpc0-16388, v249
 Mvva 68,212,232
  v_mfma_f32_16x16x32_bf16 v[72:75], v[208:211], a[220:223], 0
  buffer_load_dwordx4 a[4:7], v16, s[20:23], s46 offen offset:2048 sc1
 Mvva 72,212,236
  v_mfma_f32_16x16x32_bf16 v[76:79], v[208:211], a[224:227], 0
 TR 208,32,96
 Mvva 76,212,240
 WL 8
  v_mfma_f32_16x16x32_bf16 v[80:83], v[216:219], a[212:215], 0
 TR 210,32,608
 WL 7
 Mvva 80,220,228
  buffer_load_dwordx4 a[8:11], v17, s[20:23], s46 offen offset:0 sc1
  v_mfma_f32_16x16x32_bf16 v[84:87], v[216:219], a[216:219], 0
 TR 212,32,9568
 Mvva 84,220,232
 WL 3
  v_cmp_ne_u32 vcc, 0, v245
  s_nop 4
  s_cbranch_vccnz Lrestart
  v_mfma_f32_16x16x32_bf16 v[88:91], v[216:219], a[220:223], 0
 TR 214,32,10080
 Mvva 88,220,236
  buffer_load_dwordx4 a[12:15], v17, s[20:23], s46 offen offset:2048 sc1
  v_mfma_f32_16x16x32_bf16 v[92:95], v[216:219], a[224:227], 0
 TR 216,32,128
 Mvva 92,220,240
  s_cmp_lg_u32 s3, 0
  s_cselect_b32 s64, 256, 0
  s_and_b32 s66, s2, 0xe7
  v_mfma_f32_16x16x32_bf16 v[96:99], v[224:227], a[212:215], 0
 TR 218,32,640
  s_add_u32 s46, s45, 57344
 Mvva 96,228,228
  s_lshl_b32 s66, s66, 6
  s_lshr_b32 s65, s4, 3
  s_add_u32 s66, s66, s65
  v_mfma_f32_16x16x32_bf16 v[100:103], v[224:227], a[216:219], 0
 TR 220,32,9600
  s_lshl_b32 s66, s66, 2
 Mvva 100,228,232
  buffer_load_dwordx4 a[16:19], v16, s[20:23], s46 offen offset:0 sc1
  v_mfma_f32_16x16x32_bf16 v[104:107], v[224:227], a[220:223], 0
 TR 222,32,10112
  s_add_u32 s66, s66, 0x4480010
 Mvva 104,228,236
  global_load_dword a248, v249, s[100:101]
  v_mfma_f32_16x16x32_bf16 v[108:111], v[224:227], a[224:227], 0
 TR 224,32,160
  s_lshl_b32 s65, s64, 20
 Mvva 108,228,240
  buffer_load_dwordx4 a[20:23], v16, s[20:23], s46 offen offset:2048 sc1
 WL 7
  v_mfma_f32_16x16x32_bf16 v[112:115], v[208:211], a[212:215], 0
 TR 226,32,672
  s_add_u32 s66, s66, s65
 WL 6
 Mvva 112,212,228
  v_cmp_gt_u32 vcc, 4, v0
  v_lshlrev_b32 v245, 11, v0
  v_mov_b32 v246, 1
  v_cndmask_b32 v245, -1, v245, vcc
  v_mfma_f32_16x16x32_bf16 v[116:119], v[208:211], a[216:219], 0
 TR 228,32,9632
 Mvva 116,212,232
  buffer_load_dwordx4 a[24:27], v17, s[20:23], s46 offen offset:0 sc1
  v_mfma_f32_16x16x32_bf16 v[120:123], v[208:211], a[220:223], 0
 TR 230,32,10144
 Mvva 120,212,236
 WL 4
  v_mfma_f32_16x16x32_bf16 v[124:127], v[208:211], a[224:227], 0
 TR 208,32,192
 WL 7
 Mvva 124,212,240
  buffer_load_dwordx4 a[28:31], v17, s[20:23], s46 offen offset:2048 sc1
  v_mfma_f32_16x16x32_bf16 v[128:131], v[216:219], a[212:215], 0
 TR 210,32,704
  s_add_u32 s44, s44, 147456
 Mvva 128,220,228
  v_mfma_f32_16x16x32_bf16 v[132:135], v[216:219], a[216:219], 0
 TR 212,32,9664
  s_add_u32 m0, s47, 50176
 Mvva 132,220,232
  v_mfma_f32_16x16x32_bf16 v[136:139], v[216:219], a[220:223], 0
 TR 214,32,10176
 Mvva 136,220,236
  buffer_load_dwordx4 v1, s[12:15], s44 offen lds
  v_mfma_f32_16x16x32_bf16 v[140:143], v[216:219], a[224:227], 0
 TR 216,32,224
 Mvva 140,220,240
 WL 7
  v_mfma_f32_16x16x32_bf16 v[144:147], v[224:227], a[212:215], 0
 TR 218,32,736
 WL 6
 Mvva 144,228,228
  buffer_load_dwordx4 v2, s[12:15], s44 offen offset:1056 lds
  v_mfma_f32_16x16x32_bf16 v[148:151], v[224:227], a[216:219], 0
 TR 220,32,9696
 Mvva 148,228,232
  v_mfma_f32_16x16x32_bf16 v[152:155], v[224:227], a[220:223], 0
 TR 222,32,10208
 Mvva 152,228,236
  buffer_load_dwordx4 v3, s[12:15], s44 offen offset:2112 lds
  v_mfma_f32_16x16x32_bf16 v[156:159], v[224:227], a[224:227], 0
 TR 224,56,0
 Mvva 156,228,240
 WL 7
  v_mfma_f32_16x16x32_bf16 v[160:163], v[208:211], a[212:215], 0
 TR 226,56,512
 WL 6
 Mvva 160,212,228
  v_mfma_f32_16x16x32_bf16 v[164:167], v[208:211], a[216:219], 0
 TR 228,56,9472
 Mvva 164,212,232
  buffer_load_dwordx4 v4, s[12:15], s44 offen offset:3168 lds
  v_mfma_f32_16x16x32_bf16 v[168:171], v[208:211], a[220:223], 0
 TR 230,56,9984
  s_add_u32 m0, s47, 54400
 Mvva 168,212,236
  v_mfma_f32_16x16x32_bf16 v[172:175], v[208:211], a[224:227], 0
 TR 208,32,18944
 WL 7
 Mvva 172,212,240
  buffer_load_dwordx4 v5, s[12:15], s44 offen lds
  v_mfma_f32_16x16x32_bf16 v[176:179], v[216:219], a[212:215], 0
 TR 210,32,19456
 WL 6
 Mvva 176,220,228
  v_mfma_f32_16x16x32_bf16 v[180:183], v[216:219], a[216:219], 0
 TR 212,32,28416
 Mvva 180,220,232
  buffer_load_dwordx4 v6, s[12:15], s44 offen offset:1056 lds
  v_mfma_f32_16x16x32_bf16 v[184:187], v[216:219], a[220:223], 0
 TR 214,32,28928
 Mvva 184,220,236
  v_mfma_f32_16x16x32_bf16 v[188:191], v[216:219], a[224:227], 0
 TR 216,32,18976
 WL 7
 Mvva 188,220,240
  buffer_load_dwordx4 v7, s[12:15], s44 offen offset:2112 lds
  v_mfma_f32_16x16x32_bf16 v[192:195], v[224:227], a[212:215], 0
 TR 218,32,19488
 WL 6
 Mvva 192,228,228
  v_mfma_f32_16x16x32_bf16 v[196:199], v[224:227], a[216:219], 0
 TR 220,32,28448
 Mvva 196,228,232
  v_mfma_f32_16x16x32_bf16 v[200:203], v[224:227], a[220:223], 0
 TR 222,32,28960
  s_waitcnt vmcnt(41)
 Mvva 200,228,236
  buffer_load_dwordx4 v8, s[12:15], s44 offen offset:3168 lds
  v_mfma_f32_16x16x32_bf16 v[204:207], v[224:227], a[224:227], 0
 TR 224,32,19008
  s_add_u32 m0, s47, 58624
 Mvva 204,228,240
 WL 7
 Mvva 64,208,176
 TR 226,32,19520
 WL 6
 Mvva 64,212,192
  buffer_load_dwordx4 v9, s[20:23], s44 offen sc1 lds
 Mvva 68,208,180
 TR 228,32,28480
 Mvva 68,212,196
  s_add_u32 s46, s45, 65536
 Mvva 72,208,184
 TR 230,32,28992
 Mvva 72,212,200
  buffer_load_dwordx4 a[32:35], v16, s[20:23], s46 offen offset:0 sc1
 Mvva 76,208,188
 TR 208,32,19040
 Mvva 76,212,204
 WL 7
 Mvva 80,216,176
 TR 210,32,19552
 WL 6
 Mvva 80,220,192
  buffer_load_dwordx4 a[36:39], v16, s[20:23], s46 offen offset:2048 sc1
 Mvva 84,216,180
 TR 212,32,28512
 Mvva 84,220,196
 Mvva 88,216,184
 TR 214,32,29024
 Mvva 88,220,200
 Mvva 92,216,188
 TR 216,32,19072
 WL 7
 Mvva 92,220,204
  buffer_load_dwordx4 a[40:43], v17, s[20:23], s46 offen offset:0 sc1
 Mvva 96,224,176
 TR 218,32,19584
 WL 6
 Mvva 96,228,192
 Mvva 100,224,180
 TR 220,32,28544
 Mvva 100,228,196
  buffer_load_dwordx4 a[44:47], v17, s[20:23], s46 offen offset:2048 sc1
 Mvva 104,224,184
 TR 222,32,29056
 Mvva 104,228,200
  s_add_u32 s46, s45, 73728
 Mvva 108,224,188
 TR 224,32,19104
 WL 7
 Mvva 108,228,204
  buffer_load_dwordx4 a[48:51], v16, s[20:23], s46 offen offset:0 sc1
 Mvva 112,208,176
 TR 226,32,19616
 WL 6
 Mvva 112,212,192
 Mvva 116,208,180
 TR 228,32,28576
 Mvva 116,212,196
 Mvva 120,208,184
 TR 230,32,29088
 Mvva 120,212,200
  buffer_load_dwordx4 a[52:55], v16, s[20:23], s46 offen offset:2048 sc1
 Mvva 124,208,188
 TR 208,32,19136
 Mvva 124,212,204
 WL 7
 Mvva 128,216,176
 TR 210,32,19648
 WL 6
 Mvva 128,220,192
  buffer_load_dwordx4 a[56:59], v17, s[20:23], s46 offen offset:0 sc1
 Mvva 132,216,180
 TR 212,32,28608
 Mvva 132,220,196
 Mvva 136,216,184
 TR 214,32,29120
 Mvva 136,220,200
  buffer_load_dwordx4 a[60:63], v17, s[20:23], s46 offen offset:2048 sc1
 Mvva 140,216,188
 TR 216,32,19168
 Mvva 140,220,204
  s_add_u32 s46, s45, 81920
 WL 7
 Mvva 144,224,176
 TR 218,32,19680
 WL 6
 Mvva 144,228,192
  buffer_load_dwordx4 a[64:67], v16, s[20:23], s46 offen offset:0 sc1
 Mvva 148,224,180
 TR 220,32,28640
 Mvva 148,228,196
 Mvva 152,224,184
 TR 222,32,29152
 Mvva 152,228,200
 Mvva 156,224,188
 TR 224,56,18944
 WL 7
 Mvva 156,228,204
  buffer_load_dwordx4 a[68:71], v16, s[20:23], s46 offen offset:2048 sc1
 Mvva 160,208,176
 TR 226,56,19456
 WL 6
 Mvva 160,212,192
 Mvva 164,208,180
 TR 228,56,28416
 Mvva 164,212,196
  buffer_load_dwordx4 a[72:75], v17, s[20:23], s46 offen offset:0 sc1
 Mvva 168,208,184
 TR 230,56,28928
 Mvva 168,212,200
 Mvva 172,208,188
 WL 6
 Mvva 172,212,204
  buffer_load_dwordx4 a[76:79], v17, s[20:23], s46 offen offset:2048 sc1
 Mvva 176,216,176
 WL 4
 Mvva 176,220,192
  s_waitcnt vmcnt(30) lgkmcnt(0)
  s_barrier
 Mvva 180,216,180
 TR 208,33,0
  s_add_u32 s46, s45, 90112
 Mvva 180,220,196
 TR 210,33,512
 Mvva 184,216,184
 TR 212,33,9472
 Mvva 184,220,200
 TR 214,33,9984
 Mvva 188,216,188
 TR 216,33,32
 Mvva 188,220,204
  buffer_load_dwordx4 a[80:83], v16, s[20:23], s46 offen offset:0 sc1
 Mvva 192,224,176
 TR 218,33,544
 Mvva 192,228,192
  buffer_load_dwordx4 a[84:87], v16, s[20:23], s46 offen offset:2048 sc1
 Mvva 196,224,180
 TR 220,33,9504
 Mvva 196,228,196
  buffer_store_dword v246, v245, s[20:23], s66 offen sc1
 Mvva 200,224,184
 TR 222,33,10016
 WL 6
 Mvva 200,228,200
  buffer_load_dwordx4 a[88:91], v17, s[20:23], s46 offen offset:0 sc1
 Mvva 204,224,188
 TR 224,33,64
  s_lshr_b32 s55, s2, 3
 Mvva 204,228,204
  s_lshl_b32 s55, s55, 2
  s_bfe_u32 s65, s4, 0x20001
  s_add_u32 s55, s55, s65
 Mvva 64,208,144
 TR 226,33,576
  s_lshl_b32 s55, s55, 4
 WL 6
 Mvva 64,212,160
  buffer_load_dwordx4 a[92:95], v17, s[20:23], s46 offen offset:2048 sc1
 Mvva 68,208,148
 TR 228,33,9536
  s_add_u32 s44, s44, 147456
 Mvva 68,212,164
  s_and_b32 s65, s4, 1
  s_add_u32 s55, s55, s65
  s_mul_i32 s55, s55, 9216
 Mvva 72,208,152
 TR 230,33,10048
  s_add_u32 m0, s47, 88064
 Mvva 72,212,168
  s_add_u32 s55, s55, 0x4500000
  s_and_b32 s65, s4, 7
  s_movk_i32 s50, 8192
 Mvva 76,208,156
 TR 208,33,96
  s_movk_i32 s51, 16384
 Mvva 76,212,172
  buffer_load_dwordx4 v1, s[12:15], s44 offen lds
 WL 7
 Mvva 80,216,144
 TR 210,33,608
  s_and_b32 s66, s2, 0xf8
 WL 6
 Mvva 80,220,160
  s_lshl_b32 s56, s3, 1
  s_add_u32 s66, s66, s56
  s_lshl_b32 s66, s66, 6
 Mvva 84,216,148
 TR 212,33,9568
  s_add_u32 s66, s66, s65
 Mvva 84,220,164
  buffer_load_dwordx4 v2, s[12:15], s44 offen offset:1056 lds
 Mvva 88,216,152
 TR 214,33,10080
  s_lshl_b32 s66, s66, 2
 Mvva 88,220,168
  s_add_u32 s66, s66, 0x4480020
 Mvva 92,216,156
 TR 216,33,128
 WL 7
 Mvva 92,220,172
  buffer_load_dwordx4 v3, s[12:15], s44 offen offset:2112 lds
 Mvva 96,224,144
 TR 218,33,640
 WL 6
 Mvva 96,228,160
  v_cmp_gt_u32 vcc, 2, v0
  v_lshlrev_b32 v245, 8, v0
  v_mov_b32 v246, 1
  v_cndmask_b32 v245, -1, v245, vcc
 Mvva 100,224,148
 TR 220,33,9600
  s_sub_u32 s56, 15, s5
 Mvva 100,228,164
  buffer_load_dwordx4 v4, s[12:15], s44 offen offset:3168 lds
 Mvva 104,224,152
 TR 222,33,10112
 WL 6
 Mvva 104,228,168
  s_cmp_lt_u32 s65, 4
  s_cselect_b32 s56, s56, s5
  s_lshl_b32 s56, s56, 3
 Mvva 108,224,156
 TR 224,33,160
  s_add_u32 m0, s47, 92288
 Mvva 108,228,172
  s_bfe_u32 s69, s65, 0x10001
  s_add_u32 s56, s56, s69
  s_and_b32 s69, s65, 1
 Mvva 112,208,144
 TR 226,33,672
  s_lshl_b32 s69, s69, 2
 WL 6
 Mvva 112,212,160
  buffer_load_dwordx4 v5, s[12:15], s44 offen lds
 Mvva 116,208,148
 TR 228,33,9632
  s_add_u32 s56, s56, s69
 Mvva 116,212,164
  s_mul_i32 s56, s56, 18432
  s_lshr_b32 s69, s4, 3
  s_mul_i32 s31, s69, 224
 Mvva 120,208,152
 TR 230,33,10144
  s_lshl_b32 s69, s69, 8
 Mvva 120,212,168
  buffer_load_dwordx4 v6, s[12:15], s44 offen offset:1056 lds
 Mvva 124,208,156
 TR 208,33,192
  s_add_u32 s56, s56, s69
 Mvva 124,212,172
  s_lshl_b32 s69, s3, 10
  v_add_u32 v28, s69, v16
  s_lshl_b32 s69, s3, 8
 WL 7
 Mvva 128,216,144
 TR 210,33,704
  s_add_u32 s69, s69, 4096
 WL 6
 Mvva 128,220,160
  buffer_load_dwordx4 v7, s[12:15], s44 offen offset:2112 lds
 Mvva 132,216,148
 TR 212,33,9664
  v_lshl_add_u32 v29, v0, 2, s69
 Mvva 132,220,164
  v_and_b32 v36, 15, v0
  v_mul_u32_u24 v36, 1152, v36
 Mvva 136,216,152
 TR 214,33,10176
  v_lshrrev_b32 v37, 4, v0
 Mvva 136,220,168
  s_lshl_b32 s69, s3, 5
  v_lshl_add_u32 v36, v37, 3, v36
  v_add_u32 v30, s69, v36
 Mvva 140,216,156
 TR 216,33,224
  v_lshrrev_b32 v36, 2, v0
 Mvva 140,220,172
  buffer_load_dwordx4 v8, s[12:15], s44 offen offset:3168 lds
 WL 7
 Mvva 144,224,144
 TR 218,33,736
  s_add_u32 m0, s47, 96512
 WL 6
 Mvva 144,228,160
  v_bfe_u32 v37, v0, 1, 1
  v_lshl_add_u32 v36, v37, 5, v36
 Mvva 148,224,148
 TR 220,33,9696
  v_mul_u32_u24 v36, 1152, v36
 Mvva 148,228,164
  buffer_load_dwordx4 v9, s[20:23], s44 offen sc1 lds
 Mvva 152,224,152
 TR 222,33,10208
  v_and_b32 v37, 1, v0
 Mvva 152,228,168
  s_add_u32 s46, s45, 98304
  s_lshl_b32 s69, s3, 3
  v_lshl_add_u32 v36, v37, 2, v36
 Mvva 156,224,156
 TR 224,57,0
  s_add_u32 s69, s69, 1024
 Mvva 156,228,172
  buffer_load_dwordx4 a[96:99], v16, s[20:23], s46 offen offset:0 sc1
 WL 7
 Mvva 160,208,144
 TR 226,57,512
  s_sub_u32 s69, s69, s31
 WL 6
 Mvva 160,212,160
  s_mov_b32 s57, 0xffff
  v_add_u32 v31, s69, v36
  s_add_u32 s69, s56, 36864
 Mvva 164,208,148
 TR 228,57,9472
 Mvva 164,212,164
  buffer_load_dwordx4 a[100:103], v16, s[20:23], s46 offen offset:2048 sc1
 Mvva 168,208,152
 TR 230,57,9984
 Mvva 168,212,168
  buffer_store_dword v246, v245, s[20:23], s66 offen sc1
 Mvva 172,208,156
 TR 208,33,18944
 Mvva 172,212,172
 WL 7
 Mvva 176,216,144
 TR 210,33,19456
 WL 6
 Mvva 176,220,160
  buffer_load_dwordx4 a[104:107], v17, s[20:23], s46 offen offset:0 sc1
 Mvva 180,216,148
 TR 212,33,28416
 Mvva 180,220,164
 Mvva 184,216,152
 TR 214,33,28928
 Mvva 184,220,168
  buffer_load_dwordx4 a[108:111], v17, s[20:23], s46 offen offset:2048 sc1
 Mvva 188,216,156
 TR 216,33,18976
 Mvva 188,220,172
  s_add_u32 s46, s45, 106496
 WL 7
 Mvva 192,224,144
 TR 218,33,19488
 WL 6
 Mvva 192,228,160
  buffer_load_dwordx4 a[112:115], v16, s[20:23], s46 offen offset:0 sc1
 Mvva 196,224,148
 TR 220,33,28448
 Mvva 196,228,164
 Mvva 200,224,152
 TR 222,33,28960
  s_waitcnt vmcnt(41)
 Mvva 200,228,168
  buffer_load_dwordx4 a[116:119], v16, s[20:23], s46 offen offset:2048 sc1
 Mvva 204,224,156
 TR 224,33,19008
 Mvva 204,228,172
 WL 7
 Mvva 64,208,0
 TR 226,33,19520
 WL 6
 Mvva 64,212,16
 Mvva 68,208,4
 TR 228,33,28480
 Mvva 68,212,20
  buffer_load_dwordx4 a[120:123], v17, s[20:23], s46 offen offset:0 sc1
 Mvva 72,208,8
 TR 230,33,28992
 Mvva 72,212,24
 Mvva 76,208,12
 TR 208,33,19040
 WL 7
 Mvva 76,212,28
  buffer_load_dwordx4 a[124:127], v17, s[20:23], s46 offen offset:2048 sc1
 Mvva 80,216,0
 TR 210,33,19552
 WL 6
 Mvva 80,220,16
  s_add_u32 s46, s45, 114688
 Mvva 84,216,4
 TR 212,33,28512
 Mvva 84,220,20
  buffer_load_dwordx4 a[128:131], v16, s[20:23], s46 offen offset:0 sc1
 Mvva 88,216,8
 TR 214,33,29024
 Mvva 88,220,24
 Mvva 92,216,12
 TR 216,33,19072
 Mvva 92,220,28
 WL 7
 Mvva 96,224,0
 TR 218,33,19584
 WL 6
 Mvva 96,228,16
  buffer_load_dwordx4 a[132:135], v16, s[20:23], s46 offen offset:2048 sc1
 Mvva 100,224,4
 TR 220,33,28544
 Mvva 100,228,20
 Mvva 104,224,8
 TR 222,33,29056
 Mvva 104,228,24
  buffer_load_dwordx4 a[136:139], v17, s[20:23], s46 offen offset:0 sc1
 Mvva 108,224,12
 TR 224,33,19104
 Mvva 108,228,28
 WL 7
 Mvva 112,208,0
 TR 226,33,19616
 WL 6
 Mvva 112,212,16
  buffer_load_dwordx4 a[140:143], v17, s[20:23], s46 offen offset:2048 sc1
 Mvva 116,208,4
 TR 228,33,28576
 Mvva 116,212,20
  s_add_u32 s46, s45, 122880
 Mvva 120,208,8
 TR 230,33,29088
 Mvva 120,212,24
  buffer_load_dwordx4 v[40:43], v16, s[20:23], s46 offen offset:0 sc1
 Mvva 124,208,12
 TR 208,33,19136
 Mvva 124,212,28
 WL 7
 Mvva 128,216,0
 TR 210,33,19648
 WL 6
 Mvva 128,220,16
 Mvva 132,216,4
 TR 212,33,28608
 Mvva 132,220,20
  buffer_load_dwordx4 v[44:47], v16, s[20:23], s46 offen offset:2048 sc1
 Mvva 136,216,8
 TR 214,33,29120
 Mvva 136,220,24
  s_add_u32 s44, s44, 147456
 WL 4
 Mvva 140,216,12
 TR 216,33,19168
 WL 7
 Mvva 140,220,28
  buffer_load_dwordx4 v[48:51], v17, s[20:23], s46 offen offset:0 sc1
 Mvva 144,224,0
 TR 218,33,19680
  s_lshr_b32 s30, s3, 1
 Mvva 144,228,16
  s_lshl_b32 s30, s30, 28
 Mvva 148,224,4
 TR 220,33,28640
 Mvva 148,228,20
  buffer_load_dwordx4 v[52:55], v17, s[20:23], s46 offen offset:2048 sc1
 Mvva 152,224,8
 TR 222,33,29152
  s_add_u32 s44, s44, s30
 Mvva 152,228,24
  s_add_u32 m0, s47, 12288
 Mvva 156,224,12
 TR 224,57,18944
 WL 7
 Mvva 156,228,28
  buffer_load_dwordx4 v1, s[12:15], s44 offen lds
 Mvva 160,208,0
 TR 226,57,19456
 WL 6
 Mvva 160,212,16
 Mvva 164,208,4
 TR 228,57,28416
 Mvva 164,212,20
  buffer_load_dwordx4 v2, s[12:15], s44 offen offset:1056 lds
 Mvva 168,208,8
 TR 230,57,28928
 WL 6
 Mvva 168,212,24
  buffer_load_dwordx4 v3, s[12:15], s44 offen offset:2112 lds
 Mvva 172,208,12
  buffer_load_dwordx4 v4, s[12:15], s44 offen offset:3168 lds
 Mvva 172,212,28
  s_add_u32 m0, s47, 16512
  v_and_b32 v247, 3, v0
  v_lshlrev_b32 v247, 2, v247
 Mvva 176,216,0
  buffer_load_dword v248, v247, s[20:23], s54 offen offset:16 sc1
 WL 4
 Mvva 176,220,16
 WL 0
  s_waitcnt vmcnt(48)
  s_barrier
 Mvva 180,216,4
 TR 208,34,0
 Mvva 180,220,20
 TR 210,34,512
 Mvva 184,216,8
 TR 212,34,9472
 Mvva 184,220,24
 TR 214,34,9984
 Mvva 188,216,12
 TR 216,34,32
 Mvva 188,220,28
  buffer_load_dwordx4 v5, s[12:15], s44 offen lds
 Mvva 192,224,0
 TR 218,34,544
 Mvva 192,228,16
  buffer_load_dwordx4 v6, s[12:15], s44 offen offset:1056 lds
 Mvva 196,224,4
 TR 220,34,9504
  s_add_u32 s46, s45, 131072
 Mvva 196,228,20
  buffer_load_dwordx4 v7, s[12:15], s44 offen offset:2112 lds
 Mvva 200,224,8
 TR 222,34,10016
  s_waitcnt vmcnt(43)
 Mvva 200,228,24
  buffer_load_dwordx4 v8, s[12:15], s44 offen offset:3168 lds
 Mvva 204,224,12
 TR 224,34,64
  s_add_u32 m0, s47, 20736
 Mvva 204,228,28
  buffer_load_dwordx4 a[212:215], v16, s[20:23], s46 offen offset:0 sc1
 WL 7
 Mvva 64,208,32
 TR 226,34,576
 WL 6
 Mvva 64,212,48
  buffer_load_dwordx4 v9, s[20:23], s44 offen sc1 lds
 Mvva 68,208,36
 TR 228,34,9536
 Mvva 68,212,52
  buffer_load_dwordx4 a[216:219], v16, s[20:23], s46 offen offset:2048 sc1
 Mvva 72,208,40
 TR 230,34,10048
 Mvva 72,212,56
  buffer_load_dwordx4 a[220:223], v17, s[20:23], s46 offen offset:0 sc1
 Mvva 76,208,44
 TR 208,34,96
 Mvva 76,212,60
 WL 7
 Mvva 80,216,32
 TR 210,34,608
 WL 6
 Mvva 80,220,48
 Mvva 84,216,36
 TR 212,34,9568
 Mvva 84,220,52
  buffer_load_dwordx4 a[224:227], v17, s[20:23], s46 offen offset:2048 sc1
 Mvva 88,216,40
 TR 214,34,10080
  s_add_u32 s46, s45, 139264
 Mvva 88,220,56
 Mvva 92,216,44
 TR 216,34,128
 WL 7
 Mvva 92,220,60
  buffer_load_dwordx4 a[228:231], v16, s[20:23], s46 offen offset:0 sc1
 Mvva 96,224,32
 TR 218,34,640
 WL 6
 Mvva 96,228,48
 Mvva 100,224,36
 TR 220,34,9600
 Mvva 100,228,52
  buffer_load_dwordx4 a[232:235], v16, s[20:23], s46 offen offset:2048 sc1
 Mvva 104,224,40
 TR 222,34,10112
 Mvva 104,228,56
  global_load_dword a248, v249, s[100:101]
 Mvva 108,224,44
 TR 224,34,160
 WL 7
 Mvva 108,228,60
  buffer_load_dwordx4 a[236:239], v17, s[20:23], s46 offen offset:0 sc1
 Mvva 112,208,32
 TR 226,34,672
 WL 6
 Mvva 112,212,48
 Mvva 116,208,36
 TR 228,34,9632
  s_mov_b32 s44, s25
 Mvva 116,212,52
 Mvva 120,208,40
 TR 230,34,10144
  v_add_u32 v9, 4096, v9
 Mvva 120,212,56
  buffer_load_dwordx4 a[240:243], v17, s[20:23], s46 offen offset:2048 sc1
 Mvva 124,208,44
 TR 208,34,192
  s_add_u32 m0, s47, 125952
 Mvva 124,212,60
 WL 7
 Mvva 128,216,32
 TR 210,34,704
 WL 6
 Mvva 128,220,48
  buffer_load_dwordx4 v1, s[40:43], s44 offen lds
 Mvva 132,216,36
 TR 212,34,9664
 Mvva 132,220,52
 Mvva 136,216,40
 TR 214,34,10176
 Mvva 136,220,56
  buffer_load_dwordx4 v2, s[40:43], s44 offen offset:1056 lds
 Mvva 140,216,44
 TR 216,34,224
 Mvva 140,220,60
 WL 7
 Mvva 144,224,32
 TR 218,34,736
 WL 6
 Mvva 144,228,48
  buffer_load_dwordx4 v3, s[40:43], s44 offen offset:2112 lds
 Mvva 148,224,36
 TR 220,34,9696
 Mvva 148,228,52
 Mvva 152,224,40
 TR 222,34,10208
 Mvva 152,228,56
 WL 4
 Mvva 156,224,44
 TR 224,58,0
 WL 7
 Mvva 156,228,60
  buffer_load_dwordx4 v4, s[40:43], s44 offen offset:3168 lds
 Mvva 160,208,32
 TR 226,58,512
  s_add_u32 m0, s47, 130176
 Mvva 160,212,48
 Mvva 164,208,36
 TR 228,58,9472
 Mvva 164,212,52
  buffer_load_dwordx4 v5, s[40:43], s44 offen lds
 Mvva 168,208,40
 TR 230,58,9984
 Mvva 168,212,56
 Mvva 172,208,44
 TR 208,34,18944
 WL 7
 Mvva 172,212,60
  buffer_load_dwordx4 v6, s[40:43], s44 offen offset:1056 lds
 Mvva 176,216,32
 TR 210,34,19456
 WL 6
 Mvva 176,220,48
 Mvva 180,216,36
 TR 212,34,28416
 Mvva 180,220,52
 Mvva 184,216,40
 TR 214,34,28928
 Mvva 184,220,56
  buffer_load_dwordx4 v7, s[40:43], s44 offen offset:2112 lds
 Mvva 188,216,44
 TR 216,34,18976
 Mvva 188,220,60
 WL 7
 Mvva 192,224,32
 TR 218,34,19488
 WL 6
 Mvva 192,228,48
  buffer_load_dwordx4 v8, s[40:43], s44 offen offset:3168 lds
 Mvva 196,224,36
 TR 220,34,28448
 Mvva 196,228,52
  s_waitcnt vmcnt(22)
  v_cmp_gt_u32 vcc, 1, v248
  s_nop 4
  s_cbranch_vccnz Lpoll_ctx_9
Lback_ctx_9:
 Mvva 200,224,40
 TR 222,34,28960
 Mvva 200,228,56
  s_add_u32 m0, s47, 134400
 WL 4
 Mvva 204,224,44
 TR 224,34,19008
 WL 7
 Mvva 204,228,60
  buffer_load_dwordx4 v9, s[20:23], s44 offen sc1 lds
 Mvva 64,208,64
 TR 226,34,19520
  s_add_u32 s46, s24, 0
 Mvva 64,212,80
  buffer_load_dwordx4 a[176:179], v16, s[20:23], s46 offen offset:0 sc1
 Mvva 68,208,68
 TR 228,34,28480
 Mvva 68,212,84
 Mvva 72,208,72
 TR 230,34,28992
 Mvva 72,212,88
 Mvva 76,208,76
 TR 208,34,19040
 WL 7
 Mvva 76,212,92
  buffer_load_dwordx4 a[180:183], v16, s[20:23], s46 offen offset:2048 sc1
 Mvva 80,216,64
 TR 210,34,19552
 WL 6
 Mvva 80,220,80
 Mvva 84,216,68
 TR 212,34,28512
 Mvva 84,220,84
  buffer_load_dwordx4 a[184:187], v17, s[20:23], s46 offen offset:0 sc1
 Mvva 88,216,72
 TR 214,34,29024
 Mvva 88,220,88
 Mvva 92,216,76
 TR 216,34,19072
 WL 7
 Mvva 92,220,92
  buffer_load_dwordx4 a[188:191], v17, s[20:23], s46 offen offset:2048 sc1
 Mvva 96,224,64
 TR 218,34,19584
 WL 6
 Mvva 96,228,80
  s_add_u32 s46, s24, 8192
 Mvva 100,224,68
 TR 220,34,28544
 Mvva 100,228,84
  buffer_load_dwordx4 a[192:195], v16, s[20:23], s46 offen offset:0 sc1
 Mvva 104,224,72
 TR 222,34,29056
 Mvva 104,228,88
 Mvva 108,224,76
 TR 224,34,19104
 Mvva 108,228,92
 WL 7
 Mvva 112,208,64
 TR 226,34,19616
 WL 6
 Mvva 112,212,80
  buffer_load_dwordx4 a[196:199], v16, s[20:23], s46 offen offset:2048 sc1
 Mvva 116,208,68
 TR 228,34,28576
 Mvva 116,212,84
 Mvva 120,208,72
 TR 230,34,29088
 Mvva 120,212,88
  buffer_load_dwordx4 a[200:203], v17, s[20:23], s46 offen offset:0 sc1
 Mvva 124,208,76
 TR 208,34,19136
 Mvva 124,212,92
 WL 7
 Mvva 128,216,64
 TR 210,34,19648
 WL 6
 Mvva 128,220,80
  buffer_load_dwordx4 a[204:207], v17, s[20:23], s46 offen offset:2048 sc1
 Mvva 132,216,68
 TR 212,34,28608
 Mvva 132,220,84
 Mvva 136,216,72
 TR 214,34,29120
  s_add_u32 s46, s24, 16384
 Mvva 136,220,88
 Mvva 140,216,76
 TR 216,34,19168
 WL 7
 Mvva 140,220,92
  buffer_load_dwordx4 a[144:147], v16, s[20:23], s46 offen offset:0 sc1
 Mvva 144,224,64
 TR 218,34,19680
 WL 6
 Mvva 144,228,80
 Mvva 148,224,68
 TR 220,34,28640
 Mvva 148,228,84
  buffer_load_dwordx4 a[148:151], v16, s[20:23], s46 offen offset:2048 sc1
 Mvva 152,224,72
 TR 222,34,29152
 Mvva 152,228,88
 Mvva 156,224,76
 TR 224,58,18944
 WL 7
 Mvva 156,228,92
  buffer_load_dwordx4 a[152:155], v17, s[20:23], s46 offen offset:0 sc1
 Mvva 160,208,64
 TR 226,58,19456
 WL 6
 Mvva 160,212,80
 Mvva 164,208,68
 TR 228,58,28416
 Mvva 164,212,84
  buffer_load_dwordx4 a[156:159], v17, s[20:23], s46 offen offset:2048 sc1
 Mvva 168,208,72
 TR 230,58,28928
 Mvva 168,212,88
 Mvva 172,208,76
  s_add_u32 s46, s24, 24576
 Mvva 172,212,92
 WL 6
 WL 4
 Mvva 176,216,64
  buffer_load_dwordx4 a[160:163], v16, s[20:23], s46 offen offset:0 sc1
 Mvva 176,220,80
 WL 0
  s_barrier
 Mvva 180,216,68
 TR 208,35,0
 Mvva 180,220,84
 TR 210,35,512
 Mvva 184,216,72
 TR 212,35,9472
 Mvva 184,220,88
 TR 214,35,9984
 Mvva 188,216,76
 TR 216,35,32
 Mvva 188,220,92
  buffer_load_dwordx4 a[164:167], v16, s[20:23], s46 offen offset:2048 sc1
 Mvva 192,224,64
 TR 218,35,544
 Mvva 192,228,80
  buffer_load_dwordx4 a[168:171], v17, s[20:23], s46 offen offset:0 sc1
 Mvva 196,224,68
 TR 220,35,9504
 Mvva 196,228,84
 Mvva 200,224,72
 TR 222,35,10016
 Mvva 200,228,88
  buffer_load_dwordx4 a[172:175], v17, s[20:23], s46 offen offset:2048 sc1
 Mvva 204,224,76
 TR 224,35,64
  s_add_u32 s44, s44, 1179648
 Mvva 204,228,92
 WL 7
 WL 5
 Mvva 64,208,96
 TR 226,35,576
  s_add_u32 m0, s47, 50176
 Mvva 64,212,112
 Mvva 68,208,100
 TR 228,35,9536
 Mvva 68,212,116
  buffer_load_dwordx4 v1, s[40:43], s44 offen lds
 Mvva 72,208,104
 TR 230,35,10048
 Mvva 72,212,120
 Mvva 76,208,108
 TR 208,35,96
 WL 7
 Mvva 76,212,124
  buffer_load_dwordx4 v2, s[40:43], s44 offen offset:1056 lds
 Mvva 80,216,96
 TR 210,35,608
 WL 6
 Mvva 80,220,112
 Mvva 84,216,100
 TR 212,35,9568
 Mvva 84,220,116
  buffer_load_dwordx4 v3, s[40:43], s44 offen offset:2112 lds
 Mvva 88,216,104
 TR 214,35,10080
 Mvva 88,220,120
 Mvva 92,216,108
 TR 216,35,128
 Mvva 92,220,124
 WL 7
 Mvva 96,224,96
 TR 218,35,640
 WL 6
 Mvva 96,228,112
  buffer_load_dwordx4 v4, s[40:43], s44 offen offset:3168 lds
 Mvva 100,224,100
 TR 220,35,9600
  s_add_u32 m0, s47, 54400
 Mvva 100,228,116
 Mvva 104,224,104
 TR 222,35,10112
 Mvva 104,228,120
  buffer_load_dwordx4 v5, s[40:43], s44 offen lds
 Mvva 108,224,108
 TR 224,35,160
 Mvva 108,228,124
 WL 7
 Mvva 112,208,96
 TR 226,35,672
 WL 6
 Mvva 112,212,112
  buffer_load_dwordx4 v6, s[40:43], s44 offen offset:1056 lds
 Mvva 116,208,100
 TR 228,35,9632
 Mvva 116,212,116
 Mvva 120,208,104
 TR 230,35,10144
 Mvva 120,212,120
  buffer_load_dwordx4 v7, s[40:43], s44 offen offset:2112 lds
 Mvva 124,208,108
 TR 208,35,192
 Mvva 124,212,124
 WL 7
 Mvva 128,216,96
 TR 210,35,704
 WL 6
 Mvva 128,220,112
 Mvva 132,216,100
 TR 212,35,9664
 Mvva 132,220,116
  buffer_load_dwordx4 v8, s[40:43], s44 offen offset:3168 lds
 Mvva 136,216,104
 TR 214,35,10176
  s_add_u32 m0, s47, 58624
 Mvva 136,220,120
 Mvva 140,216,108
 TR 216,35,224
 WL 7
 Mvva 140,220,124
  buffer_load_dwordx4 v9, s[20:23], s44 offen sc1 lds
 Mvva 144,224,96
 TR 218,35,736
 WL 6
 Mvva 144,228,112
  s_add_u32 s46, s24, 32768
 Mvva 148,224,100
 TR 220,35,9696
 Mvva 148,228,116
  buffer_load_dwordx4 a[0:3], v16, s[20:23], s46 offen offset:0 sc1
 Mvva 152,224,104
 TR 222,35,10208
 Mvva 152,228,120
 Mvva 156,224,108
 TR 224,59,0
 Mvva 156,228,124
 WL 7
 Mvva 160,208,96
 TR 226,59,512
 WL 6
 Mvva 160,212,112
  buffer_load_dwordx4 a[4:7], v16, s[20:23], s46 offen offset:2048 sc1
 Mvva 164,208,100
 TR 228,59,9472
 Mvva 164,212,116
 Mvva 168,208,104
 TR 230,59,9984
 Mvva 168,212,120
  buffer_load_dwordx4 a[8:11], v17, s[20:23], s46 offen offset:0 sc1
 Mvva 172,208,108
 TR 208,35,18944
 Mvva 172,212,124
 WL 7
 Mvva 176,216,96
 TR 210,35,19456
 WL 6
 Mvva 176,220,112
  buffer_load_dwordx4 a[12:15], v17, s[20:23], s46 offen offset:2048 sc1
 Mvva 180,216,100
 TR 212,35,28416
 Mvva 180,220,116
  s_add_u32 s46, s24, 40960
 Mvva 184,216,104
 TR 214,35,28928
 Mvva 184,220,120
  buffer_load_dwordx4 a[16:19], v16, s[20:23], s46 offen offset:0 sc1
 Mvva 188,216,108
 TR 216,35,18976
 Mvva 188,220,124
 WL 7
 Mvva 192,224,96
 TR 218,35,19488
 WL 6
 Mvva 192,228,112
 Mvva 196,224,100
 TR 220,35,28448
 Mvva 196,228,116
  buffer_load_dwordx4 a[20:23], v16, s[20:23], s46 offen offset:2048 sc1
 Mvva 200,224,104
 TR 222,35,28960
 Mvva 200,228,120
 Mvva 204,224,108
 TR 224,35,19008
 WL 7
 Mvva 204,228,124
  buffer_load_dwordx4 a[24:27], v17, s[20:23], s46 offen offset:0 sc1
 Mvva 64,208,128
 TR 226,35,19520
 WL 6
 Mvvv 64,212,40
 Mvva 68,208,132
 TR 228,35,28480
 Mvvv 68,212,44
  buffer_load_dwordx4 a[28:31], v17, s[20:23], s46 offen offset:2048 sc1
 Mvva 72,208,136
 TR 230,35,28992
 Mvvv 72,212,48
  s_add_u32 s46, s24, 49152
 Mvva 76,208,140
 TR 208,35,19040
 WL 7
 Mvvv 76,212,52
  buffer_load_dwordx4 a[32:35], v16, s[20:23], s46 offen offset:0 sc1
 Mvva 80,216,128
 TR 210,35,19552
 WL 6
 Mvvv 80,220,40
 Mvva 84,216,132
 TR 212,35,28512
 Mvvv 84,220,44
 Mvva 88,216,136
 TR 214,35,29024
 Mvvv 88,220,48
  buffer_load_dwordx4 a[36:39], v16, s[20:23], s46 offen offset:2048 sc1
 Mvva 92,216,140
 TR 216,35,19072
 Mvvv 92,220,52
 WL 7
 Mvva 96,224,128
 TR 218,35,19584
 WL 6
 Mvvv 96,228,40
  buffer_load_dwordx4 a[40:43], v17, s[20:23], s46 offen offset:0 sc1
 Mvva 100,224,132
 TR 220,35,28544
 Mvvv 100,228,44
 Mvva 104,224,136
 TR 222,35,29056
 Mvvv 104,228,48
  buffer_load_dwordx4 a[44:47], v17, s[20:23], s46 offen offset:2048 sc1
 Mvva 108,224,140
 TR 224,35,19104
 Mvvv 108,228,52
 WL 7
 WL 5
 Mvva 112,208,128
 TR 226,35,19616
  s_add_u32 s46, s24, 57344
 Mvvv 112,212,40
 Mvva 116,208,132
 TR 228,35,28576
 Mvvv 116,212,44
  buffer_load_dwordx4 a[48:51], v16, s[20:23], s46 offen offset:0 sc1
 Mvva 120,208,136
 TR 230,35,29088
 Mvvv 120,212,48
 Mvva 124,208,140
 TR 208,35,19136
 WL 7
 Mvvv 124,212,52
  buffer_load_dwordx4 a[52:55], v16, s[20:23], s46 offen offset:2048 sc1
 Mvva 128,216,128
 TR 210,35,19648
 WL 6
 Mvvv 128,220,40
 Mvva 132,216,132
 TR 212,35,28608
 Mvvv 132,220,44
  buffer_load_dwordx4 a[56:59], v17, s[20:23], s46 offen offset:0 sc1
 Mvva 136,216,136
 TR 214,35,29120
 Mvvv 136,220,48
 Mvva 140,216,140
 TR 216,35,19168
 WL 7
 Mvvv 140,220,52
  buffer_load_dwordx4 a[60:63], v17, s[20:23], s46 offen offset:2048 sc1
 Mvva 144,224,128
 TR 218,35,19680
 WL 6
 Mvvv 144,228,40
 Mvva 148,224,132
 TR 220,35,28640
  s_add_u32 s46, s24, 65536
 Mvvv 148,228,44
 Mvva 152,224,136
 TR 222,35,29152
 Mvvv 152,228,48
  buffer_load_dwordx4 a[64:67], v16, s[20:23], s46 offen offset:0 sc1
 Mvva 156,224,140
 TR 224,59,18944
 Mvvv 156,228,52
 WL 7
 Mvva 160,208,128
 TR 226,59,19456
 WL 6
 Mvvv 160,212,40
  buffer_load_dwordx4 a[68:71], v16, s[20:23], s46 offen offset:2048 sc1
 Mvva 164,208,132
 TR 228,59,28416
 Mvvv 164,212,44
 Mvva 168,208,136
 TR 230,59,28928
 Mvvv 168,212,48
  buffer_load_dwordx4 a[72:75], v17, s[20:23], s46 offen offset:0 sc1
 Mvva 172,208,140
 Mvvv 172,212,52
 WL 6
 Mvva 176,216,128
 WL 4
 Mvvv 176,220,40
 WL 0
  s_waitcnt vmcnt(61)
  s_barrier
 Mvva 180,216,132
 TR 208,32,0
  s_add_u32 s44, s44, 1179648
 Mvvv 180,220,44
 TR 210,32,512
 Mvva 184,216,136
 TR 212,32,9472
  s_add_u32 m0, s47, 88064
 Mvvv 184,220,48
 TR 214,32,9984
 Mvva 188,216,140
 TR 216,32,32
 Mvvv 188,220,52
  buffer_load_dwordx4 a[76:79], v17, s[20:23], s46 offen offset:2048 sc1
 Mvva 192,224,128
 TR 218,32,544
 Mvvv 192,228,40
  buffer_load_dwordx4 v1, s[40:43], s44 offen lds
 Mvva 196,224,132
 TR 220,32,9504
 Mvvv 196,228,44
  buffer_load_dwordx4 v2, s[40:43], s44 offen offset:1056 lds
 Mvva 200,224,136
 TR 222,32,10016
  s_waitcnt vmcnt(56)
 Mvvv 200,228,48
 Mvva 204,224,140
 TR 224,32,64
 WL 7
 Mvvv 204,228,52
  buffer_load_dwordx4 v3, s[40:43], s44 offen offset:2112 lds
 Mvva 64,208,212
 TR 226,32,576
 WL 6
 Mvva 64,212,228
 Mvva 68,208,216
 TR 228,32,9536
 Mvva 68,212,232
 Mvva 72,208,220
 TR 230,32,10048
 Mvva 72,212,236
  buffer_load_dwordx4 v4, s[40:43], s44 offen offset:3168 lds
 Mvva 76,208,224
 TR 208,32,96
  s_add_u32 m0, s47, 92288
 Mvva 76,212,240
 WL 7
 Mvva 80,216,212
 TR 210,32,608
 WL 6
 Mvva 80,220,228
  buffer_load_dwordx4 v5, s[40:43], s44 offen lds
 Mvva 84,216,216
 TR 212,32,9568
 Mvva 84,220,232
 Mvva 88,216,220
 TR 214,32,10080
 Mvva 88,220,236
  buffer_load_dwordx4 v6, s[40:43], s44 offen offset:1056 lds
 Mvva 92,216,224
 TR 216,32,128
 Mvva 92,220,240
 WL 7
 Mvva 96,224,212
 TR 218,32,640
 WL 6
 Mvva 96,228,228
  buffer_load_dwordx4 v7, s[40:43], s44 offen offset:2112 lds
 Mvva 100,224,216
 TR 220,32,9600
 Mvva 100,228,232
 Mvva 104,224,220
 TR 222,32,10112
 Mvva 104,228,236
 WL 4
 Mvva 108,224,224
 TR 224,32,160
 WL 7
 Mvva 108,228,240
  buffer_load_dwordx4 v8, s[40:43], s44 offen offset:3168 lds
 Mvva 112,208,212
 TR 226,32,672
  s_add_u32 m0, s47, 96512
 Mvva 112,212,228
 Mvva 116,208,216
 TR 228,32,9632
 Mvva 116,212,232
  buffer_load_dwordx4 v9, s[20:23], s44 offen sc1 lds
 Mvva 120,208,220
 TR 230,32,10144
 Mvva 120,212,236
  s_add_u32 s46, s24, 73728
 Mvva 124,208,224
 TR 208,32,192
 WL 7
 Mvva 124,212,240
  buffer_load_dwordx4 a[80:83], v16, s[20:23], s46 offen offset:0 sc1
 Mvva 128,216,212
 TR 210,32,704
 WL 6
 Mvva 128,220,228
 Mvva 132,216,216
 TR 212,32,9664
 Mvva 132,220,232
  buffer_load_dwordx4 a[84:87], v16, s[20:23], s46 offen offset:2048 sc1
 Mvva 136,216,220
 TR 214,32,10176
 Mvva 136,220,236
  global_load_dword a248, v249, s[100:101]
 Mvva 140,216,224
 TR 216,32,224
 Mvva 140,220,240
 WL 7
 Mvva 144,224,212
 TR 218,32,736
 WL 6
 Mvva 144,228,228
  buffer_load_dwordx4 a[88:91], v17, s[20:23], s46 offen offset:0 sc1
 Mvva 148,224,216
 TR 220,32,9696
 Mvva 148,228,232
 Mvva 152,224,220
 TR 222,32,10208
 Mvva 152,228,236
  buffer_load_dwordx4 a[92:95], v17, s[20:23], s46 offen offset:2048 sc1
 Mvva 156,224,224
 TR 224,56,0
 Mvva 156,228,240
  s_add_u32 s46, s24, 81920
 WL 7
 Mvva 160,208,212
 TR 226,56,512
 WL 6
 Mvva 160,212,228
  buffer_load_dwordx4 a[96:99], v16, s[20:23], s46 offen offset:0 sc1
 Mvva 164,208,216
 TR 228,56,9472
 Mvva 164,212,232
 Mvva 168,208,220
 TR 230,56,9984
 Mvva 168,212,236
 Mvva 172,208,224
  buffer_load_dwordx4 a[100:103], v16, s[20:23], s46 offen offset:2048 sc1
 Mvva 172,212,240
 WL 6
 Mvva 176,216,212
 WL 4
 Mvva 176,220,228
 WL 0
  s_waitcnt vmcnt(61)
  s_barrier
 Mvva 180,216,216
 TR 208,33,0
 Mvva 180,220,232
 TR 210,33,512
  s_add_u32 s44, s44, 1179648
 Mvva 184,216,220
 TR 212,33,9472
 Mvva 184,220,236
 TR 214,33,9984
  s_add_u32 m0, s47, 12288
 Mvva 188,216,224
 TR 216,33,32
 Mvva 188,220,240
  buffer_load_dwordx4 a[104:107], v17, s[20:23], s46 offen offset:0 sc1
 Mvva 192,224,212
 TR 218,33,544
 Mvva 192,228,228
  buffer_load_dwordx4 v1, s[40:43], s44 offen lds
 Mvva 196,224,216
 TR 220,33,9504
 Mvva 196,228,232
  buffer_load_dwordx4 v2, s[40:43], s44 offen offset:1056 lds
 Mvva 200,224,220
 TR 222,33,10016
  s_waitcnt vmcnt(56)
 Mvva 200,228,236
 Mvva 204,224,224
 TR 224,33,64
 Mvva 204,228,240
 WL 7
 Mvva 64,208,176
 TR 226,33,576
 WL 6
 Mvva 64,212,192
  buffer_load_dwordx4 v3, s[40:43], s44 offen offset:2112 lds
 Mvva 68,208,180
 TR 228,33,9536
 Mvva 68,212,196
 Mvva 72,208,184
 TR 230,33,10048
 Mvva 72,212,200
  buffer_load_dwordx4 v4, s[40:43], s44 offen offset:3168 lds
 Mvva 76,208,188
 TR 208,33,96
 Mvva 76,212,204
  s_add_u32 m0, s47, 16512
 WL 7
 Mvva 80,216,176
 TR 210,33,608
 WL 6
 Mvva 80,220,192
  buffer_load_dwordx4 v5, s[40:43], s44 offen lds
 Mvva 84,216,180
 TR 212,33,9568
 Mvva 84,220,196
 Mvva 88,216,184
 TR 214,33,10080
 Mvva 88,220,200
 Mvva 92,216,188
 TR 216,33,128
 WL 7
 Mvva 92,220,204
  buffer_load_dwordx4 v6, s[40:43], s44 offen offset:1056 lds
 Mvva 96,224,176
 TR 218,33,640
 WL 6
 Mvva 96,228,192
 Mvva 100,224,180
 TR 220,33,9600
 Mvva 100,228,196
  buffer_load_dwordx4 v7, s[40:43], s44 offen offset:2112 lds
 Mvva 104,224,184
 TR 222,33,10112
 Mvva 104,228,200
 Mvva 108,224,188
 TR 224,33,160
 WL 7
 Mvva 108,228,204
  buffer_load_dwordx4 v8, s[40:43], s44 offen offset:3168 lds
 Mvva 112,208,176
 TR 226,33,672
 WL 6
 Mvva 112,212,192
  s_add_u32 m0, s47, 20736
 Mvva 116,208,180
 TR 228,33,9632
 Mvva 116,212,196
  buffer_load_dwordx4 v9, s[20:23], s44 offen sc1 lds
 Mvva 120,208,184
 TR 230,33,10144
 Mvva 120,212,200
 Mvva 124,208,188
 TR 208,33,192
 Mvva 124,212,204
 WL 7
 Mvva 128,216,176
 TR 210,33,704
 WL 6
 Mvva 128,220,192
  buffer_load_dwordx4 a[108:111], v17, s[20:23], s46 offen offset:2048 sc1
 Mvva 132,216,180
 TR 212,33,9664
  s_add_u32 s46, s24, 90112
 Mvva 132,220,196
 Mvva 136,216,184
 TR 214,33,10176
 Mvva 136,220,200
  buffer_load_dwordx4 a[112:115], v16, s[20:23], s46 offen offset:0 sc1
 Mvva 140,216,188
 TR 216,33,224
 Mvva 140,220,204
 WL 7
 Mvva 144,224,176
 TR 218,33,736
 WL 6
 Mvva 144,228,192
  buffer_load_dwordx4 a[116:119], v16, s[20:23], s46 offen offset:2048 sc1
 Mvva 148,224,180
 TR 220,33,9696
 Mvva 148,228,196
 Mvva 152,224,184
 TR 222,33,10208
 Mvva 152,228,200
  buffer_load_dwordx4 a[120:123], v17, s[20:23], s46 offen offset:0 sc1
 Mvva 156,224,188
 TR 224,57,0
 Mvva 156,228,204
 WL 7
 Mvva 160,208,176
 TR 226,57,512
 WL 6
 Mvva 160,212,192
 Mvva 164,208,180
 TR 228,57,9472
 Mvva 164,212,196
  buffer_load_dwordx4 a[124:127], v17, s[20:23], s46 offen offset:2048 sc1
 Mvva 168,208,184
 TR 230,57,9984
  s_add_u32 s46, s24, 98304
 Mvva 168,212,200
 Mvva 172,208,188
 TR 208,33,18944
 WL 7
 Mvva 172,212,204
  buffer_load_dwordx4 a[128:131], v16, s[20:23], s46 offen offset:0 sc1
 Mvva 176,216,176
 TR 210,33,19456
 WL 6
 Mvva 176,220,192
 Mvva 180,216,180
 TR 212,33,28416
 Mvva 180,220,196
  buffer_load_dwordx4 a[132:135], v16, s[20:23], s46 offen offset:2048 sc1
 Mvva 184,216,184
 TR 214,33,28928
 Mvva 184,220,200
 Mvva 188,216,188
 TR 216,33,18976
 Mvva 188,220,204
 WL 7
 Mvva 192,224,176
 TR 218,33,19488
 WL 6
 Mvva 192,228,192
  buffer_load_dwordx4 a[136:139], v17, s[20:23], s46 offen offset:0 sc1
 Mvva 196,224,180
 TR 220,33,28448
 Mvva 196,228,196
 Mvva 200,224,184
 TR 222,33,28960
  s_waitcnt vmcnt(62)
 Mvva 200,228,200
  buffer_load_dwordx4 a[140:143], v17, s[20:23], s46 offen offset:2048 sc1
 Mvva 204,224,188
 TR 224,33,19008
 Mvva 204,228,204
  s_add_u32 s46, s24, 106496
 WL 7
 Mvva 64,208,144
 TR 226,33,19520
 WL 6
 Mvva 64,212,160
  buffer_load_dwordx4 v[40:43], v16, s[20:23], s46 offen offset:0 sc1
 Mvva 68,208,148
 TR 228,33,28480
 Mvva 68,212,164
 Mvva 72,208,152
 TR 230,33,28992
 Mvva 72,212,168
  buffer_load_dwordx4 v[44:47], v16, s[20:23], s46 offen offset:2048 sc1
 Mvva 76,208,156
 TR 208,33,19040
 Mvva 76,212,172
 WL 7
 Mvva 80,216,144
 TR 210,33,19552
 WL 6
 Mvva 80,220,160
 Mvva 84,216,148
 TR 212,33,28512
 Mvva 84,220,164
  buffer_load_dwordx4 v[48:51], v17, s[20:23], s46 offen offset:0 sc1
 Mvva 88,216,152
 TR 214,33,29024
 Mvva 88,220,168
 Mvva 92,216,156
 TR 216,33,19072
 WL 7
 Mvva 92,220,172
  buffer_load_dwordx4 v[52:55], v17, s[20:23], s46 offen offset:2048 sc1
 Mvva 96,224,144
 TR 218,33,19584
 WL 6
 Mvva 96,228,160
  s_add_u32 s46, s24, 114688
 Mvva 100,224,148
 TR 220,33,28544
 Mvva 100,228,164
  buffer_load_dwordx4 a[212:215], v16, s[20:23], s46 offen offset:0 sc1
 Mvva 104,224,152
 TR 222,33,29056
 Mvva 104,228,168
 Mvva 108,224,156
 TR 224,33,19104
 WL 7
 Mvva 108,228,172
  buffer_load_dwordx4 a[216:219], v16, s[20:23], s46 offen offset:2048 sc1
 Mvva 112,208,144
 TR 226,33,19616
 WL 6
 Mvva 112,212,160
 Mvva 116,208,148
 TR 228,33,28576
 Mvva 116,212,164
 Mvva 120,208,152
 TR 230,33,29088
 Mvva 120,212,168
  buffer_load_dwordx4 a[220:223], v17, s[20:23], s46 offen offset:0 sc1
 Mvva 124,208,156
 TR 208,33,19136
 Mvva 124,212,172
 WL 7
 Mvva 128,216,144
 TR 210,33,19648
 WL 6
 Mvva 128,220,160
  buffer_load_dwordx4 a[224:227], v17, s[20:23], s46 offen offset:2048 sc1
 Mvva 132,216,148
 TR 212,33,28608
 Mvva 132,220,164
  s_add_u32 s46, s24, 122880
 Mvva 136,216,152
 TR 214,33,29120
 Mvva 136,220,168
  buffer_load_dwordx4 a[228:231], v16, s[20:23], s46 offen offset:0 sc1
 Mvva 140,216,156
 TR 216,33,19168
 Mvva 140,220,172
 WL 7
 Mvva 144,224,144
 TR 218,33,19680
 WL 6
 Mvva 144,228,160
 Mvva 148,224,148
 TR 220,33,28640
 Mvva 148,228,164
  buffer_load_dwordx4 a[232:235], v16, s[20:23], s46 offen offset:2048 sc1
 Mvva 152,224,152
 TR 222,33,29152
 Mvva 152,228,168
 Mvva 156,224,156
 TR 224,57,18944
 WL 7
 Mvva 156,228,172
  buffer_load_dwordx4 a[236:239], v17, s[20:23], s46 offen offset:0 sc1
 Mvva 160,208,144
 TR 226,57,19456
 WL 6
 Mvva 160,212,160
 Mvva 164,208,148
 TR 228,57,28416
 Mvva 164,212,164
  buffer_load_dwordx4 a[240:243], v17, s[20:23], s46 offen offset:2048 sc1
 Mvva 168,208,152
 TR 230,57,28928
 Mvva 168,212,168
 Mvva 172,208,156
 Mvva 172,212,172
 WL 6
 Mvva 176,216,144
 WL 4
 Mvva 176,220,160
 WL 0
  s_waitcnt vmcnt(62)
  s_barrier
 Mvva 180,216,148
 TR 208,34,0
 Mvva 180,220,164
 TR 210,34,512
 Mvva 184,216,152
 TR 212,34,9472
 Mvva 184,220,168
 TR 214,34,9984
 Mvva 188,216,156
 TR 216,34,18944
 Mvva 188,220,172
 Mvva 192,224,144
 TR 218,34,19456
 Mvva 192,228,160
 Mvva 196,224,148
 TR 220,34,28416
 Mvva 196,228,164
 Mvva 200,224,152
 TR 222,34,28928
  s_waitcnt vmcnt(59)
 Mvva 200,228,168
 Mvva 204,224,156
 Mvva 204,228,172
 WL 6
 Mvva 64,208,0
 WL 4
 Mvva 64,212,16
 WL 0
  s_waitcnt vmcnt(38)
  s_barrier
 Mvva 68,208,4
 TR 224,35,0
 Mvva 68,212,20
 TR 226,35,512
 Mvva 72,208,8
 TR 228,35,9472
 Mvva 72,212,24
 TR 230,35,9984
 Mvva 76,208,12
 TR 208,35,18944
 Mvva 76,212,28
 Mvva 64,216,32
 TR 210,35,19456
 Mvva 64,220,48
 Mvva 68,216,36
 TR 212,35,28416
 Mvva 68,220,52
 Mvva 72,216,40
 TR 214,35,28928
  s_waitcnt vmcnt(33)
 Mvva 72,220,56
 Mvva 76,216,44
 Mvva 76,220,60
 WL 6
 Mvva 64,224,64
 WL 4
 Mvva 64,228,80
 WL 0
  s_waitcnt vmcnt(21)
  s_barrier
 Mvva 68,224,68
 TR 216,32,0
 Mvva 68,228,84
 TR 218,32,512
 Mvva 72,224,72
 TR 220,32,9472
  s_waitcnt vmcnt(16)
 Mvva 72,228,88
 TR 222,32,9984
 Mvva 76,224,76
 TR 224,32,18944
 Mvva 76,228,92
 Mvva 64,208,96
 TR 226,32,19456
 Mvva 64,212,112
 Mvva 68,208,100
 TR 228,32,28416
 Mvva 68,212,116
 Mvva 72,208,104
 TR 230,32,28928
  s_waitcnt vmcnt(8)
 Mvva 72,212,120
 Mvva 76,208,108
 TR 208,34,32
 Mvva 76,212,124
 WL 7
 Mvva 64,216,128
 TR 210,34,544
 WL 6
 Mvvv 64,220,40
 Mvva 68,216,132
 TR 212,34,9504
 Mvvv 68,220,44
 Mvva 72,216,136
 TR 214,34,10016
  s_waitcnt vmcnt(0)
 Mvvv 72,220,48
 Mvva 76,216,140
 TR 216,34,18976
 Mvvv 76,220,52
 WL 7
 WL 5
 Mvva 64,224,212
 TR 218,34,19488
  v_and_b32 v247, 7, v0
 Mvva 64,228,228
  v_lshlrev_b32 v247, 2, v247
 Mvva 68,224,216
 TR 220,34,28448
 Mvva 68,228,232
  buffer_load_dword v248, v247, s[20:23], s54 offen offset:32 sc1
 Mvva 72,224,220
 TR 222,34,28960
 Mvva 72,228,236
 Mvva 76,224,224
 TR 224,35,32
 Mvva 76,228,240
 WL 7
 WL 5
 Mvva 80,208,0
 TR 226,35,544
  v_cvt_pk_bf16_f32 v64, v64, v65
 Mvva 80,212,16
  v_cvt_pk_bf16_f32 v65, v66, v67
  v_cvt_pk_bf16_f32 v66, v68, v69
 Mvva 84,208,4
 TR 228,35,9504
  v_cvt_pk_bf16_f32 v67, v70, v71
 Mvva 84,212,20
  v_min_u32 v64, -2, v64
  v_min_u32 v65, -2, v65
 Mvva 88,208,8
 TR 230,35,10016
  v_min_u32 v66, -2, v66
 Mvva 88,212,24
  v_min_u32 v67, -2, v67
 WL 4
 Mvva 92,208,12
 TR 208,35,18976
 WL 7
 Mvva 92,212,28
  buffer_store_dwordx4 v[64:67], v16, s[8:11], 0 offen offset:0 sc1
 Mvva 80,216,32
 TR 210,35,19488
  v_cvt_pk_bf16_f32 v72, v72, v73
 Mvva 80,220,48
  v_cvt_pk_bf16_f32 v73, v74, v75
  v_cvt_pk_bf16_f32 v74, v76, v77
 Mvva 84,216,36
 TR 212,35,28448
  v_cvt_pk_bf16_f32 v75, v78, v79
 Mvva 84,220,52
  v_min_u32 v72, -2, v72
  v_min_u32 v73, -2, v73
 Mvva 88,216,40
 TR 214,35,28960
  v_min_u32 v74, -2, v74
 Mvva 88,220,56
  v_min_u32 v75, -2, v75
 Mvva 92,216,44
 TR 216,32,32
 WL 7
 Mvva 92,220,60
  buffer_store_dwordx4 v[72:75], v16, s[8:11], s50 offen offset:1024 sc1
 Mvva 80,224,64
 TR 218,32,544
 WL 6
 Mvva 80,228,80
  global_load_dword a248, v249, s[100:101]
 Mvva 84,224,68
 TR 220,32,9504
 Mvva 84,228,84
 Mvva 88,224,72
 TR 222,32,10016
 Mvva 88,228,88
 Mvva 92,224,76
 TR 224,32,18976
 Mvva 92,228,92
 WL 7
 Mvva 80,208,96
 TR 226,32,19488
 WL 6
 Mvva 80,212,112
 Mvva 84,208,100
 TR 228,32,28448
 Mvva 84,212,116
 Mvva 88,208,104
 TR 230,32,28960
 Mvva 88,212,120
 Mvva 92,208,108
 TR 208,34,64
 Mvva 92,212,124
 WL 7
 Mvva 80,216,128
 TR 210,34,576
 WL 6
 Mvvv 80,220,40
 Mvva 84,216,132
 TR 212,34,9536
 Mvvv 84,220,44
 Mvva 88,216,136
 TR 214,34,10048
 Mvvv 88,220,48
 Mvva 92,216,140
 TR 216,34,19008
 Mvvv 92,220,52
 WL 7
 Mvva 80,224,212
 TR 218,34,19520
 WL 6
 Mvva 80,228,228
 Mvva 84,224,216
 TR 220,34,28480
 Mvva 84,228,232
 Mvva 88,224,220
 TR 222,34,28992
 Mvva 88,228,236
 Mvva 92,224,224
 TR 224,35,64
 Mvva 92,228,240
 WL 7
 WL 5
 Mvva 96,208,0
 TR 226,35,576
  v_cvt_pk_bf16_f32 v80, v80, v81
 Mvva 96,212,16
  v_cvt_pk_bf16_f32 v81, v82, v83
  v_cvt_pk_bf16_f32 v82, v84, v85
 Mvva 100,208,4
 TR 228,35,9536
  v_cvt_pk_bf16_f32 v83, v86, v87
 Mvva 100,212,20
  v_min_u32 v80, -2, v80
  v_min_u32 v81, -2, v81
 Mvva 104,208,8
 TR 230,35,10048
  v_min_u32 v82, -2, v82
 Mvva 104,212,24
  v_min_u32 v83, -2, v83
 WL 4
 Mvva 108,208,12
 TR 208,35,19008
 WL 7
 Mvva 108,212,28
  buffer_store_dwordx4 v[80:83], v16, s[8:11], 0 offen offset:1024 sc1
 Mvva 96,216,32
 TR 210,35,19520
  v_cvt_pk_bf16_f32 v88, v88, v89
 Mvva 96,220,48
  v_cvt_pk_bf16_f32 v89, v90, v91
  v_cvt_pk_bf16_f32 v90, v92, v93
 Mvva 100,216,36
 TR 212,35,28480
  v_cvt_pk_bf16_f32 v91, v94, v95
 Mvva 100,220,52
  v_min_u32 v88, -2, v88
  v_min_u32 v89, -2, v89
 Mvva 104,216,40
 TR 214,35,28992
  v_min_u32 v90, -2, v90
 Mvva 104,220,56
  v_min_u32 v91, -2, v91
 Mvva 108,216,44
 TR 216,32,64
 WL 7
 Mvva 108,220,60
  buffer_store_dwordx4 v[88:91], v16, s[8:11], s50 offen offset:2048 sc1
 Mvva 96,224,64
 TR 218,32,576
 WL 6
 Mvva 96,228,80
 Mvva 100,224,68
 TR 220,32,9536
 Mvva 100,228,84
 Mvva 104,224,72
 TR 222,32,10048
 Mvva 104,228,88
 Mvva 108,224,76
 TR 224,32,19008
 Mvva 108,228,92
 WL 7
 Mvva 96,208,96
 TR 226,32,19520
 WL 6
 Mvva 96,212,112
 Mvva 100,208,100
 TR 228,32,28480
 Mvva 100,212,116
 Mvva 104,208,104
 TR 230,32,28992
 Mvva 104,212,120
 Mvva 108,208,108
 TR 208,34,96
 Mvva 108,212,124
 WL 7
 Mvva 96,216,128
 TR 210,34,608
 WL 6
 Mvvv 96,220,40
 Mvva 100,216,132
 TR 212,34,9568
 Mvvv 100,220,44
 Mvva 104,216,136
 TR 214,34,10080
  v_mov_b32 v246, 2
 Mvvv 104,220,48
 Mvva 108,216,140
 TR 216,34,19040
 Mvvv 108,220,52
 WL 7
 Mvva 96,224,212
 TR 218,34,19552
 WL 6
 Mvva 96,228,228
 Mvva 100,224,216
 TR 220,34,28512
 Mvva 100,228,232
 Mvva 104,224,220
 TR 222,34,29024
 Mvva 104,228,236
 Mvva 108,224,224
 TR 224,35,96
 Mvva 108,228,240
 WL 7
 WL 5
 Mvva 112,208,0
 TR 226,35,608
  v_cvt_pk_bf16_f32 v96, v96, v97
 Mvva 112,212,16
  v_cvt_pk_bf16_f32 v97, v98, v99
  v_cvt_pk_bf16_f32 v98, v100, v101
 Mvva 116,208,4
 TR 228,35,9568
  v_cvt_pk_bf16_f32 v99, v102, v103
 Mvva 116,212,20
  v_min_u32 v96, -2, v96
  v_min_u32 v97, -2, v97
 Mvva 120,208,8
 TR 230,35,10080
  v_min_u32 v98, -2, v98
 Mvva 120,212,24
  v_min_u32 v99, -2, v99
 WL 4
 Mvva 124,208,12
 TR 208,35,19040
 WL 7
 Mvva 124,212,28
  buffer_store_dwordx4 v[96:99], v16, s[8:11], 0 offen offset:2048 sc1
 Mvva 112,216,32
 TR 210,35,19552
  v_cvt_pk_bf16_f32 v104, v104, v105
 Mvva 112,220,48
  v_cvt_pk_bf16_f32 v105, v106, v107
  v_cvt_pk_bf16_f32 v106, v108, v109
 Mvva 116,216,36
 TR 212,35,28512
  v_cvt_pk_bf16_f32 v107, v110, v111
 Mvva 116,220,52
  v_min_u32 v104, -2, v104
  v_min_u32 v105, -2, v105
 Mvva 120,216,40
 TR 214,35,29024
  v_min_u32 v106, -2, v106
 Mvva 120,220,56
  v_min_u32 v107, -2, v107
 Mvva 124,216,44
 TR 216,32,96
 WL 7
 Mvva 124,220,60
  buffer_store_dwordx4 v[104:107], v16, s[8:11], s50 offen offset:3072 sc1
 Mvva 112,224,64
 TR 218,32,608
 WL 6
 Mvva 112,228,80
 Mvva 116,224,68
 TR 220,32,9568
 Mvva 116,228,84
 Mvva 120,224,72
 TR 222,32,10080
 Mvva 120,228,88
 Mvva 124,224,76
 TR 224,32,19040
 Mvva 124,228,92
 WL 7
 Mvva 112,208,96
 TR 226,32,19552
 WL 6
 Mvva 112,212,112
 Mvva 116,208,100
 TR 228,32,28512
 Mvva 116,212,116
 Mvva 120,208,104
 TR 230,32,29024
 Mvva 120,212,120
 Mvva 124,208,108
 TR 208,34,128
 Mvva 124,212,124
 WL 7
 Mvva 112,216,128
 TR 210,34,640
 WL 6
 Mvvv 112,220,40
 Mvva 116,216,132
 TR 212,34,9600
 Mvvv 116,220,44
 Mvva 120,216,136
 TR 214,34,10112
 Mvvv 120,220,48
 Mvva 124,216,140
 TR 216,34,19072
 Mvvv 124,220,52
 WL 7
 Mvva 112,224,212
 TR 218,34,19584
 WL 6
 Mvva 112,228,228
 Mvva 116,224,216
 TR 220,34,28544
 Mvva 116,228,232
 Mvva 120,224,220
 TR 222,34,29056
 Mvva 120,228,236
 Mvva 124,224,224
 TR 224,35,128
 Mvva 124,228,240
 WL 7
 WL 5
 Mvva 128,208,0
 TR 226,35,640
  v_cvt_pk_bf16_f32 v112, v112, v113
 Mvva 128,212,16
  v_cvt_pk_bf16_f32 v113, v114, v115
  v_cvt_pk_bf16_f32 v114, v116, v117
 Mvva 132,208,4
 TR 228,35,9600
  v_cvt_pk_bf16_f32 v115, v118, v119
 Mvva 132,212,20
  v_min_u32 v112, -2, v112
  v_min_u32 v113, -2, v113
 Mvva 136,208,8
 TR 230,35,10112
  v_min_u32 v114, -2, v114
 Mvva 136,212,24
  v_min_u32 v115, -2, v115
 WL 4
 Mvva 140,208,12
 TR 208,35,19072
 WL 7
 Mvva 140,212,28
  buffer_store_dwordx4 v[112:115], v16, s[8:11], 0 offen offset:3072 sc1
 Mvva 128,216,32
 TR 210,35,19584
  v_cvt_pk_bf16_f32 v120, v120, v121
 Mvva 128,220,48
  v_cvt_pk_bf16_f32 v121, v122, v123
  v_cvt_pk_bf16_f32 v122, v124, v125
 Mvva 132,216,36
 TR 212,35,28544
  v_cvt_pk_bf16_f32 v123, v126, v127
 Mvva 132,220,52
  v_min_u32 v120, -2, v120
  v_min_u32 v121, -2, v121
 Mvva 136,216,40
 TR 214,35,29056
  v_min_u32 v122, -2, v122
 Mvva 136,220,56
  v_min_u32 v123, -2, v123
 Mvva 140,216,44
 TR 216,32,128
 WL 7
 Mvva 140,220,60
  buffer_store_dwordx4 v[120:123], v17, s[8:11], s50 offen offset:0 sc1
 Mvva 128,224,64
 TR 218,32,640
 WL 6
 Mvva 128,228,80
 Mvva 132,224,68
 TR 220,32,9600
 Mvva 132,228,84
 Mvva 136,224,72
 TR 222,32,10112
 Mvva 136,228,88
 Mvva 140,224,76
 TR 224,32,19072
 Mvva 140,228,92
 WL 7
 Mvva 128,208,96
 TR 226,32,19584
 WL 6
 Mvva 128,212,112
 Mvva 132,208,100
 TR 228,32,28544
 Mvva 132,212,116
 Mvva 136,208,104
 TR 230,32,29056
 Mvva 136,212,120
 Mvva 140,208,108
 TR 208,34,160
 Mvva 140,212,124
 WL 7
 Mvva 128,216,128
 TR 210,34,672
 WL 6
 Mvvv 128,220,40
 Mvva 132,216,132
 TR 212,34,9632
 Mvvv 132,220,44
 Mvva 136,216,136
 TR 214,34,10144
 Mvvv 136,220,48
 Mvva 140,216,140
 TR 216,34,19104
 Mvvv 140,220,52
 WL 7
 Mvva 128,224,212
 TR 218,34,19616
 WL 6
 Mvva 128,228,228
 Mvva 132,224,216
 TR 220,34,28576
 Mvva 132,228,232
 Mvva 136,224,220
 TR 222,34,29088
 Mvva 136,228,236
 Mvva 140,224,224
 TR 224,35,160
 Mvva 140,228,240
 WL 7
 WL 5
 Mvva 144,208,0
 TR 226,35,672
  v_cvt_pk_bf16_f32 v128, v128, v129
 Mvva 144,212,16
  v_cvt_pk_bf16_f32 v129, v130, v131
  v_cvt_pk_bf16_f32 v130, v132, v133
 Mvva 148,208,4
 TR 228,35,9632
  v_cvt_pk_bf16_f32 v131, v134, v135
 Mvva 148,212,20
  v_min_u32 v128, -2, v128
  v_min_u32 v129, -2, v129
 Mvva 152,208,8
 TR 230,35,10144
  v_min_u32 v130, -2, v130
 Mvva 152,212,24
  v_min_u32 v131, -2, v131
 WL 4
 Mvva 156,208,12
 TR 208,35,19104
 WL 7
 Mvva 156,212,28
  buffer_store_dwordx4 v[128:131], v17, s[8:11], 0 offen offset:0 sc1
 Mvva 144,216,32
 TR 210,35,19616
  v_cvt_pk_bf16_f32 v136, v136, v137
 Mvva 144,220,48
  v_cvt_pk_bf16_f32 v137, v138, v139
  v_cvt_pk_bf16_f32 v138, v140, v141
 Mvva 148,216,36
 TR 212,35,28576
  v_cvt_pk_bf16_f32 v139, v142, v143
 Mvva 148,220,52
  v_min_u32 v136, -2, v136
  v_min_u32 v137, -2, v137
 Mvva 152,216,40
 TR 214,35,29088
  v_min_u32 v138, -2, v138
 Mvva 152,220,56
  v_min_u32 v139, -2, v139
 Mvva 156,216,44
 TR 216,32,160
 WL 7
 Mvva 156,220,60
  buffer_store_dwordx4 v[136:139], v17, s[8:11], s50 offen offset:1024 sc1
 Mvva 144,224,64
 TR 218,32,672
 WL 6
 Mvva 144,228,80
 Mvva 148,224,68
 TR 220,32,9632
 Mvva 148,228,84
 Mvva 152,224,72
 TR 222,32,10144
 Mvva 152,228,88
 Mvva 156,224,76
 TR 224,32,19104
 Mvva 156,228,92
 WL 7
 Mvva 144,208,96
 TR 226,32,19616
 WL 6
 Mvva 144,212,112
 Mvva 148,208,100
 TR 228,32,28576
 Mvva 148,212,116
 Mvva 152,208,104
 TR 230,32,29088
 Mvva 152,212,120
 Mvva 156,208,108
 TR 208,34,192
 Mvva 156,212,124
 WL 7
 Mvva 144,216,128
 TR 210,34,704
 WL 6
 Mvvv 144,220,40
 Mvva 148,216,132
 TR 212,34,9664
 Mvvv 148,220,44
 Mvva 152,216,136
 TR 214,34,10176
 Mvvv 152,220,48
 Mvva 156,216,140
 TR 216,34,19136
 Mvvv 156,220,52
 WL 7
 Mvva 144,224,212
 TR 218,34,19648
 WL 6
 Mvva 144,228,228
 Mvva 148,224,216
 TR 220,34,28608
 Mvva 148,228,232
 Mvva 152,224,220
 TR 222,34,29120
 Mvva 152,228,236
 Mvva 156,224,224
 TR 224,35,192
 Mvva 156,228,240
 WL 7
 WL 5
 Mvva 160,208,0
 TR 226,35,704
  v_cvt_pk_bf16_f32 v144, v144, v145
 Mvva 160,212,16
  v_cvt_pk_bf16_f32 v145, v146, v147
  v_cvt_pk_bf16_f32 v146, v148, v149
 Mvva 164,208,4
 TR 228,35,9664
  v_cvt_pk_bf16_f32 v147, v150, v151
 Mvva 164,212,20
  v_min_u32 v144, -2, v144
  v_min_u32 v145, -2, v145
 Mvva 168,208,8
 TR 230,35,10176
  v_min_u32 v146, -2, v146
 Mvva 168,212,24
  v_min_u32 v147, -2, v147
 WL 4
 Mvva 172,208,12
 TR 208,35,19136
 WL 7
 Mvva 172,212,28
  buffer_store_dwordx4 v[144:147], v17, s[8:11], 0 offen offset:1024 sc1
 Mvva 160,216,32
 TR 210,35,19648
  v_cvt_pk_bf16_f32 v152, v152, v153
 Mvva 160,220,48
  v_cvt_pk_bf16_f32 v153, v154, v155
  v_cvt_pk_bf16_f32 v154, v156, v157
 Mvva 164,216,36
 TR 212,35,28608
  v_cvt_pk_bf16_f32 v155, v158, v159
 Mvva 164,220,52
  s_waitcnt vmcnt(12)
  v_cmp_gt_u32 vcc, 1, v248
  s_nop 4
  s_cbranch_vccnz Lpoll_pz_9
Lback_pz_9:
 Mvva 168,216,40
 TR 214,35,29120
  v_min_u32 v152, -2, v152
 Mvva 168,220,56
 WL 6
  v_min_u32 v153, -2, v153
  v_min_u32 v154, -2, v154
 Mvva 172,216,44
 TR 216,32,192
  v_min_u32 v155, -2, v155
 Mvva 172,220,60
  buffer_store_dwordx4 v[152:155], v17, s[8:11], s50 offen offset:2048 sc1
 Mvva 160,224,64
 TR 218,32,704
  s_add_u32 s46, s55, 0
 WL 6
 Mvva 160,228,80
  buffer_load_dwordx4 v[64:67], v28, s[20:23], s46 offen sc1
 Mvva 164,224,68
 TR 220,32,9664
 Mvva 164,228,84
 Mvva 168,224,72
 TR 222,32,10176
 Mvva 168,228,88
 Mvva 172,224,76
 TR 224,32,19136
 Mvva 172,228,92
 WL 7
 WL 5
 Mvva 160,208,96
 TR 226,32,19648
  s_add_u32 s46, s55, 18432
 Mvva 160,212,112
  buffer_load_dwordx4 v[68:71], v28, s[20:23], s46 offen sc1
 Mvva 164,208,100
 TR 228,32,28608
 Mvva 164,212,116
  v_mov_b32 v128, 0
  v_mov_b32 v129, 0
 Mvva 168,208,104
 TR 230,32,29120
  v_mov_b32 v130, 0
 Mvva 168,212,120
 WL 4
  v_mov_b32 v131, 0
  v_mov_b32 v132, 0
 Mvva 172,208,108
 TR 208,34,224
  v_mov_b32 v133, 0
 Mvva 172,212,124
 WL 7
  v_mov_b32 v134, 0
  v_mov_b32 v135, 0
 Mvva 160,216,128
 TR 210,34,736
  v_mov_b32 v136, 0
 Mvvv 160,220,40
  v_mov_b32 v137, 0
  v_mov_b32 v138, 0
 Mvva 164,216,132
 TR 212,34,9696
  s_add_u32 s46, s55, 36864
 Mvvv 164,220,44
  buffer_load_dwordx4 v[72:75], v28, s[20:23], s46 offen sc1
 Mvva 168,216,136
 TR 214,34,10208
  v_mov_b32 v139, 0
 Mvvv 168,220,48
 WL 4
  v_mov_b32 v140, 0
  v_mov_b32 v141, 0
 Mvva 172,216,140
 TR 216,34,19168
  v_mov_b32 v142, 0
 Mvvv 172,220,52
 WL 7
  v_mov_b32 v143, 0
  v_mov_b32 v144, 0
 Mvva 160,224,212
 TR 218,34,19680
  v_mov_b32 v145, 0
 Mvva 160,228,228
 Mvva 164,224,216
 TR 220,34,28640
 Mvva 164,228,232
 Mvva 168,224,220
 TR 222,34,29152
  s_add_u32 s46, s55, 55296
 Mvva 168,228,236
  buffer_load_dwordx4 v[76:79], v28, s[20:23], s46 offen sc1
 Mvva 172,224,224
 TR 224,35,224
 Mvva 172,228,240
 WL 7
 WL 5
 Mvva 176,208,0
 TR 226,35,736
  v_cvt_pk_bf16_f32 v160, v160, v161
 Mvva 176,212,16
  v_cvt_pk_bf16_f32 v161, v162, v163
  v_cvt_pk_bf16_f32 v162, v164, v165
 Mvva 180,208,4
 TR 228,35,9696
  v_cvt_pk_bf16_f32 v163, v166, v167
 Mvva 180,212,20
  v_min_u32 v160, -2, v160
  v_min_u32 v161, -2, v161
 Mvva 184,208,8
 TR 230,35,10208
  v_min_u32 v162, -2, v162
 Mvva 184,212,24
 WL 4
  v_min_u32 v163, -2, v163
 WL 6
 Mvva 188,208,12
 TR 208,35,19168
  s_add_u32 s46, s55, 73728
 Mvva 188,212,28
  buffer_store_dwordx4 v[160:163], v17, s[8:11], 0 offen offset:2048 sc1
 Mvva 176,216,32
 TR 210,35,19680
  v_cvt_pk_bf16_f32 v168, v168, v169
 Mvva 176,220,48
  buffer_load_dwordx4 v[80:83], v28, s[20:23], s46 offen sc1
 Mvva 180,216,36
 TR 212,35,28640
  v_cvt_pk_bf16_f32 v169, v170, v171
 Mvva 180,220,52
  v_cvt_pk_bf16_f32 v170, v172, v173
  v_cvt_pk_bf16_f32 v171, v174, v175
 Mvva 184,216,40
 TR 214,35,29152
  v_min_u32 v168, -2, v168
 Mvva 184,220,56
 WL 6
  v_min_u32 v169, -2, v169
  v_min_u32 v170, -2, v170
 Mvva 188,216,44
 TR 216,32,224
  v_min_u32 v171, -2, v171
 Mvva 188,220,60
  buffer_store_dwordx4 v[168:171], v17, s[8:11], s50 offen offset:3072 sc1
 Mvva 176,224,64
 TR 218,32,736
  s_add_u32 s46, s55, 92160
 WL 6
 Mvva 176,228,80
  buffer_load_dwordx4 v[84:87], v28, s[20:23], s46 offen sc1
 Mvva 180,224,68
 TR 220,32,9696
 Mvva 180,228,84
 Mvva 184,224,72
 TR 222,32,10208
 Mvva 184,228,88
 Mvva 188,224,76
 TR 224,32,19168
 Mvva 188,228,92
 WL 7
 Mvva 176,208,96
 TR 226,32,19680
 WL 6
 Mvva 176,212,112
 Mvva 180,208,100
 TR 228,32,28640
  s_add_u32 s46, s55, 110592
 Mvva 180,212,116
  buffer_load_dword v248, v247, s[20:23], s54 offen offset:32 sc1
 Mvva 184,208,104
 TR 230,32,29152
 Mvva 184,212,120
  buffer_load_dwordx4 v[88:91], v28, s[20:23], s46 offen sc1
 Mvva 188,208,108
 TR 208,58,0
 Mvva 188,212,124
 WL 7
 Mvva 176,216,128
 TR 210,58,512
 WL 6
 Mvvv 176,220,40
 Mvva 180,216,132
 TR 212,58,9472
 Mvvv 180,220,44
 Mvva 184,216,136
 TR 214,58,9984
  s_add_u32 s46, s55, 129024
 Mvvv 184,220,48
  buffer_load_dwordx4 v[92:95], v28, s[20:23], s46 offen sc1
 Mvva 188,216,140
 TR 216,58,18944
 Mvvv 188,220,52
 WL 7
 Mvva 176,224,212
 TR 218,58,19456
 WL 6
 Mvva 176,228,228
 Mvva 180,224,216
 TR 220,58,28416
 Mvva 180,228,232
 Mvva 184,224,220
 TR 222,58,28928
 Mvva 184,228,236
 Mvva 188,224,224
 TR 224,59,0
 Mvva 188,228,240
 WL 7
 WL 5
 Mvva 192,208,0
 TR 226,59,512
  v_cvt_pk_bf16_f32 v176, v176, v177
 Mvva 192,212,16
  v_cvt_pk_bf16_f32 v177, v178, v179
  v_cvt_pk_bf16_f32 v178, v180, v181
 Mvva 196,208,4
 TR 228,59,9472
  v_cvt_pk_bf16_f32 v179, v182, v183
 Mvva 196,212,20
  v_min_u32 v176, -2, v176
  v_min_u32 v177, -2, v177
 Mvva 200,208,8
 TR 230,59,9984
  v_min_u32 v178, -2, v178
 Mvva 200,212,24
  v_min_u32 v179, -2, v179
 WL 4
 Mvva 204,208,12
 TR 208,59,18944
 WL 7
 Mvva 204,212,28
  buffer_store_dwordx4 v[176:179], v17, s[8:11], 0 offen offset:3072 sc1
 Mvva 192,216,32
 TR 210,59,19456
  v_cvt_pk_bf16_f32 v184, v184, v185
 Mvva 192,220,48
  buffer_store_dword v246, v245, s[20:23], s66 offen sc1
 Mvva 196,216,36
 TR 212,59,28416
  v_cvt_pk_bf16_f32 v185, v186, v187
 Mvva 196,220,52
  v_cvt_pk_bf16_f32 v186, v188, v189
  v_cvt_pk_bf16_f32 v187, v190, v191
 Mvva 200,216,40
 TR 214,59,28928
  v_min_u32 v184, -2, v184
 Mvva 200,220,56
 WL 6
  v_min_u32 v185, -2, v185
  v_min_u32 v186, -2, v186
 Mvva 204,216,44
 TR 216,56,0
  v_min_u32 v187, -2, v187
 Mvva 204,220,60
  buffer_store_dwordx4 v[184:187], v16, s[8:11], s51 offen offset:0 sc1
 Mvva 192,224,64
 TR 218,56,512
 WL 6
 Mvva 192,228,80
 Mvva 196,224,68
 TR 220,56,9472
 Mvva 196,228,84
 Mvva 200,224,72
 TR 222,56,9984
 Mvva 200,228,88
 Mvva 204,224,76
 TR 224,56,18944
 Mvva 204,228,92
 WL 7
 Mvva 192,208,96
 TR 226,56,19456
 WL 6
 Mvva 192,212,112
 Mvva 196,208,100
 TR 228,56,28416
 Mvva 196,212,116
 Mvva 200,208,104
 TR 230,56,28928
 Mvva 200,212,120
 Mvva 204,208,108
 Mvva 204,212,124
 WL 6
 Mvva 192,216,128
 WL 4
 Mvvv 192,220,40
 Mvva 196,216,132
 Mvvv 196,220,44
 Mvva 200,216,136
 Mvvv 200,220,48
 Mvva 204,216,140
 Mvvv 204,220,52
 WL 2
 Mvva 192,224,212
 WL 0
 Mvva 192,228,228
 Mvva 196,224,216
 Mvva 196,228,232
 Mvva 200,224,220
 Mvva 200,228,236
 Mvva 204,224,224
 Mvva 204,228,240
  s_nop 1
  v_cvt_pk_bf16_f32 v192, v192, v193
  v_cvt_pk_bf16_f32 v193, v194, v195
  v_cvt_pk_bf16_f32 v194, v196, v197
  v_cvt_pk_bf16_f32 v195, v198, v199
  v_min_u32 v192, -2, v192
  v_min_u32 v193, -2, v193
  v_min_u32 v194, -2, v194
  v_min_u32 v195, -2, v195
  buffer_store_dwordx4 v[192:195], v16, s[8:11], s50 offen offset:0 sc1
  v_cvt_pk_bf16_f32 v200, v200, v201
  v_cvt_pk_bf16_f32 v201, v202, v203
  v_cvt_pk_bf16_f32 v202, v204, v205
  v_cvt_pk_bf16_f32 v203, v206, v207
  v_min_u32 v200, -2, v200
  v_min_u32 v201, -2, v201
  v_min_u32 v202, -2, v202
  v_min_u32 v203, -2, v203
  buffer_store_dwordx4 v[200:203], v16, s[8:11], s51 offen offset:1024 sc1
  s_waitcnt vmcnt(7)
  v_cmp_gt_u32 vcc, 2, v248
  s_nop 4
  s_cbranch_vccnz Lpoll_red_9
Lback_red_9:
  s_add_u32 s46, s55, 4096
  buffer_load_dwordx4 v[96:99], v28, s[20:23], s46 offen sc1
  buffer_load_dword v232, v29, s[20:23], s46 offen sc1
  s_add_u32 s46, s55, 22528
  buffer_load_dwordx4 v[100:103], v28, s[20:23], s46 offen sc1
  buffer_load_dword v233, v29, s[20:23], s46 offen sc1
  s_add_u32 s46, s55, 40960
  buffer_load_dwordx4 v[104:107], v28, s[20:23], s46 offen sc1
  buffer_load_dword v234, v29, s[20:23], s46 offen sc1
  s_add_u32 s46, s55, 59392
  buffer_load_dwordx4 v[108:111], v28, s[20:23], s46 offen sc1
  buffer_load_dword v235, v29, s[20:23], s46 offen sc1
  s_add_u32 s46, s55, 77824
  buffer_load_dwordx4 v[112:115], v28, s[20:23], s46 offen sc1
  buffer_load_dword v236, v29, s[20:23], s46 offen sc1
  s_add_u32 s46, s55, 96256
  buffer_load_dwordx4 v[116:119], v28, s[20:23], s46 offen sc1
  buffer_load_dword v237, v29, s[20:23], s46 offen sc1
  s_add_u32 s46, s55, 114688
  buffer_load_dwordx4 v[120:123], v28, s[20:23], s46 offen sc1
  buffer_load_dword v238, v29, s[20:23], s46 offen sc1
  s_add_u32 s46, s55, 133120
  buffer_load_dwordx4 v[124:127], v28, s[20:23], s46 offen sc1
  buffer_load_dword v239, v29, s[20:23], s46 offen sc1
  s_load_dwordx2 s[16:17], s[0:1], 80
  s_mov_b32 s18, 0x240000
  s_mov_b32 s19, 0x00020000
Lchk_9:
  s_bitcmp1_b32 s57, 0
  s_cbranch_scc0 Lskip0_9
  v_max3_u32 v36, v64, v65, v66
  v_max3_u32 v36, v36, v67, v67
  v_cmp_eq_u32 vcc, -1, v36
  s_nop 4
  s_cbranch_vccnz Lskip0_9
  v_lshlrev_b32 v36, 16, v64
  v_and_b32 v37, 0xffff0000, v64
  v_pk_add_f32 v[128:129], v[128:129], v[36:37]
  v_lshlrev_b32 v36, 16, v65
  v_and_b32 v37, 0xffff0000, v65
  v_pk_add_f32 v[130:131], v[130:131], v[36:37]
  v_lshlrev_b32 v36, 16, v66
  v_and_b32 v37, 0xffff0000, v66
  v_pk_add_f32 v[132:133], v[132:133], v[36:37]
  v_lshlrev_b32 v36, 16, v67
  v_and_b32 v37, 0xffff0000, v67
  v_pk_add_f32 v[134:135], v[134:135], v[36:37]
  s_bitset0_b32 s57, 0
Lskip0_9:
  s_bitcmp1_b32 s57, 1
  s_cbranch_scc0 Lskip1_9
  v_max3_u32 v36, v68, v69, v70
  v_max3_u32 v36, v36, v71, v71
  v_cmp_eq_u32 vcc, -1, v36
  s_nop 4
  s_cbranch_vccnz Lskip1_9
  v_lshlrev_b32 v36, 16, v68
  v_and_b32 v37, 0xffff0000, v68
  v_pk_add_f32 v[128:129], v[128:129], v[36:37]
  v_lshlrev_b32 v36, 16, v69
  v_and_b32 v37, 0xffff0000, v69
  v_pk_add_f32 v[130:131], v[130:131], v[36:37]
  v_lshlrev_b32 v36, 16, v70
  v_and_b32 v37, 0xffff0000, v70
  v_pk_add_f32 v[132:133], v[132:133], v[36:37]
  v_lshlrev_b32 v36, 16, v71
  v_and_b32 v37, 0xffff0000, v71
  v_pk_add_f32 v[134:135], v[134:135], v[36:37]
  s_bitset0_b32 s57, 1
Lskip1_9:
  s_bitcmp1_b32 s57, 2
  s_cbranch_scc0 Lskip2_9
  v_max3_u32 v36, v72, v73, v74
  v_max3_u32 v36, v36, v75, v75
  v_cmp_eq_u32 vcc, -1, v36
  s_nop 4
  s_cbranch_vccnz Lskip2_9
  v_lshlrev_b32 v36, 16, v72
  v_and_b32 v37, 0xffff0000, v72
  v_pk_add_f32 v[128:129], v[128:129], v[36:37]
  v_lshlrev_b32 v36, 16, v73
  v_and_b32 v37, 0xffff0000, v73
  v_pk_add_f32 v[130:131], v[130:131], v[36:37]
  v_lshlrev_b32 v36, 16, v74
  v_and_b32 v37, 0xffff0000, v74
  v_pk_add_f32 v[132:133], v[132:133], v[36:37]
  v_lshlrev_b32 v36, 16, v75
  v_and_b32 v37, 0xffff0000, v75
  v_pk_add_f32 v[134:135], v[134:135], v[36:37]
  s_bitset0_b32 s57, 2
Lskip2_9:
  s_bitcmp1_b32 s57, 3
  s_cbranch_scc0 Lskip3_9
  v_max3_u32 v36, v76, v77, v78
  v_max3_u32 v36, v36, v79, v79
  v_cmp_eq_u32 vcc, -1, v36
  s_nop 4
  s_cbranch_vccnz Lskip3_9
  v_lshlrev_b32 v36, 16, v76
  v_and_b32 v37, 0xffff0000, v76
  v_pk_add_f32 v[128:129], v[128:129], v[36:37]
  v_lshlrev_b32 v36, 16, v77
  v_and_b32 v37, 0xffff0000, v77
  v_pk_add_f32 v[130:131], v[130:131], v[36:37]
  v_lshlrev_b32 v36, 16, v78
  v_and_b32 v37, 0xffff0000, v78
  v_pk_add_f32 v[132:133], v[132:133], v[36:37]
  v_lshlrev_b32 v36, 16, v79
  v_and_b32 v37, 0xffff0000, v79
  v_pk_add_f32 v[134:135], v[134:135], v[36:37]
  s_bitset0_b32 s57, 3
Lskip3_9:
  s_bitcmp1_b32 s57, 4
  s_cbranch_scc0 Lskip4_9
  v_max3_u32 v36, v80, v81, v82
  v_max3_u32 v36, v36, v83, v83
  v_cmp_eq_u32 vcc, -1, v36
  s_nop 4
  s_cbranch_vccnz Lskip4_9
  v_lshlrev_b32 v36, 16, v80
  v_and_b32 v37, 0xffff0000, v80
  v_pk_add_f32 v[128:129], v[128:129], v[36:37]
  v_lshlrev_b32 v36, 16, v81
  v_and_b32 v37, 0xffff0000, v81
  v_pk_add_f32 v[130:131], v[130:131], v[36:37]
  v_lshlrev_b32 v36, 16, v82
  v_and_b32 v37, 0xffff0000, v82
  v_pk_add_f32 v[132:133], v[132:133], v[36:37]
  v_lshlrev_b32 v36, 16, v83
  v_and_b32 v37, 0xffff0000, v83
  v_pk_add_f32 v[134:135], v[134:135], v[36:37]
  s_bitset0_b32 s57, 4
Lskip4_9:
  s_bitcmp1_b32 s57, 5
  s_cbranch_scc0 Lskip5_9
  v_max3_u32 v36, v84, v85, v86
  v_max3_u32 v36, v36, v87, v87
  v_cmp_eq_u32 vcc, -1, v36
  s_nop 4
  s_cbranch_vccnz Lskip5_9
  v_lshlrev_b32 v36, 16, v84
  v_and_b32 v37, 0xffff0000, v84
  v_pk_add_f32 v[128:129], v[128:129], v[36:37]
  v_lshlrev_b32 v36, 16, v85
  v_and_b32 v37, 0xffff0000, v85
  v_pk_add_f32 v[130:131], v[130:131], v[36:37]
  v_lshlrev_b32 v36, 16, v86
  v_and_b32 v37, 0xffff0000, v86
  v_pk_add_f32 v[132:133], v[132:133], v[36:37]
  v_lshlrev_b32 v36, 16, v87
  v_and_b32 v37, 0xffff0000, v87
  v_pk_add_f32 v[134:135], v[134:135], v[36:37]
  s_bitset0_b32 s57, 5
Lskip5_9:
  s_bitcmp1_b32 s57, 6
  s_cbranch_scc0 Lskip6_9
  s_waitcnt vmcnt(22)
  v_max3_u32 v36, v88, v89, v90
  v_max3_u32 v36, v36, v91, v91
  v_cmp_eq_u32 vcc, -1, v36
  s_nop 4
  s_cbranch_vccnz Lskip6_9
  v_lshlrev_b32 v36, 16, v88
  v_and_b32 v37, 0xffff0000, v88
  v_pk_add_f32 v[128:129], v[128:129], v[36:37]
  v_lshlrev_b32 v36, 16, v89
  v_and_b32 v37, 0xffff0000, v89
  v_pk_add_f32 v[130:131], v[130:131], v[36:37]
  v_lshlrev_b32 v36, 16, v90
  v_and_b32 v37, 0xffff0000, v90
  v_pk_add_f32 v[132:133], v[132:133], v[36:37]
  v_lshlrev_b32 v36, 16, v91
  v_and_b32 v37, 0xffff0000, v91
  v_pk_add_f32 v[134:135], v[134:135], v[36:37]
  s_bitset0_b32 s57, 6
Lskip6_9:
  s_bitcmp1_b32 s57, 7
  s_cbranch_scc0 Lskip7_9
  s_waitcnt vmcnt(21)
  v_max3_u32 v36, v92, v93, v94
  v_max3_u32 v36, v36, v95, v95
  v_cmp_eq_u32 vcc, -1, v36
  s_nop 4
  s_cbranch_vccnz Lskip7_9
  v_lshlrev_b32 v36, 16, v92
  v_and_b32 v37, 0xffff0000, v92
  v_pk_add_f32 v[128:129], v[128:129], v[36:37]
  v_lshlrev_b32 v36, 16, v93
  v_and_b32 v37, 0xffff0000, v93
  v_pk_add_f32 v[130:131], v[130:131], v[36:37]
  v_lshlrev_b32 v36, 16, v94
  v_and_b32 v37, 0xffff0000, v94
  v_pk_add_f32 v[132:133], v[132:133], v[36:37]
  v_lshlrev_b32 v36, 16, v95
  v_and_b32 v37, 0xffff0000, v95
  v_pk_add_f32 v[134:135], v[134:135], v[36:37]
  s_bitset0_b32 s57, 7
Lskip7_9:
  s_bitcmp1_b32 s57, 8
  s_cbranch_scc0 Lskip8_9
  s_waitcnt vmcnt(15)
  v_max3_u32 v36, v96, v97, v98
  s_waitcnt vmcnt(14)
  v_max3_u32 v36, v36, v99, v232
  v_cmp_eq_u32 vcc, -1, v36
  s_nop 4
  s_cbranch_vccnz Lskip8_9
  v_lshlrev_b32 v36, 16, v96
  v_and_b32 v37, 0xffff0000, v96
  v_pk_add_f32 v[136:137], v[136:137], v[36:37]
  v_lshlrev_b32 v36, 16, v97
  v_and_b32 v37, 0xffff0000, v97
  v_pk_add_f32 v[138:139], v[138:139], v[36:37]
  v_lshlrev_b32 v36, 16, v98
  v_and_b32 v37, 0xffff0000, v98
  v_pk_add_f32 v[140:141], v[140:141], v[36:37]
  v_lshlrev_b32 v36, 16, v99
  v_and_b32 v37, 0xffff0000, v99
  v_pk_add_f32 v[142:143], v[142:143], v[36:37]
  v_lshlrev_b32 v36, 16, v232
  v_and_b32 v37, 0xffff0000, v232
  v_pk_add_f32 v[144:145], v[144:145], v[36:37]
  s_bitset0_b32 s57, 8
Lskip8_9:
  s_bitcmp1_b32 s57, 9
  s_cbranch_scc0 Lskip9_9
  s_waitcnt vmcnt(13)
  v_max3_u32 v36, v100, v101, v102
  s_waitcnt vmcnt(12)
  v_max3_u32 v36, v36, v103, v233
  v_cmp_eq_u32 vcc, -1, v36
  s_nop 4
  s_cbranch_vccnz Lskip9_9
  v_lshlrev_b32 v36, 16, v100
  v_and_b32 v37, 0xffff0000, v100
  v_pk_add_f32 v[136:137], v[136:137], v[36:37]
  v_lshlrev_b32 v36, 16, v101
  v_and_b32 v37, 0xffff0000, v101
  v_pk_add_f32 v[138:139], v[138:139], v[36:37]
  v_lshlrev_b32 v36, 16, v102
  v_and_b32 v37, 0xffff0000, v102
  v_pk_add_f32 v[140:141], v[140:141], v[36:37]
  v_lshlrev_b32 v36, 16, v103
  v_and_b32 v37, 0xffff0000, v103
  v_pk_add_f32 v[142:143], v[142:143], v[36:37]
  v_lshlrev_b32 v36, 16, v233
  v_and_b32 v37, 0xffff0000, v233
  v_pk_add_f32 v[144:145], v[144:145], v[36:37]
  s_bitset0_b32 s57, 9
Lskip9_9:
  s_bitcmp1_b32 s57, 10
  s_cbranch_scc0 Lskip10_9
  s_waitcnt vmcnt(11)
  v_max3_u32 v36, v104, v105, v106
  s_waitcnt vmcnt(10)
  v_max3_u32 v36, v36, v107, v234
  v_cmp_eq_u32 vcc, -1, v36
  s_nop 4
  s_cbranch_vccnz Lskip10_9
  v_lshlrev_b32 v36, 16, v104
  v_and_b32 v37, 0xffff0000, v104
  v_pk_add_f32 v[136:137], v[136:137], v[36:37]
  v_lshlrev_b32 v36, 16, v105
  v_and_b32 v37, 0xffff0000, v105
  v_pk_add_f32 v[138:139], v[138:139], v[36:37]
  v_lshlrev_b32 v36, 16, v106
  v_and_b32 v37, 0xffff0000, v106
  v_pk_add_f32 v[140:141], v[140:141], v[36:37]
  v_lshlrev_b32 v36, 16, v107
  v_and_b32 v37, 0xffff0000, v107
  v_pk_add_f32 v[142:143], v[142:143], v[36:37]
  v_lshlrev_b32 v36, 16, v234
  v_and_b32 v37, 0xffff0000, v234
  v_pk_add_f32 v[144:145], v[144:145], v[36:37]
  s_bitset0_b32 s57, 10
Lskip10_9:
  s_bitcmp1_b32 s57, 11
  s_cbranch_scc0 Lskip11_9
  s_waitcnt vmcnt(9)
  v_max3_u32 v36, v108, v109, v110
  s_waitcnt vmcnt(8)
  v_max3_u32 v36, v36, v111, v235
  v_cmp_eq_u32 vcc, -1, v36
  s_nop 4
  s_cbranch_vccnz Lskip11_9
  v_lshlrev_b32 v36, 16, v108
  v_and_b32 v37, 0xffff0000, v108
  v_pk_add_f32 v[136:137], v[136:137], v[36:37]
  v_lshlrev_b32 v36, 16, v109
  v_and_b32 v37, 0xffff0000, v109
  v_pk_add_f32 v[138:139], v[138:139], v[36:37]
  v_lshlrev_b32 v36, 16, v110
  v_and_b32 v37, 0xffff0000, v110
  v_pk_add_f32 v[140:141], v[140:141], v[36:37]
  v_lshlrev_b32 v36, 16, v111
  v_and_b32 v37, 0xffff0000, v111
  v_pk_add_f32 v[142:143], v[142:143], v[36:37]
  v_lshlrev_b32 v36, 16, v235
  v_and_b32 v37, 0xffff0000, v235
  v_pk_add_f32 v[144:145], v[144:145], v[36:37]
  s_bitset0_b32 s57, 11
Lskip11_9:
  s_bitcmp1_b32 s57, 12
  s_cbranch_scc0 Lskip12_9
  s_waitcnt vmcnt(7)
  v_max3_u32 v36, v112, v113, v114
  s_waitcnt vmcnt(6)
  v_max3_u32 v36, v36, v115, v236
  v_cmp_eq_u32 vcc, -1, v36
  s_nop 4
  s_cbranch_vccnz Lskip12_9
  v_lshlrev_b32 v36, 16, v112
  v_and_b32 v37, 0xffff0000, v112
  v_pk_add_f32 v[136:137], v[136:137], v[36:37]
  v_lshlrev_b32 v36, 16, v113
  v_and_b32 v37, 0xffff0000, v113
  v_pk_add_f32 v[138:139], v[138:139], v[36:37]
  v_lshlrev_b32 v36, 16, v114
  v_and_b32 v37, 0xffff0000, v114
  v_pk_add_f32 v[140:141], v[140:141], v[36:37]
  v_lshlrev_b32 v36, 16, v115
  v_and_b32 v37, 0xffff0000, v115
  v_pk_add_f32 v[142:143], v[142:143], v[36:37]
  v_lshlrev_b32 v36, 16, v236
  v_and_b32 v37, 0xffff0000, v236
  v_pk_add_f32 v[144:145], v[144:145], v[36:37]
  s_bitset0_b32 s57, 12
Lskip12_9:
  s_bitcmp1_b32 s57, 13
  s_cbranch_scc0 Lskip13_9
  s_waitcnt vmcnt(5)
  v_max3_u32 v36, v116, v117, v118
  s_waitcnt vmcnt(4)
  v_max3_u32 v36, v36, v119, v237
  v_cmp_eq_u32 vcc, -1, v36
  s_nop 4
  s_cbranch_vccnz Lskip13_9
  v_lshlrev_b32 v36, 16, v116
  v_and_b32 v37, 0xffff0000, v116
  v_pk_add_f32 v[136:137], v[136:137], v[36:37]
  v_lshlrev_b32 v36, 16, v117
  v_and_b32 v37, 0xffff0000, v117
  v_pk_add_f32 v[138:139], v[138:139], v[36:37]
  v_lshlrev_b32 v36, 16, v118
  v_and_b32 v37, 0xffff0000, v118
  v_pk_add_f32 v[140:141], v[140:141], v[36:37]
  v_lshlrev_b32 v36, 16, v119
  v_and_b32 v37, 0xffff0000, v119
  v_pk_add_f32 v[142:143], v[142:143], v[36:37]
  v_lshlrev_b32 v36, 16, v237
  v_and_b32 v37, 0xffff0000, v237
  v_pk_add_f32 v[144:145], v[144:145], v[36:37]
  s_bitset0_b32 s57, 13
Lskip13_9:
  s_bitcmp1_b32 s57, 14
  s_cbranch_scc0 Lskip14_9
  s_waitcnt vmcnt(3)
  v_max3_u32 v36, v120, v121, v122
  s_waitcnt vmcnt(2)
  v_max3_u32 v36, v36, v123, v238
  v_cmp_eq_u32 vcc, -1, v36
  s_nop 4
  s_cbranch_vccnz Lskip14_9
  v_lshlrev_b32 v36, 16, v120
  v_and_b32 v37, 0xffff0000, v120
  v_pk_add_f32 v[136:137], v[136:137], v[36:37]
  v_lshlrev_b32 v36, 16, v121
  v_and_b32 v37, 0xffff0000, v121
  v_pk_add_f32 v[138:139], v[138:139], v[36:37]
  v_lshlrev_b32 v36, 16, v122
  v_and_b32 v37, 0xffff0000, v122
  v_pk_add_f32 v[140:141], v[140:141], v[36:37]
  v_lshlrev_b32 v36, 16, v123
  v_and_b32 v37, 0xffff0000, v123
  v_pk_add_f32 v[142:143], v[142:143], v[36:37]
  v_lshlrev_b32 v36, 16, v238
  v_and_b32 v37, 0xffff0000, v238
  v_pk_add_f32 v[144:145], v[144:145], v[36:37]
  s_bitset0_b32 s57, 14
Lskip14_9:
  s_bitcmp1_b32 s57, 15
  s_cbranch_scc0 Lskip15_9
  s_waitcnt vmcnt(1)
  v_max3_u32 v36, v124, v125, v126
  s_waitcnt vmcnt(0)
  v_max3_u32 v36, v36, v127, v239
  v_cmp_eq_u32 vcc, -1, v36
  s_nop 4
  s_cbranch_vccnz Lskip15_9
  v_lshlrev_b32 v36, 16, v124
  v_and_b32 v37, 0xffff0000, v124
  v_pk_add_f32 v[136:137], v[136:137], v[36:37]
  v_lshlrev_b32 v36, 16, v125
  v_and_b32 v37, 0xffff0000, v125
  v_pk_add_f32 v[138:139], v[138:139], v[36:37]
  v_lshlrev_b32 v36, 16, v126
  v_and_b32 v37, 0xffff0000, v126
  v_pk_add_f32 v[140:141], v[140:141], v[36:37]
  v_lshlrev_b32 v36, 16, v127
  v_and_b32 v37, 0xffff0000, v127
  v_pk_add_f32 v[142:143], v[142:143], v[36:37]
  v_lshlrev_b32 v36, 16, v239
  v_and_b32 v37, 0xffff0000, v239
  v_pk_add_f32 v[144:145], v[144:145], v[36:37]
  s_bitset0_b32 s57, 15
Lskip15_9:
  s_cmp_lg_u32 s57, 0
  s_cbranch_scc1 Lretry_9
  v_cvt_pk_bf16_f32 v64, v128, v129
  v_cvt_pk_bf16_f32 v65, v130, v131
  v_cvt_pk_bf16_f32 v66, v132, v133
  v_cvt_pk_bf16_f32 v67, v134, v135
  v_cvt_pk_bf16_f32 v68, v136, v137
  v_cvt_pk_bf16_f32 v69, v138, v139
  v_cvt_pk_bf16_f32 v70, v140, v141
  v_cvt_pk_bf16_f32 v71, v142, v143
  v_cvt_pk_bf16_f32 v72, v144, v145
 WL 0
  buffer_store_dwordx2 v[64:65], v30, s[16:19], s56 offen offset:0
  buffer_store_dwordx2 v[66:67], v30, s[16:19], s69 offen offset:0
  buffer_store_dwordx2 v[68:69], v30, s[16:19], s56 offen offset:128
  buffer_store_dwordx2 v[70:71], v30, s[16:19], s69 offen offset:128
  buffer_store_dword v72, v31, s[16:19], s56 offen
Lexit_9:
  s_endpgm
Lpoll_ctx_9:
  buffer_load_dword v248, v247, s[20:23], s54 offen offset:16 sc1
  s_waitcnt vmcnt(0)
  v_cmp_gt_u32 vcc, 1, v248
  s_nop 4
  s_cbranch_vccz Lback_ctx_9
  s_branch Lpoll_ctx_9
Lpoll_pz_9:
  buffer_load_dword v248, v247, s[20:23], s54 offen offset:32 sc1
  s_waitcnt vmcnt(0)
  v_cmp_gt_u32 vcc, 1, v248
  s_nop 4
  s_cbranch_vccz Lback_pz_9
  s_branch Lpoll_pz_9
Lpoll_red_9:
  buffer_load_dword v248, v247, s[20:23], s54 offen offset:32 sc1
  s_waitcnt vmcnt(0)
  v_cmp_gt_u32 vcc, 2, v248
  s_nop 4
  s_cbranch_vccz Lback_red_9
  s_branch Lpoll_red_9
Lretry_9:
  s_bitcmp1_b32 s57, 0
  s_cbranch_scc0 Lrskip0_9
  s_add_u32 s46, s55, 0
  buffer_load_dwordx4 v[64:67], v28, s[20:23], s46 offen sc1
Lrskip0_9:
  s_bitcmp1_b32 s57, 1
  s_cbranch_scc0 Lrskip1_9
  s_add_u32 s46, s55, 18432
  buffer_load_dwordx4 v[68:71], v28, s[20:23], s46 offen sc1
Lrskip1_9:
  s_bitcmp1_b32 s57, 2
  s_cbranch_scc0 Lrskip2_9
  s_add_u32 s46, s55, 36864
  buffer_load_dwordx4 v[72:75], v28, s[20:23], s46 offen sc1
Lrskip2_9:
  s_bitcmp1_b32 s57, 3
  s_cbranch_scc0 Lrskip3_9
  s_add_u32 s46, s55, 55296
  buffer_load_dwordx4 v[76:79], v28, s[20:23], s46 offen sc1
Lrskip3_9:
  s_bitcmp1_b32 s57, 4
  s_cbranch_scc0 Lrskip4_9
  s_add_u32 s46, s55, 73728
  buffer_load_dwordx4 v[80:83], v28, s[20:23], s46 offen sc1
Lrskip4_9:
  s_bitcmp1_b32 s57, 5
  s_cbranch_scc0 Lrskip5_9
  s_add_u32 s46, s55, 92160
  buffer_load_dwordx4 v[84:87], v28, s[20:23], s46 offen sc1
Lrskip5_9:
  s_bitcmp1_b32 s57, 6
  s_cbranch_scc0 Lrskip6_9
  s_add_u32 s46, s55, 110592
  buffer_load_dwordx4 v[88:91], v28, s[20:23], s46 offen sc1
Lrskip6_9:
  s_bitcmp1_b32 s57, 7
  s_cbranch_scc0 Lrskip7_9
  s_add_u32 s46, s55, 129024
  buffer_load_dwordx4 v[92:95], v28, s[20:23], s46 offen sc1
Lrskip7_9:
  s_bitcmp1_b32 s57, 8
  s_cbranch_scc0 Lrskip8_9
  s_add_u32 s46, s55, 4096
  buffer_load_dwordx4 v[96:99], v28, s[20:23], s46 offen sc1
  buffer_load_dword v232, v29, s[20:23], s46 offen sc1
Lrskip8_9:
  s_bitcmp1_b32 s57, 9
  s_cbranch_scc0 Lrskip9_9
  s_add_u32 s46, s55, 22528
  buffer_load_dwordx4 v[100:103], v28, s[20:23], s46 offen sc1
  buffer_load_dword v233, v29, s[20:23], s46 offen sc1
Lrskip9_9:
  s_bitcmp1_b32 s57, 10
  s_cbranch_scc0 Lrskip10_9
  s_add_u32 s46, s55, 40960
  buffer_load_dwordx4 v[104:107], v28, s[20:23], s46 offen sc1
  buffer_load_dword v234, v29, s[20:23], s46 offen sc1
Lrskip10_9:
  s_bitcmp1_b32 s57, 11
  s_cbranch_scc0 Lrskip11_9
  s_add_u32 s46, s55, 59392
  buffer_load_dwordx4 v[108:111], v28, s[20:23], s46 offen sc1
  buffer_load_dword v235, v29, s[20:23], s46 offen sc1
Lrskip11_9:
  s_bitcmp1_b32 s57, 12
  s_cbranch_scc0 Lrskip12_9
  s_add_u32 s46, s55, 77824
  buffer_load_dwordx4 v[112:115], v28, s[20:23], s46 offen sc1
  buffer_load_dword v236, v29, s[20:23], s46 offen sc1
Lrskip12_9:
  s_bitcmp1_b32 s57, 13
  s_cbranch_scc0 Lrskip13_9
  s_add_u32 s46, s55, 96256
  buffer_load_dwordx4 v[116:119], v28, s[20:23], s46 offen sc1
  buffer_load_dword v237, v29, s[20:23], s46 offen sc1
Lrskip13_9:
  s_bitcmp1_b32 s57, 14
  s_cbranch_scc0 Lrskip14_9
  s_add_u32 s46, s55, 114688
  buffer_load_dwordx4 v[120:123], v28, s[20:23], s46 offen sc1
  buffer_load_dword v238, v29, s[20:23], s46 offen sc1
Lrskip14_9:
  s_bitcmp1_b32 s57, 15
  s_cbranch_scc0 Lrskip15_9
  s_add_u32 s46, s55, 133120
  buffer_load_dwordx4 v[124:127], v28, s[20:23], s46 offen sc1
  buffer_load_dword v239, v29, s[20:23], s46 offen sc1
Lrskip15_9:
  s_waitcnt vmcnt(0)
  s_branch Lchk_9
Lp4e_9:
Lp4_8:
  v_cmp_lt_u32 vcc, 0x40000000, v43
  s_lshr_b32 s65, s6, 8
  s_lshl_b32 s66, s3, 2
  v_mov_b32 v246, s66
  s_cmp_lg_u64 vcc, 0
  s_cselect_b32 s66, 1, 0
  s_andn2_b32 s66, s66, s65
  v_mov_b32 v245, s66
  ds_write_b32 v246, v245
  v_and_b32 v246, 3, v0
  v_lshlrev_b32 v246, 2, v246
  v_lshlrev_b32 v59, 3, v0
  v_add_u32 v56, 20736, v59
  v_add_u32 v57, 134400, v59
  v_add_u32 v58, 58624, v59
  v_add_u32 v59, 96512, v59
 WL 0
  s_waitcnt vmcnt(33)
  s_barrier
 TR 208,32,0
 TR 210,32,512
 TR 212,32,9472
 TR 214,32,9984
 TR 216,32,32
 TR 218,32,544
 TR 220,32,9504
 TR 222,32,10016
 TR 224,32,64
 TR 226,32,576
 TR 228,32,9536
 TR 230,32,10048
  ds_read_b32 v245, v246
 WL 11
  v_mfma_f32_16x16x32_bf16 v[64:67], v[208:211], a[212:215], 0
  s_add_u32 s46, s45, 49152
  v_lshlrev_b32 v249, 14, v0
  v_add_u32 v249, Lp4_8-Lpc0, v249
 WL 9
 Mvva 64,212,228
  buffer_load_dwordx4 a[0:3], v16, s[20:23], s46 offen offset:0 sc1
  v_mfma_f32_16x16x32_bf16 v[68:71], v[208:211], a[216:219], 0
  v_min_u32 v249, Lp4e_8-Lpc0-16388, v249
 Mvva 68,212,232
  v_mfma_f32_16x16x32_bf16 v[72:75], v[208:211], a[220:223], 0
  buffer_load_dwordx4 a[4:7], v16, s[20:23], s46 offen offset:2048 sc1
 Mvva 72,212,236
  v_mfma_f32_16x16x32_bf16 v[76:79], v[208:211], a[224:227], 0
 TR 208,32,96
 Mvva 76,212,240
 WL 8
  v_mfma_f32_16x16x32_bf16 v[80:83], v[216:219], a[212:215], 0
 TR 210,32,608
 WL 7
 Mvva 80,220,228
  buffer_load_dwordx4 a[8:11], v17, s[20:23], s46 offen offset:0 sc1
  v_mfma_f32_16x16x32_bf16 v[84:87], v[216:219], a[216:219], 0
 TR 212,32,9568
 Mvva 84,220,232
 WL 3
  v_cmp_ne_u32 vcc, 0, v245
  s_nop 4
  s_cbranch_vccnz Lrestart
  v_mfma_f32_16x16x32_bf16 v[88:91], v[216:219], a[220:223], 0
 TR 214,32,10080
 Mvva 88,220,236
  s_cmp_lg_u32 s3, 0
  s_cselect_b32 s64, 256, 0
  s_and_b32 s66, s2, 0xe7
  v_mfma_f32_16x16x32_bf16 v[92:95], v[216:219], a[224:227], 0
 TR 216,32,128
  s_lshl_b32 s66, s66, 6
 Mvva 92,220,240
  buffer_load_dwordx4 a[12:15], v17, s[20:23], s46 offen offset:2048 sc1
  v_mfma_f32_16x16x32_bf16 v[96:99], v[224:227], a[212:215], 0
 TR 218,32,640
  s_lshr_b32 s65, s4, 3
 Mvva 96,228,228
  s_add_u32 s46, s45, 57344
  s_add_u32 s66, s66, s65
  s_lshl_b32 s66, s66, 2
  v_mfma_f32_16x16x32_bf16 v[100:103], v[224:227], a[216:219], 0
 TR 220,32,9600
  s_add_u32 s66, s66, 0x4480010
 Mvva 100,228,232
  buffer_load_dwordx4 a[16:19], v16, s[20:23], s46 offen offset:0 sc1
  v_mfma_f32_16x16x32_bf16 v[104:107], v[224:227], a[220:223], 0
 TR 222,32,10112
  s_lshl_b32 s65, s64, 20
 Mvva 104,228,236
  global_load_dword a248, v249, s[100:101]
  v_mfma_f32_16x16x32_bf16 v[108:111], v[224:227], a[224:227], 0
 TR 224,32,160
  s_add_u32 s66, s66, s65
 Mvva 108,228,240
 WL 7
  v_cmp_gt_u32 vcc, 4, v0
  v_lshlrev_b32 v245, 11, v0
  v_mov_b32 v246, 1
  v_cndmask_b32 v245, -1, v245, vcc
  v_mfma_f32_16x16x32_bf16 v[112:115], v[208:211], a[212:215], 0
 TR 226,32,672
 WL 6
 Mvva 112,212,228
  buffer_load_dwordx4 a[20:23], v16, s[20:23], s46 offen offset:2048 sc1
  v_mfma_f32_16x16x32_bf16 v[116:119], v[208:211], a[216:219], 0
 TR 228,32,9632
 Mvva 116,212,232
  v_mfma_f32_16x16x32_bf16 v[120:123], v[208:211], a[220:223], 0
 TR 230,32,10144
 Mvva 120,212,236
  buffer_load_dwordx4 a[24:27], v17, s[20:23], s46 offen offset:0 sc1
  v_mfma_f32_16x16x32_bf16 v[124:127], v[208:211], a[224:227], 0
 TR 208,32,192
 Mvva 124,212,240
 WL 7
  v_mfma_f32_16x16x32_bf16 v[128:131], v[216:219], a[212:215], 0
 TR 210,32,704
 WL 6
 Mvva 128,220,228
  buffer_load_dwordx4 a[28:31], v17, s[20:23], s46 offen offset:2048 sc1
  v_mfma_f32_16x16x32_bf16 v[132:135], v[216:219], a[216:219], 0
 TR 212,32,9664
  s_add_u32 s44, s44, 147456
 Mvva 132,220,232
  v_mfma_f32_16x16x32_bf16 v[136:139], v[216:219], a[220:223], 0
 TR 214,32,10176
  s_add_u32 m0, s47, 50176
 Mvva 136,220,236
  v_mfma_f32_16x16x32_bf16 v[140:143], v[216:219], a[224:227], 0
 TR 216,32,224
 WL 7
 Mvva 140,220,240
  buffer_load_dwordx4 v1, s[12:15], s44 offen lds
  v_mfma_f32_16x16x32_bf16 v[144:147], v[224:227], a[212:215], 0
 TR 218,32,736
 WL 6
 Mvva 144,228,228
  v_mfma_f32_16x16x32_bf16 v[148:151], v[224:227], a[216:219], 0
 TR 220,32,9696
 Mvva 148,228,232
  buffer_load_dwordx4 v2, s[12:15], s44 offen offset:1056 lds
  v_mfma_f32_16x16x32_bf16 v[152:155], v[224:227], a[220:223], 0
 TR 222,32,10208
 Mvva 152,228,236
  v_mfma_f32_16x16x32_bf16 v[156:159], v[224:227], a[224:227], 0
 TR 224,56,0
 Mvva 156,228,240
 WL 7
  v_mfma_f32_16x16x32_bf16 v[160:163], v[208:211], a[212:215], 0
 TR 226,56,512
 WL 6
 Mvva 160,212,228
  buffer_load_dwordx4 v3, s[12:15], s44 offen offset:2112 lds
  v_mfma_f32_16x16x32_bf16 v[164:167], v[208:211], a[216:219], 0
 TR 228,56,9472
 Mvva 164,212,232
  v_mfma_f32_16x16x32_bf16 v[168:171], v[208:211], a[220:223], 0
 TR 230,56,9984
 Mvva 168,212,236
  buffer_load_dwordx4 v4, s[12:15], s44 offen offset:3168 lds
  v_mfma_f32_16x16x32_bf16 v[172:175], v[208:211], a[224:227], 0
 TR 208,32,18944
 Mvva 172,212,240
 WL 7
 WL 5
  v_mfma_f32_16x16x32_bf16 v[176:179], v[216:219], a[212:215], 0
 TR 210,32,19456
  s_add_u32 m0, s47, 54400
 Mvva 176,220,228
  v_mfma_f32_16x16x32_bf16 v[180:183], v[216:219], a[216:219], 0
 TR 212,32,28416
 Mvva 180,220,232
  buffer_load_dwordx4 v5, s[12:15], s44 offen lds
  v_mfma_f32_16x16x32_bf16 v[184:187], v[216:219], a[220:223], 0
 TR 214,32,28928
 Mvva 184,220,236
  v_mfma_f32_16x16x32_bf16 v[188:191], v[216:219], a[224:227], 0
 TR 216,32,18976
 WL 7
 Mvva 188,220,240
  buffer_load_dwordx4 v6, s[12:15], s44 offen offset:1056 lds
  v_mfma_f32_16x16x32_bf16 v[192:195], v[224:227], a[212:215], 0
 TR 218,32,19488
 WL 6
 Mvva 192,228,228
  v_mfma_f32_16x16x32_bf16 v[196:199], v[224:227], a[216:219], 0
 TR 220,32,28448
 Mvva 196,228,232
  buffer_load_dwordx4 v7, s[12:15], s44 offen offset:2112 lds
  v_mfma_f32_16x16x32_bf16 v[200:203], v[224:227], a[220:223], 0
 TR 222,32,28960
  s_waitcnt vmcnt(41)
 Mvva 200,228,236
  v_mfma_f32_16x16x32_bf16 v[204:207], v[224:227], a[224:227], 0
 TR 224,32,19008
 Mvva 204,228,240
 WL 7
 Mvva 64,208,176
 TR 226,32,19520
 WL 6
 Mvva 64,212,192
  buffer_load_dwordx4 v8, s[12:15], s44 offen offset:3168 lds
 Mvva 68,208,180
 TR 228,32,28480
 Mvva 68,212,196
  s_add_u32 m0, s47, 58624
 Mvva 72,208,184
 TR 230,32,28992
 Mvva 72,212,200
  buffer_load_dwordx4 v9, s[20:23], s44 offen sc1 lds
 Mvva 76,208,188
 TR 208,32,19040
 Mvva 76,212,204
 WL 7
 WL 5
 Mvva 80,216,176
 TR 210,32,19552
  s_add_u32 s46, s45, 65536
 Mvva 80,220,192
 Mvva 84,216,180
 TR 212,32,28512
 Mvva 84,220,196
  buffer_load_dwordx4 a[32:35], v16, s[20:23], s46 offen offset:0 sc1
 Mvva 88,216,184
 TR 214,32,29024
 Mvva 88,220,200
 Mvva 92,216,188
 TR 216,32,19072
 WL 7
 Mvva 92,220,204
  buffer_load_dwordx4 a[36:39], v16, s[20:23], s46 offen offset:2048 sc1
 Mvva 96,224,176
 TR 218,32,19584
 WL 6
 Mvva 96,228,192
 Mvva 100,224,180
 TR 220,32,28544
 Mvva 100,228,196
 Mvva 104,224,184
 TR 222,32,29056
 Mvva 104,228,200
  buffer_load_dwordx4 a[40:43], v17, s[20:23], s46 offen offset:0 sc1
 Mvva 108,224,188
 TR 224,32,19104
 Mvva 108,228,204
 WL 7
 Mvva 112,208,176
 TR 226,32,19616
 WL 6
 Mvva 112,212,192
  buffer_load_dwordx4 a[44:47], v17, s[20:23], s46 offen offset:2048 sc1
 Mvva 116,208,180
 TR 228,32,28576
 Mvva 116,212,196
  s_add_u32 s46, s45, 73728
 Mvva 120,208,184
 TR 230,32,29088
 Mvva 120,212,200
  buffer_load_dwordx4 a[48:51], v16, s[20:23], s46 offen offset:0 sc1
 Mvva 124,208,188
 TR 208,32,19136
 Mvva 124,212,204
 WL 7
 Mvva 128,216,176
 TR 210,32,19648
 WL 6
 Mvva 128,220,192
 Mvva 132,216,180
 TR 212,32,28608
 Mvva 132,220,196
  buffer_load_dwordx4 a[52:55], v16, s[20:23], s46 offen offset:2048 sc1
 Mvva 136,216,184
 TR 214,32,29120
 Mvva 136,220,200
 Mvva 140,216,188
 TR 216,32,19168
 WL 7
 Mvva 140,220,204
  buffer_load_dwordx4 a[56:59], v17, s[20:23], s46 offen offset:0 sc1
 Mvva 144,224,176
 TR 218,32,19680
 WL 6
 Mvva 144,228,192
 Mvva 148,224,180
 TR 220,32,28640
 Mvva 148,228,196
 Mvva 152,224,184
 TR 222,32,29152
 Mvva 152,228,200
  buffer_load_dwordx4 a[60:63], v17, s[20:23], s46 offen offset:2048 sc1
 Mvva 156,224,188
 TR 224,56,18944
 Mvva 156,228,204
  s_add_u32 s46, s45, 81920
 WL 7
 Mvva 160,208,176
 TR 226,56,19456
 WL 6
 Mvva 160,212,192
  buffer_load_dwordx4 a[64:67], v16, s[20:23], s46 offen offset:0 sc1
 Mvva 164,208,180
 TR 228,56,28416
 Mvva 164,212,196
 Mvva 168,208,184
 TR 230,56,28928
 Mvva 168,212,200
 Mvva 172,208,188
  buffer_load_dwordx4 a[68:71], v16, s[20:23], s46 offen offset:2048 sc1
 Mvva 172,212,204
 WL 6
 Mvva 176,216,176
 WL 4
 Mvva 176,220,192
  s_waitcnt vmcnt(28) lgkmcnt(0)
  s_barrier
 Mvva 180,216,180
 TR 208,33,0
 Mvva 180,220,196
 TR 210,33,512
 Mvva 184,216,184
 TR 212,33,9472
 Mvva 184,220,200
 TR 214,33,9984
 Mvva 188,216,188
 TR 216,33,32
 Mvva 188,220,204
  buffer_load_dwordx4 a[72:75], v17, s[20:23], s46 offen offset:0 sc1
 Mvva 192,224,176
 TR 218,33,544
 Mvva 192,228,192
  buffer_load_dwordx4 a[76:79], v17, s[20:23], s46 offen offset:2048 sc1
 Mvva 196,224,180
 TR 220,33,9504
  s_add_u32 s46, s45, 90112
 Mvva 196,228,196
  buffer_store_dword v246, v245, s[20:23], s66 offen sc1
 Mvva 200,224,184
 TR 222,33,10016
 WL 6
 Mvva 200,228,200
  buffer_load_dwordx4 a[80:83], v16, s[20:23], s46 offen offset:0 sc1
 Mvva 204,224,188
 TR 224,33,64
  s_lshr_b32 s55, s2, 3
 Mvva 204,228,204
  s_lshl_b32 s55, s55, 2
  s_bfe_u32 s65, s4, 0x20001
  s_add_u32 s55, s55, s65
 Mvva 64,208,144
 TR 226,33,576
  s_lshl_b32 s55, s55, 4
 WL 6
 Mvva 64,212,160
  buffer_load_dwordx4 a[84:87], v16, s[20:23], s46 offen offset:2048 sc1
 Mvva 68,208,148
 TR 228,33,9536
  s_and_b32 s65, s4, 1
 Mvva 68,212,164
  s_add_u32 s55, s55, s65
  s_mul_i32 s55, s55, 9216
  s_add_u32 s55, s55, 0x4500000
 Mvva 72,208,152
 TR 230,33,10048
  s_and_b32 s65, s4, 7
 Mvva 72,212,168
  s_movk_i32 s50, 8192
  s_movk_i32 s51, 16384
  s_and_b32 s66, s2, 0xf8
 Mvva 76,208,156
 TR 208,33,96
  s_lshl_b32 s56, s3, 1
 Mvva 76,212,172
  buffer_load_dwordx4 a[88:91], v17, s[20:23], s46 offen offset:0 sc1
 WL 7
 Mvva 80,216,144
 TR 210,33,608
  s_add_u32 s66, s66, s56
 WL 6
 Mvva 80,220,160
  s_lshl_b32 s66, s66, 6
  s_add_u32 s66, s66, s65
  s_lshl_b32 s66, s66, 2
 Mvva 84,216,148
 TR 212,33,9568
  s_add_u32 s66, s66, 0x4480020
 Mvva 84,220,164
  buffer_load_dwordx4 a[92:95], v17, s[20:23], s46 offen offset:2048 sc1
 Mvva 88,216,152
 TR 214,33,10080
  s_add_u32 s44, s44, 147456
 Mvva 88,220,168
 WL 6
  v_cmp_gt_u32 vcc, 2, v0
  v_lshlrev_b32 v245, 8, v0
  v_mov_b32 v246, 1
  v_cndmask_b32 v245, -1, v245, vcc
 Mvva 92,216,156
 TR 216,33,128
  s_add_u32 m0, s47, 88064
 Mvva 92,220,172
  s_sub_u32 s56, 15, s5
  s_cmp_lt_u32 s65, 4
  s_cselect_b32 s56, s56, s5
 Mvva 96,224,144
 TR 218,33,640
  s_lshl_b32 s56, s56, 3
 WL 6
 Mvva 96,228,160
  buffer_load_dwordx4 v1, s[12:15], s44 offen lds
 Mvva 100,224,148
 TR 220,33,9600
  s_bfe_u32 s69, s65, 0x10001
 Mvva 100,228,164
  s_add_u32 s56, s56, s69
  s_and_b32 s69, s65, 1
  s_lshl_b32 s69, s69, 2
 Mvva 104,224,152
 TR 222,33,10112
  s_add_u32 s56, s56, s69
 Mvva 104,228,168
  buffer_load_dwordx4 v2, s[12:15], s44 offen offset:1056 lds
 Mvva 108,224,156
 TR 224,33,160
  s_mul_i32 s56, s56, 18432
 Mvva 108,228,172
  s_lshr_b32 s69, s4, 3
  s_mul_i32 s31, s69, 224
  s_lshl_b32 s69, s69, 8
 WL 7
 Mvva 112,208,144
 TR 226,33,672
  s_add_u32 s56, s56, s69
 WL 6
 Mvva 112,212,160
  buffer_load_dwordx4 v3, s[12:15], s44 offen offset:2112 lds
 Mvva 116,208,148
 TR 228,33,9632
  s_lshl_b32 s69, s3, 10
 Mvva 116,212,164
  v_add_u32 v28, s69, v16
  s_lshl_b32 s69, s3, 8
 Mvva 120,208,152
 TR 230,33,10144
  s_add_u32 s69, s69, 4096
 Mvva 120,212,168
 WL 6
  v_lshl_add_u32 v29, v0, 2, s69
  v_and_b32 v36, 15, v0
 Mvva 124,208,156
 TR 208,33,192
  v_mul_u32_u24 v36, 1152, v36
 Mvva 124,212,172
  buffer_load_dwordx4 v4, s[12:15], s44 offen offset:3168 lds
 Mvva 128,216,144
 TR 210,33,704
  v_lshrrev_b32 v37, 4, v0
 WL 6
 Mvva 128,220,160
  s_add_u32 m0, s47, 92288
  s_lshl_b32 s69, s3, 5
  v_lshl_add_u32 v36, v37, 3, v36
 Mvva 132,216,148
 TR 212,33,9664
  v_add_u32 v30, s69, v36
 Mvva 132,220,164
  buffer_load_dwordx4 v5, s[12:15], s44 offen lds
 Mvva 136,216,152
 TR 214,33,10176
  v_lshrrev_b32 v36, 2, v0
 Mvva 136,220,168
 WL 6
  v_bfe_u32 v37, v0, 1, 1
  v_lshl_add_u32 v36, v37, 5, v36
 Mvva 140,216,156
 TR 216,33,224
  v_mul_u32_u24 v36, 1152, v36
 Mvva 140,220,172
  s_lshl_b32 s69, s3, 3
  v_and_b32 v37, 1, v0
  v_lshl_add_u32 v36, v37, 2, v36
 Mvva 144,224,144
 TR 218,33,736
  s_add_u32 s69, s69, 1024
 WL 6
 Mvva 144,228,160
  buffer_load_dwordx4 v6, s[12:15], s44 offen offset:1056 lds
 Mvva 148,224,148
 TR 220,33,9696
  s_sub_u32 s69, s69, s31
 Mvva 148,228,164
  s_mov_b32 s57, 0xffff
  v_add_u32 v31, s69, v36
  s_add_u32 s69, s56, 36864
 Mvva 152,224,152
 TR 222,33,10208
 Mvva 152,228,168
  buffer_load_dwordx4 v7, s[12:15], s44 offen offset:2112 lds
 Mvva 156,224,156
 TR 224,57,0
 WL 7
 Mvva 156,228,172
  buffer_store_dword v246, v245, s[20:23], s66 offen sc1
 Mvva 160,208,144
 TR 226,57,512
 WL 6
 Mvva 160,212,160
 Mvva 164,208,148
 TR 228,57,9472
 Mvva 164,212,164
  buffer_load_dwordx4 v8, s[12:15], s44 offen offset:3168 lds
 Mvva 168,208,152
 TR 230,57,9984
  s_add_u32 m0, s47, 96512
 Mvva 168,212,168
 Mvva 172,208,156
 TR 208,33,18944
 WL 7
 Mvva 172,212,172
  buffer_load_dwordx4 v9, s[20:23], s44 offen sc1 lds
 Mvva 176,216,144
 TR 210,33,19456
 WL 6
 Mvva 176,220,160
  s_add_u32 s46, s45, 98304
 Mvva 180,216,148
 TR 212,33,28416
 Mvva 180,220,164
  buffer_load_dwordx4 a[96:99], v16, s[20:23], s46 offen offset:0 sc1
 Mvva 184,216,152
 TR 214,33,28928
 Mvva 184,220,168
 Mvva 188,216,156
 TR 216,33,18976
 Mvva 188,220,172
 WL 7
 Mvva 192,224,144
 TR 218,33,19488
 WL 6
 Mvva 192,228,160
  buffer_load_dwordx4 a[100:103], v16, s[20:23], s46 offen offset:2048 sc1
 Mvva 196,224,148
 TR 220,33,28448
 Mvva 196,228,164
 Mvva 200,224,152
 TR 222,33,28960
  s_waitcnt vmcnt(38)
 Mvva 200,228,168
  buffer_load_dwordx4 a[104:107], v17, s[20:23], s46 offen offset:0 sc1
 Mvva 204,224,156
 TR 224,33,19008
 Mvva 204,228,172
 WL 7
 Mvva 64,208,0
 TR 226,33,19520
 WL 6
 Mvva 64,212,16
 Mvva 68,208,4
 TR 228,33,28480
 Mvva 68,212,20
  buffer_load_dwordx4 a[108:111], v17, s[20:23], s46 offen offset:2048 sc1
 Mvva 72,208,8
 TR 230,33,28992
 Mvva 72,212,24
  s_add_u32 s46, s45, 106496
 Mvva 76,208,12
 TR 208,33,19040
 WL 7
 Mvva 76,212,28
  buffer_load_dwordx4 a[112:115], v16, s[20:23], s46 offen offset:0 sc1
 Mvva 80,216,0
 TR 210,33,19552
 WL 6
 Mvva 80,220,16
 Mvva 84,216,4
 TR 212,33,28512
 Mvva 84,220,20
  buffer_load_dwordx4 a[116:119], v16, s[20:23], s46 offen offset:2048 sc1
 Mvva 88,216,8
 TR 214,33,29024
 Mvva 88,220,24
 Mvva 92,216,12
 TR 216,33,19072
 Mvva 92,220,28
 WL 7
 Mvva 96,224,0
 TR 218,33,19584
 WL 6
 Mvva 96,228,16
  buffer_load_dwordx4 a[120:123], v17, s[20:23], s46 offen offset:0 sc1
 Mvva 100,224,4
 TR 220,33,28544
  v_and_b32 v247, 3, v0
 Mvva 100,228,20
  v_lshlrev_b32 v247, 2, v247
 Mvva 104,224,8
 TR 222,33,29056
 Mvva 104,228,24
  buffer_load_dwordx4 a[124:127], v17, s[20:23], s46 offen offset:2048 sc1
 Mvva 108,224,12
 TR 224,33,19104
 WL 7
 Mvva 108,228,28
  buffer_load_dword v248, v247, s[20:23], s54 offen offset:16 sc1
 Mvva 112,208,0
 TR 226,33,19616
  s_add_u32 s46, s45, 114688
 WL 6
 Mvva 112,212,16
 Mvva 116,208,4
 TR 228,33,28576
 Mvva 116,212,20
  buffer_load_dwordx4 a[128:131], v16, s[20:23], s46 offen offset:0 sc1
 Mvva 120,208,8
 TR 230,33,29088
 Mvva 120,212,24
 Mvva 124,208,12
 TR 208,33,19136
 WL 7
 Mvva 124,212,28
  buffer_load_dwordx4 a[132:135], v16, s[20:23], s46 offen offset:2048 sc1
 Mvva 128,216,0
 TR 210,33,19648
 WL 6
 Mvva 128,220,16
 Mvva 132,216,4
 TR 212,33,28608
 Mvva 132,220,20
 Mvva 136,216,8
 TR 214,33,29120
 Mvva 136,220,24
  buffer_load_dwordx4 a[136:139], v17, s[20:23], s46 offen offset:0 sc1
 Mvva 140,216,12
 TR 216,33,19168
 Mvva 140,220,28
 WL 7
 Mvva 144,224,0
 TR 218,33,19680
 WL 6
 Mvva 144,228,16
  buffer_load_dwordx4 a[140:143], v17, s[20:23], s46 offen offset:2048 sc1
 Mvva 148,224,4
 TR 220,33,28640
 Mvva 148,228,20
  s_add_u32 s46, s45, 122880
 Mvva 152,224,8
 TR 222,33,29152
 Mvva 152,228,24
  buffer_load_dwordx4 v[40:43], v16, s[20:23], s46 offen offset:0 sc1
 Mvva 156,224,12
 TR 224,57,18944
 Mvva 156,228,28
 WL 7
 Mvva 160,208,0
 TR 226,57,19456
 WL 6
 Mvva 160,212,16
 Mvva 164,208,4
 TR 228,57,28416
 Mvva 164,212,20
  buffer_load_dwordx4 v[44:47], v16, s[20:23], s46 offen offset:2048 sc1
 Mvva 168,208,8
 TR 230,57,28928
 Mvva 168,212,24
 Mvva 172,208,12
 WL 6
 Mvva 172,212,28
  buffer_load_dwordx4 v[48:51], v17, s[20:23], s46 offen offset:0 sc1
 Mvva 176,216,0
 WL 4
 Mvva 176,220,16
 WL 0
  s_waitcnt vmcnt(43)
  s_barrier
 Mvva 180,216,4
 TR 208,34,0
 Mvva 180,220,20
 TR 210,34,512
  s_mov_b32 s44, s25
 Mvva 184,216,8
 TR 212,34,9472
 Mvva 184,220,24
 TR 214,34,9984
  v_add_u32 v9, 4096, v9
 Mvva 188,216,12
 TR 216,34,32
 Mvva 188,220,28
  buffer_load_dwordx4 v[52:55], v17, s[20:23], s46 offen offset:2048 sc1
 Mvva 192,224,0
 TR 218,34,544
  s_add_u32 m0, s47, 12288
 Mvva 192,228,16
  buffer_load_dwordx4 v1, s[40:43], s44 offen lds
 Mvva 196,224,4
 TR 220,34,9504
 Mvva 196,228,20
 Mvva 200,224,8
 TR 222,34,10016
  s_waitcnt vmcnt(37)
 Mvva 200,228,24
 Mvva 204,224,12
 TR 224,34,64
 WL 7
 Mvva 204,228,28
  buffer_load_dwordx4 v2, s[40:43], s44 offen offset:1056 lds
 Mvva 64,208,32
 TR 226,34,576
 WL 6
 Mvva 64,212,48
  global_load_dword a248, v249, s[100:101]
 Mvva 68,208,36
 TR 228,34,9536
 Mvva 68,212,52
  buffer_load_dwordx4 v3, s[40:43], s44 offen offset:2112 lds
 Mvva 72,208,40
 TR 230,34,10048
 Mvva 72,212,56
 Mvva 76,208,44
 TR 208,34,96
 WL 7
 Mvva 76,212,60
  buffer_load_dwordx4 v4, s[40:43], s44 offen offset:3168 lds
 Mvva 80,216,32
 TR 210,34,608
 WL 6
 Mvva 80,220,48
 Mvva 84,216,36
 TR 212,34,9568
  s_add_u32 m0, s47, 16512
 Mvva 84,220,52
 Mvva 88,216,40
 TR 214,34,10080
 Mvva 88,220,56
  buffer_load_dwordx4 v5, s[40:43], s44 offen lds
 Mvva 92,216,44
 TR 216,34,128
 Mvva 92,220,60
 WL 7
 Mvva 96,224,32
 TR 218,34,640
 WL 6
 Mvva 96,228,48
  buffer_load_dwordx4 v6, s[40:43], s44 offen offset:1056 lds
 Mvva 100,224,36
 TR 220,34,9600
 Mvva 100,228,52
 Mvva 104,224,40
 TR 222,34,10112
 Mvva 104,228,56
 Mvva 108,224,44
 TR 224,34,160
 WL 7
 Mvva 108,228,60
  buffer_load_dwordx4 v7, s[40:43], s44 offen offset:2112 lds
 Mvva 112,208,32
 TR 226,34,672
 WL 6
 Mvva 112,212,48
 Mvva 116,208,36
 TR 228,34,9632
 Mvva 116,212,52
  buffer_load_dwordx4 v8, s[40:43], s44 offen offset:3168 lds
 Mvva 120,208,40
 TR 230,34,10144
 Mvva 120,212,56
 Mvva 124,208,44
 TR 208,34,192
  s_add_u32 m0, s47, 20736
 Mvva 124,212,60
  s_waitcnt vmcnt(17)
  v_cmp_gt_u32 vcc, 1, v248
  s_nop 4
  s_cbranch_vccnz Lpoll_ctx_8
Lback_ctx_8:
 WL 7
 Mvva 128,216,32
 TR 210,34,704
 WL 6
 Mvva 128,220,48
  buffer_load_dwordx4 v9, s[20:23], s44 offen sc1 lds
 Mvva 132,216,36
 TR 212,34,9664
  s_add_u32 s46, s24, 0
 Mvva 132,220,52
 Mvva 136,216,40
 TR 214,34,10176
 Mvva 136,220,56
  buffer_load_dwordx4 a[212:215], v16, s[20:23], s46 offen offset:0 sc1
 Mvva 140,216,44
 TR 216,34,224
 Mvva 140,220,60
 WL 7
 Mvva 144,224,32
 TR 218,34,736
 WL 6
 Mvva 144,228,48
  buffer_load_dwordx4 a[216:219], v16, s[20:23], s46 offen offset:2048 sc1
 Mvva 148,224,36
 TR 220,34,9696
 Mvva 148,228,52
 Mvva 152,224,40
 TR 222,34,10208
 Mvva 152,228,56
 Mvva 156,224,44
 TR 224,58,0
 WL 7
 Mvva 156,228,60
  buffer_load_dwordx4 a[220:223], v17, s[20:23], s46 offen offset:0 sc1
 Mvva 160,208,32
 TR 226,58,512
 WL 6
 Mvva 160,212,48
 Mvva 164,208,36
 TR 228,58,9472
 Mvva 164,212,52
  buffer_load_dwordx4 a[224:227], v17, s[20:23], s46 offen offset:2048 sc1
 Mvva 168,208,40
 TR 230,58,9984
 Mvva 168,212,56
 Mvva 172,208,44
 TR 208,34,18944
  s_add_u32 s46, s24, 8192
 Mvva 172,212,60
 WL 7
 Mvva 176,216,32
 TR 210,34,19456
 WL 6
 Mvva 176,220,48
  buffer_load_dwordx4 a[228:231], v16, s[20:23], s46 offen offset:0 sc1
 Mvva 180,216,36
 TR 212,34,28416
 Mvva 180,220,52
 Mvva 184,216,40
 TR 214,34,28928
 Mvva 184,220,56
  buffer_load_dwordx4 a[232:235], v16, s[20:23], s46 offen offset:2048 sc1
 Mvva 188,216,44
 TR 216,34,18976
 Mvva 188,220,60
 WL 7
 Mvva 192,224,32
 TR 218,34,19488
 WL 6
 Mvva 192,228,48
 Mvva 196,224,36
 TR 220,34,28448
 Mvva 196,228,52
  buffer_load_dwordx4 a[236:239], v17, s[20:23], s46 offen offset:0 sc1
 Mvva 200,224,40
 TR 222,34,28960
 Mvva 200,228,56
 Mvva 204,224,44
 TR 224,34,19008
 WL 7
 Mvva 204,228,60
  buffer_load_dwordx4 a[240:243], v17, s[20:23], s46 offen offset:2048 sc1
 Mvva 64,208,64
 TR 226,34,19520
 WL 6
 Mvva 64,212,80
  s_add_u32 s46, s24, 16384
 Mvva 68,208,68
 TR 228,34,28480
 Mvva 68,212,84
  buffer_load_dwordx4 a[176:179], v16, s[20:23], s46 offen offset:0 sc1
 Mvva 72,208,72
 TR 230,34,28992
 Mvva 72,212,88
 Mvva 76,208,76
 TR 208,34,19040
 Mvva 76,212,92
 WL 7
 Mvva 80,216,64
 TR 210,34,19552
 WL 6
 Mvva 80,220,80
  buffer_load_dwordx4 a[180:183], v16, s[20:23], s46 offen offset:2048 sc1
 Mvva 84,216,68
 TR 212,34,28512
 Mvva 84,220,84
 Mvva 88,216,72
 TR 214,34,29024
 Mvva 88,220,88
  buffer_load_dwordx4 a[184:187], v17, s[20:23], s46 offen offset:0 sc1
 Mvva 92,216,76
 TR 216,34,19072
 Mvva 92,220,92
 WL 7
 Mvva 96,224,64
 TR 218,34,19584
 WL 6
 Mvva 96,228,80
 Mvva 100,224,68
 TR 220,34,28544
 Mvva 100,228,84
  buffer_load_dwordx4 a[188:191], v17, s[20:23], s46 offen offset:2048 sc1
 Mvva 104,224,72
 TR 222,34,29056
 Mvva 104,228,88
  s_add_u32 s46, s24, 24576
 Mvva 108,224,76
 TR 224,34,19104
 WL 7
 Mvva 108,228,92
  buffer_load_dwordx4 a[192:195], v16, s[20:23], s46 offen offset:0 sc1
 Mvva 112,208,64
 TR 226,34,19616
 WL 6
 Mvva 112,212,80
 Mvva 116,208,68
 TR 228,34,28576
 Mvva 116,212,84
 Mvva 120,208,72
 TR 230,34,29088
 Mvva 120,212,88
  buffer_load_dwordx4 a[196:199], v16, s[20:23], s46 offen offset:2048 sc1
 Mvva 124,208,76
 TR 208,34,19136
 Mvva 124,212,92
 WL 7
 Mvva 128,216,64
 TR 210,34,19648
 WL 6
 Mvva 128,220,80
  buffer_load_dwordx4 a[200:203], v17, s[20:23], s46 offen offset:0 sc1
 Mvva 132,216,68
 TR 212,34,28608
 Mvva 132,220,84
 Mvva 136,216,72
 TR 214,34,29120
 Mvva 136,220,88
  buffer_load_dwordx4 a[204:207], v17, s[20:23], s46 offen offset:2048 sc1
 Mvva 140,216,76
 TR 216,34,19168
  s_add_u32 s44, s44, 1179648
 Mvva 140,220,92
 WL 7
 WL 5
 Mvva 144,224,64
 TR 218,34,19680
  s_add_u32 m0, s47, 125952
 Mvva 144,228,80
 Mvva 148,224,68
 TR 220,34,28640
 Mvva 148,228,84
  buffer_load_dwordx4 v1, s[40:43], s44 offen lds
 Mvva 152,224,72
 TR 222,34,29152
 Mvva 152,228,88
 Mvva 156,224,76
 TR 224,58,18944
 WL 7
 Mvva 156,228,92
  buffer_load_dwordx4 v2, s[40:43], s44 offen offset:1056 lds
 Mvva 160,208,64
 TR 226,58,19456
 WL 6
 Mvva 160,212,80
 Mvva 164,208,68
 TR 228,58,28416
 Mvva 164,212,84
 Mvva 168,208,72
 TR 230,58,28928
 Mvva 168,212,88
  buffer_load_dwordx4 v3, s[40:43], s44 offen offset:2112 lds
 Mvva 172,208,76
 Mvva 172,212,92
 WL 6
 Mvva 176,216,64
 WL 4
 Mvva 176,220,80
 WL 0
  s_barrier
 Mvva 180,216,68
 TR 208,35,0
 Mvva 180,220,84
 TR 210,35,512
 Mvva 184,216,72
 TR 212,35,9472
 Mvva 184,220,88
 TR 214,35,9984
 Mvva 188,216,76
 TR 216,35,32
 Mvva 188,220,92
  buffer_load_dwordx4 v4, s[40:43], s44 offen offset:3168 lds
 Mvva 192,224,64
 TR 218,35,544
  s_add_u32 m0, s47, 130176
 Mvva 192,228,80
  buffer_load_dwordx4 v5, s[40:43], s44 offen lds
 Mvva 196,224,68
 TR 220,35,9504
 Mvva 196,228,84
  buffer_load_dwordx4 v6, s[40:43], s44 offen offset:1056 lds
 Mvva 200,224,72
 TR 222,35,10016
 Mvva 200,228,88
 Mvva 204,224,76
 TR 224,35,64
 WL 7
 Mvva 204,228,92
  buffer_load_dwordx4 v7, s[40:43], s44 offen offset:2112 lds
 Mvva 64,208,96
 TR 226,35,576
 WL 6
 Mvva 64,212,112
 Mvva 68,208,100
 TR 228,35,9536
 Mvva 68,212,116
 Mvva 72,208,104
 TR 230,35,10048
 Mvva 72,212,120
  buffer_load_dwordx4 v8, s[40:43], s44 offen offset:3168 lds
 Mvva 76,208,108
 TR 208,35,96
 Mvva 76,212,124
  s_add_u32 m0, s47, 134400
 WL 7
 Mvva 80,216,96
 TR 210,35,608
 WL 6
 Mvva 80,220,112
  buffer_load_dwordx4 v9, s[20:23], s44 offen sc1 lds
 Mvva 84,216,100
 TR 212,35,9568
 Mvva 84,220,116
 Mvva 88,216,104
 TR 214,35,10080
  s_add_u32 s46, s24, 32768
 Mvva 88,220,120
 Mvva 92,216,108
 TR 216,35,128
 WL 7
 Mvva 92,220,124
  buffer_load_dwordx4 a[144:147], v16, s[20:23], s46 offen offset:0 sc1
 Mvva 96,224,96
 TR 218,35,640
 WL 6
 Mvva 96,228,112
 Mvva 100,224,100
 TR 220,35,9600
 Mvva 100,228,116
  buffer_load_dwordx4 a[148:151], v16, s[20:23], s46 offen offset:2048 sc1
 Mvva 104,224,104
 TR 222,35,10112
 Mvva 104,228,120
 Mvva 108,224,108
 TR 224,35,160
 WL 7
 Mvva 108,228,124
  buffer_load_dwordx4 a[152:155], v17, s[20:23], s46 offen offset:0 sc1
 Mvva 112,208,96
 TR 226,35,672
 WL 6
 Mvva 112,212,112
 Mvva 116,208,100
 TR 228,35,9632
 Mvva 116,212,116
 Mvva 120,208,104
 TR 230,35,10144
 Mvva 120,212,120
  buffer_load_dwordx4 a[156:159], v17, s[20:23], s46 offen offset:2048 sc1
 Mvva 124,208,108
 TR 208,35,192
 Mvva 124,212,124
  s_add_u32 s46, s24, 40960
 WL 7
 Mvva 128,216,96
 TR 210,35,704
 WL 6
 Mvva 128,220,112
  buffer_load_dwordx4 a[160:163], v16, s[20:23], s46 offen offset:0 sc1
 Mvva 132,216,100
 TR 212,35,9664
 Mvva 132,220,116
 Mvva 136,216,104
 TR 214,35,10176
 Mvva 136,220,120
 Mvva 140,216,108
 TR 216,35,224
 WL 7
 Mvva 140,220,124
  buffer_load_dwordx4 a[164:167], v16, s[20:23], s46 offen offset:2048 sc1
 Mvva 144,224,96
 TR 218,35,736
 WL 6
 Mvva 144,228,112
 Mvva 148,224,100
 TR 220,35,9696
 Mvva 148,228,116
  buffer_load_dwordx4 a[168:171], v17, s[20:23], s46 offen offset:0 sc1
 Mvva 152,224,104
 TR 222,35,10208
 Mvva 152,228,120
 Mvva 156,224,108
 TR 224,59,0
 Mvva 156,228,124
 WL 7
 Mvva 160,208,96
 TR 226,59,512
 WL 6
 Mvva 160,212,112
  buffer_load_dwordx4 a[172:175], v17, s[20:23], s46 offen offset:2048 sc1
 Mvva 164,208,100
 TR 228,59,9472
  s_add_u32 s44, s44, 1179648
 Mvva 164,212,116
  s_add_u32 m0, s47, 50176
 Mvva 168,208,104
 TR 230,59,9984
 Mvva 168,212,120
  buffer_load_dwordx4 v1, s[40:43], s44 offen lds
 Mvva 172,208,108
 TR 208,35,18944
 Mvva 172,212,124
 WL 7
 Mvva 176,216,96
 TR 210,35,19456
 WL 6
 Mvva 176,220,112
  buffer_load_dwordx4 v2, s[40:43], s44 offen offset:1056 lds
 Mvva 180,216,100
 TR 212,35,28416
 Mvva 180,220,116
 Mvva 184,216,104
 TR 214,35,28928
 Mvva 184,220,120
 Mvva 188,216,108
 TR 216,35,18976
 WL 7
 Mvva 188,220,124
  buffer_load_dwordx4 v3, s[40:43], s44 offen offset:2112 lds
 Mvva 192,224,96
 TR 218,35,19488
 WL 6
 Mvva 192,228,112
 Mvva 196,224,100
 TR 220,35,28448
 Mvva 196,228,116
  buffer_load_dwordx4 v4, s[40:43], s44 offen offset:3168 lds
 Mvva 200,224,104
 TR 222,35,28960
  s_waitcnt vmcnt(47)
 Mvva 200,228,120
 Mvva 204,224,108
 TR 224,35,19008
  s_add_u32 m0, s47, 54400
 Mvva 204,228,124
 WL 7
 Mvva 64,208,128
 TR 226,35,19520
 WL 6
 Mvvv 64,212,40
  buffer_load_dwordx4 v5, s[40:43], s44 offen lds
 Mvva 68,208,132
 TR 228,35,28480
 Mvvv 68,212,44
 Mvva 72,208,136
 TR 230,35,28992
 Mvvv 72,212,48
  buffer_load_dwordx4 v6, s[40:43], s44 offen offset:1056 lds
 Mvva 76,208,140
 TR 208,35,19040
 Mvvv 76,212,52
 WL 7
 Mvva 80,216,128
 TR 210,35,19552
 WL 6
 Mvvv 80,220,40
 Mvva 84,216,132
 TR 212,35,28512
 Mvvv 84,220,44
  buffer_load_dwordx4 v7, s[40:43], s44 offen offset:2112 lds
 Mvva 88,216,136
 TR 214,35,29024
 Mvvv 88,220,48
 Mvva 92,216,140
 TR 216,35,19072
 WL 7
 Mvvv 92,220,52
  buffer_load_dwordx4 v8, s[40:43], s44 offen offset:3168 lds
 Mvva 96,224,128
 TR 218,35,19584
 WL 6
 Mvvv 96,228,40
  s_add_u32 m0, s47, 58624
 Mvva 100,224,132
 TR 220,35,28544
 Mvvv 100,228,44
  buffer_load_dwordx4 v9, s[20:23], s44 offen sc1 lds
 Mvva 104,224,136
 TR 222,35,29056
 Mvvv 104,228,48
 Mvva 108,224,140
 TR 224,35,19104
  s_add_u32 s46, s24, 49152
 Mvvv 108,228,52
 WL 7
 Mvva 112,208,128
 TR 226,35,19616
 WL 6
 Mvvv 112,212,40
  buffer_load_dwordx4 a[0:3], v16, s[20:23], s46 offen offset:0 sc1
 Mvva 116,208,132
 TR 228,35,28576
 Mvvv 116,212,44
 Mvva 120,208,136
 TR 230,35,29088
 Mvvv 120,212,48
  buffer_load_dwordx4 a[4:7], v16, s[20:23], s46 offen offset:2048 sc1
 Mvva 124,208,140
 TR 208,35,19136
 Mvvv 124,212,52
 WL 7
 Mvva 128,216,128
 TR 210,35,19648
 WL 6
 Mvvv 128,220,40
 Mvva 132,216,132
 TR 212,35,28608
 Mvvv 132,220,44
  buffer_load_dwordx4 a[8:11], v17, s[20:23], s46 offen offset:0 sc1
 Mvva 136,216,136
 TR 214,35,29120
 Mvvv 136,220,48
 Mvva 140,216,140
 TR 216,35,19168
 WL 7
 Mvvv 140,220,52
  buffer_load_dwordx4 a[12:15], v17, s[20:23], s46 offen offset:2048 sc1
 Mvva 144,224,128
 TR 218,35,19680
 WL 6
 Mvvv 144,228,40
 Mvva 148,224,132
 TR 220,35,28640
  s_add_u32 s46, s24, 57344
 Mvvv 148,228,44
 Mvva 152,224,136
 TR 222,35,29152
 Mvvv 152,228,48
  buffer_load_dwordx4 a[16:19], v16, s[20:23], s46 offen offset:0 sc1
 Mvva 156,224,140
 TR 224,59,18944
 Mvvv 156,228,52
 WL 7
 Mvva 160,208,128
 TR 226,59,19456
 WL 6
 Mvvv 160,212,40
  buffer_load_dwordx4 a[20:23], v16, s[20:23], s46 offen offset:2048 sc1
 Mvva 164,208,132
 TR 228,59,28416
 Mvvv 164,212,44
 Mvva 168,208,136
 TR 230,59,28928
 Mvvv 168,212,48
  buffer_load_dwordx4 a[24:27], v17, s[20:23], s46 offen offset:0 sc1
 Mvva 172,208,140
 Mvvv 172,212,52
 WL 6
 Mvva 176,216,128
 WL 4
 Mvvv 176,220,40
 WL 0
  s_waitcnt vmcnt(49)
  s_barrier
 Mvva 180,216,132
 TR 208,32,0
 Mvvv 180,220,44
 TR 210,32,512
 Mvva 184,216,136
 TR 212,32,9472
 Mvvv 184,220,48
 TR 214,32,9984
 Mvva 188,216,140
 TR 216,32,32
 Mvvv 188,220,52
  buffer_load_dwordx4 a[28:31], v17, s[20:23], s46 offen offset:2048 sc1
 Mvva 192,224,128
 TR 218,32,544
  s_add_u32 s46, s24, 65536
 Mvvv 192,228,40
  buffer_load_dwordx4 a[32:35], v16, s[20:23], s46 offen offset:0 sc1
 Mvva 196,224,132
 TR 220,32,9504
 Mvvv 196,228,44
 Mvva 200,224,136
 TR 222,32,10016
  s_waitcnt vmcnt(43)
 Mvvv 200,228,48
  buffer_load_dwordx4 a[36:39], v16, s[20:23], s46 offen offset:2048 sc1
 Mvva 204,224,140
 TR 224,32,64
 Mvvv 204,228,52
 WL 7
 Mvva 64,208,212
 TR 226,32,576
 WL 6
 Mvva 64,212,228
  buffer_load_dwordx4 a[40:43], v17, s[20:23], s46 offen offset:0 sc1
 Mvva 68,208,216
 TR 228,32,9536
 Mvva 68,212,232
  global_load_dword a248, v249, s[100:101]
 Mvva 72,208,220
 TR 230,32,10048
 Mvva 72,212,236
 WL 4
 Mvva 76,208,224
 TR 208,32,96
 WL 7
 Mvva 76,212,240
  buffer_load_dwordx4 a[44:47], v17, s[20:23], s46 offen offset:2048 sc1
 Mvva 80,216,212
 TR 210,32,608
  s_add_u32 s46, s24, 73728
 Mvva 80,220,228
 Mvva 84,216,216
 TR 212,32,9568
 Mvva 84,220,232
  buffer_load_dwordx4 a[48:51], v16, s[20:23], s46 offen offset:0 sc1
 Mvva 88,216,220
 TR 214,32,10080
 Mvva 88,220,236
 Mvva 92,216,224
 TR 216,32,128
 WL 7
 Mvva 92,220,240
  buffer_load_dwordx4 a[52:55], v16, s[20:23], s46 offen offset:2048 sc1
 Mvva 96,224,212
 TR 218,32,640
 WL 6
 Mvva 96,228,228
 Mvva 100,224,216
 TR 220,32,9600
 Mvva 100,228,232
 Mvva 104,224,220
 TR 222,32,10112
 Mvva 104,228,236
  buffer_load_dwordx4 a[56:59], v17, s[20:23], s46 offen offset:0 sc1
 Mvva 108,224,224
 TR 224,32,160
 Mvva 108,228,240
 WL 7
 Mvva 112,208,212
 TR 226,32,672
 WL 6
 Mvva 112,212,228
  buffer_load_dwordx4 a[60:63], v17, s[20:23], s46 offen offset:2048 sc1
 Mvva 116,208,216
 TR 228,32,9632
  s_add_u32 s44, s44, 1179648
 Mvva 116,212,232
 Mvva 120,208,220
 TR 230,32,10144
  s_add_u32 m0, s47, 88064
 Mvva 120,212,236
 Mvva 124,208,224
 TR 208,32,192
 WL 7
 Mvva 124,212,240
  buffer_load_dwordx4 v1, s[40:43], s44 offen lds
 Mvva 128,216,212
 TR 210,32,704
 WL 6
 Mvva 128,220,228
 Mvva 132,216,216
 TR 212,32,9664
 Mvva 132,220,232
  buffer_load_dwordx4 v2, s[40:43], s44 offen offset:1056 lds
 Mvva 136,216,220
 TR 214,32,10176
 Mvva 136,220,236
 Mvva 140,216,224
 TR 216,32,224
 WL 7
 Mvva 140,220,240
  buffer_load_dwordx4 v3, s[40:43], s44 offen offset:2112 lds
 Mvva 144,224,212
 TR 218,32,736
 WL 6
 Mvva 144,228,228
 Mvva 148,224,216
 TR 220,32,9696
 Mvva 148,228,232
 Mvva 152,224,220
 TR 222,32,10208
 Mvva 152,228,236
  buffer_load_dwordx4 v4, s[40:43], s44 offen offset:3168 lds
 Mvva 156,224,224
 TR 224,56,0
 Mvva 156,228,240
  s_add_u32 m0, s47, 92288
 WL 7
 Mvva 160,208,212
 TR 226,56,512
 WL 6
 Mvva 160,212,228
  buffer_load_dwordx4 v5, s[40:43], s44 offen lds
 Mvva 164,208,216
 TR 228,56,9472
 Mvva 164,212,232
 Mvva 168,208,220
 TR 230,56,9984
 Mvva 168,212,236
 Mvva 172,208,224
 TR 208,32,18944
 WL 7
 Mvva 172,212,240
  buffer_load_dwordx4 v6, s[40:43], s44 offen offset:1056 lds
 Mvva 176,216,212
 TR 210,32,19456
 WL 6
 Mvva 176,220,228
 Mvva 180,216,216
 TR 212,32,28416
 Mvva 180,220,232
  buffer_load_dwordx4 v7, s[40:43], s44 offen offset:2112 lds
 Mvva 184,216,220
 TR 214,32,28928
 Mvva 184,220,236
 Mvva 188,216,224
 TR 216,32,18976
 Mvva 188,220,240
 WL 7
 Mvva 192,224,212
 TR 218,32,19488
 WL 6
 Mvva 192,228,228
  buffer_load_dwordx4 v8, s[40:43], s44 offen offset:3168 lds
 Mvva 196,224,216
 TR 220,32,28448
 Mvva 196,228,232
  s_add_u32 m0, s47, 96512
 Mvva 200,224,220
 TR 222,32,28960
  s_waitcnt vmcnt(51)
 Mvva 200,228,236
  buffer_load_dwordx4 v9, s[20:23], s44 offen sc1 lds
 Mvva 204,224,224
 TR 224,32,19008
 Mvva 204,228,240
  s_add_u32 s46, s24, 81920
 WL 7
 Mvva 64,208,176
 TR 226,32,19520
 WL 6
 Mvva 64,212,192
  buffer_load_dwordx4 a[64:67], v16, s[20:23], s46 offen offset:0 sc1
 Mvva 68,208,180
 TR 228,32,28480
 Mvva 68,212,196
 Mvva 72,208,184
 TR 230,32,28992
 Mvva 72,212,200
 Mvva 76,208,188
 TR 208,32,19040
 WL 7
 Mvva 76,212,204
  buffer_load_dwordx4 a[68:71], v16, s[20:23], s46 offen offset:2048 sc1
 Mvva 80,216,176
 TR 210,32,19552
 WL 6
 Mvva 80,220,192
 Mvva 84,216,180
 TR 212,32,28512
 Mvva 84,220,196
  buffer_load_dwordx4 a[72:75], v17, s[20:23], s46 offen offset:0 sc1
 Mvva 88,216,184
 TR 214,32,29024
 Mvva 88,220,200
 Mvva 92,216,188
 TR 216,32,19072
 Mvva 92,220,204
 WL 7
 Mvva 96,224,176
 TR 218,32,19584
 WL 6
 Mvva 96,228,192
  buffer_load_dwordx4 a[76:79], v17, s[20:23], s46 offen offset:2048 sc1
 Mvva 100,224,180
 TR 220,32,28544
 Mvva 100,228,196
  s_add_u32 s46, s24, 90112
 Mvva 104,224,184
 TR 222,32,29056
 Mvva 104,228,200
  buffer_load_dwordx4 a[80:83], v16, s[20:23], s46 offen offset:0 sc1
 Mvva 108,224,188
 TR 224,32,19104
 Mvva 108,228,204
 WL 7
 Mvva 112,208,176
 TR 226,32,19616
 WL 6
 Mvva 112,212,192
 Mvva 116,208,180
 TR 228,32,28576
 Mvva 116,212,196
  buffer_load_dwordx4 a[84:87], v16, s[20:23], s46 offen offset:2048 sc1
 Mvva 120,208,184
 TR 230,32,29088
 Mvva 120,212,200
 Mvva 124,208,188
 TR 208,32,19136
 WL 7
 Mvva 124,212,204
  buffer_load_dwordx4 a[88:91], v17, s[20:23], s46 offen offset:0 sc1
 Mvva 128,216,176
 TR 210,32,19648
 WL 6
 Mvva 128,220,192
 Mvva 132,216,180
 TR 212,32,28608
 Mvva 132,220,196
  buffer_load_dwordx4 a[92:95], v17, s[20:23], s46 offen offset:2048 sc1
 Mvva 136,216,184
 TR 214,32,29120
 Mvva 136,220,200
 Mvva 140,216,188
 TR 216,32,19168
  s_add_u32 s46, s24, 98304
 Mvva 140,220,204
 WL 7
 Mvva 144,224,176
 TR 218,32,19680
 WL 6
 Mvva 144,228,192
  buffer_load_dwordx4 a[96:99], v16, s[20:23], s46 offen offset:0 sc1
 Mvva 148,224,180
 TR 220,32,28640
 Mvva 148,228,196
 Mvva 152,224,184
 TR 222,32,29152
 Mvva 152,228,200
  buffer_load_dwordx4 a[100:103], v16, s[20:23], s46 offen offset:2048 sc1
 Mvva 156,224,188
 TR 224,56,18944
 Mvva 156,228,204
 WL 7
 Mvva 160,208,176
 TR 226,56,19456
 WL 6
 Mvva 160,212,192
 Mvva 164,208,180
 TR 228,56,28416
 Mvva 164,212,196
  buffer_load_dwordx4 a[104:107], v17, s[20:23], s46 offen offset:0 sc1
 Mvva 168,208,184
 TR 230,56,28928
 Mvva 168,212,200
 Mvva 172,208,188
 WL 6
 Mvva 172,212,204
  buffer_load_dwordx4 a[108:111], v17, s[20:23], s46 offen offset:2048 sc1
 Mvva 176,216,176
 WL 4
 Mvva 176,220,192
 WL 0
  s_waitcnt vmcnt(55)
  s_barrier
 Mvva 180,216,180
 TR 208,33,0
  s_add_u32 s46, s24, 106496
 Mvva 180,220,196
 TR 210,33,512
 Mvva 184,216,184
 TR 212,33,9472
 Mvva 184,220,200
 TR 214,33,9984
 Mvva 188,216,188
 TR 216,33,32
 Mvva 188,220,204
  buffer_load_dwordx4 a[112:115], v16, s[20:23], s46 offen offset:0 sc1
 Mvva 192,224,176
 TR 218,33,544
 Mvva 192,228,192
  buffer_load_dwordx4 a[116:119], v16, s[20:23], s46 offen offset:2048 sc1
 Mvva 196,224,180
 TR 220,33,9504
 Mvva 196,228,196
 Mvva 200,224,184
 TR 222,33,10016
  s_waitcnt vmcnt(49)
 Mvva 200,228,200
  buffer_load_dwordx4 a[120:123], v17, s[20:23], s46 offen offset:0 sc1
 Mvva 204,224,188
 TR 224,33,64
 Mvva 204,228,204
 WL 7
 Mvva 64,208,144
 TR 226,33,576
 WL 6
 Mvva 64,212,160
 Mvva 68,208,148
 TR 228,33,9536
 Mvva 68,212,164
  buffer_load_dwordx4 a[124:127], v17, s[20:23], s46 offen offset:2048 sc1
 Mvva 72,208,152
 TR 230,33,10048
 Mvva 72,212,168
  s_add_u32 s46, s24, 114688
 Mvva 76,208,156
 TR 208,33,96
 WL 7
 Mvva 76,212,172
  buffer_load_dwordx4 a[128:131], v16, s[20:23], s46 offen offset:0 sc1
 Mvva 80,216,144
 TR 210,33,608
 WL 6
 Mvva 80,220,160
 Mvva 84,216,148
 TR 212,33,9568
 Mvva 84,220,164
 Mvva 88,216,152
 TR 214,33,10080
 Mvva 88,220,168
  buffer_load_dwordx4 a[132:135], v16, s[20:23], s46 offen offset:2048 sc1
 Mvva 92,216,156
 TR 216,33,128
 Mvva 92,220,172
 WL 7
 Mvva 96,224,144
 TR 218,33,640
 WL 6
 Mvva 96,228,160
  buffer_load_dwordx4 a[136:139], v17, s[20:23], s46 offen offset:0 sc1
 Mvva 100,224,148
 TR 220,33,9600
 Mvva 100,228,164
 Mvva 104,224,152
 TR 222,33,10112
 Mvva 104,228,168
 WL 4
 Mvva 108,224,156
 TR 224,33,160
 WL 7
 Mvva 108,228,172
  buffer_load_dwordx4 a[140:143], v17, s[20:23], s46 offen offset:2048 sc1
 Mvva 112,208,144
 TR 226,33,672
  s_add_u32 s46, s24, 122880
 Mvva 112,212,160
 Mvva 116,208,148
 TR 228,33,9632
 Mvva 116,212,164
  buffer_load_dwordx4 v[40:43], v16, s[20:23], s46 offen offset:0 sc1
 Mvva 120,208,152
 TR 230,33,10144
 Mvva 120,212,168
 Mvva 124,208,156
 TR 208,33,192
 WL 7
 Mvva 124,212,172
  buffer_load_dwordx4 v[44:47], v16, s[20:23], s46 offen offset:2048 sc1
 Mvva 128,216,144
 TR 210,33,704
 WL 6
 Mvva 128,220,160
 Mvva 132,216,148
 TR 212,33,9664
 Mvva 132,220,164
 Mvva 136,216,152
 TR 214,33,10176
 Mvva 136,220,168
  buffer_load_dwordx4 v[48:51], v17, s[20:23], s46 offen offset:0 sc1
 Mvva 140,216,156
 TR 216,33,224
 Mvva 140,220,172
 WL 7
 Mvva 144,224,144
 TR 218,33,736
 WL 6
 Mvva 144,228,160
  buffer_load_dwordx4 v[52:55], v17, s[20:23], s46 offen offset:2048 sc1
 Mvva 148,224,148
 TR 220,33,9696
 Mvva 148,228,164
 Mvva 152,224,152
 TR 222,33,10208
 Mvva 152,228,168
 Mvva 156,224,156
 TR 224,57,0
 Mvva 156,228,172
 WL 7
 Mvva 160,208,144
 TR 226,57,512
 WL 6
 Mvva 160,212,160
 Mvva 164,208,148
 TR 228,57,9472
 Mvva 164,212,164
 Mvva 168,208,152
 TR 230,57,9984
 Mvva 168,212,168
 Mvva 172,208,156
 TR 208,33,18944
 Mvva 172,212,172
 WL 7
 Mvva 176,216,144
 TR 210,33,19456
 WL 6
 Mvva 176,220,160
 Mvva 180,216,148
 TR 212,33,28416
 Mvva 180,220,164
 Mvva 184,216,152
 TR 214,33,28928
 Mvva 184,220,168
 Mvva 188,216,156
 Mvva 188,220,172
 WL 6
 Mvva 192,224,144
 WL 4
 Mvva 192,228,160
 WL 0
  s_waitcnt vmcnt(50)
  s_barrier
 Mvva 196,224,148
 TR 216,34,0
 Mvva 196,228,164
 TR 218,34,512
 Mvva 200,224,152
 TR 220,34,9472
  s_waitcnt vmcnt(42)
 Mvva 200,228,168
 TR 222,34,9984
 Mvva 204,224,156
 TR 224,34,18944
 Mvva 204,228,172
 Mvva 64,208,0
 TR 226,34,19456
 Mvva 64,212,16
 Mvva 68,208,4
 TR 228,34,28416
 Mvva 68,212,20
 Mvva 72,208,8
 TR 230,34,28928
  s_waitcnt vmcnt(33)
 Mvva 72,212,24
 Mvva 76,208,12
 Mvva 76,212,28
 WL 6
 Mvva 64,216,32
 WL 4
 Mvva 64,220,48
 WL 0
  s_waitcnt vmcnt(24)
  s_barrier
 Mvva 68,216,36
 TR 208,35,0
 Mvva 68,220,52
 TR 210,35,512
 Mvva 72,216,40
 TR 212,35,9472
  s_waitcnt vmcnt(16)
 Mvva 72,220,56
 TR 214,35,9984
 Mvva 76,216,44
 TR 216,35,18944
 Mvva 76,220,60
  global_load_dword a248, v249, s[100:101]
 Mvva 64,224,64
 TR 218,35,19456
 Mvva 64,228,80
 Mvva 68,224,68
 TR 220,35,28416
 Mvva 68,228,84
 Mvva 72,224,72
 TR 222,35,28928
  s_waitcnt vmcnt(9)
 Mvva 72,228,88
 Mvva 76,224,76
 TR 224,33,18976
 Mvva 76,228,92
 WL 7
 Mvva 64,208,96
 TR 226,33,19488
 WL 6
 Mvva 64,212,112
 Mvva 68,208,100
 TR 228,33,28448
 Mvva 68,212,116
 Mvva 72,208,104
 TR 230,33,28960
  s_waitcnt vmcnt(1)
 Mvva 72,212,120
 Mvva 76,208,108
 TR 208,34,32
 Mvva 76,212,124
 WL 7
 Mvva 64,216,128
 TR 210,34,544
 WL 6
 Mvvv 64,220,40
 Mvva 68,216,132
 TR 212,34,9504
 Mvvv 68,220,44
 Mvva 72,216,136
 TR 214,34,10016
 Mvvv 72,220,48
 Mvva 76,216,140
 TR 216,34,18976
 Mvvv 76,220,52
 WL 7
 WL 5
 Mvva 80,224,0
 TR 218,34,19488
  v_and_b32 v247, 7, v0
 Mvva 80,228,16
  v_lshlrev_b32 v247, 2, v247
  v_cvt_pk_bf16_f32 v64, v64, v65
 Mvva 84,224,4
 TR 220,34,28448
  v_cvt_pk_bf16_f32 v65, v66, v67
 Mvva 84,228,20
  buffer_load_dword v248, v247, s[20:23], s54 offen offset:32 sc1
 Mvva 88,224,8
 TR 222,34,28960
  v_cvt_pk_bf16_f32 v66, v68, v69
 Mvva 88,228,24
  v_cvt_pk_bf16_f32 v67, v70, v71
  v_min_u32 v64, -2, v64
 Mvva 92,224,12
 TR 224,35,32
  v_min_u32 v65, -2, v65
 Mvva 92,228,28
 WL 7
  v_min_u32 v66, -2, v66
  v_min_u32 v67, -2, v67
 Mvva 80,208,32
 TR 226,35,544
 WL 6
 Mvva 80,212,48
  buffer_store_dwordx4 v[64:67], v16, s[8:11], 0 offen offset:0 sc1
 Mvva 84,208,36
 TR 228,35,9504
  v_cvt_pk_bf16_f32 v72, v72, v73
 Mvva 84,212,52
  v_cvt_pk_bf16_f32 v73, v74, v75
  v_cvt_pk_bf16_f32 v74, v76, v77
 Mvva 88,208,40
 TR 230,35,10016
  v_cvt_pk_bf16_f32 v75, v78, v79
 Mvva 88,212,56
  v_min_u32 v72, -2, v72
  v_min_u32 v73, -2, v73
 Mvva 92,208,44
 TR 208,35,18976
  v_min_u32 v74, -2, v74
 Mvva 92,212,60
  v_min_u32 v75, -2, v75
 WL 7
 Mvva 80,216,64
 TR 210,35,19488
 WL 6
 Mvva 80,220,80
  buffer_store_dwordx4 v[72:75], v16, s[8:11], s50 offen offset:1024 sc1
 Mvva 84,216,68
 TR 212,35,28448
 Mvva 84,220,84
 Mvva 88,216,72
 TR 214,35,28960
  v_mov_b32 v246, 2
 Mvva 88,220,88
 Mvva 92,216,76
 TR 216,33,19008
 Mvva 92,220,92
 WL 7
 Mvva 80,224,96
 TR 218,33,19520
 WL 6
 Mvva 80,228,112
 Mvva 84,224,100
 TR 220,33,28480
 Mvva 84,228,116
 Mvva 88,224,104
 TR 222,33,28992
 Mvva 88,228,120
 Mvva 92,224,108
 TR 224,34,64
 Mvva 92,228,124
 WL 7
 Mvva 80,208,128
 TR 226,34,576
 WL 6
 Mvvv 80,212,40
 Mvva 84,208,132
 TR 228,34,9536
 Mvvv 84,212,44
 Mvva 88,208,136
 TR 230,34,10048
 Mvvv 88,212,48
 Mvva 92,208,140
 TR 208,34,19008
 Mvvv 92,212,52
 WL 7
 WL 5
 Mvva 96,216,0
 TR 210,34,19520
  v_cvt_pk_bf16_f32 v80, v80, v81
 Mvva 96,220,16
  v_cvt_pk_bf16_f32 v81, v82, v83
  v_cvt_pk_bf16_f32 v82, v84, v85
 Mvva 100,216,4
 TR 212,34,28480
  v_cvt_pk_bf16_f32 v83, v86, v87
 Mvva 100,220,20
  v_min_u32 v80, -2, v80
  v_min_u32 v81, -2, v81
 Mvva 104,216,8
 TR 214,34,28992
  v_min_u32 v82, -2, v82
 Mvva 104,220,24
  v_min_u32 v83, -2, v83
 WL 4
 Mvva 108,216,12
 TR 216,35,64
 WL 7
 Mvva 108,220,28
  buffer_store_dwordx4 v[80:83], v16, s[8:11], 0 offen offset:1024 sc1
 Mvva 96,224,32
 TR 218,35,576
  v_cvt_pk_bf16_f32 v88, v88, v89
 Mvva 96,228,48
  v_cvt_pk_bf16_f32 v89, v90, v91
  v_cvt_pk_bf16_f32 v90, v92, v93
 Mvva 100,224,36
 TR 220,35,9536
  v_cvt_pk_bf16_f32 v91, v94, v95
 Mvva 100,228,52
  v_min_u32 v88, -2, v88
  v_min_u32 v89, -2, v89
 Mvva 104,224,40
 TR 222,35,10048
  v_min_u32 v90, -2, v90
 Mvva 104,228,56
  v_min_u32 v91, -2, v91
 Mvva 108,224,44
 TR 224,35,19008
 WL 7
 Mvva 108,228,60
  buffer_store_dwordx4 v[88:91], v16, s[8:11], s50 offen offset:2048 sc1
 Mvva 96,208,64
 TR 226,35,19520
 WL 6
 Mvva 96,212,80
 Mvva 100,208,68
 TR 228,35,28480
 Mvva 100,212,84
 Mvva 104,208,72
 TR 230,35,28992
 Mvva 104,212,88
 Mvva 108,208,76
 TR 208,33,19040
 Mvva 108,212,92
 WL 7
 Mvva 96,216,96
 TR 210,33,19552
 WL 6
 Mvva 96,220,112
 Mvva 100,216,100
 TR 212,33,28512
 Mvva 100,220,116
 Mvva 104,216,104
 TR 214,33,29024
 Mvva 104,220,120
 Mvva 108,216,108
 TR 216,34,96
 Mvva 108,220,124
 WL 7
 Mvva 96,224,128
 TR 218,34,608
 WL 6
 Mvvv 96,228,40
 Mvva 100,224,132
 TR 220,34,9568
 Mvvv 100,228,44
 Mvva 104,224,136
 TR 222,34,10080
 Mvvv 104,228,48
 Mvva 108,224,140
 TR 224,34,19040
 Mvvv 108,228,52
 WL 7
 WL 5
 Mvva 112,208,0
 TR 226,34,19552
  v_cvt_pk_bf16_f32 v96, v96, v97
 Mvva 112,212,16
  v_cvt_pk_bf16_f32 v97, v98, v99
  v_cvt_pk_bf16_f32 v98, v100, v101
 Mvva 116,208,4
 TR 228,34,28512
  v_cvt_pk_bf16_f32 v99, v102, v103
 Mvva 116,212,20
  v_min_u32 v96, -2, v96
  v_min_u32 v97, -2, v97
 Mvva 120,208,8
 TR 230,34,29024
  v_min_u32 v98, -2, v98
 Mvva 120,212,24
  v_min_u32 v99, -2, v99
 WL 4
 Mvva 124,208,12
 TR 208,35,96
 WL 7
 Mvva 124,212,28
  buffer_store_dwordx4 v[96:99], v16, s[8:11], 0 offen offset:2048 sc1
 Mvva 112,216,32
 TR 210,35,608
  v_cvt_pk_bf16_f32 v104, v104, v105
 Mvva 112,220,48
  v_cvt_pk_bf16_f32 v105, v106, v107
  v_cvt_pk_bf16_f32 v106, v108, v109
 Mvva 116,216,36
 TR 212,35,9568
  v_cvt_pk_bf16_f32 v107, v110, v111
 Mvva 116,220,52
  v_min_u32 v104, -2, v104
  v_min_u32 v105, -2, v105
 Mvva 120,216,40
 TR 214,35,10080
  v_min_u32 v106, -2, v106
 Mvva 120,220,56
  v_min_u32 v107, -2, v107
 Mvva 124,216,44
 TR 216,35,19040
 WL 7
 Mvva 124,220,60
  buffer_store_dwordx4 v[104:107], v16, s[8:11], s50 offen offset:3072 sc1
 Mvva 112,224,64
 TR 218,35,19552
 WL 6
 Mvva 112,228,80
 Mvva 116,224,68
 TR 220,35,28512
 Mvva 116,228,84
 Mvva 120,224,72
 TR 222,35,29024
 Mvva 120,228,88
 Mvva 124,224,76
 TR 224,33,19072
 Mvva 124,228,92
 WL 7
 Mvva 112,208,96
 TR 226,33,19584
 WL 6
 Mvva 112,212,112
 Mvva 116,208,100
 TR 228,33,28544
 Mvva 116,212,116
 Mvva 120,208,104
 TR 230,33,29056
 Mvva 120,212,120
 Mvva 124,208,108
 TR 208,34,128
 Mvva 124,212,124
 WL 7
 Mvva 112,216,128
 TR 210,34,640
 WL 6
 Mvvv 112,220,40
 Mvva 116,216,132
 TR 212,34,9600
 Mvvv 116,220,44
 Mvva 120,216,136
 TR 214,34,10112
 Mvvv 120,220,48
 Mvva 124,216,140
 TR 216,34,19072
 Mvvv 124,220,52
 WL 7
 WL 5
 Mvva 128,224,0
 TR 218,34,19584
  v_cvt_pk_bf16_f32 v112, v112, v113
 Mvva 128,228,16
  v_cvt_pk_bf16_f32 v113, v114, v115
  v_cvt_pk_bf16_f32 v114, v116, v117
 Mvva 132,224,4
 TR 220,34,28544
  v_cvt_pk_bf16_f32 v115, v118, v119
 Mvva 132,228,20
  v_min_u32 v112, -2, v112
  v_min_u32 v113, -2, v113
 Mvva 136,224,8
 TR 222,34,29056
  v_min_u32 v114, -2, v114
 Mvva 136,228,24
  v_min_u32 v115, -2, v115
 WL 4
 Mvva 140,224,12
 TR 224,35,128
 WL 7
 Mvva 140,228,28
  buffer_store_dwordx4 v[112:115], v16, s[8:11], 0 offen offset:3072 sc1
 Mvva 128,208,32
 TR 226,35,640
  v_cvt_pk_bf16_f32 v120, v120, v121
 Mvva 128,212,48
  v_cvt_pk_bf16_f32 v121, v122, v123
  v_cvt_pk_bf16_f32 v122, v124, v125
 Mvva 132,208,36
 TR 228,35,9600
  v_cvt_pk_bf16_f32 v123, v126, v127
 Mvva 132,212,52
  v_min_u32 v120, -2, v120
  v_min_u32 v121, -2, v121
 Mvva 136,208,40
 TR 230,35,10112
  v_min_u32 v122, -2, v122
 Mvva 136,212,56
  v_min_u32 v123, -2, v123
 Mvva 140,208,44
 TR 208,35,19072
 WL 7
 Mvva 140,212,60
  buffer_store_dwordx4 v[120:123], v17, s[8:11], s50 offen offset:0 sc1
 Mvva 128,216,64
 TR 210,35,19584
 WL 6
 Mvva 128,220,80
 Mvva 132,216,68
 TR 212,35,28544
 Mvva 132,220,84
 Mvva 136,216,72
 TR 214,35,29056
 Mvva 136,220,88
 Mvva 140,216,76
 TR 216,33,19104
 Mvva 140,220,92
 WL 7
 Mvva 128,224,96
 TR 218,33,19616
 WL 6
 Mvva 128,228,112
 Mvva 132,224,100
 TR 220,33,28576
 Mvva 132,228,116
 Mvva 136,224,104
 TR 222,33,29088
 Mvva 136,228,120
 Mvva 140,224,108
 TR 224,34,160
 Mvva 140,228,124
 WL 7
 Mvva 128,208,128
 TR 226,34,672
 WL 6
 Mvvv 128,212,40
 Mvva 132,208,132
 TR 228,34,9632
 Mvvv 132,212,44
 Mvva 136,208,136
 TR 230,34,10144
 Mvvv 136,212,48
 Mvva 140,208,140
 TR 208,34,19104
 Mvvv 140,212,52
 WL 7
 WL 5
 Mvva 144,216,0
 TR 210,34,19616
  v_cvt_pk_bf16_f32 v128, v128, v129
 Mvva 144,220,16
  v_cvt_pk_bf16_f32 v129, v130, v131
  v_cvt_pk_bf16_f32 v130, v132, v133
 Mvva 148,216,4
 TR 212,34,28576
  v_cvt_pk_bf16_f32 v131, v134, v135
 Mvva 148,220,20
  v_min_u32 v128, -2, v128
  v_min_u32 v129, -2, v129
 Mvva 152,216,8
 TR 214,34,29088
  v_min_u32 v130, -2, v130
 Mvva 152,220,24
  v_min_u32 v131, -2, v131
 WL 4
 Mvva 156,216,12
 TR 216,35,160
 WL 7
 Mvva 156,220,28
  buffer_store_dwordx4 v[128:131], v17, s[8:11], 0 offen offset:0 sc1
 Mvva 144,224,32
 TR 218,35,672
  v_cvt_pk_bf16_f32 v136, v136, v137
 Mvva 144,228,48
  v_cvt_pk_bf16_f32 v137, v138, v139
  v_cvt_pk_bf16_f32 v138, v140, v141
 Mvva 148,224,36
 TR 220,35,9632
  v_cvt_pk_bf16_f32 v139, v142, v143
 Mvva 148,228,52
  v_min_u32 v136, -2, v136
  v_min_u32 v137, -2, v137
 Mvva 152,224,40
 TR 222,35,10144
  v_min_u32 v138, -2, v138
 Mvva 152,228,56
  v_min_u32 v139, -2, v139
 Mvva 156,224,44
 TR 224,35,19104
 WL 7
 Mvva 156,228,60
  buffer_store_dwordx4 v[136:139], v17, s[8:11], s50 offen offset:1024 sc1
 Mvva 144,208,64
 TR 226,35,19616
 WL 6
 Mvva 144,212,80
 Mvva 148,208,68
 TR 228,35,28576
 Mvva 148,212,84
 Mvva 152,208,72
 TR 230,35,29088
 Mvva 152,212,88
 Mvva 156,208,76
 TR 208,33,19136
 Mvva 156,212,92
 WL 7
 Mvva 144,216,96
 TR 210,33,19648
 WL 6
 Mvva 144,220,112
 Mvva 148,216,100
 TR 212,33,28608
 Mvva 148,220,116
  s_waitcnt vmcnt(10)
  v_cmp_gt_u32 vcc, 1, v248
  s_nop 4
  s_cbranch_vccnz Lpoll_pz_8
Lback_pz_8:
 Mvva 152,216,104
 TR 214,33,29120
 Mvva 152,220,120
 WL 6
 Mvva 156,216,108
 TR 216,34,192
  s_add_u32 s46, s55, 0
 Mvva 156,220,124
  buffer_load_dwordx4 v[64:67], v28, s[20:23], s46 offen sc1
 Mvva 144,224,128
 TR 218,34,704
 WL 6
 Mvvv 144,228,40
 Mvva 148,224,132
 TR 220,34,9664
 Mvvv 148,228,44
 Mvva 152,224,136
 TR 222,34,10176
 Mvvv 152,228,48
 Mvva 156,224,140
 TR 224,34,19136
 Mvvv 156,228,52
 WL 7
 WL 5
 Mvva 160,208,0
 TR 226,34,19648
  v_cvt_pk_bf16_f32 v144, v144, v145
 Mvva 160,212,16
  s_add_u32 s46, s55, 18432
  v_cvt_pk_bf16_f32 v145, v146, v147
  v_cvt_pk_bf16_f32 v146, v148, v149
 Mvva 164,208,4
 TR 228,34,28608
  v_cvt_pk_bf16_f32 v147, v150, v151
 Mvva 164,212,20
  buffer_load_dwordx4 v[68:71], v28, s[20:23], s46 offen sc1
 Mvva 168,208,8
 TR 230,34,29120
  v_min_u32 v144, -2, v144
 Mvva 168,212,24
 WL 6
  v_min_u32 v145, -2, v145
  v_min_u32 v146, -2, v146
 Mvva 172,208,12
 TR 208,35,192
  v_min_u32 v147, -2, v147
 Mvva 172,212,28
  buffer_store_dwordx4 v[144:147], v17, s[8:11], 0 offen offset:1024 sc1
 Mvva 160,216,32
 TR 210,35,704
  v_cvt_pk_bf16_f32 v152, v152, v153
 WL 6
 Mvva 160,220,48
  v_cvt_pk_bf16_f32 v153, v154, v155
  v_cvt_pk_bf16_f32 v154, v156, v157
 Mvva 164,216,36
 TR 212,35,9664
  v_cvt_pk_bf16_f32 v155, v158, v159
 Mvva 164,220,52
  s_add_u32 s46, s55, 36864
  v_min_u32 v152, -2, v152
  v_min_u32 v153, -2, v153
 Mvva 168,216,40
 TR 214,35,10176
  v_min_u32 v154, -2, v154
 Mvva 168,220,56
  buffer_load_dwordx4 v[72:75], v28, s[20:23], s46 offen sc1
 Mvva 172,216,44
 TR 216,35,19136
  v_min_u32 v155, -2, v155
 Mvva 172,220,60
  buffer_store_dwordx4 v[152:155], v17, s[8:11], s50 offen offset:2048 sc1
 WL 7
 Mvva 160,224,64
 TR 218,35,19648
 WL 6
 Mvva 160,228,80
 Mvva 164,224,68
 TR 220,35,28608
 Mvva 164,228,84
 Mvva 168,224,72
 TR 222,35,29120
  s_add_u32 s46, s55, 55296
 Mvva 168,228,88
  buffer_load_dwordx4 v[76:79], v28, s[20:23], s46 offen sc1
 Mvva 172,224,76
 TR 224,33,19168
 Mvva 172,228,92
 WL 7
 Mvva 160,208,96
 TR 226,33,19680
 WL 6
 Mvva 160,212,112
 Mvva 164,208,100
 TR 228,33,28640
 Mvva 164,212,116
  v_mov_b32 v128, 0
  v_mov_b32 v129, 0
 Mvva 168,208,104
 TR 230,33,29152
  v_mov_b32 v130, 0
 Mvva 168,212,120
 WL 6
  v_mov_b32 v131, 0
  v_mov_b32 v132, 0
 Mvva 172,208,108
 TR 208,34,224
  s_add_u32 s46, s55, 73728
 Mvva 172,212,124
  buffer_load_dwordx4 v[80:83], v28, s[20:23], s46 offen sc1
 Mvva 160,216,128
 TR 210,34,736
  v_mov_b32 v133, 0
 WL 6
 Mvvv 160,220,40
  v_mov_b32 v134, 0
  v_mov_b32 v135, 0
 Mvva 164,216,132
 TR 212,34,9696
  v_mov_b32 v136, 0
 Mvvv 164,220,44
  v_mov_b32 v137, 0
  v_mov_b32 v138, 0
 Mvva 168,216,136
 TR 214,34,10208
  v_mov_b32 v139, 0
 Mvvv 168,220,48
 WL 4
  v_mov_b32 v140, 0
  v_mov_b32 v141, 0
 Mvva 172,216,140
 TR 216,34,19168
  v_mov_b32 v142, 0
 Mvvv 172,220,52
 WL 7
  v_mov_b32 v143, 0
  v_mov_b32 v144, 0
 Mvva 176,224,0
 TR 218,34,19680
  v_cvt_pk_bf16_f32 v160, v160, v161
 Mvva 176,228,16
  s_add_u32 s46, s55, 92160
  v_cvt_pk_bf16_f32 v161, v162, v163
  v_cvt_pk_bf16_f32 v162, v164, v165
 Mvva 180,224,4
 TR 220,34,28640
  v_cvt_pk_bf16_f32 v163, v166, v167
 Mvva 180,228,20
  buffer_load_dwordx4 v[84:87], v28, s[20:23], s46 offen sc1
 Mvva 184,224,8
 TR 222,34,29152
  v_min_u32 v160, -2, v160
 Mvva 184,228,24
 WL 6
  v_min_u32 v161, -2, v161
  v_min_u32 v162, -2, v162
 Mvva 188,224,12
 TR 224,35,224
  v_min_u32 v163, -2, v163
 Mvva 188,228,28
  buffer_store_dwordx4 v[160:163], v17, s[8:11], 0 offen offset:2048 sc1
 Mvva 176,208,32
 TR 226,35,736
  v_cvt_pk_bf16_f32 v168, v168, v169
 WL 6
 Mvva 176,212,48
  v_cvt_pk_bf16_f32 v169, v170, v171
  v_cvt_pk_bf16_f32 v170, v172, v173
 Mvva 180,208,36
 TR 228,35,9696
  v_cvt_pk_bf16_f32 v171, v174, v175
 Mvva 180,212,52
  buffer_load_dword v248, v247, s[20:23], s54 offen offset:32 sc1
 Mvva 184,208,40
 TR 230,35,10208
  v_min_u32 v168, -2, v168
 Mvva 184,212,56
  s_add_u32 s46, s55, 110592
  v_min_u32 v169, -2, v169
  v_min_u32 v170, -2, v170
 Mvva 188,208,44
 TR 208,35,19168
  v_min_u32 v171, -2, v171
 Mvva 188,212,60
  buffer_load_dwordx4 v[88:91], v28, s[20:23], s46 offen sc1
 WL 7
 Mvva 176,216,64
 TR 210,35,19680
  v_mov_b32 v145, 0
 WL 6
 Mvva 176,220,80
  buffer_store_dwordx4 v[168:171], v17, s[8:11], s50 offen offset:3072 sc1
 Mvva 180,216,68
 TR 212,35,28640
 Mvva 180,220,84
 Mvva 184,216,72
 TR 214,35,29152
  s_add_u32 s46, s55, 129024
 Mvva 184,220,88
  buffer_load_dwordx4 v[92:95], v28, s[20:23], s46 offen sc1
 Mvva 188,216,76
 TR 216,57,18944
 Mvva 188,220,92
 WL 7
 Mvva 176,224,96
 TR 218,57,19456
 WL 6
 Mvva 176,228,112
 Mvva 180,224,100
 TR 220,57,28416
 Mvva 180,228,116
 Mvva 184,224,104
 TR 222,57,28928
 Mvva 184,228,120
 Mvva 188,224,108
 TR 224,58,0
 Mvva 188,228,124
 WL 7
 Mvva 176,208,128
 TR 226,58,512
 WL 6
 Mvvv 176,212,40
 Mvva 180,208,132
 TR 228,58,9472
 Mvvv 180,212,44
 Mvva 184,208,136
 TR 230,58,9984
 Mvvv 184,212,48
 Mvva 188,208,140
 TR 208,58,18944
 Mvvv 188,212,52
 WL 7
 WL 5
 Mvva 192,216,0
 TR 210,58,19456
  v_cvt_pk_bf16_f32 v176, v176, v177
 Mvva 192,220,16
  buffer_store_dword v246, v245, s[20:23], s66 offen sc1
 Mvva 196,216,4
 TR 212,58,28416
  v_cvt_pk_bf16_f32 v177, v178, v179
 Mvva 196,220,20
  v_cvt_pk_bf16_f32 v178, v180, v181
  v_cvt_pk_bf16_f32 v179, v182, v183
 Mvva 200,216,8
 TR 214,58,28928
  v_min_u32 v176, -2, v176
 Mvva 200,220,24
 WL 6
  v_min_u32 v177, -2, v177
  v_min_u32 v178, -2, v178
 Mvva 204,216,12
 TR 216,59,0
  v_min_u32 v179, -2, v179
 Mvva 204,220,28
  buffer_store_dwordx4 v[176:179], v17, s[8:11], 0 offen offset:3072 sc1
 Mvva 192,224,32
 TR 218,59,512
  v_cvt_pk_bf16_f32 v184, v184, v185
 WL 6
 Mvva 192,228,48
  v_cvt_pk_bf16_f32 v185, v186, v187
  v_cvt_pk_bf16_f32 v186, v188, v189
 Mvva 196,224,36
 TR 220,59,9472
  v_cvt_pk_bf16_f32 v187, v190, v191
 Mvva 196,228,52
  v_min_u32 v184, -2, v184
  v_min_u32 v185, -2, v185
 Mvva 200,224,40
 TR 222,59,9984
  v_min_u32 v186, -2, v186
 Mvva 200,228,56
  v_min_u32 v187, -2, v187
 Mvva 204,224,44
 TR 224,59,18944
 WL 7
 Mvva 204,228,60
  buffer_store_dwordx4 v[184:187], v16, s[8:11], s51 offen offset:0 sc1
 Mvva 192,208,64
 TR 226,59,19456
 WL 6
 Mvva 192,212,80
 Mvva 196,208,68
 TR 228,59,28416
 Mvva 196,212,84
 Mvva 200,208,72
 TR 230,59,28928
 Mvva 200,212,88
 Mvva 204,208,76
 Mvva 204,212,92
 WL 6
 Mvva 192,216,96
 WL 4
 Mvva 192,220,112
 Mvva 196,216,100
 Mvva 196,220,116
 Mvva 200,216,104
 Mvva 200,220,120
 Mvva 204,216,108
 Mvva 204,220,124
 WL 2
 Mvva 192,224,128
 WL 0
 Mvvv 192,228,40
 Mvva 196,224,132
 Mvvv 196,228,44
 Mvva 200,224,136
 Mvvv 200,228,48
 Mvva 204,224,140
 Mvvv 204,228,52
  s_nop 1
  v_cvt_pk_bf16_f32 v192, v192, v193
  v_cvt_pk_bf16_f32 v193, v194, v195
  v_cvt_pk_bf16_f32 v194, v196, v197
  v_cvt_pk_bf16_f32 v195, v198, v199
  v_min_u32 v192, -2, v192
  v_min_u32 v193, -2, v193
  v_min_u32 v194, -2, v194
  v_min_u32 v195, -2, v195
  buffer_store_dwordx4 v[192:195], v16, s[8:11], s50 offen offset:0 sc1
  v_cvt_pk_bf16_f32 v200, v200, v201
  v_cvt_pk_bf16_f32 v201, v202, v203
  v_cvt_pk_bf16_f32 v202, v204, v205
  v_cvt_pk_bf16_f32 v203, v206, v207
  v_min_u32 v200, -2, v200
  v_min_u32 v201, -2, v201
  v_min_u32 v202, -2, v202
  v_min_u32 v203, -2, v203
  buffer_store_dwordx4 v[200:203], v16, s[8:11], s51 offen offset:1024 sc1
  s_waitcnt vmcnt(8)
  v_cmp_gt_u32 vcc, 2, v248
  s_nop 4
  s_cbranch_vccnz Lpoll_red_8
Lback_red_8:
  s_add_u32 s46, s55, 4096
  buffer_load_dwordx4 v[96:99], v28, s[20:23], s46 offen sc1
  buffer_load_dword v232, v29, s[20:23], s46 offen sc1
  s_add_u32 s46, s55, 22528
  buffer_load_dwordx4 v[100:103], v28, s[20:23], s46 offen sc1
  buffer_load_dword v233, v29, s[20:23], s46 offen sc1
  s_add_u32 s46, s55, 40960
  buffer_load_dwordx4 v[104:107], v28, s[20:23], s46 offen sc1
  buffer_load_dword v234, v29, s[20:23], s46 offen sc1
  s_add_u32 s46, s55, 59392
  buffer_load_dwordx4 v[108:111], v28, s[20:23], s46 offen sc1
  buffer_load_dword v235, v29, s[20:23], s46 offen sc1
  s_add_u32 s46, s55, 77824
  buffer_load_dwordx4 v[112:115], v28, s[20:23], s46 offen sc1
  buffer_load_dword v236, v29, s[20:23], s46 offen sc1
  s_add_u32 s46, s55, 96256
  buffer_load_dwordx4 v[116:119], v28, s[20:23], s46 offen sc1
  buffer_load_dword v237, v29, s[20:23], s46 offen sc1
  s_add_u32 s46, s55, 114688
  buffer_load_dwordx4 v[120:123], v28, s[20:23], s46 offen sc1
  buffer_load_dword v238, v29, s[20:23], s46 offen sc1
  s_add_u32 s46, s55, 133120
  buffer_load_dwordx4 v[124:127], v28, s[20:23], s46 offen sc1
  buffer_load_dword v239, v29, s[20:23], s46 offen sc1
  s_load_dwordx2 s[16:17], s[0:1], 80
  s_mov_b32 s18, 0x240000
  s_mov_b32 s19, 0x00020000
Lchk_8:
  s_bitcmp1_b32 s57, 0
  s_cbranch_scc0 Lskip0_8
  v_max3_u32 v36, v64, v65, v66
  v_max3_u32 v36, v36, v67, v67
  v_cmp_eq_u32 vcc, -1, v36
  s_nop 4
  s_cbranch_vccnz Lskip0_8
  v_lshlrev_b32 v36, 16, v64
  v_and_b32 v37, 0xffff0000, v64
  v_pk_add_f32 v[128:129], v[128:129], v[36:37]
  v_lshlrev_b32 v36, 16, v65
  v_and_b32 v37, 0xffff0000, v65
  v_pk_add_f32 v[130:131], v[130:131], v[36:37]
  v_lshlrev_b32 v36, 16, v66
  v_and_b32 v37, 0xffff0000, v66
  v_pk_add_f32 v[132:133], v[132:133], v[36:37]
  v_lshlrev_b32 v36, 16, v67
  v_and_b32 v37, 0xffff0000, v67
  v_pk_add_f32 v[134:135], v[134:135], v[36:37]
  s_bitset0_b32 s57, 0
Lskip0_8:
  s_bitcmp1_b32 s57, 1
  s_cbranch_scc0 Lskip1_8
  v_max3_u32 v36, v68, v69, v70
  v_max3_u32 v36, v36, v71, v71
  v_cmp_eq_u32 vcc, -1, v36
  s_nop 4
  s_cbranch_vccnz Lskip1_8
  v_lshlrev_b32 v36, 16, v68
  v_and_b32 v37, 0xffff0000, v68
  v_pk_add_f32 v[128:129], v[128:129], v[36:37]
  v_lshlrev_b32 v36, 16, v69
  v_and_b32 v37, 0xffff0000, v69
  v_pk_add_f32 v[130:131], v[130:131], v[36:37]
  v_lshlrev_b32 v36, 16, v70
  v_and_b32 v37, 0xffff0000, v70
  v_pk_add_f32 v[132:133], v[132:133], v[36:37]
  v_lshlrev_b32 v36, 16, v71
  v_and_b32 v37, 0xffff0000, v71
  v_pk_add_f32 v[134:135], v[134:135], v[36:37]
  s_bitset0_b32 s57, 1
Lskip1_8:
  s_bitcmp1_b32 s57, 2
  s_cbranch_scc0 Lskip2_8
  v_max3_u32 v36, v72, v73, v74
  v_max3_u32 v36, v36, v75, v75
  v_cmp_eq_u32 vcc, -1, v36
  s_nop 4
  s_cbranch_vccnz Lskip2_8
  v_lshlrev_b32 v36, 16, v72
  v_and_b32 v37, 0xffff0000, v72
  v_pk_add_f32 v[128:129], v[128:129], v[36:37]
  v_lshlrev_b32 v36, 16, v73
  v_and_b32 v37, 0xffff0000, v73
  v_pk_add_f32 v[130:131], v[130:131], v[36:37]
  v_lshlrev_b32 v36, 16, v74
  v_and_b32 v37, 0xffff0000, v74
  v_pk_add_f32 v[132:133], v[132:133], v[36:37]
  v_lshlrev_b32 v36, 16, v75
  v_and_b32 v37, 0xffff0000, v75
  v_pk_add_f32 v[134:135], v[134:135], v[36:37]
  s_bitset0_b32 s57, 2
Lskip2_8:
  s_bitcmp1_b32 s57, 3
  s_cbranch_scc0 Lskip3_8
  v_max3_u32 v36, v76, v77, v78
  v_max3_u32 v36, v36, v79, v79
  v_cmp_eq_u32 vcc, -1, v36
  s_nop 4
  s_cbranch_vccnz Lskip3_8
  v_lshlrev_b32 v36, 16, v76
  v_and_b32 v37, 0xffff0000, v76
  v_pk_add_f32 v[128:129], v[128:129], v[36:37]
  v_lshlrev_b32 v36, 16, v77
  v_and_b32 v37, 0xffff0000, v77
  v_pk_add_f32 v[130:131], v[130:131], v[36:37]
  v_lshlrev_b32 v36, 16, v78
  v_and_b32 v37, 0xffff0000, v78
  v_pk_add_f32 v[132:133], v[132:133], v[36:37]
  v_lshlrev_b32 v36, 16, v79
  v_and_b32 v37, 0xffff0000, v79
  v_pk_add_f32 v[134:135], v[134:135], v[36:37]
  s_bitset0_b32 s57, 3
Lskip3_8:
  s_bitcmp1_b32 s57, 4
  s_cbranch_scc0 Lskip4_8
  v_max3_u32 v36, v80, v81, v82
  v_max3_u32 v36, v36, v83, v83
  v_cmp_eq_u32 vcc, -1, v36
  s_nop 4
  s_cbranch_vccnz Lskip4_8
  v_lshlrev_b32 v36, 16, v80
  v_and_b32 v37, 0xffff0000, v80
  v_pk_add_f32 v[128:129], v[128:129], v[36:37]
  v_lshlrev_b32 v36, 16, v81
  v_and_b32 v37, 0xffff0000, v81
  v_pk_add_f32 v[130:131], v[130:131], v[36:37]
  v_lshlrev_b32 v36, 16, v82
  v_and_b32 v37, 0xffff0000, v82
  v_pk_add_f32 v[132:133], v[132:133], v[36:37]
  v_lshlrev_b32 v36, 16, v83
  v_and_b32 v37, 0xffff0000, v83
  v_pk_add_f32 v[134:135], v[134:135], v[36:37]
  s_bitset0_b32 s57, 4
Lskip4_8:
  s_bitcmp1_b32 s57, 5
  s_cbranch_scc0 Lskip5_8
  v_max3_u32 v36, v84, v85, v86
  v_max3_u32 v36, v36, v87, v87
  v_cmp_eq_u32 vcc, -1, v36
  s_nop 4
  s_cbranch_vccnz Lskip5_8
  v_lshlrev_b32 v36, 16, v84
  v_and_b32 v37, 0xffff0000, v84
  v_pk_add_f32 v[128:129], v[128:129], v[36:37]
  v_lshlrev_b32 v36, 16, v85
  v_and_b32 v37, 0xffff0000, v85
  v_pk_add_f32 v[130:131], v[130:131], v[36:37]
  v_lshlrev_b32 v36, 16, v86
  v_and_b32 v37, 0xffff0000, v86
  v_pk_add_f32 v[132:133], v[132:133], v[36:37]
  v_lshlrev_b32 v36, 16, v87
  v_and_b32 v37, 0xffff0000, v87
  v_pk_add_f32 v[134:135], v[134:135], v[36:37]
  s_bitset0_b32 s57, 5
Lskip5_8:
  s_bitcmp1_b32 s57, 6
  s_cbranch_scc0 Lskip6_8
  s_waitcnt vmcnt(23)
  v_max3_u32 v36, v88, v89, v90
  v_max3_u32 v36, v36, v91, v91
  v_cmp_eq_u32 vcc, -1, v36
  s_nop 4
  s_cbranch_vccnz Lskip6_8
  v_lshlrev_b32 v36, 16, v88
  v_and_b32 v37, 0xffff0000, v88
  v_pk_add_f32 v[128:129], v[128:129], v[36:37]
  v_lshlrev_b32 v36, 16, v89
  v_and_b32 v37, 0xffff0000, v89
  v_pk_add_f32 v[130:131], v[130:131], v[36:37]
  v_lshlrev_b32 v36, 16, v90
  v_and_b32 v37, 0xffff0000, v90
  v_pk_add_f32 v[132:133], v[132:133], v[36:37]
  v_lshlrev_b32 v36, 16, v91
  v_and_b32 v37, 0xffff0000, v91
  v_pk_add_f32 v[134:135], v[134:135], v[36:37]
  s_bitset0_b32 s57, 6
Lskip6_8:
  s_bitcmp1_b32 s57, 7
  s_cbranch_scc0 Lskip7_8
  s_waitcnt vmcnt(21)
  v_max3_u32 v36, v92, v93, v94
  v_max3_u32 v36, v36, v95, v95
  v_cmp_eq_u32 vcc, -1, v36
  s_nop 4
  s_cbranch_vccnz Lskip7_8
  v_lshlrev_b32 v36, 16, v92
  v_and_b32 v37, 0xffff0000, v92
  v_pk_add_f32 v[128:129], v[128:129], v[36:37]
  v_lshlrev_b32 v36, 16, v93
  v_and_b32 v37, 0xffff0000, v93
  v_pk_add_f32 v[130:131], v[130:131], v[36:37]
  v_lshlrev_b32 v36, 16, v94
  v_and_b32 v37, 0xffff0000, v94
  v_pk_add_f32 v[132:133], v[132:133], v[36:37]
  v_lshlrev_b32 v36, 16, v95
  v_and_b32 v37, 0xffff0000, v95
  v_pk_add_f32 v[134:135], v[134:135], v[36:37]
  s_bitset0_b32 s57, 7
Lskip7_8:
  s_bitcmp1_b32 s57, 8
  s_cbranch_scc0 Lskip8_8
  s_waitcnt vmcnt(15)
  v_max3_u32 v36, v96, v97, v98
  s_waitcnt vmcnt(14)
  v_max3_u32 v36, v36, v99, v232
  v_cmp_eq_u32 vcc, -1, v36
  s_nop 4
  s_cbranch_vccnz Lskip8_8
  v_lshlrev_b32 v36, 16, v96
  v_and_b32 v37, 0xffff0000, v96
  v_pk_add_f32 v[136:137], v[136:137], v[36:37]
  v_lshlrev_b32 v36, 16, v97
  v_and_b32 v37, 0xffff0000, v97
  v_pk_add_f32 v[138:139], v[138:139], v[36:37]
  v_lshlrev_b32 v36, 16, v98
  v_and_b32 v37, 0xffff0000, v98
  v_pk_add_f32 v[140:141], v[140:141], v[36:37]
  v_lshlrev_b32 v36, 16, v99
  v_and_b32 v37, 0xffff0000, v99
  v_pk_add_f32 v[142:143], v[142:143], v[36:37]
  v_lshlrev_b32 v36, 16, v232
  v_and_b32 v37, 0xffff0000, v232
  v_pk_add_f32 v[144:145], v[144:145], v[36:37]
  s_bitset0_b32 s57, 8
Lskip8_8:
  s_bitcmp1_b32 s57, 9
  s_cbranch_scc0 Lskip9_8
  s_waitcnt vmcnt(13)
  v_max3_u32 v36, v100, v101, v102
  s_waitcnt vmcnt(12)
  v_max3_u32 v36, v36, v103, v233
  v_cmp_eq_u32 vcc, -1, v36
  s_nop 4
  s_cbranch_vccnz Lskip9_8
  v_lshlrev_b32 v36, 16, v100
  v_and_b32 v37, 0xffff0000, v100
  v_pk_add_f32 v[136:137], v[136:137], v[36:37]
  v_lshlrev_b32 v36, 16, v101
  v_and_b32 v37, 0xffff0000, v101
  v_pk_add_f32 v[138:139], v[138:139], v[36:37]
  v_lshlrev_b32 v36, 16, v102
  v_and_b32 v37, 0xffff0000, v102
  v_pk_add_f32 v[140:141], v[140:141], v[36:37]
  v_lshlrev_b32 v36, 16, v103
  v_and_b32 v37, 0xffff0000, v103
  v_pk_add_f32 v[142:143], v[142:143], v[36:37]
  v_lshlrev_b32 v36, 16, v233
  v_and_b32 v37, 0xffff0000, v233
  v_pk_add_f32 v[144:145], v[144:145], v[36:37]
  s_bitset0_b32 s57, 9
Lskip9_8:
  s_bitcmp1_b32 s57, 10
  s_cbranch_scc0 Lskip10_8
  s_waitcnt vmcnt(11)
  v_max3_u32 v36, v104, v105, v106
  s_waitcnt vmcnt(10)
  v_max3_u32 v36, v36, v107, v234
  v_cmp_eq_u32 vcc, -1, v36
  s_nop 4
  s_cbranch_vccnz Lskip10_8
  v_lshlrev_b32 v36, 16, v104
  v_and_b32 v37, 0xffff0000, v104
  v_pk_add_f32 v[136:137], v[136:137], v[36:37]
  v_lshlrev_b32 v36, 16, v105
  v_and_b32 v37, 0xffff0000, v105
  v_pk_add_f32 v[138:139], v[138:139], v[36:37]
  v_lshlrev_b32 v36, 16, v106
  v_and_b32 v37, 0xffff0000, v106
  v_pk_add_f32 v[140:141], v[140:141], v[36:37]
  v_lshlrev_b32 v36, 16, v107
  v_and_b32 v37, 0xffff0000, v107
  v_pk_add_f32 v[142:143], v[142:143], v[36:37]
  v_lshlrev_b32 v36, 16, v234
  v_and_b32 v37, 0xffff0000, v234
  v_pk_add_f32 v[144:145], v[144:145], v[36:37]
  s_bitset0_b32 s57, 10
Lskip10_8:
  s_bitcmp1_b32 s57, 11
  s_cbranch_scc0 Lskip11_8
  s_waitcnt vmcnt(9)
  v_max3_u32 v36, v108, v109, v110
  s_waitcnt vmcnt(8)
  v_max3_u32 v36, v36, v111, v235
  v_cmp_eq_u32 vcc, -1, v36
  s_nop 4
  s_cbranch_vccnz Lskip11_8
  v_lshlrev_b32 v36, 16, v108
  v_and_b32 v37, 0xffff0000, v108
  v_pk_add_f32 v[136:137], v[136:137], v[36:37]
  v_lshlrev_b32 v36, 16, v109
  v_and_b32 v37, 0xffff0000, v109
  v_pk_add_f32 v[138:139], v[138:139], v[36:37]
  v_lshlrev_b32 v36, 16, v110
  v_and_b32 v37, 0xffff0000, v110
  v_pk_add_f32 v[140:141], v[140:141], v[36:37]
  v_lshlrev_b32 v36, 16, v111
  v_and_b32 v37, 0xffff0000, v111
  v_pk_add_f32 v[142:143], v[142:143], v[36:37]
  v_lshlrev_b32 v36, 16, v235
  v_and_b32 v37, 0xffff0000, v235
  v_pk_add_f32 v[144:145], v[144:145], v[36:37]
  s_bitset0_b32 s57, 11
Lskip11_8:
  s_bitcmp1_b32 s57, 12
  s_cbranch_scc0 Lskip12_8
  s_waitcnt vmcnt(7)
  v_max3_u32 v36, v112, v113, v114
  s_waitcnt vmcnt(6)
  v_max3_u32 v36, v36, v115, v236
  v_cmp_eq_u32 vcc, -1, v36
  s_nop 4
  s_cbranch_vccnz Lskip12_8
  v_lshlrev_b32 v36, 16, v112
  v_and_b32 v37, 0xffff0000, v112
  v_pk_add_f32 v[136:137], v[136:137], v[36:37]
  v_lshlrev_b32 v36, 16, v113
  v_and_b32 v37, 0xffff0000, v113
  v_pk_add_f32 v[138:139], v[138:139], v[36:37]
  v_lshlrev_b32 v36, 16, v114
  v_and_b32 v37, 0xffff0000, v114
  v_pk_add_f32 v[140:141], v[140:141], v[36:37]
  v_lshlrev_b32 v36, 16, v115
  v_and_b32 v37, 0xffff0000, v115
  v_pk_add_f32 v[142:143], v[142:143], v[36:37]
  v_lshlrev_b32 v36, 16, v236
  v_and_b32 v37, 0xffff0000, v236
  v_pk_add_f32 v[144:145], v[144:145], v[36:37]
  s_bitset0_b32 s57, 12
Lskip12_8:
  s_bitcmp1_b32 s57, 13
  s_cbranch_scc0 Lskip13_8
  s_waitcnt vmcnt(5)
  v_max3_u32 v36, v116, v117, v118
  s_waitcnt vmcnt(4)
  v_max3_u32 v36, v36, v119, v237
  v_cmp_eq_u32 vcc, -1, v36
  s_nop 4
  s_cbranch_vccnz Lskip13_8
  v_lshlrev_b32 v36, 16, v116
  v_and_b32 v37, 0xffff0000, v116
  v_pk_add_f32 v[136:137], v[136:137], v[36:37]
  v_lshlrev_b32 v36, 16, v117
  v_and_b32 v37, 0xffff0000, v117
  v_pk_add_f32 v[138:139], v[138:139], v[36:37]
  v_lshlrev_b32 v36, 16, v118
  v_and_b32 v37, 0xffff0000, v118
  v_pk_add_f32 v[140:141], v[140:141], v[36:37]
  v_lshlrev_b32 v36, 16, v119
  v_and_b32 v37, 0xffff0000, v119
  v_pk_add_f32 v[142:143], v[142:143], v[36:37]
  v_lshlrev_b32 v36, 16, v237
  v_and_b32 v37, 0xffff0000, v237
  v_pk_add_f32 v[144:145], v[144:145], v[36:37]
  s_bitset0_b32 s57, 13
Lskip13_8:
  s_bitcmp1_b32 s57, 14
  s_cbranch_scc0 Lskip14_8
  s_waitcnt vmcnt(3)
  v_max3_u32 v36, v120, v121, v122
  s_waitcnt vmcnt(2)
  v_max3_u32 v36, v36, v123, v238
  v_cmp_eq_u32 vcc, -1, v36
  s_nop 4
  s_cbranch_vccnz Lskip14_8
  v_lshlrev_b32 v36, 16, v120
  v_and_b32 v37, 0xffff0000, v120
  v_pk_add_f32 v[136:137], v[136:137], v[36:37]
  v_lshlrev_b32 v36, 16, v121
  v_and_b32 v37, 0xffff0000, v121
  v_pk_add_f32 v[138:139], v[138:139], v[36:37]
  v_lshlrev_b32 v36, 16, v122
  v_and_b32 v37, 0xffff0000, v122
  v_pk_add_f32 v[140:141], v[140:141], v[36:37]
  v_lshlrev_b32 v36, 16, v123
  v_and_b32 v37, 0xffff0000, v123
  v_pk_add_f32 v[142:143], v[142:143], v[36:37]
  v_lshlrev_b32 v36, 16, v238
  v_and_b32 v37, 0xffff0000, v238
  v_pk_add_f32 v[144:145], v[144:145], v[36:37]
  s_bitset0_b32 s57, 14
Lskip14_8:
  s_bitcmp1_b32 s57, 15
  s_cbranch_scc0 Lskip15_8
  s_waitcnt vmcnt(1)
  v_max3_u32 v36, v124, v125, v126
  s_waitcnt vmcnt(0)
  v_max3_u32 v36, v36, v127, v239
  v_cmp_eq_u32 vcc, -1, v36
  s_nop 4
  s_cbranch_vccnz Lskip15_8
  v_lshlrev_b32 v36, 16, v124
  v_and_b32 v37, 0xffff0000, v124
  v_pk_add_f32 v[136:137], v[136:137], v[36:37]
  v_lshlrev_b32 v36, 16, v125
  v_and_b32 v37, 0xffff0000, v125
  v_pk_add_f32 v[138:139], v[138:139], v[36:37]
  v_lshlrev_b32 v36, 16, v126
  v_and_b32 v37, 0xffff0000, v126
  v_pk_add_f32 v[140:141], v[140:141], v[36:37]
  v_lshlrev_b32 v36, 16, v127
  v_and_b32 v37, 0xffff0000, v127
  v_pk_add_f32 v[142:143], v[142:143], v[36:37]
  v_lshlrev_b32 v36, 16, v239
  v_and_b32 v37, 0xffff0000, v239
  v_pk_add_f32 v[144:145], v[144:145], v[36:37]
  s_bitset0_b32 s57, 15
Lskip15_8:
  s_cmp_lg_u32 s57, 0
  s_cbranch_scc1 Lretry_8
  v_cvt_pk_bf16_f32 v64, v128, v129
  v_cvt_pk_bf16_f32 v65, v130, v131
  v_cvt_pk_bf16_f32 v66, v132, v133
  v_cvt_pk_bf16_f32 v67, v134, v135
  v_cvt_pk_bf16_f32 v68, v136, v137
  v_cvt_pk_bf16_f32 v69, v138, v139
  v_cvt_pk_bf16_f32 v70, v140, v141
  v_cvt_pk_bf16_f32 v71, v142, v143
  v_cvt_pk_bf16_f32 v72, v144, v145
 WL 0
  buffer_store_dwordx2 v[64:65], v30, s[16:19], s56 offen offset:0
  buffer_store_dwordx2 v[66:67], v30, s[16:19], s69 offen offset:0
  buffer_store_dwordx2 v[68:69], v30, s[16:19], s56 offen offset:128
  buffer_store_dwordx2 v[70:71], v30, s[16:19], s69 offen offset:128
  buffer_store_dword v72, v31, s[16:19], s56 offen
Lexit_8:
  s_endpgm
Lpoll_ctx_8:
  buffer_load_dword v248, v247, s[20:23], s54 offen offset:16 sc1
  s_waitcnt vmcnt(0)
  v_cmp_gt_u32 vcc, 1, v248
  s_nop 4
  s_cbranch_vccz Lback_ctx_8
  s_branch Lpoll_ctx_8
Lpoll_pz_8:
  buffer_load_dword v248, v247, s[20:23], s54 offen offset:32 sc1
  s_waitcnt vmcnt(0)
  v_cmp_gt_u32 vcc, 1, v248
  s_nop 4
  s_cbranch_vccz Lback_pz_8
  s_branch Lpoll_pz_8
Lpoll_red_8:
  buffer_load_dword v248, v247, s[20:23], s54 offen offset:32 sc1
  s_waitcnt vmcnt(0)
  v_cmp_gt_u32 vcc, 2, v248
  s_nop 4
  s_cbranch_vccz Lback_red_8
  s_branch Lpoll_red_8
Lretry_8:
  s_bitcmp1_b32 s57, 0
  s_cbranch_scc0 Lrskip0_8
  s_add_u32 s46, s55, 0
  buffer_load_dwordx4 v[64:67], v28, s[20:23], s46 offen sc1
Lrskip0_8:
  s_bitcmp1_b32 s57, 1
  s_cbranch_scc0 Lrskip1_8
  s_add_u32 s46, s55, 18432
  buffer_load_dwordx4 v[68:71], v28, s[20:23], s46 offen sc1
Lrskip1_8:
  s_bitcmp1_b32 s57, 2
  s_cbranch_scc0 Lrskip2_8
  s_add_u32 s46, s55, 36864
  buffer_load_dwordx4 v[72:75], v28, s[20:23], s46 offen sc1
Lrskip2_8:
  s_bitcmp1_b32 s57, 3
  s_cbranch_scc0 Lrskip3_8
  s_add_u32 s46, s55, 55296
  buffer_load_dwordx4 v[76:79], v28, s[20:23], s46 offen sc1
Lrskip3_8:
  s_bitcmp1_b32 s57, 4
  s_cbranch_scc0 Lrskip4_8
  s_add_u32 s46, s55, 73728
  buffer_load_dwordx4 v[80:83], v28, s[20:23], s46 offen sc1
Lrskip4_8:
  s_bitcmp1_b32 s57, 5
  s_cbranch_scc0 Lrskip5_8
  s_add_u32 s46, s55, 92160
  buffer_load_dwordx4 v[84:87], v28, s[20:23], s46 offen sc1
Lrskip5_8:
  s_bitcmp1_b32 s57, 6
  s_cbranch_scc0 Lrskip6_8
  s_add_u32 s46, s55, 110592
  buffer_load_dwordx4 v[88:91], v28, s[20:23], s46 offen sc1
Lrskip6_8:
  s_bitcmp1_b32 s57, 7
  s_cbranch_scc0 Lrskip7_8
  s_add_u32 s46, s55, 129024
  buffer_load_dwordx4 v[92:95], v28, s[20:23], s46 offen sc1
Lrskip7_8:
  s_bitcmp1_b32 s57, 8
  s_cbranch_scc0 Lrskip8_8
  s_add_u32 s46, s55, 4096
  buffer_load_dwordx4 v[96:99], v28, s[20:23], s46 offen sc1
  buffer_load_dword v232, v29, s[20:23], s46 offen sc1
Lrskip8_8:
  s_bitcmp1_b32 s57, 9
  s_cbranch_scc0 Lrskip9_8
  s_add_u32 s46, s55, 22528
  buffer_load_dwordx4 v[100:103], v28, s[20:23], s46 offen sc1
  buffer_load_dword v233, v29, s[20:23], s46 offen sc1
Lrskip9_8:
  s_bitcmp1_b32 s57, 10
  s_cbranch_scc0 Lrskip10_8
  s_add_u32 s46, s55, 40960
  buffer_load_dwordx4 v[104:107], v28, s[20:23], s46 offen sc1
  buffer_load_dword v234, v29, s[20:23], s46 offen sc1
Lrskip10_8:
  s_bitcmp1_b32 s57, 11
  s_cbranch_scc0 Lrskip11_8
  s_add_u32 s46, s55, 59392
  buffer_load_dwordx4 v[108:111], v28, s[20:23], s46 offen sc1
  buffer_load_dword v235, v29, s[20:23], s46 offen sc1
Lrskip11_8:
  s_bitcmp1_b32 s57, 12
  s_cbranch_scc0 Lrskip12_8
  s_add_u32 s46, s55, 77824
  buffer_load_dwordx4 v[112:115], v28, s[20:23], s46 offen sc1
  buffer_load_dword v236, v29, s[20:23], s46 offen sc1
Lrskip12_8:
  s_bitcmp1_b32 s57, 13
  s_cbranch_scc0 Lrskip13_8
  s_add_u32 s46, s55, 96256
  buffer_load_dwordx4 v[116:119], v28, s[20:23], s46 offen sc1
  buffer_load_dword v237, v29, s[20:23], s46 offen sc1
Lrskip13_8:
  s_bitcmp1_b32 s57, 14
  s_cbranch_scc0 Lrskip14_8
  s_add_u32 s46, s55, 114688
  buffer_load_dwordx4 v[120:123], v28, s[20:23], s46 offen sc1
  buffer_load_dword v238, v29, s[20:23], s46 offen sc1
Lrskip14_8:
  s_bitcmp1_b32 s57, 15
  s_cbranch_scc0 Lrskip15_8
  s_add_u32 s46, s55, 133120
  buffer_load_dwordx4 v[124:127], v28, s[20:23], s46 offen sc1
  buffer_load_dword v239, v29, s[20:23], s46 offen sc1
Lrskip15_8:
  s_waitcnt vmcnt(0)
  s_branch Lchk_8
Lp4e_8:
Lp4_10:
  v_cmp_lt_u32 vcc, 0x40000000, v43
  s_lshr_b32 s65, s6, 8
  s_lshl_b32 s66, s3, 2
  v_mov_b32 v246, s66
  s_cmp_lg_u64 vcc, 0
  s_cselect_b32 s66, 1, 0
  s_andn2_b32 s66, s66, s65
  v_mov_b32 v245, s66
  ds_write_b32 v246, v245
  v_and_b32 v246, 3, v0
  v_lshlrev_b32 v246, 2, v246
  v_lshlrev_b32 v59, 3, v0
  v_add_u32 v56, 20736, v59
  v_add_u32 v57, 134400, v59
  v_add_u32 v58, 58624, v59
  v_add_u32 v59, 96512, v59
 WL 0
  s_waitcnt vmcnt(33)
  s_barrier
 TR 208,32,0
 TR 210,32,512
 TR 212,32,9472
 TR 214,32,9984
 TR 216,32,32
 TR 218,32,544
 TR 220,32,9504
 TR 222,32,10016
 TR 224,32,64
 TR 226,32,576
 TR 228,32,9536
 TR 230,32,10048
  ds_read_b32 v245, v246
 WL 11
  v_mfma_f32_16x16x32_bf16 v[64:67], v[208:211], a[212:215], 0
  s_add_u32 s46, s45, 49152
  v_lshlrev_b32 v249, 14, v0
  v_add_u32 v249, Lp4_10-Lpc0, v249
 WL 9
 Mvva 64,212,228
  buffer_load_dwordx4 a[0:3], v16, s[20:23], s46 offen offset:0 sc1
  v_mfma_f32_16x16x32_bf16 v[68:71], v[208:211], a[216:219], 0
  v_min_u32 v249, Lp4e_10-Lpc0-16388, v249
 Mvva 68,212,232
  v_mfma_f32_16x16x32_bf16 v[72:75], v[208:211], a[220:223], 0
  buffer_load_dwordx4 a[4:7], v16, s[20:23], s46 offen offset:2048 sc1
 Mvva 72,212,236
  v_mfma_f32_16x16x32_bf16 v[76:79], v[208:211], a[224:227], 0
 TR 208,32,96
 Mvva 76,212,240
 WL 8
  v_mfma_f32_16x16x32_bf16 v[80:83], v[216:219], a[212:215], 0
 TR 210,32,608
 WL 7
 Mvva 80,220,228
  buffer_load_dwordx4 a[8:11], v17, s[20:23], s46 offen offset:0 sc1
  v_mfma_f32_16x16x32_bf16 v[84:87], v[216:219], a[216:219], 0
 TR 212,32,9568
 Mvva 84,220,232
 WL 3
  v_cmp_ne_u32 vcc, 0, v245
  s_nop 4
  s_cbranch_vccnz Lrestart
  v_mfma_f32_16x16x32_bf16 v[88:91], v[216:219], a[220:223], 0
 TR 214,32,10080
 Mvva 88,220,236
  buffer_load_dwordx4 a[12:15], v17, s[20:23], s46 offen offset:2048 sc1
  v_mfma_f32_16x16x32_bf16 v[92:95], v[216:219], a[224:227], 0
 TR 216,32,128
 Mvva 92,220,240
  s_cmp_lg_u32 s3, 0
  s_cselect_b32 s64, 256, 0
  s_and_b32 s66, s2, 0xe7
  v_mfma_f32_16x16x32_bf16 v[96:99], v[224:227], a[212:215], 0
 TR 218,32,640
  s_add_u32 s46, s45, 57344
 Mvva 96,228,228
  s_lshl_b32 s66, s66, 6
  s_lshr_b32 s65, s4, 3
  s_add_u32 s66, s66, s65
  v_mfma_f32_16x16x32_bf16 v[100:103], v[224:227], a[216:219], 0
 TR 220,32,9600
  s_lshl_b32 s66, s66, 2
 Mvva 100,228,232
  buffer_load_dwordx4 a[16:19], v16, s[20:23], s46 offen offset:0 sc1
  v_mfma_f32_16x16x32_bf16 v[104:107], v[224:227], a[220:223], 0
 TR 222,32,10112
  s_add_u32 s66, s66, 0x4480010
 Mvva 104,228,236
  global_load_dword a248, v249, s[100:101]
  v_mfma_f32_16x16x32_bf16 v[108:111], v[224:227], a[224:227], 0
 TR 224,32,160
  s_lshl_b32 s65, s64, 20
 Mvva 108,228,240
  buffer_load_dwordx4 a[20:23], v16, s[20:23], s46 offen offset:2048 sc1
 WL 7
  v_mfma_f32_16x16x32_bf16 v[112:115], v[208:211], a[212:215], 0
 TR 226,32,672
  s_add_u32 s66, s66, s65
 WL 6
 Mvva 112,212,228
  v_cmp_gt_u32 vcc, 4, v0
  v_lshlrev_b32 v245, 11, v0
  v_mov_b32 v246, 1
  v_cndmask_b32 v245, -1, v245, vcc
  v_mfma_f32_16x16x32_bf16 v[116:119], v[208:211], a[216:219], 0
 TR 228,32,9632
 Mvva 116,212,232
  buffer_load_dwordx4 a[24:27], v17, s[20:23], s46 offen offset:0 sc1
  v_mfma_f32_16x16x32_bf16 v[120:123], v[208:211], a[220:223], 0
 TR 230,32,10144
 Mvva 120,212,236
  v_mfma_f32_16x16x32_bf16 v[124:127], v[208:211], a[224:227], 0
 TR 208,32,192
 Mvva 124,212,240
 WL 7
 WL 5
  v_mfma_f32_16x16x32_bf16 v[128:131], v[216:219], a[212:215], 0
 TR 210,32,704
  s_add_u32 s44, s44, 147456
 Mvva 128,220,228
  buffer_load_dwordx4 a[28:31], v17, s[20:23], s46 offen offset:2048 sc1
  v_mfma_f32_16x16x32_bf16 v[132:135], v[216:219], a[216:219], 0
 TR 212,32,9664
  s_add_u32 m0, s47, 50176
 Mvva 132,220,232
  v_mfma_f32_16x16x32_bf16 v[136:139], v[216:219], a[220:223], 0
 TR 214,32,10176
 Mvva 136,220,236
  buffer_load_dwordx4 v1, s[12:15], s44 offen lds
  v_mfma_f32_16x16x32_bf16 v[140:143], v[216:219], a[224:227], 0
 TR 216,32,224
 Mvva 140,220,240
 WL 7
  v_mfma_f32_16x16x32_bf16 v[144:147], v[224:227], a[212:215], 0
 TR 218,32,736
 WL 6
 Mvva 144,228,228
  buffer_load_dwordx4 v2, s[12:15], s44 offen offset:1056 lds
  v_mfma_f32_16x16x32_bf16 v[148:151], v[224:227], a[216:219], 0
 TR 220,32,9696
 Mvva 148,228,232
  v_mfma_f32_16x16x32_bf16 v[152:155], v[224:227], a[220:223], 0
 TR 222,32,10208
 Mvva 152,228,236
  v_mfma_f32_16x16x32_bf16 v[156:159], v[224:227], a[224:227], 0
 TR 224,56,0
 WL 7
 Mvva 156,228,240
  buffer_load_dwordx4 v3, s[12:15], s44 offen offset:2112 lds
  v_mfma_f32_16x16x32_bf16 v[160:163], v[208:211], a[212:215], 0
 TR 226,56,512
 WL 6
 Mvva 160,212,228
  v_mfma_f32_16x16x32_bf16 v[164:167], v[208:211], a[216:219], 0
 TR 228,56,9472
 Mvva 164,212,232
  buffer_load_dwordx4 v4, s[12:15], s44 offen offset:3168 lds
  v_mfma_f32_16x16x32_bf16 v[168:171], v[208:211], a[220:223], 0
 TR 230,56,9984
 Mvva 168,212,236
  s_add_u32 m0, s47, 54400
  v_mfma_f32_16x16x32_bf16 v[172:175], v[208:211], a[224:227], 0
 TR 208,32,18944
 WL 7
 Mvva 172,212,240
  buffer_load_dwordx4 v5, s[12:15], s44 offen lds
  v_mfma_f32_16x16x32_bf16 v[176:179], v[216:219], a[212:215], 0
 TR 210,32,19456
 WL 6
 Mvva 176,220,228
  v_mfma_f32_16x16x32_bf16 v[180:183], v[216:219], a[216:219], 0
 TR 212,32,28416
 Mvva 180,220,232
  buffer_load_dwordx4 v6, s[12:15], s44 offen offset:1056 lds
  v_mfma_f32_16x16x32_bf16 v[184:187], v[216:219], a[220:223], 0
 TR 214,32,28928
 Mvva 184,220,236
  v_mfma_f32_16x16x32_bf16 v[188:191], v[216:219], a[224:227], 0
 TR 216,32,18976
 Mvva 188,220,240
 WL 7
  v_mfma_f32_16x16x32_bf16 v[192:195], v[224:227], a[212:215], 0
 TR 218,32,19488
 WL 6
 Mvva 192,228,228
  buffer_load_dwordx4 v7, s[12:15], s44 offen offset:2112 lds
  v_mfma_f32_16x16x32_bf16 v[196:199], v[224:227], a[216:219], 0
 TR 220,32,28448
 Mvva 196,228,232
  v_mfma_f32_16x16x32_bf16 v[200:203], v[224:227], a[220:223], 0
 TR 222,32,28960
  s_waitcnt vmcnt(41)
 Mvva 200,228,236
  buffer_load_dwordx4 v8, s[12:15], s44 offen offset:3168 lds
  v_mfma_f32_16x16x32_bf16 v[204:207], v[224:227], a[224:227], 0
 TR 224,32,19008
 Mvva 204,228,240
  s_add_u32 m0, s47, 58624
 WL 7
 Mvva 64,208,176
 TR 226,32,19520
 WL 6
 Mvva 64,212,192
  buffer_load_dwordx4 v9, s[20:23], s44 offen sc1 lds
 Mvva 68,208,180
 TR 228,32,28480
 Mvva 68,212,196
 Mvva 72,208,184
 TR 230,32,28992
  s_add_u32 s46, s45, 65536
 Mvva 72,212,200
 Mvva 76,208,188
 TR 208,32,19040
 WL 7
 Mvva 76,212,204
  buffer_load_dwordx4 a[32:35], v16, s[20:23], s46 offen offset:0 sc1
 Mvva 80,216,176
 TR 210,32,19552
 WL 6
 Mvva 80,220,192
 Mvva 84,216,180
 TR 212,32,28512
 Mvva 84,220,196
  buffer_load_dwordx4 a[36:39], v16, s[20:23], s46 offen offset:2048 sc1
 Mvva 88,216,184
 TR 214,32,29024
 Mvva 88,220,200
 Mvva 92,216,188
 TR 216,32,19072
 WL 7
 Mvva 92,220,204
  buffer_load_dwordx4 a[40:43], v17, s[20:23], s46 offen offset:0 sc1
 Mvva 96,224,176
 TR 218,32,19584
 WL 6
 Mvva 96,228,192
 Mvva 100,224,180
 TR 220,32,28544
 Mvva 100,228,196
 Mvva 104,224,184
 TR 222,32,29056
 Mvva 104,228,200
  buffer_load_dwordx4 a[44:47], v17, s[20:23], s46 offen offset:2048 sc1
 Mvva 108,224,188
 TR 224,32,19104
  s_add_u32 s46, s45, 73728
 Mvva 108,228,204
 WL 7
 Mvva 112,208,176
 TR 226,32,19616
 WL 6
 Mvva 112,212,192
  buffer_load_dwordx4 a[48:51], v16, s[20:23], s46 offen offset:0 sc1
 Mvva 116,208,180
 TR 228,32,28576
 Mvva 116,212,196
 Mvva 120,208,184
 TR 230,32,29088
 Mvva 120,212,200
  buffer_load_dwordx4 a[52:55], v16, s[20:23], s46 offen offset:2048 sc1
 Mvva 124,208,188
 TR 208,32,19136
 Mvva 124,212,204
 WL 7
 Mvva 128,216,176
 TR 210,32,19648
 WL 6
 Mvva 128,220,192
  buffer_load_dwordx4 a[56:59], v17, s[20:23], s46 offen offset:0 sc1
 Mvva 132,216,180
 TR 212,32,28608
 Mvva 132,220,196
 Mvva 136,216,184
 TR 214,32,29120
 Mvva 136,220,200
 Mvva 140,216,188
 TR 216,32,19168
 WL 7
 Mvva 140,220,204
  buffer_load_dwordx4 a[60:63], v17, s[20:23], s46 offen offset:2048 sc1
 Mvva 144,224,176
 TR 218,32,19680
 WL 6
 Mvva 144,228,192
  s_add_u32 s46, s45, 81920
 Mvva 148,224,180
 TR 220,32,28640
 Mvva 148,228,196
  buffer_load_dwordx4 a[64:67], v16, s[20:23], s46 offen offset:0 sc1
 Mvva 152,224,184
 TR 222,32,29152
 Mvva 152,228,200
 Mvva 156,224,188
 TR 224,56,18944
 WL 7
 Mvva 156,228,204
  buffer_load_dwordx4 a[68:71], v16, s[20:23], s46 offen offset:2048 sc1
 Mvva 160,208,176
 TR 226,56,19456
 WL 6
 Mvva 160,212,192
 Mvva 164,208,180
 TR 228,56,28416
 Mvva 164,212,196
 Mvva 168,208,184
 TR 230,56,28928
 Mvva 168,212,200
  buffer_load_dwordx4 a[72:75], v17, s[20:23], s46 offen offset:0 sc1
 Mvva 172,208,188
 Mvva 172,212,204
 WL 6
 WL 4
 Mvva 176,216,176
  buffer_load_dwordx4 a[76:79], v17, s[20:23], s46 offen offset:2048 sc1
 Mvva 176,220,192
  s_waitcnt vmcnt(30) lgkmcnt(0)
  s_barrier
 Mvva 180,216,180
 TR 208,33,0
 Mvva 180,220,196
 TR 210,33,512
  s_add_u32 s46, s45, 90112
 Mvva 184,216,184
 TR 212,33,9472
 Mvva 184,220,200
 TR 214,33,9984
 Mvva 188,216,188
 TR 216,33,32
 Mvva 188,220,204
  buffer_load_dwordx4 a[80:83], v16, s[20:23], s46 offen offset:0 sc1
 Mvva 192,224,176
 TR 218,33,544
 Mvva 192,228,192
  buffer_store_dword v246, v245, s[20:23], s66 offen sc1
 Mvva 196,224,180
 TR 220,33,9504
  s_lshr_b32 s55, s2, 3
 Mvva 196,228,196
  buffer_load_dwordx4 a[84:87], v16, s[20:23], s46 offen offset:2048 sc1
 Mvva 200,224,184
 TR 222,33,10016
 WL 6
 Mvva 200,228,200
  s_lshl_b32 s55, s55, 2
  s_bfe_u32 s65, s4, 0x20001
  s_add_u32 s55, s55, s65
 Mvva 204,224,188
 TR 224,33,64
  s_lshl_b32 s55, s55, 4
 Mvva 204,228,204
  buffer_load_dwordx4 a[88:91], v17, s[20:23], s46 offen offset:0 sc1
 Mvva 64,208,144
 TR 226,33,576
  s_and_b32 s65, s4, 1
 WL 6
 Mvva 64,212,160
  s_add_u32 s55, s55, s65
  s_mul_i32 s55, s55, 9216
  s_add_u32 s55, s55, 0x4500000
 Mvva 68,208,148
 TR 228,33,9536
  s_and_b32 s65, s4, 7
 Mvva 68,212,164
  buffer_load_dwordx4 a[92:95], v17, s[20:23], s46 offen offset:2048 sc1
 Mvva 72,208,152
 TR 230,33,10048
  s_add_u32 s44, s44, 147456
 Mvva 72,212,168
  s_add_u32 m0, s47, 88064
  s_movk_i32 s50, 8192
  s_movk_i32 s51, 16384
 Mvva 76,208,156
 TR 208,33,96
  s_and_b32 s66, s2, 0xf8
 Mvva 76,212,172
  buffer_load_dwordx4 v1, s[12:15], s44 offen lds
 WL 7
 Mvva 80,216,144
 TR 210,33,608
  s_lshl_b32 s56, s3, 1
 WL 6
 Mvva 80,220,160
  s_add_u32 s66, s66, s56
  s_lshl_b32 s66, s66, 6
  s_add_u32 s66, s66, s65
 Mvva 84,216,148
 TR 212,33,9568
  s_lshl_b32 s66, s66, 2
 Mvva 84,220,164
  s_add_u32 s66, s66, 0x4480020
 Mvva 88,216,152
 TR 214,33,10080
 Mvva 88,220,168
  buffer_load_dwordx4 v2, s[12:15], s44 offen offset:1056 lds
 Mvva 92,216,156
 TR 216,33,128
 WL 5
 Mvva 92,220,172
 WL 7
  v_cmp_gt_u32 vcc, 2, v0
  v_lshlrev_b32 v245, 8, v0
  v_mov_b32 v246, 1
  v_cndmask_b32 v245, -1, v245, vcc
 Mvva 96,224,144
 TR 218,33,640
  s_sub_u32 s56, 15, s5
 Mvva 96,228,160
  buffer_load_dwordx4 v3, s[12:15], s44 offen offset:2112 lds
 Mvva 100,224,148
 TR 220,33,9600
 Mvva 100,228,164
  s_cmp_lt_u32 s65, 4
  s_cselect_b32 s56, s56, s5
  s_lshl_b32 s56, s56, 3
 Mvva 104,224,152
 TR 222,33,10112
  s_bfe_u32 s69, s65, 0x10001
 Mvva 104,228,168
  buffer_load_dwordx4 v4, s[12:15], s44 offen offset:3168 lds
 Mvva 108,224,156
 TR 224,33,160
  s_add_u32 s56, s56, s69
 Mvva 108,228,172
  s_and_b32 s69, s65, 1
  s_lshl_b32 s69, s69, 2
  s_add_u32 s56, s56, s69
 WL 7
 Mvva 112,208,144
 TR 226,33,672
  s_add_u32 m0, s47, 92288
 WL 6
 Mvva 112,212,160
  s_mul_i32 s56, s56, 18432
  s_lshr_b32 s69, s4, 3
  s_mul_i32 s31, s69, 224
 Mvva 116,208,148
 TR 228,33,9632
  s_lshl_b32 s69, s69, 8
 Mvva 116,212,164
  buffer_load_dwordx4 v5, s[12:15], s44 offen lds
 Mvva 120,208,152
 TR 230,33,10144
  s_add_u32 s56, s56, s69
 Mvva 120,212,168
  s_lshl_b32 s69, s3, 10
  v_add_u32 v28, s69, v16
  s_lshl_b32 s69, s3, 8
 Mvva 124,208,156
 TR 208,33,192
  s_add_u32 s69, s69, 4096
 Mvva 124,212,172
  buffer_load_dwordx4 v6, s[12:15], s44 offen offset:1056 lds
 WL 7
 Mvva 128,216,144
 TR 210,33,704
  v_lshl_add_u32 v29, v0, 2, s69
 WL 6
 Mvva 128,220,160
  v_and_b32 v36, 15, v0
  v_mul_u32_u24 v36, 1152, v36
 Mvva 132,216,148
 TR 212,33,9664
  v_lshrrev_b32 v37, 4, v0
 Mvva 132,220,164
  buffer_load_dwordx4 v7, s[12:15], s44 offen offset:2112 lds
 Mvva 136,216,152
 TR 214,33,10176
  v_lshl_add_u32 v36, v37, 3, v36
 Mvva 136,220,168
  s_lshl_b32 s69, s3, 5
  v_add_u32 v30, s69, v36
  v_lshrrev_b32 v36, 2, v0
 Mvva 140,216,156
 TR 216,33,224
  v_bfe_u32 v37, v0, 1, 1
 Mvva 140,220,172
 WL 7
  v_lshl_add_u32 v36, v37, 5, v36
  v_mul_u32_u24 v36, 1152, v36
 Mvva 144,224,144
 TR 218,33,736
  v_and_b32 v37, 1, v0
 WL 6
 Mvva 144,228,160
  buffer_load_dwordx4 v8, s[12:15], s44 offen offset:3168 lds
 Mvva 148,224,148
 TR 220,33,9696
  s_add_u32 m0, s47, 96512
 Mvva 148,228,164
  s_lshl_b32 s69, s3, 3
  s_add_u32 s69, s69, 1024
  v_lshl_add_u32 v36, v37, 2, v36
 Mvva 152,224,152
 TR 222,33,10208
  s_sub_u32 s69, s69, s31
 Mvva 152,228,168
  buffer_load_dwordx4 v9, s[20:23], s44 offen sc1 lds
 Mvva 156,224,156
 TR 224,57,0
  v_add_u32 v31, s69, v36
 Mvva 156,228,172
  s_add_u32 s46, s45, 98304
  s_mov_b32 s57, 0xffff
  s_add_u32 s69, s56, 36864
 WL 7
 Mvva 160,208,144
 TR 226,57,512
 WL 6
 Mvva 160,212,160
  buffer_load_dwordx4 a[96:99], v16, s[20:23], s46 offen offset:0 sc1
 Mvva 164,208,148
 TR 228,57,9472
 Mvva 164,212,164
  buffer_store_dword v246, v245, s[20:23], s66 offen sc1
 Mvva 168,208,152
 TR 230,57,9984
 Mvva 168,212,168
  buffer_load_dwordx4 a[100:103], v16, s[20:23], s46 offen offset:2048 sc1
 Mvva 172,208,156
 TR 208,33,18944
 Mvva 172,212,172
 WL 7
 Mvva 176,216,144
 TR 210,33,19456
 WL 6
 Mvva 176,220,160
 Mvva 180,216,148
 TR 212,33,28416
 Mvva 180,220,164
  buffer_load_dwordx4 a[104:107], v17, s[20:23], s46 offen offset:0 sc1
 Mvva 184,216,152
 TR 214,33,28928
 Mvva 184,220,168
 Mvva 188,216,156
 TR 216,33,18976
 WL 7
 Mvva 188,220,172
  buffer_load_dwordx4 a[108:111], v17, s[20:23], s46 offen offset:2048 sc1
 Mvva 192,224,144
 TR 218,33,19488
 WL 6
 Mvva 192,228,160
  s_add_u32 s46, s45, 106496
 Mvva 196,224,148
 TR 220,33,28448
 Mvva 196,228,164
  buffer_load_dwordx4 a[112:115], v16, s[20:23], s46 offen offset:0 sc1
 Mvva 200,224,152
 TR 222,33,28960
  s_waitcnt vmcnt(41)
 Mvva 200,228,168
 Mvva 204,224,156
 TR 224,33,19008
 Mvva 204,228,172
 WL 7
 Mvva 64,208,0
 TR 226,33,19520
 WL 6
 Mvva 64,212,16
  buffer_load_dwordx4 a[116:119], v16, s[20:23], s46 offen offset:2048 sc1
 Mvva 68,208,4
 TR 228,33,28480
 Mvva 68,212,20
 Mvva 72,208,8
 TR 230,33,28992
 Mvva 72,212,24
  buffer_load_dwordx4 a[120:123], v17, s[20:23], s46 offen offset:0 sc1
 Mvva 76,208,12
 TR 208,33,19040
 Mvva 76,212,28
 WL 7
 Mvva 80,216,0
 TR 210,33,19552
 WL 6
 Mvva 80,220,16
  buffer_load_dwordx4 a[124:127], v17, s[20:23], s46 offen offset:2048 sc1
 Mvva 84,216,4
 TR 212,33,28512
 Mvva 84,220,20
 Mvva 88,216,8
 TR 214,33,29024
  s_add_u32 s46, s45, 114688
 Mvva 88,220,24
 Mvva 92,216,12
 TR 216,33,19072
 WL 7
 Mvva 92,220,28
  buffer_load_dwordx4 a[128:131], v16, s[20:23], s46 offen offset:0 sc1
 Mvva 96,224,0
 TR 218,33,19584
 WL 6
 Mvva 96,228,16
 Mvva 100,224,4
 TR 220,33,28544
 Mvva 100,228,20
  buffer_load_dwordx4 a[132:135], v16, s[20:23], s46 offen offset:2048 sc1
 Mvva 104,224,8
 TR 222,33,29056
 Mvva 104,228,24
 Mvva 108,224,12
 TR 224,33,19104
 WL 7
 Mvva 108,228,28
  buffer_load_dwordx4 a[136:139], v17, s[20:23], s46 offen offset:0 sc1
 Mvva 112,208,0
 TR 226,33,19616
 WL 6
 Mvva 112,212,16
 Mvva 116,208,4
 TR 228,33,28576
 Mvva 116,212,20
  buffer_load_dwordx4 a[140:143], v17, s[20:23], s46 offen offset:2048 sc1
 Mvva 120,208,8
 TR 230,33,29088
 Mvva 120,212,24
 Mvva 124,208,12
 TR 208,33,19136
  s_add_u32 s46, s45, 122880
 Mvva 124,212,28
 WL 7
 Mvva 128,216,0
 TR 210,33,19648
 WL 6
 Mvva 128,220,16
  buffer_load_dwordx4 v[40:43], v16, s[20:23], s46 offen offset:0 sc1
 Mvva 132,216,4
 TR 212,33,28608
 Mvva 132,220,20
 Mvva 136,216,8
 TR 214,33,29120
 Mvva 136,220,24
  buffer_load_dwordx4 v[44:47], v16, s[20:23], s46 offen offset:2048 sc1
 Mvva 140,216,12
 TR 216,33,19168
 Mvva 140,220,28
 WL 7
 Mvva 144,224,0
 TR 218,33,19680
 WL 6
 Mvva 144,228,16
  buffer_load_dwordx4 v[48:51], v17, s[20:23], s46 offen offset:0 sc1
 Mvva 148,224,4
 TR 220,33,28640
 Mvva 148,228,20
 Mvva 152,224,8
 TR 222,33,29152
 Mvva 152,228,24
 WL 6
 WL 4
 Mvva 156,224,12
 TR 224,57,18944
  s_add_u32 s44, s44, 147456
 Mvva 156,228,28
  buffer_load_dwordx4 v[52:55], v17, s[20:23], s46 offen offset:2048 sc1
 Mvva 160,208,0
 TR 226,57,19456
  s_add_u32 m0, s47, 12288
 Mvva 160,212,16
 Mvva 164,208,4
 TR 228,57,28416
 Mvva 164,212,20
  buffer_load_dwordx4 v1, s[12:15], s44 offen lds
 Mvva 168,208,8
 TR 230,57,28928
 Mvva 168,212,24
 Mvva 172,208,12
 WL 6
 Mvva 172,212,28
  buffer_load_dwordx4 v2, s[12:15], s44 offen offset:1056 lds
 Mvva 176,216,0
 WL 4
 Mvva 176,220,16
 WL 0
  s_waitcnt vmcnt(45)
  s_barrier
 Mvva 180,216,4
 TR 208,34,0
 Mvva 180,220,20
 TR 210,34,512
 Mvva 184,216,8
 TR 212,34,9472
 Mvva 184,220,24
 TR 214,34,9984
 Mvva 188,216,12
 TR 216,34,32
 Mvva 188,220,28
  buffer_load_dwordx4 v3, s[12:15], s44 offen offset:2112 lds
 Mvva 192,224,0
 TR 218,34,544
 Mvva 192,228,16
  buffer_load_dwordx4 v4, s[12:15], s44 offen offset:3168 lds
 Mvva 196,224,4
 TR 220,34,9504
 Mvva 196,228,20
  s_add_u32 m0, s47, 16512
 Mvva 200,224,8
 TR 222,34,10016
  s_waitcnt vmcnt(39)
 Mvva 200,228,24
  buffer_load_dwordx4 v5, s[12:15], s44 offen lds
 Mvva 204,224,12
 TR 224,34,64
 Mvva 204,228,28
 WL 7
 Mvva 64,208,32
 TR 226,34,576
 WL 6
 Mvva 64,212,48
  buffer_load_dwordx4 v6, s[12:15], s44 offen offset:1056 lds
 Mvva 68,208,36
 TR 228,34,9536
 Mvva 68,212,52
 Mvva 72,208,40
 TR 230,34,10048
 Mvva 72,212,56
 Mvva 76,208,44
 TR 208,34,96
 WL 7
 Mvva 76,212,60
  buffer_load_dwordx4 v7, s[12:15], s44 offen offset:2112 lds
 Mvva 80,216,32
 TR 210,34,608
 WL 6
 Mvva 80,220,48
 Mvva 84,216,36
 TR 212,34,9568
 Mvva 84,220,52
  buffer_load_dwordx4 v8, s[12:15], s44 offen offset:3168 lds
 Mvva 88,216,40
 TR 214,34,10080
 Mvva 88,220,56
  s_add_u32 m0, s47, 20736
 Mvva 92,216,44
 TR 216,34,128
 WL 7
 Mvva 92,220,60
  buffer_load_dwordx4 v9, s[20:23], s44 offen sc1 lds
 Mvva 96,224,32
 TR 218,34,640
 WL 6
 Mvva 96,228,48
 Mvva 100,224,36
 TR 220,34,9600
  s_add_u32 s46, s45, 131072
 Mvva 100,228,52
 Mvva 104,224,40
 TR 222,34,10112
 Mvva 104,228,56
  buffer_load_dwordx4 a[212:215], v16, s[20:23], s46 offen offset:0 sc1
 Mvva 108,224,44
 TR 224,34,160
 Mvva 108,228,60
 WL 7
 Mvva 112,208,32
 TR 226,34,672
 WL 6
 Mvva 112,212,48
  buffer_load_dwordx4 a[216:219], v16, s[20:23], s46 offen offset:2048 sc1
 Mvva 116,208,36
 TR 228,34,9632
 Mvva 116,212,52
 Mvva 120,208,40
 TR 230,34,10144
 Mvva 120,212,56
  buffer_load_dwordx4 a[220:223], v17, s[20:23], s46 offen offset:0 sc1
 Mvva 124,208,44
 TR 208,34,192
 Mvva 124,212,60
 WL 7
 Mvva 128,216,32
 TR 210,34,704
 WL 6
 Mvva 128,220,48
 Mvva 132,216,36
 TR 212,34,9664
 Mvva 132,220,52
  buffer_load_dwordx4 a[224:227], v17, s[20:23], s46 offen offset:2048 sc1
 Mvva 136,216,40
 TR 214,34,10176
  s_add_u32 s46, s45, 139264
 Mvva 136,220,56
  global_load_dword a248, v249, s[100:101]
 Mvva 140,216,44
 TR 216,34,224
 WL 7
 Mvva 140,220,60
  buffer_load_dwordx4 a[228:231], v16, s[20:23], s46 offen offset:0 sc1
 Mvva 144,224,32
 TR 218,34,736
 WL 6
 Mvva 144,228,48
 Mvva 148,224,36
 TR 220,34,9696
 Mvva 148,228,52
  buffer_load_dwordx4 a[232:235], v16, s[20:23], s46 offen offset:2048 sc1
 Mvva 152,224,40
 TR 222,34,10208
 Mvva 152,228,56
  v_and_b32 v247, 3, v0
  v_lshlrev_b32 v247, 2, v247
 Mvva 156,224,44
 TR 224,58,0
 WL 7
 Mvva 156,228,60
  buffer_load_dwordx4 a[236:239], v17, s[20:23], s46 offen offset:0 sc1
 Mvva 160,208,32
 TR 226,58,512
 WL 6
 Mvva 160,212,48
  buffer_load_dword v248, v247, s[20:23], s54 offen offset:16 sc1
 Mvva 164,208,36
 TR 228,58,9472
 Mvva 164,212,52
 Mvva 168,208,40
 TR 230,58,9984
 Mvva 168,212,56
  buffer_load_dwordx4 a[240:243], v17, s[20:23], s46 offen offset:2048 sc1
 Mvva 172,208,44
 TR 208,34,18944
 Mvva 172,212,60
  s_add_u32 s46, s45, 147456
 WL 7
 Mvva 176,216,32
 TR 210,34,19456
 WL 6
 Mvva 176,220,48
  buffer_load_dwordx4 a[176:179], v16, s[20:23], s46 offen offset:0 sc1
 Mvva 180,216,36
 TR 212,34,28416
 Mvva 180,220,52
 Mvva 184,216,40
 TR 214,34,28928
 Mvva 184,220,56
  buffer_load_dwordx4 a[180:183], v16, s[20:23], s46 offen offset:2048 sc1
 Mvva 188,216,44
 TR 216,34,18976
 Mvva 188,220,60
 WL 7
 Mvva 192,224,32
 TR 218,34,19488
 WL 6
 Mvva 192,228,48
 Mvva 196,224,36
 TR 220,34,28448
 Mvva 196,228,52
  buffer_load_dwordx4 a[184:187], v17, s[20:23], s46 offen offset:0 sc1
 Mvva 200,224,40
 TR 222,34,28960
  s_waitcnt vmcnt(48)
 Mvva 200,228,56
 Mvva 204,224,44
 TR 224,34,19008
 WL 7
 Mvva 204,228,60
  buffer_load_dwordx4 a[188:191], v17, s[20:23], s46 offen offset:2048 sc1
 Mvva 64,208,64
 TR 226,34,19520
 WL 6
 Mvva 64,212,80
  s_add_u32 s46, s45, 155648
 Mvva 68,208,68
 TR 228,34,28480
 Mvva 68,212,84
  buffer_load_dwordx4 a[192:195], v16, s[20:23], s46 offen offset:0 sc1
 Mvva 72,208,72
 TR 230,34,28992
 Mvva 72,212,88
 Mvva 76,208,76
 TR 208,34,19040
 Mvva 76,212,92
 WL 7
 Mvva 80,216,64
 TR 210,34,19552
 WL 6
 Mvva 80,220,80
  buffer_load_dwordx4 a[196:199], v16, s[20:23], s46 offen offset:2048 sc1
 Mvva 84,216,68
 TR 212,34,28512
 Mvva 84,220,84
 Mvva 88,216,72
 TR 214,34,29024
 Mvva 88,220,88
  buffer_load_dwordx4 a[200:203], v17, s[20:23], s46 offen offset:0 sc1
 Mvva 92,216,76
 TR 216,34,19072
 Mvva 92,220,92
  s_mov_b32 s44, s25
 WL 7
 Mvva 96,224,64
 TR 218,34,19584
 WL 6
 Mvva 96,228,80
  buffer_load_dwordx4 a[204:207], v17, s[20:23], s46 offen offset:2048 sc1
 Mvva 100,224,68
 TR 220,34,28544
  v_add_u32 v9, 4096, v9
 Mvva 100,228,84
  s_add_u32 m0, s47, 125952
 Mvva 104,224,72
 TR 222,34,29056
 Mvva 104,228,88
  buffer_load_dwordx4 v1, s[40:43], s44 offen lds
 Mvva 108,224,76
 TR 224,34,19104
 Mvva 108,228,92
 WL 7
 Mvva 112,208,64
 TR 226,34,19616
 WL 6
 Mvva 112,212,80
 Mvva 116,208,68
 TR 228,34,28576
 Mvva 116,212,84
  buffer_load_dwordx4 v2, s[40:43], s44 offen offset:1056 lds
 Mvva 120,208,72
 TR 230,34,29088
 Mvva 120,212,88
 Mvva 124,208,76
 TR 208,34,19136
 WL 7
 Mvva 124,212,92
  buffer_load_dwordx4 v3, s[40:43], s44 offen offset:2112 lds
 Mvva 128,216,64
 TR 210,34,19648
 WL 6
 Mvva 128,220,80
 Mvva 132,216,68
 TR 212,34,28608
 Mvva 132,220,84
  buffer_load_dwordx4 v4, s[40:43], s44 offen offset:3168 lds
 Mvva 136,216,72
 TR 214,34,29120
 Mvva 136,220,88
 Mvva 140,216,76
 TR 216,34,19168
  s_add_u32 m0, s47, 130176
 Mvva 140,220,92
 WL 7
 Mvva 144,224,64
 TR 218,34,19680
 WL 6
 Mvva 144,228,80
  buffer_load_dwordx4 v5, s[40:43], s44 offen lds
 Mvva 148,224,68
 TR 220,34,28640
 Mvva 148,228,84
 Mvva 152,224,72
 TR 222,34,29152
 Mvva 152,228,88
  buffer_load_dwordx4 v6, s[40:43], s44 offen offset:1056 lds
 Mvva 156,224,76
 TR 224,58,18944
 Mvva 156,228,92
 WL 7
 Mvva 160,208,64
 TR 226,58,19456
 WL 6
 Mvva 160,212,80
  buffer_load_dwordx4 v7, s[40:43], s44 offen offset:2112 lds
 Mvva 164,208,68
 TR 228,58,28416
 Mvva 164,212,84
 Mvva 168,208,72
 TR 230,58,28928
 Mvva 168,212,88
 Mvva 172,208,76
  buffer_load_dwordx4 v8, s[40:43], s44 offen offset:3168 lds
 Mvva 172,212,92
 WL 6
 Mvva 176,216,64
  s_add_u32 m0, s47, 134400
 WL 4
 Mvva 176,220,80
 WL 0
  s_waitcnt vmcnt(52)
  s_barrier
 Mvva 180,216,68
 TR 208,35,0
 Mvva 180,220,84
 TR 210,35,512
 Mvva 184,216,72
 TR 212,35,9472
 Mvva 184,220,88
 TR 214,35,9984
 Mvva 188,216,76
 TR 216,35,32
 Mvva 188,220,92
  buffer_load_dwordx4 v9, s[20:23], s44 offen sc1 lds
 Mvva 192,224,64
 TR 218,35,544
 Mvva 192,228,80
  s_waitcnt vmcnt(18)
  v_cmp_gt_u32 vcc, 1, v248
  s_nop 4
  s_cbranch_vccnz Lpoll_ctx_10
Lback_ctx_10:
 Mvva 196,224,68
 TR 220,35,9504
  s_add_u32 s46, s24, 0
 Mvva 196,228,84
  buffer_load_dwordx4 a[144:147], v16, s[20:23], s46 offen offset:0 sc1
 Mvva 200,224,72
 TR 222,35,10016
 Mvva 200,228,88
  buffer_load_dwordx4 a[148:151], v16, s[20:23], s46 offen offset:2048 sc1
 Mvva 204,224,76
 TR 224,35,64
 Mvva 204,228,92
 WL 7
 Mvva 64,208,96
 TR 226,35,576
 WL 6
 Mvva 64,212,112
  buffer_load_dwordx4 a[152:155], v17, s[20:23], s46 offen offset:0 sc1
 Mvva 68,208,100
 TR 228,35,9536
 Mvva 68,212,116
 Mvva 72,208,104
 TR 230,35,10048
 Mvva 72,212,120
  buffer_load_dwordx4 a[156:159], v17, s[20:23], s46 offen offset:2048 sc1
 Mvva 76,208,108
 TR 208,35,96
 Mvva 76,212,124
  s_add_u32 s46, s24, 8192
 WL 7
 Mvva 80,216,96
 TR 210,35,608
 WL 6
 Mvva 80,220,112
  buffer_load_dwordx4 a[160:163], v16, s[20:23], s46 offen offset:0 sc1
 Mvva 84,216,100
 TR 212,35,9568
 Mvva 84,220,116
 Mvva 88,216,104
 TR 214,35,10080
 Mvva 88,220,120
 Mvva 92,216,108
 TR 216,35,128
 WL 7
 Mvva 92,220,124
  buffer_load_dwordx4 a[164:167], v16, s[20:23], s46 offen offset:2048 sc1
 Mvva 96,224,96
 TR 218,35,640
 WL 6
 Mvva 96,228,112
 Mvva 100,224,100
 TR 220,35,9600
 Mvva 100,228,116
  buffer_load_dwordx4 a[168:171], v17, s[20:23], s46 offen offset:0 sc1
 Mvva 104,224,104
 TR 222,35,10112
 Mvva 104,228,120
 Mvva 108,224,108
 TR 224,35,160
 WL 7
 Mvva 108,228,124
  buffer_load_dwordx4 a[172:175], v17, s[20:23], s46 offen offset:2048 sc1
 Mvva 112,208,96
 TR 226,35,672
 WL 6
 Mvva 112,212,112
 Mvva 116,208,100
 TR 228,35,9632
  s_add_u32 s46, s24, 16384
 Mvva 116,212,116
 Mvva 120,208,104
 TR 230,35,10144
 Mvva 120,212,120
  buffer_load_dwordx4 a[0:3], v16, s[20:23], s46 offen offset:0 sc1
 Mvva 124,208,108
 TR 208,35,192
 Mvva 124,212,124
 WL 7
 Mvva 128,216,96
 TR 210,35,704
 WL 6
 Mvva 128,220,112
  buffer_load_dwordx4 a[4:7], v16, s[20:23], s46 offen offset:2048 sc1
 Mvva 132,216,100
 TR 212,35,9664
 Mvva 132,220,116
 Mvva 136,216,104
 TR 214,35,10176
 Mvva 136,220,120
  buffer_load_dwordx4 a[8:11], v17, s[20:23], s46 offen offset:0 sc1
 Mvva 140,216,108
 TR 216,35,224
 Mvva 140,220,124
 WL 7
 Mvva 144,224,96
 TR 218,35,736
 WL 6
 Mvva 144,228,112
  buffer_load_dwordx4 a[12:15], v17, s[20:23], s46 offen offset:2048 sc1
 Mvva 148,224,100
 TR 220,35,9696
 Mvva 148,228,116
 Mvva 152,224,104
 TR 222,35,10208
  s_add_u32 s46, s24, 24576
 Mvva 152,228,120
 Mvva 156,224,108
 TR 224,59,0
 WL 7
 Mvva 156,228,124
  buffer_load_dwordx4 a[16:19], v16, s[20:23], s46 offen offset:0 sc1
 Mvva 160,208,96
 TR 226,59,512
 WL 6
 Mvva 160,212,112
 Mvva 164,208,100
 TR 228,59,9472
 Mvva 164,212,116
  buffer_load_dwordx4 a[20:23], v16, s[20:23], s46 offen offset:2048 sc1
 Mvva 168,208,104
 TR 230,59,9984
 Mvva 168,212,120
 Mvva 172,208,108
 TR 208,35,18944
 WL 7
 Mvva 172,212,124
  buffer_load_dwordx4 a[24:27], v17, s[20:23], s46 offen offset:0 sc1
 Mvva 176,216,96
 TR 210,35,19456
 WL 6
 Mvva 176,220,112
 Mvva 180,216,100
 TR 212,35,28416
 Mvva 180,220,116
 Mvva 184,216,104
 TR 214,35,28928
  s_add_u32 s44, s44, 1179648
 Mvva 184,220,120
  buffer_load_dwordx4 a[28:31], v17, s[20:23], s46 offen offset:2048 sc1
 Mvva 188,216,108
 TR 216,35,18976
  s_add_u32 m0, s47, 50176
 Mvva 188,220,124
 WL 7
 Mvva 192,224,96
 TR 218,35,19488
 WL 6
 Mvva 192,228,112
  buffer_load_dwordx4 v1, s[40:43], s44 offen lds
 Mvva 196,224,100
 TR 220,35,28448
 Mvva 196,228,116
 Mvva 200,224,104
 TR 222,35,28960
 Mvva 200,228,120
  buffer_load_dwordx4 v2, s[40:43], s44 offen offset:1056 lds
 Mvva 204,224,108
 TR 224,35,19008
 Mvva 204,228,124
 WL 7
 Mvva 64,208,128
 TR 226,35,19520
 WL 6
 Mvvv 64,212,40
 Mvva 68,208,132
 TR 228,35,28480
 Mvvv 68,212,44
  buffer_load_dwordx4 v3, s[40:43], s44 offen offset:2112 lds
 Mvva 72,208,136
 TR 230,35,28992
 Mvvv 72,212,48
 Mvva 76,208,140
 TR 208,35,19040
 WL 7
 Mvvv 76,212,52
  buffer_load_dwordx4 v4, s[40:43], s44 offen offset:3168 lds
 Mvva 80,216,128
 TR 210,35,19552
 WL 6
 Mvvv 80,220,40
  s_add_u32 m0, s47, 54400
 Mvva 84,216,132
 TR 212,35,28512
 Mvvv 84,220,44
  buffer_load_dwordx4 v5, s[40:43], s44 offen lds
 Mvva 88,216,136
 TR 214,35,29024
 Mvvv 88,220,48
 Mvva 92,216,140
 TR 216,35,19072
 WL 7
 Mvvv 92,220,52
  buffer_load_dwordx4 v6, s[40:43], s44 offen offset:1056 lds
 Mvva 96,224,128
 TR 218,35,19584
 WL 6
 Mvvv 96,228,40
 Mvva 100,224,132
 TR 220,35,28544
 Mvvv 100,228,44
 Mvva 104,224,136
 TR 222,35,29056
 Mvvv 104,228,48
  buffer_load_dwordx4 v7, s[40:43], s44 offen offset:2112 lds
 Mvva 108,224,140
 TR 224,35,19104
 Mvvv 108,228,52
 WL 7
 Mvva 112,208,128
 TR 226,35,19616
 WL 6
 Mvvv 112,212,40
  buffer_load_dwordx4 v8, s[40:43], s44 offen offset:3168 lds
 Mvva 116,208,132
 TR 228,35,28576
 Mvvv 116,212,44
  s_add_u32 m0, s47, 58624
 Mvva 120,208,136
 TR 230,35,29088
 Mvvv 120,212,48
  buffer_load_dwordx4 v9, s[20:23], s44 offen sc1 lds
 Mvva 124,208,140
 TR 208,35,19136
 Mvvv 124,212,52
 WL 7
 WL 5
 Mvva 128,216,128
 TR 210,35,19648
  s_add_u32 s46, s24, 32768
 Mvvv 128,220,40
 Mvva 132,216,132
 TR 212,35,28608
 Mvvv 132,220,44
  buffer_load_dwordx4 a[32:35], v16, s[20:23], s46 offen offset:0 sc1
 Mvva 136,216,136
 TR 214,35,29120
 Mvvv 136,220,48
 Mvva 140,216,140
 TR 216,35,19168
 WL 7
 Mvvv 140,220,52
  buffer_load_dwordx4 a[36:39], v16, s[20:23], s46 offen offset:2048 sc1
 Mvva 144,224,128
 TR 218,35,19680
 WL 6
 Mvvv 144,228,40
 Mvva 148,224,132
 TR 220,35,28640
 Mvvv 148,228,44
  buffer_load_dwordx4 a[40:43], v17, s[20:23], s46 offen offset:0 sc1
 Mvva 152,224,136
 TR 222,35,29152
 Mvvv 152,228,48
 Mvva 156,224,140
 TR 224,59,18944
 Mvvv 156,228,52
 WL 7
 Mvva 160,208,128
 TR 226,59,19456
 WL 6
 Mvvv 160,212,40
  buffer_load_dwordx4 a[44:47], v17, s[20:23], s46 offen offset:2048 sc1
 Mvva 164,208,132
 TR 228,59,28416
  s_add_u32 s46, s24, 40960
 Mvvv 164,212,44
 Mvva 168,208,136
 TR 230,59,28928
 Mvvv 168,212,48
  buffer_load_dwordx4 a[48:51], v16, s[20:23], s46 offen offset:0 sc1
 Mvva 172,208,140
 Mvvv 172,212,52
 WL 6
 Mvva 176,216,128
 WL 4
 Mvvv 176,220,40
 WL 0
  s_barrier
 Mvva 180,216,132
 TR 208,32,0
 Mvvv 180,220,44
 TR 210,32,512
 Mvva 184,216,136
 TR 212,32,9472
 Mvvv 184,220,48
 TR 214,32,9984
 Mvva 188,216,140
 TR 216,32,32
 Mvvv 188,220,52
  buffer_load_dwordx4 a[52:55], v16, s[20:23], s46 offen offset:2048 sc1
 Mvva 192,224,128
 TR 218,32,544
 Mvvv 192,228,40
  buffer_load_dwordx4 a[56:59], v17, s[20:23], s46 offen offset:0 sc1
 Mvva 196,224,132
 TR 220,32,9504
 Mvvv 196,228,44
  buffer_load_dwordx4 a[60:63], v17, s[20:23], s46 offen offset:2048 sc1
 Mvva 200,224,136
 TR 222,32,10016
  s_waitcnt vmcnt(50)
 Mvvv 200,228,48
  s_add_u32 s44, s44, 1179648
  s_add_u32 m0, s47, 88064
 Mvva 204,224,140
 TR 224,32,64
 WL 7
 Mvvv 204,228,52
  buffer_load_dwordx4 v1, s[40:43], s44 offen lds
 Mvva 64,208,212
 TR 226,32,576
 WL 6
 Mvva 64,212,228
 Mvva 68,208,216
 TR 228,32,9536
 Mvva 68,212,232
  buffer_load_dwordx4 v2, s[40:43], s44 offen offset:1056 lds
 Mvva 72,208,220
 TR 230,32,10048
 Mvva 72,212,236
 Mvva 76,208,224
 TR 208,32,96
 Mvva 76,212,240
 WL 7
 Mvva 80,216,212
 TR 210,32,608
 WL 6
 Mvva 80,220,228
  buffer_load_dwordx4 v3, s[40:43], s44 offen offset:2112 lds
 Mvva 84,216,216
 TR 212,32,9568
 Mvva 84,220,232
 Mvva 88,216,220
 TR 214,32,10080
 Mvva 88,220,236
  buffer_load_dwordx4 v4, s[40:43], s44 offen offset:3168 lds
 Mvva 92,216,224
 TR 216,32,128
 Mvva 92,220,240
  s_add_u32 m0, s47, 92288
 WL 7
 Mvva 96,224,212
 TR 218,32,640
 WL 6
 Mvva 96,228,228
  buffer_load_dwordx4 v5, s[40:43], s44 offen lds
 Mvva 100,224,216
 TR 220,32,9600
 Mvva 100,228,232
 Mvva 104,224,220
 TR 222,32,10112
 Mvva 104,228,236
 Mvva 108,224,224
 TR 224,32,160
 WL 7
 Mvva 108,228,240
  buffer_load_dwordx4 v6, s[40:43], s44 offen offset:1056 lds
 Mvva 112,208,212
 TR 226,32,672
 WL 6
 Mvva 112,212,228
 Mvva 116,208,216
 TR 228,32,9632
 Mvva 116,212,232
  buffer_load_dwordx4 v7, s[40:43], s44 offen offset:2112 lds
 Mvva 120,208,220
 TR 230,32,10144
 Mvva 120,212,236
 Mvva 124,208,224
 TR 208,32,192
 WL 7
 Mvva 124,212,240
  buffer_load_dwordx4 v8, s[40:43], s44 offen offset:3168 lds
 Mvva 128,216,212
 TR 210,32,704
 WL 6
 Mvva 128,220,228
  s_add_u32 m0, s47, 96512
 Mvva 132,216,216
 TR 212,32,9664
 Mvva 132,220,232
  buffer_load_dwordx4 v9, s[20:23], s44 offen sc1 lds
 Mvva 136,216,220
 TR 214,32,10176
 Mvva 136,220,236
 Mvva 140,216,224
 TR 216,32,224
  s_add_u32 s46, s24, 49152
 Mvva 140,220,240
 WL 7
 Mvva 144,224,212
 TR 218,32,736
 WL 6
 Mvva 144,228,228
  buffer_load_dwordx4 a[64:67], v16, s[20:23], s46 offen offset:0 sc1
 Mvva 148,224,216
 TR 220,32,9696
 Mvva 148,228,232
 Mvva 152,224,220
 TR 222,32,10208
 Mvva 152,228,236
  buffer_load_dwordx4 a[68:71], v16, s[20:23], s46 offen offset:2048 sc1
 Mvva 156,224,224
 TR 224,56,0
 Mvva 156,228,240
 WL 7
 Mvva 160,208,212
 TR 226,56,512
 WL 6
 Mvva 160,212,228
  buffer_load_dwordx4 a[72:75], v17, s[20:23], s46 offen offset:0 sc1
 Mvva 164,208,216
 TR 228,56,9472
 Mvva 164,212,232
 Mvva 168,208,220
 TR 230,56,9984
 Mvva 168,212,236
 WL 4
 Mvva 172,208,224
 TR 208,32,18944
 WL 7
 Mvva 172,212,240
  buffer_load_dwordx4 a[76:79], v17, s[20:23], s46 offen offset:2048 sc1
 Mvva 176,216,212
 TR 210,32,19456
  s_add_u32 s46, s24, 57344
 Mvva 176,220,228
 Mvva 180,216,216
 TR 212,32,28416
 Mvva 180,220,232
  buffer_load_dwordx4 a[80:83], v16, s[20:23], s46 offen offset:0 sc1
 Mvva 184,216,220
 TR 214,32,28928
 Mvva 184,220,236
 Mvva 188,216,224
 TR 216,32,18976
 WL 7
 Mvva 188,220,240
  buffer_load_dwordx4 a[84:87], v16, s[20:23], s46 offen offset:2048 sc1
 Mvva 192,224,212
 TR 218,32,19488
 WL 6
 Mvva 192,228,228
 Mvva 196,224,216
 TR 220,32,28448
 Mvva 196,228,232
 Mvva 200,224,220
 TR 222,32,28960
  s_waitcnt vmcnt(57)
 Mvva 200,228,236
  buffer_load_dwordx4 a[88:91], v17, s[20:23], s46 offen offset:0 sc1
 Mvva 204,224,224
 TR 224,32,19008
 Mvva 204,228,240
 WL 7
 Mvva 64,208,176
 TR 226,32,19520
 WL 6
 Mvva 64,212,192
  buffer_load_dwordx4 a[92:95], v17, s[20:23], s46 offen offset:2048 sc1
 Mvva 68,208,180
 TR 228,32,28480
 Mvva 68,212,196
  global_load_dword a248, v249, s[100:101]
 Mvva 72,208,184
 TR 230,32,28992
  s_add_u32 s46, s24, 65536
 Mvva 72,212,200
  buffer_load_dwordx4 a[96:99], v16, s[20:23], s46 offen offset:0 sc1
 Mvva 76,208,188
 TR 208,32,19040
 Mvva 76,212,204
 WL 7
 Mvva 80,216,176
 TR 210,32,19552
 WL 6
 Mvva 80,220,192
  buffer_load_dwordx4 a[100:103], v16, s[20:23], s46 offen offset:2048 sc1
 Mvva 84,216,180
 TR 212,32,28512
 Mvva 84,220,196
 Mvva 88,216,184
 TR 214,32,29024
 Mvva 88,220,200
 Mvva 92,216,188
 TR 216,32,19072
 WL 7
 Mvva 92,220,204
  buffer_load_dwordx4 a[104:107], v17, s[20:23], s46 offen offset:0 sc1
 Mvva 96,224,176
 TR 218,32,19584
 WL 6
 Mvva 96,228,192
 Mvva 100,224,180
 TR 220,32,28544
 Mvva 100,228,196
  buffer_load_dwordx4 a[108:111], v17, s[20:23], s46 offen offset:2048 sc1
 Mvva 104,224,184
 TR 222,32,29056
 Mvva 104,228,200
  s_add_u32 s46, s24, 73728
 Mvva 108,224,188
 TR 224,32,19104
 WL 7
 Mvva 108,228,204
  buffer_load_dwordx4 a[112:115], v16, s[20:23], s46 offen offset:0 sc1
 Mvva 112,208,176
 TR 226,32,19616
 WL 6
 Mvva 112,212,192
 Mvva 116,208,180
 TR 228,32,28576
 Mvva 116,212,196
 Mvva 120,208,184
 TR 230,32,29088
 Mvva 120,212,200
  buffer_load_dwordx4 a[116:119], v16, s[20:23], s46 offen offset:2048 sc1
 Mvva 124,208,188
 TR 208,32,19136
 Mvva 124,212,204
 WL 7
 Mvva 128,216,176
 TR 210,32,19648
 WL 6
 Mvva 128,220,192
  buffer_load_dwordx4 a[120:123], v17, s[20:23], s46 offen offset:0 sc1
 Mvva 132,216,180
 TR 212,32,28608
 Mvva 132,220,196
 Mvva 136,216,184
 TR 214,32,29120
 Mvva 136,220,200
  buffer_load_dwordx4 a[124:127], v17, s[20:23], s46 offen offset:2048 sc1
 Mvva 140,216,188
 TR 216,32,19168
 Mvva 140,220,204
 WL 7
 WL 5
 Mvva 144,224,176
 TR 218,32,19680
  s_add_u32 s46, s24, 81920
 Mvva 144,228,192
 Mvva 148,224,180
 TR 220,32,28640
 Mvva 148,228,196
  buffer_load_dwordx4 a[128:131], v16, s[20:23], s46 offen offset:0 sc1
 Mvva 152,224,184
 TR 222,32,29152
 Mvva 152,228,200
 Mvva 156,224,188
 TR 224,56,18944
 WL 7
 Mvva 156,228,204
  buffer_load_dwordx4 a[132:135], v16, s[20:23], s46 offen offset:2048 sc1
 Mvva 160,208,176
 TR 226,56,19456
 WL 6
 Mvva 160,212,192
 Mvva 164,208,180
 TR 228,56,28416
 Mvva 164,212,196
  buffer_load_dwordx4 a[136:139], v17, s[20:23], s46 offen offset:0 sc1
 Mvva 168,208,184
 TR 230,56,28928
 Mvva 168,212,200
 Mvva 172,208,188
 WL 6
 Mvva 172,212,204
  buffer_load_dwordx4 a[140:143], v17, s[20:23], s46 offen offset:2048 sc1
 Mvva 176,216,176
 WL 4
 Mvva 176,220,192
 WL 0
  s_waitcnt vmcnt(62)
  s_barrier
 Mvva 180,216,180
 TR 208,33,0
  s_add_u32 s44, s44, 1179648
 Mvva 180,220,196
 TR 210,33,512
  s_add_u32 m0, s47, 12288
 Mvva 184,216,184
 TR 212,33,9472
 Mvva 184,220,200
 TR 214,33,9984
 Mvva 188,216,188
 TR 216,33,32
 Mvva 188,220,204
  buffer_load_dwordx4 v1, s[40:43], s44 offen lds
 Mvva 192,224,176
 TR 218,33,544
 Mvva 192,228,192
  buffer_load_dwordx4 v2, s[40:43], s44 offen offset:1056 lds
 Mvva 196,224,180
 TR 220,33,9504
 Mvva 196,228,196
 Mvva 200,224,184
 TR 222,33,10016
  s_waitcnt vmcnt(57)
 Mvva 200,228,200
  buffer_load_dwordx4 v3, s[40:43], s44 offen offset:2112 lds
 Mvva 204,224,188
 TR 224,33,64
 Mvva 204,228,204
 WL 7
 Mvva 64,208,144
 TR 226,33,576
 WL 6
 Mvva 64,212,160
 Mvva 68,208,148
 TR 228,33,9536
 Mvva 68,212,164
  buffer_load_dwordx4 v4, s[40:43], s44 offen offset:3168 lds
 Mvva 72,208,152
 TR 230,33,10048
  s_add_u32 m0, s47, 16512
 Mvva 72,212,168
 Mvva 76,208,156
 TR 208,33,96
 WL 7
 Mvva 76,212,172
  buffer_load_dwordx4 v5, s[40:43], s44 offen lds
 Mvva 80,216,144
 TR 210,33,608
 WL 6
 Mvva 80,220,160
 Mvva 84,216,148
 TR 212,33,9568
 Mvva 84,220,164
  buffer_load_dwordx4 v6, s[40:43], s44 offen offset:1056 lds
 Mvva 88,216,152
 TR 214,33,10080
 Mvva 88,220,168
 Mvva 92,216,156
 TR 216,33,128
 Mvva 92,220,172
 WL 7
 Mvva 96,224,144
 TR 218,33,640
 WL 6
 Mvva 96,228,160
  buffer_load_dwordx4 v7, s[40:43], s44 offen offset:2112 lds
 Mvva 100,224,148
 TR 220,33,9600
 Mvva 100,228,164
 Mvva 104,224,152
 TR 222,33,10112
 Mvva 104,228,168
  buffer_load_dwordx4 v8, s[40:43], s44 offen offset:3168 lds
 Mvva 108,224,156
 TR 224,33,160
 Mvva 108,228,172
  s_add_u32 m0, s47, 20736
 WL 7
 Mvva 112,208,144
 TR 226,33,672
 WL 6
 Mvva 112,212,160
  buffer_load_dwordx4 v9, s[20:23], s44 offen sc1 lds
 Mvva 116,208,148
 TR 228,33,9632
 Mvva 116,212,164
  s_add_u32 s46, s24, 90112
 Mvva 120,208,152
 TR 230,33,10144
 Mvva 120,212,168
  buffer_load_dwordx4 v[40:43], v16, s[20:23], s46 offen offset:0 sc1
 Mvva 124,208,156
 TR 208,33,192
 Mvva 124,212,172
 WL 7
 Mvva 128,216,144
 TR 210,33,704
 WL 6
 Mvva 128,220,160
 Mvva 132,216,148
 TR 212,33,9664
 Mvva 132,220,164
  buffer_load_dwordx4 v[44:47], v16, s[20:23], s46 offen offset:2048 sc1
 Mvva 136,216,152
 TR 214,33,10176
 Mvva 136,220,168
 Mvva 140,216,156
 TR 216,33,224
 WL 7
 Mvva 140,220,172
  buffer_load_dwordx4 v[48:51], v17, s[20:23], s46 offen offset:0 sc1
 Mvva 144,224,144
 TR 218,33,736
 WL 6
 Mvva 144,228,160
 Mvva 148,224,148
 TR 220,33,9696
 Mvva 148,228,164
  buffer_load_dwordx4 v[52:55], v17, s[20:23], s46 offen offset:2048 sc1
 Mvva 152,224,152
 TR 222,33,10208
 Mvva 152,228,168
 Mvva 156,224,156
 TR 224,57,0
  s_add_u32 s46, s24, 98304
 Mvva 156,228,172
 WL 7
 Mvva 160,208,144
 TR 226,57,512
 WL 6
 Mvva 160,212,160
  buffer_load_dwordx4 a[212:215], v16, s[20:23], s46 offen offset:0 sc1
 Mvva 164,208,148
 TR 228,57,9472
 Mvva 164,212,164
 Mvva 168,208,152
 TR 230,57,9984
 Mvva 168,212,168
  buffer_load_dwordx4 a[216:219], v16, s[20:23], s46 offen offset:2048 sc1
 Mvva 172,208,156
 TR 208,33,18944
 Mvva 172,212,172
 WL 7
 Mvva 176,216,144
 TR 210,33,19456
 WL 6
 Mvva 176,220,160
  buffer_load_dwordx4 a[220:223], v17, s[20:23], s46 offen offset:0 sc1
 Mvva 180,216,148
 TR 212,33,28416
 Mvva 180,220,164
 Mvva 184,216,152
 TR 214,33,28928
 Mvva 184,220,168
 WL 4
 Mvva 188,216,156
 TR 216,33,18976
 WL 7
 Mvva 188,220,172
  buffer_load_dwordx4 a[224:227], v17, s[20:23], s46 offen offset:2048 sc1
 Mvva 192,224,144
 TR 218,33,19488
  s_add_u32 s46, s24, 106496
 Mvva 192,228,160
 Mvva 196,224,148
 TR 220,33,28448
 Mvva 196,228,164
  buffer_load_dwordx4 a[228:231], v16, s[20:23], s46 offen offset:0 sc1
 Mvva 200,224,152
 TR 222,33,28960
  s_waitcnt vmcnt(62)
 Mvva 200,228,168
 Mvva 204,224,156
 TR 224,33,19008
 WL 7
 Mvva 204,228,172
  buffer_load_dwordx4 a[232:235], v16, s[20:23], s46 offen offset:2048 sc1
 Mvva 64,208,0
 TR 226,33,19520
 WL 6
 Mvva 64,212,16
 Mvva 68,208,4
 TR 228,33,28480
 Mvva 68,212,20
  buffer_load_dwordx4 a[236:239], v17, s[20:23], s46 offen offset:0 sc1
 Mvva 72,208,8
 TR 230,33,28992
 Mvva 72,212,24
 Mvva 76,208,12
 TR 208,33,19040
 Mvva 76,212,28
 WL 7
 Mvva 80,216,0
 TR 210,33,19552
 WL 6
 Mvva 80,220,16
  buffer_load_dwordx4 a[240:243], v17, s[20:23], s46 offen offset:2048 sc1
 Mvva 84,216,4
 TR 212,33,28512
 Mvva 84,220,20
  s_add_u32 s46, s24, 114688
 Mvva 88,216,8
 TR 214,33,29024
 Mvva 88,220,24
  buffer_load_dwordx4 a[176:179], v16, s[20:23], s46 offen offset:0 sc1
 Mvva 92,216,12
 TR 216,33,19072
 Mvva 92,220,28
 WL 7
 Mvva 96,224,0
 TR 218,33,19584
 WL 6
 Mvva 96,228,16
  buffer_load_dwordx4 a[180:183], v16, s[20:23], s46 offen offset:2048 sc1
 Mvva 100,224,4
 TR 220,33,28544
 Mvva 100,228,20
 Mvva 104,224,8
 TR 222,33,29056
 Mvva 104,228,24
 Mvva 108,224,12
 TR 224,33,19104
 WL 7
 Mvva 108,228,28
  buffer_load_dwordx4 a[184:187], v17, s[20:23], s46 offen offset:0 sc1
 Mvva 112,208,0
 TR 226,33,19616
 WL 6
 Mvva 112,212,16
 Mvva 116,208,4
 TR 228,33,28576
 Mvva 116,212,20
  buffer_load_dwordx4 a[188:191], v17, s[20:23], s46 offen offset:2048 sc1
 Mvva 120,208,8
 TR 230,33,29088
 Mvva 120,212,24
  s_add_u32 s46, s24, 122880
 Mvva 124,208,12
 TR 208,33,19136
 WL 7
 Mvva 124,212,28
  buffer_load_dwordx4 a[192:195], v16, s[20:23], s46 offen offset:0 sc1
 Mvva 128,216,0
 TR 210,33,19648
 WL 6
 Mvva 128,220,16
 Mvva 132,216,4
 TR 212,33,28608
 Mvva 132,220,20
 Mvva 136,216,8
 TR 214,33,29120
 Mvva 136,220,24
  buffer_load_dwordx4 a[196:199], v16, s[20:23], s46 offen offset:2048 sc1
 Mvva 140,216,12
 TR 216,33,19168
 Mvva 140,220,28
 WL 7
 Mvva 144,224,0
 TR 218,33,19680
 WL 6
 Mvva 144,228,16
  buffer_load_dwordx4 a[200:203], v17, s[20:23], s46 offen offset:0 sc1
 Mvva 148,224,4
 TR 220,33,28640
 Mvva 148,228,20
 Mvva 152,224,8
 TR 222,33,29152
 Mvva 152,228,24
  buffer_load_dwordx4 a[204:207], v17, s[20:23], s46 offen offset:2048 sc1
 Mvva 156,224,12
 TR 224,57,18944
 Mvva 156,228,28
 WL 7
 Mvva 160,208,0
 TR 226,57,19456
 WL 6
 Mvva 160,212,16
 Mvva 164,208,4
 TR 228,57,28416
 Mvva 164,212,20
 Mvva 168,208,8
 TR 230,57,28928
 Mvva 168,212,24
 Mvva 172,208,12
 Mvva 172,212,28
 WL 6
 Mvva 176,216,0
 WL 4
 Mvva 176,220,16
 WL 0
  s_waitcnt vmcnt(62)
  s_barrier
 Mvva 180,216,4
 TR 208,34,0
 Mvva 180,220,20
 TR 210,34,512
 Mvva 184,216,8
 TR 212,34,9472
 Mvva 184,220,24
 TR 214,34,9984
 Mvva 188,216,12
 TR 216,34,18944
 Mvva 188,220,28
 Mvva 192,224,0
 TR 218,34,19456
 Mvva 192,228,16
 Mvva 196,224,4
 TR 220,34,28416
 Mvva 196,228,20
 Mvva 200,224,8
 TR 222,34,28928
  s_waitcnt vmcnt(59)
 Mvva 200,228,24
 Mvva 204,224,12
 Mvva 204,228,28
 WL 6
 Mvva 64,208,32
 WL 4
 Mvva 64,212,48
 WL 0
  s_waitcnt vmcnt(50)
  s_barrier
 Mvva 68,208,36
 TR 224,35,0
 Mvva 68,212,52
 TR 226,35,512
 Mvva 72,208,40
 TR 228,35,9472
  s_waitcnt vmcnt(42)
 Mvva 72,212,56
 TR 230,35,9984
 Mvva 76,208,44
 TR 208,35,18944
 Mvva 76,212,60
 Mvva 64,216,64
 TR 210,35,19456
 Mvva 64,220,80
 Mvva 68,216,68
 TR 212,35,28416
 Mvva 68,220,84
 Mvva 72,216,72
 TR 214,35,28928
  s_waitcnt vmcnt(33)
 Mvva 72,220,88
 Mvva 76,216,76
 Mvva 76,220,92
 WL 6
 Mvva 64,224,96
 WL 4
 Mvva 64,228,112
 WL 0
  s_waitcnt vmcnt(20)
  s_barrier
 Mvva 68,224,100
 TR 216,32,0
 Mvva 68,228,116
 TR 218,32,512
 Mvva 72,224,104
 TR 220,32,9472
  s_waitcnt vmcnt(16)
 Mvva 72,228,120
 TR 222,32,9984
 Mvva 76,224,108
 TR 224,32,18944
 Mvva 76,228,124
 Mvva 64,208,128
 TR 226,32,19456
 Mvvv 64,212,40
 Mvva 68,208,132
 TR 228,32,28416
 Mvvv 68,212,44
 Mvva 72,208,136
 TR 230,32,28928
  s_waitcnt vmcnt(8)
 Mvvv 72,212,48
 Mvva 76,208,140
 TR 208,34,32
 Mvvv 76,212,52
 WL 7
 Mvva 64,216,212
 TR 210,34,544
 WL 6
 Mvva 64,220,228
 Mvva 68,216,216
 TR 212,34,9504
 Mvva 68,220,232
 Mvva 72,216,220
 TR 214,34,10016
  s_waitcnt vmcnt(0)
 Mvva 72,220,236
 Mvva 76,216,224
 TR 216,34,18976
 Mvva 76,220,240
 WL 7
 WL 5
 Mvva 64,224,176
 TR 218,34,19488
  v_and_b32 v247, 7, v0
 Mvva 64,228,192
  v_lshlrev_b32 v247, 2, v247
 Mvva 68,224,180
 TR 220,34,28448
 Mvva 68,228,196
  buffer_load_dword v248, v247, s[20:23], s54 offen offset:32 sc1
 Mvva 72,224,184
 TR 222,34,28960
 Mvva 72,228,200
  global_load_dword a248, v249, s[100:101]
 Mvva 76,224,188
 TR 224,35,32
 Mvva 76,228,204
 WL 7
 WL 5
 Mvva 80,208,32
 TR 226,35,544
  v_cvt_pk_bf16_f32 v64, v64, v65
 Mvva 80,212,48
  v_cvt_pk_bf16_f32 v65, v66, v67
  v_cvt_pk_bf16_f32 v66, v68, v69
 Mvva 84,208,36
 TR 228,35,9504
  v_cvt_pk_bf16_f32 v67, v70, v71
 Mvva 84,212,52
  v_min_u32 v64, -2, v64
  v_min_u32 v65, -2, v65
 Mvva 88,208,40
 TR 230,35,10016
  v_min_u32 v66, -2, v66
 Mvva 88,212,56
  v_min_u32 v67, -2, v67
 WL 4
 Mvva 92,208,44
 TR 208,35,18976
 WL 7
 Mvva 92,212,60
  buffer_store_dwordx4 v[64:67], v16, s[8:11], 0 offen offset:0 sc1
 Mvva 80,216,64
 TR 210,35,19488
  v_cvt_pk_bf16_f32 v72, v72, v73
 Mvva 80,220,80
  v_cvt_pk_bf16_f32 v73, v74, v75
  v_cvt_pk_bf16_f32 v74, v76, v77
 Mvva 84,216,68
 TR 212,35,28448
  v_cvt_pk_bf16_f32 v75, v78, v79
 Mvva 84,220,84
  v_min_u32 v72, -2, v72
  v_min_u32 v73, -2, v73
 Mvva 88,216,72
 TR 214,35,28960
  v_min_u32 v74, -2, v74
 Mvva 88,220,88
  v_min_u32 v75, -2, v75
 Mvva 92,216,76
 TR 216,32,32
 WL 7
 Mvva 92,220,92
  buffer_store_dwordx4 v[72:75], v16, s[8:11], s50 offen offset:1024 sc1
 Mvva 80,224,96
 TR 218,32,544
 WL 6
 Mvva 80,228,112
 Mvva 84,224,100
 TR 220,32,9504
 Mvva 84,228,116
 Mvva 88,224,104
 TR 222,32,10016
 Mvva 88,228,120
 Mvva 92,224,108
 TR 224,32,18976
 Mvva 92,228,124
 WL 7
 Mvva 80,208,128
 TR 226,32,19488
 WL 6
 Mvvv 80,212,40
 Mvva 84,208,132
 TR 228,32,28448
 Mvvv 84,212,44
 Mvva 88,208,136
 TR 230,32,28960
 Mvvv 88,212,48
 Mvva 92,208,140
 TR 208,34,64
 Mvvv 92,212,52
 WL 7
 Mvva 80,216,212
 TR 210,34,576
 WL 6
 Mvva 80,220,228
 Mvva 84,216,216
 TR 212,34,9536
 Mvva 84,220,232
 Mvva 88,216,220
 TR 214,34,10048
 Mvva 88,220,236
 Mvva 92,216,224
 TR 216,34,19008
 Mvva 92,220,240
 WL 7
 Mvva 80,224,176
 TR 218,34,19520
 WL 6
 Mvva 80,228,192
 Mvva 84,224,180
 TR 220,34,28480
 Mvva 84,228,196
 Mvva 88,224,184
 TR 222,34,28992
 Mvva 88,228,200
 Mvva 92,224,188
 TR 224,35,64
 Mvva 92,228,204
 WL 7
 WL 5
 Mvva 96,208,32
 TR 226,35,576
  v_cvt_pk_bf16_f32 v80, v80, v81
 Mvva 96,212,48
  v_cvt_pk_bf16_f32 v81, v82, v83
  v_cvt_pk_bf16_f32 v82, v84, v85
 Mvva 100,208,36
 TR 228,35,9536
  v_cvt_pk_bf16_f32 v83, v86, v87
 Mvva 100,212,52
  v_min_u32 v80, -2, v80
  v_min_u32 v81, -2, v81
 Mvva 104,208,40
 TR 230,35,10048
  v_min_u32 v82, -2, v82
 Mvva 104,212,56
  v_min_u32 v83, -2, v83
 WL 4
 Mvva 108,208,44
 TR 208,35,19008
 WL 7
 Mvva 108,212,60
  buffer_store_dwordx4 v[80:83], v16, s[8:11], 0 offen offset:1024 sc1
 Mvva 96,216,64
 TR 210,35,19520
  v_cvt_pk_bf16_f32 v88, v88, v89
 Mvva 96,220,80
  v_cvt_pk_bf16_f32 v89, v90, v91
  v_cvt_pk_bf16_f32 v90, v92, v93
 Mvva 100,216,68
 TR 212,35,28480
  v_cvt_pk_bf16_f32 v91, v94, v95
 Mvva 100,220,84
  v_min_u32 v88, -2, v88
  v_min_u32 v89, -2, v89
 Mvva 104,216,72
 TR 214,35,28992
  v_min_u32 v90, -2, v90
 Mvva 104,220,88
  v_min_u32 v91, -2, v91
 Mvva 108,216,76
 TR 216,32,64
 WL 7
 Mvva 108,220,92
  buffer_store_dwordx4 v[88:91], v16, s[8:11], s50 offen offset:2048 sc1
 Mvva 96,224,96
 TR 218,32,576
 WL 6
 Mvva 96,228,112
 Mvva 100,224,100
 TR 220,32,9536
 Mvva 100,228,116
 Mvva 104,224,104
 TR 222,32,10048
 Mvva 104,228,120
 Mvva 108,224,108
 TR 224,32,19008
 Mvva 108,228,124
 WL 7
 Mvva 96,208,128
 TR 226,32,19520
 WL 6
 Mvvv 96,212,40
 Mvva 100,208,132
 TR 228,32,28480
 Mvvv 100,212,44
 Mvva 104,208,136
 TR 230,32,28992
 Mvvv 104,212,48
 Mvva 108,208,140
 TR 208,34,96
 Mvvv 108,212,52
 WL 7
 Mvva 96,216,212
 TR 210,34,608
 WL 6
 Mvva 96,220,228
 Mvva 100,216,216
 TR 212,34,9568
 Mvva 100,220,232
 Mvva 104,216,220
 TR 214,34,10080
  v_mov_b32 v246, 2
 Mvva 104,220,236
 Mvva 108,216,224
 TR 216,34,19040
 Mvva 108,220,240
 WL 7
 Mvva 96,224,176
 TR 218,34,19552
 WL 6
 Mvva 96,228,192
 Mvva 100,224,180
 TR 220,34,28512
 Mvva 100,228,196
 Mvva 104,224,184
 TR 222,34,29024
 Mvva 104,228,200
 Mvva 108,224,188
 TR 224,35,96
 Mvva 108,228,204
 WL 7
 WL 5
 Mvva 112,208,32
 TR 226,35,608
  v_cvt_pk_bf16_f32 v96, v96, v97
 Mvva 112,212,48
  v_cvt_pk_bf16_f32 v97, v98, v99
  v_cvt_pk_bf16_f32 v98, v100, v101
 Mvva 116,208,36
 TR 228,35,9568
  v_cvt_pk_bf16_f32 v99, v102, v103
 Mvva 116,212,52
  v_min_u32 v96, -2, v96
  v_min_u32 v97, -2, v97
 Mvva 120,208,40
 TR 230,35,10080
  v_min_u32 v98, -2, v98
 Mvva 120,212,56
  v_min_u32 v99, -2, v99
 WL 4
 Mvva 124,208,44
 TR 208,35,19040
 WL 7
 Mvva 124,212,60
  buffer_store_dwordx4 v[96:99], v16, s[8:11], 0 offen offset:2048 sc1
 Mvva 112,216,64
 TR 210,35,19552
  v_cvt_pk_bf16_f32 v104, v104, v105
 Mvva 112,220,80
  v_cvt_pk_bf16_f32 v105, v106, v107
  v_cvt_pk_bf16_f32 v106, v108, v109
 Mvva 116,216,68
 TR 212,35,28512
  v_cvt_pk_bf16_f32 v107, v110, v111
 Mvva 116,220,84
  v_min_u32 v104, -2, v104
  v_min_u32 v105, -2, v105
 Mvva 120,216,72
 TR 214,35,29024
  v_min_u32 v106, -2, v106
 Mvva 120,220,88
  v_min_u32 v107, -2, v107
 Mvva 124,216,76
 TR 216,32,96
 WL 7
 Mvva 124,220,92
  buffer_store_dwordx4 v[104:107], v16, s[8:11], s50 offen offset:3072 sc1
 Mvva 112,224,96
 TR 218,32,608
 WL 6
 Mvva 112,228,112
 Mvva 116,224,100
 TR 220,32,9568
 Mvva 116,228,116
 Mvva 120,224,104
 TR 222,32,10080
 Mvva 120,228,120
 Mvva 124,224,108
 TR 224,32,19040
 Mvva 124,228,124
 WL 7
 Mvva 112,208,128
 TR 226,32,19552
 WL 6
 Mvvv 112,212,40
 Mvva 116,208,132
 TR 228,32,28512
 Mvvv 116,212,44
 Mvva 120,208,136
 TR 230,32,29024
 Mvvv 120,212,48
 Mvva 124,208,140
 TR 208,34,128
 Mvvv 124,212,52
 WL 7
 Mvva 112,216,212
 TR 210,34,640
 WL 6
 Mvva 112,220,228
 Mvva 116,216,216
 TR 212,34,9600
 Mvva 116,220,232
 Mvva 120,216,220
 TR 214,34,10112
 Mvva 120,220,236
 Mvva 124,216,224
 TR 216,34,19072
 Mvva 124,220,240
 WL 7
 Mvva 112,224,176
 TR 218,34,19584
 WL 6
 Mvva 112,228,192
 Mvva 116,224,180
 TR 220,34,28544
 Mvva 116,228,196
 Mvva 120,224,184
 TR 222,34,29056
 Mvva 120,228,200
 Mvva 124,224,188
 TR 224,35,128
 Mvva 124,228,204
 WL 7
 WL 5
 Mvva 128,208,32
 TR 226,35,640
  v_cvt_pk_bf16_f32 v112, v112, v113
 Mvva 128,212,48
  v_cvt_pk_bf16_f32 v113, v114, v115
  v_cvt_pk_bf16_f32 v114, v116, v117
 Mvva 132,208,36
 TR 228,35,9600
  v_cvt_pk_bf16_f32 v115, v118, v119
 Mvva 132,212,52
  v_min_u32 v112, -2, v112
  v_min_u32 v113, -2, v113
 Mvva 136,208,40
 TR 230,35,10112
  v_min_u32 v114, -2, v114
 Mvva 136,212,56
  v_min_u32 v115, -2, v115
 WL 4
 Mvva 140,208,44
 TR 208,35,19072
 WL 7
 Mvva 140,212,60
  buffer_store_dwordx4 v[112:115], v16, s[8:11], 0 offen offset:3072 sc1
 Mvva 128,216,64
 TR 210,35,19584
  v_cvt_pk_bf16_f32 v120, v120, v121
 Mvva 128,220,80
  v_cvt_pk_bf16_f32 v121, v122, v123
  v_cvt_pk_bf16_f32 v122, v124, v125
 Mvva 132,216,68
 TR 212,35,28544
  v_cvt_pk_bf16_f32 v123, v126, v127
 Mvva 132,220,84
  v_min_u32 v120, -2, v120
  v_min_u32 v121, -2, v121
 Mvva 136,216,72
 TR 214,35,29056
  v_min_u32 v122, -2, v122
 Mvva 136,220,88
  v_min_u32 v123, -2, v123
 Mvva 140,216,76
 TR 216,32,128
 WL 7
 Mvva 140,220,92
  buffer_store_dwordx4 v[120:123], v17, s[8:11], s50 offen offset:0 sc1
 Mvva 128,224,96
 TR 218,32,640
 WL 6
 Mvva 128,228,112
 Mvva 132,224,100
 TR 220,32,9600
 Mvva 132,228,116
 Mvva 136,224,104
 TR 222,32,10112
 Mvva 136,228,120
 Mvva 140,224,108
 TR 224,32,19072
 Mvva 140,228,124
 WL 7
 Mvva 128,208,128
 TR 226,32,19584
 WL 6
 Mvvv 128,212,40
 Mvva 132,208,132
 TR 228,32,28544
 Mvvv 132,212,44
 Mvva 136,208,136
 TR 230,32,29056
 Mvvv 136,212,48
 Mvva 140,208,140
 TR 208,34,160
 Mvvv 140,212,52
 WL 7
 Mvva 128,216,212
 TR 210,34,672
 WL 6
 Mvva 128,220,228
 Mvva 132,216,216
 TR 212,34,9632
 Mvva 132,220,232
 Mvva 136,216,220
 TR 214,34,10144
 Mvva 136,220,236
 Mvva 140,216,224
 TR 216,34,19104
 Mvva 140,220,240
 WL 7
 Mvva 128,224,176
 TR 218,34,19616
 WL 6
 Mvva 128,228,192
 Mvva 132,224,180
 TR 220,34,28576
 Mvva 132,228,196
 Mvva 136,224,184
 TR 222,34,29088
 Mvva 136,228,200
 Mvva 140,224,188
 TR 224,35,160
 Mvva 140,228,204
 WL 7
 WL 5
 Mvva 144,208,32
 TR 226,35,672
  v_cvt_pk_bf16_f32 v128, v128, v129
 Mvva 144,212,48
  v_cvt_pk_bf16_f32 v129, v130, v131
  v_cvt_pk_bf16_f32 v130, v132, v133
 Mvva 148,208,36
 TR 228,35,9632
  v_cvt_pk_bf16_f32 v131, v134, v135
 Mvva 148,212,52
  v_min_u32 v128, -2, v128
  v_min_u32 v129, -2, v129
 Mvva 152,208,40
 TR 230,35,10144
  v_min_u32 v130, -2, v130
 Mvva 152,212,56
  v_min_u32 v131, -2, v131
 WL 4
 Mvva 156,208,44
 TR 208,35,19104
 WL 7
 Mvva 156,212,60
  buffer_store_dwordx4 v[128:131], v17, s[8:11], 0 offen offset:0 sc1
 Mvva 144,216,64
 TR 210,35,19616
  v_cvt_pk_bf16_f32 v136, v136, v137
 Mvva 144,220,80
  v_cvt_pk_bf16_f32 v137, v138, v139
  v_cvt_pk_bf16_f32 v138, v140, v141
 Mvva 148,216,68
 TR 212,35,28576
  v_cvt_pk_bf16_f32 v139, v142, v143
 Mvva 148,220,84
  v_min_u32 v136, -2, v136
  v_min_u32 v137, -2, v137
 Mvva 152,216,72
 TR 214,35,29088
  v_min_u32 v138, -2, v138
 Mvva 152,220,88
  v_min_u32 v139, -2, v139
 Mvva 156,216,76
 TR 216,32,160
 WL 7
 Mvva 156,220,92
  buffer_store_dwordx4 v[136:139], v17, s[8:11], s50 offen offset:1024 sc1
 Mvva 144,224,96
 TR 218,32,672
 WL 6
 Mvva 144,228,112
 Mvva 148,224,100
 TR 220,32,9632
 Mvva 148,228,116
 Mvva 152,224,104
 TR 222,32,10144
 Mvva 152,228,120
 Mvva 156,224,108
 TR 224,32,19104
 Mvva 156,228,124
 WL 7
 Mvva 144,208,128
 TR 226,32,19616
 WL 6
 Mvvv 144,212,40
 Mvva 148,208,132
 TR 228,32,28576
 Mvvv 148,212,44
 Mvva 152,208,136
 TR 230,32,29088
 Mvvv 152,212,48
 Mvva 156,208,140
 TR 208,34,192
 Mvvv 156,212,52
 WL 7
 Mvva 144,216,212
 TR 210,34,704
 WL 6
 Mvva 144,220,228
 Mvva 148,216,216
 TR 212,34,9664
 Mvva 148,220,232
 Mvva 152,216,220
 TR 214,34,10176
 Mvva 152,220,236
 Mvva 156,216,224
 TR 216,34,19136
 Mvva 156,220,240
 WL 7
 Mvva 144,224,176
 TR 218,34,19648
 WL 6
 Mvva 144,228,192
 Mvva 148,224,180
 TR 220,34,28608
 Mvva 148,228,196
 Mvva 152,224,184
 TR 222,34,29120
 Mvva 152,228,200
 Mvva 156,224,188
 TR 224,35,192
 Mvva 156,228,204
 WL 7
 WL 5
 Mvva 160,208,32
 TR 226,35,704
  v_cvt_pk_bf16_f32 v144, v144, v145
 Mvva 160,212,48
  v_cvt_pk_bf16_f32 v145, v146, v147
  v_cvt_pk_bf16_f32 v146, v148, v149
 Mvva 164,208,36
 TR 228,35,9664
  v_cvt_pk_bf16_f32 v147, v150, v151
 Mvva 164,212,52
  v_min_u32 v144, -2, v144
  v_min_u32 v145, -2, v145
 Mvva 168,208,40
 TR 230,35,10176
  v_min_u32 v146, -2, v146
 Mvva 168,212,56
  v_min_u32 v147, -2, v147
 WL 4
 Mvva 172,208,44
 TR 208,35,19136
 WL 7
 Mvva 172,212,60
  buffer_store_dwordx4 v[144:147], v17, s[8:11], 0 offen offset:1024 sc1
 Mvva 160,216,64
 TR 210,35,19648
  v_cvt_pk_bf16_f32 v152, v152, v153
 Mvva 160,220,80
  v_cvt_pk_bf16_f32 v153, v154, v155
  v_cvt_pk_bf16_f32 v154, v156, v157
 Mvva 164,216,68
 TR 212,35,28608
  v_cvt_pk_bf16_f32 v155, v158, v159
 Mvva 164,220,84
  s_waitcnt vmcnt(12)
  v_cmp_gt_u32 vcc, 1, v248
  s_nop 4
  s_cbranch_vccnz Lpoll_pz_10
Lback_pz_10:
 Mvva 168,216,72
 TR 214,35,29120
  v_min_u32 v152, -2, v152
 Mvva 168,220,88
 WL 6
  v_min_u32 v153, -2, v153
  v_min_u32 v154, -2, v154
 Mvva 172,216,76
 TR 216,32,192
  v_min_u32 v155, -2, v155
 Mvva 172,220,92
  buffer_store_dwordx4 v[152:155], v17, s[8:11], s50 offen offset:2048 sc1
 Mvva 160,224,96
 TR 218,32,704
  s_add_u32 s46, s55, 0
 WL 6
 Mvva 160,228,112
  buffer_load_dwordx4 v[64:67], v28, s[20:23], s46 offen sc1
 Mvva 164,224,100
 TR 220,32,9664
 Mvva 164,228,116
 Mvva 168,224,104
 TR 222,32,10176
 Mvva 168,228,120
 Mvva 172,224,108
 TR 224,32,19136
 Mvva 172,228,124
 WL 7
 WL 5
 Mvva 160,208,128
 TR 226,32,19648
  s_add_u32 s46, s55, 18432
 Mvvv 160,212,40
  buffer_load_dwordx4 v[68:71], v28, s[20:23], s46 offen sc1
 Mvva 164,208,132
 TR 228,32,28608
 Mvvv 164,212,44
  v_mov_b32 v128, 0
  v_mov_b32 v129, 0
 Mvva 168,208,136
 TR 230,32,29120
  v_mov_b32 v130, 0
 Mvvv 168,212,48
 WL 4
  v_mov_b32 v131, 0
  v_mov_b32 v132, 0
 Mvva 172,208,140
 TR 208,34,224
  v_mov_b32 v133, 0
 Mvvv 172,212,52
 WL 7
  v_mov_b32 v134, 0
  v_mov_b32 v135, 0
 Mvva 160,216,212
 TR 210,34,736
  v_mov_b32 v136, 0
 Mvva 160,220,228
  v_mov_b32 v137, 0
  v_mov_b32 v138, 0
 Mvva 164,216,216
 TR 212,34,9696
  s_add_u32 s46, s55, 36864
 Mvva 164,220,232
  buffer_load_dwordx4 v[72:75], v28, s[20:23], s46 offen sc1
 Mvva 168,216,220
 TR 214,34,10208
  v_mov_b32 v139, 0
 Mvva 168,220,236
 WL 4
  v_mov_b32 v140, 0
  v_mov_b32 v141, 0
 Mvva 172,216,224
 TR 216,34,19168
  v_mov_b32 v142, 0
 Mvva 172,220,240
 WL 7
  v_mov_b32 v143, 0
  v_mov_b32 v144, 0
 Mvva 160,224,176
 TR 218,34,19680
  v_mov_b32 v145, 0
 Mvva 160,228,192
 Mvva 164,224,180
 TR 220,34,28640
 Mvva 164,228,196
 Mvva 168,224,184
 TR 222,34,29152
  s_add_u32 s46, s55, 55296
 Mvva 168,228,200
  buffer_load_dwordx4 v[76:79], v28, s[20:23], s46 offen sc1
 Mvva 172,224,188
 TR 224,35,224
 Mvva 172,228,204
 WL 7
 WL 5
 Mvva 176,208,32
 TR 226,35,736
  v_cvt_pk_bf16_f32 v160, v160, v161
 Mvva 176,212,48
  v_cvt_pk_bf16_f32 v161, v162, v163
  v_cvt_pk_bf16_f32 v162, v164, v165
 Mvva 180,208,36
 TR 228,35,9696
  v_cvt_pk_bf16_f32 v163, v166, v167
 Mvva 180,212,52
  v_min_u32 v160, -2, v160
  v_min_u32 v161, -2, v161
 Mvva 184,208,40
 TR 230,35,10208
  v_min_u32 v162, -2, v162
 Mvva 184,212,56
 WL 4
  v_min_u32 v163, -2, v163
 WL 6
 Mvva 188,208,44
 TR 208,35,19168
  s_add_u32 s46, s55, 73728
 Mvva 188,212,60
  buffer_store_dwordx4 v[160:163], v17, s[8:11], 0 offen offset:2048 sc1
 Mvva 176,216,64
 TR 210,35,19680
  v_cvt_pk_bf16_f32 v168, v168, v169
 Mvva 176,220,80
  buffer_load_dwordx4 v[80:83], v28, s[20:23], s46 offen sc1
 Mvva 180,216,68
 TR 212,35,28640
  v_cvt_pk_bf16_f32 v169, v170, v171
 Mvva 180,220,84
  v_cvt_pk_bf16_f32 v170, v172, v173
  v_cvt_pk_bf16_f32 v171, v174, v175
 Mvva 184,216,72
 TR 214,35,29152
  v_min_u32 v168, -2, v168
 Mvva 184,220,88
 WL 6
  v_min_u32 v169, -2, v169
  v_min_u32 v170, -2, v170
 Mvva 188,216,76
 TR 216,32,224
  v_min_u32 v171, -2, v171
 Mvva 188,220,92
  buffer_store_dwordx4 v[168:171], v17, s[8:11], s50 offen offset:3072 sc1
 Mvva 176,224,96
 TR 218,32,736
  s_add_u32 s46, s55, 92160
 WL 6
 Mvva 176,228,112
  buffer_load_dwordx4 v[84:87], v28, s[20:23], s46 offen sc1
 Mvva 180,224,100
 TR 220,32,9696
 Mvva 180,228,116
 Mvva 184,224,104
 TR 222,32,10208
 Mvva 184,228,120
 Mvva 188,224,108
 TR 224,32,19168
 Mvva 188,228,124
 WL 7
 Mvva 176,208,128
 TR 226,32,19680
 WL 6
 Mvvv 176,212,40
 Mvva 180,208,132
 TR 228,32,28640
  s_add_u32 s46, s55, 110592
 Mvvv 180,212,44
  buffer_load_dword v248, v247, s[20:23], s54 offen offset:32 sc1
 Mvva 184,208,136
 TR 230,32,29152
 Mvvv 184,212,48
  buffer_load_dwordx4 v[88:91], v28, s[20:23], s46 offen sc1
 Mvva 188,208,140
 TR 208,58,0
 Mvvv 188,212,52
 WL 7
 Mvva 176,216,212
 TR 210,58,512
 WL 6
 Mvva 176,220,228
 Mvva 180,216,216
 TR 212,58,9472
 Mvva 180,220,232
 Mvva 184,216,220
 TR 214,58,9984
  s_add_u32 s46, s55, 129024
 Mvva 184,220,236
  buffer_load_dwordx4 v[92:95], v28, s[20:23], s46 offen sc1
 Mvva 188,216,224
 TR 216,58,18944
 Mvva 188,220,240
 WL 7
 Mvva 176,224,176
 TR 218,58,19456
 WL 6
 Mvva 176,228,192
 Mvva 180,224,180
 TR 220,58,28416
 Mvva 180,228,196
 Mvva 184,224,184
 TR 222,58,28928
 Mvva 184,228,200
 Mvva 188,224,188
 TR 224,59,0
 Mvva 188,228,204
 WL 7
 WL 5
 Mvva 192,208,32
 TR 226,59,512
  v_cvt_pk_bf16_f32 v176, v176, v177
 Mvva 192,212,48
  v_cvt_pk_bf16_f32 v177, v178, v179
  v_cvt_pk_bf16_f32 v178, v180, v181
 Mvva 196,208,36
 TR 228,59,9472
  v_cvt_pk_bf16_f32 v179, v182, v183
 Mvva 196,212,52
  v_min_u32 v176, -2, v176
  v_min_u32 v177, -2, v177
 Mvva 200,208,40
 TR 230,59,9984
  v_min_u32 v178, -2, v178
 Mvva 200,212,56
  v_min_u32 v179, -2, v179
 WL 4
 Mvva 204,208,44
 TR 208,59,18944
 WL 7
 Mvva 204,212,60
  buffer_store_dwordx4 v[176:179], v17, s[8:11], 0 offen offset:3072 sc1
 Mvva 192,216,64
 TR 210,59,19456
  v_cvt_pk_bf16_f32 v184, v184, v185
 Mvva 192,220,80
  buffer_store_dword v246, v245, s[20:23], s66 offen sc1
 Mvva 196,216,68
 TR 212,59,28416
  v_cvt_pk_bf16_f32 v185, v186, v187
 Mvva 196,220,84
  v_cvt_pk_bf16_f32 v186, v188, v189
  v_cvt_pk_bf16_f32 v187, v190, v191
 Mvva 200,216,72
 TR 214,59,28928
  v_min_u32 v184, -2, v184
 Mvva 200,220,88
 WL 6
  v_min_u32 v185, -2, v185
  v_min_u32 v186, -2, v186
 Mvva 204,216,76
 TR 216,56,0
  v_min_u32 v187, -2, v187
 Mvva 204,220,92
  buffer_store_dwordx4 v[184:187], v16, s[8:11], s51 offen offset:0 sc1
 Mvva 192,224,96
 TR 218,56,512
 WL 6
 Mvva 192,228,112
 Mvva 196,224,100
 TR 220,56,9472
 Mvva 196,228,116
 Mvva 200,224,104
 TR 222,56,9984
 Mvva 200,228,120
 Mvva 204,224,108
 TR 224,56,18944
 Mvva 204,228,124
 WL 7
 Mvva 192,208,128
 TR 226,56,19456
 WL 6
 Mvvv 192,212,40
 Mvva 196,208,132
 TR 228,56,28416
 Mvvv 196,212,44
 Mvva 200,208,136
 TR 230,56,28928
 Mvvv 200,212,48
 Mvva 204,208,140
 Mvvv 204,212,52
 WL 6
 Mvva 192,216,212
 WL 4
 Mvva 192,220,228
 Mvva 196,216,216
 Mvva 196,220,232
 Mvva 200,216,220
 Mvva 200,220,236
 Mvva 204,216,224
 Mvva 204,220,240
 WL 2
 Mvva 192,224,176
 WL 0
 Mvva 192,228,192
 Mvva 196,224,180
 Mvva 196,228,196
 Mvva 200,224,184
 Mvva 200,228,200
 Mvva 204,224,188
 Mvva 204,228,204
  s_nop 1
  v_cvt_pk_bf16_f32 v192, v192, v193
  v_cvt_pk_bf16_f32 v193, v194, v195
  v_cvt_pk_bf16_f32 v194, v196, v197
  v_cvt_pk_bf16_f32 v195, v198, v199
  v_min_u32 v192, -2, v192
  v_min_u32 v193, -2, v193
  v_min_u32 v194, -2, v194
  v_min_u32 v195, -2, v195
  buffer_store_dwordx4 v[192:195], v16, s[8:11], s50 offen offset:0 sc1
  v_cvt_pk_bf16_f32 v200, v200, v201
  v_cvt_pk_bf16_f32 v201, v202, v203
  v_cvt_pk_bf16_f32 v202, v204, v205
  v_cvt_pk_bf16_f32 v203, v206, v207
  v_min_u32 v200, -2, v200
  v_min_u32 v201, -2, v201
  v_min_u32 v202, -2, v202
  v_min_u32 v203, -2, v203
  buffer_store_dwordx4 v[200:203], v16, s[8:11], s51 offen offset:1024 sc1
  s_waitcnt vmcnt(7)
  v_cmp_gt_u32 vcc, 2, v248
  s_nop 4
  s_cbranch_vccnz Lpoll_red_10
Lback_red_10:
  s_add_u32 s46, s55, 4096
  buffer_load_dwordx4 v[96:99], v28, s[20:23], s46 offen sc1
  buffer_load_dword v232, v29, s[20:23], s46 offen sc1
  s_add_u32 s46, s55, 22528
  buffer_load_dwordx4 v[100:103], v28, s[20:23], s46 offen sc1
  buffer_load_dword v233, v29, s[20:23], s46 offen sc1
  s_add_u32 s46, s55, 40960
  buffer_load_dwordx4 v[104:107], v28, s[20:23], s46 offen sc1
  buffer_load_dword v234, v29, s[20:23], s46 offen sc1
  s_add_u32 s46, s55, 59392
  buffer_load_dwordx4 v[108:111], v28, s[20:23], s46 offen sc1
  buffer_load_dword v235, v29, s[20:23], s46 offen sc1
  s_add_u32 s46, s55, 77824
  buffer_load_dwordx4 v[112:115], v28, s[20:23], s46 offen sc1
  buffer_load_dword v236, v29, s[20:23], s46 offen sc1
  s_add_u32 s46, s55, 96256
  buffer_load_dwordx4 v[116:119], v28, s[20:23], s46 offen sc1
  buffer_load_dword v237, v29, s[20:23], s46 offen sc1
  s_add_u32 s46, s55, 114688
  buffer_load_dwordx4 v[120:123], v28, s[20:23], s46 offen sc1
  buffer_load_dword v238, v29, s[20:23], s46 offen sc1
  s_add_u32 s46, s55, 133120
  buffer_load_dwordx4 v[124:127], v28, s[20:23], s46 offen sc1
  buffer_load_dword v239, v29, s[20:23], s46 offen sc1
  s_load_dwordx2 s[16:17], s[0:1], 80
  s_mov_b32 s18, 0x240000
  s_mov_b32 s19, 0x00020000
Lchk_10:
  s_bitcmp1_b32 s57, 0
  s_cbranch_scc0 Lskip0_10
  v_max3_u32 v36, v64, v65, v66
  v_max3_u32 v36, v36, v67, v67
  v_cmp_eq_u32 vcc, -1, v36
  s_nop 4
  s_cbranch_vccnz Lskip0_10
  v_lshlrev_b32 v36, 16, v64
  v_and_b32 v37, 0xffff0000, v64
  v_pk_add_f32 v[128:129], v[128:129], v[36:37]
  v_lshlrev_b32 v36, 16, v65
  v_and_b32 v37, 0xffff0000, v65
  v_pk_add_f32 v[130:131], v[130:131], v[36:37]
  v_lshlrev_b32 v36, 16, v66
  v_and_b32 v37, 0xffff0000, v66
  v_pk_add_f32 v[132:133], v[132:133], v[36:37]
  v_lshlrev_b32 v36, 16, v67
  v_and_b32 v37, 0xffff0000, v67
  v_pk_add_f32 v[134:135], v[134:135], v[36:37]
  s_bitset0_b32 s57, 0
Lskip0_10:
  s_bitcmp1_b32 s57, 1
  s_cbranch_scc0 Lskip1_10
  v_max3_u32 v36, v68, v69, v70
  v_max3_u32 v36, v36, v71, v71
  v_cmp_eq_u32 vcc, -1, v36
  s_nop 4
  s_cbranch_vccnz Lskip1_10
  v_lshlrev_b32 v36, 16, v68
  v_and_b32 v37, 0xffff0000, v68
  v_pk_add_f32 v[128:129], v[128:129], v[36:37]
  v_lshlrev_b32 v36, 16, v69
  v_and_b32 v37, 0xffff0000, v69
  v_pk_add_f32 v[130:131], v[130:131], v[36:37]
  v_lshlrev_b32 v36, 16, v70
  v_and_b32 v37, 0xffff0000, v70
  v_pk_add_f32 v[132:133], v[132:133], v[36:37]
  v_lshlrev_b32 v36, 16, v71
  v_and_b32 v37, 0xffff0000, v71
  v_pk_add_f32 v[134:135], v[134:135], v[36:37]
  s_bitset0_b32 s57, 1
Lskip1_10:
  s_bitcmp1_b32 s57, 2
  s_cbranch_scc0 Lskip2_10
  v_max3_u32 v36, v72, v73, v74
  v_max3_u32 v36, v36, v75, v75
  v_cmp_eq_u32 vcc, -1, v36
  s_nop 4
  s_cbranch_vccnz Lskip2_10
  v_lshlrev_b32 v36, 16, v72
  v_and_b32 v37, 0xffff0000, v72
  v_pk_add_f32 v[128:129], v[128:129], v[36:37]
  v_lshlrev_b32 v36, 16, v73
  v_and_b32 v37, 0xffff0000, v73
  v_pk_add_f32 v[130:131], v[130:131], v[36:37]
  v_lshlrev_b32 v36, 16, v74
  v_and_b32 v37, 0xffff0000, v74
  v_pk_add_f32 v[132:133], v[132:133], v[36:37]
  v_lshlrev_b32 v36, 16, v75
  v_and_b32 v37, 0xffff0000, v75
  v_pk_add_f32 v[134:135], v[134:135], v[36:37]
  s_bitset0_b32 s57, 2
Lskip2_10:
  s_bitcmp1_b32 s57, 3
  s_cbranch_scc0 Lskip3_10
  v_max3_u32 v36, v76, v77, v78
  v_max3_u32 v36, v36, v79, v79
  v_cmp_eq_u32 vcc, -1, v36
  s_nop 4
  s_cbranch_vccnz Lskip3_10
  v_lshlrev_b32 v36, 16, v76
  v_and_b32 v37, 0xffff0000, v76
  v_pk_add_f32 v[128:129], v[128:129], v[36:37]
  v_lshlrev_b32 v36, 16, v77
  v_and_b32 v37, 0xffff0000, v77
  v_pk_add_f32 v[130:131], v[130:131], v[36:37]
  v_lshlrev_b32 v36, 16, v78
  v_and_b32 v37, 0xffff0000, v78
  v_pk_add_f32 v[132:133], v[132:133], v[36:37]
  v_lshlrev_b32 v36, 16, v79
  v_and_b32 v37, 0xffff0000, v79
  v_pk_add_f32 v[134:135], v[134:135], v[36:37]
  s_bitset0_b32 s57, 3
Lskip3_10:
  s_bitcmp1_b32 s57, 4
  s_cbranch_scc0 Lskip4_10
  v_max3_u32 v36, v80, v81, v82
  v_max3_u32 v36, v36, v83, v83
  v_cmp_eq_u32 vcc, -1, v36
  s_nop 4
  s_cbranch_vccnz Lskip4_10
  v_lshlrev_b32 v36, 16, v80
  v_and_b32 v37, 0xffff0000, v80
  v_pk_add_f32 v[128:129], v[128:129], v[36:37]
  v_lshlrev_b32 v36, 16, v81
  v_and_b32 v37, 0xffff0000, v81
  v_pk_add_f32 v[130:131], v[130:131], v[36:37]
  v_lshlrev_b32 v36, 16, v82
  v_and_b32 v37, 0xffff0000, v82
  v_pk_add_f32 v[132:133], v[132:133], v[36:37]
  v_lshlrev_b32 v36, 16, v83
  v_and_b32 v37, 0xffff0000, v83
  v_pk_add_f32 v[134:135], v[134:135], v[36:37]
  s_bitset0_b32 s57, 4
Lskip4_10:
  s_bitcmp1_b32 s57, 5
  s_cbranch_scc0 Lskip5_10
  v_max3_u32 v36, v84, v85, v86
  v_max3_u32 v36, v36, v87, v87
  v_cmp_eq_u32 vcc, -1, v36
  s_nop 4
  s_cbranch_vccnz Lskip5_10
  v_lshlrev_b32 v36, 16, v84
  v_and_b32 v37, 0xffff0000, v84
  v_pk_add_f32 v[128:129], v[128:129], v[36:37]
  v_lshlrev_b32 v36, 16, v85
  v_and_b32 v37, 0xffff0000, v85
  v_pk_add_f32 v[130:131], v[130:131], v[36:37]
  v_lshlrev_b32 v36, 16, v86
  v_and_b32 v37, 0xffff0000, v86
  v_pk_add_f32 v[132:133], v[132:133], v[36:37]
  v_lshlrev_b32 v36, 16, v87
  v_and_b32 v37, 0xffff0000, v87
  v_pk_add_f32 v[134:135], v[134:135], v[36:37]
  s_bitset0_b32 s57, 5
Lskip5_10:
  s_bitcmp1_b32 s57, 6
  s_cbranch_scc0 Lskip6_10
  s_waitcnt vmcnt(22)
  v_max3_u32 v36, v88, v89, v90
  v_max3_u32 v36, v36, v91, v91
  v_cmp_eq_u32 vcc, -1, v36
  s_nop 4
  s_cbranch_vccnz Lskip6_10
  v_lshlrev_b32 v36, 16, v88
  v_and_b32 v37, 0xffff0000, v88
  v_pk_add_f32 v[128:129], v[128:129], v[36:37]
  v_lshlrev_b32 v36, 16, v89
  v_and_b32 v37, 0xffff0000, v89
  v_pk_add_f32 v[130:131], v[130:131], v[36:37]
  v_lshlrev_b32 v36, 16, v90
  v_and_b32 v37, 0xffff0000, v90
  v_pk_add_f32 v[132:133], v[132:133], v[36:37]
  v_lshlrev_b32 v36, 16, v91
  v_and_b32 v37, 0xffff0000, v91
  v_pk_add_f32 v[134:135], v[134:135], v[36:37]
  s_bitset0_b32 s57, 6
Lskip6_10:
  s_bitcmp1_b32 s57, 7
  s_cbranch_scc0 Lskip7_10
  s_waitcnt vmcnt(21)
  v_max3_u32 v36, v92, v93, v94
  v_max3_u32 v36, v36, v95, v95
  v_cmp_eq_u32 vcc, -1, v36
  s_nop 4
  s_cbranch_vccnz Lskip7_10
  v_lshlrev_b32 v36, 16, v92
  v_and_b32 v37, 0xffff0000, v92
  v_pk_add_f32 v[128:129], v[128:129], v[36:37]
  v_lshlrev_b32 v36, 16, v93
  v_and_b32 v37, 0xffff0000, v93
  v_pk_add_f32 v[130:131], v[130:131], v[36:37]
  v_lshlrev_b32 v36, 16, v94
  v_and_b32 v37, 0xffff0000, v94
  v_pk_add_f32 v[132:133], v[132:133], v[36:37]
  v_lshlrev_b32 v36, 16, v95
  v_and_b32 v37, 0xffff0000, v95
  v_pk_add_f32 v[134:135], v[134:135], v[36:37]
  s_bitset0_b32 s57, 7
Lskip7_10:
  s_bitcmp1_b32 s57, 8
  s_cbranch_scc0 Lskip8_10
  s_waitcnt vmcnt(15)
  v_max3_u32 v36, v96, v97, v98
  s_waitcnt vmcnt(14)
  v_max3_u32 v36, v36, v99, v232
  v_cmp_eq_u32 vcc, -1, v36
  s_nop 4
  s_cbranch_vccnz Lskip8_10
  v_lshlrev_b32 v36, 16, v96
  v_and_b32 v37, 0xffff0000, v96
  v_pk_add_f32 v[136:137], v[136:137], v[36:37]
  v_lshlrev_b32 v36, 16, v97
  v_and_b32 v37, 0xffff0000, v97
  v_pk_add_f32 v[138:139], v[138:139], v[36:37]
  v_lshlrev_b32 v36, 16, v98
  v_and_b32 v37, 0xffff0000, v98
  v_pk_add_f32 v[140:141], v[140:141], v[36:37]
  v_lshlrev_b32 v36, 16, v99
  v_and_b32 v37, 0xffff0000, v99
  v_pk_add_f32 v[142:143], v[142:143], v[36:37]
  v_lshlrev_b32 v36, 16, v232
  v_and_b32 v37, 0xffff0000, v232
  v_pk_add_f32 v[144:145], v[144:145], v[36:37]
  s_bitset0_b32 s57, 8
Lskip8_10:
  s_bitcmp1_b32 s57, 9
  s_cbranch_scc0 Lskip9_10
  s_waitcnt vmcnt(13)
  v_max3_u32 v36, v100, v101, v102
  s_waitcnt vmcnt(12)
  v_max3_u32 v36, v36, v103, v233
  v_cmp_eq_u32 vcc, -1, v36
  s_nop 4
  s_cbranch_vccnz Lskip9_10
  v_lshlrev_b32 v36, 16, v100
  v_and_b32 v37, 0xffff0000, v100
  v_pk_add_f32 v[136:137], v[136:137], v[36:37]
  v_lshlrev_b32 v36, 16, v101
  v_and_b32 v37, 0xffff0000, v101
  v_pk_add_f32 v[138:139], v[138:139], v[36:37]
  v_lshlrev_b32 v36, 16, v102
  v_and_b32 v37, 0xffff0000, v102
  v_pk_add_f32 v[140:141], v[140:141], v[36:37]
  v_lshlrev_b32 v36, 16, v103
  v_and_b32 v37, 0xffff0000, v103
  v_pk_add_f32 v[142:143], v[142:143], v[36:37]
  v_lshlrev_b32 v36, 16, v233
  v_and_b32 v37, 0xffff0000, v233
  v_pk_add_f32 v[144:145], v[144:145], v[36:37]
  s_bitset0_b32 s57, 9
Lskip9_10:
  s_bitcmp1_b32 s57, 10
  s_cbranch_scc0 Lskip10_10
  s_waitcnt vmcnt(11)
  v_max3_u32 v36, v104, v105, v106
  s_waitcnt vmcnt(10)
  v_max3_u32 v36, v36, v107, v234
  v_cmp_eq_u32 vcc, -1, v36
  s_nop 4
  s_cbranch_vccnz Lskip10_10
  v_lshlrev_b32 v36, 16, v104
  v_and_b32 v37, 0xffff0000, v104
  v_pk_add_f32 v[136:137], v[136:137], v[36:37]
  v_lshlrev_b32 v36, 16, v105
  v_and_b32 v37, 0xffff0000, v105
  v_pk_add_f32 v[138:139], v[138:139], v[36:37]
  v_lshlrev_b32 v36, 16, v106
  v_and_b32 v37, 0xffff0000, v106
  v_pk_add_f32 v[140:141], v[140:141], v[36:37]
  v_lshlrev_b32 v36, 16, v107
  v_and_b32 v37, 0xffff0000, v107
  v_pk_add_f32 v[142:143], v[142:143], v[36:37]
  v_lshlrev_b32 v36, 16, v234
  v_and_b32 v37, 0xffff0000, v234
  v_pk_add_f32 v[144:145], v[144:145], v[36:37]
  s_bitset0_b32 s57, 10
Lskip10_10:
  s_bitcmp1_b32 s57, 11
  s_cbranch_scc0 Lskip11_10
  s_waitcnt vmcnt(9)
  v_max3_u32 v36, v108, v109, v110
  s_waitcnt vmcnt(8)
  v_max3_u32 v36, v36, v111, v235
  v_cmp_eq_u32 vcc, -1, v36
  s_nop 4
  s_cbranch_vccnz Lskip11_10
  v_lshlrev_b32 v36, 16, v108
  v_and_b32 v37, 0xffff0000, v108
  v_pk_add_f32 v[136:137], v[136:137], v[36:37]
  v_lshlrev_b32 v36, 16, v109
  v_and_b32 v37, 0xffff0000, v109
  v_pk_add_f32 v[138:139], v[138:139], v[36:37]
  v_lshlrev_b32 v36, 16, v110
  v_and_b32 v37, 0xffff0000, v110
  v_pk_add_f32 v[140:141], v[140:141], v[36:37]
  v_lshlrev_b32 v36, 16, v111
  v_and_b32 v37, 0xffff0000, v111
  v_pk_add_f32 v[142:143], v[142:143], v[36:37]
  v_lshlrev_b32 v36, 16, v235
  v_and_b32 v37, 0xffff0000, v235
  v_pk_add_f32 v[144:145], v[144:145], v[36:37]
  s_bitset0_b32 s57, 11
Lskip11_10:
  s_bitcmp1_b32 s57, 12
  s_cbranch_scc0 Lskip12_10
  s_waitcnt vmcnt(7)
  v_max3_u32 v36, v112, v113, v114
  s_waitcnt vmcnt(6)
  v_max3_u32 v36, v36, v115, v236
  v_cmp_eq_u32 vcc, -1, v36
  s_nop 4
  s_cbranch_vccnz Lskip12_10
  v_lshlrev_b32 v36, 16, v112
  v_and_b32 v37, 0xffff0000, v112
  v_pk_add_f32 v[136:137], v[136:137], v[36:37]
  v_lshlrev_b32 v36, 16, v113
  v_and_b32 v37, 0xffff0000, v113
  v_pk_add_f32 v[138:139], v[138:139], v[36:37]
  v_lshlrev_b32 v36, 16, v114
  v_and_b32 v37, 0xffff0000, v114
  v_pk_add_f32 v[140:141], v[140:141], v[36:37]
  v_lshlrev_b32 v36, 16, v115
  v_and_b32 v37, 0xffff0000, v115
  v_pk_add_f32 v[142:143], v[142:143], v[36:37]
  v_lshlrev_b32 v36, 16, v236
  v_and_b32 v37, 0xffff0000, v236
  v_pk_add_f32 v[144:145], v[144:145], v[36:37]
  s_bitset0_b32 s57, 12
Lskip12_10:
  s_bitcmp1_b32 s57, 13
  s_cbranch_scc0 Lskip13_10
  s_waitcnt vmcnt(5)
  v_max3_u32 v36, v116, v117, v118
  s_waitcnt vmcnt(4)
  v_max3_u32 v36, v36, v119, v237
  v_cmp_eq_u32 vcc, -1, v36
  s_nop 4
  s_cbranch_vccnz Lskip13_10
  v_lshlrev_b32 v36, 16, v116
  v_and_b32 v37, 0xffff0000, v116
  v_pk_add_f32 v[136:137], v[136:137], v[36:37]
  v_lshlrev_b32 v36, 16, v117
  v_and_b32 v37, 0xffff0000, v117
  v_pk_add_f32 v[138:139], v[138:139], v[36:37]
  v_lshlrev_b32 v36, 16, v118
  v_and_b32 v37, 0xffff0000, v118
  v_pk_add_f32 v[140:141], v[140:141], v[36:37]
  v_lshlrev_b32 v36, 16, v119
  v_and_b32 v37, 0xffff0000, v119
  v_pk_add_f32 v[142:143], v[142:143], v[36:37]
  v_lshlrev_b32 v36, 16, v237
  v_and_b32 v37, 0xffff0000, v237
  v_pk_add_f32 v[144:145], v[144:145], v[36:37]
  s_bitset0_b32 s57, 13
Lskip13_10:
  s_bitcmp1_b32 s57, 14
  s_cbranch_scc0 Lskip14_10
  s_waitcnt vmcnt(3)
  v_max3_u32 v36, v120, v121, v122
  s_waitcnt vmcnt(2)
  v_max3_u32 v36, v36, v123, v238
  v_cmp_eq_u32 vcc, -1, v36
  s_nop 4
  s_cbranch_vccnz Lskip14_10
  v_lshlrev_b32 v36, 16, v120
  v_and_b32 v37, 0xffff0000, v120
  v_pk_add_f32 v[136:137], v[136:137], v[36:37]
  v_lshlrev_b32 v36, 16, v121
  v_and_b32 v37, 0xffff0000, v121
  v_pk_add_f32 v[138:139], v[138:139], v[36:37]
  v_lshlrev_b32 v36, 16, v122
  v_and_b32 v37, 0xffff0000, v122
  v_pk_add_f32 v[140:141], v[140:141], v[36:37]
  v_lshlrev_b32 v36, 16, v123
  v_and_b32 v37, 0xffff0000, v123
  v_pk_add_f32 v[142:143], v[142:143], v[36:37]
  v_lshlrev_b32 v36, 16, v238
  v_and_b32 v37, 0xffff0000, v238
  v_pk_add_f32 v[144:145], v[144:145], v[36:37]
  s_bitset0_b32 s57, 14
Lskip14_10:
  s_bitcmp1_b32 s57, 15
  s_cbranch_scc0 Lskip15_10
  s_waitcnt vmcnt(1)
  v_max3_u32 v36, v124, v125, v126
  s_waitcnt vmcnt(0)
  v_max3_u32 v36, v36, v127, v239
  v_cmp_eq_u32 vcc, -1, v36
  s_nop 4
  s_cbranch_vccnz Lskip15_10
  v_lshlrev_b32 v36, 16, v124
  v_and_b32 v37, 0xffff0000, v124
  v_pk_add_f32 v[136:137], v[136:137], v[36:37]
  v_lshlrev_b32 v36, 16, v125
  v_and_b32 v37, 0xffff0000, v125
  v_pk_add_f32 v[138:139], v[138:139], v[36:37]
  v_lshlrev_b32 v36, 16, v126
  v_and_b32 v37, 0xffff0000, v126
  v_pk_add_f32 v[140:141], v[140:141], v[36:37]
  v_lshlrev_b32 v36, 16, v127
  v_and_b32 v37, 0xffff0000, v127
  v_pk_add_f32 v[142:143], v[142:143], v[36:37]
  v_lshlrev_b32 v36, 16, v239
  v_and_b32 v37, 0xffff0000, v239
  v_pk_add_f32 v[144:145], v[144:145], v[36:37]
  s_bitset0_b32 s57, 15
Lskip15_10:
  s_cmp_lg_u32 s57, 0
  s_cbranch_scc1 Lretry_10
  v_cvt_pk_bf16_f32 v64, v128, v129
  v_cvt_pk_bf16_f32 v65, v130, v131
  v_cvt_pk_bf16_f32 v66, v132, v133
  v_cvt_pk_bf16_f32 v67, v134, v135
  v_cvt_pk_bf16_f32 v68, v136, v137
  v_cvt_pk_bf16_f32 v69, v138, v139
  v_cvt_pk_bf16_f32 v70, v140, v141
  v_cvt_pk_bf16_f32 v71, v142, v143
  v_cvt_pk_bf16_f32 v72, v144, v145
 WL 0
  buffer_store_dwordx2 v[64:65], v30, s[16:19], s56 offen offset:0
  buffer_store_dwordx2 v[66:67], v30, s[16:19], s69 offen offset:0
  buffer_store_dwordx2 v[68:69], v30, s[16:19], s56 offen offset:128
  buffer_store_dwordx2 v[70:71], v30, s[16:19], s69 offen offset:128
  buffer_store_dword v72, v31, s[16:19], s56 offen
Lexit_10:
  s_endpgm
Lpoll_ctx_10:
  buffer_load_dword v248, v247, s[20:23], s54 offen offset:16 sc1
  s_waitcnt vmcnt(0)
  v_cmp_gt_u32 vcc, 1, v248
  s_nop 4
  s_cbranch_vccz Lback_ctx_10
  s_branch Lpoll_ctx_10
Lpoll_pz_10:
  buffer_load_dword v248, v247, s[20:23], s54 offen offset:32 sc1
  s_waitcnt vmcnt(0)
  v_cmp_gt_u32 vcc, 1, v248
  s_nop 4
  s_cbranch_vccz Lback_pz_10
  s_branch Lpoll_pz_10
Lpoll_red_10:
  buffer_load_dword v248, v247, s[20:23], s54 offen offset:32 sc1
  s_waitcnt vmcnt(0)
  v_cmp_gt_u32 vcc, 2, v248
  s_nop 4
  s_cbranch_vccz Lback_red_10
  s_branch Lpoll_red_10
Lretry_10:
  s_bitcmp1_b32 s57, 0
  s_cbranch_scc0 Lrskip0_10
  s_add_u32 s46, s55, 0
  buffer_load_dwordx4 v[64:67], v28, s[20:23], s46 offen sc1
Lrskip0_10:
  s_bitcmp1_b32 s57, 1
  s_cbranch_scc0 Lrskip1_10
  s_add_u32 s46, s55, 18432
  buffer_load_dwordx4 v[68:71], v28, s[20:23], s46 offen sc1
Lrskip1_10:
  s_bitcmp1_b32 s57, 2
  s_cbranch_scc0 Lrskip2_10
  s_add_u32 s46, s55, 36864
  buffer_load_dwordx4 v[72:75], v28, s[20:23], s46 offen sc1
Lrskip2_10:
  s_bitcmp1_b32 s57, 3
  s_cbranch_scc0 Lrskip3_10
  s_add_u32 s46, s55, 55296
  buffer_load_dwordx4 v[76:79], v28, s[20:23], s46 offen sc1
Lrskip3_10:
  s_bitcmp1_b32 s57, 4
  s_cbranch_scc0 Lrskip4_10
  s_add_u32 s46, s55, 73728
  buffer_load_dwordx4 v[80:83], v28, s[20:23], s46 offen sc1
Lrskip4_10:
  s_bitcmp1_b32 s57, 5
  s_cbranch_scc0 Lrskip5_10
  s_add_u32 s46, s55, 92160
  buffer_load_dwordx4 v[84:87], v28, s[20:23], s46 offen sc1
Lrskip5_10:
  s_bitcmp1_b32 s57, 6
  s_cbranch_scc0 Lrskip6_10
  s_add_u32 s46, s55, 110592
  buffer_load_dwordx4 v[88:91], v28, s[20:23], s46 offen sc1
Lrskip6_10:
  s_bitcmp1_b32 s57, 7
  s_cbranch_scc0 Lrskip7_10
  s_add_u32 s46, s55, 129024
  buffer_load_dwordx4 v[92:95], v28, s[20:23], s46 offen sc1
Lrskip7_10:
  s_bitcmp1_b32 s57, 8
  s_cbranch_scc0 Lrskip8_10
  s_add_u32 s46, s55, 4096
  buffer_load_dwordx4 v[96:99], v28, s[20:23], s46 offen sc1
  buffer_load_dword v232, v29, s[20:23], s46 offen sc1
Lrskip8_10:
  s_bitcmp1_b32 s57, 9
  s_cbranch_scc0 Lrskip9_10
  s_add_u32 s46, s55, 22528
  buffer_load_dwordx4 v[100:103], v28, s[20:23], s46 offen sc1
  buffer_load_dword v233, v29, s[20:23], s46 offen sc1
Lrskip9_10:
  s_bitcmp1_b32 s57, 10
  s_cbranch_scc0 Lrskip10_10
  s_add_u32 s46, s55, 40960
  buffer_load_dwordx4 v[104:107], v28, s[20:23], s46 offen sc1
  buffer_load_dword v234, v29, s[20:23], s46 offen sc1
Lrskip10_10:
  s_bitcmp1_b32 s57, 11
  s_cbranch_scc0 Lrskip11_10
  s_add_u32 s46, s55, 59392
  buffer_load_dwordx4 v[108:111], v28, s[20:23], s46 offen sc1
  buffer_load_dword v235, v29, s[20:23], s46 offen sc1
Lrskip11_10:
  s_bitcmp1_b32 s57, 12
  s_cbranch_scc0 Lrskip12_10
  s_add_u32 s46, s55, 77824
  buffer_load_dwordx4 v[112:115], v28, s[20:23], s46 offen sc1
  buffer_load_dword v236, v29, s[20:23], s46 offen sc1
Lrskip12_10:
  s_bitcmp1_b32 s57, 13
  s_cbranch_scc0 Lrskip13_10
  s_add_u32 s46, s55, 96256
  buffer_load_dwordx4 v[116:119], v28, s[20:23], s46 offen sc1
  buffer_load_dword v237, v29, s[20:23], s46 offen sc1
Lrskip13_10:
  s_bitcmp1_b32 s57, 14
  s_cbranch_scc0 Lrskip14_10
  s_add_u32 s46, s55, 114688
  buffer_load_dwordx4 v[120:123], v28, s[20:23], s46 offen sc1
  buffer_load_dword v238, v29, s[20:23], s46 offen sc1
Lrskip14_10:
  s_bitcmp1_b32 s57, 15
  s_cbranch_scc0 Lrskip15_10
  s_add_u32 s46, s55, 133120
  buffer_load_dwordx4 v[124:127], v28, s[20:23], s46 offen sc1
  buffer_load_dword v239, v29, s[20:23], s46 offen sc1
Lrskip15_10:
  s_waitcnt vmcnt(0)
  s_branch Lchk_10
Lp4e_10:
Lp4_11:
  v_cmp_lt_u32 vcc, 0x40000000, v43
  s_lshr_b32 s65, s6, 8
  s_lshl_b32 s66, s3, 2
  v_mov_b32 v246, s66
  s_cmp_lg_u64 vcc, 0
  s_cselect_b32 s66, 1, 0
  s_andn2_b32 s66, s66, s65
  v_mov_b32 v245, s66
  ds_write_b32 v246, v245
  v_and_b32 v246, 3, v0
  v_lshlrev_b32 v246, 2, v246
  v_lshlrev_b32 v59, 3, v0
  v_add_u32 v56, 20736, v59
  v_add_u32 v57, 134400, v59
  v_add_u32 v58, 58624, v59
  v_add_u32 v59, 96512, v59
 WL 0
  s_waitcnt vmcnt(33)
  s_barrier
 TR 208,32,0
 TR 210,32,512
 TR 212,32,9472
 TR 214,32,9984
 TR 216,32,32
 TR 218,32,544
 TR 220,32,9504
 TR 222,32,10016
 TR 224,32,64
 TR 226,32,576
 TR 228,32,9536
 TR 230,32,10048
  ds_read_b32 v245, v246
 WL 11
  v_mfma_f32_16x16x32_bf16 v[64:67], v[208:211], a[212:215], 0
  s_add_u32 s46, s45, 49152
  v_lshlrev_b32 v249, 14, v0
  v_add_u32 v249, Lp4_11-Lpc0, v249
 WL 9
 Mvva 64,212,228
  buffer_load_dwordx4 a[0:3], v16, s[20:23], s46 offen offset:0 sc1
  v_mfma_f32_16x16x32_bf16 v[68:71], v[208:211], a[216:219], 0
  v_min_u32 v249, Lp4e_11-Lpc0-16388, v249
 Mvva 68,212,232
  v_mfma_f32_16x16x32_bf16 v[72:75], v[208:211], a[220:223], 0
  buffer_load_dwordx4 a[4:7], v16, s[20:23], s46 offen offset:2048 sc1
 Mvva 72,212,236
  v_mfma_f32_16x16x32_bf16 v[76:79], v[208:211], a[224:227], 0
 TR 208,32,96
 Mvva 76,212,240
 WL 8
  v_mfma_f32_16x16x32_bf16 v[80:83], v[216:219], a[212:215], 0
 TR 210,32,608
 WL 7
 Mvva 80,220,228
  buffer_load_dwordx4 a[8:11], v17, s[20:23], s46 offen offset:0 sc1
  v_mfma_f32_16x16x32_bf16 v[84:87], v[216:219], a[216:219], 0
 TR 212,32,9568
 Mvva 84,220,232
 WL 3
  v_cmp_ne_u32 vcc, 0, v245
  s_nop 4
  s_cbranch_vccnz Lrestart
  v_mfma_f32_16x16x32_bf16 v[88:91], v[216:219], a[220:223], 0
 TR 214,32,10080
 Mvva 88,220,236
  s_cmp_lg_u32 s3, 0
  s_cselect_b32 s64, 256, 0
  s_and_b32 s66, s2, 0xe7
  v_mfma_f32_16x16x32_bf16 v[92:95], v[216:219], a[224:227], 0
 TR 216,32,128
  s_lshl_b32 s66, s66, 6
 Mvva 92,220,240
  buffer_load_dwordx4 a[12:15], v17, s[20:23], s46 offen offset:2048 sc1
  v_mfma_f32_16x16x32_bf16 v[96:99], v[224:227], a[212:215], 0
 TR 218,32,640
  s_add_u32 s46, s45, 57344
 Mvva 96,228,228
  s_lshr_b32 s65, s4, 3
  s_add_u32 s66, s66, s65
  s_lshl_b32 s66, s66, 2
  v_mfma_f32_16x16x32_bf16 v[100:103], v[224:227], a[216:219], 0
 TR 220,32,9600
  s_add_u32 s66, s66, 0x4480010
 Mvva 100,228,232
  buffer_load_dwordx4 a[16:19], v16, s[20:23], s46 offen offset:0 sc1
  v_mfma_f32_16x16x32_bf16 v[104:107], v[224:227], a[220:223], 0
 TR 222,32,10112
  s_lshl_b32 s65, s64, 20
 Mvva 104,228,236
  global_load_dword a248, v249, s[100:101]
  v_mfma_f32_16x16x32_bf16 v[108:111], v[224:227], a[224:227], 0
 TR 224,32,160
  s_add_u32 s66, s66, s65
 Mvva 108,228,240
  buffer_load_dwordx4 a[20:23], v16, s[20:23], s46 offen offset:2048 sc1
 WL 7
  v_mfma_f32_16x16x32_bf16 v[112:115], v[208:211], a[212:215], 0
 TR 226,32,672
 WL 6
 Mvva 112,212,228
  v_cmp_gt_u32 vcc, 4, v0
  v_lshlrev_b32 v245, 11, v0
  v_mov_b32 v246, 1
  v_cndmask_b32 v245, -1, v245, vcc
  v_mfma_f32_16x16x32_bf16 v[116:119], v[208:211], a[216:219], 0
 TR 228,32,9632
 Mvva 116,212,232
  v_mfma_f32_16x16x32_bf16 v[120:123], v[208:211], a[220:223], 0
 TR 230,32,10144
 Mvva 120,212,236
  buffer_load_dwordx4 a[24:27], v17, s[20:23], s46 offen offset:0 sc1
  v_mfma_f32_16x16x32_bf16 v[124:127], v[208:211], a[224:227], 0
 TR 208,32,192
 Mvva 124,212,240
 WL 7
  v_mfma_f32_16x16x32_bf16 v[128:131], v[216:219], a[212:215], 0
 TR 210,32,704
 WL 6
 Mvva 128,220,228
  buffer_load_dwordx4 a[28:31], v17, s[20:23], s46 offen offset:2048 sc1
  v_mfma_f32_16x16x32_bf16 v[132:135], v[216:219], a[216:219], 0
 TR 212,32,9664
  s_add_u32 s44, s44, 147456
 Mvva 132,220,232
  s_add_u32 m0, s47, 50176
  v_mfma_f32_16x16x32_bf16 v[136:139], v[216:219], a[220:223], 0
 TR 214,32,10176
 Mvva 136,220,236
  buffer_load_dwordx4 v1, s[12:15], s44 offen lds
  v_mfma_f32_16x16x32_bf16 v[140:143], v[216:219], a[224:227], 0
 TR 216,32,224
 Mvva 140,220,240
 WL 7
  v_mfma_f32_16x16x32_bf16 v[144:147], v[224:227], a[212:215], 0
 TR 218,32,736
 WL 6
 Mvva 144,228,228
  v_mfma_f32_16x16x32_bf16 v[148:151], v[224:227], a[216:219], 0
 TR 220,32,9696
 Mvva 148,228,232
  buffer_load_dwordx4 v2, s[12:15], s44 offen offset:1056 lds
  v_mfma_f32_16x16x32_bf16 v[152:155], v[224:227], a[220:223], 0
 TR 222,32,10208
 Mvva 152,228,236
  v_mfma_f32_16x16x32_bf16 v[156:159], v[224:227], a[224:227], 0
 TR 224,56,0
 WL 7
 Mvva 156,228,240
  buffer_load_dwordx4 v3, s[12:15], s44 offen offset:2112 lds
  v_mfma_f32_16x16x32_bf16 v[160:163], v[208:211], a[212:215], 0
 TR 226,56,512
 WL 6
 Mvva 160,212,228
  v_mfma_f32_16x16x32_bf16 v[164:167], v[208:211], a[216:219], 0
 TR 228,56,9472
 Mvva 164,212,232
  buffer_load_dwordx4 v4, s[12:15], s44 offen offset:3168 lds
  v_mfma_f32_16x16x32_bf16 v[168:171], v[208:211], a[220:223], 0
 TR 230,56,9984
 Mvva 168,212,236
  v_mfma_f32_16x16x32_bf16 v[172:175], v[208:211], a[224:227], 0
 TR 208,32,18944
  s_add_u32 m0, s47, 54400
 Mvva 172,212,240
 WL 7
  v_mfma_f32_16x16x32_bf16 v[176:179], v[216:219], a[212:215], 0
 TR 210,32,19456
 WL 6
 Mvva 176,220,228
  buffer_load_dwordx4 v5, s[12:15], s44 offen lds
  v_mfma_f32_16x16x32_bf16 v[180:183], v[216:219], a[216:219], 0
 TR 212,32,28416
 Mvva 180,220,232
  v_mfma_f32_16x16x32_bf16 v[184:187], v[216:219], a[220:223], 0
 TR 214,32,28928
 Mvva 184,220,236
  buffer_load_dwordx4 v6, s[12:15], s44 offen offset:1056 lds
  v_mfma_f32_16x16x32_bf16 v[188:191], v[216:219], a[224:227], 0
 TR 216,32,18976
 Mvva 188,220,240
 WL 7
  v_mfma_f32_16x16x32_bf16 v[192:195], v[224:227], a[212:215], 0
 TR 218,32,19488
 WL 6
 Mvva 192,228,228
  buffer_load_dwordx4 v7, s[12:15], s44 offen offset:2112 lds
  v_mfma_f32_16x16x32_bf16 v[196:199], v[224:227], a[216:219], 0
 TR 220,32,28448
 Mvva 196,228,232
  v_mfma_f32_16x16x32_bf16 v[200:203], v[224:227], a[220:223], 0
 TR 222,32,28960
  s_waitcnt vmcnt(41)
 Mvva 200,228,236
  v_mfma_f32_16x16x32_bf16 v[204:207], v[224:227], a[224:227], 0
 TR 224,32,19008
 WL 7
 Mvva 204,228,240
  buffer_load_dwordx4 v8, s[12:15], s44 offen offset:3168 lds
 Mvva 64,208,176
 TR 226,32,19520
 WL 6
 Mvva 64,212,192
  s_add_u32 m0, s47, 58624
 Mvva 68,208,180
 TR 228,32,28480
 Mvva 68,212,196
  buffer_load_dwordx4 v9, s[20:23], s44 offen sc1 lds
 Mvva 72,208,184
 TR 230,32,28992
 Mvva 72,212,200
  s_add_u32 s46, s45, 65536
 Mvva 76,208,188
 TR 208,32,19040
 WL 7
 Mvva 76,212,204
  buffer_load_dwordx4 a[32:35], v16, s[20:23], s46 offen offset:0 sc1
 Mvva 80,216,176
 TR 210,32,19552
 WL 6
 Mvva 80,220,192
 Mvva 84,216,180
 TR 212,32,28512
 Mvva 84,220,196
 Mvva 88,216,184
 TR 214,32,29024
 Mvva 88,220,200
  buffer_load_dwordx4 a[36:39], v16, s[20:23], s46 offen offset:2048 sc1
 Mvva 92,216,188
 TR 216,32,19072
 Mvva 92,220,204
 WL 7
 Mvva 96,224,176
 TR 218,32,19584
 WL 6
 Mvva 96,228,192
  buffer_load_dwordx4 a[40:43], v17, s[20:23], s46 offen offset:0 sc1
 Mvva 100,224,180
 TR 220,32,28544
 Mvva 100,228,196
 Mvva 104,224,184
 TR 222,32,29056
 Mvva 104,228,200
 WL 4
 Mvva 108,224,188
 TR 224,32,19104
 WL 7
 Mvva 108,228,204
  buffer_load_dwordx4 a[44:47], v17, s[20:23], s46 offen offset:2048 sc1
 Mvva 112,208,176
 TR 226,32,19616
  s_add_u32 s46, s45, 73728
 Mvva 112,212,192
 Mvva 116,208,180
 TR 228,32,28576
 Mvva 116,212,196
  buffer_load_dwordx4 a[48:51], v16, s[20:23], s46 offen offset:0 sc1
 Mvva 120,208,184
 TR 230,32,29088
 Mvva 120,212,200
 Mvva 124,208,188
 TR 208,32,19136
 WL 7
 Mvva 124,212,204
  buffer_load_dwordx4 a[52:55], v16, s[20:23], s46 offen offset:2048 sc1
 Mvva 128,216,176
 TR 210,32,19648
 WL 6
 Mvva 128,220,192
 Mvva 132,216,180
 TR 212,32,28608
 Mvva 132,220,196
 Mvva 136,216,184
 TR 214,32,29120
 Mvva 136,220,200
  buffer_load_dwordx4 a[56:59], v17, s[20:23], s46 offen offset:0 sc1
 Mvva 140,216,188
 TR 216,32,19168
 Mvva 140,220,204
 WL 7
 Mvva 144,224,176
 TR 218,32,19680
 WL 6
 Mvva 144,228,192
  buffer_load_dwordx4 a[60:63], v17, s[20:23], s46 offen offset:2048 sc1
 Mvva 148,224,180
 TR 220,32,28640
 Mvva 148,228,196
  s_add_u32 s46, s45, 81920
 Mvva 152,224,184
 TR 222,32,29152
 Mvva 152,228,200
  buffer_load_dwordx4 a[64:67], v16, s[20:23], s46 offen offset:0 sc1
 Mvva 156,224,188
 TR 224,56,18944
 Mvva 156,228,204
 WL 7
 Mvva 160,208,176
 TR 226,56,19456
 WL 6
 Mvva 160,212,192
 Mvva 164,208,180
 TR 228,56,28416
 Mvva 164,212,196
  buffer_load_dwordx4 a[68:71], v16, s[20:23], s46 offen offset:2048 sc1
 Mvva 168,208,184
 TR 230,56,28928
 Mvva 168,212,200
 Mvva 172,208,188
  buffer_load_dwordx4 a[72:75], v17, s[20:23], s46 offen offset:0 sc1
 Mvva 172,212,204
 WL 6
 Mvva 176,216,176
 WL 4
 Mvva 176,220,192
  s_waitcnt vmcnt(29) lgkmcnt(0)
  s_barrier
 Mvva 180,216,180
 TR 208,33,0
 Mvva 180,220,196
 TR 210,33,512
 Mvva 184,216,184
 TR 212,33,9472
 Mvva 184,220,200
 TR 214,33,9984
 Mvva 188,216,188
 TR 216,33,32
 Mvva 188,220,204
  buffer_load_dwordx4 a[76:79], v17, s[20:23], s46 offen offset:2048 sc1
 Mvva 192,224,176
 TR 218,33,544
  s_add_u32 s46, s45, 90112
 Mvva 192,228,192
  buffer_load_dwordx4 a[80:83], v16, s[20:23], s46 offen offset:0 sc1
 Mvva 196,224,180
 TR 220,33,9504
 Mvva 196,228,196
  buffer_store_dword v246, v245, s[20:23], s66 offen sc1
 Mvva 200,224,184
 TR 222,33,10016
 WL 6
 Mvva 200,228,200
  buffer_load_dwordx4 a[84:87], v16, s[20:23], s46 offen offset:2048 sc1
 Mvva 204,224,188
 TR 224,33,64
  s_lshr_b32 s55, s2, 3
 Mvva 204,228,204
  s_lshl_b32 s55, s55, 2
  s_bfe_u32 s65, s4, 0x20001
  s_add_u32 s55, s55, s65
 Mvva 64,208,144
 TR 226,33,576
  s_lshl_b32 s55, s55, 4
 WL 6
 Mvva 64,212,160
  buffer_load_dwordx4 a[88:91], v17, s[20:23], s46 offen offset:0 sc1
 Mvva 68,208,148
 TR 228,33,9536
  s_and_b32 s65, s4, 1
 Mvva 68,212,164
  s_add_u32 s55, s55, s65
  s_mul_i32 s55, s55, 9216
  s_add_u32 s55, s55, 0x4500000
 Mvva 72,208,152
 TR 230,33,10048
  s_and_b32 s65, s4, 7
 Mvva 72,212,168
  s_movk_i32 s50, 8192
  s_movk_i32 s51, 16384
  s_and_b32 s66, s2, 0xf8
 Mvva 76,208,156
 TR 208,33,96
  s_lshl_b32 s56, s3, 1
 Mvva 76,212,172
  buffer_load_dwordx4 a[92:95], v17, s[20:23], s46 offen offset:2048 sc1
 WL 7
 Mvva 80,216,144
 TR 210,33,608
  s_add_u32 s44, s44, 147456
 WL 6
 Mvva 80,220,160
  s_add_u32 m0, s47, 88064
  s_add_u32 s66, s66, s56
  s_lshl_b32 s66, s66, 6
 Mvva 84,216,148
 TR 212,33,9568
  s_add_u32 s66, s66, s65
 Mvva 84,220,164
  buffer_load_dwordx4 v1, s[12:15], s44 offen lds
 Mvva 88,216,152
 TR 214,33,10080
  s_lshl_b32 s66, s66, 2
 Mvva 88,220,168
  s_add_u32 s66, s66, 0x4480020
 Mvva 92,216,156
 TR 216,33,128
 WL 7
 Mvva 92,220,172
  buffer_load_dwordx4 v2, s[12:15], s44 offen offset:1056 lds
 Mvva 96,224,144
 TR 218,33,640
 WL 6
 Mvva 96,228,160
  v_cmp_gt_u32 vcc, 2, v0
  v_lshlrev_b32 v245, 8, v0
  v_mov_b32 v246, 1
  v_cndmask_b32 v245, -1, v245, vcc
 Mvva 100,224,148
 TR 220,33,9600
  s_sub_u32 s56, 15, s5
 Mvva 100,228,164
  s_cmp_lt_u32 s65, 4
  s_cselect_b32 s56, s56, s5
  s_lshl_b32 s56, s56, 3
 Mvva 104,224,152
 TR 222,33,10112
  s_bfe_u32 s69, s65, 0x10001
 Mvva 104,228,168
  buffer_load_dwordx4 v3, s[12:15], s44 offen offset:2112 lds
 Mvva 108,224,156
 TR 224,33,160
  s_add_u32 s56, s56, s69
 Mvva 108,228,172
  s_and_b32 s69, s65, 1
  s_lshl_b32 s69, s69, 2
  s_add_u32 s56, s56, s69
 WL 7
 Mvva 112,208,144
 TR 226,33,672
  s_mul_i32 s56, s56, 18432
 WL 6
 Mvva 112,212,160
  buffer_load_dwordx4 v4, s[12:15], s44 offen offset:3168 lds
 Mvva 116,208,148
 TR 228,33,9632
  s_lshr_b32 s69, s4, 3
 Mvva 116,212,164
  s_add_u32 m0, s47, 92288
  s_mul_i32 s31, s69, 224
  s_lshl_b32 s69, s69, 8
 Mvva 120,208,152
 TR 230,33,10144
  s_add_u32 s56, s56, s69
 Mvva 120,212,168
  buffer_load_dwordx4 v5, s[12:15], s44 offen lds
 Mvva 124,208,156
 TR 208,33,192
  s_lshl_b32 s69, s3, 10
 Mvva 124,212,172
 WL 7
  v_add_u32 v28, s69, v16
  s_lshl_b32 s69, s3, 8
 Mvva 128,216,144
 TR 210,33,704
  s_add_u32 s69, s69, 4096
 WL 6
 Mvva 128,220,160
  v_lshl_add_u32 v29, v0, 2, s69
  v_and_b32 v36, 15, v0
 Mvva 132,216,148
 TR 212,33,9664
  v_mul_u32_u24 v36, 1152, v36
 Mvva 132,220,164
  buffer_load_dwordx4 v6, s[12:15], s44 offen offset:1056 lds
 Mvva 136,216,152
 TR 214,33,10176
  v_lshrrev_b32 v37, 4, v0
 Mvva 136,220,168
  s_lshl_b32 s69, s3, 5
  v_lshl_add_u32 v36, v37, 3, v36
  v_add_u32 v30, s69, v36
 Mvva 140,216,156
 TR 216,33,224
  v_lshrrev_b32 v36, 2, v0
 Mvva 140,220,172
  buffer_load_dwordx4 v7, s[12:15], s44 offen offset:2112 lds
 WL 7
 Mvva 144,224,144
 TR 218,33,736
  v_bfe_u32 v37, v0, 1, 1
 WL 6
 Mvva 144,228,160
  v_lshl_add_u32 v36, v37, 5, v36
  v_mul_u32_u24 v36, 1152, v36
 Mvva 148,224,148
 TR 220,33,9696
  v_and_b32 v37, 1, v0
 Mvva 148,228,164
  s_lshl_b32 s69, s3, 3
  s_add_u32 s69, s69, 1024
  v_lshl_add_u32 v36, v37, 2, v36
 Mvva 152,224,152
 TR 222,33,10208
  s_sub_u32 s69, s69, s31
 Mvva 152,228,168
  buffer_load_dwordx4 v8, s[12:15], s44 offen offset:3168 lds
 Mvva 156,224,156
 TR 224,57,0
  s_add_u32 m0, s47, 96512
 Mvva 156,228,172
  s_mov_b32 s57, 0xffff
  v_add_u32 v31, s69, v36
  s_add_u32 s69, s56, 36864
 WL 7
 Mvva 160,208,144
 TR 226,57,512
 WL 6
 Mvva 160,212,160
  buffer_load_dwordx4 v9, s[20:23], s44 offen sc1 lds
 Mvva 164,208,148
 TR 228,57,9472
 Mvva 164,212,164
  buffer_store_dword v246, v245, s[20:23], s66 offen sc1
 Mvva 168,208,152
 TR 230,57,9984
  s_add_u32 s46, s45, 98304
 Mvva 168,212,168
  buffer_load_dwordx4 a[96:99], v16, s[20:23], s46 offen offset:0 sc1
 Mvva 172,208,156
 TR 208,33,18944
 Mvva 172,212,172
 WL 7
 Mvva 176,216,144
 TR 210,33,19456
 WL 6
 Mvva 176,220,160
 Mvva 180,216,148
 TR 212,33,28416
 Mvva 180,220,164
  buffer_load_dwordx4 a[100:103], v16, s[20:23], s46 offen offset:2048 sc1
 Mvva 184,216,152
 TR 214,33,28928
 Mvva 184,220,168
 Mvva 188,216,156
 TR 216,33,18976
 WL 7
 Mvva 188,220,172
  buffer_load_dwordx4 a[104:107], v17, s[20:23], s46 offen offset:0 sc1
 Mvva 192,224,144
 TR 218,33,19488
 WL 6
 Mvva 192,228,160
 Mvva 196,224,148
 TR 220,33,28448
 Mvva 196,228,164
  buffer_load_dwordx4 a[108:111], v17, s[20:23], s46 offen offset:2048 sc1
 Mvva 200,224,152
 TR 222,33,28960
  s_waitcnt vmcnt(40)
 Mvva 200,228,168
 Mvva 204,224,156
 TR 224,33,19008
  s_add_u32 s46, s45, 106496
 Mvva 204,228,172
 WL 7
 Mvva 64,208,0
 TR 226,33,19520
 WL 6
 Mvva 64,212,16
  buffer_load_dwordx4 a[112:115], v16, s[20:23], s46 offen offset:0 sc1
 Mvva 68,208,4
 TR 228,33,28480
 Mvva 68,212,20
 Mvva 72,208,8
 TR 230,33,28992
 Mvva 72,212,24
  buffer_load_dwordx4 a[116:119], v16, s[20:23], s46 offen offset:2048 sc1
 Mvva 76,208,12
 TR 208,33,19040
 Mvva 76,212,28
 WL 7
 Mvva 80,216,0
 TR 210,33,19552
 WL 6
 Mvva 80,220,16
  buffer_load_dwordx4 a[120:123], v17, s[20:23], s46 offen offset:0 sc1
 Mvva 84,216,4
 TR 212,33,28512
 Mvva 84,220,20
 Mvva 88,216,8
 TR 214,33,29024
 Mvva 88,220,24
 Mvva 92,216,12
 TR 216,33,19072
 WL 7
 Mvva 92,220,28
  buffer_load_dwordx4 a[124:127], v17, s[20:23], s46 offen offset:2048 sc1
 Mvva 96,224,0
 TR 218,33,19584
 WL 6
 Mvva 96,228,16
  s_add_u32 s46, s45, 114688
 Mvva 100,224,4
 TR 220,33,28544
 Mvva 100,228,20
  buffer_load_dwordx4 a[128:131], v16, s[20:23], s46 offen offset:0 sc1
 Mvva 104,224,8
 TR 222,33,29056
 Mvva 104,228,24
 Mvva 108,224,12
 TR 224,33,19104
 WL 7
 Mvva 108,228,28
  buffer_load_dwordx4 a[132:135], v16, s[20:23], s46 offen offset:2048 sc1
 Mvva 112,208,0
 TR 226,33,19616
 WL 6
 Mvva 112,212,16
 Mvva 116,208,4
 TR 228,33,28576
 Mvva 116,212,20
 Mvva 120,208,8
 TR 230,33,29088
 Mvva 120,212,24
  buffer_load_dwordx4 a[136:139], v17, s[20:23], s46 offen offset:0 sc1
 Mvva 124,208,12
 TR 208,33,19136
 Mvva 124,212,28
 WL 7
 Mvva 128,216,0
 TR 210,33,19648
 WL 6
 Mvva 128,220,16
  buffer_load_dwordx4 a[140:143], v17, s[20:23], s46 offen offset:2048 sc1
 Mvva 132,216,4
 TR 212,33,28608
 Mvva 132,220,20
  s_add_u32 s46, s45, 122880
 Mvva 136,216,8
 TR 214,33,29120
 Mvva 136,220,24
  buffer_load_dwordx4 v[40:43], v16, s[20:23], s46 offen offset:0 sc1
 Mvva 140,216,12
 TR 216,33,19168
 Mvva 140,220,28
 WL 7
 Mvva 144,224,0
 TR 218,33,19680
 WL 6
 Mvva 144,228,16
 Mvva 148,224,4
 TR 220,33,28640
 Mvva 148,228,20
  buffer_load_dwordx4 v[44:47], v16, s[20:23], s46 offen offset:2048 sc1
 Mvva 152,224,8
 TR 222,33,29152
 Mvva 152,228,24
 Mvva 156,224,12
 TR 224,57,18944
 WL 7
 Mvva 156,228,28
  buffer_load_dwordx4 v[48:51], v17, s[20:23], s46 offen offset:0 sc1
 Mvva 160,208,0
 TR 226,57,19456
 WL 6
 Mvva 160,212,16
 Mvva 164,208,4
 TR 228,57,28416
 Mvva 164,212,20
  buffer_load_dwordx4 v[52:55], v17, s[20:23], s46 offen offset:2048 sc1
 Mvva 168,208,8
 TR 230,57,28928
  s_add_u32 s44, s44, 147456
 Mvva 168,212,24
 Mvva 172,208,12
  s_add_u32 m0, s47, 12288
 Mvva 172,212,28
 WL 6
 WL 4
 Mvva 176,216,0
  buffer_load_dwordx4 v1, s[12:15], s44 offen lds
 Mvva 176,220,16
 WL 0
  s_waitcnt vmcnt(44)
  s_barrier
 Mvva 180,216,4
 TR 208,34,0
 Mvva 180,220,20
 TR 210,34,512
 Mvva 184,216,8
 TR 212,34,9472
 Mvva 184,220,24
 TR 214,34,9984
 Mvva 188,216,12
 TR 216,34,32
 Mvva 188,220,28
  buffer_load_dwordx4 v2, s[12:15], s44 offen offset:1056 lds
 Mvva 192,224,0
 TR 218,34,544
 Mvva 192,228,16
 Mvva 196,224,4
 TR 220,34,9504
 Mvva 196,228,20
  buffer_load_dwordx4 v3, s[12:15], s44 offen offset:2112 lds
 Mvva 200,224,8
 TR 222,34,10016
  s_waitcnt vmcnt(38)
 Mvva 200,228,24
 Mvva 204,224,12
 TR 224,34,64
 WL 7
 Mvva 204,228,28
  buffer_load_dwordx4 v4, s[12:15], s44 offen offset:3168 lds
 Mvva 64,208,32
 TR 226,34,576
 WL 6
 Mvva 64,212,48
  s_add_u32 m0, s47, 16512
 Mvva 68,208,36
 TR 228,34,9536
 Mvva 68,212,52
  buffer_load_dwordx4 v5, s[12:15], s44 offen lds
 Mvva 72,208,40
 TR 230,34,10048
 Mvva 72,212,56
 Mvva 76,208,44
 TR 208,34,96
 Mvva 76,212,60
 WL 7
 Mvva 80,216,32
 TR 210,34,608
 WL 6
 Mvva 80,220,48
  buffer_load_dwordx4 v6, s[12:15], s44 offen offset:1056 lds
 Mvva 84,216,36
 TR 212,34,9568
 Mvva 84,220,52
 Mvva 88,216,40
 TR 214,34,10080
 Mvva 88,220,56
  buffer_load_dwordx4 v7, s[12:15], s44 offen offset:2112 lds
 Mvva 92,216,44
 TR 216,34,128
 Mvva 92,220,60
 WL 7
 Mvva 96,224,32
 TR 218,34,640
 WL 6
 Mvva 96,228,48
  buffer_load_dwordx4 v8, s[12:15], s44 offen offset:3168 lds
 Mvva 100,224,36
 TR 220,34,9600
 Mvva 100,228,52
 Mvva 104,224,40
 TR 222,34,10112
  s_add_u32 m0, s47, 20736
 Mvva 104,228,56
 WL 4
 Mvva 108,224,44
 TR 224,34,160
 WL 7
 Mvva 108,228,60
  buffer_load_dwordx4 v9, s[20:23], s44 offen sc1 lds
 Mvva 112,208,32
 TR 226,34,672
  s_add_u32 s46, s45, 131072
 Mvva 112,212,48
 Mvva 116,208,36
 TR 228,34,9632
 Mvva 116,212,52
  buffer_load_dwordx4 a[212:215], v16, s[20:23], s46 offen offset:0 sc1
 Mvva 120,208,40
 TR 230,34,10144
 Mvva 120,212,56
 Mvva 124,208,44
 TR 208,34,192
 WL 7
 Mvva 124,212,60
  buffer_load_dwordx4 a[216:219], v16, s[20:23], s46 offen offset:2048 sc1
 Mvva 128,216,32
 TR 210,34,704
 WL 6
 Mvva 128,220,48
 Mvva 132,216,36
 TR 212,34,9664
 Mvva 132,220,52
 Mvva 136,216,40
 TR 214,34,10176
 Mvva 136,220,56
  buffer_load_dwordx4 a[220:223], v17, s[20:23], s46 offen offset:0 sc1
 Mvva 140,216,44
 TR 216,34,224
 Mvva 140,220,60
 WL 7
 Mvva 144,224,32
 TR 218,34,736
 WL 6
 Mvva 144,228,48
  buffer_load_dwordx4 a[224:227], v17, s[20:23], s46 offen offset:2048 sc1
 Mvva 148,224,36
 TR 220,34,9696
 Mvva 148,228,52
  s_add_u32 s46, s45, 139264
 Mvva 152,224,40
 TR 222,34,10208
 Mvva 152,228,56
  buffer_load_dwordx4 a[228:231], v16, s[20:23], s46 offen offset:0 sc1
 Mvva 156,224,44
 TR 224,58,0
 Mvva 156,228,60
 WL 7
 Mvva 160,208,32
 TR 226,58,512
 WL 6
 Mvva 160,212,48
 Mvva 164,208,36
 TR 228,58,9472
 Mvva 164,212,52
  buffer_load_dwordx4 a[232:235], v16, s[20:23], s46 offen offset:2048 sc1
 Mvva 168,208,40
 TR 230,58,9984
 Mvva 168,212,56
 Mvva 172,208,44
 TR 208,34,18944
 WL 7
 Mvva 172,212,60
  buffer_load_dwordx4 a[236:239], v17, s[20:23], s46 offen offset:0 sc1
 Mvva 176,216,32
 TR 210,34,19456
 WL 6
 Mvva 176,220,48
  global_load_dword a248, v249, s[100:101]
 Mvva 180,216,36
 TR 212,34,28416
 Mvva 180,220,52
  buffer_load_dwordx4 a[240:243], v17, s[20:23], s46 offen offset:2048 sc1
 Mvva 184,216,40
 TR 214,34,28928
 Mvva 184,220,56
 Mvva 188,216,44
 TR 216,34,18976
  s_add_u32 s46, s45, 147456
 Mvva 188,220,60
 WL 7
 Mvva 192,224,32
 TR 218,34,19488
 WL 6
 Mvva 192,228,48
  buffer_load_dwordx4 a[176:179], v16, s[20:23], s46 offen offset:0 sc1
 Mvva 196,224,36
 TR 220,34,28448
 Mvva 196,228,52
 Mvva 200,224,40
 TR 222,34,28960
  s_waitcnt vmcnt(45)
 Mvva 200,228,56
  buffer_load_dwordx4 a[180:183], v16, s[20:23], s46 offen offset:2048 sc1
 Mvva 204,224,44
 TR 224,34,19008
 Mvva 204,228,60
 WL 7
 Mvva 64,208,64
 TR 226,34,19520
 WL 6
 Mvva 64,212,80
  buffer_load_dwordx4 a[184:187], v17, s[20:23], s46 offen offset:0 sc1
 Mvva 68,208,68
 TR 228,34,28480
 Mvva 68,212,84
 Mvva 72,208,72
 TR 230,34,28992
 Mvva 72,212,88
 Mvva 76,208,76
 TR 208,34,19040
 WL 7
 Mvva 76,212,92
  buffer_load_dwordx4 a[188:191], v17, s[20:23], s46 offen offset:2048 sc1
 Mvva 80,216,64
 TR 210,34,19552
 WL 6
 Mvva 80,220,80
  s_add_u32 s46, s45, 155648
 Mvva 84,216,68
 TR 212,34,28512
 Mvva 84,220,84
  buffer_load_dwordx4 a[192:195], v16, s[20:23], s46 offen offset:0 sc1
 Mvva 88,216,72
 TR 214,34,29024
 Mvva 88,220,88
 Mvva 92,216,76
 TR 216,34,19072
 Mvva 92,220,92
 WL 7
 Mvva 96,224,64
 TR 218,34,19584
 WL 6
 Mvva 96,228,80
  buffer_load_dwordx4 a[196:199], v16, s[20:23], s46 offen offset:2048 sc1
 Mvva 100,224,68
 TR 220,34,28544
 Mvva 100,228,84
 Mvva 104,224,72
 TR 222,34,29056
  s_add_u32 s44, s44, 147456
 Mvva 104,228,88
  buffer_load_dwordx4 a[200:203], v17, s[20:23], s46 offen offset:0 sc1
 Mvva 108,224,76
 TR 224,34,19104
  s_lshr_b32 s30, s3, 1
 Mvva 108,228,92
 WL 7
 WL 5
 Mvva 112,208,64
 TR 226,34,19616
  s_lshl_b32 s30, s30, 28
 Mvva 112,212,80
  buffer_load_dwordx4 a[204:207], v17, s[20:23], s46 offen offset:2048 sc1
 Mvva 116,208,68
 TR 228,34,28576
  s_add_u32 s44, s44, s30
 Mvva 116,212,84
 Mvva 120,208,72
 TR 230,34,29088
  s_add_u32 m0, s47, 125952
 Mvva 120,212,88
 Mvva 124,208,76
 TR 208,34,19136
 WL 7
 Mvva 124,212,92
  buffer_load_dwordx4 v1, s[12:15], s44 offen lds
 Mvva 128,216,64
 TR 210,34,19648
 WL 6
 Mvva 128,220,80
  buffer_load_dwordx4 v2, s[12:15], s44 offen offset:1056 lds
 Mvva 132,216,68
 TR 212,34,28608
 Mvva 132,220,84
  buffer_load_dwordx4 v3, s[12:15], s44 offen offset:2112 lds
 Mvva 136,216,72
 TR 214,34,29120
 WL 6
 Mvva 136,220,88
  buffer_load_dwordx4 v4, s[12:15], s44 offen offset:3168 lds
 Mvva 140,216,76
 TR 216,34,19168
  s_add_u32 m0, s47, 130176
 Mvva 140,220,92
  buffer_load_dwordx4 v5, s[12:15], s44 offen lds
 Mvva 144,224,64
 TR 218,34,19680
 WL 6
 Mvva 144,228,80
  buffer_load_dwordx4 v6, s[12:15], s44 offen offset:1056 lds
 Mvva 148,224,68
 TR 220,34,28640
  v_and_b32 v247, 3, v0
 Mvva 148,228,84
  v_lshlrev_b32 v247, 2, v247
 Mvva 152,224,72
 TR 222,34,29152
 Mvva 152,228,88
  buffer_load_dwordx4 v7, s[12:15], s44 offen offset:2112 lds
 Mvva 156,224,76
 TR 224,58,18944
 WL 7
 Mvva 156,228,92
  buffer_load_dwordx4 v8, s[12:15], s44 offen offset:3168 lds
 Mvva 160,208,64
 TR 226,58,19456
  s_add_u32 m0, s47, 134400
 WL 6
 Mvva 160,212,80
  buffer_load_dword v248, v247, s[20:23], s54 offen offset:16 sc1
 Mvva 164,208,68
 TR 228,58,28416
  s_add_u32 s46, s45, 163840
 Mvva 164,212,84
  buffer_load_dwordx4 v9, s[20:23], s44 offen sc1 lds
 Mvva 168,208,72
 TR 230,58,28928
 Mvva 168,212,88
  buffer_load_dwordx4 a[144:147], v16, s[20:23], s46 offen offset:0 sc1
 Mvva 172,208,76
 WL 6
 Mvva 172,212,92
  buffer_load_dwordx4 a[148:151], v16, s[20:23], s46 offen offset:2048 sc1
 Mvva 176,216,64
 WL 4
 Mvva 176,220,80
 WL 0
  s_waitcnt vmcnt(55)
  s_barrier
 Mvva 180,216,68
 TR 208,35,0
 Mvva 180,220,84
 TR 210,35,512
 Mvva 184,216,72
 TR 212,35,9472
 Mvva 184,220,88
 TR 214,35,9984
 Mvva 188,216,76
 TR 216,35,32
 Mvva 188,220,92
  buffer_load_dwordx4 a[152:155], v17, s[20:23], s46 offen offset:0 sc1
 Mvva 192,224,64
 TR 218,35,544
 Mvva 192,228,80
  buffer_load_dwordx4 a[156:159], v17, s[20:23], s46 offen offset:2048 sc1
 Mvva 196,224,68
 TR 220,35,9504
 Mvva 196,228,84
 Mvva 200,224,72
 TR 222,35,10016
  s_waitcnt vmcnt(48)
 Mvva 200,228,88
  s_add_u32 s46, s45, 172032
 Mvva 204,224,76
 TR 224,35,64
 WL 7
 Mvva 204,228,92
  buffer_load_dwordx4 a[160:163], v16, s[20:23], s46 offen offset:0 sc1
 Mvva 64,208,96
 TR 226,35,576
 WL 6
 Mvva 64,212,112
 Mvva 68,208,100
 TR 228,35,9536
 Mvva 68,212,116
  buffer_load_dwordx4 a[164:167], v16, s[20:23], s46 offen offset:2048 sc1
 Mvva 72,208,104
 TR 230,35,10048
 Mvva 72,212,120
 Mvva 76,208,108
 TR 208,35,96
 WL 7
 Mvva 76,212,124
  buffer_load_dwordx4 a[168:171], v17, s[20:23], s46 offen offset:0 sc1
 Mvva 80,216,96
 TR 210,35,608
 WL 6
 Mvva 80,220,112
 Mvva 84,216,100
 TR 212,35,9568
  s_mov_b32 s44, s25
 Mvva 84,220,116
 Mvva 88,216,104
 TR 214,35,10080
  v_add_u32 v9, 4096, v9
 Mvva 88,220,120
  buffer_load_dwordx4 a[172:175], v17, s[20:23], s46 offen offset:2048 sc1
 Mvva 92,216,108
 TR 216,35,128
  s_add_u32 m0, s47, 50176
 Mvva 92,220,124
 WL 7
 Mvva 96,224,96
 TR 218,35,640
 WL 6
 Mvva 96,228,112
  buffer_load_dwordx4 v1, s[40:43], s44 offen lds
 Mvva 100,224,100
 TR 220,35,9600
 Mvva 100,228,116
 Mvva 104,224,104
 TR 222,35,10112
 Mvva 104,228,120
  buffer_load_dwordx4 v2, s[40:43], s44 offen offset:1056 lds
 Mvva 108,224,108
 TR 224,35,160
 Mvva 108,228,124
 WL 7
 Mvva 112,208,96
 TR 226,35,672
 WL 6
 Mvva 112,212,112
 Mvva 116,208,100
 TR 228,35,9632
 Mvva 116,212,116
  buffer_load_dwordx4 v3, s[40:43], s44 offen offset:2112 lds
 Mvva 120,208,104
 TR 230,35,10144
 Mvva 120,212,120
 Mvva 124,208,108
 TR 208,35,192
 WL 7
 Mvva 124,212,124
  buffer_load_dwordx4 v4, s[40:43], s44 offen offset:3168 lds
 Mvva 128,216,96
 TR 210,35,704
 WL 6
 Mvva 128,220,112
  s_add_u32 m0, s47, 54400
 Mvva 132,216,100
 TR 212,35,9664
 Mvva 132,220,116
  buffer_load_dwordx4 v5, s[40:43], s44 offen lds
 Mvva 136,216,104
 TR 214,35,10176
 Mvva 136,220,120
 Mvva 140,216,108
 TR 216,35,224
 Mvva 140,220,124
 WL 7
 Mvva 144,224,96
 TR 218,35,736
 WL 6
 Mvva 144,228,112
  buffer_load_dwordx4 v6, s[40:43], s44 offen offset:1056 lds
 Mvva 148,224,100
 TR 220,35,9696
 Mvva 148,228,116
 Mvva 152,224,104
 TR 222,35,10208
 Mvva 152,228,120
  buffer_load_dwordx4 v7, s[40:43], s44 offen offset:2112 lds
 Mvva 156,224,108
 TR 224,59,0
 Mvva 156,228,124
 WL 7
 Mvva 160,208,96
 TR 226,59,512
 WL 6
 Mvva 160,212,112
  buffer_load_dwordx4 v8, s[40:43], s44 offen offset:3168 lds
 Mvva 164,208,100
 TR 228,59,9472
 Mvva 164,212,116
 Mvva 168,208,104
 TR 230,59,9984
  s_add_u32 m0, s47, 58624
 Mvva 168,212,120
  s_waitcnt vmcnt(17)
  v_cmp_gt_u32 vcc, 1, v248
  s_nop 4
  s_cbranch_vccnz Lpoll_ctx_11
Lback_ctx_11:
 Mvva 172,208,108
 TR 208,35,18944
 WL 7
 Mvva 172,212,124
  buffer_load_dwordx4 v9, s[20:23], s44 offen sc1 lds
 Mvva 176,216,96
 TR 210,35,19456
 WL 6
 Mvva 176,220,112
  s_add_u32 s46, s24, 0
 Mvva 180,216,100
 TR 212,35,28416
 Mvva 180,220,116
  buffer_load_dwordx4 a[0:3], v16, s[20:23], s46 offen offset:0 sc1
 Mvva 184,216,104
 TR 214,35,28928
 Mvva 184,220,120
 Mvva 188,216,108
 TR 216,35,18976
 WL 7
 Mvva 188,220,124
  buffer_load_dwordx4 a[4:7], v16, s[20:23], s46 offen offset:2048 sc1
 Mvva 192,224,96
 TR 218,35,19488
 WL 6
 Mvva 192,228,112
 Mvva 196,224,100
 TR 220,35,28448
 Mvva 196,228,116
 Mvva 200,224,104
 TR 222,35,28960
 Mvva 200,228,120
  buffer_load_dwordx4 a[8:11], v17, s[20:23], s46 offen offset:0 sc1
 Mvva 204,224,108
 TR 224,35,19008
 Mvva 204,228,124
 WL 7
 Mvva 64,208,128
 TR 226,35,19520
 WL 6
 Mvvv 64,212,40
  buffer_load_dwordx4 a[12:15], v17, s[20:23], s46 offen offset:2048 sc1
 Mvva 68,208,132
 TR 228,35,28480
 Mvvv 68,212,44
  s_add_u32 s46, s24, 8192
 Mvva 72,208,136
 TR 230,35,28992
 Mvvv 72,212,48
  buffer_load_dwordx4 a[16:19], v16, s[20:23], s46 offen offset:0 sc1
 Mvva 76,208,140
 TR 208,35,19040
 Mvvv 76,212,52
 WL 7
 Mvva 80,216,128
 TR 210,35,19552
 WL 6
 Mvvv 80,220,40
 Mvva 84,216,132
 TR 212,35,28512
 Mvvv 84,220,44
  buffer_load_dwordx4 a[20:23], v16, s[20:23], s46 offen offset:2048 sc1
 Mvva 88,216,136
 TR 214,35,29024
 Mvvv 88,220,48
 Mvva 92,216,140
 TR 216,35,19072
 WL 7
 Mvvv 92,220,52
  buffer_load_dwordx4 a[24:27], v17, s[20:23], s46 offen offset:0 sc1
 Mvva 96,224,128
 TR 218,35,19584
 WL 6
 Mvvv 96,228,40
 Mvva 100,224,132
 TR 220,35,28544
 Mvvv 100,228,44
 Mvva 104,224,136
 TR 222,35,29056
 Mvvv 104,228,48
  buffer_load_dwordx4 a[28:31], v17, s[20:23], s46 offen offset:2048 sc1
 Mvva 108,224,140
 TR 224,35,19104
  s_add_u32 s46, s24, 16384
 Mvvv 108,228,52
 WL 7
 Mvva 112,208,128
 TR 226,35,19616
 WL 6
 Mvvv 112,212,40
  buffer_load_dwordx4 a[32:35], v16, s[20:23], s46 offen offset:0 sc1
 Mvva 116,208,132
 TR 228,35,28576
 Mvvv 116,212,44
 Mvva 120,208,136
 TR 230,35,29088
 Mvvv 120,212,48
  buffer_load_dwordx4 a[36:39], v16, s[20:23], s46 offen offset:2048 sc1
 Mvva 124,208,140
 TR 208,35,19136
 Mvvv 124,212,52
 WL 7
 Mvva 128,216,128
 TR 210,35,19648
 WL 6
 Mvvv 128,220,40
 Mvva 132,216,132
 TR 212,35,28608
 Mvvv 132,220,44
  buffer_load_dwordx4 a[40:43], v17, s[20:23], s46 offen offset:0 sc1
 Mvva 136,216,136
 TR 214,35,29120
 Mvvv 136,220,48
 Mvva 140,216,140
 TR 216,35,19168
 WL 7
 Mvvv 140,220,52
  buffer_load_dwordx4 a[44:47], v17, s[20:23], s46 offen offset:2048 sc1
 Mvva 144,224,128
 TR 218,35,19680
 WL 6
 Mvvv 144,228,40
  s_add_u32 s46, s24, 24576
 Mvva 148,224,132
 TR 220,35,28640
 Mvvv 148,228,44
  buffer_load_dwordx4 a[48:51], v16, s[20:23], s46 offen offset:0 sc1
 Mvva 152,224,136
 TR 222,35,29152
 Mvvv 152,228,48
 Mvva 156,224,140
 TR 224,59,18944
 Mvvv 156,228,52
 WL 7
 Mvva 160,208,128
 TR 226,59,19456
 WL 6
 Mvvv 160,212,40
  buffer_load_dwordx4 a[52:55], v16, s[20:23], s46 offen offset:2048 sc1
 Mvva 164,208,132
 TR 228,59,28416
 Mvvv 164,212,44
 Mvva 168,208,136
 TR 230,59,28928
 Mvvv 168,212,48
  buffer_load_dwordx4 a[56:59], v17, s[20:23], s46 offen offset:0 sc1
 Mvva 172,208,140
 Mvvv 172,212,52
 WL 6
 Mvva 176,216,128
 WL 4
 Mvvv 176,220,40
 WL 0
  s_barrier
 Mvva 180,216,132
 TR 208,32,0
  s_add_u32 s44, s44, 1179648
 Mvvv 180,220,44
 TR 210,32,512
 Mvva 184,216,136
 TR 212,32,9472
  s_add_u32 m0, s47, 88064
 Mvvv 184,220,48
 TR 214,32,9984
 Mvva 188,216,140
 TR 216,32,32
 Mvvv 188,220,52
  buffer_load_dwordx4 a[60:63], v17, s[20:23], s46 offen offset:2048 sc1
 Mvva 192,224,128
 TR 218,32,544
 Mvvv 192,228,40
  buffer_load_dwordx4 v1, s[40:43], s44 offen lds
 Mvva 196,224,132
 TR 220,32,9504
 Mvvv 196,228,44
  buffer_load_dwordx4 v2, s[40:43], s44 offen offset:1056 lds
 Mvva 200,224,136
 TR 222,32,10016
 Mvvv 200,228,48
 Mvva 204,224,140
 TR 224,32,64
 WL 7
 Mvvv 204,228,52
  buffer_load_dwordx4 v3, s[40:43], s44 offen offset:2112 lds
 Mvva 64,208,212
 TR 226,32,576
 WL 6
 Mvva 64,212,228
 Mvva 68,208,216
 TR 228,32,9536
 Mvva 68,212,232
 Mvva 72,208,220
 TR 230,32,10048
 Mvva 72,212,236
  buffer_load_dwordx4 v4, s[40:43], s44 offen offset:3168 lds
 Mvva 76,208,224
 TR 208,32,96
 Mvva 76,212,240
  s_add_u32 m0, s47, 92288
 WL 7
 Mvva 80,216,212
 TR 210,32,608
 WL 6
 Mvva 80,220,228
  buffer_load_dwordx4 v5, s[40:43], s44 offen lds
 Mvva 84,216,216
 TR 212,32,9568
 Mvva 84,220,232
 Mvva 88,216,220
 TR 214,32,10080
 Mvva 88,220,236
  buffer_load_dwordx4 v6, s[40:43], s44 offen offset:1056 lds
 Mvva 92,216,224
 TR 216,32,128
 Mvva 92,220,240
 WL 7
 Mvva 96,224,212
 TR 218,32,640
 WL 6
 Mvva 96,228,228
 Mvva 100,224,216
 TR 220,32,9600
 Mvva 100,228,232
  buffer_load_dwordx4 v7, s[40:43], s44 offen offset:2112 lds
 Mvva 104,224,220
 TR 222,32,10112
 Mvva 104,228,236
 Mvva 108,224,224
 TR 224,32,160
 WL 7
 Mvva 108,228,240
  buffer_load_dwordx4 v8, s[40:43], s44 offen offset:3168 lds
 Mvva 112,208,212
 TR 226,32,672
 WL 6
 Mvva 112,212,228
  s_add_u32 m0, s47, 96512
 Mvva 116,208,216
 TR 228,32,9632
 Mvva 116,212,232
  buffer_load_dwordx4 v9, s[20:23], s44 offen sc1 lds
 Mvva 120,208,220
 TR 230,32,10144
 Mvva 120,212,236
 Mvva 124,208,224
 TR 208,32,192
  s_add_u32 s46, s24, 32768
 Mvva 124,212,240
 WL 7
 Mvva 128,216,212
 TR 210,32,704
 WL 6
 Mvva 128,220,228
  buffer_load_dwordx4 a[64:67], v16, s[20:23], s46 offen offset:0 sc1
 Mvva 132,216,216
 TR 212,32,9664
 Mvva 132,220,232
 Mvva 136,216,220
 TR 214,32,10176
 Mvva 136,220,236
  buffer_load_dwordx4 a[68:71], v16, s[20:23], s46 offen offset:2048 sc1
 Mvva 140,216,224
 TR 216,32,224
 Mvva 140,220,240
 WL 7
 Mvva 144,224,212
 TR 218,32,736
 WL 6
 Mvva 144,228,228
 Mvva 148,224,216
 TR 220,32,9696
 Mvva 148,228,232
  buffer_load_dwordx4 a[72:75], v17, s[20:23], s46 offen offset:0 sc1
 Mvva 152,224,220
 TR 222,32,10208
 Mvva 152,228,236
 Mvva 156,224,224
 TR 224,56,0
 WL 7
 Mvva 156,228,240
  buffer_load_dwordx4 a[76:79], v17, s[20:23], s46 offen offset:2048 sc1
 Mvva 160,208,212
 TR 226,56,512
 WL 6
 Mvva 160,212,228
  s_add_u32 s46, s24, 40960
 Mvva 164,208,216
 TR 228,56,9472
 Mvva 164,212,232
  buffer_load_dwordx4 a[80:83], v16, s[20:23], s46 offen offset:0 sc1
 Mvva 168,208,220
 TR 230,56,9984
 Mvva 168,212,236
 Mvva 172,208,224
 TR 208,32,18944
 Mvva 172,212,240
 WL 7
 Mvva 176,216,212
 TR 210,32,19456
 WL 6
 Mvva 176,220,228
  buffer_load_dwordx4 a[84:87], v16, s[20:23], s46 offen offset:2048 sc1
 Mvva 180,216,216
 TR 212,32,28416
 Mvva 180,220,232
 Mvva 184,216,220
 TR 214,32,28928
 Mvva 184,220,236
  buffer_load_dwordx4 a[88:91], v17, s[20:23], s46 offen offset:0 sc1
 Mvva 188,216,224
 TR 216,32,18976
 Mvva 188,220,240
 WL 7
 Mvva 192,224,212
 TR 218,32,19488
 WL 6
 Mvva 192,228,228
  buffer_load_dwordx4 a[92:95], v17, s[20:23], s46 offen offset:2048 sc1
 Mvva 196,224,216
 TR 220,32,28448
 Mvva 196,228,232
 Mvva 200,224,220
 TR 222,32,28960
 Mvva 200,228,236
  s_add_u32 s46, s24, 49152
 Mvva 204,224,224
 TR 224,32,19008
 WL 7
 Mvva 204,228,240
  buffer_load_dwordx4 a[96:99], v16, s[20:23], s46 offen offset:0 sc1
 Mvva 64,208,176
 TR 226,32,19520
 WL 6
 Mvva 64,212,192
 Mvva 68,208,180
 TR 228,32,28480
 Mvva 68,212,196
  buffer_load_dwordx4 a[100:103], v16, s[20:23], s46 offen offset:2048 sc1
 Mvva 72,208,184
 TR 230,32,28992
 Mvva 72,212,200
 Mvva 76,208,188
 TR 208,32,19040
 WL 7
 Mvva 76,212,204
  buffer_load_dwordx4 a[104:107], v17, s[20:23], s46 offen offset:0 sc1
 Mvva 80,216,176
 TR 210,32,19552
 WL 6
 Mvva 80,220,192
 Mvva 84,216,180
 TR 212,32,28512
 Mvva 84,220,196
 Mvva 88,216,184
 TR 214,32,29024
 Mvva 88,220,200
  buffer_load_dwordx4 a[108:111], v17, s[20:23], s46 offen offset:2048 sc1
 Mvva 92,216,188
 TR 216,32,19072
 Mvva 92,220,204
  s_add_u32 s46, s24, 57344
 WL 7
 Mvva 96,224,176
 TR 218,32,19584
 WL 6
 Mvva 96,228,192
  buffer_load_dwordx4 a[112:115], v16, s[20:23], s46 offen offset:0 sc1
 Mvva 100,224,180
 TR 220,32,28544
 Mvva 100,228,196
 Mvva 104,224,184
 TR 222,32,29056
 Mvva 104,228,200
  buffer_load_dwordx4 a[116:119], v16, s[20:23], s46 offen offset:2048 sc1
 Mvva 108,224,188
 TR 224,32,19104
 Mvva 108,228,204
 WL 7
 Mvva 112,208,176
 TR 226,32,19616
 WL 6
 Mvva 112,212,192
 Mvva 116,208,180
 TR 228,32,28576
 Mvva 116,212,196
  buffer_load_dwordx4 a[120:123], v17, s[20:23], s46 offen offset:0 sc1
 Mvva 120,208,184
 TR 230,32,29088
 Mvva 120,212,200
 Mvva 124,208,188
 TR 208,32,19136
 WL 7
 Mvva 124,212,204
  buffer_load_dwordx4 a[124:127], v17, s[20:23], s46 offen offset:2048 sc1
 Mvva 128,216,176
 TR 210,32,19648
 WL 6
 Mvva 128,220,192
  s_add_u32 s46, s24, 65536
 Mvva 132,216,180
 TR 212,32,28608
 Mvva 132,220,196
  buffer_load_dwordx4 a[128:131], v16, s[20:23], s46 offen offset:0 sc1
 Mvva 136,216,184
 TR 214,32,29120
 Mvva 136,220,200
  global_load_dword a248, v249, s[100:101]
 Mvva 140,216,188
 TR 216,32,19168
 Mvva 140,220,204
 WL 7
 Mvva 144,224,176
 TR 218,32,19680
 WL 6
 Mvva 144,228,192
  buffer_load_dwordx4 a[132:135], v16, s[20:23], s46 offen offset:2048 sc1
 Mvva 148,224,180
 TR 220,32,28640
 Mvva 148,228,196
 Mvva 152,224,184
 TR 222,32,29152
 Mvva 152,228,200
  buffer_load_dwordx4 a[136:139], v17, s[20:23], s46 offen offset:0 sc1
 Mvva 156,224,188
 TR 224,56,18944
 Mvva 156,228,204
 WL 7
 Mvva 160,208,176
 TR 226,56,19456
 WL 6
 Mvva 160,212,192
  buffer_load_dwordx4 a[140:143], v17, s[20:23], s46 offen offset:2048 sc1
 Mvva 164,208,180
 TR 228,56,28416
 Mvva 164,212,196
 Mvva 168,208,184
 TR 230,56,28928
  s_add_u32 s46, s24, 73728
 Mvva 168,212,200
 Mvva 172,208,188
  buffer_load_dwordx4 v[40:43], v16, s[20:23], s46 offen offset:0 sc1
 Mvva 172,212,204
 WL 6
 Mvva 176,216,176
 WL 4
 Mvva 176,220,192
 WL 0
  s_waitcnt vmcnt(62)
  s_barrier
 Mvva 180,216,180
 TR 208,33,0
  s_add_u32 s44, s44, 1179648
 Mvva 180,220,196
 TR 210,33,512
  s_add_u32 m0, s47, 12288
 Mvva 184,216,184
 TR 212,33,9472
 Mvva 184,220,200
 TR 214,33,9984
 Mvva 188,216,188
 TR 216,33,32
 Mvva 188,220,204
  buffer_load_dwordx4 v1, s[40:43], s44 offen lds
 Mvva 192,224,176
 TR 218,33,544
 Mvva 192,228,192
  buffer_load_dwordx4 v2, s[40:43], s44 offen offset:1056 lds
 Mvva 196,224,180
 TR 220,33,9504
 Mvva 196,228,196
 Mvva 200,224,184
 TR 222,33,10016
  s_waitcnt vmcnt(58)
 Mvva 200,228,200
  buffer_load_dwordx4 v3, s[40:43], s44 offen offset:2112 lds
 Mvva 204,224,188
 TR 224,33,64
 Mvva 204,228,204
 WL 7
 Mvva 64,208,144
 TR 226,33,576
 WL 6
 Mvva 64,212,160
  buffer_load_dwordx4 v4, s[40:43], s44 offen offset:3168 lds
 Mvva 68,208,148
 TR 228,33,9536
 Mvva 68,212,164
 Mvva 72,208,152
 TR 230,33,10048
  s_add_u32 m0, s47, 16512
 Mvva 72,212,168
 Mvva 76,208,156
 TR 208,33,96
 WL 7
 Mvva 76,212,172
  buffer_load_dwordx4 v5, s[40:43], s44 offen lds
 Mvva 80,216,144
 TR 210,33,608
 WL 6
 Mvva 80,220,160
 Mvva 84,216,148
 TR 212,33,9568
 Mvva 84,220,164
  buffer_load_dwordx4 v6, s[40:43], s44 offen offset:1056 lds
 Mvva 88,216,152
 TR 214,33,10080
 Mvva 88,220,168
 Mvva 92,216,156
 TR 216,33,128
 WL 7
 Mvva 92,220,172
  buffer_load_dwordx4 v7, s[40:43], s44 offen offset:2112 lds
 Mvva 96,224,144
 TR 218,33,640
 WL 6
 Mvva 96,228,160
 Mvva 100,224,148
 TR 220,33,9600
 Mvva 100,228,164
 Mvva 104,224,152
 TR 222,33,10112
 Mvva 104,228,168
  buffer_load_dwordx4 v8, s[40:43], s44 offen offset:3168 lds
 Mvva 108,224,156
 TR 224,33,160
  s_add_u32 m0, s47, 20736
 Mvva 108,228,172
 WL 7
 Mvva 112,208,144
 TR 226,33,672
 WL 6
 Mvva 112,212,160
  buffer_load_dwordx4 v9, s[20:23], s44 offen sc1 lds
 Mvva 116,208,148
 TR 228,33,9632
 Mvva 116,212,164
 Mvva 120,208,152
 TR 230,33,10144
 Mvva 120,212,168
  buffer_load_dwordx4 v[44:47], v16, s[20:23], s46 offen offset:2048 sc1
 Mvva 124,208,156
 TR 208,33,192
 Mvva 124,212,172
 WL 7
 Mvva 128,216,144
 TR 210,33,704
 WL 6
 Mvva 128,220,160
 Mvva 132,216,148
 TR 212,33,9664
 Mvva 132,220,164
  buffer_load_dwordx4 v[48:51], v17, s[20:23], s46 offen offset:0 sc1
 Mvva 136,216,152
 TR 214,33,10176
 Mvva 136,220,168
 Mvva 140,216,156
 TR 216,33,224
 WL 7
 Mvva 140,220,172
  buffer_load_dwordx4 v[52:55], v17, s[20:23], s46 offen offset:2048 sc1
 Mvva 144,224,144
 TR 218,33,736
 WL 6
 Mvva 144,228,160
  s_add_u32 s46, s24, 81920
 Mvva 148,224,148
 TR 220,33,9696
 Mvva 148,228,164
  buffer_load_dwordx4 a[212:215], v16, s[20:23], s46 offen offset:0 sc1
 Mvva 152,224,152
 TR 222,33,10208
 Mvva 152,228,168
 Mvva 156,224,156
 TR 224,57,0
 Mvva 156,228,172
 WL 7
 Mvva 160,208,144
 TR 226,57,512
 WL 6
 Mvva 160,212,160
  buffer_load_dwordx4 a[216:219], v16, s[20:23], s46 offen offset:2048 sc1
 Mvva 164,208,148
 TR 228,57,9472
 Mvva 164,212,164
 Mvva 168,208,152
 TR 230,57,9984
 Mvva 168,212,168
  buffer_load_dwordx4 a[220:223], v17, s[20:23], s46 offen offset:0 sc1
 Mvva 172,208,156
 Mvva 172,212,172
 WL 6
 Mvva 176,216,144
 WL 4
 Mvva 176,220,160
 WL 0
  s_waitcnt vmcnt(62)
  s_barrier
 Mvva 180,216,148
 TR 208,34,0
  s_add_u32 s44, s44, 1179648
 Mvva 180,220,164
 TR 210,34,512
 Mvva 184,216,152
 TR 212,34,9472
  s_add_u32 m0, s47, 125952
 Mvva 184,220,168
 TR 214,34,9984
 Mvva 188,216,156
 TR 216,34,32
 Mvva 188,220,172
  buffer_load_dwordx4 a[224:227], v17, s[20:23], s46 offen offset:2048 sc1
 Mvva 192,224,144
 TR 218,34,544
 Mvva 192,228,160
  buffer_load_dwordx4 v1, s[40:43], s44 offen lds
 Mvva 196,224,148
 TR 220,34,9504
 Mvva 196,228,164
  buffer_load_dwordx4 v2, s[40:43], s44 offen offset:1056 lds
 Mvva 200,224,152
 TR 222,34,10016
  s_waitcnt vmcnt(57)
 Mvva 200,228,168
 Mvva 204,224,156
 TR 224,34,64
 WL 7
 Mvva 204,228,172
  buffer_load_dwordx4 v3, s[40:43], s44 offen offset:2112 lds
 Mvva 64,208,0
 TR 226,34,576
 WL 6
 Mvva 64,212,16
 Mvva 68,208,4
 TR 228,34,9536
 Mvva 68,212,20
 Mvva 72,208,8
 TR 230,34,10048
 Mvva 72,212,24
  buffer_load_dwordx4 v4, s[40:43], s44 offen offset:3168 lds
 Mvva 76,208,12
 TR 208,34,96
 Mvva 76,212,28
  s_add_u32 m0, s47, 130176
 WL 7
 Mvva 80,216,0
 TR 210,34,608
 WL 6
 Mvva 80,220,16
  buffer_load_dwordx4 v5, s[40:43], s44 offen lds
 Mvva 84,216,4
 TR 212,34,9568
 Mvva 84,220,20
 Mvva 88,216,8
 TR 214,34,10080
 Mvva 88,220,24
 Mvva 92,216,12
 TR 216,34,128
 WL 7
 Mvva 92,220,28
  buffer_load_dwordx4 v6, s[40:43], s44 offen offset:1056 lds
 Mvva 96,224,0
 TR 218,34,640
 WL 6
 Mvva 96,228,16
 Mvva 100,224,4
 TR 220,34,9600
 Mvva 100,228,20
  buffer_load_dwordx4 v7, s[40:43], s44 offen offset:2112 lds
 Mvva 104,224,8
 TR 222,34,10112
 Mvva 104,228,24
 Mvva 108,224,12
 TR 224,34,160
 WL 7
 Mvva 108,228,28
  buffer_load_dwordx4 v8, s[40:43], s44 offen offset:3168 lds
 Mvva 112,208,0
 TR 226,34,672
 WL 6
 Mvva 112,212,16
 Mvva 116,208,4
 TR 228,34,9632
  s_add_u32 m0, s47, 134400
 Mvva 116,212,20
 Mvva 120,208,8
 TR 230,34,10144
 Mvva 120,212,24
  buffer_load_dwordx4 v9, s[20:23], s44 offen sc1 lds
 Mvva 124,208,12
 TR 208,34,192
  s_add_u32 s46, s24, 90112
 Mvva 124,212,28
 WL 7
 Mvva 128,216,0
 TR 210,34,704
 WL 6
 Mvva 128,220,16
  buffer_load_dwordx4 a[228:231], v16, s[20:23], s46 offen offset:0 sc1
 Mvva 132,216,4
 TR 212,34,9664
 Mvva 132,220,20
 Mvva 136,216,8
 TR 214,34,10176
 Mvva 136,220,24
  buffer_load_dwordx4 a[232:235], v16, s[20:23], s46 offen offset:2048 sc1
 Mvva 140,216,12
 TR 216,34,224
 Mvva 140,220,28
 WL 7
 Mvva 144,224,0
 TR 218,34,736
 WL 6
 Mvva 144,228,16
 Mvva 148,224,4
 TR 220,34,9696
 Mvva 148,228,20
  buffer_load_dwordx4 a[236:239], v17, s[20:23], s46 offen offset:0 sc1
 Mvva 152,224,8
 TR 222,34,10208
 Mvva 152,228,24
 Mvva 156,224,12
 TR 224,58,0
 WL 7
 Mvva 156,228,28
  buffer_load_dwordx4 a[240:243], v17, s[20:23], s46 offen offset:2048 sc1
 Mvva 160,208,0
 TR 226,58,512
 WL 6
 Mvva 160,212,16
  s_add_u32 s46, s24, 98304
 Mvva 164,208,4
 TR 228,58,9472
 Mvva 164,212,20
  buffer_load_dwordx4 a[176:179], v16, s[20:23], s46 offen offset:0 sc1
 Mvva 168,208,8
 TR 230,58,9984
 Mvva 168,212,24
 Mvva 172,208,12
 TR 208,34,18944
 Mvva 172,212,28
 WL 7
 Mvva 176,216,0
 TR 210,34,19456
 WL 6
 Mvva 176,220,16
  buffer_load_dwordx4 a[180:183], v16, s[20:23], s46 offen offset:2048 sc1
 Mvva 180,216,4
 TR 212,34,28416
 Mvva 180,220,20
 Mvva 184,216,8
 TR 214,34,28928
 Mvva 184,220,24
  buffer_load_dwordx4 a[184:187], v17, s[20:23], s46 offen offset:0 sc1
 Mvva 188,216,12
 TR 216,34,18976
 Mvva 188,220,28
 WL 7
 Mvva 192,224,0
 TR 218,34,19488
 WL 6
 Mvva 192,228,16
  buffer_load_dwordx4 a[188:191], v17, s[20:23], s46 offen offset:2048 sc1
 Mvva 196,224,4
 TR 220,34,28448
 Mvva 196,228,20
 Mvva 200,224,8
 TR 222,34,28960
  s_waitcnt vmcnt(62)
 Mvva 200,228,24
  s_add_u32 s46, s24, 106496
 Mvva 204,224,12
 TR 224,34,19008
 WL 7
 Mvva 204,228,28
  buffer_load_dwordx4 a[192:195], v16, s[20:23], s46 offen offset:0 sc1
 Mvva 64,208,32
 TR 226,34,19520
 WL 6
 Mvva 64,212,48
 Mvva 68,208,36
 TR 228,34,28480
 Mvva 68,212,52
  buffer_load_dwordx4 a[196:199], v16, s[20:23], s46 offen offset:2048 sc1
 Mvva 72,208,40
 TR 230,34,28992
 Mvva 72,212,56
 Mvva 76,208,44
 TR 208,34,19040
 WL 7
 Mvva 76,212,60
  buffer_load_dwordx4 a[200:203], v17, s[20:23], s46 offen offset:0 sc1
 Mvva 80,216,32
 TR 210,34,19552
 WL 6
 Mvva 80,220,48
 Mvva 84,216,36
 TR 212,34,28512
 Mvva 84,220,52
 Mvva 88,216,40
 TR 214,34,29024
 Mvva 88,220,56
  buffer_load_dwordx4 a[204:207], v17, s[20:23], s46 offen offset:2048 sc1
 Mvva 92,216,44
 TR 216,34,19072
 Mvva 92,220,60
  s_add_u32 s46, s24, 114688
 WL 7
 Mvva 96,224,32
 TR 218,34,19584
 WL 6
 Mvva 96,228,48
  buffer_load_dwordx4 a[144:147], v16, s[20:23], s46 offen offset:0 sc1
 Mvva 100,224,36
 TR 220,34,28544
 Mvva 100,228,52
 Mvva 104,224,40
 TR 222,34,29056
 Mvva 104,228,56
  buffer_load_dwordx4 a[148:151], v16, s[20:23], s46 offen offset:2048 sc1
 Mvva 108,224,44
 TR 224,34,19104
 Mvva 108,228,60
 WL 7
 Mvva 112,208,32
 TR 226,34,19616
 WL 6
 Mvva 112,212,48
 Mvva 116,208,36
 TR 228,34,28576
 Mvva 116,212,52
  buffer_load_dwordx4 a[152:155], v17, s[20:23], s46 offen offset:0 sc1
 Mvva 120,208,40
 TR 230,34,29088
 Mvva 120,212,56
 Mvva 124,208,44
 TR 208,34,19136
 WL 7
 Mvva 124,212,60
  buffer_load_dwordx4 a[156:159], v17, s[20:23], s46 offen offset:2048 sc1
 Mvva 128,216,32
 TR 210,34,19648
 WL 6
 Mvva 128,220,48
 Mvva 132,216,36
 TR 212,34,28608
  s_add_u32 s46, s24, 122880
 Mvva 132,220,52
 Mvva 136,216,40
 TR 214,34,29120
 Mvva 136,220,56
  buffer_load_dwordx4 a[160:163], v16, s[20:23], s46 offen offset:0 sc1
 Mvva 140,216,44
 TR 216,34,19168
 Mvva 140,220,60
 WL 7
 Mvva 144,224,32
 TR 218,34,19680
 WL 6
 Mvva 144,228,48
  buffer_load_dwordx4 a[164:167], v16, s[20:23], s46 offen offset:2048 sc1
 Mvva 148,224,36
 TR 220,34,28640
 Mvva 148,228,52
 Mvva 152,224,40
 TR 222,34,29152
 Mvva 152,228,56
  buffer_load_dwordx4 a[168:171], v17, s[20:23], s46 offen offset:0 sc1
 Mvva 156,224,44
 TR 224,58,18944
 Mvva 156,228,60
 WL 7
 Mvva 160,208,32
 TR 226,58,19456
 WL 6
 Mvva 160,212,48
 Mvva 164,208,36
 TR 228,58,28416
 Mvva 164,212,52
  buffer_load_dwordx4 a[172:175], v17, s[20:23], s46 offen offset:2048 sc1
 Mvva 168,208,40
 TR 230,58,28928
 Mvva 168,212,56
 Mvva 172,208,44
 Mvva 172,212,60
 WL 6
 Mvva 176,216,32
 WL 4
 Mvva 176,220,48
 WL 0
  s_waitcnt vmcnt(62)
  s_barrier
 Mvva 180,216,36
 TR 208,35,0
 Mvva 180,220,52
 TR 210,35,512
 Mvva 184,216,40
 TR 212,35,9472
 Mvva 184,220,56
 TR 214,35,9984
 Mvva 188,216,44
 TR 216,35,18944
 Mvva 188,220,60
 Mvva 192,224,32
 TR 218,35,19456
 Mvva 192,228,48
 Mvva 196,224,36
 TR 220,35,28416
 Mvva 196,228,52
 Mvva 200,224,40
 TR 222,35,28928
  s_waitcnt vmcnt(59)
 Mvva 200,228,56
 Mvva 204,224,44
 Mvva 204,228,60
 WL 6
 Mvva 64,208,64
 WL 4
 Mvva 64,212,80
 WL 0
  s_waitcnt vmcnt(36)
  s_barrier
 Mvva 68,208,68
 TR 224,32,0
 Mvva 68,212,84
 TR 226,32,512
 Mvva 72,208,72
 TR 228,32,9472
 Mvva 72,212,88
 TR 230,32,9984
 Mvva 76,208,76
 TR 208,32,18944
 Mvva 76,212,92
 Mvva 64,216,96
 TR 210,32,19456
 Mvva 64,220,112
 Mvva 68,216,100
 TR 212,32,28416
 Mvva 68,220,116
 Mvva 72,216,104
 TR 214,32,28928
  s_waitcnt vmcnt(33)
 Mvva 72,220,120
 Mvva 76,216,108
 Mvva 76,220,124
 WL 6
 Mvva 64,224,128
 WL 4
 Mvvv 64,228,40
 WL 0
  s_waitcnt vmcnt(20)
  s_barrier
 Mvva 68,224,132
 TR 216,33,0
 Mvvv 68,228,44
 TR 218,33,512
 Mvva 72,224,136
 TR 220,33,9472
  s_waitcnt vmcnt(16)
 Mvvv 72,228,48
 TR 222,33,9984
 Mvva 76,224,140
 TR 224,33,18944
 Mvvv 76,228,52
  global_load_dword a248, v249, s[100:101]
 Mvva 64,208,212
 TR 226,33,19456
 Mvva 64,212,228
 Mvva 68,208,216
 TR 228,33,28416
 Mvva 68,212,232
 Mvva 72,208,220
 TR 230,33,28928
  s_waitcnt vmcnt(9)
 Mvva 72,212,236
 Mvva 76,208,224
 TR 208,35,32
 Mvva 76,212,240
 WL 7
 Mvva 64,216,176
 TR 210,35,544
 WL 6
 Mvva 64,220,192
 Mvva 68,216,180
 TR 212,35,9504
 Mvva 68,220,196
 Mvva 72,216,184
 TR 214,35,10016
  s_waitcnt vmcnt(1)
 Mvva 72,220,200
 Mvva 76,216,188
 TR 216,35,18976
 Mvva 76,220,204
 WL 7
 WL 5
 Mvva 64,224,144
 TR 218,35,19488
  v_and_b32 v247, 7, v0
 Mvva 64,228,160
  v_lshlrev_b32 v247, 2, v247
 Mvva 68,224,148
 TR 220,35,28448
 Mvva 68,228,164
  buffer_load_dword v248, v247, s[20:23], s54 offen offset:32 sc1
 Mvva 72,224,152
 TR 222,35,28960
 Mvva 72,228,168
 Mvva 76,224,156
 TR 224,32,32
 Mvva 76,228,172
 WL 7
 WL 5
 Mvva 80,208,64
 TR 226,32,544
  v_cvt_pk_bf16_f32 v64, v64, v65
 Mvva 80,212,80
  v_cvt_pk_bf16_f32 v65, v66, v67
  v_cvt_pk_bf16_f32 v66, v68, v69
 Mvva 84,208,68
 TR 228,32,9504
  v_cvt_pk_bf16_f32 v67, v70, v71
 Mvva 84,212,84
  v_min_u32 v64, -2, v64
  v_min_u32 v65, -2, v65
 Mvva 88,208,72
 TR 230,32,10016
  v_min_u32 v66, -2, v66
 Mvva 88,212,88
  v_min_u32 v67, -2, v67
 WL 4
 Mvva 92,208,76
 TR 208,32,18976
 WL 7
 Mvva 92,212,92
  buffer_store_dwordx4 v[64:67], v16, s[8:11], 0 offen offset:0 sc1
 Mvva 80,216,96
 TR 210,32,19488
  v_cvt_pk_bf16_f32 v72, v72, v73
 Mvva 80,220,112
  v_cvt_pk_bf16_f32 v73, v74, v75
  v_cvt_pk_bf16_f32 v74, v76, v77
 Mvva 84,216,100
 TR 212,32,28448
  v_cvt_pk_bf16_f32 v75, v78, v79
 Mvva 84,220,116
  v_min_u32 v72, -2, v72
  v_min_u32 v73, -2, v73
 Mvva 88,216,104
 TR 214,32,28960
  v_min_u32 v74, -2, v74
 Mvva 88,220,120
  v_min_u32 v75, -2, v75
 Mvva 92,216,108
 TR 216,33,32
 WL 7
 Mvva 92,220,124
  buffer_store_dwordx4 v[72:75], v16, s[8:11], s50 offen offset:1024 sc1
 Mvva 80,224,128
 TR 218,33,544
 WL 6
 Mvvv 80,228,40
 Mvva 84,224,132
 TR 220,33,9504
 Mvvv 84,228,44
 Mvva 88,224,136
 TR 222,33,10016
 Mvvv 88,228,48
 Mvva 92,224,140
 TR 224,33,18976
 Mvvv 92,228,52
 WL 7
 Mvva 80,208,212
 TR 226,33,19488
 WL 6
 Mvva 80,212,228
 Mvva 84,208,216
 TR 228,33,28448
 Mvva 84,212,232
 Mvva 88,208,220
 TR 230,33,28960
 Mvva 88,212,236
 Mvva 92,208,224
 TR 208,35,64
 Mvva 92,212,240
 WL 7
 Mvva 80,216,176
 TR 210,35,576
 WL 6
 Mvva 80,220,192
 Mvva 84,216,180
 TR 212,35,9536
 Mvva 84,220,196
 Mvva 88,216,184
 TR 214,35,10048
 Mvva 88,220,200
 Mvva 92,216,188
 TR 216,35,19008
 Mvva 92,220,204
 WL 7
 Mvva 80,224,144
 TR 218,35,19520
 WL 6
 Mvva 80,228,160
 Mvva 84,224,148
 TR 220,35,28480
 Mvva 84,228,164
 Mvva 88,224,152
 TR 222,35,28992
 Mvva 88,228,168
 Mvva 92,224,156
 TR 224,32,64
 Mvva 92,228,172
 WL 7
 WL 5
 Mvva 96,208,64
 TR 226,32,576
  v_cvt_pk_bf16_f32 v80, v80, v81
 Mvva 96,212,80
  v_cvt_pk_bf16_f32 v81, v82, v83
  v_cvt_pk_bf16_f32 v82, v84, v85
 Mvva 100,208,68
 TR 228,32,9536
  v_cvt_pk_bf16_f32 v83, v86, v87
 Mvva 100,212,84
  v_min_u32 v80, -2, v80
  v_min_u32 v81, -2, v81
 Mvva 104,208,72
 TR 230,32,10048
  v_min_u32 v82, -2, v82
 Mvva 104,212,88
  v_min_u32 v83, -2, v83
 WL 4
 Mvva 108,208,76
 TR 208,32,19008
 WL 7
 Mvva 108,212,92
  buffer_store_dwordx4 v[80:83], v16, s[8:11], 0 offen offset:1024 sc1
 Mvva 96,216,96
 TR 210,32,19520
  v_cvt_pk_bf16_f32 v88, v88, v89
 Mvva 96,220,112
  v_cvt_pk_bf16_f32 v89, v90, v91
  v_cvt_pk_bf16_f32 v90, v92, v93
 Mvva 100,216,100
 TR 212,32,28480
  v_cvt_pk_bf16_f32 v91, v94, v95
 Mvva 100,220,116
  v_min_u32 v88, -2, v88
  v_min_u32 v89, -2, v89
 Mvva 104,216,104
 TR 214,32,28992
  v_min_u32 v90, -2, v90
 Mvva 104,220,120
  v_min_u32 v91, -2, v91
 Mvva 108,216,108
 TR 216,33,64
 WL 7
 Mvva 108,220,124
  buffer_store_dwordx4 v[88:91], v16, s[8:11], s50 offen offset:2048 sc1
 Mvva 96,224,128
 TR 218,33,576
 WL 6
 Mvvv 96,228,40
 Mvva 100,224,132
 TR 220,33,9536
 Mvvv 100,228,44
 Mvva 104,224,136
 TR 222,33,10048
 Mvvv 104,228,48
 Mvva 108,224,140
 TR 224,33,19008
 Mvvv 108,228,52
 WL 7
 Mvva 96,208,212
 TR 226,33,19520
 WL 6
 Mvva 96,212,228
 Mvva 100,208,216
 TR 228,33,28480
 Mvva 100,212,232
 Mvva 104,208,220
 TR 230,33,28992
 Mvva 104,212,236
 Mvva 108,208,224
 TR 208,35,96
 Mvva 108,212,240
 WL 7
 Mvva 96,216,176
 TR 210,35,608
 WL 6
 Mvva 96,220,192
 Mvva 100,216,180
 TR 212,35,9568
 Mvva 100,220,196
 Mvva 104,216,184
 TR 214,35,10080
  v_mov_b32 v246, 2
 Mvva 104,220,200
 Mvva 108,216,188
 TR 216,35,19040
 Mvva 108,220,204
 WL 7
 Mvva 96,224,144
 TR 218,35,19552
 WL 6
 Mvva 96,228,160
 Mvva 100,224,148
 TR 220,35,28512
 Mvva 100,228,164
 Mvva 104,224,152
 TR 222,35,29024
 Mvva 104,228,168
 Mvva 108,224,156
 TR 224,32,96
 Mvva 108,228,172
 WL 7
 WL 5
 Mvva 112,208,64
 TR 226,32,608
  v_cvt_pk_bf16_f32 v96, v96, v97
 Mvva 112,212,80
  v_cvt_pk_bf16_f32 v97, v98, v99
  v_cvt_pk_bf16_f32 v98, v100, v101
 Mvva 116,208,68
 TR 228,32,9568
  v_cvt_pk_bf16_f32 v99, v102, v103
 Mvva 116,212,84
  v_min_u32 v96, -2, v96
  v_min_u32 v97, -2, v97
 Mvva 120,208,72
 TR 230,32,10080
  v_min_u32 v98, -2, v98
 Mvva 120,212,88
  v_min_u32 v99, -2, v99
 WL 4
 Mvva 124,208,76
 TR 208,32,19040
 WL 7
 Mvva 124,212,92
  buffer_store_dwordx4 v[96:99], v16, s[8:11], 0 offen offset:2048 sc1
 Mvva 112,216,96
 TR 210,32,19552
  v_cvt_pk_bf16_f32 v104, v104, v105
 Mvva 112,220,112
  v_cvt_pk_bf16_f32 v105, v106, v107
  v_cvt_pk_bf16_f32 v106, v108, v109
 Mvva 116,216,100
 TR 212,32,28512
  v_cvt_pk_bf16_f32 v107, v110, v111
 Mvva 116,220,116
  v_min_u32 v104, -2, v104
  v_min_u32 v105, -2, v105
 Mvva 120,216,104
 TR 214,32,29024
  v_min_u32 v106, -2, v106
 Mvva 120,220,120
  v_min_u32 v107, -2, v107
 Mvva 124,216,108
 TR 216,33,96
 WL 7
 Mvva 124,220,124
  buffer_store_dwordx4 v[104:107], v16, s[8:11], s50 offen offset:3072 sc1
 Mvva 112,224,128
 TR 218,33,608
 WL 6
 Mvvv 112,228,40
 Mvva 116,224,132
 TR 220,33,9568
 Mvvv 116,228,44
 Mvva 120,224,136
 TR 222,33,10080
 Mvvv 120,228,48
 Mvva 124,224,140
 TR 224,33,19040
 Mvvv 124,228,52
 WL 7
 Mvva 112,208,212
 TR 226,33,19552
 WL 6
 Mvva 112,212,228
 Mvva 116,208,216
 TR 228,33,28512
 Mvva 116,212,232
 Mvva 120,208,220
 TR 230,33,29024
 Mvva 120,212,236
 Mvva 124,208,224
 TR 208,35,128
 Mvva 124,212,240
 WL 7
 Mvva 112,216,176
 TR 210,35,640
 WL 6
 Mvva 112,220,192
 Mvva 116,216,180
 TR 212,35,9600
 Mvva 116,220,196
 Mvva 120,216,184
 TR 214,35,10112
 Mvva 120,220,200
 Mvva 124,216,188
 TR 216,35,19072
 Mvva 124,220,204
 WL 7
 Mvva 112,224,144
 TR 218,35,19584
 WL 6
 Mvva 112,228,160
 Mvva 116,224,148
 TR 220,35,28544
 Mvva 116,228,164
 Mvva 120,224,152
 TR 222,35,29056
 Mvva 120,228,168
 Mvva 124,224,156
 TR 224,32,128
 Mvva 124,228,172
 WL 7
 WL 5
 Mvva 128,208,64
 TR 226,32,640
  v_cvt_pk_bf16_f32 v112, v112, v113
 Mvva 128,212,80
  v_cvt_pk_bf16_f32 v113, v114, v115
  v_cvt_pk_bf16_f32 v114, v116, v117
 Mvva 132,208,68
 TR 228,32,9600
  v_cvt_pk_bf16_f32 v115, v118, v119
 Mvva 132,212,84
  v_min_u32 v112, -2, v112
  v_min_u32 v113, -2, v113
 Mvva 136,208,72
 TR 230,32,10112
  v_min_u32 v114, -2, v114
 Mvva 136,212,88
  v_min_u32 v115, -2, v115
 WL 4
 Mvva 140,208,76
 TR 208,32,19072
 WL 7
 Mvva 140,212,92
  buffer_store_dwordx4 v[112:115], v16, s[8:11], 0 offen offset:3072 sc1
 Mvva 128,216,96
 TR 210,32,19584
  v_cvt_pk_bf16_f32 v120, v120, v121
 Mvva 128,220,112
  v_cvt_pk_bf16_f32 v121, v122, v123
  v_cvt_pk_bf16_f32 v122, v124, v125
 Mvva 132,216,100
 TR 212,32,28544
  v_cvt_pk_bf16_f32 v123, v126, v127
 Mvva 132,220,116
  v_min_u32 v120, -2, v120
  v_min_u32 v121, -2, v121
 Mvva 136,216,104
 TR 214,32,29056
  v_min_u32 v122, -2, v122
 Mvva 136,220,120
  v_min_u32 v123, -2, v123
 Mvva 140,216,108
 TR 216,33,128
 WL 7
 Mvva 140,220,124
  buffer_store_dwordx4 v[120:123], v17, s[8:11], s50 offen offset:0 sc1
 Mvva 128,224,128
 TR 218,33,640
 WL 6
 Mvvv 128,228,40
 Mvva 132,224,132
 TR 220,33,9600
 Mvvv 132,228,44
 Mvva 136,224,136
 TR 222,33,10112
 Mvvv 136,228,48
 Mvva 140,224,140
 TR 224,33,19072
 Mvvv 140,228,52
 WL 7
 Mvva 128,208,212
 TR 226,33,19584
 WL 6
 Mvva 128,212,228
 Mvva 132,208,216
 TR 228,33,28544
 Mvva 132,212,232
 Mvva 136,208,220
 TR 230,33,29056
 Mvva 136,212,236
 Mvva 140,208,224
 TR 208,35,160
 Mvva 140,212,240
 WL 7
 Mvva 128,216,176
 TR 210,35,672
 WL 6
 Mvva 128,220,192
 Mvva 132,216,180
 TR 212,35,9632
 Mvva 132,220,196
 Mvva 136,216,184
 TR 214,35,10144
 Mvva 136,220,200
 Mvva 140,216,188
 TR 216,35,19104
 Mvva 140,220,204
 WL 7
 Mvva 128,224,144
 TR 218,35,19616
 WL 6
 Mvva 128,228,160
 Mvva 132,224,148
 TR 220,35,28576
 Mvva 132,228,164
 Mvva 136,224,152
 TR 222,35,29088
 Mvva 136,228,168
 Mvva 140,224,156
 TR 224,32,160
 Mvva 140,228,172
 WL 7
 WL 5
 Mvva 144,208,64
 TR 226,32,672
  v_cvt_pk_bf16_f32 v128, v128, v129
 Mvva 144,212,80
  v_cvt_pk_bf16_f32 v129, v130, v131
  v_cvt_pk_bf16_f32 v130, v132, v133
 Mvva 148,208,68
 TR 228,32,9632
  v_cvt_pk_bf16_f32 v131, v134, v135
 Mvva 148,212,84
  v_min_u32 v128, -2, v128
  v_min_u32 v129, -2, v129
 Mvva 152,208,72
 TR 230,32,10144
  v_min_u32 v130, -2, v130
 Mvva 152,212,88
  v_min_u32 v131, -2, v131
 WL 4
 Mvva 156,208,76
 TR 208,32,19104
 WL 7
 Mvva 156,212,92
  buffer_store_dwordx4 v[128:131], v17, s[8:11], 0 offen offset:0 sc1
 Mvva 144,216,96
 TR 210,32,19616
  v_cvt_pk_bf16_f32 v136, v136, v137
 Mvva 144,220,112
  v_cvt_pk_bf16_f32 v137, v138, v139
  v_cvt_pk_bf16_f32 v138, v140, v141
 Mvva 148,216,100
 TR 212,32,28576
  v_cvt_pk_bf16_f32 v139, v142, v143
 Mvva 148,220,116
  v_min_u32 v136, -2, v136
  v_min_u32 v137, -2, v137
 Mvva 152,216,104
 TR 214,32,29088
  v_min_u32 v138, -2, v138
 Mvva 152,220,120
  v_min_u32 v139, -2, v139
 Mvva 156,216,108
 TR 216,33,160
 WL 7
 Mvva 156,220,124
  buffer_store_dwordx4 v[136:139], v17, s[8:11], s50 offen offset:1024 sc1
 Mvva 144,224,128
 TR 218,33,672
 WL 6
 Mvvv 144,228,40
 Mvva 148,224,132
 TR 220,33,9632
 Mvvv 148,228,44
 Mvva 152,224,136
 TR 222,33,10144
 Mvvv 152,228,48
 Mvva 156,224,140
 TR 224,33,19104
 Mvvv 156,228,52
 WL 7
 Mvva 144,208,212
 TR 226,33,19616
 WL 6
 Mvva 144,212,228
 Mvva 148,208,216
 TR 228,33,28576
 Mvva 148,212,232
 Mvva 152,208,220
 TR 230,33,29088
 Mvva 152,212,236
 Mvva 156,208,224
 TR 208,35,192
 Mvva 156,212,240
 WL 7
 Mvva 144,216,176
 TR 210,35,704
 WL 6
 Mvva 144,220,192
 Mvva 148,216,180
 TR 212,35,9664
 Mvva 148,220,196
 Mvva 152,216,184
 TR 214,35,10176
 Mvva 152,220,200
 Mvva 156,216,188
 TR 216,35,19136
 Mvva 156,220,204
 WL 7
 Mvva 144,224,144
 TR 218,35,19648
 WL 6
 Mvva 144,228,160
 Mvva 148,224,148
 TR 220,35,28608
 Mvva 148,228,164
 Mvva 152,224,152
 TR 222,35,29120
 Mvva 152,228,168
 Mvva 156,224,156
 TR 224,32,192
 Mvva 156,228,172
 WL 7
 WL 5
 Mvva 160,208,64
 TR 226,32,704
  v_cvt_pk_bf16_f32 v144, v144, v145
 Mvva 160,212,80
  v_cvt_pk_bf16_f32 v145, v146, v147
  v_cvt_pk_bf16_f32 v146, v148, v149
 Mvva 164,208,68
 TR 228,32,9664
  v_cvt_pk_bf16_f32 v147, v150, v151
 Mvva 164,212,84
  v_min_u32 v144, -2, v144
  v_min_u32 v145, -2, v145
 Mvva 168,208,72
 TR 230,32,10176
  v_min_u32 v146, -2, v146
 Mvva 168,212,88
  v_min_u32 v147, -2, v147
 WL 4
 Mvva 172,208,76
 TR 208,32,19136
 WL 7
 Mvva 172,212,92
  buffer_store_dwordx4 v[144:147], v17, s[8:11], 0 offen offset:1024 sc1
 Mvva 160,216,96
 TR 210,32,19648
  v_cvt_pk_bf16_f32 v152, v152, v153
 Mvva 160,220,112
  v_cvt_pk_bf16_f32 v153, v154, v155
  v_cvt_pk_bf16_f32 v154, v156, v157
 Mvva 164,216,100
 TR 212,32,28608
  v_cvt_pk_bf16_f32 v155, v158, v159
 Mvva 164,220,116
  s_waitcnt vmcnt(11)
  v_cmp_gt_u32 vcc, 1, v248
  s_nop 4
  s_cbranch_vccnz Lpoll_pz_11
Lback_pz_11:
 Mvva 168,216,104
 TR 214,32,29120
  v_min_u32 v152, -2, v152
 Mvva 168,220,120
 WL 6
  v_min_u32 v153, -2, v153
  v_min_u32 v154, -2, v154
 Mvva 172,216,108
 TR 216,33,192
  v_min_u32 v155, -2, v155
 Mvva 172,220,124
  buffer_store_dwordx4 v[152:155], v17, s[8:11], s50 offen offset:2048 sc1
 Mvva 160,224,128
 TR 218,33,704
  s_add_u32 s46, s55, 0
 WL 6
 Mvvv 160,228,40
  buffer_load_dwordx4 v[64:67], v28, s[20:23], s46 offen sc1
 Mvva 164,224,132
 TR 220,33,9664
 Mvvv 164,228,44
 Mvva 168,224,136
 TR 222,33,10176
 Mvvv 168,228,48
 Mvva 172,224,140
 TR 224,33,19136
 Mvvv 172,228,52
 WL 7
 WL 5
 Mvva 160,208,212
 TR 226,33,19648
  s_add_u32 s46, s55, 18432
 Mvva 160,212,228
  buffer_load_dwordx4 v[68:71], v28, s[20:23], s46 offen sc1
 Mvva 164,208,216
 TR 228,33,28608
 Mvva 164,212,232
  v_mov_b32 v128, 0
  v_mov_b32 v129, 0
 Mvva 168,208,220
 TR 230,33,29120
  v_mov_b32 v130, 0
 Mvva 168,212,236
 WL 4
  v_mov_b32 v131, 0
  v_mov_b32 v132, 0
 Mvva 172,208,224
 TR 208,35,224
  v_mov_b32 v133, 0
 Mvva 172,212,240
 WL 7
  v_mov_b32 v134, 0
  v_mov_b32 v135, 0
 Mvva 160,216,176
 TR 210,35,736
  v_mov_b32 v136, 0
 Mvva 160,220,192
  v_mov_b32 v137, 0
  v_mov_b32 v138, 0
 Mvva 164,216,180
 TR 212,35,9696
  s_add_u32 s46, s55, 36864
 Mvva 164,220,196
  buffer_load_dwordx4 v[72:75], v28, s[20:23], s46 offen sc1
 Mvva 168,216,184
 TR 214,35,10208
  v_mov_b32 v139, 0
 Mvva 168,220,200
 WL 4
  v_mov_b32 v140, 0
  v_mov_b32 v141, 0
 Mvva 172,216,188
 TR 216,35,19168
  v_mov_b32 v142, 0
 Mvva 172,220,204
 WL 7
  v_mov_b32 v143, 0
  v_mov_b32 v144, 0
 Mvva 160,224,144
 TR 218,35,19680
  v_mov_b32 v145, 0
 Mvva 160,228,160
 Mvva 164,224,148
 TR 220,35,28640
 Mvva 164,228,164
 Mvva 168,224,152
 TR 222,35,29152
  s_add_u32 s46, s55, 55296
 Mvva 168,228,168
  buffer_load_dwordx4 v[76:79], v28, s[20:23], s46 offen sc1
 Mvva 172,224,156
 TR 224,32,224
 Mvva 172,228,172
 WL 7
 WL 5
 Mvva 176,208,64
 TR 226,32,736
  v_cvt_pk_bf16_f32 v160, v160, v161
 Mvva 176,212,80
  v_cvt_pk_bf16_f32 v161, v162, v163
  v_cvt_pk_bf16_f32 v162, v164, v165
 Mvva 180,208,68
 TR 228,32,9696
  v_cvt_pk_bf16_f32 v163, v166, v167
 Mvva 180,212,84
  v_min_u32 v160, -2, v160
  v_min_u32 v161, -2, v161
 Mvva 184,208,72
 TR 230,32,10208
  v_min_u32 v162, -2, v162
 Mvva 184,212,88
 WL 4
  v_min_u32 v163, -2, v163
 WL 6
 Mvva 188,208,76
 TR 208,32,19168
  s_add_u32 s46, s55, 73728
 Mvva 188,212,92
  buffer_store_dwordx4 v[160:163], v17, s[8:11], 0 offen offset:2048 sc1
 Mvva 176,216,96
 TR 210,32,19680
  v_cvt_pk_bf16_f32 v168, v168, v169
 Mvva 176,220,112
  buffer_load_dwordx4 v[80:83], v28, s[20:23], s46 offen sc1
 Mvva 180,216,100
 TR 212,32,28640
  v_cvt_pk_bf16_f32 v169, v170, v171
 Mvva 180,220,116
  v_cvt_pk_bf16_f32 v170, v172, v173
  v_cvt_pk_bf16_f32 v171, v174, v175
 Mvva 184,216,104
 TR 214,32,29152
  v_min_u32 v168, -2, v168
 Mvva 184,220,120
 WL 6
  v_min_u32 v169, -2, v169
  v_min_u32 v170, -2, v170
 Mvva 188,216,108
 TR 216,33,224
  v_min_u32 v171, -2, v171
 Mvva 188,220,124
  buffer_store_dwordx4 v[168:171], v17, s[8:11], s50 offen offset:3072 sc1
 Mvva 176,224,128
 TR 218,33,736
  s_add_u32 s46, s55, 92160
 WL 6
 Mvvv 176,228,40
  buffer_load_dwordx4 v[84:87], v28, s[20:23], s46 offen sc1
 Mvva 180,224,132
 TR 220,33,9696
 Mvvv 180,228,44
 Mvva 184,224,136
 TR 222,33,10208
 Mvvv 184,228,48
 Mvva 188,224,140
 TR 224,33,19168
 Mvvv 188,228,52
 WL 7
 Mvva 176,208,212
 TR 226,33,19680
 WL 6
 Mvva 176,212,228
 Mvva 180,208,216
 TR 228,33,28640
  s_add_u32 s46, s55, 110592
 Mvva 180,212,232
  buffer_load_dword v248, v247, s[20:23], s54 offen offset:32 sc1
 Mvva 184,208,220
 TR 230,33,29152
 Mvva 184,212,236
  buffer_load_dwordx4 v[88:91], v28, s[20:23], s46 offen sc1
 Mvva 188,208,224
 TR 208,59,0
 Mvva 188,212,240
 WL 7
 Mvva 176,216,176
 TR 210,59,512
 WL 6
 Mvva 176,220,192
 Mvva 180,216,180
 TR 212,59,9472
 Mvva 180,220,196
 Mvva 184,216,184
 TR 214,59,9984
  s_add_u32 s46, s55, 129024
 Mvva 184,220,200
  buffer_load_dwordx4 v[92:95], v28, s[20:23], s46 offen sc1
 Mvva 188,216,188
 TR 216,59,18944
 Mvva 188,220,204
 WL 7
 Mvva 176,224,144
 TR 218,59,19456
 WL 6
 Mvva 176,228,160
 Mvva 180,224,148
 TR 220,59,28416
 Mvva 180,228,164
 Mvva 184,224,152
 TR 222,59,28928
 Mvva 184,228,168
 Mvva 188,224,156
 TR 224,56,0
 Mvva 188,228,172
 WL 7
 WL 5
 Mvva 192,208,64
 TR 226,56,512
  v_cvt_pk_bf16_f32 v176, v176, v177
 Mvva 192,212,80
  v_cvt_pk_bf16_f32 v177, v178, v179
  v_cvt_pk_bf16_f32 v178, v180, v181
 Mvva 196,208,68
 TR 228,56,9472
  v_cvt_pk_bf16_f32 v179, v182, v183
 Mvva 196,212,84
  v_min_u32 v176, -2, v176
  v_min_u32 v177, -2, v177
 Mvva 200,208,72
 TR 230,56,9984
  v_min_u32 v178, -2, v178
 Mvva 200,212,88
  v_min_u32 v179, -2, v179
 WL 4
 Mvva 204,208,76
 TR 208,56,18944
 WL 7
 Mvva 204,212,92
  buffer_store_dwordx4 v[176:179], v17, s[8:11], 0 offen offset:3072 sc1
 Mvva 192,216,96
 TR 210,56,19456
  v_cvt_pk_bf16_f32 v184, v184, v185
 Mvva 192,220,112
  buffer_store_dword v246, v245, s[20:23], s66 offen sc1
 Mvva 196,216,100
 TR 212,56,28416
  v_cvt_pk_bf16_f32 v185, v186, v187
 Mvva 196,220,116
  v_cvt_pk_bf16_f32 v186, v188, v189
  v_cvt_pk_bf16_f32 v187, v190, v191
 Mvva 200,216,104
 TR 214,56,28928
  v_min_u32 v184, -2, v184
 Mvva 200,220,120
 WL 6
  v_min_u32 v185, -2, v185
  v_min_u32 v186, -2, v186
 Mvva 204,216,108
 TR 216,57,0
  v_min_u32 v187, -2, v187
 Mvva 204,220,124
  buffer_store_dwordx4 v[184:187], v16, s[8:11], s51 offen offset:0 sc1
 Mvva 192,224,128
 TR 218,57,512
 WL 6
 Mvvv 192,228,40
 Mvva 196,224,132
 TR 220,57,9472
 Mvvv 196,228,44
 Mvva 200,224,136
 TR 222,57,9984
 Mvvv 200,228,48
 Mvva 204,224,140
 TR 224,57,18944
 Mvvv 204,228,52
 WL 7
 Mvva 192,208,212
 TR 226,57,19456
 WL 6
 Mvva 192,212,228
 Mvva 196,208,216
 TR 228,57,28416
 Mvva 196,212,232
 Mvva 200,208,220
 TR 230,57,28928
 Mvva 200,212,236
 Mvva 204,208,224
 Mvva 204,212,240
 WL 6
 Mvva 192,216,176
 WL 4
 Mvva 192,220,192
 Mvva 196,216,180
 Mvva 196,220,196
 Mvva 200,216,184
 Mvva 200,220,200
 Mvva 204,216,188
 Mvva 204,220,204
 WL 2
 Mvva 192,224,144
 WL 0
 Mvva 192,228,160
 Mvva 196,224,148
 Mvva 196,228,164
 Mvva 200,224,152
 Mvva 200,228,168
 Mvva 204,224,156
 Mvva 204,228,172
  s_nop 1
  v_cvt_pk_bf16_f32 v192, v192, v193
  v_cvt_pk_bf16_f32 v193, v194, v195
  v_cvt_pk_bf16_f32 v194, v196, v197
  v_cvt_pk_bf16_f32 v195, v198, v199
  v_min_u32 v192, -2, v192
  v_min_u32 v193, -2, v193
  v_min_u32 v194, -2, v194
  v_min_u32 v195, -2, v195
  buffer_store_dwordx4 v[192:195], v16, s[8:11], s50 offen offset:0 sc1
  v_cvt_pk_bf16_f32 v200, v200, v201
  v_cvt_pk_bf16_f32 v201, v202, v203
  v_cvt_pk_bf16_f32 v202, v204, v205
  v_cvt_pk_bf16_f32 v203, v206, v207
  v_min_u32 v200, -2, v200
  v_min_u32 v201, -2, v201
  v_min_u32 v202, -2, v202
  v_min_u32 v203, -2, v203
  buffer_store_dwordx4 v[200:203], v16, s[8:11], s51 offen offset:1024 sc1
  s_waitcnt vmcnt(7)
  v_cmp_gt_u32 vcc, 2, v248
  s_nop 4
  s_cbranch_vccnz Lpoll_red_11
Lback_red_11:
  s_add_u32 s46, s55, 4096
  buffer_load_dwordx4 v[96:99], v28, s[20:23], s46 offen sc1
  buffer_load_dword v232, v29, s[20:23], s46 offen sc1
  s_add_u32 s46, s55, 22528
  buffer_load_dwordx4 v[100:103], v28, s[20:23], s46 offen sc1
  buffer_load_dword v233, v29, s[20:23], s46 offen sc1
  s_add_u32 s46, s55, 40960
  buffer_load_dwordx4 v[104:107], v28, s[20:23], s46 offen sc1
  buffer_load_dword v234, v29, s[20:23], s46 offen sc1
  s_add_u32 s46, s55, 59392
  buffer_load_dwordx4 v[108:111], v28, s[20:23], s46 offen sc1
  buffer_load_dword v235, v29, s[20:23], s46 offen sc1
  s_add_u32 s46, s55, 77824
  buffer_load_dwordx4 v[112:115], v28, s[20:23], s46 offen sc1
  buffer_load_dword v236, v29, s[20:23], s46 offen sc1
  s_add_u32 s46, s55, 96256
  buffer_load_dwordx4 v[116:119], v28, s[20:23], s46 offen sc1
  buffer_load_dword v237, v29, s[20:23], s46 offen sc1
  s_add_u32 s46, s55, 114688
  buffer_load_dwordx4 v[120:123], v28, s[20:23], s46 offen sc1
  buffer_load_dword v238, v29, s[20:23], s46 offen sc1
  s_add_u32 s46, s55, 133120
  buffer_load_dwordx4 v[124:127], v28, s[20:23], s46 offen sc1
  buffer_load_dword v239, v29, s[20:23], s46 offen sc1
  s_load_dwordx2 s[16:17], s[0:1], 80
  s_mov_b32 s18, 0x240000
  s_mov_b32 s19, 0x00020000
Lchk_11:
  s_bitcmp1_b32 s57, 0
  s_cbranch_scc0 Lskip0_11
  v_max3_u32 v36, v64, v65, v66
  v_max3_u32 v36, v36, v67, v67
  v_cmp_eq_u32 vcc, -1, v36
  s_nop 4
  s_cbranch_vccnz Lskip0_11
  v_lshlrev_b32 v36, 16, v64
  v_and_b32 v37, 0xffff0000, v64
  v_pk_add_f32 v[128:129], v[128:129], v[36:37]
  v_lshlrev_b32 v36, 16, v65
  v_and_b32 v37, 0xffff0000, v65
  v_pk_add_f32 v[130:131], v[130:131], v[36:37]
  v_lshlrev_b32 v36, 16, v66
  v_and_b32 v37, 0xffff0000, v66
  v_pk_add_f32 v[132:133], v[132:133], v[36:37]
  v_lshlrev_b32 v36, 16, v67
  v_and_b32 v37, 0xffff0000, v67
  v_pk_add_f32 v[134:135], v[134:135], v[36:37]
  s_bitset0_b32 s57, 0
Lskip0_11:
  s_bitcmp1_b32 s57, 1
  s_cbranch_scc0 Lskip1_11
  v_max3_u32 v36, v68, v69, v70
  v_max3_u32 v36, v36, v71, v71
  v_cmp_eq_u32 vcc, -1, v36
  s_nop 4
  s_cbranch_vccnz Lskip1_11
  v_lshlrev_b32 v36, 16, v68
  v_and_b32 v37, 0xffff0000, v68
  v_pk_add_f32 v[128:129], v[128:129], v[36:37]
  v_lshlrev_b32 v36, 16, v69
  v_and_b32 v37, 0xffff0000, v69
  v_pk_add_f32 v[130:131], v[130:131], v[36:37]
  v_lshlrev_b32 v36, 16, v70
  v_and_b32 v37, 0xffff0000, v70
  v_pk_add_f32 v[132:133], v[132:133], v[36:37]
  v_lshlrev_b32 v36, 16, v71
  v_and_b32 v37, 0xffff0000, v71
  v_pk_add_f32 v[134:135], v[134:135], v[36:37]
  s_bitset0_b32 s57, 1
Lskip1_11:
  s_bitcmp1_b32 s57, 2
  s_cbranch_scc0 Lskip2_11
  v_max3_u32 v36, v72, v73, v74
  v_max3_u32 v36, v36, v75, v75
  v_cmp_eq_u32 vcc, -1, v36
  s_nop 4
  s_cbranch_vccnz Lskip2_11
  v_lshlrev_b32 v36, 16, v72
  v_and_b32 v37, 0xffff0000, v72
  v_pk_add_f32 v[128:129], v[128:129], v[36:37]
  v_lshlrev_b32 v36, 16, v73
  v_and_b32 v37, 0xffff0000, v73
  v_pk_add_f32 v[130:131], v[130:131], v[36:37]
  v_lshlrev_b32 v36, 16, v74
  v_and_b32 v37, 0xffff0000, v74
  v_pk_add_f32 v[132:133], v[132:133], v[36:37]
  v_lshlrev_b32 v36, 16, v75
  v_and_b32 v37, 0xffff0000, v75
  v_pk_add_f32 v[134:135], v[134:135], v[36:37]
  s_bitset0_b32 s57, 2
Lskip2_11:
  s_bitcmp1_b32 s57, 3
  s_cbranch_scc0 Lskip3_11
  v_max3_u32 v36, v76, v77, v78
  v_max3_u32 v36, v36, v79, v79
  v_cmp_eq_u32 vcc, -1, v36
  s_nop 4
  s_cbranch_vccnz Lskip3_11
  v_lshlrev_b32 v36, 16, v76
  v_and_b32 v37, 0xffff0000, v76
  v_pk_add_f32 v[128:129], v[128:129], v[36:37]
  v_lshlrev_b32 v36, 16, v77
  v_and_b32 v37, 0xffff0000, v77
  v_pk_add_f32 v[130:131], v[130:131], v[36:37]
  v_lshlrev_b32 v36, 16, v78
  v_and_b32 v37, 0xffff0000, v78
  v_pk_add_f32 v[132:133], v[132:133], v[36:37]
  v_lshlrev_b32 v36, 16, v79
  v_and_b32 v37, 0xffff0000, v79
  v_pk_add_f32 v[134:135], v[134:135], v[36:37]
  s_bitset0_b32 s57, 3
Lskip3_11:
  s_bitcmp1_b32 s57, 4
  s_cbranch_scc0 Lskip4_11
  v_max3_u32 v36, v80, v81, v82
  v_max3_u32 v36, v36, v83, v83
  v_cmp_eq_u32 vcc, -1, v36
  s_nop 4
  s_cbranch_vccnz Lskip4_11
  v_lshlrev_b32 v36, 16, v80
  v_and_b32 v37, 0xffff0000, v80
  v_pk_add_f32 v[128:129], v[128:129], v[36:37]
  v_lshlrev_b32 v36, 16, v81
  v_and_b32 v37, 0xffff0000, v81
  v_pk_add_f32 v[130:131], v[130:131], v[36:37]
  v_lshlrev_b32 v36, 16, v82
  v_and_b32 v37, 0xffff0000, v82
  v_pk_add_f32 v[132:133], v[132:133], v[36:37]
  v_lshlrev_b32 v36, 16, v83
  v_and_b32 v37, 0xffff0000, v83
  v_pk_add_f32 v[134:135], v[134:135], v[36:37]
  s_bitset0_b32 s57, 4
Lskip4_11:
  s_bitcmp1_b32 s57, 5
  s_cbranch_scc0 Lskip5_11
  v_max3_u32 v36, v84, v85, v86
  v_max3_u32 v36, v36, v87, v87
  v_cmp_eq_u32 vcc, -1, v36
  s_nop 4
  s_cbranch_vccnz Lskip5_11
  v_lshlrev_b32 v36, 16, v84
  v_and_b32 v37, 0xffff0000, v84
  v_pk_add_f32 v[128:129], v[128:129], v[36:37]
  v_lshlrev_b32 v36, 16, v85
  v_and_b32 v37, 0xffff0000, v85
  v_pk_add_f32 v[130:131], v[130:131], v[36:37]
  v_lshlrev_b32 v36, 16, v86
  v_and_b32 v37, 0xffff0000, v86
  v_pk_add_f32 v[132:133], v[132:133], v[36:37]
  v_lshlrev_b32 v36, 16, v87
  v_and_b32 v37, 0xffff0000, v87
  v_pk_add_f32 v[134:135], v[134:135], v[36:37]
  s_bitset0_b32 s57, 5
Lskip5_11:
  s_bitcmp1_b32 s57, 6
  s_cbranch_scc0 Lskip6_11
  s_waitcnt vmcnt(22)
  v_max3_u32 v36, v88, v89, v90
  v_max3_u32 v36, v36, v91, v91
  v_cmp_eq_u32 vcc, -1, v36
  s_nop 4
  s_cbranch_vccnz Lskip6_11
  v_lshlrev_b32 v36, 16, v88
  v_and_b32 v37, 0xffff0000, v88
  v_pk_add_f32 v[128:129], v[128:129], v[36:37]
  v_lshlrev_b32 v36, 16, v89
  v_and_b32 v37, 0xffff0000, v89
  v_pk_add_f32 v[130:131], v[130:131], v[36:37]
  v_lshlrev_b32 v36, 16, v90
  v_and_b32 v37, 0xffff0000, v90
  v_pk_add_f32 v[132:133], v[132:133], v[36:37]
  v_lshlrev_b32 v36, 16, v91
  v_and_b32 v37, 0xffff0000, v91
  v_pk_add_f32 v[134:135], v[134:135], v[36:37]
  s_bitset0_b32 s57, 6
Lskip6_11:
  s_bitcmp1_b32 s57, 7
  s_cbranch_scc0 Lskip7_11
  s_waitcnt vmcnt(21)
  v_max3_u32 v36, v92, v93, v94
  v_max3_u32 v36, v36, v95, v95
  v_cmp_eq_u32 vcc, -1, v36
  s_nop 4
  s_cbranch_vccnz Lskip7_11
  v_lshlrev_b32 v36, 16, v92
  v_and_b32 v37, 0xffff0000, v92
  v_pk_add_f32 v[128:129], v[128:129], v[36:37]
  v_lshlrev_b32 v36, 16, v93
  v_and_b32 v37, 0xffff0000, v93
  v_pk_add_f32 v[130:131], v[130:131], v[36:37]
  v_lshlrev_b32 v36, 16, v94
  v_and_b32 v37, 0xffff0000, v94
  v_pk_add_f32 v[132:133], v[132:133], v[36:37]
  v_lshlrev_b32 v36, 16, v95
  v_and_b32 v37, 0xffff0000, v95
  v_pk_add_f32 v[134:135], v[134:135], v[36:37]
  s_bitset0_b32 s57, 7
Lskip7_11:
  s_bitcmp1_b32 s57, 8
  s_cbranch_scc0 Lskip8_11
  s_waitcnt vmcnt(15)
  v_max3_u32 v36, v96, v97, v98
  s_waitcnt vmcnt(14)
  v_max3_u32 v36, v36, v99, v232
  v_cmp_eq_u32 vcc, -1, v36
  s_nop 4
  s_cbranch_vccnz Lskip8_11
  v_lshlrev_b32 v36, 16, v96
  v_and_b32 v37, 0xffff0000, v96
  v_pk_add_f32 v[136:137], v[136:137], v[36:37]
  v_lshlrev_b32 v36, 16, v97
  v_and_b32 v37, 0xffff0000, v97
  v_pk_add_f32 v[138:139], v[138:139], v[36:37]
  v_lshlrev_b32 v36, 16, v98
  v_and_b32 v37, 0xffff0000, v98
  v_pk_add_f32 v[140:141], v[140:141], v[36:37]
  v_lshlrev_b32 v36, 16, v99
  v_and_b32 v37, 0xffff0000, v99
  v_pk_add_f32 v[142:143], v[142:143], v[36:37]
  v_lshlrev_b32 v36, 16, v232
  v_and_b32 v37, 0xffff0000, v232
  v_pk_add_f32 v[144:145], v[144:145], v[36:37]
  s_bitset0_b32 s57, 8
Lskip8_11:
  s_bitcmp1_b32 s57, 9
  s_cbranch_scc0 Lskip9_11
  s_waitcnt vmcnt(13)
  v_max3_u32 v36, v100, v101, v102
  s_waitcnt vmcnt(12)
  v_max3_u32 v36, v36, v103, v233
  v_cmp_eq_u32 vcc, -1, v36
  s_nop 4
  s_cbranch_vccnz Lskip9_11
  v_lshlrev_b32 v36, 16, v100
  v_and_b32 v37, 0xffff0000, v100
  v_pk_add_f32 v[136:137], v[136:137], v[36:37]
  v_lshlrev_b32 v36, 16, v101
  v_and_b32 v37, 0xffff0000, v101
  v_pk_add_f32 v[138:139], v[138:139], v[36:37]
  v_lshlrev_b32 v36, 16, v102
  v_and_b32 v37, 0xffff0000, v102
  v_pk_add_f32 v[140:141], v[140:141], v[36:37]
  v_lshlrev_b32 v36, 16, v103
  v_and_b32 v37, 0xffff0000, v103
  v_pk_add_f32 v[142:143], v[142:143], v[36:37]
  v_lshlrev_b32 v36, 16, v233
  v_and_b32 v37, 0xffff0000, v233
  v_pk_add_f32 v[144:145], v[144:145], v[36:37]
  s_bitset0_b32 s57, 9
Lskip9_11:
  s_bitcmp1_b32 s57, 10
  s_cbranch_scc0 Lskip10_11
  s_waitcnt vmcnt(11)
  v_max3_u32 v36, v104, v105, v106
  s_waitcnt vmcnt(10)
  v_max3_u32 v36, v36, v107, v234
  v_cmp_eq_u32 vcc, -1, v36
  s_nop 4
  s_cbranch_vccnz Lskip10_11
  v_lshlrev_b32 v36, 16, v104
  v_and_b32 v37, 0xffff0000, v104
  v_pk_add_f32 v[136:137], v[136:137], v[36:37]
  v_lshlrev_b32 v36, 16, v105
  v_and_b32 v37, 0xffff0000, v105
  v_pk_add_f32 v[138:139], v[138:139], v[36:37]
  v_lshlrev_b32 v36, 16, v106
  v_and_b32 v37, 0xffff0000, v106
  v_pk_add_f32 v[140:141], v[140:141], v[36:37]
  v_lshlrev_b32 v36, 16, v107
  v_and_b32 v37, 0xffff0000, v107
  v_pk_add_f32 v[142:143], v[142:143], v[36:37]
  v_lshlrev_b32 v36, 16, v234
  v_and_b32 v37, 0xffff0000, v234
  v_pk_add_f32 v[144:145], v[144:145], v[36:37]
  s_bitset0_b32 s57, 10
Lskip10_11:
  s_bitcmp1_b32 s57, 11
  s_cbranch_scc0 Lskip11_11
  s_waitcnt vmcnt(9)
  v_max3_u32 v36, v108, v109, v110
  s_waitcnt vmcnt(8)
  v_max3_u32 v36, v36, v111, v235
  v_cmp_eq_u32 vcc, -1, v36
  s_nop 4
  s_cbranch_vccnz Lskip11_11
  v_lshlrev_b32 v36, 16, v108
  v_and_b32 v37, 0xffff0000, v108
  v_pk_add_f32 v[136:137], v[136:137], v[36:37]
  v_lshlrev_b32 v36, 16, v109
  v_and_b32 v37, 0xffff0000, v109
  v_pk_add_f32 v[138:139], v[138:139], v[36:37]
  v_lshlrev_b32 v36, 16, v110
  v_and_b32 v37, 0xffff0000, v110
  v_pk_add_f32 v[140:141], v[140:141], v[36:37]
  v_lshlrev_b32 v36, 16, v111
  v_and_b32 v37, 0xffff0000, v111
  v_pk_add_f32 v[142:143], v[142:143], v[36:37]
  v_lshlrev_b32 v36, 16, v235
  v_and_b32 v37, 0xffff0000, v235
  v_pk_add_f32 v[144:145], v[144:145], v[36:37]
  s_bitset0_b32 s57, 11
Lskip11_11:
  s_bitcmp1_b32 s57, 12
  s_cbranch_scc0 Lskip12_11
  s_waitcnt vmcnt(7)
  v_max3_u32 v36, v112, v113, v114
  s_waitcnt vmcnt(6)
  v_max3_u32 v36, v36, v115, v236
  v_cmp_eq_u32 vcc, -1, v36
  s_nop 4
  s_cbranch_vccnz Lskip12_11
  v_lshlrev_b32 v36, 16, v112
  v_and_b32 v37, 0xffff0000, v112
  v_pk_add_f32 v[136:137], v[136:137], v[36:37]
  v_lshlrev_b32 v36, 16, v113
  v_and_b32 v37, 0xffff0000, v113
  v_pk_add_f32 v[138:139], v[138:139], v[36:37]
  v_lshlrev_b32 v36, 16, v114
  v_and_b32 v37, 0xffff0000, v114
  v_pk_add_f32 v[140:141], v[140:141], v[36:37]
  v_lshlrev_b32 v36, 16, v115
  v_and_b32 v37, 0xffff0000, v115
  v_pk_add_f32 v[142:143], v[142:143], v[36:37]
  v_lshlrev_b32 v36, 16, v236
  v_and_b32 v37, 0xffff0000, v236
  v_pk_add_f32 v[144:145], v[144:145], v[36:37]
  s_bitset0_b32 s57, 12
Lskip12_11:
  s_bitcmp1_b32 s57, 13
  s_cbranch_scc0 Lskip13_11
  s_waitcnt vmcnt(5)
  v_max3_u32 v36, v116, v117, v118
  s_waitcnt vmcnt(4)
  v_max3_u32 v36, v36, v119, v237
  v_cmp_eq_u32 vcc, -1, v36
  s_nop 4
  s_cbranch_vccnz Lskip13_11
  v_lshlrev_b32 v36, 16, v116
  v_and_b32 v37, 0xffff0000, v116
  v_pk_add_f32 v[136:137], v[136:137], v[36:37]
  v_lshlrev_b32 v36, 16, v117
  v_and_b32 v37, 0xffff0000, v117
  v_pk_add_f32 v[138:139], v[138:139], v[36:37]
  v_lshlrev_b32 v36, 16, v118
  v_and_b32 v37, 0xffff0000, v118
  v_pk_add_f32 v[140:141], v[140:141], v[36:37]
  v_lshlrev_b32 v36, 16, v119
  v_and_b32 v37, 0xffff0000, v119
  v_pk_add_f32 v[142:143], v[142:143], v[36:37]
  v_lshlrev_b32 v36, 16, v237
  v_and_b32 v37, 0xffff0000, v237
  v_pk_add_f32 v[144:145], v[144:145], v[36:37]
  s_bitset0_b32 s57, 13
Lskip13_11:
  s_bitcmp1_b32 s57, 14
  s_cbranch_scc0 Lskip14_11
  s_waitcnt vmcnt(3)
  v_max3_u32 v36, v120, v121, v122
  s_waitcnt vmcnt(2)
  v_max3_u32 v36, v36, v123, v238
  v_cmp_eq_u32 vcc, -1, v36
  s_nop 4
  s_cbranch_vccnz Lskip14_11
  v_lshlrev_b32 v36, 16, v120
  v_and_b32 v37, 0xffff0000, v120
  v_pk_add_f32 v[136:137], v[136:137], v[36:37]
  v_lshlrev_b32 v36, 16, v121
  v_and_b32 v37, 0xffff0000, v121
  v_pk_add_f32 v[138:139], v[138:139], v[36:37]
  v_lshlrev_b32 v36, 16, v122
  v_and_b32 v37, 0xffff0000, v122
  v_pk_add_f32 v[140:141], v[140:141], v[36:37]
  v_lshlrev_b32 v36, 16, v123
  v_and_b32 v37, 0xffff0000, v123
  v_pk_add_f32 v[142:143], v[142:143], v[36:37]
  v_lshlrev_b32 v36, 16, v238
  v_and_b32 v37, 0xffff0000, v238
  v_pk_add_f32 v[144:145], v[144:145], v[36:37]
  s_bitset0_b32 s57, 14
Lskip14_11:
  s_bitcmp1_b32 s57, 15
  s_cbranch_scc0 Lskip15_11
  s_waitcnt vmcnt(1)
  v_max3_u32 v36, v124, v125, v126
  s_waitcnt vmcnt(0)
  v_max3_u32 v36, v36, v127, v239
  v_cmp_eq_u32 vcc, -1, v36
  s_nop 4
  s_cbranch_vccnz Lskip15_11
  v_lshlrev_b32 v36, 16, v124
  v_and_b32 v37, 0xffff0000, v124
  v_pk_add_f32 v[136:137], v[136:137], v[36:37]
  v_lshlrev_b32 v36, 16, v125
  v_and_b32 v37, 0xffff0000, v125
  v_pk_add_f32 v[138:139], v[138:139], v[36:37]
  v_lshlrev_b32 v36, 16, v126
  v_and_b32 v37, 0xffff0000, v126
  v_pk_add_f32 v[140:141], v[140:141], v[36:37]
  v_lshlrev_b32 v36, 16, v127
  v_and_b32 v37, 0xffff0000, v127
  v_pk_add_f32 v[142:143], v[142:143], v[36:37]
  v_lshlrev_b32 v36, 16, v239
  v_and_b32 v37, 0xffff0000, v239
  v_pk_add_f32 v[144:145], v[144:145], v[36:37]
  s_bitset0_b32 s57, 15
Lskip15_11:
  s_cmp_lg_u32 s57, 0
  s_cbranch_scc1 Lretry_11
  v_cvt_pk_bf16_f32 v64, v128, v129
  v_cvt_pk_bf16_f32 v65, v130, v131
  v_cvt_pk_bf16_f32 v66, v132, v133
  v_cvt_pk_bf16_f32 v67, v134, v135
  v_cvt_pk_bf16_f32 v68, v136, v137
  v_cvt_pk_bf16_f32 v69, v138, v139
  v_cvt_pk_bf16_f32 v70, v140, v141
  v_cvt_pk_bf16_f32 v71, v142, v143
  v_cvt_pk_bf16_f32 v72, v144, v145
 WL 0
  buffer_store_dwordx2 v[64:65], v30, s[16:19], s56 offen offset:0
  buffer_store_dwordx2 v[66:67], v30, s[16:19], s69 offen offset:0
  buffer_store_dwordx2 v[68:69], v30, s[16:19], s56 offen offset:128
  buffer_store_dwordx2 v[70:71], v30, s[16:19], s69 offen offset:128
  buffer_store_dword v72, v31, s[16:19], s56 offen
Lexit_11:
  s_endpgm
Lpoll_ctx_11:
  buffer_load_dword v248, v247, s[20:23], s54 offen offset:16 sc1
  s_waitcnt vmcnt(0)
  v_cmp_gt_u32 vcc, 1, v248
  s_nop 4
  s_cbranch_vccz Lback_ctx_11
  s_branch Lpoll_ctx_11
Lpoll_pz_11:
  buffer_load_dword v248, v247, s[20:23], s54 offen offset:32 sc1
  s_waitcnt vmcnt(0)
  v_cmp_gt_u32 vcc, 1, v248
  s_nop 4
  s_cbranch_vccz Lback_pz_11
  s_branch Lpoll_pz_11
Lpoll_red_11:
  buffer_load_dword v248, v247, s[20:23], s54 offen offset:32 sc1
  s_waitcnt vmcnt(0)
  v_cmp_gt_u32 vcc, 2, v248
  s_nop 4
  s_cbranch_vccz Lback_red_11
  s_branch Lpoll_red_11
Lretry_11:
  s_bitcmp1_b32 s57, 0
  s_cbranch_scc0 Lrskip0_11
  s_add_u32 s46, s55, 0
  buffer_load_dwordx4 v[64:67], v28, s[20:23], s46 offen sc1
Lrskip0_11:
  s_bitcmp1_b32 s57, 1
  s_cbranch_scc0 Lrskip1_11
  s_add_u32 s46, s55, 18432
  buffer_load_dwordx4 v[68:71], v28, s[20:23], s46 offen sc1
Lrskip1_11:
  s_bitcmp1_b32 s57, 2
  s_cbranch_scc0 Lrskip2_11
  s_add_u32 s46, s55, 36864
  buffer_load_dwordx4 v[72:75], v28, s[20:23], s46 offen sc1
Lrskip2_11:
  s_bitcmp1_b32 s57, 3
  s_cbranch_scc0 Lrskip3_11
  s_add_u32 s46, s55, 55296
  buffer_load_dwordx4 v[76:79], v28, s[20:23], s46 offen sc1
Lrskip3_11:
  s_bitcmp1_b32 s57, 4
  s_cbranch_scc0 Lrskip4_11
  s_add_u32 s46, s55, 73728
  buffer_load_dwordx4 v[80:83], v28, s[20:23], s46 offen sc1
Lrskip4_11:
  s_bitcmp1_b32 s57, 5
  s_cbranch_scc0 Lrskip5_11
  s_add_u32 s46, s55, 92160
  buffer_load_dwordx4 v[84:87], v28, s[20:23], s46 offen sc1
Lrskip5_11:
  s_bitcmp1_b32 s57, 6
  s_cbranch_scc0 Lrskip6_11
  s_add_u32 s46, s55, 110592
  buffer_load_dwordx4 v[88:91], v28, s[20:23], s46 offen sc1
Lrskip6_11:
  s_bitcmp1_b32 s57, 7
  s_cbranch_scc0 Lrskip7_11
  s_add_u32 s46, s55, 129024
  buffer_load_dwordx4 v[92:95], v28, s[20:23], s46 offen sc1
Lrskip7_11:
  s_bitcmp1_b32 s57, 8
  s_cbranch_scc0 Lrskip8_11
  s_add_u32 s46, s55, 4096
  buffer_load_dwordx4 v[96:99], v28, s[20:23], s46 offen sc1
  buffer_load_dword v232, v29, s[20:23], s46 offen sc1
Lrskip8_11:
  s_bitcmp1_b32 s57, 9
  s_cbranch_scc0 Lrskip9_11
  s_add_u32 s46, s55, 22528
  buffer_load_dwordx4 v[100:103], v28, s[20:23], s46 offen sc1
  buffer_load_dword v233, v29, s[20:23], s46 offen sc1
Lrskip9_11:
  s_bitcmp1_b32 s57, 10
  s_cbranch_scc0 Lrskip10_11
  s_add_u32 s46, s55, 40960
  buffer_load_dwordx4 v[104:107], v28, s[20:23], s46 offen sc1
  buffer_load_dword v234, v29, s[20:23], s46 offen sc1
Lrskip10_11:
  s_bitcmp1_b32 s57, 11
  s_cbranch_scc0 Lrskip11_11
  s_add_u32 s46, s55, 59392
  buffer_load_dwordx4 v[108:111], v28, s[20:23], s46 offen sc1
  buffer_load_dword v235, v29, s[20:23], s46 offen sc1
Lrskip11_11:
  s_bitcmp1_b32 s57, 12
  s_cbranch_scc0 Lrskip12_11
  s_add_u32 s46, s55, 77824
  buffer_load_dwordx4 v[112:115], v28, s[20:23], s46 offen sc1
  buffer_load_dword v236, v29, s[20:23], s46 offen sc1
Lrskip12_11:
  s_bitcmp1_b32 s57, 13
  s_cbranch_scc0 Lrskip13_11
  s_add_u32 s46, s55, 96256
  buffer_load_dwordx4 v[116:119], v28, s[20:23], s46 offen sc1
  buffer_load_dword v237, v29, s[20:23], s46 offen sc1
Lrskip13_11:
  s_bitcmp1_b32 s57, 14
  s_cbranch_scc0 Lrskip14_11
  s_add_u32 s46, s55, 114688
  buffer_load_dwordx4 v[120:123], v28, s[20:23], s46 offen sc1
  buffer_load_dword v238, v29, s[20:23], s46 offen sc1
Lrskip14_11:
  s_bitcmp1_b32 s57, 15
  s_cbranch_scc0 Lrskip15_11
  s_add_u32 s46, s55, 133120
  buffer_load_dwordx4 v[124:127], v28, s[20:23], s46 offen sc1
  buffer_load_dword v239, v29, s[20:23], s46 offen sc1
Lrskip15_11:
  s_waitcnt vmcnt(0)
  s_branch Lchk_11
Lp4e_11:
Lp4_12:
  v_cmp_lt_u32 vcc, 0x40000000, v43
  s_lshr_b32 s65, s6, 8
  s_lshl_b32 s66, s3, 2
  v_mov_b32 v246, s66
  s_cmp_lg_u64 vcc, 0
  s_cselect_b32 s66, 1, 0
  s_andn2_b32 s66, s66, s65
  v_mov_b32 v245, s66
  ds_write_b32 v246, v245
  v_and_b32 v246, 3, v0
  v_lshlrev_b32 v246, 2, v246
  v_lshlrev_b32 v59, 3, v0
  v_add_u32 v56, 20736, v59
  v_add_u32 v57, 134400, v59
  v_add_u32 v58, 58624, v59
  v_add_u32 v59, 96512, v59
 WL 0
  s_waitcnt vmcnt(33)
  s_barrier
 TR 208,32,0
 TR 210,32,512
 TR 212,32,9472
 TR 214,32,9984
 TR 216,32,32
 TR 218,32,544
 TR 220,32,9504
 TR 222,32,10016
 TR 224,32,64
 TR 226,32,576
 TR 228,32,9536
 TR 230,32,10048
  ds_read_b32 v245, v246
 WL 11
  v_mfma_f32_16x16x32_bf16 v[64:67], v[208:211], a[212:215], 0
  s_add_u32 s46, s45, 49152
  v_lshlrev_b32 v249, 14, v0
  v_add_u32 v249, Lp4_12-Lpc0, v249
 WL 9
 Mvva 64,212,228
  buffer_load_dwordx4 a[0:3], v16, s[20:23], s46 offen offset:0 sc1
  v_mfma_f32_16x16x32_bf16 v[68:71], v[208:211], a[216:219], 0
  v_min_u32 v249, Lp4e_12-Lpc0-16388, v249
 Mvva 68,212,232
  v_mfma_f32_16x16x32_bf16 v[72:75], v[208:211], a[220:223], 0
  buffer_load_dwordx4 a[4:7], v16, s[20:23], s46 offen offset:2048 sc1
 Mvva 72,212,236
  v_mfma_f32_16x16x32_bf16 v[76:79], v[208:211], a[224:227], 0
 TR 208,32,96
 Mvva 76,212,240
 WL 8
  v_mfma_f32_16x16x32_bf16 v[80:83], v[216:219], a[212:215], 0
 TR 210,32,608
 WL 7
 Mvva 80,220,228
  buffer_load_dwordx4 a[8:11], v17, s[20:23], s46 offen offset:0 sc1
  v_mfma_f32_16x16x32_bf16 v[84:87], v[216:219], a[216:219], 0
 TR 212,32,9568
 Mvva 84,220,232
 WL 3
  v_cmp_ne_u32 vcc, 0, v245
  s_nop 4
  s_cbranch_vccnz Lrestart
  v_mfma_f32_16x16x32_bf16 v[88:91], v[216:219], a[220:223], 0
 TR 214,32,10080
 Mvva 88,220,236
  s_cmp_lg_u32 s3, 0
  s_cselect_b32 s64, 256, 0
  s_and_b32 s66, s2, 0xe7
  v_mfma_f32_16x16x32_bf16 v[92:95], v[216:219], a[224:227], 0
 TR 216,32,128
  s_lshl_b32 s66, s66, 6
 Mvva 92,220,240
  buffer_load_dwordx4 a[12:15], v17, s[20:23], s46 offen offset:2048 sc1
  v_mfma_f32_16x16x32_bf16 v[96:99], v[224:227], a[212:215], 0
 TR 218,32,640
  s_lshr_b32 s65, s4, 3
 Mvva 96,228,228
  s_add_u32 s46, s45, 57344
  s_add_u32 s66, s66, s65
  s_lshl_b32 s66, s66, 2
  v_mfma_f32_16x16x32_bf16 v[100:103], v[224:227], a[216:219], 0
 TR 220,32,9600
  s_add_u32 s66, s66, 0x4480010
 Mvva 100,228,232
  buffer_load_dwordx4 a[16:19], v16, s[20:23], s46 offen offset:0 sc1
  v_mfma_f32_16x16x32_bf16 v[104:107], v[224:227], a[220:223], 0
 TR 222,32,10112
  s_lshl_b32 s65, s64, 20
 Mvva 104,228,236
  global_load_dword a248, v249, s[100:101]
  v_mfma_f32_16x16x32_bf16 v[108:111], v[224:227], a[224:227], 0
 TR 224,32,160
  s_add_u32 s66, s66, s65
 Mvva 108,228,240
  buffer_load_dwordx4 a[20:23], v16, s[20:23], s46 offen offset:2048 sc1
 WL 7
  v_mfma_f32_16x16x32_bf16 v[112:115], v[208:211], a[212:215], 0
 TR 226,32,672
 WL 6
 Mvva 112,212,228
  v_cmp_gt_u32 vcc, 4, v0
  v_lshlrev_b32 v245, 11, v0
  v_mov_b32 v246, 1
  v_cndmask_b32 v245, -1, v245, vcc
  v_mfma_f32_16x16x32_bf16 v[116:119], v[208:211], a[216:219], 0
 TR 228,32,9632
 Mvva 116,212,232
  v_mfma_f32_16x16x32_bf16 v[120:123], v[208:211], a[220:223], 0
 TR 230,32,10144
 Mvva 120,212,236
  buffer_load_dwordx4 a[24:27], v17, s[20:23], s46 offen offset:0 sc1
  v_mfma_f32_16x16x32_bf16 v[124:127], v[208:211], a[224:227], 0
 TR 208,32,192
 Mvva 124,212,240
 WL 7
  v_mfma_f32_16x16x32_bf16 v[128:131], v[216:219], a[212:215], 0
 TR 210,32,704
 WL 6
 Mvva 128,220,228
  buffer_load_dwordx4 a[28:31], v17, s[20:23], s46 offen offset:2048 sc1
  v_mfma_f32_16x16x32_bf16 v[132:135], v[216:219], a[216:219], 0
 TR 212,32,9664
  s_add_u32 s44, s44, 147456
 Mvva 132,220,232
  v_mfma_f32_16x16x32_bf16 v[136:139], v[216:219], a[220:223], 0
 TR 214,32,10176
  s_add_u32 m0, s47, 50176
 Mvva 136,220,236
  v_mfma_f32_16x16x32_bf16 v[140:143], v[216:219], a[224:227], 0
 TR 216,32,224
 WL 7
 Mvva 140,220,240
  buffer_load_dwordx4 v1, s[12:15], s44 offen lds
  v_mfma_f32_16x16x32_bf16 v[144:147], v[224:227], a[212:215], 0
 TR 218,32,736
 WL 6
 Mvva 144,228,228
  v_mfma_f32_16x16x32_bf16 v[148:151], v[224:227], a[216:219], 0
 TR 220,32,9696
 Mvva 148,228,232
  buffer_load_dwordx4 v2, s[12:15], s44 offen offset:1056 lds
  v_mfma_f32_16x16x32_bf16 v[152:155], v[224:227], a[220:223], 0
 TR 222,32,10208
 Mvva 152,228,236
  v_mfma_f32_16x16x32_bf16 v[156:159], v[224:227], a[224:227], 0
 TR 224,56,0
 WL 7
 Mvva 156,228,240
  buffer_load_dwordx4 v3, s[12:15], s44 offen offset:2112 lds
  v_mfma_f32_16x16x32_bf16 v[160:163], v[208:211], a[212:215], 0
 TR 226,56,512
 WL 6
 Mvva 160,212,228
  v_mfma_f32_16x16x32_bf16 v[164:167], v[208:211], a[216:219], 0
 TR 228,56,9472
 Mvva 164,212,232
  v_mfma_f32_16x16x32_bf16 v[168:171], v[208:211], a[220:223], 0
 TR 230,56,9984
 Mvva 168,212,236
  buffer_load_dwordx4 v4, s[12:15], s44 offen offset:3168 lds
  v_mfma_f32_16x16x32_bf16 v[172:175], v[208:211], a[224:227], 0
 TR 208,32,18944
 Mvva 172,212,240
  s_add_u32 m0, s47, 54400
 WL 7
  v_mfma_f32_16x16x32_bf16 v[176:179], v[216:219], a[212:215], 0
 TR 210,32,19456
 WL 6
 Mvva 176,220,228
  buffer_load_dwordx4 v5, s[12:15], s44 offen lds
  v_mfma_f32_16x16x32_bf16 v[180:183], v[216:219], a[216:219], 0
 TR 212,32,28416
 Mvva 180,220,232
  v_mfma_f32_16x16x32_bf16 v[184:187], v[216:219], a[220:223], 0
 TR 214,32,28928
 Mvva 184,220,236
  buffer_load_dwordx4 v6, s[12:15], s44 offen offset:1056 lds
  v_mfma_f32_16x16x32_bf16 v[188:191], v[216:219], a[224:227], 0
 TR 216,32,18976
 Mvva 188,220,240
 WL 7
  v_mfma_f32_16x16x32_bf16 v[192:195], v[224:227], a[212:215], 0
 TR 218,32,19488
 WL 6
 Mvva 192,228,228
  v_mfma_f32_16x16x32_bf16 v[196:199], v[224:227], a[216:219], 0
 TR 220,32,28448
 Mvva 196,228,232
  buffer_load_dwordx4 v7, s[12:15], s44 offen offset:2112 lds
  v_mfma_f32_16x16x32_bf16 v[200:203], v[224:227], a[220:223], 0
 TR 222,32,28960
  s_waitcnt vmcnt(41)
 Mvva 200,228,236
  v_mfma_f32_16x16x32_bf16 v[204:207], v[224:227], a[224:227], 0
 TR 224,32,19008
 WL 7
 Mvva 204,228,240
  buffer_load_dwordx4 v8, s[12:15], s44 offen offset:3168 lds
 Mvva 64,208,176
 TR 226,32,19520
 WL 6
 Mvva 64,212,192
 Mvva 68,208,180
 TR 228,32,28480
  s_add_u32 m0, s47, 58624
 Mvva 68,212,196
 Mvva 72,208,184
 TR 230,32,28992
 Mvva 72,212,200
  buffer_load_dwordx4 v9, s[20:23], s44 offen sc1 lds
 Mvva 76,208,188
 TR 208,32,19040
  s_add_u32 s46, s45, 65536
 Mvva 76,212,204
 WL 7
 Mvva 80,216,176
 TR 210,32,19552
 WL 6
 Mvva 80,220,192
  buffer_load_dwordx4 a[32:35], v16, s[20:23], s46 offen offset:0 sc1
 Mvva 84,216,180
 TR 212,32,28512
 Mvva 84,220,196
 Mvva 88,216,184
 TR 214,32,29024
 Mvva 88,220,200
  buffer_load_dwordx4 a[36:39], v16, s[20:23], s46 offen offset:2048 sc1
 Mvva 92,216,188
 TR 216,32,19072
 Mvva 92,220,204
 WL 7
 Mvva 96,224,176
 TR 218,32,19584
 WL 6
 Mvva 96,228,192
 Mvva 100,224,180
 TR 220,32,28544
 Mvva 100,228,196
  buffer_load_dwordx4 a[40:43], v17, s[20:23], s46 offen offset:0 sc1
 Mvva 104,224,184
 TR 222,32,29056
 Mvva 104,228,200
 Mvva 108,224,188
 TR 224,32,19104
 WL 7
 Mvva 108,228,204
  buffer_load_dwordx4 a[44:47], v17, s[20:23], s46 offen offset:2048 sc1
 Mvva 112,208,176
 TR 226,32,19616
 WL 6
 Mvva 112,212,192
  s_add_u32 s46, s45, 73728
 Mvva 116,208,180
 TR 228,32,28576
 Mvva 116,212,196
  buffer_load_dwordx4 a[48:51], v16, s[20:23], s46 offen offset:0 sc1
 Mvva 120,208,184
 TR 230,32,29088
 Mvva 120,212,200
 Mvva 124,208,188
 TR 208,32,19136
 Mvva 124,212,204
 WL 7
 Mvva 128,216,176
 TR 210,32,19648
 WL 6
 Mvva 128,220,192
  buffer_load_dwordx4 a[52:55], v16, s[20:23], s46 offen offset:2048 sc1
 Mvva 132,216,180
 TR 212,32,28608
 Mvva 132,220,196
 Mvva 136,216,184
 TR 214,32,29120
 Mvva 136,220,200
  buffer_load_dwordx4 a[56:59], v17, s[20:23], s46 offen offset:0 sc1
 Mvva 140,216,188
 TR 216,32,19168
 Mvva 140,220,204
 WL 7
 Mvva 144,224,176
 TR 218,32,19680
 WL 6
 Mvva 144,228,192
 Mvva 148,224,180
 TR 220,32,28640
 Mvva 148,228,196
  buffer_load_dwordx4 a[60:63], v17, s[20:23], s46 offen offset:2048 sc1
 Mvva 152,224,184
 TR 222,32,29152
  s_add_u32 s46, s45, 81920
 Mvva 152,228,200
 Mvva 156,224,188
 TR 224,56,18944
 WL 7
 Mvva 156,228,204
  buffer_load_dwordx4 a[64:67], v16, s[20:23], s46 offen offset:0 sc1
 Mvva 160,208,176
 TR 226,56,19456
 WL 6
 Mvva 160,212,192
 Mvva 164,208,180
 TR 228,56,28416
 Mvva 164,212,196
  buffer_load_dwordx4 a[68:71], v16, s[20:23], s46 offen offset:2048 sc1
 Mvva 168,208,184
 TR 230,56,28928
 Mvva 168,212,200
 Mvva 172,208,188
 Mvva 172,212,204
 WL 6
 WL 4
 Mvva 176,216,176
  buffer_load_dwordx4 a[72:75], v17, s[20:23], s46 offen offset:0 sc1
 Mvva 176,220,192
  s_waitcnt vmcnt(29) lgkmcnt(0)
  s_barrier
 Mvva 180,216,180
 TR 208,33,0
 Mvva 180,220,196
 TR 210,33,512
 Mvva 184,216,184
 TR 212,33,9472
 Mvva 184,220,200
 TR 214,33,9984
 Mvva 188,216,188
 TR 216,33,32
 Mvva 188,220,204
  buffer_load_dwordx4 a[76:79], v17, s[20:23], s46 offen offset:2048 sc1
 Mvva 192,224,176
 TR 218,33,544
  s_add_u32 s46, s45, 90112
 Mvva 192,228,192
  buffer_load_dwordx4 a[80:83], v16, s[20:23], s46 offen offset:0 sc1
 Mvva 196,224,180
 TR 220,33,9504
 Mvva 196,228,196
  buffer_store_dword v246, v245, s[20:23], s66 offen sc1
 Mvva 200,224,184
 TR 222,33,10016
 WL 6
 Mvva 200,228,200
  s_lshr_b32 s55, s2, 3
  s_lshl_b32 s55, s55, 2
  s_bfe_u32 s65, s4, 0x20001
 Mvva 204,224,188
 TR 224,33,64
  s_add_u32 s55, s55, s65
 Mvva 204,228,204
  buffer_load_dwordx4 a[84:87], v16, s[20:23], s46 offen offset:2048 sc1
 Mvva 64,208,144
 TR 226,33,576
  s_lshl_b32 s55, s55, 4
 WL 6
 Mvva 64,212,160
  s_and_b32 s65, s4, 1
  s_add_u32 s55, s55, s65
  s_mul_i32 s55, s55, 9216
 Mvva 68,208,148
 TR 228,33,9536
  s_add_u32 s55, s55, 0x4500000
 Mvva 68,212,164
  buffer_load_dwordx4 a[88:91], v17, s[20:23], s46 offen offset:0 sc1
 Mvva 72,208,152
 TR 230,33,10048
  s_and_b32 s65, s4, 7
 Mvva 72,212,168
  s_movk_i32 s50, 8192
  s_movk_i32 s51, 16384
  s_and_b32 s66, s2, 0xf8
 Mvva 76,208,156
 TR 208,33,96
  s_lshl_b32 s56, s3, 1
 Mvva 76,212,172
  s_add_u32 s66, s66, s56
  s_lshl_b32 s66, s66, 6
  s_add_u32 s66, s66, s65
 WL 7
 Mvva 80,216,144
 TR 210,33,608
  s_add_u32 s44, s44, 147456
 WL 6
 Mvva 80,220,160
  buffer_load_dwordx4 a[92:95], v17, s[20:23], s46 offen offset:2048 sc1
 Mvva 84,216,148
 TR 212,33,9568
  s_add_u32 m0, s47, 88064
 Mvva 84,220,164
  s_lshl_b32 s66, s66, 2
  s_add_u32 s66, s66, 0x4480020
 Mvva 88,216,152
 TR 214,33,10080
 Mvva 88,220,168
  buffer_load_dwordx4 v1, s[12:15], s44 offen lds
 Mvva 92,216,156
 TR 216,33,128
 WL 5
 Mvva 92,220,172
 WL 7
  v_cmp_gt_u32 vcc, 2, v0
  v_lshlrev_b32 v245, 8, v0
  v_mov_b32 v246, 1
  v_cndmask_b32 v245, -1, v245, vcc
 Mvva 96,224,144
 TR 218,33,640
  s_sub_u32 s56, 15, s5
 Mvva 96,228,160
  buffer_load_dwordx4 v2, s[12:15], s44 offen offset:1056 lds
 Mvva 100,224,148
 TR 220,33,9600
 Mvva 100,228,164
  s_cmp_lt_u32 s65, 4
  s_cselect_b32 s56, s56, s5
  s_lshl_b32 s56, s56, 3
 Mvva 104,224,152
 TR 222,33,10112
  s_bfe_u32 s69, s65, 0x10001
 Mvva 104,228,168
  s_add_u32 s56, s56, s69
  s_and_b32 s69, s65, 1
  s_lshl_b32 s69, s69, 2
 Mvva 108,224,156
 TR 224,33,160
  s_add_u32 s56, s56, s69
 Mvva 108,228,172
  buffer_load_dwordx4 v3, s[12:15], s44 offen offset:2112 lds
 WL 7
 Mvva 112,208,144
 TR 226,33,672
  s_mul_i32 s56, s56, 18432
 WL 6
 Mvva 112,212,160
  s_lshr_b32 s69, s4, 3
  s_mul_i32 s31, s69, 224
  s_lshl_b32 s69, s69, 8
 Mvva 116,208,148
 TR 228,33,9632
  s_add_u32 s56, s56, s69
 Mvva 116,212,164
  buffer_load_dwordx4 v4, s[12:15], s44 offen offset:3168 lds
 Mvva 120,208,152
 TR 230,33,10144
  s_lshl_b32 s69, s3, 10
 Mvva 120,212,168
  s_add_u32 m0, s47, 92288
  v_add_u32 v28, s69, v16
  s_lshl_b32 s69, s3, 8
 Mvva 124,208,156
 TR 208,33,192
  s_add_u32 s69, s69, 4096
 Mvva 124,212,172
  buffer_load_dwordx4 v5, s[12:15], s44 offen lds
 WL 7
 Mvva 128,216,144
 TR 210,33,704
  v_lshl_add_u32 v29, v0, 2, s69
 WL 6
 Mvva 128,220,160
  v_and_b32 v36, 15, v0
  v_mul_u32_u24 v36, 1152, v36
 Mvva 132,216,148
 TR 212,33,9664
  v_lshrrev_b32 v37, 4, v0
 Mvva 132,220,164
  s_lshl_b32 s69, s3, 5
  v_lshl_add_u32 v36, v37, 3, v36
  v_add_u32 v30, s69, v36
 Mvva 136,216,152
 TR 214,33,10176
  v_lshrrev_b32 v36, 2, v0
 Mvva 136,220,168
  buffer_load_dwordx4 v6, s[12:15], s44 offen offset:1056 lds
 Mvva 140,216,156
 TR 216,33,224
  v_bfe_u32 v37, v0, 1, 1
 Mvva 140,220,172
 WL 7
  v_lshl_add_u32 v36, v37, 5, v36
  v_mul_u32_u24 v36, 1152, v36
 Mvva 144,224,144
 TR 218,33,736
  v_and_b32 v37, 1, v0
 WL 6
 Mvva 144,228,160
  buffer_load_dwordx4 v7, s[12:15], s44 offen offset:2112 lds
 Mvva 148,224,148
 TR 220,33,9696
  v_lshl_add_u32 v36, v37, 2, v36
 Mvva 148,228,164
  s_lshl_b32 s69, s3, 3
  s_add_u32 s69, s69, 1024
  s_sub_u32 s69, s69, s31
 Mvva 152,224,152
 TR 222,33,10208
  v_add_u32 v31, s69, v36
 Mvva 152,228,168
  s_mov_b32 s57, 0xffff
  s_add_u32 s69, s56, 36864
 WL 4
 Mvva 156,224,156
 TR 224,57,0
 WL 7
 Mvva 156,228,172
  buffer_load_dwordx4 v8, s[12:15], s44 offen offset:3168 lds
 Mvva 160,208,144
 TR 226,57,512
  s_add_u32 m0, s47, 96512
 Mvva 160,212,160
  buffer_store_dword v246, v245, s[20:23], s66 offen sc1
 Mvva 164,208,148
 TR 228,57,9472
 Mvva 164,212,164
  buffer_load_dwordx4 v9, s[20:23], s44 offen sc1 lds
 Mvva 168,208,152
 TR 230,57,9984
 Mvva 168,212,168
  s_add_u32 s46, s45, 98304
 Mvva 172,208,156
 TR 208,33,18944
 WL 7
 Mvva 172,212,172
  buffer_load_dwordx4 a[96:99], v16, s[20:23], s46 offen offset:0 sc1
 Mvva 176,216,144
 TR 210,33,19456
 WL 6
 Mvva 176,220,160
 Mvva 180,216,148
 TR 212,33,28416
 Mvva 180,220,164
 Mvva 184,216,152
 TR 214,33,28928
 Mvva 184,220,168
  buffer_load_dwordx4 a[100:103], v16, s[20:23], s46 offen offset:2048 sc1
 Mvva 188,216,156
 TR 216,33,18976
 Mvva 188,220,172
 WL 7
 Mvva 192,224,144
 TR 218,33,19488
 WL 6
 Mvva 192,228,160
  buffer_load_dwordx4 a[104:107], v17, s[20:23], s46 offen offset:0 sc1
 Mvva 196,224,148
 TR 220,33,28448
 Mvva 196,228,164
 Mvva 200,224,152
 TR 222,33,28960
  s_waitcnt vmcnt(39)
 Mvva 200,228,168
  buffer_load_dwordx4 a[108:111], v17, s[20:23], s46 offen offset:2048 sc1
 Mvva 204,224,156
 TR 224,33,19008
 Mvva 204,228,172
 WL 7
 WL 5
 Mvva 64,208,0
 TR 226,33,19520
  s_add_u32 s46, s45, 106496
 Mvva 64,212,16
 Mvva 68,208,4
 TR 228,33,28480
 Mvva 68,212,20
  buffer_load_dwordx4 a[112:115], v16, s[20:23], s46 offen offset:0 sc1
 Mvva 72,208,8
 TR 230,33,28992
 Mvva 72,212,24
 Mvva 76,208,12
 TR 208,33,19040
 WL 7
 Mvva 76,212,28
  buffer_load_dwordx4 a[116:119], v16, s[20:23], s46 offen offset:2048 sc1
 Mvva 80,216,0
 TR 210,33,19552
 WL 6
 Mvva 80,220,16
 Mvva 84,216,4
 TR 212,33,28512
 Mvva 84,220,20
 Mvva 88,216,8
 TR 214,33,29024
 Mvva 88,220,24
  buffer_load_dwordx4 a[120:123], v17, s[20:23], s46 offen offset:0 sc1
 Mvva 92,216,12
 TR 216,33,19072
 Mvva 92,220,28
 WL 7
 Mvva 96,224,0
 TR 218,33,19584
 WL 6
 Mvva 96,228,16
  buffer_load_dwordx4 a[124:127], v17, s[20:23], s46 offen offset:2048 sc1
 Mvva 100,224,4
 TR 220,33,28544
 Mvva 100,228,20
  s_add_u32 s46, s45, 114688
 Mvva 104,224,8
 TR 222,33,29056
 Mvva 104,228,24
  buffer_load_dwordx4 a[128:131], v16, s[20:23], s46 offen offset:0 sc1
 Mvva 108,224,12
 TR 224,33,19104
 Mvva 108,228,28
 WL 7
 Mvva 112,208,0
 TR 226,33,19616
 WL 6
 Mvva 112,212,16
 Mvva 116,208,4
 TR 228,33,28576
 Mvva 116,212,20
  buffer_load_dwordx4 a[132:135], v16, s[20:23], s46 offen offset:2048 sc1
 Mvva 120,208,8
 TR 230,33,29088
 Mvva 120,212,24
 Mvva 124,208,12
 TR 208,33,19136
 WL 7
 Mvva 124,212,28
  buffer_load_dwordx4 a[136:139], v17, s[20:23], s46 offen offset:0 sc1
 Mvva 128,216,0
 TR 210,33,19648
 WL 6
 Mvva 128,220,16
 Mvva 132,216,4
 TR 212,33,28608
 Mvva 132,220,20
  buffer_load_dwordx4 a[140:143], v17, s[20:23], s46 offen offset:2048 sc1
 Mvva 136,216,8
 TR 214,33,29120
 Mvva 136,220,24
 Mvva 140,216,12
 TR 216,33,19168
  s_add_u32 s46, s45, 122880
 Mvva 140,220,28
 WL 7
 Mvva 144,224,0
 TR 218,33,19680
 WL 6
 Mvva 144,228,16
  buffer_load_dwordx4 v[40:43], v16, s[20:23], s46 offen offset:0 sc1
 Mvva 148,224,4
 TR 220,33,28640
 Mvva 148,228,20
 Mvva 152,224,8
 TR 222,33,29152
 Mvva 152,228,24
  buffer_load_dwordx4 v[44:47], v16, s[20:23], s46 offen offset:2048 sc1
 Mvva 156,224,12
 TR 224,57,18944
 Mvva 156,228,28
 WL 7
 Mvva 160,208,0
 TR 226,57,19456
 WL 6
 Mvva 160,212,16
 Mvva 164,208,4
 TR 228,57,28416
 Mvva 164,212,20
  buffer_load_dwordx4 v[48:51], v17, s[20:23], s46 offen offset:0 sc1
 Mvva 168,208,8
 TR 230,57,28928
 Mvva 168,212,24
 Mvva 172,208,12
  buffer_load_dwordx4 v[52:55], v17, s[20:23], s46 offen offset:2048 sc1
 Mvva 172,212,28
  s_add_u32 s44, s44, 147456
 WL 6
 Mvva 176,216,0
 WL 4
 Mvva 176,220,16
 WL 0
  s_waitcnt vmcnt(43)
  s_barrier
 Mvva 180,216,4
 TR 208,34,0
  s_add_u32 m0, s47, 12288
 Mvva 180,220,20
 TR 210,34,512
 Mvva 184,216,8
 TR 212,34,9472
 Mvva 184,220,24
 TR 214,34,9984
 Mvva 188,216,12
 TR 216,34,32
 Mvva 188,220,28
  buffer_load_dwordx4 v1, s[12:15], s44 offen lds
 Mvva 192,224,0
 TR 218,34,544
 Mvva 192,228,16
  buffer_load_dwordx4 v2, s[12:15], s44 offen offset:1056 lds
 Mvva 196,224,4
 TR 220,34,9504
 Mvva 196,228,20
 Mvva 200,224,8
 TR 222,34,10016
  s_waitcnt vmcnt(37)
 Mvva 200,228,24
  buffer_load_dwordx4 v3, s[12:15], s44 offen offset:2112 lds
 Mvva 204,224,12
 TR 224,34,64
 Mvva 204,228,28
 WL 7
 Mvva 64,208,32
 TR 226,34,576
 WL 6
 Mvva 64,212,48
  buffer_load_dwordx4 v4, s[12:15], s44 offen offset:3168 lds
 Mvva 68,208,36
 TR 228,34,9536
 Mvva 68,212,52
 Mvva 72,208,40
 TR 230,34,10048
  s_add_u32 m0, s47, 16512
 Mvva 72,212,56
 Mvva 76,208,44
 TR 208,34,96
 WL 7
 Mvva 76,212,60
  buffer_load_dwordx4 v5, s[12:15], s44 offen lds
 Mvva 80,216,32
 TR 210,34,608
 WL 6
 Mvva 80,220,48
 Mvva 84,216,36
 TR 212,34,9568
 Mvva 84,220,52
  buffer_load_dwordx4 v6, s[12:15], s44 offen offset:1056 lds
 Mvva 88,216,40
 TR 214,34,10080
 Mvva 88,220,56
 Mvva 92,216,44
 TR 216,34,128
 Mvva 92,220,60
 WL 7
 Mvva 96,224,32
 TR 218,34,640
 WL 6
 Mvva 96,228,48
  buffer_load_dwordx4 v7, s[12:15], s44 offen offset:2112 lds
 Mvva 100,224,36
 TR 220,34,9600
 Mvva 100,228,52
 Mvva 104,224,40
 TR 222,34,10112
 Mvva 104,228,56
  buffer_load_dwordx4 v8, s[12:15], s44 offen offset:3168 lds
 Mvva 108,224,44
 TR 224,34,160
 Mvva 108,228,60
  s_add_u32 m0, s47, 20736
 WL 7
 Mvva 112,208,32
 TR 226,34,672
 WL 6
 Mvva 112,212,48
  buffer_load_dwordx4 v9, s[20:23], s44 offen sc1 lds
 Mvva 116,208,36
 TR 228,34,9632
 Mvva 116,212,52
 Mvva 120,208,40
 TR 230,34,10144
  s_add_u32 s46, s45, 131072
 Mvva 120,212,56
 Mvva 124,208,44
 TR 208,34,192
 WL 7
 Mvva 124,212,60
  buffer_load_dwordx4 a[212:215], v16, s[20:23], s46 offen offset:0 sc1
 Mvva 128,216,32
 TR 210,34,704
 WL 6
 Mvva 128,220,48
 Mvva 132,216,36
 TR 212,34,9664
 Mvva 132,220,52
  buffer_load_dwordx4 a[216:219], v16, s[20:23], s46 offen offset:2048 sc1
 Mvva 136,216,40
 TR 214,34,10176
 Mvva 136,220,56
 Mvva 140,216,44
 TR 216,34,224
 WL 7
 Mvva 140,220,60
  buffer_load_dwordx4 a[220:223], v17, s[20:23], s46 offen offset:0 sc1
 Mvva 144,224,32
 TR 218,34,736
 WL 6
 Mvva 144,228,48
 Mvva 148,224,36
 TR 220,34,9696
 Mvva 148,228,52
 Mvva 152,224,40
 TR 222,34,10208
 Mvva 152,228,56
  buffer_load_dwordx4 a[224:227], v17, s[20:23], s46 offen offset:2048 sc1
 Mvva 156,224,44
 TR 224,58,0
 Mvva 156,228,60
  s_add_u32 s46, s45, 139264
 WL 7
 Mvva 160,208,32
 TR 226,58,512
 WL 6
 Mvva 160,212,48
  buffer_load_dwordx4 a[228:231], v16, s[20:23], s46 offen offset:0 sc1
 Mvva 164,208,36
 TR 228,58,9472
 Mvva 164,212,52
 Mvva 168,208,40
 TR 230,58,9984
 Mvva 168,212,56
 Mvva 172,208,44
 TR 208,34,18944
 WL 7
 Mvva 172,212,60
  buffer_load_dwordx4 a[232:235], v16, s[20:23], s46 offen offset:2048 sc1
 Mvva 176,216,32
 TR 210,34,19456
 WL 6
 Mvva 176,220,48
 Mvva 180,216,36
 TR 212,34,28416
 Mvva 180,220,52
  buffer_load_dwordx4 a[236:239], v17, s[20:23], s46 offen offset:0 sc1
 Mvva 184,216,40
 TR 214,34,28928
 Mvva 184,220,56
 Mvva 188,216,44
 TR 216,34,18976
 WL 7
 Mvva 188,220,60
  buffer_load_dwordx4 a[240:243], v17, s[20:23], s46 offen offset:2048 sc1
 Mvva 192,224,32
 TR 218,34,19488
 WL 6
 Mvva 192,228,48
 Mvva 196,224,36
 TR 220,34,28448
  s_add_u32 s46, s45, 147456
 Mvva 196,228,52
 Mvva 200,224,40
 TR 222,34,28960
  s_waitcnt vmcnt(43)
 Mvva 200,228,56
  buffer_load_dwordx4 a[176:179], v16, s[20:23], s46 offen offset:0 sc1
 Mvva 204,224,44
 TR 224,34,19008
 Mvva 204,228,60
 WL 7
 Mvva 64,208,64
 TR 226,34,19520
 WL 6
 Mvva 64,212,80
  buffer_load_dwordx4 a[180:183], v16, s[20:23], s46 offen offset:2048 sc1
 Mvva 68,208,68
 TR 228,34,28480
 Mvva 68,212,84
  global_load_dword a248, v249, s[100:101]
 Mvva 72,208,72
 TR 230,34,28992
 Mvva 72,212,88
  buffer_load_dwordx4 a[184:187], v17, s[20:23], s46 offen offset:0 sc1
 Mvva 76,208,76
 TR 208,34,19040
 Mvva 76,212,92
 WL 7
 Mvva 80,216,64
 TR 210,34,19552
 WL 6
 Mvva 80,220,80
 Mvva 84,216,68
 TR 212,34,28512
 Mvva 84,220,84
  buffer_load_dwordx4 a[188:191], v17, s[20:23], s46 offen offset:2048 sc1
 Mvva 88,216,72
 TR 214,34,29024
 Mvva 88,220,88
  s_add_u32 s46, s45, 155648
 Mvva 92,216,76
 TR 216,34,19072
 WL 7
 Mvva 92,220,92
  buffer_load_dwordx4 a[192:195], v16, s[20:23], s46 offen offset:0 sc1
 Mvva 96,224,64
 TR 218,34,19584
 WL 6
 Mvva 96,228,80
 Mvva 100,224,68
 TR 220,34,28544
 Mvva 100,228,84
 Mvva 104,224,72
 TR 222,34,29056
 Mvva 104,228,88
  buffer_load_dwordx4 a[196:199], v16, s[20:23], s46 offen offset:2048 sc1
 Mvva 108,224,76
 TR 224,34,19104
 Mvva 108,228,92
 WL 7
 Mvva 112,208,64
 TR 226,34,19616
 WL 6
 Mvva 112,212,80
  buffer_load_dwordx4 a[200:203], v17, s[20:23], s46 offen offset:0 sc1
 Mvva 116,208,68
 TR 228,34,28576
 Mvva 116,212,84
 Mvva 120,208,72
 TR 230,34,29088
 Mvva 120,212,88
  buffer_load_dwordx4 a[204:207], v17, s[20:23], s46 offen offset:2048 sc1
 Mvva 124,208,76
 TR 208,34,19136
  s_add_u32 s44, s44, 147456
 Mvva 124,212,92
 WL 7
 WL 5
 Mvva 128,216,64
 TR 210,34,19648
  s_add_u32 m0, s47, 125952
 Mvva 128,220,80
 Mvva 132,216,68
 TR 212,34,28608
 Mvva 132,220,84
  buffer_load_dwordx4 v1, s[12:15], s44 offen lds
 Mvva 136,216,72
 TR 214,34,29120
 Mvva 136,220,88
 Mvva 140,216,76
 TR 216,34,19168
 WL 7
 Mvva 140,220,92
  buffer_load_dwordx4 v2, s[12:15], s44 offen offset:1056 lds
 Mvva 144,224,64
 TR 218,34,19680
 WL 6
 Mvva 144,228,80
 Mvva 148,224,68
 TR 220,34,28640
 Mvva 148,228,84
  buffer_load_dwordx4 v3, s[12:15], s44 offen offset:2112 lds
 Mvva 152,224,72
 TR 222,34,29152
 Mvva 152,228,88
 Mvva 156,224,76
 TR 224,58,18944
 Mvva 156,228,92
 WL 7
 Mvva 160,208,64
 TR 226,58,19456
 WL 6
 Mvva 160,212,80
  buffer_load_dwordx4 v4, s[12:15], s44 offen offset:3168 lds
 Mvva 164,208,68
 TR 228,58,28416
 Mvva 164,212,84
  s_add_u32 m0, s47, 130176
 Mvva 168,208,72
 TR 230,58,28928
 Mvva 168,212,88
  buffer_load_dwordx4 v5, s[12:15], s44 offen lds
 Mvva 172,208,76
 Mvva 172,212,92
 WL 6
 Mvva 176,216,64
 WL 4
 Mvva 176,220,80
 WL 0
  s_waitcnt vmcnt(47)
  s_barrier
 Mvva 180,216,68
 TR 208,35,0
 Mvva 180,220,84
 TR 210,35,512
 Mvva 184,216,72
 TR 212,35,9472
 Mvva 184,220,88
 TR 214,35,9984
 Mvva 188,216,76
 TR 216,35,32
 Mvva 188,220,92
  buffer_load_dwordx4 v6, s[12:15], s44 offen offset:1056 lds
 Mvva 192,224,64
 TR 218,35,544
 Mvva 192,228,80
  buffer_load_dwordx4 v7, s[12:15], s44 offen offset:2112 lds
 Mvva 196,224,68
 TR 220,35,9504
 Mvva 196,228,84
  buffer_load_dwordx4 v8, s[12:15], s44 offen offset:3168 lds
 Mvva 200,224,72
 TR 222,35,10016
  s_waitcnt vmcnt(42)
 Mvva 200,228,88
 Mvva 204,224,76
 TR 224,35,64
  s_add_u32 m0, s47, 134400
 Mvva 204,228,92
 WL 7
 Mvva 64,208,96
 TR 226,35,576
 WL 6
 Mvva 64,212,112
  buffer_load_dwordx4 v9, s[20:23], s44 offen sc1 lds
 Mvva 68,208,100
 TR 228,35,9536
 Mvva 68,212,116
  s_add_u32 s46, s45, 163840
 Mvva 72,208,104
 TR 230,35,10048
 Mvva 72,212,120
  buffer_load_dwordx4 a[144:147], v16, s[20:23], s46 offen offset:0 sc1
 Mvva 76,208,108
 TR 208,35,96
 Mvva 76,212,124
 WL 7
 Mvva 80,216,96
 TR 210,35,608
 WL 6
 Mvva 80,220,112
  buffer_load_dwordx4 a[148:151], v16, s[20:23], s46 offen offset:2048 sc1
 Mvva 84,216,100
 TR 212,35,9568
 Mvva 84,220,116
 Mvva 88,216,104
 TR 214,35,10080
 Mvva 88,220,120
 Mvva 92,216,108
 TR 216,35,128
 WL 7
 Mvva 92,220,124
  buffer_load_dwordx4 a[152:155], v17, s[20:23], s46 offen offset:0 sc1
 Mvva 96,224,96
 TR 218,35,640
 WL 6
 Mvva 96,228,112
 Mvva 100,224,100
 TR 220,35,9600
 Mvva 100,228,116
  buffer_load_dwordx4 a[156:159], v17, s[20:23], s46 offen offset:2048 sc1
 Mvva 104,224,104
 TR 222,35,10112
 Mvva 104,228,120
 Mvva 108,224,108
 TR 224,35,160
  s_add_u32 s46, s45, 172032
 Mvva 108,228,124
 WL 7
 Mvva 112,208,96
 TR 226,35,672
 WL 6
 Mvva 112,212,112
  buffer_load_dwordx4 a[160:163], v16, s[20:23], s46 offen offset:0 sc1
 Mvva 116,208,100
 TR 228,35,9632
 Mvva 116,212,116
 Mvva 120,208,104
 TR 230,35,10144
 Mvva 120,212,120
  buffer_load_dwordx4 a[164:167], v16, s[20:23], s46 offen offset:2048 sc1
 Mvva 124,208,108
 TR 208,35,192
 Mvva 124,212,124
 WL 7
 Mvva 128,216,96
 TR 210,35,704
 WL 6
 Mvva 128,220,112
  buffer_load_dwordx4 a[168:171], v17, s[20:23], s46 offen offset:0 sc1
 Mvva 132,216,100
 TR 212,35,9664
  v_and_b32 v247, 3, v0
 Mvva 132,220,116
  v_lshlrev_b32 v247, 2, v247
 Mvva 136,216,104
 TR 214,35,10176
 Mvva 136,220,120
  buffer_load_dword v248, v247, s[20:23], s54 offen offset:16 sc1
 Mvva 140,216,108
 TR 216,35,224
 WL 7
 Mvva 140,220,124
  buffer_load_dwordx4 a[172:175], v17, s[20:23], s46 offen offset:2048 sc1
 Mvva 144,224,96
 TR 218,35,736
 WL 6
 Mvva 144,228,112
  s_add_u32 s46, s45, 180224
 Mvva 148,224,100
 TR 220,35,9696
 Mvva 148,228,116
  buffer_load_dwordx4 a[0:3], v16, s[20:23], s46 offen offset:0 sc1
 Mvva 152,224,104
 TR 222,35,10208
 Mvva 152,228,120
 Mvva 156,224,108
 TR 224,59,0
 WL 7
 Mvva 156,228,124
  buffer_load_dwordx4 a[4:7], v16, s[20:23], s46 offen offset:2048 sc1
 Mvva 160,208,96
 TR 226,59,512
 WL 6
 Mvva 160,212,112
 Mvva 164,208,100
 TR 228,59,9472
 Mvva 164,212,116
 Mvva 168,208,104
 TR 230,59,9984
 Mvva 168,212,120
  buffer_load_dwordx4 a[8:11], v17, s[20:23], s46 offen offset:0 sc1
 Mvva 172,208,108
 TR 208,35,18944
 Mvva 172,212,124
 WL 7
 Mvva 176,216,96
 TR 210,35,19456
 WL 6
 Mvva 176,220,112
  buffer_load_dwordx4 a[12:15], v17, s[20:23], s46 offen offset:2048 sc1
 Mvva 180,216,100
 TR 212,35,28416
 Mvva 180,220,116
 Mvva 184,216,104
 TR 214,35,28928
  s_add_u32 s46, s45, 188416
 Mvva 184,220,120
 Mvva 188,216,108
 TR 216,35,18976
 WL 7
 Mvva 188,220,124
  buffer_load_dwordx4 a[16:19], v16, s[20:23], s46 offen offset:0 sc1
 Mvva 192,224,96
 TR 218,35,19488
 WL 6
 Mvva 192,228,112
 Mvva 196,224,100
 TR 220,35,28448
 Mvva 196,228,116
  buffer_load_dwordx4 a[20:23], v16, s[20:23], s46 offen offset:2048 sc1
 Mvva 200,224,104
 TR 222,35,28960
  s_waitcnt vmcnt(50)
 Mvva 200,228,120
 Mvva 204,224,108
 TR 224,35,19008
 WL 7
 Mvva 204,228,124
  buffer_load_dwordx4 a[24:27], v17, s[20:23], s46 offen offset:0 sc1
 Mvva 64,208,128
 TR 226,35,19520
 WL 6
 Mvvv 64,212,40
 Mvva 68,208,132
 TR 228,35,28480
 Mvvv 68,212,44
  s_mov_b32 s44, s25
 Mvva 72,208,136
 TR 230,35,28992
 Mvvv 72,212,48
  buffer_load_dwordx4 a[28:31], v17, s[20:23], s46 offen offset:2048 sc1
 Mvva 76,208,140
 TR 208,35,19040
  v_add_u32 v9, 4096, v9
 Mvvv 76,212,52
  s_add_u32 m0, s47, 50176
 WL 7
 Mvva 80,216,128
 TR 210,35,19552
 WL 6
 Mvvv 80,220,40
  buffer_load_dwordx4 v1, s[40:43], s44 offen lds
 Mvva 84,216,132
 TR 212,35,28512
 Mvvv 84,220,44
 Mvva 88,216,136
 TR 214,35,29024
 Mvvv 88,220,48
  buffer_load_dwordx4 v2, s[40:43], s44 offen offset:1056 lds
 Mvva 92,216,140
 TR 216,35,19072
 Mvvv 92,220,52
 WL 7
 Mvva 96,224,128
 TR 218,35,19584
 WL 6
 Mvvv 96,228,40
 Mvva 100,224,132
 TR 220,35,28544
 Mvvv 100,228,44
  buffer_load_dwordx4 v3, s[40:43], s44 offen offset:2112 lds
 Mvva 104,224,136
 TR 222,35,29056
 Mvvv 104,228,48
 Mvva 108,224,140
 TR 224,35,19104
 WL 7
 Mvvv 108,228,52
  buffer_load_dwordx4 v4, s[40:43], s44 offen offset:3168 lds
 Mvva 112,208,128
 TR 226,35,19616
 WL 6
 Mvvv 112,212,40
 Mvva 116,208,132
 TR 228,35,28576
  s_add_u32 m0, s47, 54400
 Mvvv 116,212,44
 Mvva 120,208,136
 TR 230,35,29088
 Mvvv 120,212,48
  buffer_load_dwordx4 v5, s[40:43], s44 offen lds
 Mvva 124,208,140
 TR 208,35,19136
 Mvvv 124,212,52
 WL 7
 Mvva 128,216,128
 TR 210,35,19648
 WL 6
 Mvvv 128,220,40
  buffer_load_dwordx4 v6, s[40:43], s44 offen offset:1056 lds
 Mvva 132,216,132
 TR 212,35,28608
 Mvvv 132,220,44
 Mvva 136,216,136
 TR 214,35,29120
 Mvvv 136,220,48
  buffer_load_dwordx4 v7, s[40:43], s44 offen offset:2112 lds
 Mvva 140,216,140
 TR 216,35,19168
 Mvvv 140,220,52
 WL 7
 Mvva 144,224,128
 TR 218,35,19680
 WL 6
 Mvvv 144,228,40
 Mvva 148,224,132
 TR 220,35,28640
 Mvvv 148,228,44
  buffer_load_dwordx4 v8, s[40:43], s44 offen offset:3168 lds
 Mvva 152,224,136
 TR 222,35,29152
 Mvvv 152,228,48
  s_waitcnt vmcnt(17)
  v_cmp_gt_u32 vcc, 1, v248
  s_nop 4
  s_cbranch_vccnz Lpoll_ctx_12
Lback_ctx_12:
 Mvva 156,224,140
 TR 224,59,18944
  s_add_u32 m0, s47, 58624
 Mvvv 156,228,52
  buffer_load_dwordx4 v9, s[20:23], s44 offen sc1 lds
 WL 7
 Mvva 160,208,128
 TR 226,59,19456
 WL 6
 Mvvv 160,212,40
  s_add_u32 s46, s24, 0
 Mvva 164,208,132
 TR 228,59,28416
 Mvvv 164,212,44
  buffer_load_dwordx4 a[32:35], v16, s[20:23], s46 offen offset:0 sc1
 Mvva 168,208,136
 TR 230,59,28928
 Mvvv 168,212,48
 Mvva 172,208,140
 Mvvv 172,212,52
 WL 6
 WL 4
 Mvva 176,216,128
  buffer_load_dwordx4 a[36:39], v16, s[20:23], s46 offen offset:2048 sc1
 Mvvv 176,220,40
 WL 0
  s_barrier
 Mvva 180,216,132
 TR 208,32,0
 Mvvv 180,220,44
 TR 210,32,512
 Mvva 184,216,136
 TR 212,32,9472
 Mvvv 184,220,48
 TR 214,32,9984
 Mvva 188,216,140
 TR 216,32,32
 Mvvv 188,220,52
  buffer_load_dwordx4 a[40:43], v17, s[20:23], s46 offen offset:0 sc1
 Mvva 192,224,128
 TR 218,32,544
 Mvvv 192,228,40
 Mvva 196,224,132
 TR 220,32,9504
 Mvvv 196,228,44
  buffer_load_dwordx4 a[44:47], v17, s[20:23], s46 offen offset:2048 sc1
 Mvva 200,224,136
 TR 222,32,10016
 Mvvv 200,228,48
  s_add_u32 s46, s24, 8192
 Mvva 204,224,140
 TR 224,32,64
 WL 7
 Mvvv 204,228,52
  buffer_load_dwordx4 a[48:51], v16, s[20:23], s46 offen offset:0 sc1
 Mvva 64,208,212
 TR 226,32,576
 WL 6
 Mvva 64,212,228
 Mvva 68,208,216
 TR 228,32,9536
 Mvva 68,212,232
  buffer_load_dwordx4 a[52:55], v16, s[20:23], s46 offen offset:2048 sc1
 Mvva 72,208,220
 TR 230,32,10048
 Mvva 72,212,236
 Mvva 76,208,224
 TR 208,32,96
 Mvva 76,212,240
 WL 7
 Mvva 80,216,212
 TR 210,32,608
 WL 6
 Mvva 80,220,228
  buffer_load_dwordx4 a[56:59], v17, s[20:23], s46 offen offset:0 sc1
 Mvva 84,216,216
 TR 212,32,9568
 Mvva 84,220,232
 Mvva 88,216,220
 TR 214,32,10080
 Mvva 88,220,236
  buffer_load_dwordx4 a[60:63], v17, s[20:23], s46 offen offset:2048 sc1
 Mvva 92,216,224
 TR 216,32,128
 Mvva 92,220,240
  s_add_u32 s46, s24, 16384
 WL 7
 Mvva 96,224,212
 TR 218,32,640
 WL 6
 Mvva 96,228,228
  buffer_load_dwordx4 a[64:67], v16, s[20:23], s46 offen offset:0 sc1
 Mvva 100,224,216
 TR 220,32,9600
 Mvva 100,228,232
 Mvva 104,224,220
 TR 222,32,10112
 Mvva 104,228,236
 Mvva 108,224,224
 TR 224,32,160
 WL 7
 Mvva 108,228,240
  buffer_load_dwordx4 a[68:71], v16, s[20:23], s46 offen offset:2048 sc1
 Mvva 112,208,212
 TR 226,32,672
 WL 6
 Mvva 112,212,228
 Mvva 116,208,216
 TR 228,32,9632
 Mvva 116,212,232
  buffer_load_dwordx4 a[72:75], v17, s[20:23], s46 offen offset:0 sc1
 Mvva 120,208,220
 TR 230,32,10144
 Mvva 120,212,236
 Mvva 124,208,224
 TR 208,32,192
 Mvva 124,212,240
 WL 7
 Mvva 128,216,212
 TR 210,32,704
 WL 6
 Mvva 128,220,228
  buffer_load_dwordx4 a[76:79], v17, s[20:23], s46 offen offset:2048 sc1
 Mvva 132,216,216
 TR 212,32,9664
  s_add_u32 s46, s24, 24576
 Mvva 132,220,232
 Mvva 136,216,220
 TR 214,32,10176
 Mvva 136,220,236
  buffer_load_dwordx4 a[80:83], v16, s[20:23], s46 offen offset:0 sc1
 Mvva 140,216,224
 TR 216,32,224
 Mvva 140,220,240
 WL 7
 Mvva 144,224,212
 TR 218,32,736
 WL 6
 Mvva 144,228,228
  buffer_load_dwordx4 a[84:87], v16, s[20:23], s46 offen offset:2048 sc1
 Mvva 148,224,216
 TR 220,32,9696
 Mvva 148,228,232
 Mvva 152,224,220
 TR 222,32,10208
 Mvva 152,228,236
 Mvva 156,224,224
 TR 224,56,0
 WL 7
 Mvva 156,228,240
  buffer_load_dwordx4 a[88:91], v17, s[20:23], s46 offen offset:0 sc1
 Mvva 160,208,212
 TR 226,56,512
 WL 6
 Mvva 160,212,228
 Mvva 164,208,216
 TR 228,56,9472
 Mvva 164,212,232
  buffer_load_dwordx4 a[92:95], v17, s[20:23], s46 offen offset:2048 sc1
 Mvva 168,208,220
 TR 230,56,9984
  s_add_u32 s44, s44, 1179648
 Mvva 168,212,236
  s_add_u32 m0, s47, 88064
 Mvva 172,208,224
 TR 208,32,18944
 WL 7
 Mvva 172,212,240
  buffer_load_dwordx4 v1, s[40:43], s44 offen lds
 Mvva 176,216,212
 TR 210,32,19456
 WL 6
 Mvva 176,220,228
 Mvva 180,216,216
 TR 212,32,28416
 Mvva 180,220,232
 Mvva 184,216,220
 TR 214,32,28928
 Mvva 184,220,236
  buffer_load_dwordx4 v2, s[40:43], s44 offen offset:1056 lds
 Mvva 188,216,224
 TR 216,32,18976
 Mvva 188,220,240
 WL 7
 Mvva 192,224,212
 TR 218,32,19488
 WL 6
 Mvva 192,228,228
  buffer_load_dwordx4 v3, s[40:43], s44 offen offset:2112 lds
 Mvva 196,224,216
 TR 220,32,28448
 Mvva 196,228,232
 Mvva 200,224,220
 TR 222,32,28960
 Mvva 200,228,236
 WL 4
 Mvva 204,224,224
 TR 224,32,19008
 WL 7
 Mvva 204,228,240
  buffer_load_dwordx4 v4, s[40:43], s44 offen offset:3168 lds
 Mvva 64,208,176
 TR 226,32,19520
  s_add_u32 m0, s47, 92288
 Mvva 64,212,192
 Mvva 68,208,180
 TR 228,32,28480
 Mvva 68,212,196
  buffer_load_dwordx4 v5, s[40:43], s44 offen lds
 Mvva 72,208,184
 TR 230,32,28992
 Mvva 72,212,200
 Mvva 76,208,188
 TR 208,32,19040
 WL 7
 Mvva 76,212,204
  buffer_load_dwordx4 v6, s[40:43], s44 offen offset:1056 lds
 Mvva 80,216,176
 TR 210,32,19552
 WL 6
 Mvva 80,220,192
 Mvva 84,216,180
 TR 212,32,28512
 Mvva 84,220,196
 Mvva 88,216,184
 TR 214,32,29024
 Mvva 88,220,200
  buffer_load_dwordx4 v7, s[40:43], s44 offen offset:2112 lds
 Mvva 92,216,188
 TR 216,32,19072
 Mvva 92,220,204
 WL 7
 Mvva 96,224,176
 TR 218,32,19584
 WL 6
 Mvva 96,228,192
  buffer_load_dwordx4 v8, s[40:43], s44 offen offset:3168 lds
 Mvva 100,224,180
 TR 220,32,28544
 Mvva 100,228,196
  s_add_u32 m0, s47, 96512
 Mvva 104,224,184
 TR 222,32,29056
 Mvva 104,228,200
  buffer_load_dwordx4 v9, s[20:23], s44 offen sc1 lds
 Mvva 108,224,188
 TR 224,32,19104
 Mvva 108,228,204
 WL 7
 WL 5
 Mvva 112,208,176
 TR 226,32,19616
  s_add_u32 s46, s24, 32768
 Mvva 112,212,192
 Mvva 116,208,180
 TR 228,32,28576
 Mvva 116,212,196
  buffer_load_dwordx4 a[96:99], v16, s[20:23], s46 offen offset:0 sc1
 Mvva 120,208,184
 TR 230,32,29088
 Mvva 120,212,200
 Mvva 124,208,188
 TR 208,32,19136
 WL 7
 Mvva 124,212,204
  buffer_load_dwordx4 a[100:103], v16, s[20:23], s46 offen offset:2048 sc1
 Mvva 128,216,176
 TR 210,32,19648
 WL 6
 Mvva 128,220,192
 Mvva 132,216,180
 TR 212,32,28608
 Mvva 132,220,196
 Mvva 136,216,184
 TR 214,32,29120
 Mvva 136,220,200
  buffer_load_dwordx4 a[104:107], v17, s[20:23], s46 offen offset:0 sc1
 Mvva 140,216,188
 TR 216,32,19168
 Mvva 140,220,204
 WL 7
 Mvva 144,224,176
 TR 218,32,19680
 WL 6
 Mvva 144,228,192
  buffer_load_dwordx4 a[108:111], v17, s[20:23], s46 offen offset:2048 sc1
 Mvva 148,224,180
 TR 220,32,28640
 Mvva 148,228,196
  s_add_u32 s46, s24, 40960
 Mvva 152,224,184
 TR 222,32,29152
 Mvva 152,228,200
  buffer_load_dwordx4 a[112:115], v16, s[20:23], s46 offen offset:0 sc1
 Mvva 156,224,188
 TR 224,56,18944
 Mvva 156,228,204
 WL 7
 Mvva 160,208,176
 TR 226,56,19456
 WL 6
 Mvva 160,212,192
 Mvva 164,208,180
 TR 228,56,28416
 Mvva 164,212,196
  buffer_load_dwordx4 a[116:119], v16, s[20:23], s46 offen offset:2048 sc1
 Mvva 168,208,184
 TR 230,56,28928
 Mvva 168,212,200
 Mvva 172,208,188
 WL 6
 Mvva 172,212,204
  buffer_load_dwordx4 a[120:123], v17, s[20:23], s46 offen offset:0 sc1
 Mvva 176,216,176
 WL 4
 Mvva 176,220,192
 WL 0
  s_barrier
 Mvva 180,216,180
 TR 208,33,0
 Mvva 180,220,196
 TR 210,33,512
 Mvva 184,216,184
 TR 212,33,9472
  s_add_u32 s44, s44, 1179648
 Mvva 184,220,200
 TR 214,33,9984
 Mvva 188,216,188
 TR 216,33,32
  s_add_u32 m0, s47, 12288
 Mvva 188,220,204
  buffer_load_dwordx4 a[124:127], v17, s[20:23], s46 offen offset:2048 sc1
 Mvva 192,224,176
 TR 218,33,544
 Mvva 192,228,192
  buffer_load_dwordx4 v1, s[40:43], s44 offen lds
 Mvva 196,224,180
 TR 220,33,9504
 Mvva 196,228,196
 Mvva 200,224,184
 TR 222,33,10016
  s_waitcnt vmcnt(51)
 Mvva 200,228,200
  buffer_load_dwordx4 v2, s[40:43], s44 offen offset:1056 lds
 Mvva 204,224,188
 TR 224,33,64
 Mvva 204,228,204
 WL 7
 Mvva 64,208,144
 TR 226,33,576
 WL 6
 Mvva 64,212,160
  global_load_dword a248, v249, s[100:101]
 Mvva 68,208,148
 TR 228,33,9536
 Mvva 68,212,164
  buffer_load_dwordx4 v3, s[40:43], s44 offen offset:2112 lds
 Mvva 72,208,152
 TR 230,33,10048
 Mvva 72,212,168
 Mvva 76,208,156
 TR 208,33,96
 WL 7
 Mvva 76,212,172
  buffer_load_dwordx4 v4, s[40:43], s44 offen offset:3168 lds
 Mvva 80,216,144
 TR 210,33,608
 WL 6
 Mvva 80,220,160
  s_add_u32 m0, s47, 16512
 Mvva 84,216,148
 TR 212,33,9568
 Mvva 84,220,164
  buffer_load_dwordx4 v5, s[40:43], s44 offen lds
 Mvva 88,216,152
 TR 214,33,10080
 Mvva 88,220,168
 Mvva 92,216,156
 TR 216,33,128
 Mvva 92,220,172
 WL 7
 Mvva 96,224,144
 TR 218,33,640
 WL 6
 Mvva 96,228,160
  buffer_load_dwordx4 v6, s[40:43], s44 offen offset:1056 lds
 Mvva 100,224,148
 TR 220,33,9600
 Mvva 100,228,164
 Mvva 104,224,152
 TR 222,33,10112
 Mvva 104,228,168
  buffer_load_dwordx4 v7, s[40:43], s44 offen offset:2112 lds
 Mvva 108,224,156
 TR 224,33,160
 Mvva 108,228,172
 WL 7
 Mvva 112,208,144
 TR 226,33,672
 WL 6
 Mvva 112,212,160
  buffer_load_dwordx4 v8, s[40:43], s44 offen offset:3168 lds
 Mvva 116,208,148
 TR 228,33,9632
 Mvva 116,212,164
 Mvva 120,208,152
 TR 230,33,10144
  s_add_u32 m0, s47, 20736
 Mvva 120,212,168
 Mvva 124,208,156
 TR 208,33,192
 WL 7
 Mvva 124,212,172
  buffer_load_dwordx4 v9, s[20:23], s44 offen sc1 lds
 Mvva 128,216,144
 TR 210,33,704
 WL 6
 Mvva 128,220,160
  s_add_u32 s46, s24, 49152
 Mvva 132,216,148
 TR 212,33,9664
 Mvva 132,220,164
  buffer_load_dwordx4 a[128:131], v16, s[20:23], s46 offen offset:0 sc1
 Mvva 136,216,152
 TR 214,33,10176
 Mvva 136,220,168
 Mvva 140,216,156
 TR 216,33,224
 Mvva 140,220,172
 WL 7
 Mvva 144,224,144
 TR 218,33,736
 WL 6
 Mvva 144,228,160
  buffer_load_dwordx4 a[132:135], v16, s[20:23], s46 offen offset:2048 sc1
 Mvva 148,224,148
 TR 220,33,9696
 Mvva 148,228,164
 Mvva 152,224,152
 TR 222,33,10208
 Mvva 152,228,168
  buffer_load_dwordx4 a[136:139], v17, s[20:23], s46 offen offset:0 sc1
 Mvva 156,224,156
 TR 224,57,0
 Mvva 156,228,172
 WL 7
 Mvva 160,208,144
 TR 226,57,512
 WL 6
 Mvva 160,212,160
  buffer_load_dwordx4 a[140:143], v17, s[20:23], s46 offen offset:2048 sc1
 Mvva 164,208,148
 TR 228,57,9472
 Mvva 164,212,164
 Mvva 168,208,152
 TR 230,57,9984
  s_add_u32 s46, s24, 57344
 Mvva 168,212,168
 Mvva 172,208,156
 TR 208,33,18944
 WL 7
 Mvva 172,212,172
  buffer_load_dwordx4 v[40:43], v16, s[20:23], s46 offen offset:0 sc1
 Mvva 176,216,144
 TR 210,33,19456
 WL 6
 Mvva 176,220,160
 Mvva 180,216,148
 TR 212,33,28416
 Mvva 180,220,164
  buffer_load_dwordx4 v[44:47], v16, s[20:23], s46 offen offset:2048 sc1
 Mvva 184,216,152
 TR 214,33,28928
 Mvva 184,220,168
 Mvva 188,216,156
 TR 216,33,18976
 WL 7
 Mvva 188,220,172
  buffer_load_dwordx4 v[48:51], v17, s[20:23], s46 offen offset:0 sc1
 Mvva 192,224,144
 TR 218,33,19488
 WL 6
 Mvva 192,228,160
 Mvva 196,224,148
 TR 220,33,28448
 Mvva 196,228,164
 Mvva 200,224,152
 TR 222,33,28960
  s_waitcnt vmcnt(59)
 Mvva 200,228,168
  buffer_load_dwordx4 v[52:55], v17, s[20:23], s46 offen offset:2048 sc1
 Mvva 204,224,156
 TR 224,33,19008
 Mvva 204,228,172
  s_add_u32 s46, s24, 65536
 WL 7
 Mvva 64,208,0
 TR 226,33,19520
 WL 6
 Mvva 64,212,16
  buffer_load_dwordx4 a[212:215], v16, s[20:23], s46 offen offset:0 sc1
 Mvva 68,208,4
 TR 228,33,28480
 Mvva 68,212,20
 Mvva 72,208,8
 TR 230,33,28992
 Mvva 72,212,24
 Mvva 76,208,12
 TR 208,33,19040
 WL 7
 Mvva 76,212,28
  buffer_load_dwordx4 a[216:219], v16, s[20:23], s46 offen offset:2048 sc1
 Mvva 80,216,0
 TR 210,33,19552
 WL 6
 Mvva 80,220,16
 Mvva 84,216,4
 TR 212,33,28512
 Mvva 84,220,20
  buffer_load_dwordx4 a[220:223], v17, s[20:23], s46 offen offset:0 sc1
 Mvva 88,216,8
 TR 214,33,29024
 Mvva 88,220,24
 Mvva 92,216,12
 TR 216,33,19072
 WL 7
 Mvva 92,220,28
  buffer_load_dwordx4 a[224:227], v17, s[20:23], s46 offen offset:2048 sc1
 Mvva 96,224,0
 TR 218,33,19584
 WL 6
 Mvva 96,228,16
 Mvva 100,224,4
 TR 220,33,28544
  s_add_u32 s46, s24, 73728
 Mvva 100,228,20
 Mvva 104,224,8
 TR 222,33,29056
 Mvva 104,228,24
  buffer_load_dwordx4 a[228:231], v16, s[20:23], s46 offen offset:0 sc1
 Mvva 108,224,12
 TR 224,33,19104
 Mvva 108,228,28
 WL 7
 Mvva 112,208,0
 TR 226,33,19616
 WL 6
 Mvva 112,212,16
  buffer_load_dwordx4 a[232:235], v16, s[20:23], s46 offen offset:2048 sc1
 Mvva 116,208,4
 TR 228,33,28576
 Mvva 116,212,20
 Mvva 120,208,8
 TR 230,33,29088
 Mvva 120,212,24
  buffer_load_dwordx4 a[236:239], v17, s[20:23], s46 offen offset:0 sc1
 Mvva 124,208,12
 TR 208,33,19136
 Mvva 124,212,28
 WL 7
 Mvva 128,216,0
 TR 210,33,19648
 WL 6
 Mvva 128,220,16
 Mvva 132,216,4
 TR 212,33,28608
 Mvva 132,220,20
  buffer_load_dwordx4 a[240:243], v17, s[20:23], s46 offen offset:2048 sc1
 Mvva 136,216,8
 TR 214,33,29120
 Mvva 136,220,24
  s_add_u32 s46, s24, 81920
 Mvva 140,216,12
 TR 216,33,19168
 WL 7
 Mvva 140,220,28
  buffer_load_dwordx4 a[176:179], v16, s[20:23], s46 offen offset:0 sc1
 Mvva 144,224,0
 TR 218,33,19680
 WL 6
 Mvva 144,228,16
 Mvva 148,224,4
 TR 220,33,28640
 Mvva 148,228,20
 Mvva 152,224,8
 TR 222,33,29152
 Mvva 152,228,24
  buffer_load_dwordx4 a[180:183], v16, s[20:23], s46 offen offset:2048 sc1
 Mvva 156,224,12
 TR 224,57,18944
 Mvva 156,228,28
 WL 7
 Mvva 160,208,0
 TR 226,57,19456
 WL 6
 Mvva 160,212,16
  buffer_load_dwordx4 a[184:187], v17, s[20:23], s46 offen offset:0 sc1
 Mvva 164,208,4
 TR 228,57,28416
 Mvva 164,212,20
 Mvva 168,208,8
 TR 230,57,28928
 Mvva 168,212,24
  buffer_load_dwordx4 a[188:191], v17, s[20:23], s46 offen offset:2048 sc1
 Mvva 172,208,12
 Mvva 172,212,28
 WL 6
 Mvva 176,216,0
  s_add_u32 s46, s24, 90112
 WL 4
 Mvva 176,220,16
 WL 0
  s_waitcnt vmcnt(62)
  s_barrier
 Mvva 180,216,4
 TR 208,34,0
 Mvva 180,220,20
 TR 210,34,512
  s_add_u32 s44, s44, 1179648
 Mvva 184,216,8
 TR 212,34,9472
 Mvva 184,220,24
 TR 214,34,9984
  s_add_u32 m0, s47, 125952
 Mvva 188,216,12
 TR 216,34,32
 Mvva 188,220,28
  buffer_load_dwordx4 a[192:195], v16, s[20:23], s46 offen offset:0 sc1
 Mvva 192,224,0
 TR 218,34,544
 Mvva 192,228,16
  buffer_load_dwordx4 v1, s[40:43], s44 offen lds
 Mvva 196,224,4
 TR 220,34,9504
 Mvva 196,228,20
  buffer_load_dwordx4 v2, s[40:43], s44 offen offset:1056 lds
 Mvva 200,224,8
 TR 222,34,10016
  s_waitcnt vmcnt(58)
 Mvva 200,228,24
 Mvva 204,224,12
 TR 224,34,64
 Mvva 204,228,28
 WL 7
 Mvva 64,208,32
 TR 226,34,576
 WL 6
 Mvva 64,212,48
  buffer_load_dwordx4 v3, s[40:43], s44 offen offset:2112 lds
 Mvva 68,208,36
 TR 228,34,9536
 Mvva 68,212,52
 Mvva 72,208,40
 TR 230,34,10048
 Mvva 72,212,56
  buffer_load_dwordx4 v4, s[40:43], s44 offen offset:3168 lds
 Mvva 76,208,44
 TR 208,34,96
 Mvva 76,212,60
 WL 7
 WL 5
 Mvva 80,216,32
 TR 210,34,608
  s_add_u32 m0, s47, 130176
 Mvva 80,220,48
 Mvva 84,216,36
 TR 212,34,9568
 Mvva 84,220,52
  buffer_load_dwordx4 v5, s[40:43], s44 offen lds
 Mvva 88,216,40
 TR 214,34,10080
 Mvva 88,220,56
 Mvva 92,216,44
 TR 216,34,128
 WL 7
 Mvva 92,220,60
  buffer_load_dwordx4 v6, s[40:43], s44 offen offset:1056 lds
 Mvva 96,224,32
 TR 218,34,640
 WL 6
 Mvva 96,228,48
 Mvva 100,224,36
 TR 220,34,9600
 Mvva 100,228,52
  buffer_load_dwordx4 v7, s[40:43], s44 offen offset:2112 lds
 Mvva 104,224,40
 TR 222,34,10112
 Mvva 104,228,56
 Mvva 108,224,44
 TR 224,34,160
 Mvva 108,228,60
 WL 7
 Mvva 112,208,32
 TR 226,34,672
 WL 6
 Mvva 112,212,48
  buffer_load_dwordx4 v8, s[40:43], s44 offen offset:3168 lds
 Mvva 116,208,36
 TR 228,34,9632
 Mvva 116,212,52
  s_add_u32 m0, s47, 134400
 Mvva 120,208,40
 TR 230,34,10144
 Mvva 120,212,56
  buffer_load_dwordx4 v9, s[20:23], s44 offen sc1 lds
 Mvva 124,208,44
 TR 208,34,192
 Mvva 124,212,60
 WL 7
 Mvva 128,216,32
 TR 210,34,704
 WL 6
 Mvva 128,220,48
  buffer_load_dwordx4 a[196:199], v16, s[20:23], s46 offen offset:2048 sc1
 Mvva 132,216,36
 TR 212,34,9664
 Mvva 132,220,52
 Mvva 136,216,40
 TR 214,34,10176
 Mvva 136,220,56
 Mvva 140,216,44
 TR 216,34,224
 WL 7
 Mvva 140,220,60
  buffer_load_dwordx4 a[200:203], v17, s[20:23], s46 offen offset:0 sc1
 Mvva 144,224,32
 TR 218,34,736
 WL 6
 Mvva 144,228,48
 Mvva 148,224,36
 TR 220,34,9696
 Mvva 148,228,52
  buffer_load_dwordx4 a[204:207], v17, s[20:23], s46 offen offset:2048 sc1
 Mvva 152,224,40
 TR 222,34,10208
 Mvva 152,228,56
 Mvva 156,224,44
 TR 224,58,0
  s_add_u32 s46, s24, 98304
 Mvva 156,228,60
 WL 7
 Mvva 160,208,32
 TR 226,58,512
 WL 6
 Mvva 160,212,48
  buffer_load_dwordx4 a[144:147], v16, s[20:23], s46 offen offset:0 sc1
 Mvva 164,208,36
 TR 228,58,9472
 Mvva 164,212,52
 Mvva 168,208,40
 TR 230,58,9984
 Mvva 168,212,56
  buffer_load_dwordx4 a[148:151], v16, s[20:23], s46 offen offset:2048 sc1
 Mvva 172,208,44
 TR 208,34,18944
 Mvva 172,212,60
 WL 7
 Mvva 176,216,32
 TR 210,34,19456
 WL 6
 Mvva 176,220,48
  buffer_load_dwordx4 a[152:155], v17, s[20:23], s46 offen offset:0 sc1
 Mvva 180,216,36
 TR 212,34,28416
 Mvva 180,220,52
 Mvva 184,216,40
 TR 214,34,28928
 Mvva 184,220,56
 Mvva 188,216,44
 TR 216,34,18976
 WL 7
 Mvva 188,220,60
  buffer_load_dwordx4 a[156:159], v17, s[20:23], s46 offen offset:2048 sc1
 Mvva 192,224,32
 TR 218,34,19488
 WL 6
 Mvva 192,228,48
  s_add_u32 s46, s24, 106496
 Mvva 196,224,36
 TR 220,34,28448
 Mvva 196,228,52
  buffer_load_dwordx4 a[160:163], v16, s[20:23], s46 offen offset:0 sc1
 Mvva 200,224,40
 TR 222,34,28960
  s_waitcnt vmcnt(62)
 Mvva 200,228,56
 Mvva 204,224,44
 TR 224,34,19008
 WL 7
 Mvva 204,228,60
  buffer_load_dwordx4 a[164:167], v16, s[20:23], s46 offen offset:2048 sc1
 Mvva 64,208,64
 TR 226,34,19520
 WL 6
 Mvva 64,212,80
 Mvva 68,208,68
 TR 228,34,28480
 Mvva 68,212,84
 Mvva 72,208,72
 TR 230,34,28992
 Mvva 72,212,88
  buffer_load_dwordx4 a[168:171], v17, s[20:23], s46 offen offset:0 sc1
 Mvva 76,208,76
 TR 208,34,19040
 Mvva 76,212,92
 WL 7
 Mvva 80,216,64
 TR 210,34,19552
 WL 6
 Mvva 80,220,80
  buffer_load_dwordx4 a[172:175], v17, s[20:23], s46 offen offset:2048 sc1
 Mvva 84,216,68
 TR 212,34,28512
 Mvva 84,220,84
 Mvva 88,216,72
 TR 214,34,29024
  s_add_u32 s46, s24, 114688
 Mvva 88,220,88
 Mvva 92,216,76
 TR 216,34,19072
 WL 7
 Mvva 92,220,92
  buffer_load_dwordx4 a[0:3], v16, s[20:23], s46 offen offset:0 sc1
 Mvva 96,224,64
 TR 218,34,19584
 WL 6
 Mvva 96,228,80
 Mvva 100,224,68
 TR 220,34,28544
 Mvva 100,228,84
  buffer_load_dwordx4 a[4:7], v16, s[20:23], s46 offen offset:2048 sc1
 Mvva 104,224,72
 TR 222,34,29056
 Mvva 104,228,88
 Mvva 108,224,76
 TR 224,34,19104
 WL 7
 Mvva 108,228,92
  buffer_load_dwordx4 a[8:11], v17, s[20:23], s46 offen offset:0 sc1
 Mvva 112,208,64
 TR 226,34,19616
 WL 6
 Mvva 112,212,80
 Mvva 116,208,68
 TR 228,34,28576
 Mvva 116,212,84
 Mvva 120,208,72
 TR 230,34,29088
 Mvva 120,212,88
  buffer_load_dwordx4 a[12:15], v17, s[20:23], s46 offen offset:2048 sc1
 Mvva 124,208,76
 TR 208,34,19136
 Mvva 124,212,92
  s_add_u32 s46, s24, 122880
 WL 7
 Mvva 128,216,64
 TR 210,34,19648
 WL 6
 Mvva 128,220,80
  buffer_load_dwordx4 a[16:19], v16, s[20:23], s46 offen offset:0 sc1
 Mvva 132,216,68
 TR 212,34,28608
 Mvva 132,220,84
 Mvva 136,216,72
 TR 214,34,29120
 Mvva 136,220,88
  buffer_load_dwordx4 a[20:23], v16, s[20:23], s46 offen offset:2048 sc1
 Mvva 140,216,76
 TR 216,34,19168
 Mvva 140,220,92
 WL 7
 Mvva 144,224,64
 TR 218,34,19680
 WL 6
 Mvva 144,228,80
 Mvva 148,224,68
 TR 220,34,28640
 Mvva 148,228,84
  buffer_load_dwordx4 a[24:27], v17, s[20:23], s46 offen offset:0 sc1
 Mvva 152,224,72
 TR 222,34,29152
 Mvva 152,228,88
 Mvva 156,224,76
 TR 224,58,18944
 WL 7
 Mvva 156,228,92
  buffer_load_dwordx4 a[28:31], v17, s[20:23], s46 offen offset:2048 sc1
 Mvva 160,208,64
 TR 226,58,19456
 WL 6
 Mvva 160,212,80
 Mvva 164,208,68
 TR 228,58,28416
 Mvva 164,212,84
 Mvva 168,208,72
 TR 230,58,28928
 Mvva 168,212,88
 Mvva 172,208,76
 Mvva 172,212,92
 WL 6
 Mvva 176,216,64
 WL 4
 Mvva 176,220,80
 WL 0
  s_waitcnt vmcnt(62)
  s_barrier
 Mvva 180,216,68
 TR 208,35,0
 Mvva 180,220,84
 TR 210,35,512
 Mvva 184,216,72
 TR 212,35,9472
 Mvva 184,220,88
 TR 214,35,9984
 Mvva 188,216,76
 TR 216,35,18944
 Mvva 188,220,92
 Mvva 192,224,64
 TR 218,35,19456
 Mvva 192,228,80
 Mvva 196,224,68
 TR 220,35,28416
 Mvva 196,228,84
 Mvva 200,224,72
 TR 222,35,28928
  s_waitcnt vmcnt(59)
 Mvva 200,228,88
 Mvva 204,224,76
 Mvva 204,228,92
 WL 6
 WL 4
 Mvva 64,208,96
  global_load_dword a248, v249, s[100:101]
 Mvva 64,212,112
 WL 0
  s_waitcnt vmcnt(50)
  s_barrier
 Mvva 68,208,100
 TR 224,32,0
 Mvva 68,212,116
 TR 226,32,512
 Mvva 72,208,104
 TR 228,32,9472
  s_waitcnt vmcnt(42)
 Mvva 72,212,120
 TR 230,32,9984
 Mvva 76,208,108
 TR 208,32,18944
 Mvva 76,212,124
 Mvva 64,216,128
 TR 210,32,19456
 Mvvv 64,220,40
 Mvva 68,216,132
 TR 212,32,28416
 Mvvv 68,220,44
 Mvva 72,216,136
 TR 214,32,28928
  s_waitcnt vmcnt(34)
 Mvvv 72,220,48
 Mvva 76,216,140
 Mvvv 76,220,52
 WL 6
 Mvva 64,224,212
 WL 4
 Mvva 64,228,228
 WL 0
  s_waitcnt vmcnt(20)
  s_barrier
 Mvva 68,224,216
 TR 216,33,0
 Mvva 68,228,232
 TR 218,33,512
 Mvva 72,224,220
 TR 220,33,9472
  s_waitcnt vmcnt(17)
 Mvva 72,228,236
 TR 222,33,9984
 Mvva 76,224,224
 TR 224,33,18944
 Mvva 76,228,240
 Mvva 64,208,176
 TR 226,33,19456
 Mvva 64,212,192
 Mvva 68,208,180
 TR 228,33,28416
 Mvva 68,212,196
 Mvva 72,208,184
 TR 230,33,28928
  s_waitcnt vmcnt(9)
 Mvva 72,212,200
 Mvva 76,208,188
 TR 208,35,32
 Mvva 76,212,204
 WL 7
 Mvva 64,216,144
 TR 210,35,544
 WL 6
 Mvva 64,220,160
 Mvva 68,216,148
 TR 212,35,9504
 Mvva 68,220,164
 Mvva 72,216,152
 TR 214,35,10016
  s_waitcnt vmcnt(1)
 Mvva 72,220,168
 Mvva 76,216,156
 TR 216,35,18976
 Mvva 76,220,172
 WL 7
 WL 5
 Mvva 64,224,0
 TR 218,35,19488
  v_and_b32 v247, 7, v0
 Mvva 64,228,16
  v_lshlrev_b32 v247, 2, v247
 Mvva 68,224,4
 TR 220,35,28448
 Mvva 68,228,20
  buffer_load_dword v248, v247, s[20:23], s54 offen offset:32 sc1
 Mvva 72,224,8
 TR 222,35,28960
 Mvva 72,228,24
 Mvva 76,224,12
 TR 224,32,32
 Mvva 76,228,28
 WL 7
 WL 5
 Mvva 80,208,96
 TR 226,32,544
  v_cvt_pk_bf16_f32 v64, v64, v65
 Mvva 80,212,112
  v_cvt_pk_bf16_f32 v65, v66, v67
  v_cvt_pk_bf16_f32 v66, v68, v69
 Mvva 84,208,100
 TR 228,32,9504
  v_cvt_pk_bf16_f32 v67, v70, v71
 Mvva 84,212,116
  v_min_u32 v64, -2, v64
  v_min_u32 v65, -2, v65
 Mvva 88,208,104
 TR 230,32,10016
  v_min_u32 v66, -2, v66
 Mvva 88,212,120
  v_min_u32 v67, -2, v67
 WL 4
 Mvva 92,208,108
 TR 208,32,18976
 WL 7
 Mvva 92,212,124
  buffer_store_dwordx4 v[64:67], v16, s[8:11], 0 offen offset:0 sc1
 Mvva 80,216,128
 TR 210,32,19488
  v_cvt_pk_bf16_f32 v72, v72, v73
 Mvvv 80,220,40
  v_cvt_pk_bf16_f32 v73, v74, v75
  v_cvt_pk_bf16_f32 v74, v76, v77
 Mvva 84,216,132
 TR 212,32,28448
  v_cvt_pk_bf16_f32 v75, v78, v79
 Mvvv 84,220,44
  v_min_u32 v72, -2, v72
  v_min_u32 v73, -2, v73
 Mvva 88,216,136
 TR 214,32,28960
  v_min_u32 v74, -2, v74
 Mvvv 88,220,48
  v_min_u32 v75, -2, v75
 Mvva 92,216,140
 TR 216,33,32
 WL 7
 Mvvv 92,220,52
  buffer_store_dwordx4 v[72:75], v16, s[8:11], s50 offen offset:1024 sc1
 Mvva 80,224,212
 TR 218,33,544
 WL 6
 Mvva 80,228,228
 Mvva 84,224,216
 TR 220,33,9504
 Mvva 84,228,232
 Mvva 88,224,220
 TR 222,33,10016
 Mvva 88,228,236
 Mvva 92,224,224
 TR 224,33,18976
 Mvva 92,228,240
 WL 7
 Mvva 80,208,176
 TR 226,33,19488
 WL 6
 Mvva 80,212,192
 Mvva 84,208,180
 TR 228,33,28448
 Mvva 84,212,196
 Mvva 88,208,184
 TR 230,33,28960
 Mvva 88,212,200
 Mvva 92,208,188
 TR 208,35,64
 Mvva 92,212,204
 WL 7
 Mvva 80,216,144
 TR 210,35,576
 WL 6
 Mvva 80,220,160
 Mvva 84,216,148
 TR 212,35,9536
 Mvva 84,220,164
 Mvva 88,216,152
 TR 214,35,10048
 Mvva 88,220,168
 Mvva 92,216,156
 TR 216,35,19008
 Mvva 92,220,172
 WL 7
 Mvva 80,224,0
 TR 218,35,19520
 WL 6
 Mvva 80,228,16
 Mvva 84,224,4
 TR 220,35,28480
 Mvva 84,228,20
 Mvva 88,224,8
 TR 222,35,28992
 Mvva 88,228,24
 Mvva 92,224,12
 TR 224,32,64
 Mvva 92,228,28
 WL 7
 WL 5
 Mvva 96,208,96
 TR 226,32,576
  v_cvt_pk_bf16_f32 v80, v80, v81
 Mvva 96,212,112
  v_cvt_pk_bf16_f32 v81, v82, v83
  v_cvt_pk_bf16_f32 v82, v84, v85
 Mvva 100,208,100
 TR 228,32,9536
  v_cvt_pk_bf16_f32 v83, v86, v87
 Mvva 100,212,116
  v_min_u32 v80, -2, v80
  v_min_u32 v81, -2, v81
 Mvva 104,208,104
 TR 230,32,10048
  v_min_u32 v82, -2, v82
 Mvva 104,212,120
  v_min_u32 v83, -2, v83
 WL 4
 Mvva 108,208,108
 TR 208,32,19008
 WL 7
 Mvva 108,212,124
  buffer_store_dwordx4 v[80:83], v16, s[8:11], 0 offen offset:1024 sc1
 Mvva 96,216,128
 TR 210,32,19520
  v_cvt_pk_bf16_f32 v88, v88, v89
 Mvvv 96,220,40
  v_cvt_pk_bf16_f32 v89, v90, v91
  v_cvt_pk_bf16_f32 v90, v92, v93
 Mvva 100,216,132
 TR 212,32,28480
  v_cvt_pk_bf16_f32 v91, v94, v95
 Mvvv 100,220,44
  v_min_u32 v88, -2, v88
  v_min_u32 v89, -2, v89
 Mvva 104,216,136
 TR 214,32,28992
  v_min_u32 v90, -2, v90
 Mvvv 104,220,48
  v_min_u32 v91, -2, v91
 Mvva 108,216,140
 TR 216,33,64
 WL 7
 Mvvv 108,220,52
  buffer_store_dwordx4 v[88:91], v16, s[8:11], s50 offen offset:2048 sc1
 Mvva 96,224,212
 TR 218,33,576
 WL 6
 Mvva 96,228,228
 Mvva 100,224,216
 TR 220,33,9536
 Mvva 100,228,232
 Mvva 104,224,220
 TR 222,33,10048
 Mvva 104,228,236
 Mvva 108,224,224
 TR 224,33,19008
 Mvva 108,228,240
 WL 7
 Mvva 96,208,176
 TR 226,33,19520
 WL 6
 Mvva 96,212,192
 Mvva 100,208,180
 TR 228,33,28480
 Mvva 100,212,196
 Mvva 104,208,184
 TR 230,33,28992
 Mvva 104,212,200
 Mvva 108,208,188
 TR 208,35,96
 Mvva 108,212,204
 WL 7
 Mvva 96,216,144
 TR 210,35,608
 WL 6
 Mvva 96,220,160
 Mvva 100,216,148
 TR 212,35,9568
 Mvva 100,220,164
 Mvva 104,216,152
 TR 214,35,10080
  v_mov_b32 v246, 2
 Mvva 104,220,168
 Mvva 108,216,156
 TR 216,35,19040
 Mvva 108,220,172
 WL 7
 Mvva 96,224,0
 TR 218,35,19552
 WL 6
 Mvva 96,228,16
 Mvva 100,224,4
 TR 220,35,28512
 Mvva 100,228,20
 Mvva 104,224,8
 TR 222,35,29024
 Mvva 104,228,24
 Mvva 108,224,12
 TR 224,32,96
 Mvva 108,228,28
 WL 7
 WL 5
 Mvva 112,208,96
 TR 226,32,608
  v_cvt_pk_bf16_f32 v96, v96, v97
 Mvva 112,212,112
  v_cvt_pk_bf16_f32 v97, v98, v99
  v_cvt_pk_bf16_f32 v98, v100, v101
 Mvva 116,208,100
 TR 228,32,9568
  v_cvt_pk_bf16_f32 v99, v102, v103
 Mvva 116,212,116
  v_min_u32 v96, -2, v96
  v_min_u32 v97, -2, v97
 Mvva 120,208,104
 TR 230,32,10080
  v_min_u32 v98, -2, v98
 Mvva 120,212,120
  v_min_u32 v99, -2, v99
 WL 4
 Mvva 124,208,108
 TR 208,32,19040
 WL 7
 Mvva 124,212,124
  buffer_store_dwordx4 v[96:99], v16, s[8:11], 0 offen offset:2048 sc1
 Mvva 112,216,128
 TR 210,32,19552
  v_cvt_pk_bf16_f32 v104, v104, v105
 Mvvv 112,220,40
  v_cvt_pk_bf16_f32 v105, v106, v107
  v_cvt_pk_bf16_f32 v106, v108, v109
 Mvva 116,216,132
 TR 212,32,28512
  v_cvt_pk_bf16_f32 v107, v110, v111
 Mvvv 116,220,44
  v_min_u32 v104, -2, v104
  v_min_u32 v105, -2, v105
 Mvva 120,216,136
 TR 214,32,29024
  v_min_u32 v106, -2, v106
 Mvvv 120,220,48
  v_min_u32 v107, -2, v107
 Mvva 124,216,140
 TR 216,33,96
 WL 7
 Mvvv 124,220,52
  buffer_store_dwordx4 v[104:107], v16, s[8:11], s50 offen offset:3072 sc1
 Mvva 112,224,212
 TR 218,33,608
 WL 6
 Mvva 112,228,228
 Mvva 116,224,216
 TR 220,33,9568
 Mvva 116,228,232
 Mvva 120,224,220
 TR 222,33,10080
 Mvva 120,228,236
 Mvva 124,224,224
 TR 224,33,19040
 Mvva 124,228,240
 WL 7
 Mvva 112,208,176
 TR 226,33,19552
 WL 6
 Mvva 112,212,192
 Mvva 116,208,180
 TR 228,33,28512
 Mvva 116,212,196
 Mvva 120,208,184
 TR 230,33,29024
 Mvva 120,212,200
 Mvva 124,208,188
 TR 208,35,128
 Mvva 124,212,204
 WL 7
 Mvva 112,216,144
 TR 210,35,640
 WL 6
 Mvva 112,220,160
 Mvva 116,216,148
 TR 212,35,9600
 Mvva 116,220,164
 Mvva 120,216,152
 TR 214,35,10112
 Mvva 120,220,168
 Mvva 124,216,156
 TR 216,35,19072
 Mvva 124,220,172
 WL 7
 Mvva 112,224,0
 TR 218,35,19584
 WL 6
 Mvva 112,228,16
 Mvva 116,224,4
 TR 220,35,28544
 Mvva 116,228,20
 Mvva 120,224,8
 TR 222,35,29056
 Mvva 120,228,24
 Mvva 124,224,12
 TR 224,32,128
 Mvva 124,228,28
 WL 7
 WL 5
 Mvva 128,208,96
 TR 226,32,640
  v_cvt_pk_bf16_f32 v112, v112, v113
 Mvva 128,212,112
  v_cvt_pk_bf16_f32 v113, v114, v115
  v_cvt_pk_bf16_f32 v114, v116, v117
 Mvva 132,208,100
 TR 228,32,9600
  v_cvt_pk_bf16_f32 v115, v118, v119
 Mvva 132,212,116
  v_min_u32 v112, -2, v112
  v_min_u32 v113, -2, v113
 Mvva 136,208,104
 TR 230,32,10112
  v_min_u32 v114, -2, v114
 Mvva 136,212,120
  v_min_u32 v115, -2, v115
 WL 4
 Mvva 140,208,108
 TR 208,32,19072
 WL 7
 Mvva 140,212,124
  buffer_store_dwordx4 v[112:115], v16, s[8:11], 0 offen offset:3072 sc1
 Mvva 128,216,128
 TR 210,32,19584
  v_cvt_pk_bf16_f32 v120, v120, v121
 Mvvv 128,220,40
  v_cvt_pk_bf16_f32 v121, v122, v123
  v_cvt_pk_bf16_f32 v122, v124, v125
 Mvva 132,216,132
 TR 212,32,28544
  v_cvt_pk_bf16_f32 v123, v126, v127
 Mvvv 132,220,44
  v_min_u32 v120, -2, v120
  v_min_u32 v121, -2, v121
 Mvva 136,216,136
 TR 214,32,29056
  v_min_u32 v122, -2, v122
 Mvvv 136,220,48
  v_min_u32 v123, -2, v123
 Mvva 140,216,140
 TR 216,33,128
 WL 7
 Mvvv 140,220,52
  buffer_store_dwordx4 v[120:123], v17, s[8:11], s50 offen offset:0 sc1
 Mvva 128,224,212
 TR 218,33,640
 WL 6
 Mvva 128,228,228
 Mvva 132,224,216
 TR 220,33,9600
 Mvva 132,228,232
 Mvva 136,224,220
 TR 222,33,10112
 Mvva 136,228,236
 Mvva 140,224,224
 TR 224,33,19072
 Mvva 140,228,240
 WL 7
 Mvva 128,208,176
 TR 226,33,19584
 WL 6
 Mvva 128,212,192
 Mvva 132,208,180
 TR 228,33,28544
 Mvva 132,212,196
 Mvva 136,208,184
 TR 230,33,29056
 Mvva 136,212,200
 Mvva 140,208,188
 TR 208,35,160
 Mvva 140,212,204
 WL 7
 Mvva 128,216,144
 TR 210,35,672
 WL 6
 Mvva 128,220,160
 Mvva 132,216,148
 TR 212,35,9632
 Mvva 132,220,164
 Mvva 136,216,152
 TR 214,35,10144
 Mvva 136,220,168
 Mvva 140,216,156
 TR 216,35,19104
 Mvva 140,220,172
 WL 7
 Mvva 128,224,0
 TR 218,35,19616
 WL 6
 Mvva 128,228,16
 Mvva 132,224,4
 TR 220,35,28576
 Mvva 132,228,20
 Mvva 136,224,8
 TR 222,35,29088
 Mvva 136,228,24
 Mvva 140,224,12
 TR 224,32,160
 Mvva 140,228,28
 WL 7
 WL 5
 Mvva 144,208,96
 TR 226,32,672
  v_cvt_pk_bf16_f32 v128, v128, v129
 Mvva 144,212,112
  v_cvt_pk_bf16_f32 v129, v130, v131
  v_cvt_pk_bf16_f32 v130, v132, v133
 Mvva 148,208,100
 TR 228,32,9632
  v_cvt_pk_bf16_f32 v131, v134, v135
 Mvva 148,212,116
  v_min_u32 v128, -2, v128
  v_min_u32 v129, -2, v129
 Mvva 152,208,104
 TR 230,32,10144
  v_min_u32 v130, -2, v130
 Mvva 152,212,120
  v_min_u32 v131, -2, v131
 WL 4
 Mvva 156,208,108
 TR 208,32,19104
 WL 7
 Mvva 156,212,124
  buffer_store_dwordx4 v[128:131], v17, s[8:11], 0 offen offset:0 sc1
 Mvva 144,216,128
 TR 210,32,19616
  v_cvt_pk_bf16_f32 v136, v136, v137
 Mvvv 144,220,40
  v_cvt_pk_bf16_f32 v137, v138, v139
  v_cvt_pk_bf16_f32 v138, v140, v141
 Mvva 148,216,132
 TR 212,32,28576
  v_cvt_pk_bf16_f32 v139, v142, v143
 Mvvv 148,220,44
  v_min_u32 v136, -2, v136
  v_min_u32 v137, -2, v137
 Mvva 152,216,136
 TR 214,32,29088
  v_min_u32 v138, -2, v138
 Mvvv 152,220,48
  v_min_u32 v139, -2, v139
 Mvva 156,216,140
 TR 216,33,160
 WL 7
 Mvvv 156,220,52
  buffer_store_dwordx4 v[136:139], v17, s[8:11], s50 offen offset:1024 sc1
 Mvva 144,224,212
 TR 218,33,672
 WL 6
 Mvva 144,228,228
 Mvva 148,224,216
 TR 220,33,9632
 Mvva 148,228,232
 Mvva 152,224,220
 TR 222,33,10144
 Mvva 152,228,236
 Mvva 156,224,224
 TR 224,33,19104
 Mvva 156,228,240
 WL 7
 Mvva 144,208,176
 TR 226,33,19616
 WL 6
 Mvva 144,212,192
 Mvva 148,208,180
 TR 228,33,28576
 Mvva 148,212,196
 Mvva 152,208,184
 TR 230,33,29088
 Mvva 152,212,200
 Mvva 156,208,188
 TR 208,35,192
 Mvva 156,212,204
 WL 7
 Mvva 144,216,144
 TR 210,35,704
 WL 6
 Mvva 144,220,160
 Mvva 148,216,148
 TR 212,35,9664
 Mvva 148,220,164
 Mvva 152,216,152
 TR 214,35,10176
 Mvva 152,220,168
 Mvva 156,216,156
 TR 216,35,19136
 Mvva 156,220,172
 WL 7
 Mvva 144,224,0
 TR 218,35,19648
 WL 6
 Mvva 144,228,16
 Mvva 148,224,4
 TR 220,35,28608
 Mvva 148,228,20
 Mvva 152,224,8
 TR 222,35,29120
 Mvva 152,228,24
 Mvva 156,224,12
 TR 224,32,192
 Mvva 156,228,28
 WL 7
 WL 5
 Mvva 160,208,96
 TR 226,32,704
  v_cvt_pk_bf16_f32 v144, v144, v145
 Mvva 160,212,112
  v_cvt_pk_bf16_f32 v145, v146, v147
  v_cvt_pk_bf16_f32 v146, v148, v149
 Mvva 164,208,100
 TR 228,32,9664
  v_cvt_pk_bf16_f32 v147, v150, v151
 Mvva 164,212,116
  v_min_u32 v144, -2, v144
  v_min_u32 v145, -2, v145
 Mvva 168,208,104
 TR 230,32,10176
  v_min_u32 v146, -2, v146
 Mvva 168,212,120
  v_min_u32 v147, -2, v147
 WL 4
 Mvva 172,208,108
 TR 208,32,19136
 WL 7
 Mvva 172,212,124
  buffer_store_dwordx4 v[144:147], v17, s[8:11], 0 offen offset:1024 sc1
 Mvva 160,216,128
 TR 210,32,19648
  v_cvt_pk_bf16_f32 v152, v152, v153
 Mvvv 160,220,40
  v_cvt_pk_bf16_f32 v153, v154, v155
  v_cvt_pk_bf16_f32 v154, v156, v157
 Mvva 164,216,132
 TR 212,32,28608
  v_cvt_pk_bf16_f32 v155, v158, v159
 Mvvv 164,220,44
  s_waitcnt vmcnt(11)
  v_cmp_gt_u32 vcc, 1, v248
  s_nop 4
  s_cbranch_vccnz Lpoll_pz_12
Lback_pz_12:
 Mvva 168,216,136
 TR 214,32,29120
  v_min_u32 v152, -2, v152
 Mvvv 168,220,48
 WL 6
  v_min_u32 v153, -2, v153
  v_min_u32 v154, -2, v154
 Mvva 172,216,140
 TR 216,33,192
  v_min_u32 v155, -2, v155
 Mvvv 172,220,52
  buffer_store_dwordx4 v[152:155], v17, s[8:11], s50 offen offset:2048 sc1
 Mvva 160,224,212
 TR 218,33,704
  s_add_u32 s46, s55, 0
 WL 6
 Mvva 160,228,228
  buffer_load_dwordx4 v[64:67], v28, s[20:23], s46 offen sc1
 Mvva 164,224,216
 TR 220,33,9664
 Mvva 164,228,232
 Mvva 168,224,220
 TR 222,33,10176
 Mvva 168,228,236
 Mvva 172,224,224
 TR 224,33,19136
 Mvva 172,228,240
 WL 7
 WL 5
 Mvva 160,208,176
 TR 226,33,19648
  s_add_u32 s46, s55, 18432
 Mvva 160,212,192
  buffer_load_dwordx4 v[68:71], v28, s[20:23], s46 offen sc1
 Mvva 164,208,180
 TR 228,33,28608
 Mvva 164,212,196
  v_mov_b32 v128, 0
  v_mov_b32 v129, 0
 Mvva 168,208,184
 TR 230,33,29120
  v_mov_b32 v130, 0
 Mvva 168,212,200
 WL 4
  v_mov_b32 v131, 0
  v_mov_b32 v132, 0
 Mvva 172,208,188
 TR 208,35,224
  v_mov_b32 v133, 0
 Mvva 172,212,204
 WL 7
  v_mov_b32 v134, 0
  v_mov_b32 v135, 0
 Mvva 160,216,144
 TR 210,35,736
  v_mov_b32 v136, 0
 Mvva 160,220,160
  v_mov_b32 v137, 0
  v_mov_b32 v138, 0
 Mvva 164,216,148
 TR 212,35,9696
  s_add_u32 s46, s55, 36864
 Mvva 164,220,164
  buffer_load_dwordx4 v[72:75], v28, s[20:23], s46 offen sc1
 Mvva 168,216,152
 TR 214,35,10208
  v_mov_b32 v139, 0
 Mvva 168,220,168
 WL 4
  v_mov_b32 v140, 0
  v_mov_b32 v141, 0
 Mvva 172,216,156
 TR 216,35,19168
  v_mov_b32 v142, 0
 Mvva 172,220,172
 WL 7
  v_mov_b32 v143, 0
  v_mov_b32 v144, 0
 Mvva 160,224,0
 TR 218,35,19680
  v_mov_b32 v145, 0
 Mvva 160,228,16
 Mvva 164,224,4
 TR 220,35,28640
 Mvva 164,228,20
 Mvva 168,224,8
 TR 222,35,29152
  s_add_u32 s46, s55, 55296
 Mvva 168,228,24
  buffer_load_dwordx4 v[76:79], v28, s[20:23], s46 offen sc1
 Mvva 172,224,12
 TR 224,32,224
 Mvva 172,228,28
 WL 7
 WL 5
 Mvva 176,208,96
 TR 226,32,736
  v_cvt_pk_bf16_f32 v160, v160, v161
 Mvva 176,212,112
  v_cvt_pk_bf16_f32 v161, v162, v163
  v_cvt_pk_bf16_f32 v162, v164, v165
 Mvva 180,208,100
 TR 228,32,9696
  v_cvt_pk_bf16_f32 v163, v166, v167
 Mvva 180,212,116
  v_min_u32 v160, -2, v160
  v_min_u32 v161, -2, v161
 Mvva 184,208,104
 TR 230,32,10208
  v_min_u32 v162, -2, v162
 Mvva 184,212,120
 WL 4
  v_min_u32 v163, -2, v163
 WL 6
 Mvva 188,208,108
 TR 208,32,19168
  s_add_u32 s46, s55, 73728
 Mvva 188,212,124
  buffer_store_dwordx4 v[160:163], v17, s[8:11], 0 offen offset:2048 sc1
 Mvva 176,216,128
 TR 210,32,19680
  v_cvt_pk_bf16_f32 v168, v168, v169
 Mvvv 176,220,40
  buffer_load_dwordx4 v[80:83], v28, s[20:23], s46 offen sc1
 Mvva 180,216,132
 TR 212,32,28640
  v_cvt_pk_bf16_f32 v169, v170, v171
 Mvvv 180,220,44
  v_cvt_pk_bf16_f32 v170, v172, v173
  v_cvt_pk_bf16_f32 v171, v174, v175
 Mvva 184,216,136
 TR 214,32,29152
  v_min_u32 v168, -2, v168
 Mvvv 184,220,48
 WL 6
  v_min_u32 v169, -2, v169
  v_min_u32 v170, -2, v170
 Mvva 188,216,140
 TR 216,33,224
  v_min_u32 v171, -2, v171
 Mvvv 188,220,52
  buffer_store_dwordx4 v[168:171], v17, s[8:11], s50 offen offset:3072 sc1
 Mvva 176,224,212
 TR 218,33,736
  s_add_u32 s46, s55, 92160
 WL 6
 Mvva 176,228,228
  buffer_load_dwordx4 v[84:87], v28, s[20:23], s46 offen sc1
 Mvva 180,224,216
 TR 220,33,9696
 Mvva 180,228,232
 Mvva 184,224,220
 TR 222,33,10208
 Mvva 184,228,236
 Mvva 188,224,224
 TR 224,33,19168
 Mvva 188,228,240
 WL 7
 Mvva 176,208,176
 TR 226,33,19680
 WL 6
 Mvva 176,212,192
 Mvva 180,208,180
 TR 228,33,28640
  s_add_u32 s46, s55, 110592
 Mvva 180,212,196
  buffer_load_dword v248, v247, s[20:23], s54 offen offset:32 sc1
 Mvva 184,208,184
 TR 230,33,29152
 Mvva 184,212,200
  buffer_load_dwordx4 v[88:91], v28, s[20:23], s46 offen sc1
 Mvva 188,208,188
 TR 208,59,0
 Mvva 188,212,204
 WL 7
 Mvva 176,216,144
 TR 210,59,512
 WL 6
 Mvva 176,220,160
 Mvva 180,216,148
 TR 212,59,9472
 Mvva 180,220,164
 Mvva 184,216,152
 TR 214,59,9984
  s_add_u32 s46, s55, 129024
 Mvva 184,220,168
  buffer_load_dwordx4 v[92:95], v28, s[20:23], s46 offen sc1
 Mvva 188,216,156
 TR 216,59,18944
 Mvva 188,220,172
 WL 7
 Mvva 176,224,0
 TR 218,59,19456
 WL 6
 Mvva 176,228,16
 Mvva 180,224,4
 TR 220,59,28416
 Mvva 180,228,20
 Mvva 184,224,8
 TR 222,59,28928
 Mvva 184,228,24
 Mvva 188,224,12
 TR 224,56,0
 Mvva 188,228,28
 WL 7
 WL 5
 Mvva 192,208,96
 TR 226,56,512
  v_cvt_pk_bf16_f32 v176, v176, v177
 Mvva 192,212,112
  v_cvt_pk_bf16_f32 v177, v178, v179
  v_cvt_pk_bf16_f32 v178, v180, v181
 Mvva 196,208,100
 TR 228,56,9472
  v_cvt_pk_bf16_f32 v179, v182, v183
 Mvva 196,212,116
  v_min_u32 v176, -2, v176
  v_min_u32 v177, -2, v177
 Mvva 200,208,104
 TR 230,56,9984
  v_min_u32 v178, -2, v178
 Mvva 200,212,120
  v_min_u32 v179, -2, v179
 WL 4
 Mvva 204,208,108
 TR 208,56,18944
 WL 7
 Mvva 204,212,124
  buffer_store_dwordx4 v[176:179], v17, s[8:11], 0 offen offset:3072 sc1
 Mvva 192,216,128
 TR 210,56,19456
  v_cvt_pk_bf16_f32 v184, v184, v185
 Mvvv 192,220,40
  buffer_store_dword v246, v245, s[20:23], s66 offen sc1
 Mvva 196,216,132
 TR 212,56,28416
  v_cvt_pk_bf16_f32 v185, v186, v187
 Mvvv 196,220,44
  v_cvt_pk_bf16_f32 v186, v188, v189
  v_cvt_pk_bf16_f32 v187, v190, v191
 Mvva 200,216,136
 TR 214,56,28928
  v_min_u32 v184, -2, v184
 Mvvv 200,220,48
 WL 6
  v_min_u32 v185, -2, v185
  v_min_u32 v186, -2, v186
 Mvva 204,216,140
 TR 216,57,0
  v_min_u32 v187, -2, v187
 Mvvv 204,220,52
  buffer_store_dwordx4 v[184:187], v16, s[8:11], s51 offen offset:0 sc1
 Mvva 192,224,212
 TR 218,57,512
 WL 6
 Mvva 192,228,228
 Mvva 196,224,216
 TR 220,57,9472
 Mvva 196,228,232
 Mvva 200,224,220
 TR 222,57,9984
 Mvva 200,228,236
 Mvva 204,224,224
 TR 224,57,18944
 Mvva 204,228,240
 WL 7
 Mvva 192,208,176
 TR 226,57,19456
 WL 6
 Mvva 192,212,192
 Mvva 196,208,180
 TR 228,57,28416
 Mvva 196,212,196
 Mvva 200,208,184
 TR 230,57,28928
 Mvva 200,212,200
 Mvva 204,208,188
 Mvva 204,212,204
 WL 6
 Mvva 192,216,144
 WL 4
 Mvva 192,220,160
 Mvva 196,216,148
 Mvva 196,220,164
 Mvva 200,216,152
 Mvva 200,220,168
 Mvva 204,216,156
 Mvva 204,220,172
 WL 2
 Mvva 192,224,0
 WL 0
 Mvva 192,228,16
 Mvva 196,224,4
 Mvva 196,228,20
 Mvva 200,224,8
 Mvva 200,228,24
 Mvva 204,224,12
 Mvva 204,228,28
  s_nop 1
  v_cvt_pk_bf16_f32 v192, v192, v193
  v_cvt_pk_bf16_f32 v193, v194, v195
  v_cvt_pk_bf16_f32 v194, v196, v197
  v_cvt_pk_bf16_f32 v195, v198, v199
  v_min_u32 v192, -2, v192
  v_min_u32 v193, -2, v193
  v_min_u32 v194, -2, v194
  v_min_u32 v195, -2, v195
  buffer_store_dwordx4 v[192:195], v16, s[8:11], s50 offen offset:0 sc1
  v_cvt_pk_bf16_f32 v200, v200, v201
  v_cvt_pk_bf16_f32 v201, v202, v203
  v_cvt_pk_bf16_f32 v202, v204, v205
  v_cvt_pk_bf16_f32 v203, v206, v207
  v_min_u32 v200, -2, v200
  v_min_u32 v201, -2, v201
  v_min_u32 v202, -2, v202
  v_min_u32 v203, -2, v203
  buffer_store_dwordx4 v[200:203], v16, s[8:11], s51 offen offset:1024 sc1
  s_waitcnt vmcnt(7)
  v_cmp_gt_u32 vcc, 2, v248
  s_nop 4
  s_cbranch_vccnz Lpoll_red_12
Lback_red_12:
  s_add_u32 s46, s55, 4096
  buffer_load_dwordx4 v[96:99], v28, s[20:23], s46 offen sc1
  buffer_load_dword v232, v29, s[20:23], s46 offen sc1
  s_add_u32 s46, s55, 22528
  buffer_load_dwordx4 v[100:103], v28, s[20:23], s46 offen sc1
  buffer_load_dword v233, v29, s[20:23], s46 offen sc1
  s_add_u32 s46, s55, 40960
  buffer_load_dwordx4 v[104:107], v28, s[20:23], s46 offen sc1
  buffer_load_dword v234, v29, s[20:23], s46 offen sc1
  s_add_u32 s46, s55, 59392
  buffer_load_dwordx4 v[108:111], v28, s[20:23], s46 offen sc1
  buffer_load_dword v235, v29, s[20:23], s46 offen sc1
  s_add_u32 s46, s55, 77824
  buffer_load_dwordx4 v[112:115], v28, s[20:23], s46 offen sc1
  buffer_load_dword v236, v29, s[20:23], s46 offen sc1
  s_add_u32 s46, s55, 96256
  buffer_load_dwordx4 v[116:119], v28, s[20:23], s46 offen sc1
  buffer_load_dword v237, v29, s[20:23], s46 offen sc1
  s_add_u32 s46, s55, 114688
  buffer_load_dwordx4 v[120:123], v28, s[20:23], s46 offen sc1
  buffer_load_dword v238, v29, s[20:23], s46 offen sc1
  s_add_u32 s46, s55, 133120
  buffer_load_dwordx4 v[124:127], v28, s[20:23], s46 offen sc1
  buffer_load_dword v239, v29, s[20:23], s46 offen sc1
  s_load_dwordx2 s[16:17], s[0:1], 80
  s_mov_b32 s18, 0x240000
  s_mov_b32 s19, 0x00020000
Lchk_12:
  s_bitcmp1_b32 s57, 0
  s_cbranch_scc0 Lskip0_12
  v_max3_u32 v36, v64, v65, v66
  v_max3_u32 v36, v36, v67, v67
  v_cmp_eq_u32 vcc, -1, v36
  s_nop 4
  s_cbranch_vccnz Lskip0_12
  v_lshlrev_b32 v36, 16, v64
  v_and_b32 v37, 0xffff0000, v64
  v_pk_add_f32 v[128:129], v[128:129], v[36:37]
  v_lshlrev_b32 v36, 16, v65
  v_and_b32 v37, 0xffff0000, v65
  v_pk_add_f32 v[130:131], v[130:131], v[36:37]
  v_lshlrev_b32 v36, 16, v66
  v_and_b32 v37, 0xffff0000, v66
  v_pk_add_f32 v[132:133], v[132:133], v[36:37]
  v_lshlrev_b32 v36, 16, v67
  v_and_b32 v37, 0xffff0000, v67
  v_pk_add_f32 v[134:135], v[134:135], v[36:37]
  s_bitset0_b32 s57, 0
Lskip0_12:
  s_bitcmp1_b32 s57, 1
  s_cbranch_scc0 Lskip1_12
  v_max3_u32 v36, v68, v69, v70
  v_max3_u32 v36, v36, v71, v71
  v_cmp_eq_u32 vcc, -1, v36
  s_nop 4
  s_cbranch_vccnz Lskip1_12
  v_lshlrev_b32 v36, 16, v68
  v_and_b32 v37, 0xffff0000, v68
  v_pk_add_f32 v[128:129], v[128:129], v[36:37]
  v_lshlrev_b32 v36, 16, v69
  v_and_b32 v37, 0xffff0000, v69
  v_pk_add_f32 v[130:131], v[130:131], v[36:37]
  v_lshlrev_b32 v36, 16, v70
  v_and_b32 v37, 0xffff0000, v70
  v_pk_add_f32 v[132:133], v[132:133], v[36:37]
  v_lshlrev_b32 v36, 16, v71
  v_and_b32 v37, 0xffff0000, v71
  v_pk_add_f32 v[134:135], v[134:135], v[36:37]
  s_bitset0_b32 s57, 1
Lskip1_12:
  s_bitcmp1_b32 s57, 2
  s_cbranch_scc0 Lskip2_12
  v_max3_u32 v36, v72, v73, v74
  v_max3_u32 v36, v36, v75, v75
  v_cmp_eq_u32 vcc, -1, v36
  s_nop 4
  s_cbranch_vccnz Lskip2_12
  v_lshlrev_b32 v36, 16, v72
  v_and_b32 v37, 0xffff0000, v72
  v_pk_add_f32 v[128:129], v[128:129], v[36:37]
  v_lshlrev_b32 v36, 16, v73
  v_and_b32 v37, 0xffff0000, v73
  v_pk_add_f32 v[130:131], v[130:131], v[36:37]
  v_lshlrev_b32 v36, 16, v74
  v_and_b32 v37, 0xffff0000, v74
  v_pk_add_f32 v[132:133], v[132:133], v[36:37]
  v_lshlrev_b32 v36, 16, v75
  v_and_b32 v37, 0xffff0000, v75
  v_pk_add_f32 v[134:135], v[134:135], v[36:37]
  s_bitset0_b32 s57, 2
Lskip2_12:
  s_bitcmp1_b32 s57, 3
  s_cbranch_scc0 Lskip3_12
  v_max3_u32 v36, v76, v77, v78
  v_max3_u32 v36, v36, v79, v79
  v_cmp_eq_u32 vcc, -1, v36
  s_nop 4
  s_cbranch_vccnz Lskip3_12
  v_lshlrev_b32 v36, 16, v76
  v_and_b32 v37, 0xffff0000, v76
  v_pk_add_f32 v[128:129], v[128:129], v[36:37]
  v_lshlrev_b32 v36, 16, v77
  v_and_b32 v37, 0xffff0000, v77
  v_pk_add_f32 v[130:131], v[130:131], v[36:37]
  v_lshlrev_b32 v36, 16, v78
  v_and_b32 v37, 0xffff0000, v78
  v_pk_add_f32 v[132:133], v[132:133], v[36:37]
  v_lshlrev_b32 v36, 16, v79
  v_and_b32 v37, 0xffff0000, v79
  v_pk_add_f32 v[134:135], v[134:135], v[36:37]
  s_bitset0_b32 s57, 3
Lskip3_12:
  s_bitcmp1_b32 s57, 4
  s_cbranch_scc0 Lskip4_12
  v_max3_u32 v36, v80, v81, v82
  v_max3_u32 v36, v36, v83, v83
  v_cmp_eq_u32 vcc, -1, v36
  s_nop 4
  s_cbranch_vccnz Lskip4_12
  v_lshlrev_b32 v36, 16, v80
  v_and_b32 v37, 0xffff0000, v80
  v_pk_add_f32 v[128:129], v[128:129], v[36:37]
  v_lshlrev_b32 v36, 16, v81
  v_and_b32 v37, 0xffff0000, v81
  v_pk_add_f32 v[130:131], v[130:131], v[36:37]
  v_lshlrev_b32 v36, 16, v82
  v_and_b32 v37, 0xffff0000, v82
  v_pk_add_f32 v[132:133], v[132:133], v[36:37]
  v_lshlrev_b32 v36, 16, v83
  v_and_b32 v37, 0xffff0000, v83
  v_pk_add_f32 v[134:135], v[134:135], v[36:37]
  s_bitset0_b32 s57, 4
Lskip4_12:
  s_bitcmp1_b32 s57, 5
  s_cbranch_scc0 Lskip5_12
  v_max3_u32 v36, v84, v85, v86
  v_max3_u32 v36, v36, v87, v87
  v_cmp_eq_u32 vcc, -1, v36
  s_nop 4
  s_cbranch_vccnz Lskip5_12
  v_lshlrev_b32 v36, 16, v84
  v_and_b32 v37, 0xffff0000, v84
  v_pk_add_f32 v[128:129], v[128:129], v[36:37]
  v_lshlrev_b32 v36, 16, v85
  v_and_b32 v37, 0xffff0000, v85
  v_pk_add_f32 v[130:131], v[130:131], v[36:37]
  v_lshlrev_b32 v36, 16, v86
  v_and_b32 v37, 0xffff0000, v86
  v_pk_add_f32 v[132:133], v[132:133], v[36:37]
  v_lshlrev_b32 v36, 16, v87
  v_and_b32 v37, 0xffff0000, v87
  v_pk_add_f32 v[134:135], v[134:135], v[36:37]
  s_bitset0_b32 s57, 5
Lskip5_12:
  s_bitcmp1_b32 s57, 6
  s_cbranch_scc0 Lskip6_12
  s_waitcnt vmcnt(22)
  v_max3_u32 v36, v88, v89, v90
  v_max3_u32 v36, v36, v91, v91
  v_cmp_eq_u32 vcc, -1, v36
  s_nop 4
  s_cbranch_vccnz Lskip6_12
  v_lshlrev_b32 v36, 16, v88
  v_and_b32 v37, 0xffff0000, v88
  v_pk_add_f32 v[128:129], v[128:129], v[36:37]
  v_lshlrev_b32 v36, 16, v89
  v_and_b32 v37, 0xffff0000, v89
  v_pk_add_f32 v[130:131], v[130:131], v[36:37]
  v_lshlrev_b32 v36, 16, v90
  v_and_b32 v37, 0xffff0000, v90
  v_pk_add_f32 v[132:133], v[132:133], v[36:37]
  v_lshlrev_b32 v36, 16, v91
  v_and_b32 v37, 0xffff0000, v91
  v_pk_add_f32 v[134:135], v[134:135], v[36:37]
  s_bitset0_b32 s57, 6
Lskip6_12:
  s_bitcmp1_b32 s57, 7
  s_cbranch_scc0 Lskip7_12
  s_waitcnt vmcnt(21)
  v_max3_u32 v36, v92, v93, v94
  v_max3_u32 v36, v36, v95, v95
  v_cmp_eq_u32 vcc, -1, v36
  s_nop 4
  s_cbranch_vccnz Lskip7_12
  v_lshlrev_b32 v36, 16, v92
  v_and_b32 v37, 0xffff0000, v92
  v_pk_add_f32 v[128:129], v[128:129], v[36:37]
  v_lshlrev_b32 v36, 16, v93
  v_and_b32 v37, 0xffff0000, v93
  v_pk_add_f32 v[130:131], v[130:131], v[36:37]
  v_lshlrev_b32 v36, 16, v94
  v_and_b32 v37, 0xffff0000, v94
  v_pk_add_f32 v[132:133], v[132:133], v[36:37]
  v_lshlrev_b32 v36, 16, v95
  v_and_b32 v37, 0xffff0000, v95
  v_pk_add_f32 v[134:135], v[134:135], v[36:37]
  s_bitset0_b32 s57, 7
Lskip7_12:
  s_bitcmp1_b32 s57, 8
  s_cbranch_scc0 Lskip8_12
  s_waitcnt vmcnt(15)
  v_max3_u32 v36, v96, v97, v98
  s_waitcnt vmcnt(14)
  v_max3_u32 v36, v36, v99, v232
  v_cmp_eq_u32 vcc, -1, v36
  s_nop 4
  s_cbranch_vccnz Lskip8_12
  v_lshlrev_b32 v36, 16, v96
  v_and_b32 v37, 0xffff0000, v96
  v_pk_add_f32 v[136:137], v[136:137], v[36:37]
  v_lshlrev_b32 v36, 16, v97
  v_and_b32 v37, 0xffff0000, v97
  v_pk_add_f32 v[138:139], v[138:139], v[36:37]
  v_lshlrev_b32 v36, 16, v98
  v_and_b32 v37, 0xffff0000, v98
  v_pk_add_f32 v[140:141], v[140:141], v[36:37]
  v_lshlrev_b32 v36, 16, v99
  v_and_b32 v37, 0xffff0000, v99
  v_pk_add_f32 v[142:143], v[142:143], v[36:37]
  v_lshlrev_b32 v36, 16, v232
  v_and_b32 v37, 0xffff0000, v232
  v_pk_add_f32 v[144:145], v[144:145], v[36:37]
  s_bitset0_b32 s57, 8
Lskip8_12:
  s_bitcmp1_b32 s57, 9
  s_cbranch_scc0 Lskip9_12
  s_waitcnt vmcnt(13)
  v_max3_u32 v36, v100, v101, v102
  s_waitcnt vmcnt(12)
  v_max3_u32 v36, v36, v103, v233
  v_cmp_eq_u32 vcc, -1, v36
  s_nop 4
  s_cbranch_vccnz Lskip9_12
  v_lshlrev_b32 v36, 16, v100
  v_and_b32 v37, 0xffff0000, v100
  v_pk_add_f32 v[136:137], v[136:137], v[36:37]
  v_lshlrev_b32 v36, 16, v101
  v_and_b32 v37, 0xffff0000, v101
  v_pk_add_f32 v[138:139], v[138:139], v[36:37]
  v_lshlrev_b32 v36, 16, v102
  v_and_b32 v37, 0xffff0000, v102
  v_pk_add_f32 v[140:141], v[140:141], v[36:37]
  v_lshlrev_b32 v36, 16, v103
  v_and_b32 v37, 0xffff0000, v103
  v_pk_add_f32 v[142:143], v[142:143], v[36:37]
  v_lshlrev_b32 v36, 16, v233
  v_and_b32 v37, 0xffff0000, v233
  v_pk_add_f32 v[144:145], v[144:145], v[36:37]
  s_bitset0_b32 s57, 9
Lskip9_12:
  s_bitcmp1_b32 s57, 10
  s_cbranch_scc0 Lskip10_12
  s_waitcnt vmcnt(11)
  v_max3_u32 v36, v104, v105, v106
  s_waitcnt vmcnt(10)
  v_max3_u32 v36, v36, v107, v234
  v_cmp_eq_u32 vcc, -1, v36
  s_nop 4
  s_cbranch_vccnz Lskip10_12
  v_lshlrev_b32 v36, 16, v104
  v_and_b32 v37, 0xffff0000, v104
  v_pk_add_f32 v[136:137], v[136:137], v[36:37]
  v_lshlrev_b32 v36, 16, v105
  v_and_b32 v37, 0xffff0000, v105
  v_pk_add_f32 v[138:139], v[138:139], v[36:37]
  v_lshlrev_b32 v36, 16, v106
  v_and_b32 v37, 0xffff0000, v106
  v_pk_add_f32 v[140:141], v[140:141], v[36:37]
  v_lshlrev_b32 v36, 16, v107
  v_and_b32 v37, 0xffff0000, v107
  v_pk_add_f32 v[142:143], v[142:143], v[36:37]
  v_lshlrev_b32 v36, 16, v234
  v_and_b32 v37, 0xffff0000, v234
  v_pk_add_f32 v[144:145], v[144:145], v[36:37]
  s_bitset0_b32 s57, 10
Lskip10_12:
  s_bitcmp1_b32 s57, 11
  s_cbranch_scc0 Lskip11_12
  s_waitcnt vmcnt(9)
  v_max3_u32 v36, v108, v109, v110
  s_waitcnt vmcnt(8)
  v_max3_u32 v36, v36, v111, v235
  v_cmp_eq_u32 vcc, -1, v36
  s_nop 4
  s_cbranch_vccnz Lskip11_12
  v_lshlrev_b32 v36, 16, v108
  v_and_b32 v37, 0xffff0000, v108
  v_pk_add_f32 v[136:137], v[136:137], v[36:37]
  v_lshlrev_b32 v36, 16, v109
  v_and_b32 v37, 0xffff0000, v109
  v_pk_add_f32 v[138:139], v[138:139], v[36:37]
  v_lshlrev_b32 v36, 16, v110
  v_and_b32 v37, 0xffff0000, v110
  v_pk_add_f32 v[140:141], v[140:141], v[36:37]
  v_lshlrev_b32 v36, 16, v111
  v_and_b32 v37, 0xffff0000, v111
  v_pk_add_f32 v[142:143], v[142:143], v[36:37]
  v_lshlrev_b32 v36, 16, v235
  v_and_b32 v37, 0xffff0000, v235
  v_pk_add_f32 v[144:145], v[144:145], v[36:37]
  s_bitset0_b32 s57, 11
Lskip11_12:
  s_bitcmp1_b32 s57, 12
  s_cbranch_scc0 Lskip12_12
  s_waitcnt vmcnt(7)
  v_max3_u32 v36, v112, v113, v114
  s_waitcnt vmcnt(6)
  v_max3_u32 v36, v36, v115, v236
  v_cmp_eq_u32 vcc, -1, v36
  s_nop 4
  s_cbranch_vccnz Lskip12_12
  v_lshlrev_b32 v36, 16, v112
  v_and_b32 v37, 0xffff0000, v112
  v_pk_add_f32 v[136:137], v[136:137], v[36:37]
  v_lshlrev_b32 v36, 16, v113
  v_and_b32 v37, 0xffff0000, v113
  v_pk_add_f32 v[138:139], v[138:139], v[36:37]
  v_lshlrev_b32 v36, 16, v114
  v_and_b32 v37, 0xffff0000, v114
  v_pk_add_f32 v[140:141], v[140:141], v[36:37]
  v_lshlrev_b32 v36, 16, v115
  v_and_b32 v37, 0xffff0000, v115
  v_pk_add_f32 v[142:143], v[142:143], v[36:37]
  v_lshlrev_b32 v36, 16, v236
  v_and_b32 v37, 0xffff0000, v236
  v_pk_add_f32 v[144:145], v[144:145], v[36:37]
  s_bitset0_b32 s57, 12
Lskip12_12:
  s_bitcmp1_b32 s57, 13
  s_cbranch_scc0 Lskip13_12
  s_waitcnt vmcnt(5)
  v_max3_u32 v36, v116, v117, v118
  s_waitcnt vmcnt(4)
  v_max3_u32 v36, v36, v119, v237
  v_cmp_eq_u32 vcc, -1, v36
  s_nop 4
  s_cbranch_vccnz Lskip13_12
  v_lshlrev_b32 v36, 16, v116
  v_and_b32 v37, 0xffff0000, v116
  v_pk_add_f32 v[136:137], v[136:137], v[36:37]
  v_lshlrev_b32 v36, 16, v117
  v_and_b32 v37, 0xffff0000, v117
  v_pk_add_f32 v[138:139], v[138:139], v[36:37]
  v_lshlrev_b32 v36, 16, v118
  v_and_b32 v37, 0xffff0000, v118
  v_pk_add_f32 v[140:141], v[140:141], v[36:37]
  v_lshlrev_b32 v36, 16, v119
  v_and_b32 v37, 0xffff0000, v119
  v_pk_add_f32 v[142:143], v[142:143], v[36:37]
  v_lshlrev_b32 v36, 16, v237
  v_and_b32 v37, 0xffff0000, v237
  v_pk_add_f32 v[144:145], v[144:145], v[36:37]
  s_bitset0_b32 s57, 13
Lskip13_12:
  s_bitcmp1_b32 s57, 14
  s_cbranch_scc0 Lskip14_12
  s_waitcnt vmcnt(3)
  v_max3_u32 v36, v120, v121, v122
  s_waitcnt vmcnt(2)
  v_max3_u32 v36, v36, v123, v238
  v_cmp_eq_u32 vcc, -1, v36
  s_nop 4
  s_cbranch_vccnz Lskip14_12
  v_lshlrev_b32 v36, 16, v120
  v_and_b32 v37, 0xffff0000, v120
  v_pk_add_f32 v[136:137], v[136:137], v[36:37]
  v_lshlrev_b32 v36, 16, v121
  v_and_b32 v37, 0xffff0000, v121
  v_pk_add_f32 v[138:139], v[138:139], v[36:37]
  v_lshlrev_b32 v36, 16, v122
  v_and_b32 v37, 0xffff0000, v122
  v_pk_add_f32 v[140:141], v[140:141], v[36:37]
  v_lshlrev_b32 v36, 16, v123
  v_and_b32 v37, 0xffff0000, v123
  v_pk_add_f32 v[142:143], v[142:143], v[36:37]
  v_lshlrev_b32 v36, 16, v238
  v_and_b32 v37, 0xffff0000, v238
  v_pk_add_f32 v[144:145], v[144:145], v[36:37]
  s_bitset0_b32 s57, 14
Lskip14_12:
  s_bitcmp1_b32 s57, 15
  s_cbranch_scc0 Lskip15_12
  s_waitcnt vmcnt(1)
  v_max3_u32 v36, v124, v125, v126
  s_waitcnt vmcnt(0)
  v_max3_u32 v36, v36, v127, v239
  v_cmp_eq_u32 vcc, -1, v36
  s_nop 4
  s_cbranch_vccnz Lskip15_12
  v_lshlrev_b32 v36, 16, v124
  v_and_b32 v37, 0xffff0000, v124
  v_pk_add_f32 v[136:137], v[136:137], v[36:37]
  v_lshlrev_b32 v36, 16, v125
  v_and_b32 v37, 0xffff0000, v125
  v_pk_add_f32 v[138:139], v[138:139], v[36:37]
  v_lshlrev_b32 v36, 16, v126
  v_and_b32 v37, 0xffff0000, v126
  v_pk_add_f32 v[140:141], v[140:141], v[36:37]
  v_lshlrev_b32 v36, 16, v127
  v_and_b32 v37, 0xffff0000, v127
  v_pk_add_f32 v[142:143], v[142:143], v[36:37]
  v_lshlrev_b32 v36, 16, v239
  v_and_b32 v37, 0xffff0000, v239
  v_pk_add_f32 v[144:145], v[144:145], v[36:37]
  s_bitset0_b32 s57, 15
Lskip15_12:
  s_cmp_lg_u32 s57, 0
  s_cbranch_scc1 Lretry_12
  v_cvt_pk_bf16_f32 v64, v128, v129
  v_cvt_pk_bf16_f32 v65, v130, v131
  v_cvt_pk_bf16_f32 v66, v132, v133
  v_cvt_pk_bf16_f32 v67, v134, v135
  v_cvt_pk_bf16_f32 v68, v136, v137
  v_cvt_pk_bf16_f32 v69, v138, v139
  v_cvt_pk_bf16_f32 v70, v140, v141
  v_cvt_pk_bf16_f32 v71, v142, v143
  v_cvt_pk_bf16_f32 v72, v144, v145
 WL 0
  buffer_store_dwordx2 v[64:65], v30, s[16:19], s56 offen offset:0
  buffer_store_dwordx2 v[66:67], v30, s[16:19], s69 offen offset:0
  buffer_store_dwordx2 v[68:69], v30, s[16:19], s56 offen offset:128
  buffer_store_dwordx2 v[70:71], v30, s[16:19], s69 offen offset:128
  buffer_store_dword v72, v31, s[16:19], s56 offen
Lexit_12:
  s_endpgm
Lpoll_ctx_12:
  buffer_load_dword v248, v247, s[20:23], s54 offen offset:16 sc1
  s_waitcnt vmcnt(0)
  v_cmp_gt_u32 vcc, 1, v248
  s_nop 4
  s_cbranch_vccz Lback_ctx_12
  s_branch Lpoll_ctx_12
Lpoll_pz_12:
  buffer_load_dword v248, v247, s[20:23], s54 offen offset:32 sc1
  s_waitcnt vmcnt(0)
  v_cmp_gt_u32 vcc, 1, v248
  s_nop 4
  s_cbranch_vccz Lback_pz_12
  s_branch Lpoll_pz_12
Lpoll_red_12:
  buffer_load_dword v248, v247, s[20:23], s54 offen offset:32 sc1
  s_waitcnt vmcnt(0)
  v_cmp_gt_u32 vcc, 2, v248
  s_nop 4
  s_cbranch_vccz Lback_red_12
  s_branch Lpoll_red_12
Lretry_12:
  s_bitcmp1_b32 s57, 0
  s_cbranch_scc0 Lrskip0_12
  s_add_u32 s46, s55, 0
  buffer_load_dwordx4 v[64:67], v28, s[20:23], s46 offen sc1
Lrskip0_12:
  s_bitcmp1_b32 s57, 1
  s_cbranch_scc0 Lrskip1_12
  s_add_u32 s46, s55, 18432
  buffer_load_dwordx4 v[68:71], v28, s[20:23], s46 offen sc1
Lrskip1_12:
  s_bitcmp1_b32 s57, 2
  s_cbranch_scc0 Lrskip2_12
  s_add_u32 s46, s55, 36864
  buffer_load_dwordx4 v[72:75], v28, s[20:23], s46 offen sc1
Lrskip2_12:
  s_bitcmp1_b32 s57, 3
  s_cbranch_scc0 Lrskip3_12
  s_add_u32 s46, s55, 55296
  buffer_load_dwordx4 v[76:79], v28, s[20:23], s46 offen sc1
Lrskip3_12:
  s_bitcmp1_b32 s57, 4
  s_cbranch_scc0 Lrskip4_12
  s_add_u32 s46, s55, 73728
  buffer_load_dwordx4 v[80:83], v28, s[20:23], s46 offen sc1
Lrskip4_12:
  s_bitcmp1_b32 s57, 5
  s_cbranch_scc0 Lrskip5_12
  s_add_u32 s46, s55, 92160
  buffer_load_dwordx4 v[84:87], v28, s[20:23], s46 offen sc1
Lrskip5_12:
  s_bitcmp1_b32 s57, 6
  s_cbranch_scc0 Lrskip6_12
  s_add_u32 s46, s55, 110592
  buffer_load_dwordx4 v[88:91], v28, s[20:23], s46 offen sc1
Lrskip6_12:
  s_bitcmp1_b32 s57, 7
  s_cbranch_scc0 Lrskip7_12
  s_add_u32 s46, s55, 129024
  buffer_load_dwordx4 v[92:95], v28, s[20:23], s46 offen sc1
Lrskip7_12:
  s_bitcmp1_b32 s57, 8
  s_cbranch_scc0 Lrskip8_12
  s_add_u32 s46, s55, 4096
  buffer_load_dwordx4 v[96:99], v28, s[20:23], s46 offen sc1
  buffer_load_dword v232, v29, s[20:23], s46 offen sc1
Lrskip8_12:
  s_bitcmp1_b32 s57, 9
  s_cbranch_scc0 Lrskip9_12
  s_add_u32 s46, s55, 22528
  buffer_load_dwordx4 v[100:103], v28, s[20:23], s46 offen sc1
  buffer_load_dword v233, v29, s[20:23], s46 offen sc1
Lrskip9_12:
  s_bitcmp1_b32 s57, 10
  s_cbranch_scc0 Lrskip10_12
  s_add_u32 s46, s55, 40960
  buffer_load_dwordx4 v[104:107], v28, s[20:23], s46 offen sc1
  buffer_load_dword v234, v29, s[20:23], s46 offen sc1
Lrskip10_12:
  s_bitcmp1_b32 s57, 11
  s_cbranch_scc0 Lrskip11_12
  s_add_u32 s46, s55, 59392
  buffer_load_dwordx4 v[108:111], v28, s[20:23], s46 offen sc1
  buffer_load_dword v235, v29, s[20:23], s46 offen sc1
Lrskip11_12:
  s_bitcmp1_b32 s57, 12
  s_cbranch_scc0 Lrskip12_12
  s_add_u32 s46, s55, 77824
  buffer_load_dwordx4 v[112:115], v28, s[20:23], s46 offen sc1
  buffer_load_dword v236, v29, s[20:23], s46 offen sc1
Lrskip12_12:
  s_bitcmp1_b32 s57, 13
  s_cbranch_scc0 Lrskip13_12
  s_add_u32 s46, s55, 96256
  buffer_load_dwordx4 v[116:119], v28, s[20:23], s46 offen sc1
  buffer_load_dword v237, v29, s[20:23], s46 offen sc1
Lrskip13_12:
  s_bitcmp1_b32 s57, 14
  s_cbranch_scc0 Lrskip14_12
  s_add_u32 s46, s55, 114688
  buffer_load_dwordx4 v[120:123], v28, s[20:23], s46 offen sc1
  buffer_load_dword v238, v29, s[20:23], s46 offen sc1
Lrskip14_12:
  s_bitcmp1_b32 s57, 15
  s_cbranch_scc0 Lrskip15_12
  s_add_u32 s46, s55, 133120
  buffer_load_dwordx4 v[124:127], v28, s[20:23], s46 offen sc1
  buffer_load_dword v239, v29, s[20:23], s46 offen sc1
Lrskip15_12:
  s_waitcnt vmcnt(0)
  s_branch Lchk_12
Lp4e_12:
Lend:
  s_endpgm
.section .rodata,"a"
.p2align 6
.amdhsa_kernel gated_mix__compressed_kv_cla__dense_activation_silu__prompt_kernel
  .amdhsa_next_free_vgpr 512
  .amdhsa_next_free_sgpr 102
  .amdhsa_accum_offset 256
  .amdhsa_group_segment_fixed_size 0
  .amdhsa_kernarg_size 104
  .amdhsa_user_sgpr_count 2
  .amdhsa_user_sgpr_kernarg_segment_ptr 1
  .amdhsa_system_sgpr_workgroup_id_x 1
.end_amdhsa_kernel
```
